```python
import torch

def _softmax(x, axis=-1):
    return torch.softmax(x, dim=axis)
def _gelu(x):
    return torch.nn.functional.gelu(x, approximate="tanh")
def _silu(x):
    return torch.nn.functional.silu(x)
def _sigmoid(x):
    return torch.sigmoid(x)
def _layernorm(x, axis=-1, eps=1e-5):
    m = x.mean(dim=axis, keepdim=True)
    v = x.var(dim=axis, keepdim=True, unbiased=False)
    return (x - m) / torch.sqrt(v + eps)
def _scatter_add(tgt, idx, src, axis=0):
    return tgt.clone().index_add_(axis, idx, src)
def _segment_sum(src, seg, n):
    out = torch.zeros((n,) + src.shape[1:], dtype=src.dtype)
    return out.index_add_(0, seg, src)
def _pad(x, pw):
    flat = tuple(v for pair in reversed(pw) for v in pair)
    return torch.nn.functional.pad(x, flat)

kernel_name = 'recurrent_scan__sliding_block_cached__dense_activation_silu__prompt'

def setup_inputs():

    _w = (lambda a: (lambda t: t.to(torch.bfloat16) if t.is_floating_point() else t)(torch.as_tensor(a)))
    def _A_setup():
        B, Sq, D = 1, 2048, 576
        Hq, Hkv, Sk, Dh = 32, 16, 2048, 128
        assert Hq % Hkv == 0, (Hq, Hkv)
        return {
            "x": _w((lambda *s: torch.randn(*s, dtype=torch.bfloat16) * 0.05)(B, Sq, D)),
            "k_cache": _w((lambda *s: torch.randn(*s, dtype=torch.bfloat16) * 1.6)(B, Hkv, Sk, Dh)),
            "v_cache": _w((lambda *s: torch.randn(*s, dtype=torch.bfloat16) * 0.8)(B, Hkv, Sk, Dh)),
            "wq": _w((lambda *s: torch.randn(*s, dtype=torch.bfloat16) * 1.6)(D, Hq * Dh) * (D ** -0.5)),
            "wo": _w((lambda *s: torch.randn(*s, dtype=torch.bfloat16) * 0.8)(Hq * Dh, D) * ((Hq * Dh) ** -0.5)),
        }
    _A_in = _A_setup()

    def _B_setup():
        B, S, D, F = 1, 2048, 576, 4608
        return {
            "x": _w((lambda *s: torch.randn(*s, dtype=torch.bfloat16) * 0.05)(B, S, D)),
            "w1": _w((lambda *s: torch.randn(*s, dtype=torch.bfloat16) * 1.6)(D, F) * (D ** -0.5)),
            "w2": _w((lambda *s: torch.randn(*s, dtype=torch.bfloat16) * 0.2)(F, D) * (F ** -0.5)),
        }
    _B_in = _B_setup()

    return {
        "A_x": _A_in["x"],
        "A_k_cache": _A_in["k_cache"],
        "A_v_cache": _A_in["v_cache"],
        "A_wq": _A_in["wq"],
        "A_wo": _A_in["wo"],
        "B_x": _B_in["x"],
        "B_w1": _B_in["w1"],
        "B_w2": _B_in["w2"],
    }

def reference(A_x, A_k_cache, A_v_cache, A_wq, A_wo, B_x, B_w1, B_w2):
    def _A_ref(x, k_cache, v_cache, wq, wo):
        B, Sq, D = x.shape
        Hq, Dh = 32, 128
        Hkv, Sk = k_cache.shape[1], k_cache.shape[2]
        W = min(4096, max(256, Sk // 4))
        rep = Hq // Hkv
        q = (lambda x, *d: x.permute(*d))((x @ wq).reshape(B, Sq, Hq, Dh), 0, 2, 1, 3)
        k = (lambda x, n, axis: torch.repeat_interleave(x, n, dim=axis))(k_cache[:, :, Sk - W:, :], rep, axis=1)
        v = (lambda x, n, axis: torch.repeat_interleave(x, n, dim=axis))(v_cache[:, :, Sk - W:, :], rep, axis=1)
        scores = torch.einsum("bhqd,bhkd->bhqk", q, k) * (Dh ** -0.5)
        p = _softmax(scores, axis=-1)
        o = torch.einsum("bhqk,bhkd->bhqd", p, v)
        return (lambda x, *d: x.permute(*d))(o, 0, 2, 1, 3).reshape(B, Sq, Hq * Dh) @ wo

    def _B_ref(x, w1, w2):
        h = torch.einsum("bsd,df->bsf", x, w1)
        h = _silu(h)
        out = torch.einsum("bsf,fd->bsd", h, w2)
        return out

    x = A_x
    xn = _layernorm(x, axis=-1)
    s = _A_ref(xn, A_k_cache, A_v_cache, A_wq, A_wo)
    g = _silu(_B_ref(xn, B_w1, B_w2))
    return x + s * g
```

```asm
; @launch grid=(256,1,1) block=(256,1,1) lds=163840
.amdgcn_target "amdgcn-amd-amdhsa--gfx950"
.macro MC d,a,b
 v_mfma_f32_16x16x32_bf16 a[\d:\d+3], a[\a:\a+3], v[\b:\b+3], a[\d:\d+3]
.endm
.macro NV d,a,b
 v_mfma_f32_32x32x16_bf16 v[\d:\d+15], a[\a:\a+3], v[\b:\b+3], v[\d:\d+15]
.endm
.macro NA d,a,b
 v_mfma_f32_32x32x16_bf16 v[\d:\d+15], a[\a:\a+3], a[\b:\b+3], v[\d:\d+15]
.endm
.macro MV d,a,b
 v_mfma_f32_16x16x32_bf16 v[\d:\d+3], a[\a:\a+3], v[\b:\b+3], v[\d:\d+3]
.endm
.macro MA d,a,b
 v_mfma_f32_16x16x32_bf16 v[\d:\d+3], a[\a:\a+3], a[\b:\b+3], v[\d:\d+3]
.endm
.macro RT d,a,o
 ds_read_b64_tr_b16 a[\d:\d+1], v\a offset:\o
.endm
.macro RB d,a,o
 ds_read_b128 a[\d:\d+3], v\a offset:\o
.endm
.macro CV d,a,b
 v_cvt_pk_bf16_f32 v\d, v\a, v\b
.endm
.macro AW d,a
 v_accvgpr_write_b32 a\d, v\a
.endm
.macro EX d,a
 v_exp_f32 v\d, v\a
.endm
.macro AD d,a,b
 v_add_f32 v\d, v\a, v\b
.endm
.macro ML d,a,b
 v_mul_f32 v\d, v\a, v\b
.endm
.macro WL n
 s_waitcnt lgkmcnt(\n)
.endm
.text
.globl recurrent_scan__sliding_block_cached__dense_activation_silu__prompt_kernel
.p2align 8
.type recurrent_scan__sliding_block_cached__dense_activation_silu__prompt_kernel,@function
recurrent_scan__sliding_block_cached__dense_activation_silu__prompt_kernel:
 s_cmp_ge_u32 s2, 0x100
 s_cbranch_scc0 L_go
 s_endpgm
L_go:
 s_load_dwordx8 s[40:47], s[0:1], 0
 s_load_dwordx2 s[48:49], s[0:1], 32
 s_load_dwordx8 s[52:59], s[0:1], 48
 s_load_dwordx2 s[50:51], s[0:1], 80
 s_bfe_u32 s3, s2, 0x20003
 s_bfe_u32 s4, s2, 0x10001
 s_lshl_b32 s4, s4, 2
 s_or_b32 s3, s3, s4
 s_lshl_b32 s3, s3, 2
 s_bitcmp1_b32 s2, 2
 s_mov_b32 s4, 0xc543b210
 s_cselect_b32 s4, 0xfa98ed76, s4
 s_lshr_b32 s4, s4, s3
 s_and_b32 s63, s4, 15
 s_and_b32 s3, s2, 1
 s_lshl_b32 s3, s3, 3
 s_lshr_b32 s64, s2, 5
 s_or_b32 s64, s64, s3
 v_lshrrev_b32 v1, 6, v0
 s_nop 0
 v_readfirstlane_b32 s62, v1
 v_and_b32 v0, 63, v0
 v_lshrrev_b32 v1, 3, v0
 v_and_b32 v20, 7, v0
 v_lshrrev_b32 v21, 4, v0
 v_xor_b32 v22, v20, v21
 v_xor_b32 v23, 4, v22
 s_mov_b32 s3, 0x480
 v_mul_u32_u24 v24, s3, v1
 v_lshl_add_u32 v16, v22, 4, v24
 v_lshl_add_u32 v17, v23, 4, v24
 v_add_u32 v17, 0x2000, v17
 v_add_u32 v18, 0x4000, v16
 v_add_u32 v19, 0x4000, v17
 s_mul_i32 s6, s62, 0x9000
 s_lshl_b32 s7, s64, 2
 s_add_u32 s7, s7, s62
 s_mul_i32 s7, s7, 0x9000
 s_getpc_b64 s[94:95]
L_pc:
 s_mov_b32 s4, L_roleA-L_pc
 s_mov_b32 s5, L_roleA_end-L_pc-4
 s_cmp_ge_u32 s63, 10
 s_cselect_b32 s4, L_roleM-L_pc, s4
 s_cselect_b32 s5, L_roleM_end-L_pc-4, s5
 s_cmp_ge_u32 s63, 11
 s_cselect_b32 s4, L_roleF-L_pc, s4
 s_cselect_b32 s5, L_roleF_end-L_pc-4, s5
 WL 0
 s_mov_b32 s8, s40
 s_and_b32 s9, s41, 0xffff
 s_mov_b32 s10, 0x240000
 s_mov_b32 s11, 0x20000
 s_add_u32 m0, s6, 0
 s_add_u32 s70, s7, 0
 buffer_load_dwordx4 v16, s[8:11], s70 offen lds
 buffer_load_dwordx4 v17, s[8:11], s70 offen offset:1024 lds
 buffer_load_dwordx4 v18, s[8:11], s70 offen offset:2048 lds
 buffer_load_dwordx4 v19, s[8:11], s70 offen offset:3072 lds
 s_add_u32 m0, s6, 0x1000
 s_add_u32 s70, s7, 0x80
 buffer_load_dwordx4 v16, s[8:11], s70 offen lds
 buffer_load_dwordx4 v17, s[8:11], s70 offen offset:1024 lds
 buffer_load_dwordx4 v18, s[8:11], s70 offen offset:2048 lds
 buffer_load_dwordx4 v19, s[8:11], s70 offen offset:3072 lds
 s_add_u32 m0, s6, 0x2000
 s_add_u32 s70, s7, 0x100
 buffer_load_dwordx4 v16, s[8:11], s70 offen lds
 buffer_load_dwordx4 v17, s[8:11], s70 offen offset:1024 lds
 buffer_load_dwordx4 v18, s[8:11], s70 offen offset:2048 lds
 buffer_load_dwordx4 v19, s[8:11], s70 offen offset:3072 lds
 s_add_u32 m0, s6, 0x3000
 s_add_u32 s70, s7, 0x180
 buffer_load_dwordx4 v16, s[8:11], s70 offen lds
 buffer_load_dwordx4 v17, s[8:11], s70 offen offset:1024 lds
 buffer_load_dwordx4 v18, s[8:11], s70 offen offset:2048 lds
 buffer_load_dwordx4 v19, s[8:11], s70 offen offset:3072 lds
 s_add_u32 m0, s6, 0x4000
 s_add_u32 s70, s7, 0x200
 buffer_load_dwordx4 v16, s[8:11], s70 offen lds
 buffer_load_dwordx4 v17, s[8:11], s70 offen offset:1024 lds
 buffer_load_dwordx4 v18, s[8:11], s70 offen offset:2048 lds
 buffer_load_dwordx4 v19, s[8:11], s70 offen offset:3072 lds
 s_and_b32 s3, s64, 7
 s_lshl_b32 s3, s3, 2
 s_add_u32 s3, s3, s62
 s_mul_i32 s3, s3, 0xc00
 s_add_u32 s3, s3, s4
 v_min_u32 v2, 23, v0
 v_lshlrev_b32 v2, 7, v2
 v_add_u32 v2, s3, v2
 v_min_u32 v3, s5, v2
 global_load_dword v47, v3, s[94:95]
 s_mov_b32 s12, s42
 s_and_b32 s13, s43, 0xffff
 s_mov_b32 s14, 0x800000
 s_mov_b32 s15, 0x20000
 s_mov_b32 s16, s44
 s_and_b32 s17, s45, 0xffff
 s_mov_b32 s18, 0x800000
 s_mov_b32 s19, 0x20000
 s_mov_b32 s20, s46
 s_and_b32 s21, s47, 0xffff
 s_mov_b32 s22, 0x480000
 s_mov_b32 s23, 0x20000
 s_mov_b32 s24, s48
 s_and_b32 s25, s49, 0xffff
 s_mov_b32 s26, 0x480000
 s_mov_b32 s27, 0x20000
 s_mov_b32 s28, s52
 s_and_b32 s29, s53, 0xffff
 s_mov_b32 s30, 0x510000
 s_mov_b32 s31, 0x20000
 s_mov_b32 s32, s54
 s_and_b32 s33, s55, 0xffff
 s_mov_b32 s34, 0x510000
 s_mov_b32 s35, 0x20000
 s_mov_b32 s36, s50
 s_and_b32 s37, s51, 0xffff
 s_mov_b32 s38, 0x10000000
 s_mov_b32 s39, 0x20000
 s_mov_b32 s48, s56
 s_and_b32 s49, s57, 0xffff
 s_mov_b32 s50, 0x240000
 s_mov_b32 s51, 0x20000
 s_mov_b32 s52, s58
 s_and_b32 s53, s59, 0xffff
 s_mov_b32 s54, 0x100
 s_mov_b32 s55, 0x20000
 s_mul_i32 s65, s62, 0x2200
 s_mul_i32 s66, s62, 0x440
 s_add_u32 s66, s66, 0x8800
 s_lshl_b32 s67, s62, 13
 s_lshl_b32 s68, s62, 10
 s_add_u32 s68, s68, 0x8000
 s_mul_i32 s69, s62, 0x880
 s_mul_i32 s60, s62, 0x1100
 s_add_u32 s61, s69, 0x4400
 s_cmp_ge_u32 s63, 11
 s_cbranch_scc1 L_roleF
 s_cmp_ge_u32 s63, 10
 s_getpc_b64 s[94:95]
L_pc2:
 s_cbranch_scc1 L_jM
 s_add_u32 s94, s94, L_roleA-L_pc2
 s_addc_u32 s95, s95, 0
 s_setpc_b64 s[94:95]
L_jM:
 s_add_u32 s94, s94, L_roleM-L_pc2
 s_addc_u32 s95, s95, 0
 s_setpc_b64 s[94:95]
.p2align 6
L_roleF:
 v_lshrrev_b32 v48, 4, v0
 v_and_b32 v49, 15, v0
 v_bfe_u32 v50, v0, 1, 3
 v_xor_b32 v50, v50, v48
 v_lshlrev_b32 v49, 7, v49
 v_add_u32 v49, s6, v49
 v_lshl_add_u32 v20, v50, 4, v49
 v_xor_b32 v21, 64, v20
 v_mov_b32 v56, 0
 v_mov_b32 v57, 0
 v_mov_b32 v58, 0
 v_mov_b32 v59, 0
 v_mov_b32 v60, 0
 v_mov_b32 v61, 0
 v_mov_b32 v62, 0
 v_mov_b32 v63, 0
 s_mov_b32 s97, 0x3f803f80
 s_waitcnt vmcnt(17)
 ds_read_b128 v[112:115], v20 offset:0
 ds_read_b128 v[116:119], v20 offset:2048
 ds_read_b128 v[120:123], v21 offset:0
 ds_read_b128 v[124:127], v21 offset:2048
 s_add_u32 m0, s6, 0x5000
 s_add_u32 s70, s7, 0x280
 buffer_load_dwordx4 v16, s[8:11], s70 offen lds
 buffer_load_dwordx4 v17, s[8:11], s70 offen offset:1024 lds
 buffer_load_dwordx4 v18, s[8:11], s70 offen offset:2048 lds
 buffer_load_dwordx4 v19, s[8:11], s70 offen offset:3072 lds
 s_lshl_b32 s92, s64, 2
 s_add_u32 s92, s92, s62
 s_lshl_b32 s92, s92, 16
 v_or_b32 v38, s92, v0
 s_sub_u32 s3, s63, 11
 s_mul_i32 s44, s3, 0x680
 s_lshl_b32 s45, s3, 6
 s_add_u32 s45, s45, 0x2280
 s_mul_i32 s73, s62, 0x90000
 s_add_u32 s73, s73, s44
 s_mul_i32 s74, s62, 0x12000
 s_add_u32 s74, s74, s44
 s_add_u32 s74, s74, 0x240000
 s_mul_i32 s75, s62, 0x120000
 s_add_u32 s75, s75, s45
 s_mul_i32 s76, s62, 0x24000
 s_add_u32 s76, s76, s45
 s_waitcnt vmcnt(17)
 ds_read_b128 v[128:131], v20 offset:4096
 ds_read_b128 v[132:135], v20 offset:6144
 ds_read_b128 v[136:139], v21 offset:4096
 ds_read_b128 v[140:143], v21 offset:6144
 s_add_u32 m0, s6, 0x6000
 s_add_u32 s70, s7, 0x300
 buffer_load_dwordx4 v16, s[8:11], s70 offen lds
 buffer_load_dwordx4 v17, s[8:11], s70 offen offset:1024 lds
 buffer_load_dwordx4 v18, s[8:11], s70 offen offset:2048 lds
 buffer_load_dwordx4 v19, s[8:11], s70 offen offset:3072 lds
 s_add_u32 s76, s76, 0x480000
 s_mul_i32 s46, s44, 0x240
 s_mul_i32 s47, s45, 0x240
 s_mul_i32 s84, s62, 0x12000
 s_add_u32 s84, s84, s46
 s_mul_i32 s85, s62, 0x1200
 s_add_u32 s86, s85, s47
 s_add_u32 s85, s85, s46
 s_add_u32 s85, s85, 0x48000
 v_bfe_u32 v40, v38, 16, 5
 v_and_b32 v8, 63, v38
 v_min_u32 v8, 17, v8
 v_mad_u32_u24 v8, v40, 18, v8
 s_mov_b32 s92, 0x2400
 v_mul_u32_u24 v8, s92, v8
 s_add_u32 s3, s44, 0
 s_add_u32 s93, s63, 1
 WL 4
 v_dot2c_f32_bf16 v56, s97, v112
 v_dot2c_f32_bf16 v60, v112, v112
 v_dot2c_f32_bf16 v57, s97, v113
 v_dot2c_f32_bf16 v61, v113, v113
 v_dot2c_f32_bf16 v56, s97, v114
 v_dot2c_f32_bf16 v60, v114, v114
 v_dot2c_f32_bf16 v57, s97, v115
 v_dot2c_f32_bf16 v61, v115, v115
 v_dot2c_f32_bf16 v58, s97, v116
 v_dot2c_f32_bf16 v62, v116, v116
 v_dot2c_f32_bf16 v59, s97, v117
 v_dot2c_f32_bf16 v63, v117, v117
 v_dot2c_f32_bf16 v58, s97, v118
 v_dot2c_f32_bf16 v62, v118, v118
 v_dot2c_f32_bf16 v59, s97, v119
 v_dot2c_f32_bf16 v63, v119, v119
 v_dot2c_f32_bf16 v56, s97, v120
 v_dot2c_f32_bf16 v60, v120, v120
 v_dot2c_f32_bf16 v57, s97, v121
 v_dot2c_f32_bf16 v61, v121, v121
 v_dot2c_f32_bf16 v56, s97, v122
 v_dot2c_f32_bf16 v60, v122, v122
 v_dot2c_f32_bf16 v57, s97, v123
 v_dot2c_f32_bf16 v61, v123, v123
 v_dot2c_f32_bf16 v58, s97, v124
 v_dot2c_f32_bf16 v62, v124, v124
 v_dot2c_f32_bf16 v59, s97, v125
 v_dot2c_f32_bf16 v63, v125, v125
 v_dot2c_f32_bf16 v58, s97, v126
 v_dot2c_f32_bf16 v62, v126, v126
 v_dot2c_f32_bf16 v59, s97, v127
 v_dot2c_f32_bf16 v63, v127, v127
 s_waitcnt vmcnt(17)
 ds_read_b128 v[144:147], v20 offset:8192
 ds_read_b128 v[148:151], v20 offset:10240
 ds_read_b128 v[152:155], v21 offset:8192
 ds_read_b128 v[156:159], v21 offset:10240
 s_add_u32 m0, s6, 0x7000
 s_add_u32 s70, s7, 0x380
 buffer_load_dwordx4 v16, s[8:11], s70 offen lds
 buffer_load_dwordx4 v17, s[8:11], s70 offen offset:1024 lds
 buffer_load_dwordx4 v18, s[8:11], s70 offen offset:2048 lds
 buffer_load_dwordx4 v19, s[8:11], s70 offen offset:3072 lds
 s_mul_i32 s90, s93, 0x240000
 s_lshl_b32 s93, s64, 2
 s_add_u32 s93, s93, s62
 s_mul_i32 s93, s93, 0x9000
 s_add_u32 s90, s90, s93
 s_lshl_b32 s92, s64, 14
 s_add_u32 s92, s92, 0x2f00000
 s_add_u32 s93, s63, 1
 s_lshl_b32 s93, s93, 2
 s_add_u32 s93, s93, s92
 s_cmp_eq_u32 s62, 0
 s_cselect_b32 s93, s93, 0x10000000
 s_cselect_b32 s92, s92, 0x10000000
 v_and_b32 v24, 15, v0
 v_lshlrev_b32 v25, 7, v24
 v_add_u32 v25, 0x80, v25
 v_cmp_eq_u32 vcc, 0, v24
 s_nop 1
 v_cndmask_b32 v25, v25, v24, vcc
 WL 4
 v_dot2c_f32_bf16 v56, s97, v128
 v_dot2c_f32_bf16 v60, v128, v128
 v_dot2c_f32_bf16 v57, s97, v129
 v_dot2c_f32_bf16 v61, v129, v129
 v_dot2c_f32_bf16 v56, s97, v130
 v_dot2c_f32_bf16 v60, v130, v130
 v_dot2c_f32_bf16 v57, s97, v131
 v_dot2c_f32_bf16 v61, v131, v131
 v_dot2c_f32_bf16 v58, s97, v132
 v_dot2c_f32_bf16 v62, v132, v132
 v_dot2c_f32_bf16 v59, s97, v133
 v_dot2c_f32_bf16 v63, v133, v133
 v_dot2c_f32_bf16 v58, s97, v134
 v_dot2c_f32_bf16 v62, v134, v134
 v_dot2c_f32_bf16 v59, s97, v135
 v_dot2c_f32_bf16 v63, v135, v135
 v_dot2c_f32_bf16 v56, s97, v136
 v_dot2c_f32_bf16 v60, v136, v136
 v_dot2c_f32_bf16 v57, s97, v137
 v_dot2c_f32_bf16 v61, v137, v137
 v_dot2c_f32_bf16 v56, s97, v138
 v_dot2c_f32_bf16 v60, v138, v138
 v_dot2c_f32_bf16 v57, s97, v139
 v_dot2c_f32_bf16 v61, v139, v139
 v_dot2c_f32_bf16 v58, s97, v140
 v_dot2c_f32_bf16 v62, v140, v140
 v_dot2c_f32_bf16 v59, s97, v141
 v_dot2c_f32_bf16 v63, v141, v141
 v_dot2c_f32_bf16 v58, s97, v142
 v_dot2c_f32_bf16 v62, v142, v142
 v_dot2c_f32_bf16 v59, s97, v143
 v_dot2c_f32_bf16 v63, v143, v143
 s_waitcnt vmcnt(17)
 ds_read_b128 v[160:163], v20 offset:12288
 ds_read_b128 v[164:167], v20 offset:14336
 ds_read_b128 v[168:171], v21 offset:12288
 ds_read_b128 v[172:175], v21 offset:14336
 s_add_u32 m0, s6, 0x8000
 s_add_u32 s70, s7, 0x400
 buffer_load_dwordx4 v16, s[8:11], s70 offen lds
 buffer_load_dwordx4 v17, s[8:11], s70 offen offset:1024 lds
 buffer_load_dwordx4 v18, s[8:11], s70 offen offset:2048 lds
 buffer_load_dwordx4 v19, s[8:11], s70 offen offset:3072 lds
 v_lshrrev_b32 v26, 4, v0
 v_lshl_add_u32 v25, v26, 2, v25
 v_add_u32 v25, s93, v25
 s_mov_b32 vcc_lo, 0xffff
 s_mov_b32 vcc_hi, 0
 v_mov_b32 v42, 0x10000000
 s_nop 1
 v_cndmask_b32 v42, v42, v25, vcc
 v_mov_b32 v24, v42
 v_and_b32 v26, 15, v0
 v_lshlrev_b32 v26, 8, v26
 s_add_u32 s92, s92, 0x1000
 v_add_u32 v26, s92, v26
 s_mov_b32 s98, 0xf12ff
 s_sub_u32 s4, s63, 11
 s_lshl_b32 s4, s4, 2
 WL 4
 v_dot2c_f32_bf16 v56, s97, v144
 v_dot2c_f32_bf16 v60, v144, v144
 v_dot2c_f32_bf16 v57, s97, v145
 v_dot2c_f32_bf16 v61, v145, v145
 v_dot2c_f32_bf16 v56, s97, v146
 v_dot2c_f32_bf16 v60, v146, v146
 v_dot2c_f32_bf16 v57, s97, v147
 v_dot2c_f32_bf16 v61, v147, v147
 v_dot2c_f32_bf16 v58, s97, v148
 v_dot2c_f32_bf16 v62, v148, v148
 v_dot2c_f32_bf16 v59, s97, v149
 v_dot2c_f32_bf16 v63, v149, v149
 v_dot2c_f32_bf16 v58, s97, v150
 v_dot2c_f32_bf16 v62, v150, v150
 v_dot2c_f32_bf16 v59, s97, v151
 v_dot2c_f32_bf16 v63, v151, v151
 v_dot2c_f32_bf16 v56, s97, v152
 v_dot2c_f32_bf16 v60, v152, v152
 v_dot2c_f32_bf16 v57, s97, v153
 v_dot2c_f32_bf16 v61, v153, v153
 v_dot2c_f32_bf16 v56, s97, v154
 v_dot2c_f32_bf16 v60, v154, v154
 v_dot2c_f32_bf16 v57, s97, v155
 v_dot2c_f32_bf16 v61, v155, v155
 v_dot2c_f32_bf16 v58, s97, v156
 v_dot2c_f32_bf16 v62, v156, v156
 v_dot2c_f32_bf16 v59, s97, v157
 v_dot2c_f32_bf16 v63, v157, v157
 v_dot2c_f32_bf16 v58, s97, v158
 v_dot2c_f32_bf16 v62, v158, v158
 v_dot2c_f32_bf16 v59, s97, v159
 v_dot2c_f32_bf16 v63, v159, v159
 s_waitcnt vmcnt(17)
 ds_read_b128 v[176:179], v20 offset:16384
 ds_read_b128 v[180:183], v20 offset:18432
 ds_read_b128 v[184:187], v21 offset:16384
 ds_read_b128 v[188:191], v21 offset:18432
 s_lshr_b32 s4, s98, s4
 s_and_b32 s4, s4, 15
 s_add_u32 s4, s4, 25
 v_mov_b32 v27, s4
 v_lshl_add_u32 v26, v27, 2, v26
 v_mov_b32 v25, 0
 buffer_store_dword v25, v26, s[36:39], 0 offen sc1
 v_mov_b32 v25, 0
 buffer_store_dword v25, v24, s[36:39], 0 offen sc1
 s_lshl_b32 s92, s64, 4
 s_cmp_eq_u32 s62, 0
 s_cselect_b32 s92, s92, 0x100
 v_mov_b32 v23, 0x100
 v_writelane_b32 v23, s92, 0
 v_lshrrev_b32 v24, 4, v0
 v_bfe_u32 v25, v0, 2, 2
 WL 4
 v_dot2c_f32_bf16 v56, s97, v160
 v_dot2c_f32_bf16 v60, v160, v160
 v_dot2c_f32_bf16 v57, s97, v161
 v_dot2c_f32_bf16 v61, v161, v161
 v_dot2c_f32_bf16 v56, s97, v162
 v_dot2c_f32_bf16 v60, v162, v162
 v_dot2c_f32_bf16 v57, s97, v163
 v_dot2c_f32_bf16 v61, v163, v163
 v_dot2c_f32_bf16 v58, s97, v164
 v_dot2c_f32_bf16 v62, v164, v164
 v_dot2c_f32_bf16 v59, s97, v165
 v_dot2c_f32_bf16 v63, v165, v165
 v_dot2c_f32_bf16 v58, s97, v166
 v_dot2c_f32_bf16 v62, v166, v166
 v_dot2c_f32_bf16 v59, s97, v167
 v_dot2c_f32_bf16 v63, v167, v167
 v_dot2c_f32_bf16 v56, s97, v168
 v_dot2c_f32_bf16 v60, v168, v168
 v_dot2c_f32_bf16 v57, s97, v169
 v_dot2c_f32_bf16 v61, v169, v169
 v_dot2c_f32_bf16 v56, s97, v170
 v_dot2c_f32_bf16 v60, v170, v170
 v_dot2c_f32_bf16 v57, s97, v171
 v_dot2c_f32_bf16 v61, v171, v171
 v_dot2c_f32_bf16 v58, s97, v172
 v_dot2c_f32_bf16 v62, v172, v172
 v_dot2c_f32_bf16 v59, s97, v173
 v_dot2c_f32_bf16 v63, v173, v173
 v_dot2c_f32_bf16 v58, s97, v174
 v_dot2c_f32_bf16 v62, v174, v174
 v_dot2c_f32_bf16 v59, s97, v175
 v_dot2c_f32_bf16 v63, v175, v175
 s_waitcnt vmcnt(14)
 ds_read_b128 v[192:195], v20 offset:20480
 ds_read_b128 v[196:199], v20 offset:22528
 ds_read_b128 v[200:203], v21 offset:20480
 ds_read_b128 v[204:207], v21 offset:22528
 v_and_b32 v26, 3, v0
 v_bfe_u32 v27, v0, 3, 1
 v_and_b32 v28, 7, v0
 v_bfe_u32 v29, v0, 4, 1
 v_lshlrev_b32 v29, 1, v29
 v_xor_b32 v28, v28, v29
 v_lshlrev_b32 v2, 4, v28
 v_lshrrev_b32 v28, 5, v0
 v_and_b32 v29, 3, v1
 v_lshl_add_u32 v41, v28, 4, v29
 s_mov_b32 s92, 0x440
 v_mul_u32_u24 v28, s92, v24
 v_lshl_add_u32 v28, v25, 7, v28
 v_lshl_add_u32 v28, v26, 3, v28
 v_lshl_add_u32 v9, v27, 5, v28
 v_mov_b32 v44, v9
 WL 4
 v_dot2c_f32_bf16 v56, s97, v176
 v_dot2c_f32_bf16 v60, v176, v176
 v_dot2c_f32_bf16 v57, s97, v177
 v_dot2c_f32_bf16 v61, v177, v177
 v_dot2c_f32_bf16 v56, s97, v178
 v_dot2c_f32_bf16 v60, v178, v178
 v_dot2c_f32_bf16 v57, s97, v179
 v_dot2c_f32_bf16 v61, v179, v179
 v_dot2c_f32_bf16 v58, s97, v180
 v_dot2c_f32_bf16 v62, v180, v180
 v_dot2c_f32_bf16 v59, s97, v181
 v_dot2c_f32_bf16 v63, v181, v181
 v_dot2c_f32_bf16 v58, s97, v182
 v_dot2c_f32_bf16 v62, v182, v182
 v_dot2c_f32_bf16 v59, s97, v183
 v_dot2c_f32_bf16 v63, v183, v183
 v_dot2c_f32_bf16 v56, s97, v184
 v_dot2c_f32_bf16 v60, v184, v184
 v_dot2c_f32_bf16 v57, s97, v185
 v_dot2c_f32_bf16 v61, v185, v185
 v_dot2c_f32_bf16 v56, s97, v186
 v_dot2c_f32_bf16 v60, v186, v186
 v_dot2c_f32_bf16 v57, s97, v187
 v_dot2c_f32_bf16 v61, v187, v187
 v_dot2c_f32_bf16 v58, s97, v188
 v_dot2c_f32_bf16 v62, v188, v188
 v_dot2c_f32_bf16 v59, s97, v189
 v_dot2c_f32_bf16 v63, v189, v189
 v_dot2c_f32_bf16 v58, s97, v190
 v_dot2c_f32_bf16 v62, v190, v190
 v_dot2c_f32_bf16 v59, s97, v191
 v_dot2c_f32_bf16 v63, v191, v191
 s_waitcnt vmcnt(10)
 ds_read_b128 v[208:211], v20 offset:24576
 ds_read_b128 v[212:215], v20 offset:26624
 ds_read_b128 v[216:219], v21 offset:24576
 ds_read_b128 v[220:223], v21 offset:26624
 v_xor_b32 v10, 32, v9
 v_add_u32 v11, 0x10000, v9
 v_add_u32 v12, 0x10000, v10
 v_add_u32 v13, 0x20000, v9
 v_add_u32 v14, 0x20000, v10
 v_lshlrev_b32 v28, 9, v24
 v_lshl_add_u32 v28, v25, 6, v28
 v_lshl_add_u32 v28, v26, 3, v28
 v_and_b32 v29, 1, v24
 v_lshl_add_u32 v15, v29, 5, v28
 v_xor_b32 v37, 32, v15
 v_lshrrev_b32 v28, 5, v0
 v_lshlrev_b32 v28, 1, v28
 v_xor_b32 v28, v28, v26
 v_lshlrev_b32 v28, 4, v28
 v_lshrrev_b32 v29, 2, v0
 WL 4
 v_dot2c_f32_bf16 v56, s97, v192
 v_dot2c_f32_bf16 v60, v192, v192
 v_dot2c_f32_bf16 v57, s97, v193
 v_dot2c_f32_bf16 v61, v193, v193
 v_dot2c_f32_bf16 v56, s97, v194
 v_dot2c_f32_bf16 v60, v194, v194
 v_dot2c_f32_bf16 v57, s97, v195
 v_dot2c_f32_bf16 v61, v195, v195
 v_dot2c_f32_bf16 v58, s97, v196
 v_dot2c_f32_bf16 v62, v196, v196
 v_dot2c_f32_bf16 v59, s97, v197
 v_dot2c_f32_bf16 v63, v197, v197
 v_dot2c_f32_bf16 v58, s97, v198
 v_dot2c_f32_bf16 v62, v198, v198
 v_dot2c_f32_bf16 v59, s97, v199
 v_dot2c_f32_bf16 v63, v199, v199
 v_dot2c_f32_bf16 v56, s97, v200
 v_dot2c_f32_bf16 v60, v200, v200
 v_dot2c_f32_bf16 v57, s97, v201
 v_dot2c_f32_bf16 v61, v201, v201
 v_dot2c_f32_bf16 v56, s97, v202
 v_dot2c_f32_bf16 v60, v202, v202
 v_dot2c_f32_bf16 v57, s97, v203
 v_dot2c_f32_bf16 v61, v203, v203
 v_dot2c_f32_bf16 v58, s97, v204
 v_dot2c_f32_bf16 v62, v204, v204
 v_dot2c_f32_bf16 v59, s97, v205
 v_dot2c_f32_bf16 v63, v205, v205
 v_dot2c_f32_bf16 v58, s97, v206
 v_dot2c_f32_bf16 v62, v206, v206
 v_dot2c_f32_bf16 v59, s97, v207
 v_dot2c_f32_bf16 v63, v207, v207
 s_waitcnt vmcnt(6)
 ds_read_b128 v[224:227], v20 offset:28672
 ds_read_b128 v[228:231], v20 offset:30720
 ds_read_b128 v[232:235], v21 offset:28672
 ds_read_b128 v[236:239], v21 offset:30720
 s_mov_b32 s92, 0x2400
 v_mad_u32_u24 v7, v29, s92, v28
 s_mov_b32 s92, 0x2400
 v_mad_u32_u24 v3, v1, s92, v2
 v_add_u32 v4, 0x11bc0, v3
 v_add_u32 v5, 0x11bc0, v4
 v_add_u32 v6, 0x11bc0, v5
 v_and_b32 v28, 15, v0
 v_bfe_u32 v29, v0, 1, 3
 v_xor_b32 v29, v29, v24
 v_lshlrev_b32 v28, 7, v28
 v_add_u32 v28, s6, v28
 v_lshl_add_u32 v20, v29, 4, v28
 v_xor_b32 v21, 64, v20
 v_lshlrev_b32 v0, 4, v0
 WL 4
 v_dot2c_f32_bf16 v56, s97, v208
 v_dot2c_f32_bf16 v60, v208, v208
 v_dot2c_f32_bf16 v57, s97, v209
 v_dot2c_f32_bf16 v61, v209, v209
 v_dot2c_f32_bf16 v56, s97, v210
 v_dot2c_f32_bf16 v60, v210, v210
 v_dot2c_f32_bf16 v57, s97, v211
 v_dot2c_f32_bf16 v61, v211, v211
 v_dot2c_f32_bf16 v58, s97, v212
 v_dot2c_f32_bf16 v62, v212, v212
 v_dot2c_f32_bf16 v59, s97, v213
 v_dot2c_f32_bf16 v63, v213, v213
 v_dot2c_f32_bf16 v58, s97, v214
 v_dot2c_f32_bf16 v62, v214, v214
 v_dot2c_f32_bf16 v59, s97, v215
 v_dot2c_f32_bf16 v63, v215, v215
 v_dot2c_f32_bf16 v56, s97, v216
 v_dot2c_f32_bf16 v60, v216, v216
 v_dot2c_f32_bf16 v57, s97, v217
 v_dot2c_f32_bf16 v61, v217, v217
 v_dot2c_f32_bf16 v56, s97, v218
 v_dot2c_f32_bf16 v60, v218, v218
 v_dot2c_f32_bf16 v57, s97, v219
 v_dot2c_f32_bf16 v61, v219, v219
 v_dot2c_f32_bf16 v58, s97, v220
 v_dot2c_f32_bf16 v62, v220, v220
 v_dot2c_f32_bf16 v59, s97, v221
 v_dot2c_f32_bf16 v63, v221, v221
 v_dot2c_f32_bf16 v58, s97, v222
 v_dot2c_f32_bf16 v62, v222, v222
 v_dot2c_f32_bf16 v59, s97, v223
 v_dot2c_f32_bf16 v63, v223, v223
 s_waitcnt vmcnt(2)
 ds_read_b128 v[240:243], v20 offset:32768
 ds_read_b128 v[244:247], v20 offset:34816
 ds_read_b128 v[248:251], v21 offset:32768
 ds_read_b128 v[252:255], v21 offset:34816
 WL 4
 v_dot2c_f32_bf16 v56, s97, v224
 v_dot2c_f32_bf16 v60, v224, v224
 v_dot2c_f32_bf16 v57, s97, v225
 v_dot2c_f32_bf16 v61, v225, v225
 v_dot2c_f32_bf16 v56, s97, v226
 v_dot2c_f32_bf16 v60, v226, v226
 v_dot2c_f32_bf16 v57, s97, v227
 v_dot2c_f32_bf16 v61, v227, v227
 v_dot2c_f32_bf16 v58, s97, v228
 v_dot2c_f32_bf16 v62, v228, v228
 v_dot2c_f32_bf16 v59, s97, v229
 v_dot2c_f32_bf16 v63, v229, v229
 v_dot2c_f32_bf16 v58, s97, v230
 v_dot2c_f32_bf16 v62, v230, v230
 v_dot2c_f32_bf16 v59, s97, v231
 v_dot2c_f32_bf16 v63, v231, v231
 v_dot2c_f32_bf16 v56, s97, v232
 v_dot2c_f32_bf16 v60, v232, v232
 v_dot2c_f32_bf16 v57, s97, v233
 v_dot2c_f32_bf16 v61, v233, v233
 v_dot2c_f32_bf16 v56, s97, v234
 v_dot2c_f32_bf16 v60, v234, v234
 v_dot2c_f32_bf16 v57, s97, v235
 v_dot2c_f32_bf16 v61, v235, v235
 v_dot2c_f32_bf16 v58, s97, v236
 v_dot2c_f32_bf16 v62, v236, v236
 v_dot2c_f32_bf16 v59, s97, v237
 v_dot2c_f32_bf16 v63, v237, v237
 v_dot2c_f32_bf16 v58, s97, v238
 v_dot2c_f32_bf16 v62, v238, v238
 v_dot2c_f32_bf16 v59, s97, v239
 v_dot2c_f32_bf16 v63, v239, v239
 WL 0
 s_barrier
 s_add_u32 m0, s65, 0
 s_add_u32 s70, s73, 0
 buffer_load_dwordx4 v3, s[28:31], s70 offen lds
 buffer_load_dwordx4 v4, s[28:31], s70 offen offset:1088 lds
 buffer_load_dwordx4 v5, s[28:31], s70 offen offset:2176 lds
 v_dot2c_f32_bf16 v56, s97, v240
 v_dot2c_f32_bf16 v60, v240, v240
 v_dot2c_f32_bf16 v57, s97, v241
 v_dot2c_f32_bf16 v61, v241, v241
 v_dot2c_f32_bf16 v56, s97, v242
 v_dot2c_f32_bf16 v60, v242, v242
 v_dot2c_f32_bf16 v57, s97, v243
 v_dot2c_f32_bf16 v61, v243, v243
 v_dot2c_f32_bf16 v58, s97, v244
 v_dot2c_f32_bf16 v62, v244, v244
 v_dot2c_f32_bf16 v59, s97, v245
 v_dot2c_f32_bf16 v63, v245, v245
 v_dot2c_f32_bf16 v58, s97, v246
 v_dot2c_f32_bf16 v62, v246, v246
 v_dot2c_f32_bf16 v59, s97, v247
 v_dot2c_f32_bf16 v63, v247, v247
 v_dot2c_f32_bf16 v56, s97, v248
 v_dot2c_f32_bf16 v60, v248, v248
 v_dot2c_f32_bf16 v57, s97, v249
 v_dot2c_f32_bf16 v61, v249, v249
 v_dot2c_f32_bf16 v56, s97, v250
 v_dot2c_f32_bf16 v60, v250, v250
 v_dot2c_f32_bf16 v57, s97, v251
 v_dot2c_f32_bf16 v61, v251, v251
 v_dot2c_f32_bf16 v58, s97, v252
 v_dot2c_f32_bf16 v62, v252, v252
 v_dot2c_f32_bf16 v59, s97, v253
 v_dot2c_f32_bf16 v63, v253, v253
 v_dot2c_f32_bf16 v58, s97, v254
 v_dot2c_f32_bf16 v62, v254, v254
 v_dot2c_f32_bf16 v59, s97, v255
 v_dot2c_f32_bf16 v63, v255, v255
 AD 56,56,57
 s_nop 0
 AD 58,58,59
 AD 60,60,61
 AD 62,62,63
 v_mov_b32 v57, v56
 v_mov_b32 v59, v58
 v_mov_b32 v61, v60
 v_mov_b32 v63, v62
 v_permlane16_swap_b32 v56, v57
 v_permlane16_swap_b32 v58, v59
 v_permlane16_swap_b32 v60, v61
 v_permlane16_swap_b32 v62, v63
 AD 56,56,57
 AD 58,58,59
 AD 60,60,61
 AD 62,62,63
 v_mov_b32 v57, v56
 v_mov_b32 v59, v58
 v_mov_b32 v61, v60
 v_mov_b32 v63, v62
 v_permlane32_swap_b32 v56, v57
 v_permlane32_swap_b32 v58, v59
 v_permlane32_swap_b32 v60, v61
 v_permlane32_swap_b32 v62, v63
 AD 56,56,57
 AD 58,58,59
 AD 60,60,61
 AD 62,62,63
 v_mul_f32 v56, 0x3ae38e39, v56
 v_mul_f32 v58, 0x3ae38e39, v58
 v_mul_f32 v60, 0x3ae38e39, v60
 v_mul_f32 v62, 0x3ae38e39, v62
 v_fma_f32 v60, -v56, v56, v60
 v_fma_f32 v62, -v58, v58, v62
 v_max_f32 v60, 0, v60
 v_max_f32 v62, 0, v62
 v_add_f32 v60, 0x3727c5ac, v60
 v_add_f32 v62, 0x3727c5ac, v62
 v_rsq_f32 v60, v60
 v_rsq_f32 v62, v62
 v_mul_f32 v60, 0xbfb8aa3b, v60
 v_mul_f32 v62, 0xbfb8aa3b, v62
 v_mov_b32 v20, v56
 v_mov_b32 v21, v58
 v_mul_f32 v56, -v56, v60
 v_mul_f32 v58, -v58, v62
 s_mov_b32 s92, 0xffff0000
 v_cvt_pk_bf16_f32 v57, v60, 0
 v_cvt_pk_bf16_f32 v59, v62, 0
 v_lshlrev_b32 v61, 16, v57
 v_lshlrev_b32 v63, 16, v59
 v_mul_f32 v56, -v20, v61
 v_mul_f32 v58, -v21, v63
 v_dot2_f32_bf16 v24, v112, v57, v56
 v_dot2_f32_bf16 v25, v112, v61, v56
 v_dot2_f32_bf16 v26, v113, v57, v56
 v_dot2_f32_bf16 v27, v113, v61, v56
 v_dot2_f32_bf16 v16, v114, v57, v56
 v_dot2_f32_bf16 v17, v114, v61, v56
 v_dot2_f32_bf16 v18, v115, v57, v56
 v_dot2_f32_bf16 v19, v115, v61, v56
 CV 112,24,25
 CV 113,26,27
 CV 114,16,17
 CV 115,18,19
 buffer_load_dwordx4 v6, s[28:31], s70 offen offset:3264 lds
 v_dot2_f32_bf16 v24, v116, v59, v58
 v_dot2_f32_bf16 v25, v116, v63, v58
 v_dot2_f32_bf16 v26, v117, v59, v58
 v_dot2_f32_bf16 v27, v117, v63, v58
 v_dot2_f32_bf16 v16, v118, v59, v58
 v_dot2_f32_bf16 v17, v118, v63, v58
 v_dot2_f32_bf16 v18, v119, v59, v58
 v_dot2_f32_bf16 v19, v119, v63, v58
 CV 116,24,25
 CV 117,26,27
 CV 118,16,17
 CV 119,18,19
 s_add_u32 m0, m0, 0x1100
 s_add_u32 s70, s73, 0x48000
 buffer_load_dwordx4 v3, s[28:31], s70 offen lds
 v_dot2_f32_bf16 v24, v120, v57, v56
 v_dot2_f32_bf16 v25, v120, v61, v56
 v_dot2_f32_bf16 v26, v121, v57, v56
 v_dot2_f32_bf16 v27, v121, v61, v56
 v_dot2_f32_bf16 v16, v122, v57, v56
 v_dot2_f32_bf16 v17, v122, v61, v56
 v_dot2_f32_bf16 v18, v123, v57, v56
 v_dot2_f32_bf16 v19, v123, v61, v56
 CV 120,24,25
 CV 121,26,27
 CV 122,16,17
 CV 123,18,19
 buffer_load_dwordx4 v4, s[28:31], s70 offen offset:1088 lds
 v_dot2_f32_bf16 v24, v124, v59, v58
 v_dot2_f32_bf16 v25, v124, v63, v58
 v_dot2_f32_bf16 v26, v125, v59, v58
 v_dot2_f32_bf16 v27, v125, v63, v58
 v_dot2_f32_bf16 v16, v126, v59, v58
 v_dot2_f32_bf16 v17, v126, v63, v58
 v_dot2_f32_bf16 v18, v127, v59, v58
 v_dot2_f32_bf16 v19, v127, v63, v58
 CV 124,24,25
 CV 125,26,27
 CV 126,16,17
 CV 127,18,19
 buffer_load_dwordx4 v5, s[28:31], s70 offen offset:2176 lds
 v_dot2_f32_bf16 v24, v128, v57, v56
 v_dot2_f32_bf16 v25, v128, v61, v56
 v_dot2_f32_bf16 v26, v129, v57, v56
 v_dot2_f32_bf16 v27, v129, v61, v56
 v_dot2_f32_bf16 v16, v130, v57, v56
 v_dot2_f32_bf16 v17, v130, v61, v56
 v_dot2_f32_bf16 v18, v131, v57, v56
 v_dot2_f32_bf16 v19, v131, v61, v56
 CV 128,24,25
 CV 129,26,27
 CV 130,16,17
 CV 131,18,19
 buffer_load_dwordx4 v6, s[28:31], s70 offen offset:3264 lds
 v_dot2_f32_bf16 v24, v132, v59, v58
 v_dot2_f32_bf16 v25, v132, v63, v58
 v_dot2_f32_bf16 v26, v133, v59, v58
 v_dot2_f32_bf16 v27, v133, v63, v58
 v_dot2_f32_bf16 v16, v134, v59, v58
 v_dot2_f32_bf16 v17, v134, v63, v58
 v_dot2_f32_bf16 v18, v135, v59, v58
 v_dot2_f32_bf16 v19, v135, v63, v58
 CV 132,24,25
 CV 133,26,27
 CV 134,16,17
 CV 135,18,19
 s_add_u32 m0, s66, 0
 s_add_u32 s70, s74, 0
 buffer_load_dwordx4 v3, s[28:31], s70 offen lds
 v_dot2_f32_bf16 v24, v136, v57, v56
 v_dot2_f32_bf16 v25, v136, v61, v56
 v_dot2_f32_bf16 v26, v137, v57, v56
 v_dot2_f32_bf16 v27, v137, v61, v56
 v_dot2_f32_bf16 v16, v138, v57, v56
 v_dot2_f32_bf16 v17, v138, v61, v56
 v_dot2_f32_bf16 v18, v139, v57, v56
 v_dot2_f32_bf16 v19, v139, v61, v56
 CV 136,24,25
 CV 137,26,27
 CV 138,16,17
 CV 139,18,19
 s_add_u32 m0, s65, 0x9900
 s_add_u32 s70, s73, 0x288000
 buffer_load_dwordx4 v3, s[28:31], s70 offen lds
 v_dot2_f32_bf16 v24, v140, v59, v58
 v_dot2_f32_bf16 v25, v140, v63, v58
 v_dot2_f32_bf16 v26, v141, v59, v58
 v_dot2_f32_bf16 v27, v141, v63, v58
 v_dot2_f32_bf16 v16, v142, v59, v58
 v_dot2_f32_bf16 v17, v142, v63, v58
 v_dot2_f32_bf16 v18, v143, v59, v58
 v_dot2_f32_bf16 v19, v143, v63, v58
 CV 140,24,25
 CV 141,26,27
 CV 142,16,17
 CV 143,18,19
 buffer_load_dwordx4 v4, s[28:31], s70 offen offset:1088 lds
 v_dot2_f32_bf16 v24, v144, v57, v56
 v_dot2_f32_bf16 v25, v144, v61, v56
 v_dot2_f32_bf16 v26, v145, v57, v56
 v_dot2_f32_bf16 v27, v145, v61, v56
 v_dot2_f32_bf16 v16, v146, v57, v56
 v_dot2_f32_bf16 v17, v146, v61, v56
 v_dot2_f32_bf16 v18, v147, v57, v56
 v_dot2_f32_bf16 v19, v147, v61, v56
 CV 144,24,25
 CV 145,26,27
 CV 146,16,17
 CV 147,18,19
 buffer_load_dwordx4 v5, s[28:31], s70 offen offset:2176 lds
 v_dot2_f32_bf16 v24, v148, v59, v58
 v_dot2_f32_bf16 v25, v148, v63, v58
 v_dot2_f32_bf16 v26, v149, v59, v58
 v_dot2_f32_bf16 v27, v149, v63, v58
 v_dot2_f32_bf16 v16, v150, v59, v58
 v_dot2_f32_bf16 v17, v150, v63, v58
 v_dot2_f32_bf16 v18, v151, v59, v58
 v_dot2_f32_bf16 v19, v151, v63, v58
 CV 148,24,25
 CV 149,26,27
 CV 150,16,17
 CV 151,18,19
 buffer_load_dwordx4 v6, s[28:31], s70 offen offset:3264 lds
 v_dot2_f32_bf16 v24, v152, v57, v56
 v_dot2_f32_bf16 v25, v152, v61, v56
 v_dot2_f32_bf16 v26, v153, v57, v56
 v_dot2_f32_bf16 v27, v153, v61, v56
 v_dot2_f32_bf16 v16, v154, v57, v56
 v_dot2_f32_bf16 v17, v154, v61, v56
 v_dot2_f32_bf16 v18, v155, v57, v56
 v_dot2_f32_bf16 v19, v155, v61, v56
 CV 152,24,25
 CV 153,26,27
 CV 154,16,17
 CV 155,18,19
 s_add_u32 m0, m0, 0x1100
 s_add_u32 s70, s73, 0x2d0000
 buffer_load_dwordx4 v3, s[28:31], s70 offen lds
 v_dot2_f32_bf16 v24, v156, v59, v58
 v_dot2_f32_bf16 v25, v156, v63, v58
 v_dot2_f32_bf16 v26, v157, v59, v58
 v_dot2_f32_bf16 v27, v157, v63, v58
 v_dot2_f32_bf16 v16, v158, v59, v58
 v_dot2_f32_bf16 v17, v158, v63, v58
 v_dot2_f32_bf16 v18, v159, v59, v58
 v_dot2_f32_bf16 v19, v159, v63, v58
 CV 156,24,25
 CV 157,26,27
 CV 158,16,17
 CV 159,18,19
 buffer_load_dwordx4 v4, s[28:31], s70 offen offset:1088 lds
 v_dot2_f32_bf16 v24, v160, v57, v56
 v_dot2_f32_bf16 v25, v160, v61, v56
 v_dot2_f32_bf16 v26, v161, v57, v56
 v_dot2_f32_bf16 v27, v161, v61, v56
 v_dot2_f32_bf16 v16, v162, v57, v56
 v_dot2_f32_bf16 v17, v162, v61, v56
 v_dot2_f32_bf16 v18, v163, v57, v56
 v_dot2_f32_bf16 v19, v163, v61, v56
 CV 160,24,25
 CV 161,26,27
 CV 162,16,17
 CV 163,18,19
 buffer_load_dwordx4 v5, s[28:31], s70 offen offset:2176 lds
 v_dot2_f32_bf16 v24, v164, v59, v58
 v_dot2_f32_bf16 v25, v164, v63, v58
 v_dot2_f32_bf16 v26, v165, v59, v58
 v_dot2_f32_bf16 v27, v165, v63, v58
 v_dot2_f32_bf16 v16, v166, v59, v58
 v_dot2_f32_bf16 v17, v166, v63, v58
 v_dot2_f32_bf16 v18, v167, v59, v58
 v_dot2_f32_bf16 v19, v167, v63, v58
 CV 164,24,25
 CV 165,26,27
 CV 166,16,17
 CV 167,18,19
 buffer_load_dwordx4 v6, s[28:31], s70 offen offset:3264 lds
 v_dot2_f32_bf16 v24, v168, v57, v56
 v_dot2_f32_bf16 v25, v168, v61, v56
 v_dot2_f32_bf16 v26, v169, v57, v56
 v_dot2_f32_bf16 v27, v169, v61, v56
 v_dot2_f32_bf16 v16, v170, v57, v56
 v_dot2_f32_bf16 v17, v170, v61, v56
 v_dot2_f32_bf16 v18, v171, v57, v56
 v_dot2_f32_bf16 v19, v171, v61, v56
 CV 168,24,25
 CV 169,26,27
 CV 170,16,17
 CV 171,18,19
 s_add_u32 m0, s66, 0x9900
 s_add_u32 s70, s74, 0x288000
 buffer_load_dwordx4 v3, s[28:31], s70 offen lds
 v_dot2_f32_bf16 v24, v172, v59, v58
 v_dot2_f32_bf16 v25, v172, v63, v58
 v_dot2_f32_bf16 v26, v173, v59, v58
 v_dot2_f32_bf16 v27, v173, v63, v58
 v_dot2_f32_bf16 v16, v174, v59, v58
 v_dot2_f32_bf16 v17, v174, v63, v58
 v_dot2_f32_bf16 v18, v175, v59, v58
 v_dot2_f32_bf16 v19, v175, v63, v58
 CV 172,24,25
 CV 173,26,27
 CV 174,16,17
 CV 175,18,19
 s_add_u32 s3, s3, 0x80
 buffer_load_dword v47, v8, s[28:31], s3 offen
 v_dot2_f32_bf16 v24, v176, v57, v56
 v_dot2_f32_bf16 v25, v176, v61, v56
 v_dot2_f32_bf16 v26, v177, v57, v56
 v_dot2_f32_bf16 v27, v177, v61, v56
 v_dot2_f32_bf16 v16, v178, v57, v56
 v_dot2_f32_bf16 v17, v178, v61, v56
 v_dot2_f32_bf16 v18, v179, v57, v56
 v_dot2_f32_bf16 v19, v179, v61, v56
 CV 176,24,25
 CV 177,26,27
 CV 178,16,17
 CV 179,18,19
 s_add_u32 s3, s3, 0x80
 buffer_load_dword v47, v8, s[28:31], s3 offen
 v_dot2_f32_bf16 v24, v180, v59, v58
 v_dot2_f32_bf16 v25, v180, v63, v58
 v_dot2_f32_bf16 v26, v181, v59, v58
 v_dot2_f32_bf16 v27, v181, v63, v58
 v_dot2_f32_bf16 v16, v182, v59, v58
 v_dot2_f32_bf16 v17, v182, v63, v58
 v_dot2_f32_bf16 v18, v183, v59, v58
 v_dot2_f32_bf16 v19, v183, v63, v58
 CV 180,24,25
 CV 181,26,27
 CV 182,16,17
 CV 183,18,19
 v_dot2_f32_bf16 v24, v184, v57, v56
 v_dot2_f32_bf16 v25, v184, v61, v56
 v_dot2_f32_bf16 v26, v185, v57, v56
 v_dot2_f32_bf16 v27, v185, v61, v56
 v_dot2_f32_bf16 v16, v186, v57, v56
 v_dot2_f32_bf16 v17, v186, v61, v56
 v_dot2_f32_bf16 v18, v187, v57, v56
 v_dot2_f32_bf16 v19, v187, v61, v56
 CV 184,24,25
 CV 185,26,27
 CV 186,16,17
 CV 187,18,19
 v_dot2_f32_bf16 v24, v188, v59, v58
 v_dot2_f32_bf16 v25, v188, v63, v58
 v_dot2_f32_bf16 v26, v189, v59, v58
 v_dot2_f32_bf16 v27, v189, v63, v58
 v_dot2_f32_bf16 v16, v190, v59, v58
 v_dot2_f32_bf16 v17, v190, v63, v58
 v_dot2_f32_bf16 v18, v191, v59, v58
 v_dot2_f32_bf16 v19, v191, v63, v58
 CV 188,24,25
 CV 189,26,27
 CV 190,16,17
 CV 191,18,19
 v_dot2_f32_bf16 v24, v192, v57, v56
 v_dot2_f32_bf16 v25, v192, v61, v56
 v_dot2_f32_bf16 v26, v193, v57, v56
 v_dot2_f32_bf16 v27, v193, v61, v56
 v_dot2_f32_bf16 v16, v194, v57, v56
 v_dot2_f32_bf16 v17, v194, v61, v56
 v_dot2_f32_bf16 v18, v195, v57, v56
 v_dot2_f32_bf16 v19, v195, v61, v56
 CV 192,24,25
 CV 193,26,27
 CV 194,16,17
 CV 195,18,19
 v_dot2_f32_bf16 v24, v196, v59, v58
 v_dot2_f32_bf16 v25, v196, v63, v58
 v_dot2_f32_bf16 v26, v197, v59, v58
 v_dot2_f32_bf16 v27, v197, v63, v58
 v_dot2_f32_bf16 v16, v198, v59, v58
 v_dot2_f32_bf16 v17, v198, v63, v58
 v_dot2_f32_bf16 v18, v199, v59, v58
 v_dot2_f32_bf16 v19, v199, v63, v58
 CV 196,24,25
 CV 197,26,27
 CV 198,16,17
 CV 199,18,19
 v_dot2_f32_bf16 v24, v200, v57, v56
 v_dot2_f32_bf16 v25, v200, v61, v56
 v_dot2_f32_bf16 v26, v201, v57, v56
 v_dot2_f32_bf16 v27, v201, v61, v56
 v_dot2_f32_bf16 v16, v202, v57, v56
 v_dot2_f32_bf16 v17, v202, v61, v56
 v_dot2_f32_bf16 v18, v203, v57, v56
 v_dot2_f32_bf16 v19, v203, v61, v56
 CV 200,24,25
 CV 201,26,27
 CV 202,16,17
 CV 203,18,19
 v_dot2_f32_bf16 v24, v204, v59, v58
 v_dot2_f32_bf16 v25, v204, v63, v58
 v_dot2_f32_bf16 v26, v205, v59, v58
 v_dot2_f32_bf16 v27, v205, v63, v58
 v_dot2_f32_bf16 v16, v206, v59, v58
 v_dot2_f32_bf16 v17, v206, v63, v58
 v_dot2_f32_bf16 v18, v207, v59, v58
 v_dot2_f32_bf16 v19, v207, v63, v58
 CV 204,24,25
 CV 205,26,27
 CV 206,16,17
 CV 207,18,19
 v_dot2_f32_bf16 v24, v208, v57, v56
 v_dot2_f32_bf16 v25, v208, v61, v56
 v_dot2_f32_bf16 v26, v209, v57, v56
 v_dot2_f32_bf16 v27, v209, v61, v56
 v_dot2_f32_bf16 v16, v210, v57, v56
 v_dot2_f32_bf16 v17, v210, v61, v56
 v_dot2_f32_bf16 v18, v211, v57, v56
 v_dot2_f32_bf16 v19, v211, v61, v56
 CV 208,24,25
 CV 209,26,27
 CV 210,16,17
 CV 211,18,19
 v_dot2_f32_bf16 v24, v212, v59, v58
 v_dot2_f32_bf16 v25, v212, v63, v58
 v_dot2_f32_bf16 v26, v213, v59, v58
 v_dot2_f32_bf16 v27, v213, v63, v58
 v_dot2_f32_bf16 v16, v214, v59, v58
 v_dot2_f32_bf16 v17, v214, v63, v58
 v_dot2_f32_bf16 v18, v215, v59, v58
 v_dot2_f32_bf16 v19, v215, v63, v58
 CV 212,24,25
 CV 213,26,27
 CV 214,16,17
 CV 215,18,19
 v_dot2_f32_bf16 v24, v216, v57, v56
 v_dot2_f32_bf16 v25, v216, v61, v56
 v_dot2_f32_bf16 v26, v217, v57, v56
 v_dot2_f32_bf16 v27, v217, v61, v56
 v_dot2_f32_bf16 v16, v218, v57, v56
 v_dot2_f32_bf16 v17, v218, v61, v56
 v_dot2_f32_bf16 v18, v219, v57, v56
 v_dot2_f32_bf16 v19, v219, v61, v56
 CV 216,24,25
 CV 217,26,27
 CV 218,16,17
 CV 219,18,19
 v_dot2_f32_bf16 v24, v220, v59, v58
 v_dot2_f32_bf16 v25, v220, v63, v58
 v_dot2_f32_bf16 v26, v221, v59, v58
 v_dot2_f32_bf16 v27, v221, v63, v58
 v_dot2_f32_bf16 v16, v222, v59, v58
 v_dot2_f32_bf16 v17, v222, v63, v58
 v_dot2_f32_bf16 v18, v223, v59, v58
 v_dot2_f32_bf16 v19, v223, v63, v58
 CV 220,24,25
 CV 221,26,27
 CV 222,16,17
 CV 223,18,19
 v_dot2_f32_bf16 v24, v224, v57, v56
 v_dot2_f32_bf16 v25, v224, v61, v56
 v_dot2_f32_bf16 v26, v225, v57, v56
 v_dot2_f32_bf16 v27, v225, v61, v56
 v_dot2_f32_bf16 v16, v226, v57, v56
 v_dot2_f32_bf16 v17, v226, v61, v56
 v_dot2_f32_bf16 v18, v227, v57, v56
 v_dot2_f32_bf16 v19, v227, v61, v56
 CV 224,24,25
 CV 225,26,27
 CV 226,16,17
 CV 227,18,19
 v_dot2_f32_bf16 v24, v228, v59, v58
 v_dot2_f32_bf16 v25, v228, v63, v58
 v_dot2_f32_bf16 v26, v229, v59, v58
 v_dot2_f32_bf16 v27, v229, v63, v58
 v_dot2_f32_bf16 v16, v230, v59, v58
 v_dot2_f32_bf16 v17, v230, v63, v58
 v_dot2_f32_bf16 v18, v231, v59, v58
 v_dot2_f32_bf16 v19, v231, v63, v58
 CV 228,24,25
 CV 229,26,27
 CV 230,16,17
 CV 231,18,19
 v_dot2_f32_bf16 v24, v232, v57, v56
 v_dot2_f32_bf16 v25, v232, v61, v56
 v_dot2_f32_bf16 v26, v233, v57, v56
 v_dot2_f32_bf16 v27, v233, v61, v56
 v_dot2_f32_bf16 v16, v234, v57, v56
 v_dot2_f32_bf16 v17, v234, v61, v56
 v_dot2_f32_bf16 v18, v235, v57, v56
 v_dot2_f32_bf16 v19, v235, v61, v56
 CV 232,24,25
 CV 233,26,27
 CV 234,16,17
 CV 235,18,19
 v_dot2_f32_bf16 v24, v236, v59, v58
 v_dot2_f32_bf16 v25, v236, v63, v58
 v_dot2_f32_bf16 v26, v237, v59, v58
 v_dot2_f32_bf16 v27, v237, v63, v58
 v_dot2_f32_bf16 v16, v238, v59, v58
 v_dot2_f32_bf16 v17, v238, v63, v58
 v_dot2_f32_bf16 v18, v239, v59, v58
 v_dot2_f32_bf16 v19, v239, v63, v58
 CV 236,24,25
 CV 237,26,27
 CV 238,16,17
 CV 239,18,19
 v_dot2_f32_bf16 v24, v240, v57, v56
 v_dot2_f32_bf16 v25, v240, v61, v56
 v_dot2_f32_bf16 v26, v241, v57, v56
 v_dot2_f32_bf16 v27, v241, v61, v56
 v_dot2_f32_bf16 v16, v242, v57, v56
 v_dot2_f32_bf16 v17, v242, v61, v56
 v_dot2_f32_bf16 v18, v243, v57, v56
 v_dot2_f32_bf16 v19, v243, v61, v56
 CV 240,24,25
 CV 241,26,27
 CV 242,16,17
 CV 243,18,19
 v_dot2_f32_bf16 v24, v244, v59, v58
 v_dot2_f32_bf16 v25, v244, v63, v58
 v_dot2_f32_bf16 v26, v245, v59, v58
 v_dot2_f32_bf16 v27, v245, v63, v58
 v_dot2_f32_bf16 v16, v246, v59, v58
 v_dot2_f32_bf16 v17, v246, v63, v58
 v_dot2_f32_bf16 v18, v247, v59, v58
 v_dot2_f32_bf16 v19, v247, v63, v58
 CV 244,24,25
 CV 245,26,27
 CV 246,16,17
 CV 247,18,19
 v_dot2_f32_bf16 v24, v248, v57, v56
 v_dot2_f32_bf16 v25, v248, v61, v56
 v_dot2_f32_bf16 v26, v249, v57, v56
 v_dot2_f32_bf16 v27, v249, v61, v56
 v_dot2_f32_bf16 v16, v250, v57, v56
 v_dot2_f32_bf16 v17, v250, v61, v56
 v_dot2_f32_bf16 v18, v251, v57, v56
 v_dot2_f32_bf16 v19, v251, v61, v56
 CV 248,24,25
 CV 249,26,27
 CV 250,16,17
 CV 251,18,19
 v_dot2_f32_bf16 v24, v252, v59, v58
 v_dot2_f32_bf16 v25, v252, v63, v58
 v_dot2_f32_bf16 v26, v253, v59, v58
 v_dot2_f32_bf16 v27, v253, v63, v58
 v_dot2_f32_bf16 v16, v254, v59, v58
 v_dot2_f32_bf16 v17, v254, v63, v58
 v_dot2_f32_bf16 v18, v255, v59, v58
 v_dot2_f32_bf16 v19, v255, v63, v58
 CV 252,24,25
 CV 253,26,27
 CV 254,16,17
 CV 255,18,19
 v_mov_b32 v24, 1
 s_waitcnt vmcnt(20)
 buffer_atomic_add v24, v23, s[52:55], 0 offen sc1
 v_lshrrev_b32 v40, 16, v38
 v_and_b32 v36, 63, v38
 v_min_u32 v36, 9, v36
 v_mad_u32_u24 v36, v40, 10, v36
 v_lshlrev_b32 v36, 7, v36
 s_mov_b32 s96, 0xbdb504f3
 s_waitcnt vmcnt(12)
 s_barrier
 RT 216,9,0
 RT 218,9,512
 RT 220,10,0
 RT 222,10,512
 RT 224,9,64
 RT 226,9,576
 RT 228,10,64
 RT 230,10,576
 RT 232,9,4352
 RT 234,9,4864
 RT 236,10,4352
 RT 238,10,4864
 RT 240,9,4416
 RT 242,9,4928
 RT 244,10,4416
 RT 246,10,4928
 WL 8
 v_mfma_f32_16x16x32_bf16 v[48:51], a[216:219], v[112:115], 0
 RT 248,9,8704
 RT 250,9,9216
 v_mfma_f32_16x16x32_bf16 v[52:55], a[216:219], v[116:119], 0
 s_add_u32 s73, s73, 0x80
 s_add_u32 s74, s74, 0x80
 v_mfma_f32_16x16x32_bf16 v[60:63], a[220:223], v[116:119], 0
 RT 216,10,8704
 RT 218,10,9216
 v_mfma_f32_16x16x32_bf16 v[56:59], a[220:223], v[112:115], 0
 s_add_u32 m0, s65, 0x13200
 s_add_u32 s70, s73, 0
 v_mfma_f32_16x16x32_bf16 v[64:67], a[224:227], v[112:115], 0
 RT 220,9,8768
 RT 222,9,9280
 v_mfma_f32_16x16x32_bf16 v[68:71], a[224:227], v[116:119], 0
 buffer_load_dwordx4 v3, s[28:31], s70 offen lds
 v_mfma_f32_16x16x32_bf16 v[76:79], a[228:231], v[116:119], 0
 WL 6
 RT 224,10,8768
 v_mfma_f32_16x16x32_bf16 v[72:75], a[228:231], v[112:115], 0
 RT 226,10,9280
 MV 48,232,120
 RT 228,9,13056
 MV 52,232,124
 RT 230,9,13568
 MV 60,236,124
 RT 232,10,13056
 RT 234,10,13568
 MV 56,236,120
 buffer_load_dwordx4 v4, s[28:31], s70 offen offset:1088 lds
 MV 64,240,120
 RT 236,9,13120
 MV 68,240,124
 RT 238,9,13632
 MV 76,244,124
 WL 6
 RT 240,10,13120
 MV 72,244,120
 RT 242,10,13632
 MV 48,248,128
 RT 244,9,17408
 RT 246,9,17920
 MV 52,248,132
 buffer_load_dwordx4 v5, s[28:31], s70 offen offset:2176 lds
 MV 60,216,132
 RT 248,10,17408
 MV 56,216,128
 RT 250,10,17920
 MV 64,220,128
 RT 216,9,17472
 MV 68,220,132
 RT 218,9,17984
 MV 76,224,132
 WL 6
 RT 220,10,17472
 RT 222,10,17984
 MV 72,224,128
 buffer_load_dwordx4 v6, s[28:31], s70 offen offset:3264 lds
 MV 48,228,136
 RT 224,9,21760
 MV 52,228,140
 RT 226,9,22272
 MV 60,232,140
 RT 228,10,21760
 MV 56,232,136
 RT 230,10,22272
 MV 64,236,136
 RT 232,9,21824
 RT 234,9,22336
 MV 68,236,140
 s_add_u32 m0, m0, 0x1100
 s_add_u32 s70, s73, 0x48000
 MV 76,240,140
 WL 6
 RT 236,10,21824
 RT 238,10,22336
 MV 72,240,136
 buffer_load_dwordx4 v3, s[28:31], s70 offen lds
 MV 48,244,144
 RT 240,9,26112
 MV 52,244,148
 RT 242,9,26624
 MV 60,248,148
 RT 244,10,26112
 MV 56,248,144
 RT 246,10,26624
 MV 64,216,144
 RT 248,9,26176
 RT 250,9,26688
 MV 68,216,148
 buffer_load_dwordx4 v4, s[28:31], s70 offen offset:1088 lds
 MV 76,220,148
 WL 6
 RT 216,10,26176
 MV 72,220,144
 RT 218,10,26688
 MV 48,224,152
 RT 220,9,30464
 MV 52,224,156
 RT 222,9,30976
 MV 60,228,156
 RT 224,10,30464
 RT 226,10,30976
 MV 56,228,152
 buffer_load_dwordx4 v5, s[28:31], s70 offen offset:2176 lds
 MV 64,232,152
 RT 228,9,30528
 MV 68,232,156
 RT 230,9,31040
 MV 76,236,156
 WL 6
 RT 232,10,30528
 MV 72,236,152
 RT 234,10,31040
 MV 48,240,160
 RT 236,9,34816
 RT 238,9,35328
 MV 52,240,164
 buffer_load_dwordx4 v6, s[28:31], s70 offen offset:3264 lds
 MV 60,244,164
 RT 240,10,34816
 MV 56,244,160
 RT 242,10,35328
 MV 64,248,160
 RT 244,9,34880
 MV 68,248,164
 RT 246,9,35392
 MV 76,216,164
 WL 6
 RT 248,10,34880
 RT 250,10,35392
 MV 72,216,160
 s_add_u32 m0, s66, 0x13200
 s_add_u32 s70, s74, 0
 MV 48,220,168
 buffer_load_dwordx4 v3, s[28:31], s70 offen lds
 s_add_u32 s3, s3, 0x80
 buffer_load_dword v47, v8, s[28:31], s3 offen
 s_waitcnt vmcnt(13)
 s_barrier
 RT 216,9,39168
 RT 218,9,39680
 MV 52,220,172
 s_add_u32 m0, s65, 0x1cb00
 s_add_u32 s70, s73, 0x288000
 MV 60,224,172
 RT 220,10,39168
 RT 222,10,39680
 MV 56,224,168
 buffer_load_dwordx4 v3, s[28:31], s70 offen lds
 MV 64,228,168
 RT 224,9,43520
 MV 68,228,172
 RT 226,9,44032
 MV 76,232,172
 WL 6
 RT 228,10,43520
 MV 72,232,168
 RT 230,10,44032
 MV 48,236,176
 RT 232,9,47872
 RT 234,9,48384
 MV 52,236,180
 buffer_load_dwordx4 v4, s[28:31], s70 offen offset:1088 lds
 MV 60,240,180
 RT 236,10,47872
 MV 56,240,176
 RT 238,10,48384
 MV 64,244,176
 RT 240,9,52224
 MV 68,244,180
 RT 242,9,52736
 MV 76,248,180
 WL 6
 RT 244,10,52224
 RT 246,10,52736
 MV 72,248,176
 buffer_load_dwordx4 v5, s[28:31], s70 offen offset:2176 lds
 MV 48,216,184
 RT 248,9,56576
 MV 52,216,188
 RT 250,9,57088
 MV 60,220,188
 RT 216,10,56576
 MV 56,220,184
 RT 218,10,57088
 MV 48,224,192
 RT 220,9,60928
 RT 222,9,61440
 MV 52,224,196
 buffer_load_dwordx4 v6, s[28:31], s70 offen offset:3264 lds
 MV 60,228,196
 WL 6
 RT 224,10,60928
 MV 56,228,192
 RT 226,10,61440
 MV 48,232,200
 RT 228,9,65280
 MV 52,232,204
 RT 230,11,256
 MV 60,236,204
 RT 232,10,65280
 RT 234,12,256
 MV 56,236,200
 s_add_u32 m0, m0, 0x1100
 s_add_u32 s70, s73, 0x2d0000
 MV 48,240,208
 RT 236,11,4096
 RT 238,11,4608
 MV 52,240,212
 buffer_load_dwordx4 v3, s[28:31], s70 offen lds
 MV 60,244,212
 WL 6
 RT 240,12,4096
 MV 56,244,208
 RT 242,12,4608
 MV 48,248,216
 RT 244,11,8448
 MV 52,248,220
 RT 246,11,8960
 MV 60,216,220
 RT 248,12,8448
 RT 250,12,8960
 MV 56,216,216
 buffer_load_dwordx4 v4, s[28:31], s70 offen offset:1088 lds
 MV 48,220,224
 RT 216,9,39232
 MV 52,220,228
 RT 218,9,39744
 MV 60,224,228
 WL 6
 RT 220,10,39232
 MV 56,224,224
 RT 222,10,39744
 MV 48,228,232
 RT 224,9,43584
 RT 226,9,44096
 MV 52,228,236
 buffer_load_dwordx4 v5, s[28:31], s70 offen offset:2176 lds
 MV 60,232,236
 RT 228,10,43584
 MV 56,232,232
 RT 230,10,44096
 MV 48,236,240
 RT 232,9,47936
 MV 52,236,244
 RT 234,9,48448
 MV 60,240,244
 WL 6
 RT 236,10,47936
 RT 238,10,48448
 MV 56,240,240
 buffer_load_dwordx4 v6, s[28:31], s70 offen offset:3264 lds
 MV 48,244,248
 RT 240,9,52288
 MV 52,244,252
 RT 242,9,52800
 MV 60,248,252
 RT 244,10,52288
 MV 56,248,248
 RT 246,10,52800
 MV 64,216,184
 RT 248,9,56640
 RT 250,9,57152
 MV 68,216,188
 s_add_u32 m0, s66, 0x1cb00
 s_add_u32 s70, s74, 0x288000
 MV 76,220,188
 WL 6
 RT 216,10,56640
 RT 218,10,57152
 MV 72,220,184
 buffer_load_dwordx4 v3, s[28:31], s70 offen lds
 MV 64,224,192
 RT 220,9,60992
 RT 222,9,61504
 MV 68,224,196
 EX 16,48
 MV 76,228,196
 RT 224,10,60992
 RT 226,10,61504
 MV 72,228,192
 EX 17,49
 MV 64,232,200
 RT 228,9,65344
 RT 230,11,320
 MV 68,232,204
 EX 18,50
 MV 76,236,204
 WL 6
 RT 232,10,65344
 RT 234,12,320
 MV 72,236,200
 EX 19,51
 MV 64,240,208
 RT 236,11,4160
 RT 238,11,4672
 MV 68,240,212
 v_add_f32 v16, 1.0, v16
 v_add_f32 v17, 1.0, v17
 MV 76,244,212
 RT 240,12,4160
 RT 242,12,4672
 MV 72,244,208
 v_add_f32 v18, 1.0, v18
 v_add_f32 v19, 1.0, v19
 MV 64,248,216
 RT 244,11,8512
 RT 246,11,9024
 MV 68,248,220
 v_rcp_f32 v16, v16
 MV 76,216,220
 WL 6
 RT 248,12,8512
 RT 250,12,9024
 MV 72,216,216
 v_rcp_f32 v17, v17
 MV 64,220,224
 s_waitcnt vmcnt(10)
 s_barrier
 RT 216,11,12800
 RT 218,11,13312
 MV 68,220,228
 s_add_u32 s73, s73, 0x80
 s_add_u32 s74, s74, 0x80
 MV 76,224,228
 RT 220,12,12800
 RT 222,12,13312
 MV 72,224,224
 s_add_u32 m0, s65, 0
 s_add_u32 s70, s73, 0
 MV 64,228,232
 RT 224,11,12864
 RT 226,11,13376
 MV 68,228,236
 buffer_load_dwordx4 v3, s[28:31], s70 offen lds
 MV 76,232,236
 WL 6
 RT 228,12,12864
 RT 230,12,13376
 MV 72,232,232
 MV 64,236,240
 RT 232,11,17152
 RT 234,11,17664
 MV 68,236,244
 MV 76,240,244
 RT 236,12,17152
 RT 238,12,17664
 MV 72,240,240
 buffer_load_dwordx4 v4, s[28:31], s70 offen offset:1088 lds
 MV 64,244,248
 RT 240,11,17216
 RT 242,11,17728
 MV 68,244,252
 MV 76,248,252
 WL 6
 RT 244,12,17216
 RT 246,12,17728
 MV 72,248,248
 v_mfma_f32_16x16x32_bf16 v[80:83], a[216:219], v[112:115], 0
 RT 248,11,21504
 RT 250,11,22016
 v_mfma_f32_16x16x32_bf16 v[84:87], a[216:219], v[116:119], 0
 buffer_load_dwordx4 v5, s[28:31], s70 offen offset:2176 lds
 v_rcp_f32 v18, v18
 ML 16,48,16
 v_mfma_f32_16x16x32_bf16 v[92:95], a[220:223], v[116:119], 0
 RT 216,12,21504
 RT 218,12,22016
 v_mfma_f32_16x16x32_bf16 v[88:91], a[220:223], v[112:115], 0
 v_rcp_f32 v19, v19
 ML 17,49,17
 v_mfma_f32_16x16x32_bf16 v[96:99], a[224:227], v[112:115], 0
 RT 220,11,21568
 RT 222,11,22080
 v_mfma_f32_16x16x32_bf16 v[100:103], a[224:227], v[116:119], 0
 ML 18,50,18
 ML 19,51,19
 CV 48,16,17
 v_mfma_f32_16x16x32_bf16 v[108:111], a[228:231], v[116:119], 0
 WL 6
 RT 224,12,21568
 RT 226,12,22080
 v_mfma_f32_16x16x32_bf16 v[104:107], a[228:231], v[112:115], 0
 buffer_load_dwordx4 v6, s[28:31], s70 offen offset:3264 lds
 CV 50,18,19
 EX 20,56
 MV 80,232,120
 RT 228,11,25856
 RT 230,11,26368
 MV 84,232,124
 EX 21,57
 v_add_f32 v20, 1.0, v20
 MV 92,236,124
 RT 232,12,25856
 RT 234,12,26368
 MV 88,236,120
 EX 22,58
 v_add_f32 v21, 1.0, v21
 MV 96,240,120
 RT 236,11,25920
 RT 238,11,26432
 MV 100,240,124
 s_add_u32 m0, m0, 0x1100
 s_add_u32 s70, s73, 0x48000
 EX 23,59
 v_add_f32 v22, 1.0, v22
 MV 108,244,124
 WL 6
 RT 240,12,25920
 RT 242,12,26432
 MV 104,244,120
 buffer_load_dwordx4 v3, s[28:31], s70 offen lds
 v_add_f32 v23, 1.0, v23
 v_rcp_f32 v20, v20
 MV 80,248,128
 RT 244,11,30208
 RT 246,11,30720
 MV 84,248,132
 v_rcp_f32 v21, v21
 ML 20,56,20
 MV 92,216,132
 RT 248,12,30208
 RT 250,12,30720
 MV 88,216,128
 v_rcp_f32 v22, v22
 ML 21,57,21
 MV 96,220,128
 RT 216,11,30272
 RT 218,11,30784
 MV 100,220,132
 buffer_load_dwordx4 v4, s[28:31], s70 offen offset:1088 lds
 v_rcp_f32 v23, v23
 ML 22,58,22
 MV 108,224,132
 WL 6
 RT 220,12,30272
 RT 222,12,30784
 MV 104,224,128
 ML 23,59,23
 CV 56,20,21
 CV 58,22,23
 MV 80,228,136
 RT 224,11,34560
 RT 226,11,35072
 MV 84,228,140
 EX 24,52
 MV 92,232,140
 RT 228,12,34560
 RT 230,12,35072
 MV 88,232,136
 buffer_load_dwordx4 v5, s[28:31], s70 offen offset:2176 lds
 EX 25,53
 EX 26,54
 MV 96,236,136
 RT 232,11,34624
 RT 234,11,35136
 MV 100,236,140
 EX 27,55
 v_add_f32 v24, 1.0, v24
 MV 108,240,140
 WL 6
 RT 236,12,34624
 RT 238,12,35136
 MV 104,240,136
 v_add_f32 v25, 1.0, v25
 v_add_f32 v26, 1.0, v26
 v_add_f32 v27, 1.0, v27
 MV 80,244,144
 RT 240,11,38912
 RT 242,11,39424
 MV 84,244,148
 buffer_load_dwordx4 v6, s[28:31], s70 offen offset:3264 lds
 v_rcp_f32 v24, v24
 MV 92,248,148
 RT 244,12,38912
 RT 246,12,39424
 MV 88,248,144
 v_rcp_f32 v25, v25
 v_rcp_f32 v26, v26
 MV 96,216,144
 RT 248,11,38976
 RT 250,11,39488
 MV 100,216,148
 v_rcp_f32 v27, v27
 ML 24,52,24
 MV 108,220,148
 WL 6
 RT 216,12,38976
 RT 218,12,39488
 MV 104,220,144
 s_add_u32 m0, s66, 0
 s_add_u32 s70, s74, 0
 ML 25,53,25
 ML 26,54,26
 ML 27,55,27
 MV 80,224,152
 RT 220,11,43264
 RT 222,11,43776
 MV 84,224,156
 buffer_load_dwordx4 v3, s[28:31], s70 offen lds
 CV 52,24,25
 CV 54,26,27
 MV 92,228,156
 RT 224,12,43264
 RT 226,12,43776
 MV 88,228,152
 EX 28,60
 EX 29,61
 MV 96,232,152
 RT 228,11,43328
 RT 230,11,43840
 MV 100,232,156
 EX 30,62
 v_add_f32 v28, 1.0, v28
 MV 108,236,156
 WL 6
 RT 232,12,43328
 RT 234,12,43840
 MV 104,236,152
 s_add_u32 s3, s3, 0x80
 EX 31,63
 v_add_f32 v29, 1.0, v29
 MV 80,240,160
 RT 236,11,47616
 RT 238,11,48128
 MV 84,240,164
 buffer_load_dword v47, v8, s[28:31], s3 offen
 v_add_f32 v30, 1.0, v30
 v_add_f32 v31, 1.0, v31
 MV 92,244,164
 RT 240,12,47616
 RT 242,12,48128
 MV 88,244,160
 v_rcp_f32 v28, v28
 v_rcp_f32 v29, v29
 MV 96,248,160
 RT 244,11,47680
 RT 246,11,48192
 MV 100,248,164
 v_rcp_f32 v30, v30
 ML 28,60,28
 MV 108,216,164
 WL 6
 RT 248,12,47680
 RT 250,12,48192
 MV 104,216,160
 v_rcp_f32 v31, v31
 ML 29,61,29
 MV 80,220,168
 s_waitcnt vmcnt(10)
 s_barrier
 RT 216,11,51968
 RT 218,11,52480
 MV 84,220,172
 s_add_u32 m0, s65, 0x9900
 s_add_u32 s70, s73, 0x288000
 ML 30,62,30
 ML 31,63,31
 CV 60,28,29
 MV 92,224,172
 RT 220,12,51968
 RT 222,12,52480
 MV 88,224,168
 buffer_load_dwordx4 v3, s[28:31], s70 offen lds
 CV 62,30,31
 EX 16,64
 MV 96,228,168
 RT 224,11,56320
 RT 226,11,56832
 MV 100,228,172
 EX 17,65
 v_add_f32 v16, 1.0, v16
 MV 108,232,172
 WL 6
 RT 228,12,56320
 RT 230,12,56832
 MV 104,232,168
 EX 18,66
 v_add_f32 v17, 1.0, v17
 MV 80,236,176
 RT 232,11,60672
 RT 234,11,61184
 MV 84,236,180
 buffer_load_dwordx4 v4, s[28:31], s70 offen offset:1088 lds
 EX 19,67
 v_add_f32 v18, 1.0, v18
 MV 92,240,180
 RT 236,12,60672
 RT 238,12,61184
 MV 88,240,176
 v_add_f32 v19, 1.0, v19
 v_rcp_f32 v16, v16
 MV 96,244,176
 RT 240,11,65024
 RT 242,13,0
 MV 100,244,180
 v_rcp_f32 v17, v17
 ML 16,64,16
 MV 108,248,180
 WL 6
 RT 244,12,65024
 RT 246,14,0
 MV 104,248,176
 buffer_load_dwordx4 v5, s[28:31], s70 offen offset:2176 lds
 v_rcp_f32 v18, v18
 ML 17,65,17
 MV 80,216,184
 RT 248,13,3840
 RT 250,13,4352
 MV 84,216,188
 v_rcp_f32 v19, v19
 ML 18,66,18
 MV 92,220,188
 RT 216,14,3840
 RT 218,14,4352
 MV 88,220,184
 ML 19,67,19
 CV 64,16,17
 CV 66,18,19
 MV 80,224,192
 RT 220,13,8192
 RT 222,13,8704
 MV 84,224,196
 buffer_load_dwordx4 v6, s[28:31], s70 offen offset:3264 lds
 EX 20,72
 MV 92,228,196
 WL 6
 RT 224,14,8192
 RT 226,14,8704
 MV 88,228,192
 EX 21,73
 EX 22,74
 MV 80,232,200
 RT 228,13,12544
 RT 230,13,13056
 MV 84,232,204
 EX 23,75
 v_add_f32 v20, 1.0, v20
 MV 92,236,204
 RT 232,14,12544
 RT 234,14,13056
 MV 88,236,200
 s_add_u32 m0, m0, 0x1100
 s_add_u32 s70, s73, 0x2d0000
 v_add_f32 v21, 1.0, v21
 v_add_f32 v22, 1.0, v22
 v_add_f32 v23, 1.0, v23
 MV 80,240,208
 RT 236,13,16896
 RT 238,13,17408
 MV 84,240,212
 buffer_load_dwordx4 v3, s[28:31], s70 offen lds
 v_rcp_f32 v20, v20
 MV 92,244,212
 WL 6
 RT 240,14,16896
 RT 242,14,17408
 MV 88,244,208
 v_rcp_f32 v21, v21
 v_rcp_f32 v22, v22
 MV 80,248,216
 RT 244,13,21248
 RT 246,13,21760
 MV 84,248,220
 v_rcp_f32 v23, v23
 ML 20,72,20
 MV 92,216,220
 RT 248,14,21248
 RT 250,14,21760
 MV 88,216,216
 buffer_load_dwordx4 v4, s[28:31], s70 offen offset:1088 lds
 ML 21,73,21
 ML 22,74,22
 ML 23,75,23
 MV 80,220,224
 RT 216,11,52032
 RT 218,11,52544
 MV 84,220,228
 CV 72,20,21
 CV 74,22,23
 MV 92,224,228
 WL 6
 RT 220,12,52032
 RT 222,12,52544
 MV 88,224,224
 EX 24,68
 EX 25,69
 MV 80,228,232
 RT 224,11,56384
 RT 226,11,56896
 MV 84,228,236
 buffer_load_dwordx4 v5, s[28:31], s70 offen offset:2176 lds
 EX 26,70
 v_add_f32 v24, 1.0, v24
 MV 92,232,236
 RT 228,12,56384
 RT 230,12,56896
 MV 88,232,232
 EX 27,71
 v_add_f32 v25, 1.0, v25
 MV 80,236,240
 RT 232,11,60736
 RT 234,11,61248
 MV 84,236,244
 v_add_f32 v26, 1.0, v26
 v_add_f32 v27, 1.0, v27
 MV 92,240,244
 WL 6
 RT 236,12,60736
 RT 238,12,61248
 MV 88,240,240
 buffer_load_dwordx4 v6, s[28:31], s70 offen offset:3264 lds
 v_rcp_f32 v24, v24
 v_rcp_f32 v25, v25
 MV 80,244,248
 RT 240,11,65088
 RT 242,13,64
 MV 84,244,252
 v_rcp_f32 v26, v26
 ML 24,68,24
 MV 92,248,252
 RT 244,12,65088
 RT 246,14,64
 MV 88,248,248
 v_rcp_f32 v27, v27
 ML 25,69,25
 MV 96,216,184
 RT 248,13,3904
 RT 250,13,4416
 MV 100,216,188
 s_add_u32 m0, s66, 0x9900
 s_add_u32 s70, s74, 0x288000
 ML 26,70,26
 ML 27,71,27
 CV 68,24,25
 MV 108,220,188
 WL 6
 RT 216,14,3904
 RT 218,14,4416
 MV 104,220,184
 buffer_load_dwordx4 v3, s[28:31], s70 offen lds
 CV 70,26,27
 EX 28,76
 MV 96,224,192
 RT 220,13,8256
 RT 222,13,8768
 MV 100,224,196
 EX 29,77
 v_add_f32 v28, 1.0, v28
 MV 108,228,196
 RT 224,14,8256
 RT 226,14,8768
 MV 104,228,192
 EX 30,78
 v_add_f32 v29, 1.0, v29
 MV 96,232,200
 RT 228,13,12608
 RT 230,13,13120
 MV 100,232,204
 v_min_u32 v39, 0xe9f80, v36
 v_add_u32 v36, 0x14000, v36
 EX 31,79
 v_add_f32 v30, 1.0, v30
 MV 108,236,204
 WL 6
 RT 232,14,12608
 RT 234,14,13120
 MV 104,236,200
 buffer_load_dword v47, v39, s[32:35], s46 offen
 v_add_f32 v31, 1.0, v31
 v_rcp_f32 v28, v28
 MV 96,240,208
 RT 236,13,16960
 RT 238,13,17472
 MV 100,240,212
 v_rcp_f32 v29, v29
 ML 28,76,28
 MV 108,244,212
 RT 240,14,16960
 RT 242,14,17472
 MV 104,244,208
 v_rcp_f32 v30, v30
 ML 29,77,29
 MV 96,248,216
 RT 244,13,21312
 RT 246,13,21824
 MV 100,248,220
 v_rcp_f32 v31, v31
 ML 30,78,30
 MV 108,216,220
 WL 6
 RT 248,14,21312
 RT 250,14,21824
 MV 104,216,216
 ML 31,79,31
 CV 76,28,29
 CV 78,30,31
 MV 96,220,224
 s_waitcnt vmcnt(11)
 s_barrier
 RT 216,9,0
 RT 218,9,512
 MV 100,220,228
 s_add_u32 s73, s73, 0x80
 s_add_u32 s74, s74, 0x80
 AW 0,48
 AW 1,50
 MV 108,224,228
 RT 220,10,0
 RT 222,10,512
 MV 104,224,224
 s_add_u32 m0, s65, 0x13200
 s_add_u32 s70, s73, 0
 AW 2,56
 AW 3,58
 MV 96,228,232
 RT 224,9,64
 RT 226,9,576
 MV 100,228,236
 buffer_load_dwordx4 v3, s[28:31], s70 offen lds
 AW 4,52
 AW 5,54
 MV 108,232,236
 WL 6
 RT 228,10,64
 RT 230,10,576
 MV 104,232,232
 AW 6,60
 AW 7,62
 MV 96,236,240
 RT 232,9,4352
 RT 234,9,4864
 MV 100,236,244
 AW 8,64
 AW 9,66
 MV 108,240,244
 RT 236,10,4352
 RT 238,10,4864
 MV 104,240,240
 buffer_load_dwordx4 v4, s[28:31], s70 offen offset:1088 lds
 AW 10,72
 AW 11,74
 MV 96,244,248
 RT 240,9,4416
 RT 242,9,4928
 MV 100,244,252
 AW 12,68
 AW 13,70
 MV 108,248,252
 WL 6
 RT 244,10,4416
 RT 246,10,4928
 MV 104,248,248
 AW 14,76
 AW 15,78
 v_mfma_f32_16x16x32_bf16 v[48:51], a[216:219], v[112:115], 0
 s_call_b64 s[56:57], L_F_sub0
 s_waitcnt vmcnt(11)
 s_barrier
 RT 216,11,12800
 RT 218,11,13312
 MV 68,220,228
 s_add_u32 s73, s73, 0x80
 s_add_u32 s74, s74, 0x80
 AW 16,80
 AW 17,82
 MV 76,224,228
 RT 220,12,12800
 RT 222,12,13312
 MV 72,224,224
 s_add_u32 m0, s65, 0
 s_add_u32 s70, s73, 0
 AW 18,88
 AW 19,90
 MV 64,228,232
 RT 224,11,12864
 RT 226,11,13376
 MV 68,228,236
 buffer_load_dwordx4 v3, s[28:31], s70 offen lds
 AW 20,84
 AW 21,86
 MV 76,232,236
 WL 6
 RT 228,12,12864
 RT 230,12,13376
 MV 72,232,232
 AW 22,92
 AW 23,94
 MV 64,236,240
 RT 232,11,17152
 RT 234,11,17664
 MV 68,236,244
 AW 24,96
 AW 25,98
 MV 76,240,244
 RT 236,12,17152
 RT 238,12,17664
 MV 72,240,240
 buffer_load_dwordx4 v4, s[28:31], s70 offen offset:1088 lds
 AW 26,104
 AW 27,106
 MV 64,244,248
 RT 240,11,17216
 RT 242,11,17728
 MV 68,244,252
 AW 28,100
 AW 29,102
 MV 76,248,252
 WL 6
 RT 244,12,17216
 RT 246,12,17728
 MV 72,248,248
 AW 30,108
 AW 31,110
 v_mfma_f32_16x16x32_bf16 v[80:83], a[216:219], v[112:115], 0
 s_call_b64 s[56:57], L_F_sub1
 s_waitcnt vmcnt(11)
 s_barrier
 RT 216,9,0
 RT 218,9,512
 MV 100,220,228
 s_add_u32 s73, s73, 0x80
 s_add_u32 s74, s74, 0x80
 AW 32,48
 AW 33,50
 MV 108,224,228
 RT 220,10,0
 RT 222,10,512
 MV 104,224,224
 s_add_u32 m0, s65, 0x13200
 s_add_u32 s70, s73, 0
 AW 34,56
 AW 35,58
 MV 96,228,232
 RT 224,9,64
 RT 226,9,576
 MV 100,228,236
 buffer_load_dwordx4 v3, s[28:31], s70 offen lds
 AW 36,52
 AW 37,54
 MV 108,232,236
 WL 6
 RT 228,10,64
 RT 230,10,576
 MV 104,232,232
 AW 38,60
 AW 39,62
 MV 96,236,240
 RT 232,9,4352
 RT 234,9,4864
 MV 100,236,244
 AW 40,64
 AW 41,66
 MV 108,240,244
 RT 236,10,4352
 RT 238,10,4864
 MV 104,240,240
 buffer_load_dwordx4 v4, s[28:31], s70 offen offset:1088 lds
 AW 42,72
 AW 43,74
 MV 96,244,248
 RT 240,9,4416
 RT 242,9,4928
 MV 100,244,252
 AW 44,68
 AW 45,70
 MV 108,248,252
 WL 6
 RT 244,10,4416
 RT 246,10,4928
 MV 104,248,248
 AW 46,76
 AW 47,78
 v_mfma_f32_16x16x32_bf16 v[48:51], a[216:219], v[112:115], 0
 s_call_b64 s[56:57], L_F_sub0
 s_waitcnt vmcnt(11)
 s_barrier
 RT 216,11,12800
 RT 218,11,13312
 MV 68,220,228
 s_add_u32 s73, s73, 0x80
 s_add_u32 s74, s74, 0x80
 AW 48,80
 AW 49,82
 MV 76,224,228
 RT 220,12,12800
 RT 222,12,13312
 MV 72,224,224
 s_add_u32 m0, s65, 0
 s_add_u32 s70, s73, 0
 AW 50,88
 AW 51,90
 MV 64,228,232
 RT 224,11,12864
 RT 226,11,13376
 MV 68,228,236
 buffer_load_dwordx4 v3, s[28:31], s70 offen lds
 AW 52,84
 AW 53,86
 MV 76,232,236
 WL 6
 RT 228,12,12864
 RT 230,12,13376
 MV 72,232,232
 AW 54,92
 AW 55,94
 MV 64,236,240
 RT 232,11,17152
 RT 234,11,17664
 MV 68,236,244
 AW 56,96
 AW 57,98
 MV 76,240,244
 RT 236,12,17152
 RT 238,12,17664
 MV 72,240,240
 buffer_load_dwordx4 v4, s[28:31], s70 offen offset:1088 lds
 AW 58,104
 AW 59,106
 MV 64,244,248
 RT 240,11,17216
 RT 242,11,17728
 MV 68,244,252
 AW 60,100
 AW 61,102
 MV 76,248,252
 WL 6
 RT 244,12,17216
 RT 246,12,17728
 MV 72,248,248
 AW 62,108
 AW 63,110
 v_mfma_f32_16x16x32_bf16 v[80:83], a[216:219], v[112:115], 0
 s_call_b64 s[56:57], L_F_sub1
 s_waitcnt vmcnt(11)
 s_barrier
 RT 216,9,0
 RT 218,9,512
 MV 100,220,228
 s_add_u32 s73, s73, 0x80
 s_add_u32 s74, s74, 0x80
 AW 64,48
 AW 65,50
 MV 108,224,228
 RT 220,10,0
 RT 222,10,512
 MV 104,224,224
 s_add_u32 m0, s65, 0x13200
 s_add_u32 s70, s73, 0
 AW 66,56
 AW 67,58
 MV 96,228,232
 RT 224,9,64
 RT 226,9,576
 MV 100,228,236
 buffer_load_dwordx4 v3, s[28:31], s70 offen lds
 AW 68,52
 AW 69,54
 MV 108,232,236
 WL 6
 RT 228,10,64
 RT 230,10,576
 MV 104,232,232
 AW 70,60
 AW 71,62
 MV 96,236,240
 RT 232,9,4352
 RT 234,9,4864
 MV 100,236,244
 AW 72,64
 AW 73,66
 MV 108,240,244
 RT 236,10,4352
 RT 238,10,4864
 MV 104,240,240
 buffer_load_dwordx4 v4, s[28:31], s70 offen offset:1088 lds
 AW 74,72
 AW 75,74
 MV 96,244,248
 RT 240,9,4416
 RT 242,9,4928
 MV 100,244,252
 AW 76,68
 AW 77,70
 MV 108,248,252
 WL 6
 RT 244,10,4416
 RT 246,10,4928
 MV 104,248,248
 AW 78,76
 AW 79,78
 v_mfma_f32_16x16x32_bf16 v[48:51], a[216:219], v[112:115], 0
 s_call_b64 s[56:57], L_F_sub0
 s_waitcnt vmcnt(11)
 s_barrier
 RT 216,11,12800
 RT 218,11,13312
 MV 68,220,228
 s_add_u32 s73, s73, 0x80
 s_add_u32 s74, s74, 0x80
 AW 80,80
 AW 81,82
 MV 76,224,228
 RT 220,12,12800
 RT 222,12,13312
 MV 72,224,224
 s_add_u32 m0, s65, 0
 s_add_u32 s70, s73, 0
 AW 82,88
 AW 83,90
 MV 64,228,232
 RT 224,11,12864
 RT 226,11,13376
 MV 68,228,236
 buffer_load_dwordx4 v3, s[28:31], s70 offen lds
 AW 84,84
 AW 85,86
 MV 76,232,236
 WL 6
 RT 228,12,12864
 RT 230,12,13376
 MV 72,232,232
 AW 86,92
 AW 87,94
 MV 64,236,240
 RT 232,11,17152
 RT 234,11,17664
 MV 68,236,244
 AW 88,96
 AW 89,98
 MV 76,240,244
 RT 236,12,17152
 RT 238,12,17664
 MV 72,240,240
 buffer_load_dwordx4 v4, s[28:31], s70 offen offset:1088 lds
 AW 90,104
 AW 91,106
 MV 64,244,248
 RT 240,11,17216
 RT 242,11,17728
 MV 68,244,252
 AW 92,100
 AW 93,102
 MV 76,248,252
 WL 6
 RT 244,12,17216
 RT 246,12,17728
 MV 72,248,248
 AW 94,108
 AW 95,110
 v_mfma_f32_16x16x32_bf16 v[80:83], a[216:219], v[112:115], 0
 s_call_b64 s[56:57], L_F_sub1
 s_waitcnt vmcnt(11)
 s_barrier
 RT 216,9,0
 RT 218,9,512
 MV 100,220,228
 s_add_u32 s73, s73, 0x80
 s_add_u32 s74, s74, 0x80
 AW 96,48
 AW 97,50
 MV 108,224,228
 RT 220,10,0
 RT 222,10,512
 MV 104,224,224
 s_add_u32 m0, s65, 0x13200
 s_add_u32 s70, s73, 0
 AW 98,56
 AW 99,58
 MV 96,228,232
 RT 224,9,64
 RT 226,9,576
 MV 100,228,236
 buffer_load_dwordx4 v3, s[28:31], s70 offen lds
 AW 100,52
 AW 101,54
 MV 108,232,236
 WL 6
 RT 228,10,64
 RT 230,10,576
 MV 104,232,232
 AW 102,60
 AW 103,62
 MV 96,236,240
 RT 232,9,4352
 RT 234,9,4864
 MV 100,236,244
 AW 104,64
 AW 105,66
 MV 108,240,244
 RT 236,10,4352
 RT 238,10,4864
 MV 104,240,240
 buffer_load_dwordx4 v4, s[28:31], s70 offen offset:1088 lds
 AW 106,72
 AW 107,74
 MV 96,244,248
 RT 240,9,4416
 RT 242,9,4928
 MV 100,244,252
 AW 108,68
 AW 109,70
 MV 108,248,252
 WL 6
 RT 244,10,4416
 RT 246,10,4928
 MV 104,248,248
 AW 110,76
 AW 111,78
 v_mfma_f32_16x16x32_bf16 v[48:51], a[216:219], v[112:115], 0
 s_call_b64 s[56:57], L_F_sub0
 s_waitcnt vmcnt(11)
 s_barrier
 RT 216,11,12800
 RT 218,11,13312
 MV 68,220,228
 s_add_u32 s73, s73, 0x80
 s_add_u32 s74, s74, 0x80
 AW 112,80
 AW 113,82
 MV 76,224,228
 RT 220,12,12800
 RT 222,12,13312
 MV 72,224,224
 s_add_u32 m0, s65, 0
 s_add_u32 s70, s73, 0
 AW 114,88
 AW 115,90
 MV 64,228,232
 RT 224,11,12864
 RT 226,11,13376
 MV 68,228,236
 buffer_load_dwordx4 v3, s[28:31], s70 offen lds
 AW 116,84
 AW 117,86
 MV 76,232,236
 WL 6
 RT 228,12,12864
 RT 230,12,13376
 MV 72,232,232
 AW 118,92
 AW 119,94
 MV 64,236,240
 RT 232,11,17152
 RT 234,11,17664
 MV 68,236,244
 AW 120,96
 AW 121,98
 MV 76,240,244
 RT 236,12,17152
 RT 238,12,17664
 MV 72,240,240
 buffer_load_dwordx4 v4, s[28:31], s70 offen offset:1088 lds
 AW 122,104
 AW 123,106
 MV 64,244,248
 RT 240,11,17216
 RT 242,11,17728
 MV 68,244,252
 AW 124,100
 AW 125,102
 MV 76,248,252
 WL 6
 RT 244,12,17216
 RT 246,12,17728
 MV 72,248,248
 AW 126,108
 AW 127,110
 v_mfma_f32_16x16x32_bf16 v[80:83], a[216:219], v[112:115], 0
 s_call_b64 s[56:57], L_F_sub1
 s_waitcnt vmcnt(11)
 s_barrier
 RT 216,9,0
 RT 218,9,512
 MV 100,220,228
 s_add_u32 s73, s73, 0x80
 s_add_u32 s74, s74, 0x80
 AW 128,48
 AW 129,50
 MV 108,224,228
 RT 220,10,0
 RT 222,10,512
 MV 104,224,224
 s_add_u32 m0, s65, 0x13200
 s_add_u32 s70, s73, 0
 AW 130,56
 AW 131,58
 MV 96,228,232
 RT 224,9,64
 RT 226,9,576
 MV 100,228,236
 buffer_load_dwordx4 v3, s[28:31], s70 offen lds
 AW 132,52
 AW 133,54
 MV 108,232,236
 WL 6
 RT 228,10,64
 RT 230,10,576
 MV 104,232,232
 AW 134,60
 AW 135,62
 MV 96,236,240
 RT 232,9,4352
 RT 234,9,4864
 MV 100,236,244
 AW 136,64
 AW 137,66
 MV 108,240,244
 RT 236,10,4352
 RT 238,10,4864
 MV 104,240,240
 buffer_load_dwordx4 v4, s[28:31], s70 offen offset:1088 lds
 AW 138,72
 AW 139,74
 MV 96,244,248
 RT 240,9,4416
 RT 242,9,4928
 MV 100,244,252
 AW 140,68
 AW 141,70
 MV 108,248,252
 WL 6
 RT 244,10,4416
 RT 246,10,4928
 MV 104,248,248
 AW 142,76
 AW 143,78
 v_mfma_f32_16x16x32_bf16 v[48:51], a[216:219], v[112:115], 0
 s_call_b64 s[56:57], L_F_sub0
 s_waitcnt vmcnt(11)
 s_barrier
 RT 216,11,12800
 RT 218,11,13312
 MV 68,220,228
 s_add_u32 s73, s73, 0x80
 s_add_u32 s74, s74, 0x80
 AW 144,80
 AW 145,82
 MV 76,224,228
 RT 220,12,12800
 RT 222,12,13312
 MV 72,224,224
 s_add_u32 m0, s65, 0
 s_add_u32 s70, s73, 0
 AW 146,88
 AW 147,90
 MV 64,228,232
 RT 224,11,12864
 RT 226,11,13376
 MV 68,228,236
 buffer_load_dwordx4 v3, s[28:31], s70 offen lds
 AW 148,84
 AW 149,86
 MV 76,232,236
 WL 6
 RT 228,12,12864
 RT 230,12,13376
 MV 72,232,232
 AW 150,92
 AW 151,94
 MV 64,236,240
 RT 232,11,17152
 RT 234,11,17664
 MV 68,236,244
 AW 152,96
 AW 153,98
 MV 76,240,244
 RT 236,12,17152
 RT 238,12,17664
 MV 72,240,240
 buffer_load_dwordx4 v4, s[28:31], s70 offen offset:1088 lds
 AW 154,104
 AW 155,106
 MV 64,244,248
 RT 240,11,17216
 RT 242,11,17728
 MV 68,244,252
 AW 156,100
 AW 157,102
 MV 76,248,252
 WL 6
 RT 244,12,17216
 RT 246,12,17728
 MV 72,248,248
 AW 158,108
 AW 159,110
 v_mfma_f32_16x16x32_bf16 v[80:83], a[216:219], v[112:115], 0
 s_call_b64 s[56:57], L_F_sub1
 s_waitcnt vmcnt(11)
 s_barrier
 RT 216,9,0
 RT 218,9,512
 MV 100,220,228
 s_add_u32 m0, s67, 0x13200
 s_add_u32 s70, s75, 0
 AW 160,48
 AW 161,50
 MV 108,224,228
 RT 220,10,0
 RT 222,10,512
 MV 104,224,224
 buffer_load_dwordx4 v7, s[28:31], s70 offen lds
 AW 162,56
 AW 163,58
 MV 96,228,232
 RT 224,9,64
 RT 226,9,576
 MV 100,228,236
 AW 164,52
 AW 165,54
 MV 108,232,236
 WL 6
 RT 228,10,64
 RT 230,10,576
 MV 104,232,232
 AW 166,60
 AW 167,62
 MV 96,236,240
 RT 232,9,4352
 RT 234,9,4864
 MV 100,236,244
 s_add_u32 s70, s75, 0x23c00
 AW 168,64
 AW 169,66
 MV 108,240,244
 RT 236,10,4352
 RT 238,10,4864
 MV 104,240,240
 buffer_load_dwordx4 v7, s[28:31], s70 offen offset:1024 lds
 AW 170,72
 AW 171,74
 MV 96,244,248
 RT 240,9,4416
 RT 242,9,4928
 MV 100,244,252
 AW 172,68
 AW 173,70
 MV 108,248,252
 WL 6
 RT 244,10,4416
 RT 246,10,4928
 MV 104,248,248
 AW 174,76
 AW 175,78
 v_mfma_f32_16x16x32_bf16 v[48:51], a[216:219], v[112:115], 0
 RT 248,9,8704
 RT 250,9,9216
 v_mfma_f32_16x16x32_bf16 v[52:55], a[216:219], v[116:119], 0
 s_add_u32 s70, s75, 0x47800
 EX 16,80
 EX 17,81
 v_mfma_f32_16x16x32_bf16 v[60:63], a[220:223], v[116:119], 0
 RT 216,10,8704
 RT 218,10,9216
 v_mfma_f32_16x16x32_bf16 v[56:59], a[220:223], v[112:115], 0
 buffer_load_dwordx4 v7, s[28:31], s70 offen offset:2048 lds
 EX 18,82
 EX 19,83
 v_mfma_f32_16x16x32_bf16 v[64:67], a[224:227], v[112:115], 0
 RT 220,9,8768
 RT 222,9,9280
 v_mfma_f32_16x16x32_bf16 v[68:71], a[224:227], v[116:119], 0
 v_add_f32 v16, 1.0, v16
 v_add_f32 v17, 1.0, v17
 v_add_f32 v18, 1.0, v18
 v_add_f32 v19, 1.0, v19
 v_mfma_f32_16x16x32_bf16 v[76:79], a[228:231], v[116:119], 0
 WL 6
 RT 224,10,8768
 RT 226,10,9280
 v_mfma_f32_16x16x32_bf16 v[72:75], a[228:231], v[112:115], 0
 v_rcp_f32 v16, v16
 v_rcp_f32 v17, v17
 MV 48,232,120
 RT 228,9,13056
 RT 230,9,13568
 MV 52,232,124
 s_add_u32 s70, s75, 0x6b400
 v_rcp_f32 v18, v18
 v_rcp_f32 v19, v19
 MV 60,236,124
 RT 232,10,13056
 RT 234,10,13568
 MV 56,236,120
 buffer_load_dwordx4 v7, s[28:31], s70 offen offset:3072 lds
 ML 16,80,16
 ML 17,81,17
 ML 18,82,18
 ML 19,83,19
 MV 64,240,120
 RT 236,9,13120
 RT 238,9,13632
 MV 68,240,124
 CV 80,16,17
 CV 82,18,19
 EX 20,88
 MV 76,244,124
 WL 6
 RT 240,10,13120
 RT 242,10,13632
 MV 72,244,120
 EX 21,89
 EX 22,90
 MV 48,248,128
 RT 244,9,17408
 RT 246,9,17920
 MV 52,248,132
 s_add_u32 m0, m0, 0x1000
 s_add_u32 s70, s75, 0x90000
 EX 23,91
 v_add_f32 v20, 1.0, v20
 v_add_f32 v21, 1.0, v21
 MV 60,216,132
 RT 248,10,17408
 RT 250,10,17920
 MV 56,216,128
 buffer_load_dwordx4 v7, s[28:31], s70 offen lds
 v_add_f32 v22, 1.0, v22
 v_add_f32 v23, 1.0, v23
 v_rcp_f32 v20, v20
 MV 64,220,128
 RT 216,9,17472
 RT 218,9,17984
 MV 68,220,132
 v_rcp_f32 v21, v21
 v_rcp_f32 v22, v22
 MV 76,224,132
 WL 6
 RT 220,10,17472
 RT 222,10,17984
 MV 72,224,128
 v_rcp_f32 v23, v23
 ML 20,88,20
 ML 21,89,21
 MV 48,228,136
 RT 224,9,21760
 RT 226,9,22272
 MV 52,228,140
 s_add_u32 s70, s75, 0xb3c00
 ML 22,90,22
 ML 23,91,23
 CV 88,20,21
 CV 90,22,23
 MV 60,232,140
 RT 228,10,21760
 RT 230,10,22272
 MV 56,232,136
 buffer_load_dwordx4 v7, s[28:31], s70 offen offset:1024 lds
 EX 24,84
 EX 25,85
 MV 64,236,136
 RT 232,9,21824
 RT 234,9,22336
 MV 68,236,140
 EX 26,86
 EX 27,87
 MV 76,240,140
 WL 6
 RT 236,10,21824
 RT 238,10,22336
 MV 72,240,136
 v_add_f32 v24, 1.0, v24
 v_add_f32 v25, 1.0, v25
 v_add_f32 v26, 1.0, v26
 v_add_f32 v27, 1.0, v27
 MV 48,244,144
 RT 240,9,26112
 RT 242,9,26624
 MV 52,244,148
 s_add_u32 s70, s75, 0xd7800
 v_rcp_f32 v24, v24
 MV 60,248,148
 RT 244,10,26112
 RT 246,10,26624
 MV 56,248,144
 buffer_load_dwordx4 v7, s[28:31], s70 offen offset:2048 lds
 v_rcp_f32 v25, v25
 v_rcp_f32 v26, v26
 MV 64,216,144
 RT 248,9,26176
 RT 250,9,26688
 MV 68,216,148
 v_rcp_f32 v27, v27
 ML 24,84,24
 MV 76,220,148
 WL 6
 RT 216,10,26176
 RT 218,10,26688
 MV 72,220,144
 ML 25,85,25
 ML 26,86,26
 ML 27,87,27
 MV 48,224,152
 RT 220,9,30464
 RT 222,9,30976
 MV 52,224,156
 s_add_u32 s70, s75, 0xfb400
 CV 84,24,25
 CV 86,26,27
 MV 60,228,156
 RT 224,10,30464
 RT 226,10,30976
 MV 56,228,152
 buffer_load_dwordx4 v7, s[28:31], s70 offen offset:3072 lds
 EX 28,92
 EX 29,93
 MV 64,232,152
 RT 228,9,30528
 RT 230,9,31040
 MV 68,232,156
 EX 30,94
 v_add_f32 v28, 1.0, v28
 MV 76,236,156
 WL 6
 RT 232,10,30528
 RT 234,10,31040
 MV 72,236,152
 EX 31,95
 v_add_f32 v29, 1.0, v29
 MV 48,240,160
 RT 236,9,34816
 RT 238,9,35328
 MV 52,240,164
 s_add_u32 m0, s68, 0x13200
 v_add_f32 v30, 1.0, v30
 v_add_f32 v31, 1.0, v31
 MV 60,244,164
 RT 240,10,34816
 RT 242,10,35328
 MV 56,244,160
 buffer_load_dwordx4 v7, s[28:31], s76 offen lds
 v_rcp_f32 v28, v28
 v_rcp_f32 v29, v29
 MV 64,248,160
 RT 244,9,34880
 RT 246,9,35392
 MV 68,248,164
 v_rcp_f32 v30, v30
 ML 28,92,28
 MV 76,216,164
 WL 6
 RT 248,10,34880
 RT 250,10,35392
 MV 72,216,160
 v_rcp_f32 v31, v31
 ML 29,93,29
 MV 48,220,168
 s_add_u32 s3, s3, 0x80
 buffer_load_dword v47, v8, s[28:31], s3 offen
 s_waitcnt vmcnt(11)
 s_barrier
 RT 216,9,39168
 RT 218,9,39680
 MV 52,220,172
 s_mov_b32 s92, 0x480
 v_mad_u32_u24 v3, v41, s92, v2
 v_add_u32 v4, 0xdc0, v3
 v_add_u32 v5, 0xdc0, v4
 v_add_u32 v6, 0xdc0, v5
 ML 30,94,30
 ML 31,95,31
 CV 92,28,29
 MV 60,224,172
 RT 220,10,39168
 RT 222,10,39680
 MV 56,224,168
 s_add_u32 m0, s65, 0x1cb00
 s_add_u32 s70, s84, 0
 CV 94,30,31
 EX 16,96
 MV 64,228,168
 RT 224,9,43520
 RT 226,9,44032
 MV 68,228,172
 buffer_load_dwordx4 v3, s[32:35], s70 offen lds
 EX 17,97
 v_add_f32 v16, 1.0, v16
 MV 76,232,172
 WL 6
 RT 228,10,43520
 RT 230,10,44032
 MV 72,232,168
 EX 18,98
 v_add_f32 v17, 1.0, v17
 MV 48,236,176
 RT 232,9,47872
 RT 234,9,48384
 MV 52,236,180
 EX 19,99
 v_add_f32 v18, 1.0, v18
 MV 60,240,180
 RT 236,10,47872
 RT 238,10,48384
 MV 56,240,176
 buffer_load_dwordx4 v4, s[32:35], s70 offen offset:1088 lds
 v_add_f32 v19, 1.0, v19
 v_rcp_f32 v16, v16
 MV 64,244,176
 RT 240,9,52224
 RT 242,9,52736
 MV 68,244,180
 v_rcp_f32 v17, v17
 ML 16,96,16
 MV 76,248,180
 WL 6
 RT 244,10,52224
 RT 246,10,52736
 MV 72,248,176
 v_rcp_f32 v18, v18
 ML 17,97,17
 MV 48,216,184
 RT 248,9,56576
 RT 250,9,57088
 MV 52,216,188
 buffer_load_dwordx4 v5, s[32:35], s70 offen offset:2176 lds
 v_rcp_f32 v19, v19
 ML 18,98,18
 MV 60,220,188
 RT 216,10,56576
 RT 218,10,57088
 MV 56,220,184
 ML 19,99,19
 CV 96,16,17
 CV 98,18,19
 MV 48,224,192
 RT 220,9,60928
 RT 222,9,61440
 MV 52,224,196
 EX 20,104
 MV 60,228,196
 WL 6
 RT 224,10,60928
 RT 226,10,61440
 MV 56,228,192
 buffer_load_dwordx4 v6, s[32:35], s70 offen offset:3264 lds
 EX 21,105
 EX 22,106
 MV 48,232,200
 RT 228,9,65280
 RT 230,11,256
 MV 52,232,204
 EX 23,107
 v_add_f32 v20, 1.0, v20
 MV 60,236,204
 RT 232,10,65280
 RT 234,12,256
 MV 56,236,200
 v_add_f32 v21, 1.0, v21
 v_add_f32 v22, 1.0, v22
 v_add_f32 v23, 1.0, v23
 MV 48,240,208
 RT 236,11,4096
 RT 238,11,4608
 MV 52,240,212
 s_add_u32 m0, m0, 0x1100
 s_add_u32 s70, s84, 0x9000
 v_rcp_f32 v20, v20
 MV 60,244,212
 WL 6
 RT 240,12,4096
 RT 242,12,4608
 MV 56,244,208
 buffer_load_dwordx4 v3, s[32:35], s70 offen lds
 v_rcp_f32 v21, v21
 v_rcp_f32 v22, v22
 MV 48,248,216
 RT 244,11,8448
 RT 246,11,8960
 MV 52,248,220
 v_rcp_f32 v23, v23
 ML 20,104,20
 MV 60,216,220
 RT 248,12,8448
 RT 250,12,8960
 MV 56,216,216
 ML 21,105,21
 ML 22,106,22
 ML 23,107,23
 MV 48,220,224
 RT 216,9,39232
 RT 218,9,39744
 MV 52,220,228
 buffer_load_dwordx4 v4, s[32:35], s70 offen offset:1088 lds
 CV 104,20,21
 CV 106,22,23
 MV 60,224,228
 WL 6
 RT 220,10,39232
 RT 222,10,39744
 MV 56,224,224
 EX 24,100
 EX 25,101
 MV 48,228,232
 RT 224,9,43584
 RT 226,9,44096
 MV 52,228,236
 EX 26,102
 v_add_f32 v24, 1.0, v24
 MV 60,232,236
 RT 228,10,43584
 RT 230,10,44096
 MV 56,232,232
 buffer_load_dwordx4 v5, s[32:35], s70 offen offset:2176 lds
 EX 27,103
 v_add_f32 v25, 1.0, v25
 MV 48,236,240
 RT 232,9,47936
 RT 234,9,48448
 MV 52,236,244
 v_add_f32 v26, 1.0, v26
 v_add_f32 v27, 1.0, v27
 MV 60,240,244
 WL 6
 RT 236,10,47936
 RT 238,10,48448
 MV 56,240,240
 v_rcp_f32 v24, v24
 v_rcp_f32 v25, v25
 MV 48,244,248
 RT 240,9,52288
 RT 242,9,52800
 MV 52,244,252
 buffer_load_dwordx4 v6, s[32:35], s70 offen offset:3264 lds
 v_rcp_f32 v26, v26
 ML 24,100,24
 MV 60,248,252
 RT 244,10,52288
 RT 246,10,52800
 MV 56,248,248
 v_rcp_f32 v27, v27
 ML 25,101,25
 MV 64,216,184
 RT 248,9,56640
 RT 250,9,57152
 MV 68,216,188
 ML 26,102,26
 ML 27,103,27
 CV 100,24,25
 MV 76,220,188
 WL 6
 RT 216,10,56640
 RT 218,10,57152
 MV 72,220,184
 s_add_u32 m0, s66, 0x1cb00
 s_add_u32 s70, s85, 0
 CV 102,26,27
 EX 28,108
 MV 64,224,192
 RT 220,9,60992
 RT 222,9,61504
 MV 68,224,196
 buffer_load_dwordx4 v3, s[32:35], s70 offen lds
 EX 29,109
 v_add_f32 v28, 1.0, v28
 MV 76,228,196
 RT 224,10,60992
 RT 226,10,61504
 MV 72,228,192
 EX 30,110
 v_add_f32 v29, 1.0, v29
 MV 64,232,200
 RT 228,9,65344
 RT 230,11,320
 MV 68,232,204
 EX 31,111
 v_add_f32 v30, 1.0, v30
 MV 76,236,204
 WL 6
 RT 232,10,65344
 RT 234,12,320
 MV 72,236,200
 v_min_u32 v39, 0xe9f80, v36
 v_add_u32 v36, 0x14000, v36
 v_add_f32 v31, 1.0, v31
 v_rcp_f32 v28, v28
 MV 64,240,208
 RT 236,11,4160
 RT 238,11,4672
 MV 68,240,212
 buffer_load_dword v47, v39, s[32:35], s46 offen
 v_rcp_f32 v29, v29
 ML 28,108,28
 MV 76,244,212
 RT 240,12,4160
 RT 242,12,4672
 MV 72,244,208
 v_rcp_f32 v30, v30
 ML 29,109,29
 MV 64,248,216
 RT 244,11,8512
 RT 246,11,9024
 MV 68,248,220
 v_rcp_f32 v31, v31
 ML 30,110,30
 MV 76,216,220
 WL 6
 RT 248,12,8512
 RT 250,12,9024
 MV 72,216,216
 s_getpc_b64 s[94:95]
L_cp0:
 s_add_u32 s94, s94, L_F_p2-L_cp0
 s_addc_u32 s95, s95, 0
 v_bfe_u32 v40, v38, 16, 5
 v_and_b32 v39, 63, v38
 v_min_u32 v39, 4, v39
 v_mad_u32_u24 v39, v40, 5, v39
 v_lshlrev_b32 v39, 7, v39
 v_min_u32 v39, L_F_p2+20480-L_F_p2-4, v39
 v_add_u32 v15, 0x13200, v15
 v_add_u32 v37, 0x13200, v37
 ML 31,111,31
 CV 108,28,29
 CV 110,30,31
 MV 64,220,224
 global_load_dword v47, v39, s[94:95]
 s_waitcnt vmcnt(12)
 s_barrier
 RT 216,15,0
 RT 218,15,256
 MV 68,220,228
 s_add_u32 m0, s65, 0
 s_add_u32 s70, s84, 0x51000
 AW 176,80
 AW 177,82
 MV 76,224,228
 RT 220,37,0
 RT 222,37,256
 MV 72,224,224
 buffer_load_dwordx4 v3, s[32:35], s70 offen lds
 AW 178,88
 AW 179,90
 MV 64,228,232
 RT 224,15,2048
 RT 226,15,2304
 MV 68,228,236
 AW 180,84
 AW 181,86
 MV 76,232,236
 WL 6
 RT 228,37,2048
 RT 230,37,2304
 MV 72,232,232
 AW 182,92
 AW 183,94
 MV 64,236,240
 RT 232,15,4096
 RT 234,15,4352
 MV 68,236,244
 buffer_load_dwordx4 v4, s[32:35], s70 offen offset:1088 lds
 AW 184,96
 AW 185,98
 MV 76,240,244
 RT 236,37,4096
 RT 238,37,4352
 MV 72,240,240
 AW 186,104
 AW 187,106
 MV 64,244,248
 RT 240,15,6144
 RT 242,15,6400
 MV 68,244,252
 AW 188,100
 AW 189,102
 MV 76,248,252
 WL 6
 RT 244,37,6144
 RT 246,37,6400
 MV 72,248,248
 buffer_load_dwordx4 v5, s[32:35], s70 offen offset:2176 lds
 AW 190,108
 AW 191,110
 v_mfma_f32_16x16x32_bf16 v[80:83], a[216:219], v[112:115], 0
 RT 248,15,8192
 RT 250,15,8448
 v_mfma_f32_16x16x32_bf16 v[84:87], a[216:219], v[116:119], 0
 EX 16,48
 v_mfma_f32_16x16x32_bf16 v[92:95], a[220:223], v[116:119], 0
 RT 216,37,8192
 RT 218,37,8448
 v_mfma_f32_16x16x32_bf16 v[88:91], a[220:223], v[112:115], 0
 EX 17,49
 MV 80,224,120
 RT 220,15,10240
 RT 222,15,10496
 MV 84,224,124
 buffer_load_dwordx4 v6, s[32:35], s70 offen offset:3264 lds
 EX 18,50
 MV 92,228,124
 WL 6
 RT 224,37,10240
 RT 226,37,10496
 MV 88,228,120
 EX 19,51
 MV 80,232,128
 RT 228,15,12288
 RT 230,15,12544
 MV 84,232,132
 v_add_f32 v16, 1.0, v16
 v_add_f32 v17, 1.0, v17
 MV 92,236,132
 RT 232,37,12288
 RT 234,37,12544
 MV 88,236,128
 s_add_u32 m0, m0, 0x1100
 s_add_u32 s70, s84, 0x5a000
 v_add_f32 v18, 1.0, v18
 v_add_f32 v19, 1.0, v19
 MV 80,240,136
 RT 236,15,14336
 RT 238,15,14592
 MV 84,240,140
 buffer_load_dwordx4 v3, s[32:35], s70 offen lds
 v_rcp_f32 v16, v16
 MV 92,244,140
 WL 6
 RT 240,37,14336
 RT 242,37,14592
 MV 88,244,136
 v_rcp_f32 v17, v17
 MV 80,248,144
 RT 244,15,16384
 RT 246,15,16640
 MV 84,248,148
 v_rcp_f32 v18, v18
 MV 92,216,148
 RT 248,37,16384
 RT 250,37,16640
 MV 88,216,144
 buffer_load_dwordx4 v4, s[32:35], s70 offen offset:1088 lds
 v_rcp_f32 v19, v19
 MV 80,220,152
 RT 216,15,18432
 RT 218,15,18688
 MV 84,220,156
 ML 16,48,16
 ML 17,49,17
 MV 92,224,156
 WL 6
 RT 220,37,18432
 RT 222,37,18688
 MV 88,224,152
 ML 18,50,18
 ML 19,51,19
 MV 80,228,160
 RT 224,15,20480
 RT 226,15,20736
 MV 84,228,164
 buffer_load_dwordx4 v5, s[32:35], s70 offen offset:2176 lds
 CV 48,16,17
 CV 50,18,19
 MV 92,232,164
 RT 228,37,20480
 RT 230,37,20736
 MV 88,232,160
 EX 20,56
 MV 80,236,168
 RT 232,15,22528
 RT 234,15,22784
 MV 84,236,172
 EX 21,57
 MV 92,240,172
 WL 6
 RT 236,37,22528
 RT 238,37,22784
 MV 88,240,168
 buffer_load_dwordx4 v6, s[32:35], s70 offen offset:3264 lds
 EX 22,58
 MV 80,244,176
 RT 240,15,24576
 RT 242,15,24832
 MV 84,244,180
 EX 23,59
 MV 92,248,180
 RT 244,37,24576
 RT 246,37,24832
 MV 88,248,176
 v_add_f32 v20, 1.0, v20
 v_add_f32 v21, 1.0, v21
 MV 80,216,184
 RT 248,15,26624
 RT 250,15,26880
 MV 84,216,188
 s_add_u32 m0, s66, 0
 s_add_u32 s70, s85, 0x51000
 v_add_f32 v22, 1.0, v22
 v_add_f32 v23, 1.0, v23
 MV 92,220,188
 WL 6
 RT 216,37,26624
 RT 218,37,26880
 MV 88,220,184
 buffer_load_dwordx4 v3, s[32:35], s70 offen lds
 v_rcp_f32 v20, v20
 MV 80,224,192
 RT 220,15,28672
 RT 222,15,28928
 MV 84,224,196
 v_rcp_f32 v21, v21
 MV 92,228,196
 RT 224,37,28672
 RT 226,37,28928
 MV 88,228,192
 v_rcp_f32 v22, v22
 MV 80,232,200
 RT 228,15,30720
 RT 230,15,30976
 MV 84,232,204
 v_lshrrev_b32 v40, 16, v38
 v_and_b32 v39, 63, v38
 v_min_u32 v39, 7, v39
 v_mad_u32_u24 v39, v40, 8, v39
 v_lshlrev_b32 v39, 7, v39
 v_add_u32 v39, 0, v39
 v_min_u32 v39, 0x8f80, v39
 v_rcp_f32 v23, v23
 MV 92,236,204
 WL 6
 RT 232,37,30720
 RT 234,37,30976
 MV 88,236,200
 buffer_load_dword v47, v39, s[32:35], s47 offen
 ML 20,56,20
 ML 21,57,21
 MV 80,240,208
 RT 236,15,32768
 RT 238,15,33024
 MV 84,240,212
 ML 22,58,22
 ML 23,59,23
 MV 92,244,212
 RT 240,37,32768
 RT 242,37,33024
 MV 88,244,208
 CV 56,20,21
 CV 58,22,23
 MV 80,248,216
 RT 244,15,34816
 RT 246,15,35072
 MV 84,248,220
 EX 24,52
 MV 92,216,220
 WL 6
 RT 248,37,34816
 RT 250,37,35072
 MV 88,216,216
 v_add_u32 v45, 0x1cb00, v44
 v_xor_b32 v46, 32, v45
 EX 25,53
 MV 80,220,224
L_F_p2:
 s_waitcnt vmcnt(12)
 s_barrier
 RT 216,45,0
 RT 218,45,512
 MV 84,220,228
 s_mov_b32 s89, 0x9900
 s_mov_b32 s88, 0x13200
 EX 26,54
 MV 92,224,228
 RT 220,46,0
 RT 222,46,512
 MV 88,224,224
 s_mov_b32 s87, 0x1cb00
 EX 27,55
 MV 80,228,232
 RT 224,45,4352
 RT 226,45,4864
 MV 84,228,236
 v_mov_b32 v36, 0
 v_add_f32 v24, 1.0, v24
 v_add_f32 v25, 1.0, v25
 MV 92,232,236
 WL 6
 RT 228,46,4352
 RT 230,46,4864
 MV 88,232,232
 s_add_u32 m0, s89, s65
 s_add_u32 s70, s84, 0xa2000
 v_add_f32 v26, 1.0, v26
 v_add_f32 v27, 1.0, v27
 MV 80,236,240
 RT 232,45,8704
 RT 234,45,9216
 MV 84,236,244
 buffer_load_dwordx4 v3, s[32:35], s70 offen lds
 v_rcp_f32 v24, v24
 MV 92,240,244
 RT 236,46,8704
 RT 238,46,9216
 MV 88,240,240
 v_rcp_f32 v25, v25
 MV 80,244,248
 RT 240,45,13056
 RT 242,45,13568
 MV 84,244,252
 v_rcp_f32 v26, v26
 MV 92,248,252
 WL 6
 RT 244,46,13056
 RT 246,46,13568
 MV 88,248,248
 buffer_load_dwordx4 v4, s[32:35], s70 offen offset:1088 lds
 v_rcp_f32 v27, v27
 v_mfma_f32_16x16x32_bf16 v[112:115], a[216:219], a[0:3], 0
 RT 248,45,17408
 RT 250,45,17920
 v_mfma_f32_16x16x32_bf16 v[116:119], a[216:219], a[4:7], 0
 ML 24,52,24
 ML 25,53,25
 ML 26,54,26
 v_mfma_f32_16x16x32_bf16 v[124:127], a[220:223], a[4:7], 0
 RT 216,46,17408
 RT 218,46,17920
 v_mfma_f32_16x16x32_bf16 v[120:123], a[220:223], a[0:3], 0
 ML 27,55,27
 CV 52,24,25
 CV 54,26,27
 MA 112,224,8
 RT 220,45,21760
 RT 222,45,22272
 MA 116,224,12
 s_add_u32 s4, s87, 0x9900
 s_cmp_lt_u32 s4, 0x26400
 s_cselect_b32 s4, s4, 0
 EX 28,60
 AW 192,48
 MA 124,228,12
 WL 6
 RT 224,46,21760
 RT 226,46,22272
 MA 120,228,8
 buffer_load_dwordx4 v5, s[32:35], s70 offen offset:2176 lds
 EX 29,61
 v_add_f32 v28, 1.0, v28
 MA 112,232,16
 RT 228,45,26112
 RT 230,45,26624
 MA 116,232,20
 EX 30,62
 v_add_f32 v29, 1.0, v29
 MA 124,236,20
 RT 232,46,26112
 RT 234,46,26624
 MA 120,236,16
 EX 31,63
 v_add_f32 v30, 1.0, v30
 MA 112,240,24
 RT 236,45,30464
 RT 238,45,30976
 MA 116,240,28
 buffer_load_dwordx4 v6, s[32:35], s70 offen offset:3264 lds
 v_add_f32 v31, 1.0, v31
 v_rcp_f32 v28, v28
 MA 124,244,28
 WL 6
 RT 240,46,30464
 RT 242,46,30976
 MA 120,244,24
 v_rcp_f32 v29, v29
 ML 28,60,28
 MA 112,248,32
 RT 244,45,34816
 RT 246,45,35328
 MA 116,248,36
 v_rcp_f32 v30, v30
 ML 29,61,29
 MA 124,216,36
 RT 248,46,34816
 RT 250,46,35328
 MA 120,216,32
 s_add_u32 m0, m0, 0x1100
 s_add_u32 s70, s84, 0xab000
 v_rcp_f32 v31, v31
 ML 30,62,30
 MA 112,220,40
 RT 216,45,64
 RT 218,45,576
 MA 116,220,44
 buffer_load_dwordx4 v3, s[32:35], s70 offen lds
 ML 31,63,31
 CV 60,28,29
 CV 62,30,31
 MA 124,224,44
 WL 6
 RT 220,46,64
 RT 222,46,576
 MA 120,224,40
 AW 193,50
 AW 194,56
 AW 195,58
 MA 112,228,48
 RT 224,45,4416
 RT 226,45,4928
 MA 116,228,52
 AW 196,52
 AW 197,54
 AW 198,60
 MA 124,232,52
 RT 228,46,4416
 RT 230,46,4928
 MA 120,232,48
 buffer_load_dwordx4 v4, s[32:35], s70 offen offset:1088 lds
 AW 199,62
 EX 16,64
 MA 112,236,56
 RT 232,45,8768
 RT 234,45,9280
 MA 116,236,60
 EX 17,65
 v_add_f32 v16, 1.0, v16
 MA 124,240,60
 WL 6
 RT 236,46,8768
 RT 238,46,9280
 MA 120,240,56
 EX 18,66
 v_add_f32 v17, 1.0, v17
 MA 112,244,64
 RT 240,45,13120
 RT 242,45,13632
 MA 116,244,68
 buffer_load_dwordx4 v5, s[32:35], s70 offen offset:2176 lds
 EX 19,67
 v_add_f32 v18, 1.0, v18
 MA 124,248,68
 RT 244,46,13120
 RT 246,46,13632
 MA 120,248,64
 v_add_f32 v19, 1.0, v19
 v_rcp_f32 v16, v16
 v_mfma_f32_16x16x32_bf16 v[128:131], a[216:219], a[0:3], 0
 RT 248,45,17472
 RT 250,45,17984
 v_mfma_f32_16x16x32_bf16 v[132:135], a[216:219], a[4:7], 0
 v_rcp_f32 v17, v17
 ML 16,64,16
 v_mfma_f32_16x16x32_bf16 v[140:143], a[220:223], a[4:7], 0
 WL 6
 RT 216,46,17472
 RT 218,46,17984
 v_mfma_f32_16x16x32_bf16 v[136:139], a[220:223], a[0:3], 0
 buffer_load_dwordx4 v6, s[32:35], s70 offen offset:3264 lds
 v_rcp_f32 v18, v18
 ML 17,65,17
 MA 128,224,8
 RT 220,45,21824
 RT 222,45,22336
 MA 132,224,12
 v_rcp_f32 v19, v19
 ML 18,66,18
 MA 140,228,12
 RT 224,46,21824
 RT 226,46,22336
 MA 136,228,8
 ML 19,67,19
 CV 64,16,17
 CV 66,18,19
 MA 128,232,16
 RT 228,45,26176
 RT 230,45,26688
 MA 132,232,20
 s_add_u32 m0, s89, s66
 s_add_u32 s70, s86, 0
 EX 20,72
 MA 140,236,20
 WL 6
 RT 232,46,26176
 RT 234,46,26688
 MA 136,236,16
 buffer_load_dwordx4 v3, s[32:35], s70 offen lds
 EX 21,73
 EX 22,74
 MA 128,240,24
 RT 236,45,30528
 RT 238,45,31040
 MA 132,240,28
 EX 23,75
 v_add_f32 v20, 1.0, v20
 MA 140,244,28
 RT 240,46,30528
 RT 242,46,31040
 MA 136,244,24
 v_add_f32 v21, 1.0, v21
 v_add_f32 v22, 1.0, v22
 v_add_f32 v23, 1.0, v23
 MA 128,248,32
 RT 244,45,34880
 RT 246,45,35392
 MA 132,248,36
 v_rcp_f32 v20, v20
 MA 140,216,36
 WL 6
 RT 248,46,34880
 RT 250,46,35392
 MA 136,216,32
 v_add_u32 v45, s4, v44
 v_xor_b32 v46, 32, v45
 v_rcp_f32 v21, v21
 v_rcp_f32 v22, v22
 MA 128,220,40
 s_waitcnt vmcnt(10)
 s_barrier
 RT 216,45,0
 RT 218,45,512
 MA 132,220,44
 s_mov_b32 s89, s88
 s_mov_b32 s88, s87
 v_rcp_f32 v23, v23
 ML 20,72,20
 MA 140,224,44
 RT 220,46,0
 RT 222,46,512
 MA 136,224,40
 s_mov_b32 s87, s4
 ML 21,73,21
 ML 22,74,22
 ML 23,75,23
 MA 128,228,48
 RT 224,45,4352
 RT 226,45,4864
 MA 132,228,52
 s_add_u32 s84, s84, 0x80
 s_add_u32 s85, s85, 0x80
 s_add_u32 s86, s86, 0x80
 CV 72,20,21
 CV 74,22,23
 MA 140,232,52
 WL 6
 RT 228,46,4352
 RT 230,46,4864
 MA 136,232,48
 s_add_u32 m0, s89, s65
 s_add_u32 s70, s84, 0
 EX 24,68
 EX 25,69
 MA 128,236,56
 RT 232,45,8704
 RT 234,45,9216
 MA 132,236,60
 buffer_load_dwordx4 v3, s[32:35], s70 offen lds
 EX 26,70
 v_add_f32 v24, 1.0, v24
 MA 140,240,60
 RT 236,46,8704
 RT 238,46,9216
 MA 136,240,56
 EX 27,71
 v_add_f32 v25, 1.0, v25
 MA 128,244,64
 RT 240,45,13056
 RT 242,45,13568
 MA 132,244,68
 v_add_f32 v26, 1.0, v26
 v_add_f32 v27, 1.0, v27
 MA 140,248,68
 WL 6
 RT 244,46,13056
 RT 246,46,13568
 MA 136,248,64
 buffer_load_dwordx4 v4, s[32:35], s70 offen offset:1088 lds
 v_rcp_f32 v24, v24
 v_rcp_f32 v25, v25
 MA 112,216,72
 RT 248,45,17408
 RT 250,45,17920
 MA 116,216,76
 v_rcp_f32 v26, v26
 ML 24,68,24
 MA 124,220,76
 RT 216,46,17408
 RT 218,46,17920
 MA 120,220,72
 v_rcp_f32 v27, v27
 ML 25,69,25
 MA 112,224,80
 RT 220,45,21760
 RT 222,45,22272
 MA 116,224,84
 s_add_u32 s4, s87, 0x9900
 s_cmp_lt_u32 s4, 0x26400
 s_cselect_b32 s4, s4, 0
 ML 26,70,26
 ML 27,71,27
 CV 68,24,25
 MA 124,228,84
 WL 6
 RT 224,46,21760
 RT 226,46,22272
 MA 120,228,80
 buffer_load_dwordx4 v5, s[32:35], s70 offen offset:2176 lds
 CV 70,26,27
 EX 28,76
 MA 112,232,88
 RT 228,45,26112
 RT 230,45,26624
 MA 116,232,92
 EX 29,77
 v_add_f32 v28, 1.0, v28
 MA 124,236,92
 RT 232,46,26112
 RT 234,46,26624
 MA 120,236,88
 EX 30,78
 v_add_f32 v29, 1.0, v29
 MA 112,240,96
 RT 236,45,30464
 RT 238,45,30976
 MA 116,240,100
 buffer_load_dwordx4 v6, s[32:35], s70 offen offset:3264 lds
 EX 31,79
 v_add_f32 v30, 1.0, v30
 MA 124,244,100
 WL 6
 RT 240,46,30464
 RT 242,46,30976
 MA 120,244,96
 v_add_f32 v31, 1.0, v31
 v_rcp_f32 v28, v28
 MA 112,248,104
 RT 244,45,34816
 RT 246,45,35328
 MA 116,248,108
 v_rcp_f32 v29, v29
 ML 28,76,28
 MA 124,216,108
 RT 248,46,34816
 RT 250,46,35328
 MA 120,216,104
 s_add_u32 m0, m0, 0x1100
 s_add_u32 s70, s84, 0x9000
 v_rcp_f32 v30, v30
 ML 29,77,29
 MA 112,220,112
 RT 216,45,64
 RT 218,45,576
 MA 116,220,116
 buffer_load_dwordx4 v3, s[32:35], s70 offen lds
 v_rcp_f32 v31, v31
 ML 30,78,30
 MA 124,224,116
 WL 6
 RT 220,46,64
 RT 222,46,576
 MA 120,224,112
 ML 31,79,31
 CV 76,28,29
 CV 78,30,31
 MA 112,228,120
 RT 224,45,4416
 RT 226,45,4928
 MA 116,228,124
 AW 200,64
 AW 201,66
 AW 202,72
 MA 124,232,124
 RT 228,46,4416
 RT 230,46,4928
 MA 120,232,120
 buffer_load_dwordx4 v4, s[32:35], s70 offen offset:1088 lds
 AW 203,74
 AW 204,68
 AW 205,70
 MA 112,236,128
 RT 232,45,8768
 RT 234,45,9280
 MA 116,236,132
 AW 206,76
 AW 207,78
 MA 124,240,132
 WL 6
 RT 236,46,8768
 RT 238,46,9280
 MA 120,240,128
 EX 16,80
 EX 17,81
 MA 112,244,136
 RT 240,45,13120
 RT 242,45,13632
 MA 116,244,140
 buffer_load_dwordx4 v5, s[32:35], s70 offen offset:2176 lds
 EX 18,82
 v_add_f32 v16, 1.0, v16
 MA 124,248,140
 RT 244,46,13120
 RT 246,46,13632
 MA 120,248,136
 EX 19,83
 v_add_f32 v17, 1.0, v17
 MA 128,216,72
 RT 248,45,17472
 RT 250,45,17984
 MA 132,216,76
 v_add_f32 v18, 1.0, v18
 v_add_f32 v19, 1.0, v19
 MA 140,220,76
 WL 6
 RT 216,46,17472
 RT 218,46,17984
 MA 136,220,72
 buffer_load_dwordx4 v6, s[32:35], s70 offen offset:3264 lds
 v_rcp_f32 v16, v16
 v_rcp_f32 v17, v17
 MA 128,224,80
 RT 220,45,21824
 RT 222,45,22336
 MA 132,224,84
 v_rcp_f32 v18, v18
 ML 16,80,16
 MA 140,228,84
 RT 224,46,21824
 RT 226,46,22336
 MA 136,228,80
 v_rcp_f32 v19, v19
 ML 17,81,17
 MA 128,232,88
 RT 228,45,26176
 RT 230,45,26688
 MA 132,232,92
 s_add_u32 m0, s89, s66
 s_add_u32 s70, s85, 0
 ML 18,82,18
 ML 19,83,19
 CV 80,16,17
 MA 140,236,92
 WL 6
 RT 232,46,26176
 RT 234,46,26688
 MA 136,236,88
 buffer_load_dwordx4 v3, s[32:35], s70 offen lds
 CV 82,18,19
 EX 20,88
 MA 128,240,96
 RT 236,45,30528
 RT 238,45,31040
 MA 132,240,100
 EX 21,89
 v_add_f32 v20, 1.0, v20
 MA 140,244,100
 RT 240,46,30528
 RT 242,46,31040
 MA 136,244,96
 EX 22,90
 v_add_f32 v21, 1.0, v21
 MA 128,248,104
 RT 244,45,34880
 RT 246,45,35392
 MA 132,248,108
 EX 23,91
 v_add_f32 v22, 1.0, v22
 MA 140,216,108
 WL 6
 RT 248,46,34880
 RT 250,46,35392
 MA 136,216,104
 v_add_u32 v45, s4, v44
 v_xor_b32 v46, 32, v45
 v_add_f32 v23, 1.0, v23
 v_rcp_f32 v20, v20
 MA 128,220,112
 s_waitcnt vmcnt(9)
 s_barrier
 RT 216,45,0
 RT 218,45,512
 MA 132,220,116
 s_mov_b32 s89, s88
 s_mov_b32 s88, s87
 v_rcp_f32 v21, v21
 ML 20,88,20
 MA 140,224,116
 RT 220,46,0
 RT 222,46,512
 MA 136,224,112
 s_mov_b32 s87, s4
 v_rcp_f32 v22, v22
 ML 21,89,21
 MA 128,228,120
 RT 224,45,4352
 RT 226,45,4864
 MA 132,228,124
 s_add_u32 m0, s89, s65
 s_add_u32 s70, s84, 0x51000
 v_rcp_f32 v23, v23
 ML 22,90,22
 MA 140,232,124
 WL 6
 RT 228,46,4352
 RT 230,46,4864
 MA 136,232,120
 buffer_load_dwordx4 v3, s[32:35], s70 offen lds
 ML 23,91,23
 CV 88,20,21
 CV 90,22,23
 MA 128,236,128
 RT 232,45,8704
 RT 234,45,9216
 MA 132,236,132
 EX 24,84
 MA 140,240,132
 RT 236,46,8704
 RT 238,46,9216
 MA 136,240,128
 EX 25,85
 EX 26,86
 MA 128,244,136
 RT 240,45,13056
 RT 242,45,13568
 MA 132,244,140
 buffer_load_dwordx4 v4, s[32:35], s70 offen offset:1088 lds
 EX 27,87
 v_add_f32 v24, 1.0, v24
 MA 140,248,140
 WL 6
 RT 244,46,13056
 RT 246,46,13568
 MA 136,248,136
 v_add_f32 v25, 1.0, v25
 v_add_f32 v26, 1.0, v26
 v_add_f32 v27, 1.0, v27
 MA 112,216,144
 RT 248,45,17408
 RT 250,45,17920
 MA 116,216,148
 v_rcp_f32 v24, v24
 MA 124,220,148
 RT 216,46,17408
 RT 218,46,17920
 MA 120,220,144
 buffer_load_dwordx4 v5, s[32:35], s70 offen offset:2176 lds
 v_rcp_f32 v25, v25
 v_rcp_f32 v26, v26
 MA 112,224,152
 RT 220,45,21760
 RT 222,45,22272
 MA 116,224,156
 v_rcp_f32 v27, v27
 ML 24,84,24
 MA 124,228,156
 WL 6
 RT 224,46,21760
 RT 226,46,22272
 MA 120,228,152
 ML 25,85,25
 ML 26,86,26
 ML 27,87,27
 MA 112,232,160
 RT 228,45,26112
 RT 230,45,26624
 MA 116,232,164
 s_add_u32 s4, s87, 0x9900
 s_cmp_lt_u32 s4, 0x26400
 s_cselect_b32 s4, s4, 0
 CV 84,24,25
 CV 86,26,27
 AW 208,80
 MA 124,236,164
 RT 232,46,26112
 RT 234,46,26624
 MA 120,236,160
 buffer_load_dwordx4 v6, s[32:35], s70 offen offset:3264 lds
 EX 28,92
 AW 209,82
 MA 112,240,168
 RT 236,45,30464
 RT 238,45,30976
 MA 116,240,172
 EX 29,93
 v_add_f32 v28, 1.0, v28
 MA 124,244,172
 WL 6
 RT 240,46,30464
 RT 242,46,30976
 MA 120,244,168
 EX 30,94
 v_add_f32 v29, 1.0, v29
 MA 112,248,176
 RT 244,45,34816
 RT 246,45,35328
 MA 116,248,180
 s_add_u32 m0, m0, 0x1100
 s_add_u32 s70, s84, 0x5a000
 EX 31,95
 v_add_f32 v30, 1.0, v30
 MA 124,216,180
 RT 248,46,34816
 RT 250,46,35328
 MA 120,216,176
 buffer_load_dwordx4 v3, s[32:35], s70 offen lds
 v_add_f32 v31, 1.0, v31
 v_rcp_f32 v28, v28
 MA 112,220,184
 RT 216,45,64
 RT 218,45,576
 MA 116,220,188
 v_rcp_f32 v29, v29
 ML 28,92,28
 MA 124,224,188
 WL 6
 RT 220,46,64
 RT 222,46,576
 MA 120,224,184
 v_rcp_f32 v30, v30
 ML 29,93,29
 MA 112,228,192
 RT 224,45,4416
 RT 226,45,4928
 MA 116,228,196
 buffer_load_dwordx4 v4, s[32:35], s70 offen offset:1088 lds
 v_rcp_f32 v31, v31
 ML 30,94,30
 MA 124,232,196
 RT 228,46,4416
 RT 230,46,4928
 MA 120,232,192
 ML 31,95,31
 CV 92,28,29
 CV 94,30,31
 MA 112,236,200
 RT 232,45,8768
 RT 234,45,9280
 MA 116,236,204
 AW 210,88
 AW 211,90
 AW 212,84
 MA 124,240,204
 WL 6
 RT 236,46,8768
 RT 238,46,9280
 MA 120,240,200
 buffer_load_dwordx4 v5, s[32:35], s70 offen offset:2176 lds
 AW 213,86
 AW 214,92
 AW 215,94
 MA 112,244,208
 RT 240,45,13120
 MA 116,244,212
 RT 242,45,13632
 MA 124,248,212
 RT 244,46,13120
 MA 120,248,208
 RT 246,46,13632
 MA 128,216,144
 RT 248,45,17472
 RT 250,45,17984
 MA 132,216,148
 buffer_load_dwordx4 v6, s[32:35], s70 offen offset:3264 lds
 MA 140,220,148
 WL 6
 RT 216,46,17472
 RT 218,46,17984
 MA 136,220,144
 CV 144,112,113
 CV 145,114,115
 MA 128,224,152
 RT 220,45,21824
 RT 222,45,22336
 MA 132,224,156
 CV 146,120,121
 CV 147,122,123
 MA 140,228,156
 RT 224,46,21824
 RT 226,46,22336
 MA 136,228,152
 s_add_u32 m0, s89, s66
 s_add_u32 s70, s85, 0x51000
 MA 128,232,160
 RT 228,45,26176
 RT 230,45,26688
 MA 132,232,164
 buffer_load_dwordx4 v3, s[32:35], s70 offen lds
 MA 140,236,164
 WL 6
 RT 232,46,26176
 RT 234,46,26688
 MA 136,236,160
 buffer_store_dwordx4 v[144:147], v0, s[36:39], s90 offen sc1
 MA 128,240,168
 RT 236,45,30528
 RT 238,45,31040
 MA 132,240,172
 CV 148,116,117
 CV 149,118,119
 MA 140,244,172
 RT 240,46,30528
 RT 242,46,31040
 MA 136,244,168
 CV 150,124,125
 CV 151,126,127
 MA 128,248,176
 RT 244,45,34880
 RT 246,45,35392
 MA 132,248,180
 buffer_store_dwordx4 v[148:151], v0, s[36:39], s90 offen offset:1024 sc1
 MA 140,216,180
 WL 6
 RT 248,46,34880
 RT 250,46,35392
 MA 136,216,176
 v_add_u32 v45, s4, v44
 v_xor_b32 v46, 32, v45
 MA 128,220,184
 s_waitcnt vmcnt(11)
 s_barrier
 RT 216,45,0
 RT 218,45,512
 MA 132,220,188
 s_mov_b32 s89, s88
 s_mov_b32 s88, s87
 MA 140,224,188
 RT 220,46,0
 RT 222,46,512
 MA 136,224,184
 s_mov_b32 s87, s4
 MA 128,228,192
 RT 224,45,4352
 RT 226,45,4864
 MA 132,228,196
 s_add_u32 m0, s89, s65
 s_add_u32 s70, s84, 0xa2000
 MA 140,232,196
 WL 6
 RT 228,46,4352
 RT 230,46,4864
 MA 136,232,192
 buffer_load_dwordx4 v3, s[32:35], s70 offen lds
 MA 128,236,200
 RT 232,45,8704
 MA 132,236,204
 RT 234,45,9216
 MA 140,240,204
 RT 236,46,8704
 MA 136,240,200
 RT 238,46,9216
 MA 128,244,208
 RT 240,45,13056
 RT 242,45,13568
 MA 132,244,212
 buffer_load_dwordx4 v4, s[32:35], s70 offen offset:1088 lds
 MA 140,248,212
 WL 6
 RT 244,46,13056
 MA 136,248,208
 RT 246,46,13568
 v_mfma_f32_16x16x32_bf16 v[112:115], a[216:219], a[0:3], 0
 RT 248,45,17408
 RT 250,45,17920
 v_mfma_f32_16x16x32_bf16 v[116:119], a[216:219], a[4:7], 0
 CV 152,128,129
 CV 153,130,131
 v_mfma_f32_16x16x32_bf16 v[124:127], a[220:223], a[4:7], 0
 RT 216,46,17408
 RT 218,46,17920
 v_mfma_f32_16x16x32_bf16 v[120:123], a[220:223], a[0:3], 0
 buffer_load_dwordx4 v5, s[32:35], s70 offen offset:2176 lds
 MA 112,224,8
 RT 220,45,21760
 RT 222,45,22272
 MA 116,224,12
 CV 154,136,137
 CV 155,138,139
 MA 124,228,12
 WL 6
 RT 224,46,21760
 RT 226,46,22272
 MA 120,228,8
 buffer_store_dwordx4 v[152:155], v0, s[36:39], s90 offen offset:2048 sc1
 MA 112,232,16
 RT 228,45,26112
 RT 230,45,26624
 MA 116,232,20
 s_add_u32 s4, s87, 0x9900
 s_cmp_lt_u32 s4, 0x26400
 s_cselect_b32 s4, s4, 0
 MA 124,236,20
 RT 232,46,26112
 RT 234,46,26624
 MA 120,236,16
 buffer_load_dwordx4 v6, s[32:35], s70 offen offset:3264 lds
 MA 112,240,24
 RT 236,45,30464
 RT 238,45,30976
 MA 116,240,28
 CV 156,132,133
 CV 157,134,135
 MA 124,244,28
 WL 6
 RT 240,46,30464
 RT 242,46,30976
 MA 120,244,24
 CV 158,140,141
 CV 159,142,143
 MA 112,248,32
 RT 244,45,34816
 RT 246,45,35328
 MA 116,248,36
 s_add_u32 m0, m0, 0x1100
 s_add_u32 s70, s84, 0xab000
 MA 124,216,36
 RT 248,46,34816
 RT 250,46,35328
 MA 120,216,32
 buffer_load_dwordx4 v3, s[32:35], s70 offen lds
 MA 112,220,40
 RT 216,45,64
 RT 218,45,576
 MA 116,220,44
 buffer_store_dwordx4 v[156:159], v0, s[36:39], s90 offen offset:3072 sc1
 MA 124,224,44
 WL 6
 RT 220,46,64
 RT 222,46,576
 MA 120,224,40
 s_add_u32 s90, s90, 0x1000
 MA 112,228,48
 RT 224,45,4416
 RT 226,45,4928
 MA 116,228,52
 buffer_load_dwordx4 v4, s[32:35], s70 offen offset:1088 lds
 MA 124,232,52
 RT 228,46,4416
 MA 120,232,48
 RT 230,46,4928
 MA 112,236,56
 RT 232,45,8768
 MA 116,236,60
 RT 234,45,9280
 MA 124,240,60
 WL 6
 RT 236,46,8768
 RT 238,46,9280
 MA 120,240,56
 buffer_load_dwordx4 v5, s[32:35], s70 offen offset:2176 lds
 MA 112,244,64
 RT 240,45,13120
 MA 116,244,68
 RT 242,45,13632
 MA 124,248,68
 RT 244,46,13120
 MA 120,248,64
 RT 246,46,13632
 v_mfma_f32_16x16x32_bf16 v[128:131], a[216:219], a[0:3], 0
 RT 248,45,17472
 RT 250,45,17984
 v_mfma_f32_16x16x32_bf16 v[132:135], a[216:219], a[4:7], 0
 buffer_load_dwordx4 v6, s[32:35], s70 offen offset:3264 lds
 v_mfma_f32_16x16x32_bf16 v[140:143], a[220:223], a[4:7], 0
 WL 6
 RT 216,46,17472
 v_mfma_f32_16x16x32_bf16 v[136:139], a[220:223], a[0:3], 0
 RT 218,46,17984
 MA 128,224,8
 RT 220,45,21824
 MA 132,224,12
 RT 222,45,22336
 MA 140,228,12
 RT 224,46,21824
 RT 226,46,22336
 MA 136,228,8
 s_add_u32 m0, s89, s66
 s_add_u32 s70, s86, 0
 MA 128,232,16
 RT 228,45,26176
 RT 230,45,26688
 MA 132,232,20
 buffer_load_dwordx4 v3, s[32:35], s70 offen lds
 MA 140,236,20
 WL 6
 RT 232,46,26176
 MA 136,236,16
 RT 234,46,26688
 MA 128,240,24
 RT 236,45,30528
 MA 132,240,28
 RT 238,45,31040
 MA 140,244,28
 RT 240,46,30528
 RT 242,46,31040
 MA 136,244,24
 s_lshl_b32 s82, s64, 14
 s_add_u32 s82, s82, 0x2f00000
 s_cmp_eq_u32 s62, 0
 s_cselect_b32 s93, 0, 0x10000000
 v_lshrrev_b32 v21, 2, v0
 v_add_u32 v21, s93, v21
 v_mov_b32 v26, 0x10000000
 s_add_u32 s92, s93, 0x44
 v_writelane_b32 v26, s92, 0
 v_mov_b32 v29, v26
 v_min_u32 v30, 0x110, v0
 v_lshrrev_b32 v30, 2, v30
 v_add_u32 v30, s93, v30
 s_add_u32 s92, s93, 0xfc
 v_writelane_b32 v26, s92, 1
 s_lshl_b32 s92, s64, 4
 s_add_u32 s92, s92, s93
 v_mov_b32 v22, 0x100
 v_writelane_b32 v22, s92, 0
 s_lshl_b32 s76, s63, 7
 s_add_u32 s76, s76, 0x100
 s_add_u32 s76, s76, s82
 s_lshl_b32 s77, s63, 8
 s_add_u32 s77, s77, 0x1000
 s_add_u32 s77, s77, s82
 v_mov_b32 v17, 0
 MA 128,248,32
 RT 244,45,34880
 RT 246,45,35392
 MA 132,248,36
 buffer_atomic_add v17, v22, s[52:55], 0 offen sc0 sc1
 MA 140,216,36
 WL 6
 RT 248,46,34880
 RT 250,46,35392
 MA 136,216,32
 v_add_u32 v45, s4, v44
 v_xor_b32 v46, 32, v45
 MA 128,220,40
 s_waitcnt vmcnt(14)
 s_barrier
 RT 216,45,0
 RT 218,45,512
 MA 132,220,44
 s_mov_b32 s89, s88
 s_mov_b32 s88, s87
 MA 140,224,44
 RT 220,46,0
 RT 222,46,512
 MA 136,224,40
 s_mov_b32 s87, s4
 MA 128,228,48
 RT 224,45,4352
 RT 226,45,4864
 MA 132,228,52
 s_add_u32 s84, s84, 0x80
 s_add_u32 s85, s85, 0x80
 s_add_u32 s86, s86, 0x80
 MA 140,232,52
 WL 6
 RT 228,46,4352
 RT 230,46,4864
 MA 136,232,48
 s_add_u32 m0, s89, s65
 s_add_u32 s70, s84, 0
 MA 128,236,56
 RT 232,45,8704
 RT 234,45,9216
 MA 132,236,60
 buffer_load_dwordx4 v3, s[32:35], s70 offen lds
 MA 140,240,60
 RT 236,46,8704
 MA 136,240,56
 RT 238,46,9216
 MA 128,244,64
 RT 240,45,13056
 MA 132,244,68
 RT 242,45,13568
 MA 140,248,68
 WL 6
 RT 244,46,13056
 RT 246,46,13568
 MA 136,248,64
 buffer_load_dwordx4 v4, s[32:35], s70 offen offset:1088 lds
 MA 112,216,72
 RT 248,45,17408
 MA 116,216,76
 RT 250,45,17920
 MA 124,220,76
 RT 216,46,17408
 MA 120,220,72
 RT 218,46,17920
 MA 112,224,80
 RT 220,45,21760
 RT 222,45,22272
 MA 116,224,84
 s_add_u32 s4, s87, 0x9900
 s_cmp_lt_u32 s4, 0x26400
 s_cselect_b32 s4, s4, 0
 MA 124,228,84
 WL 6
 RT 224,46,21760
 RT 226,46,22272
 MA 120,228,80
 buffer_load_dwordx4 v5, s[32:35], s70 offen offset:2176 lds
 MA 112,232,88
 RT 228,45,26112
 MA 116,232,92
 RT 230,45,26624
 MA 124,236,92
 RT 232,46,26112
 MA 120,236,88
 RT 234,46,26624
 MA 112,240,96
 RT 236,45,30464
 RT 238,45,30976
 MA 116,240,100
 buffer_load_dwordx4 v6, s[32:35], s70 offen offset:3264 lds
 MA 124,244,100
 WL 6
 RT 240,46,30464
 MA 120,244,96
 RT 242,46,30976
 MA 112,248,104
 RT 244,45,34816
 MA 116,248,108
 RT 246,45,35328
 MA 124,216,108
 RT 248,46,34816
 RT 250,46,35328
 MA 120,216,104
 s_add_u32 m0, m0, 0x1100
 s_add_u32 s70, s84, 0x9000
 MA 112,220,112
 RT 216,45,64
 RT 218,45,576
 MA 116,220,116
 buffer_load_dwordx4 v3, s[32:35], s70 offen lds
 MA 124,224,116
 WL 6
 RT 220,46,64
 MA 120,224,112
 RT 222,46,576
 MA 112,228,120
 RT 224,45,4416
 MA 116,228,124
 RT 226,45,4928
 MA 124,232,124
 RT 228,46,4416
 RT 230,46,4928
 MA 120,232,120
 buffer_load_dwordx4 v4, s[32:35], s70 offen offset:1088 lds
 MA 112,236,128
 RT 232,45,8768
 MA 116,236,132
 RT 234,45,9280
 MA 124,240,132
 WL 6
 RT 236,46,8768
 MA 120,240,128
 RT 238,46,9280
 MA 112,244,136
 RT 240,45,13120
 RT 242,45,13632
 MA 116,244,140
 buffer_load_dwordx4 v5, s[32:35], s70 offen offset:2176 lds
 MA 124,248,140
 RT 244,46,13120
 MA 120,248,136
 RT 246,46,13632
 MA 128,216,72
 RT 248,45,17472
 MA 132,216,76
 RT 250,45,17984
 MA 140,220,76
 WL 6
 RT 216,46,17472
 RT 218,46,17984
 MA 136,220,72
 buffer_load_dwordx4 v6, s[32:35], s70 offen offset:3264 lds
 MA 128,224,80
 RT 220,45,21824
 MA 132,224,84
 RT 222,45,22336
 MA 140,228,84
 RT 224,46,21824
 MA 136,228,80
 RT 226,46,22336
 MA 128,232,88
 RT 228,45,26176
 RT 230,45,26688
 MA 132,232,92
 s_add_u32 m0, s89, s66
 s_add_u32 s70, s85, 0
 MA 140,236,92
 WL 6
 RT 232,46,26176
 RT 234,46,26688
 MA 136,236,88
 buffer_load_dwordx4 v3, s[32:35], s70 offen lds
 MA 128,240,96
 RT 236,45,30528
 MA 132,240,100
 RT 238,45,31040
 MA 140,244,100
 RT 240,46,30528
 MA 136,244,96
 RT 242,46,31040
 MA 128,248,104
 RT 244,45,34880
 MA 132,248,108
 RT 246,45,35392
 MA 140,216,108
 WL 6
 RT 248,46,34880
 RT 250,46,35392
 MA 136,216,104
 v_add_u32 v45, s4, v44
 v_xor_b32 v46, 32, v45
 MA 128,220,112
 s_waitcnt vmcnt(10)
 s_barrier
 RT 216,45,0
 RT 218,45,512
 MA 132,220,116
 s_mov_b32 s89, s88
 s_mov_b32 s88, s87
 MA 140,224,116
 RT 220,46,0
 RT 222,46,512
 MA 136,224,112
 s_mov_b32 s87, s4
 MA 128,228,120
 RT 224,45,4352
 RT 226,45,4864
 MA 132,228,124
 v_add_u32 v36, 1, v36
 MA 140,232,124
 WL 6
 RT 228,46,4352
 RT 230,46,4864
 MA 136,232,120
 buffer_store_dword v36, v42, s[36:39], 0 offen sc1
 MA 128,236,128
 RT 232,45,8704
 RT 234,45,9216
 MA 132,236,132
 s_add_u32 m0, s89, s65
 s_add_u32 s70, s84, 0x51000
 MA 140,240,132
 RT 236,46,8704
 RT 238,46,9216
 MA 136,240,128
 buffer_load_dwordx4 v3, s[32:35], s70 offen lds
 MA 128,244,136
 RT 240,45,13056
 MA 132,244,140
 RT 242,45,13568
 MA 140,248,140
 WL 6
 RT 244,46,13056
 MA 136,248,136
 RT 246,46,13568
 MA 112,216,144
 RT 248,45,17408
 RT 250,45,17920
 MA 116,216,148
 buffer_load_dwordx4 v4, s[32:35], s70 offen offset:1088 lds
 MA 124,220,148
 RT 216,46,17408
 MA 120,220,144
 RT 218,46,17920
 MA 112,224,152
 RT 220,45,21760
 MA 116,224,156
 RT 222,45,22272
 MA 124,228,156
 WL 6
 RT 224,46,21760
 RT 226,46,22272
 MA 120,228,152
 s_add_u32 s4, s87, 0x9900
 s_cmp_lt_u32 s4, 0x26400
 s_cselect_b32 s4, s4, 0
 MA 112,232,160
 RT 228,45,26112
 RT 230,45,26624
 MA 116,232,164
 buffer_load_dwordx4 v5, s[32:35], s70 offen offset:2176 lds
 MA 124,236,164
 RT 232,46,26112
 MA 120,236,160
 RT 234,46,26624
 MA 112,240,168
 RT 236,45,30464
 MA 116,240,172
 RT 238,45,30976
 MA 124,244,172
 WL 6
 RT 240,46,30464
 RT 242,46,30976
 MA 120,244,168
 buffer_load_dwordx4 v6, s[32:35], s70 offen offset:3264 lds
 MA 112,248,176
 RT 244,45,34816
 MA 116,248,180
 RT 246,45,35328
 MA 124,216,180
 RT 248,46,34816
 MA 120,216,176
 RT 250,46,35328
 MA 112,220,184
 RT 216,45,64
 RT 218,45,576
 MA 116,220,188
 s_add_u32 m0, m0, 0x1100
 s_add_u32 s70, s84, 0x5a000
 MA 124,224,188
 WL 6
 RT 220,46,64
 RT 222,46,576
 MA 120,224,184
 buffer_load_dwordx4 v3, s[32:35], s70 offen lds
 MA 112,228,192
 RT 224,45,4416
 MA 116,228,196
 RT 226,45,4928
 MA 124,232,196
 RT 228,46,4416
 MA 120,232,192
 RT 230,46,4928
 MA 112,236,200
 RT 232,45,8768
 RT 234,45,9280
 MA 116,236,204
 buffer_load_dwordx4 v4, s[32:35], s70 offen offset:1088 lds
 MA 124,240,204
 WL 6
 RT 236,46,8768
 MA 120,240,200
 RT 238,46,9280
 MA 112,244,208
 RT 240,45,13120
 MA 116,244,212
 RT 242,45,13632
 MA 124,248,212
 RT 244,46,13120
 RT 246,46,13632
 MA 120,248,208
 buffer_load_dwordx4 v5, s[32:35], s70 offen offset:2176 lds
 MA 128,216,144
 RT 248,45,17472
 RT 250,45,17984
 MA 132,216,148
 CV 144,112,113
 CV 145,114,115
 MA 140,220,148
 WL 6
 RT 216,46,17472
 RT 218,46,17984
 MA 136,220,144
 CV 146,120,121
 CV 147,122,123
 MA 128,224,152
 RT 220,45,21824
 RT 222,45,22336
 MA 132,224,156
 buffer_load_dwordx4 v6, s[32:35], s70 offen offset:3264 lds
 MA 140,228,156
 RT 224,46,21824
 RT 226,46,22336
 MA 136,228,152
 buffer_store_dwordx4 v[144:147], v0, s[36:39], s90 offen sc1
 MA 128,232,160
 RT 228,45,26176
 RT 230,45,26688
 MA 132,232,164
 CV 148,116,117
 CV 149,118,119
 MA 140,236,164
 WL 6
 RT 232,46,26176
 RT 234,46,26688
 MA 136,236,160
 s_add_u32 m0, s89, s66
 s_add_u32 s70, s85, 0x51000
 MA 128,240,168
 RT 236,45,30528
 RT 238,45,31040
 MA 132,240,172
 buffer_load_dwordx4 v3, s[32:35], s70 offen lds
 MA 140,244,172
 RT 240,46,30528
 RT 242,46,31040
 MA 136,244,168
 CV 150,124,125
 CV 151,126,127
 MA 128,248,176
 RT 244,45,34880
 RT 246,45,35392
 MA 132,248,180
 buffer_store_dwordx4 v[148:151], v0, s[36:39], s90 offen offset:1024 sc1
 MA 140,216,180
 WL 6
 RT 248,46,34880
 RT 250,46,35392
 MA 136,216,176
 v_add_u32 v45, s4, v44
 v_xor_b32 v46, 32, v45
 MA 128,220,184
 s_mov_b32 s91, 6
.p2align 3
L_F_loop0:
 s_waitcnt vmcnt(12)
 s_barrier
 RT 216,45,0
 RT 218,45,512
 MA 132,220,188
 s_mov_b32 s89, s88
 s_mov_b32 s88, s87
 MA 140,224,188
 RT 220,46,0
 RT 222,46,512
 MA 136,224,184
 s_mov_b32 s87, s4
 MA 128,228,192
 RT 224,45,4352
 RT 226,45,4864
 MA 132,228,196
 s_add_u32 m0, s89, s65
 s_add_u32 s70, s84, 0xa2000
 MA 140,232,196
 WL 6
 RT 228,46,4352
 RT 230,46,4864
 MA 136,232,192
 buffer_load_dwordx4 v3, s[32:35], s70 offen lds
 MA 128,236,200
 RT 232,45,8704
 MA 132,236,204
 RT 234,45,9216
 MA 140,240,204
 RT 236,46,8704
 MA 136,240,200
 RT 238,46,9216
 MA 128,244,208
 RT 240,45,13056
 RT 242,45,13568
 MA 132,244,212
 buffer_load_dwordx4 v4, s[32:35], s70 offen offset:1088 lds
 MA 140,248,212
 WL 6
 RT 244,46,13056
 MA 136,248,208
 RT 246,46,13568
 v_mfma_f32_16x16x32_bf16 v[112:115], a[216:219], a[0:3], 0
 RT 248,45,17408
 RT 250,45,17920
 v_mfma_f32_16x16x32_bf16 v[116:119], a[216:219], a[4:7], 0
 CV 152,128,129
 CV 153,130,131
 v_mfma_f32_16x16x32_bf16 v[124:127], a[220:223], a[4:7], 0
 RT 216,46,17408
 RT 218,46,17920
 v_mfma_f32_16x16x32_bf16 v[120:123], a[220:223], a[0:3], 0
 buffer_load_dwordx4 v5, s[32:35], s70 offen offset:2176 lds
 MA 112,224,8
 RT 220,45,21760
 RT 222,45,22272
 MA 116,224,12
 CV 154,136,137
 CV 155,138,139
 MA 124,228,12
 WL 6
 RT 224,46,21760
 RT 226,46,22272
 MA 120,228,8
 buffer_store_dwordx4 v[152:155], v0, s[36:39], s90 offen offset:2048 sc1
 MA 112,232,16
 RT 228,45,26112
 RT 230,45,26624
 MA 116,232,20
 s_add_u32 s4, s87, 0x9900
 s_cmp_lt_u32 s4, 0x26400
 s_cselect_b32 s4, s4, 0
 MA 124,236,20
 RT 232,46,26112
 RT 234,46,26624
 MA 120,236,16
 buffer_load_dwordx4 v6, s[32:35], s70 offen offset:3264 lds
 MA 112,240,24
 RT 236,45,30464
 RT 238,45,30976
 MA 116,240,28
 CV 156,132,133
 CV 157,134,135
 MA 124,244,28
 WL 6
 RT 240,46,30464
 RT 242,46,30976
 MA 120,244,24
 CV 158,140,141
 CV 159,142,143
 MA 112,248,32
 RT 244,45,34816
 RT 246,45,35328
 MA 116,248,36
 s_add_u32 m0, m0, 0x1100
 s_add_u32 s70, s84, 0xab000
 MA 124,216,36
 RT 248,46,34816
 RT 250,46,35328
 MA 120,216,32
 buffer_load_dwordx4 v3, s[32:35], s70 offen lds
 MA 112,220,40
 RT 216,45,64
 RT 218,45,576
 MA 116,220,44
 buffer_store_dwordx4 v[156:159], v0, s[36:39], s90 offen offset:3072 sc1
 MA 124,224,44
 WL 6
 RT 220,46,64
 RT 222,46,576
 MA 120,224,40
 s_add_u32 s90, s90, 0x1000
 MA 112,228,48
 RT 224,45,4416
 RT 226,45,4928
 MA 116,228,52
 buffer_load_dwordx4 v4, s[32:35], s70 offen offset:1088 lds
 MA 124,232,52
 RT 228,46,4416
 MA 120,232,48
 RT 230,46,4928
 MA 112,236,56
 RT 232,45,8768
 MA 116,236,60
 RT 234,45,9280
 MA 124,240,60
 WL 6
 RT 236,46,8768
 RT 238,46,9280
 MA 120,240,56
 buffer_load_dwordx4 v5, s[32:35], s70 offen offset:2176 lds
 MA 112,244,64
 RT 240,45,13120
 MA 116,244,68
 RT 242,45,13632
 MA 124,248,68
 RT 244,46,13120
 MA 120,248,64
 RT 246,46,13632
 v_mfma_f32_16x16x32_bf16 v[128:131], a[216:219], a[0:3], 0
 RT 248,45,17472
 RT 250,45,17984
 v_mfma_f32_16x16x32_bf16 v[132:135], a[216:219], a[4:7], 0
 buffer_load_dwordx4 v6, s[32:35], s70 offen offset:3264 lds
 v_mfma_f32_16x16x32_bf16 v[140:143], a[220:223], a[4:7], 0
 WL 6
 RT 216,46,17472
 v_mfma_f32_16x16x32_bf16 v[136:139], a[220:223], a[0:3], 0
 RT 218,46,17984
 MA 128,224,8
 RT 220,45,21824
 MA 132,224,12
 RT 222,45,22336
 MA 140,228,12
 RT 224,46,21824
 RT 226,46,22336
 MA 136,228,8
 s_add_u32 m0, s89, s66
 s_add_u32 s70, s86, 0
 MA 128,232,16
 RT 228,45,26176
 RT 230,45,26688
 MA 132,232,20
 buffer_load_dwordx4 v3, s[32:35], s70 offen lds
 MA 140,236,20
 WL 6
 RT 232,46,26176
 MA 136,236,16
 RT 234,46,26688
 MA 128,240,24
 RT 236,45,30528
 MA 132,240,28
 RT 238,45,31040
 MA 140,244,28
 RT 240,46,30528
 MA 136,244,24
 RT 242,46,31040
 MA 128,248,32
 RT 244,45,34880
 MA 132,248,36
 RT 246,45,35392
 MA 140,216,36
 WL 6
 RT 248,46,34880
 RT 250,46,35392
 MA 136,216,32
 v_add_u32 v45, s4, v44
 v_xor_b32 v46, 32, v45
 MA 128,220,40
 s_waitcnt vmcnt(12)
 s_barrier
 RT 216,45,0
 RT 218,45,512
 MA 132,220,44
 s_mov_b32 s89, s88
 s_mov_b32 s88, s87
 MA 140,224,44
 RT 220,46,0
 RT 222,46,512
 MA 136,224,40
 s_mov_b32 s87, s4
 MA 128,228,48
 RT 224,45,4352
 RT 226,45,4864
 MA 132,228,52
 s_add_u32 s84, s84, 0x80
 s_add_u32 s85, s85, 0x80
 s_add_u32 s86, s86, 0x80
 MA 140,232,52
 WL 6
 RT 228,46,4352
 RT 230,46,4864
 MA 136,232,48
 s_add_u32 m0, s89, s65
 s_add_u32 s70, s84, 0
 MA 128,236,56
 RT 232,45,8704
 RT 234,45,9216
 MA 132,236,60
 buffer_load_dwordx4 v3, s[32:35], s70 offen lds
 MA 140,240,60
 RT 236,46,8704
 MA 136,240,56
 RT 238,46,9216
 MA 128,244,64
 RT 240,45,13056
 MA 132,244,68
 RT 242,45,13568
 MA 140,248,68
 WL 6
 RT 244,46,13056
 RT 246,46,13568
 MA 136,248,64
 buffer_load_dwordx4 v4, s[32:35], s70 offen offset:1088 lds
 MA 112,216,72
 RT 248,45,17408
 MA 116,216,76
 RT 250,45,17920
 MA 124,220,76
 RT 216,46,17408
 MA 120,220,72
 RT 218,46,17920
 MA 112,224,80
 RT 220,45,21760
 RT 222,45,22272
 MA 116,224,84
 s_add_u32 s4, s87, 0x9900
 s_cmp_lt_u32 s4, 0x26400
 s_cselect_b32 s4, s4, 0
 MA 124,228,84
 WL 6
 RT 224,46,21760
 RT 226,46,22272
 MA 120,228,80
 buffer_load_dwordx4 v5, s[32:35], s70 offen offset:2176 lds
 MA 112,232,88
 RT 228,45,26112
 MA 116,232,92
 RT 230,45,26624
 MA 124,236,92
 RT 232,46,26112
 MA 120,236,88
 RT 234,46,26624
 MA 112,240,96
 RT 236,45,30464
 RT 238,45,30976
 MA 116,240,100
 buffer_load_dwordx4 v6, s[32:35], s70 offen offset:3264 lds
 MA 124,244,100
 WL 6
 RT 240,46,30464
 MA 120,244,96
 RT 242,46,30976
 MA 112,248,104
 RT 244,45,34816
 MA 116,248,108
 RT 246,45,35328
 MA 124,216,108
 RT 248,46,34816
 RT 250,46,35328
 MA 120,216,104
 s_add_u32 m0, m0, 0x1100
 s_add_u32 s70, s84, 0x9000
 MA 112,220,112
 RT 216,45,64
 RT 218,45,576
 MA 116,220,116
 buffer_load_dwordx4 v3, s[32:35], s70 offen lds
 MA 124,224,116
 WL 6
 RT 220,46,64
 MA 120,224,112
 RT 222,46,576
 MA 112,228,120
 RT 224,45,4416
 MA 116,228,124
 RT 226,45,4928
 MA 124,232,124
 RT 228,46,4416
 RT 230,46,4928
 MA 120,232,120
 buffer_load_dwordx4 v4, s[32:35], s70 offen offset:1088 lds
 MA 112,236,128
 RT 232,45,8768
 MA 116,236,132
 RT 234,45,9280
 MA 124,240,132
 WL 6
 RT 236,46,8768
 MA 120,240,128
 RT 238,46,9280
 MA 112,244,136
 RT 240,45,13120
 RT 242,45,13632
 MA 116,244,140
 buffer_load_dwordx4 v5, s[32:35], s70 offen offset:2176 lds
 MA 124,248,140
 RT 244,46,13120
 MA 120,248,136
 RT 246,46,13632
 MA 128,216,72
 RT 248,45,17472
 MA 132,216,76
 RT 250,45,17984
 MA 140,220,76
 WL 6
 RT 216,46,17472
 RT 218,46,17984
 MA 136,220,72
 buffer_load_dwordx4 v6, s[32:35], s70 offen offset:3264 lds
 MA 128,224,80
 RT 220,45,21824
 MA 132,224,84
 RT 222,45,22336
 MA 140,228,84
 RT 224,46,21824
 MA 136,228,80
 RT 226,46,22336
 MA 128,232,88
 RT 228,45,26176
 RT 230,45,26688
 MA 132,232,92
 s_add_u32 m0, s89, s66
 s_add_u32 s70, s85, 0
 MA 140,236,92
 WL 6
 RT 232,46,26176
 RT 234,46,26688
 MA 136,236,88
 buffer_load_dwordx4 v3, s[32:35], s70 offen lds
 MA 128,240,96
 RT 236,45,30528
 MA 132,240,100
 RT 238,45,31040
 MA 140,244,100
 RT 240,46,30528
 MA 136,244,96
 RT 242,46,31040
 MA 128,248,104
 RT 244,45,34880
 MA 132,248,108
 RT 246,45,35392
 MA 140,216,108
 WL 6
 RT 248,46,34880
 RT 250,46,35392
 MA 136,216,104
 v_add_u32 v45, s4, v44
 v_xor_b32 v46, 32, v45
 MA 128,220,112
 s_waitcnt vmcnt(9)
 s_barrier
 RT 216,45,0
 RT 218,45,512
 MA 132,220,116
 s_mov_b32 s89, s88
 s_mov_b32 s88, s87
 MA 140,224,116
 RT 220,46,0
 RT 222,46,512
 MA 136,224,112
 s_mov_b32 s87, s4
 MA 128,228,120
 RT 224,45,4352
 RT 226,45,4864
 MA 132,228,124
 v_add_u32 v36, 1, v36
 MA 140,232,124
 WL 6
 RT 228,46,4352
 RT 230,46,4864
 MA 136,232,120
 buffer_store_dword v36, v42, s[36:39], 0 offen sc1
 MA 128,236,128
 RT 232,45,8704
 RT 234,45,9216
 MA 132,236,132
 s_add_u32 m0, s89, s65
 s_add_u32 s70, s84, 0x51000
 MA 140,240,132
 RT 236,46,8704
 RT 238,46,9216
 MA 136,240,128
 buffer_load_dwordx4 v3, s[32:35], s70 offen lds
 MA 128,244,136
 RT 240,45,13056
 MA 132,244,140
 RT 242,45,13568
 MA 140,248,140
 WL 6
 RT 244,46,13056
 MA 136,248,136
 RT 246,46,13568
 MA 112,216,144
 RT 248,45,17408
 RT 250,45,17920
 MA 116,216,148
 buffer_load_dwordx4 v4, s[32:35], s70 offen offset:1088 lds
 MA 124,220,148
 RT 216,46,17408
 MA 120,220,144
 RT 218,46,17920
 MA 112,224,152
 RT 220,45,21760
 MA 116,224,156
 RT 222,45,22272
 MA 124,228,156
 WL 6
 RT 224,46,21760
 RT 226,46,22272
 MA 120,228,152
 s_add_u32 s4, s87, 0x9900
 s_cmp_lt_u32 s4, 0x26400
 s_cselect_b32 s4, s4, 0
 MA 112,232,160
 RT 228,45,26112
 RT 230,45,26624
 MA 116,232,164
 buffer_load_dwordx4 v5, s[32:35], s70 offen offset:2176 lds
 MA 124,236,164
 RT 232,46,26112
 MA 120,236,160
 RT 234,46,26624
 MA 112,240,168
 RT 236,45,30464
 MA 116,240,172
 RT 238,45,30976
 MA 124,244,172
 WL 6
 RT 240,46,30464
 RT 242,46,30976
 MA 120,244,168
 buffer_load_dwordx4 v6, s[32:35], s70 offen offset:3264 lds
 MA 112,248,176
 RT 244,45,34816
 MA 116,248,180
 RT 246,45,35328
 MA 124,216,180
 RT 248,46,34816
 MA 120,216,176
 RT 250,46,35328
 MA 112,220,184
 RT 216,45,64
 RT 218,45,576
 MA 116,220,188
 s_add_u32 m0, m0, 0x1100
 s_add_u32 s70, s84, 0x5a000
 MA 124,224,188
 WL 6
 RT 220,46,64
 RT 222,46,576
 MA 120,224,184
 buffer_load_dwordx4 v3, s[32:35], s70 offen lds
 MA 112,228,192
 RT 224,45,4416
 MA 116,228,196
 RT 226,45,4928
 MA 124,232,196
 RT 228,46,4416
 MA 120,232,192
 RT 230,46,4928
 MA 112,236,200
 RT 232,45,8768
 RT 234,45,9280
 MA 116,236,204
 buffer_load_dwordx4 v4, s[32:35], s70 offen offset:1088 lds
 MA 124,240,204
 WL 6
 RT 236,46,8768
 MA 120,240,200
 RT 238,46,9280
 MA 112,244,208
 RT 240,45,13120
 MA 116,244,212
 RT 242,45,13632
 MA 124,248,212
 RT 244,46,13120
 RT 246,46,13632
 MA 120,248,208
 buffer_load_dwordx4 v5, s[32:35], s70 offen offset:2176 lds
 MA 128,216,144
 RT 248,45,17472
 RT 250,45,17984
 MA 132,216,148
 CV 144,112,113
 CV 145,114,115
 MA 140,220,148
 WL 6
 RT 216,46,17472
 RT 218,46,17984
 MA 136,220,144
 CV 146,120,121
 CV 147,122,123
 MA 128,224,152
 RT 220,45,21824
 RT 222,45,22336
 MA 132,224,156
 buffer_load_dwordx4 v6, s[32:35], s70 offen offset:3264 lds
 MA 140,228,156
 RT 224,46,21824
 RT 226,46,22336
 MA 136,228,152
 buffer_store_dwordx4 v[144:147], v0, s[36:39], s90 offen sc1
 MA 128,232,160
 RT 228,45,26176
 RT 230,45,26688
 MA 132,232,164
 CV 148,116,117
 CV 149,118,119
 MA 140,236,164
 WL 6
 RT 232,46,26176
 RT 234,46,26688
 MA 136,236,160
 s_add_u32 m0, s89, s66
 s_add_u32 s70, s85, 0x51000
 MA 128,240,168
 RT 236,45,30528
 RT 238,45,31040
 MA 132,240,172
 buffer_load_dwordx4 v3, s[32:35], s70 offen lds
 MA 140,244,172
 RT 240,46,30528
 RT 242,46,31040
 MA 136,244,168
 CV 150,124,125
 CV 151,126,127
 MA 128,248,176
 RT 244,45,34880
 RT 246,45,35392
 MA 132,248,180
 buffer_store_dwordx4 v[148:151], v0, s[36:39], s90 offen offset:1024 sc1
 MA 140,216,180
 WL 6
 RT 248,46,34880
 RT 250,46,35392
 MA 136,216,176
 v_add_u32 v45, s4, v44
 v_xor_b32 v46, 32, v45
 MA 128,220,184
 s_sub_u32 s91, s91, 1
 s_cmp_lg_u32 s91, 0
 s_cbranch_scc1 L_F_loop0
 s_waitcnt vmcnt(12)
 s_barrier
 RT 216,45,0
 RT 218,45,512
 MA 132,220,188
 s_mov_b32 s89, s88
 s_mov_b32 s88, s87
 MA 140,224,188
 RT 220,46,0
 RT 222,46,512
 MA 136,224,184
 s_mov_b32 s87, s4
 MA 128,228,192
 RT 224,45,4352
 RT 226,45,4864
 MA 132,228,196
 s_add_u32 m0, s89, s65
 s_add_u32 s70, s84, 0xa2000
 MA 140,232,196
 WL 6
 RT 228,46,4352
 RT 230,46,4864
 MA 136,232,192
 buffer_load_dwordx4 v3, s[32:35], s70 offen lds
 MA 128,236,200
 RT 232,45,8704
 MA 132,236,204
 RT 234,45,9216
 MA 140,240,204
 RT 236,46,8704
 MA 136,240,200
 RT 238,46,9216
 MA 128,244,208
 RT 240,45,13056
 RT 242,45,13568
 MA 132,244,212
 buffer_load_dwordx4 v4, s[32:35], s70 offen offset:1088 lds
 MA 140,248,212
 WL 6
 RT 244,46,13056
 MA 136,248,208
 RT 246,46,13568
 v_mfma_f32_16x16x32_bf16 v[112:115], a[216:219], a[0:3], 0
 RT 248,45,17408
 RT 250,45,17920
 v_mfma_f32_16x16x32_bf16 v[116:119], a[216:219], a[4:7], 0
 CV 152,128,129
 CV 153,130,131
 v_mfma_f32_16x16x32_bf16 v[124:127], a[220:223], a[4:7], 0
 RT 216,46,17408
 RT 218,46,17920
 v_mfma_f32_16x16x32_bf16 v[120:123], a[220:223], a[0:3], 0
 buffer_load_dwordx4 v5, s[32:35], s70 offen offset:2176 lds
 MA 112,224,8
 RT 220,45,21760
 RT 222,45,22272
 MA 116,224,12
 CV 154,136,137
 CV 155,138,139
 MA 124,228,12
 WL 6
 RT 224,46,21760
 RT 226,46,22272
 MA 120,228,8
 buffer_store_dwordx4 v[152:155], v0, s[36:39], s90 offen offset:2048 sc1
 MA 112,232,16
 RT 228,45,26112
 RT 230,45,26624
 MA 116,232,20
 s_add_u32 s4, s87, 0x9900
 s_cmp_lt_u32 s4, 0x26400
 s_cselect_b32 s4, s4, 0
 MA 124,236,20
 RT 232,46,26112
 RT 234,46,26624
 MA 120,236,16
 buffer_load_dwordx4 v6, s[32:35], s70 offen offset:3264 lds
 MA 112,240,24
 RT 236,45,30464
 RT 238,45,30976
 MA 116,240,28
 CV 156,132,133
 CV 157,134,135
 MA 124,244,28
 WL 6
 RT 240,46,30464
 RT 242,46,30976
 MA 120,244,24
 CV 158,140,141
 CV 159,142,143
 MA 112,248,32
 RT 244,45,34816
 RT 246,45,35328
 MA 116,248,36
 s_add_u32 m0, m0, 0x1100
 s_add_u32 s70, s84, 0xab000
 MA 124,216,36
 RT 248,46,34816
 RT 250,46,35328
 MA 120,216,32
 buffer_load_dwordx4 v3, s[32:35], s70 offen lds
 MA 112,220,40
 RT 216,45,64
 RT 218,45,576
 MA 116,220,44
 buffer_store_dwordx4 v[156:159], v0, s[36:39], s90 offen offset:3072 sc1
 MA 124,224,44
 WL 6
 RT 220,46,64
 RT 222,46,576
 MA 120,224,40
 s_add_u32 s90, s90, 0x1000
 MA 112,228,48
 RT 224,45,4416
 RT 226,45,4928
 MA 116,228,52
 buffer_load_dwordx4 v4, s[32:35], s70 offen offset:1088 lds
 MA 124,232,52
 RT 228,46,4416
 MA 120,232,48
 RT 230,46,4928
 MA 112,236,56
 RT 232,45,8768
 MA 116,236,60
 RT 234,45,9280
 MA 124,240,60
 WL 6
 RT 236,46,8768
 RT 238,46,9280
 MA 120,240,56
 buffer_load_dwordx4 v5, s[32:35], s70 offen offset:2176 lds
 MA 112,244,64
 RT 240,45,13120
 MA 116,244,68
 RT 242,45,13632
 MA 124,248,68
 RT 244,46,13120
 MA 120,248,64
 RT 246,46,13632
 v_mfma_f32_16x16x32_bf16 v[128:131], a[216:219], a[0:3], 0
 RT 248,45,17472
 RT 250,45,17984
 v_mfma_f32_16x16x32_bf16 v[132:135], a[216:219], a[4:7], 0
 buffer_load_dwordx4 v6, s[32:35], s70 offen offset:3264 lds
 v_mfma_f32_16x16x32_bf16 v[140:143], a[220:223], a[4:7], 0
 WL 6
 RT 216,46,17472
 v_mfma_f32_16x16x32_bf16 v[136:139], a[220:223], a[0:3], 0
 RT 218,46,17984
 MA 128,224,8
 RT 220,45,21824
 MA 132,224,12
 RT 222,45,22336
 MA 140,228,12
 RT 224,46,21824
 RT 226,46,22336
 MA 136,228,8
 s_add_u32 m0, s89, s66
 s_add_u32 s70, s86, 0
 MA 128,232,16
 RT 228,45,26176
 RT 230,45,26688
 MA 132,232,20
 buffer_load_dwordx4 v3, s[32:35], s70 offen lds
 MA 140,236,20
 WL 6
 RT 232,46,26176
 MA 136,236,16
 RT 234,46,26688
 MA 128,240,24
 RT 236,45,30528
 MA 132,240,28
 RT 238,45,31040
 MA 140,244,28
 RT 240,46,30528
 MA 136,244,24
 RT 242,46,31040
 MA 128,248,32
 RT 244,45,34880
 MA 132,248,36
 RT 246,45,35392
 MA 140,216,36
 WL 6
 RT 248,46,34880
 RT 250,46,35392
 MA 136,216,32
 v_add_u32 v45, s4, v44
 v_xor_b32 v46, 32, v45
 MA 128,220,40
 s_waitcnt vmcnt(12)
 s_barrier
 RT 216,45,0
 RT 218,45,512
 MA 132,220,44
 s_mov_b32 s89, s88
 s_mov_b32 s88, s87
 MA 140,224,44
 RT 220,46,0
 RT 222,46,512
 MA 136,224,40
 s_mov_b32 s87, s4
 MA 128,228,48
 RT 224,45,4352
 RT 226,45,4864
 MA 132,228,52
 s_getpc_b64 s[94:95]
L_cp1:
 s_add_u32 s94, s94, L_F_red-L_cp1
 s_addc_u32 s95, s95, 0
 v_bfe_u32 v40, v38, 16, 5
 v_and_b32 v39, 63, v38
 v_min_u32 v39, 3, v39
 v_mad_u32_u24 v39, v40, 4, v39
 v_lshlrev_b32 v39, 7, v39
 v_min_u32 v39, L_roleF_end-L_F_red-4, v39
 MA 140,232,52
 WL 6
 RT 228,46,4352
 RT 230,46,4864
 MA 136,232,48
 global_load_dword v47, v39, s[94:95]
 MA 128,236,56
 RT 232,45,8704
 MA 132,236,60
 RT 234,45,9216
 MA 140,240,60
 RT 236,46,8704
 MA 136,240,56
 RT 238,46,9216
 MA 128,244,64
 RT 240,45,13056
 RT 242,45,13568
 MA 132,244,68
 s_add_u32 s4, s87, 0x9900
 s_cmp_lt_u32 s4, 0x26400
 s_cselect_b32 s4, s4, 0
 MA 140,248,68
 WL 6
 RT 244,46,13056
 MA 136,248,64
 RT 246,46,13568
 MA 112,216,72
 RT 248,45,17408
 MA 116,216,76
 RT 250,45,17920
 MA 124,220,76
 RT 216,46,17408
 MA 120,220,72
 RT 218,46,17920
 MA 112,224,80
 RT 220,45,21760
 MA 116,224,84
 RT 222,45,22272
 MA 124,228,84
 WL 6
 RT 224,46,21760
 MA 120,228,80
 RT 226,46,22272
 MA 112,232,88
 RT 228,45,26112
 MA 116,232,92
 RT 230,45,26624
 MA 124,236,92
 RT 232,46,26112
 MA 120,236,88
 RT 234,46,26624
 MA 112,240,96
 RT 236,45,30464
 MA 116,240,100
 RT 238,45,30976
 MA 124,244,100
 WL 6
 RT 240,46,30464
 MA 120,244,96
 RT 242,46,30976
 MA 112,248,104
 RT 244,45,34816
 MA 116,248,108
 RT 246,45,35328
 MA 124,216,108
 RT 248,46,34816
 MA 120,216,104
 RT 250,46,35328
 MA 112,220,112
 RT 216,45,64
 MA 116,220,116
 RT 218,45,576
 MA 124,224,116
 WL 6
 RT 220,46,64
 MA 120,224,112
 RT 222,46,576
 MA 112,228,120
 RT 224,45,4416
 MA 116,228,124
 RT 226,45,4928
 MA 124,232,124
 RT 228,46,4416
 MA 120,232,120
 RT 230,46,4928
 MA 112,236,128
 RT 232,45,8768
 MA 116,236,132
 RT 234,45,9280
 MA 124,240,132
 WL 6
 RT 236,46,8768
 MA 120,240,128
 RT 238,46,9280
 MA 112,244,136
 RT 240,45,13120
 MA 116,244,140
 RT 242,45,13632
 MA 124,248,140
 RT 244,46,13120
 MA 120,248,136
 RT 246,46,13632
 MA 128,216,72
 RT 248,45,17472
 MA 132,216,76
 RT 250,45,17984
 MA 140,220,76
 WL 6
 RT 216,46,17472
 MA 136,220,72
 RT 218,46,17984
 MA 128,224,80
 RT 220,45,21824
 MA 132,224,84
 RT 222,45,22336
 MA 140,228,84
 RT 224,46,21824
 MA 136,228,80
 RT 226,46,22336
 MA 128,232,88
 RT 228,45,26176
 MA 132,232,92
 RT 230,45,26688
 MA 140,236,92
 WL 6
 RT 232,46,26176
 MA 136,236,88
 RT 234,46,26688
 MA 128,240,96
 RT 236,45,30528
 MA 132,240,100
 RT 238,45,31040
 MA 140,244,100
 RT 240,46,30528
 MA 136,244,96
 RT 242,46,31040
 MA 128,248,104
 RT 244,45,34880
 MA 132,248,108
 RT 246,45,35392
 MA 140,216,108
 WL 6
 RT 248,46,34880
 RT 250,46,35392
 MA 136,216,104
 v_add_u32 v45, s4, v44
 v_xor_b32 v46, 32, v45
 MA 128,220,112
 s_waitcnt vmcnt(1)
 s_barrier
 RT 216,45,0
 RT 218,45,512
 MA 132,220,116
 s_mov_b32 s89, s88
 s_mov_b32 s88, s87
 MA 140,224,116
 RT 220,46,0
 RT 222,46,512
 MA 136,224,112
 s_mov_b32 s87, s4
 MA 128,228,120
 RT 224,45,4352
 RT 226,45,4864
 MA 132,228,124
 v_add_u32 v36, 1, v36
 MA 140,232,124
 WL 6
 RT 228,46,4352
 RT 230,46,4864
 MA 136,232,120
 buffer_store_dword v36, v42, s[36:39], 0 offen sc1
 MA 128,236,128
 RT 232,45,8704
 RT 234,45,9216
 MA 132,236,132
 buffer_load_dword v16, v30, s[36:39], s76 offen sc1
 MA 140,240,132
 RT 236,46,8704
 MA 136,240,128
 RT 238,46,9216
 MA 128,244,136
 RT 240,45,13056
 MA 132,244,140
 RT 242,45,13568
 MA 140,248,140
 WL 6
 RT 244,46,13056
 MA 136,248,136
 RT 246,46,13568
 MA 112,216,144
 RT 248,45,17408
 MA 116,216,148
 RT 250,45,17920
 MA 124,220,148
 RT 216,46,17408
 MA 120,220,144
 RT 218,46,17920
 MA 112,224,152
 RT 220,45,21760
 MA 116,224,156
 RT 222,45,22272
 MA 124,228,156
 WL 6
 RT 224,46,21760
 MA 120,228,152
 RT 226,46,22272
 MA 112,232,160
 RT 228,45,26112
 MA 116,232,164
 RT 230,45,26624
 MA 124,236,164
 RT 232,46,26112
 MA 120,236,160
 RT 234,46,26624
 MA 112,240,168
 RT 236,45,30464
 MA 116,240,172
 RT 238,45,30976
 MA 124,244,172
 WL 6
 RT 240,46,30464
 MA 120,244,168
 RT 242,46,30976
 MA 112,248,176
 RT 244,45,34816
 MA 116,248,180
 RT 246,45,35328
 MA 124,216,180
 RT 248,46,34816
 MA 120,216,176
 RT 250,46,35328
 MA 112,220,184
 RT 216,45,64
 MA 116,220,188
 RT 218,45,576
 MA 124,224,188
 WL 6
 RT 220,46,64
 MA 120,224,184
 RT 222,46,576
 MA 112,228,192
 RT 224,45,4416
 MA 116,228,196
 RT 226,45,4928
 MA 124,232,196
 RT 228,46,4416
 MA 120,232,192
 RT 230,46,4928
 MA 112,236,200
 RT 232,45,8768
 MA 116,236,204
 RT 234,45,9280
 MA 124,240,204
 WL 6
 RT 236,46,8768
 MA 120,240,200
 RT 238,46,9280
 MA 112,244,208
 RT 240,45,13120
 MA 116,244,212
 RT 242,45,13632
 MA 124,248,212
 RT 244,46,13120
 MA 120,248,208
 RT 246,46,13632
 MA 128,216,144
 RT 248,45,17472
 RT 250,45,17984
 MA 132,216,148
 CV 144,112,113
 CV 145,114,115
 MA 140,220,148
 WL 6
 RT 216,46,17472
 RT 218,46,17984
 MA 136,220,144
 CV 146,120,121
 CV 147,122,123
 MA 128,224,152
 RT 220,45,21824
 RT 222,45,22336
 MA 132,224,156
 buffer_store_dwordx4 v[144:147], v0, s[36:39], s90 offen sc1
 MA 140,228,156
 RT 224,46,21824
 RT 226,46,22336
 MA 136,228,152
 CV 148,116,117
 CV 149,118,119
 MA 128,232,160
 RT 228,45,26176
 RT 230,45,26688
 MA 132,232,164
 CV 150,124,125
 CV 151,126,127
 MA 140,236,164
 WL 6
 RT 232,46,26176
 RT 234,46,26688
 MA 136,236,160
 buffer_store_dwordx4 v[148:151], v0, s[36:39], s90 offen offset:1024 sc1
 MA 128,240,168
 RT 236,45,30528
 MA 132,240,172
 RT 238,45,31040
 MA 140,244,172
 RT 240,46,30528
 MA 136,244,168
 RT 242,46,31040
 MA 128,248,176
 RT 244,45,34880
 MA 132,248,180
 RT 246,45,35392
 MA 140,216,180
 WL 6
 RT 248,46,34880
 MA 136,216,176
 RT 250,46,35392
 MA 128,220,184
 MA 132,220,188
 s_nop 0
 MA 140,224,188
 MA 136,224,184
 s_nop 0
 MA 128,228,192
 MA 132,228,196
 s_nop 0
 MA 140,232,196
 WL 0
 MA 136,232,192
 s_nop 0
 MA 128,236,200
 MA 132,236,204
 s_nop 0
 MA 140,240,204
 MA 136,240,200
 s_nop 0
 MA 128,244,208
 MA 132,244,212
 s_nop 0
 MA 140,248,212
 MA 136,248,208
 s_nop 0
 s_nop 2
 CV 152,128,129
 CV 153,130,131
 s_nop 1
 CV 154,136,137
 CV 155,138,139
 buffer_store_dwordx4 v[152:155], v0, s[36:39], s90 offen offset:2048 sc1
 CV 156,132,133
 CV 157,134,135
 CV 158,140,141
 CV 159,142,143
 buffer_store_dwordx4 v[156:159], v0, s[36:39], s90 offen offset:3072 sc1
 s_add_u32 s90, s90, 0x1000
 s_mov_b32 s78, 0
 s_mov_b32 s79, 0
 s_mov_b32 s40, 0
 s_mov_b32 s58, 0
 s_mov_b32 s41, 0x26404
 s_nop 1
 s_cmp_eq_u32 s62, 0
 s_cbranch_scc0 L_F_e2
 s_waitcnt vmcnt(4)
 v_readfirstlane_b32 s40, v17
 s_nop 1
 s_cmp_ge_u32 s40, 16
 s_cbranch_scc0 L_F_e1
 v_cmp_ne_u32 vcc, 0, v16
 s_nop 1
 s_lshr_b64 s[72:73], vcc, 18
 s_and_b32 s73, s73, 15
 s_mov_b32 s78, 0
 s_mov_b32 s79, 0
 v_cmp_ge_u32 vcc, 0, v16
 s_nop 1
 s_and_b32 s92, vcc_lo, 0x7ff
 s_cselect_b32 s78, s78, 4
 s_and_b32 s92, vcc_lo, 0x1f800
 s_cselect_b32 s79, s79, 4
 v_cmp_ge_u32 vcc, 1, v16
 s_nop 1
 s_and_b32 s92, vcc_lo, 0x7ff
 s_cselect_b32 s78, s78, 8
 s_and_b32 s92, vcc_lo, 0x1f800
 s_cselect_b32 s79, s79, 8
 v_cmp_ge_u32 vcc, 2, v16
 s_nop 1
 s_and_b32 s92, vcc_lo, 0x7ff
 s_cselect_b32 s78, s78, 12
 s_and_b32 s92, vcc_lo, 0x1f800
 s_cselect_b32 s79, s79, 12
 v_cmp_ge_u32 vcc, 3, v16
 s_nop 1
 s_and_b32 s92, vcc_lo, 0x7ff
 s_cselect_b32 s78, s78, 16
 s_and_b32 s92, vcc_lo, 0x1f800
 s_cselect_b32 s79, s79, 16
 v_cmp_ge_u32 vcc, 4, v16
 s_nop 1
 s_and_b32 s92, vcc_lo, 0x7ff
 s_cselect_b32 s78, s78, 20
 s_and_b32 s92, vcc_lo, 0x1f800
 s_cselect_b32 s79, s79, 20
 v_cmp_ge_u32 vcc, 5, v16
 s_nop 1
 s_and_b32 s92, vcc_lo, 0x7ff
 s_cselect_b32 s78, s78, 24
 s_and_b32 s92, vcc_lo, 0x1f800
 s_cselect_b32 s79, s79, 24
 v_cmp_ge_u32 vcc, 6, v16
 s_nop 1
 s_and_b32 s92, vcc_lo, 0x7ff
 s_cselect_b32 s78, s78, 28
 s_and_b32 s92, vcc_lo, 0x1f800
 s_cselect_b32 s79, s79, 28
 v_cmp_ge_u32 vcc, 7, v16
 s_nop 1
 s_and_b32 s92, vcc_lo, 0x7ff
 s_cselect_b32 s78, s78, 32
 s_and_b32 s92, vcc_lo, 0x1f800
 s_cselect_b32 s79, s79, 32
 v_cmp_ge_u32 vcc, 8, v16
 s_nop 1
 s_and_b32 s92, vcc_lo, 0x7ff
 s_cselect_b32 s78, s78, 36
 s_and_b32 s92, vcc_lo, 0x1f800
 s_cselect_b32 s79, s79, 36
L_F_e1:
 s_lshl_b32 s92, s79, 8
 s_or_b32 s92, s92, s78
 s_lshl_b32 s93, s58, 16
 s_or_b32 s92, s92, s93
 v_mov_b32 v24, s92
 v_mov_b32 v23, 0x26400
 ds_write_b32 v23, v24
 WL 0
L_F_e2:
 s_waitcnt vmcnt(0)
 s_barrier
 v_mov_b32 v36, 9
 buffer_store_dword v36, v42, s[36:39], 0 offen sc1
 s_call_b64 s[56:57], L_F_red
 s_endpgm
.p2align 6
L_F_sub0:
 RT 248,9,8704
 RT 250,9,9216
 v_mfma_f32_16x16x32_bf16 v[52:55], a[216:219], v[116:119], 0
 buffer_load_dwordx4 v5, s[28:31], s70 offen offset:2176 lds
 EX 16,80
 EX 17,81
 v_mfma_f32_16x16x32_bf16 v[60:63], a[220:223], v[116:119], 0
 RT 216,10,8704
 RT 218,10,9216
 v_mfma_f32_16x16x32_bf16 v[56:59], a[220:223], v[112:115], 0
 EX 18,82
 EX 19,83
 v_mfma_f32_16x16x32_bf16 v[64:67], a[224:227], v[112:115], 0
 RT 220,9,8768
 RT 222,9,9280
 v_mfma_f32_16x16x32_bf16 v[68:71], a[224:227], v[116:119], 0
 v_add_f32 v16, 1.0, v16
 v_add_f32 v17, 1.0, v17
 v_add_f32 v18, 1.0, v18
 v_add_f32 v19, 1.0, v19
 v_mfma_f32_16x16x32_bf16 v[76:79], a[228:231], v[116:119], 0
 WL 6
 RT 224,10,8768
 RT 226,10,9280
 v_mfma_f32_16x16x32_bf16 v[72:75], a[228:231], v[112:115], 0
 buffer_load_dwordx4 v6, s[28:31], s70 offen offset:3264 lds
 v_rcp_f32 v16, v16
 v_rcp_f32 v17, v17
 MV 48,232,120
 RT 228,9,13056
 RT 230,9,13568
 MV 52,232,124
 v_rcp_f32 v18, v18
 v_rcp_f32 v19, v19
 MV 60,236,124
 RT 232,10,13056
 RT 234,10,13568
 MV 56,236,120
 ML 16,80,16
 ML 17,81,17
 ML 18,82,18
 ML 19,83,19
 MV 64,240,120
 RT 236,9,13120
 RT 238,9,13632
 MV 68,240,124
 s_add_u32 m0, m0, 0x1100
 s_add_u32 s70, s73, 0x48000
 CV 80,16,17
 CV 82,18,19
 EX 20,88
 MV 76,244,124
 WL 6
 RT 240,10,13120
 RT 242,10,13632
 MV 72,244,120
 buffer_load_dwordx4 v3, s[28:31], s70 offen lds
 EX 21,89
 EX 22,90
 MV 48,248,128
 RT 244,9,17408
 RT 246,9,17920
 MV 52,248,132
 EX 23,91
 v_add_f32 v20, 1.0, v20
 v_add_f32 v21, 1.0, v21
 MV 60,216,132
 RT 248,10,17408
 RT 250,10,17920
 MV 56,216,128
 v_add_f32 v22, 1.0, v22
 v_add_f32 v23, 1.0, v23
 v_rcp_f32 v20, v20
 MV 64,220,128
 RT 216,9,17472
 RT 218,9,17984
 MV 68,220,132
 buffer_load_dwordx4 v4, s[28:31], s70 offen offset:1088 lds
 v_rcp_f32 v21, v21
 v_rcp_f32 v22, v22
 MV 76,224,132
 WL 6
 RT 220,10,17472
 RT 222,10,17984
 MV 72,224,128
 v_rcp_f32 v23, v23
 ML 20,88,20
 ML 21,89,21
 MV 48,228,136
 RT 224,9,21760
 RT 226,9,22272
 MV 52,228,140
 ML 22,90,22
 ML 23,91,23
 CV 88,20,21
 CV 90,22,23
 MV 60,232,140
 RT 228,10,21760
 RT 230,10,22272
 MV 56,232,136
 buffer_load_dwordx4 v5, s[28:31], s70 offen offset:2176 lds
 EX 24,84
 EX 25,85
 MV 64,236,136
 RT 232,9,21824
 RT 234,9,22336
 MV 68,236,140
 EX 26,86
 EX 27,87
 MV 76,240,140
 WL 6
 RT 236,10,21824
 RT 238,10,22336
 MV 72,240,136
 v_add_f32 v24, 1.0, v24
 v_add_f32 v25, 1.0, v25
 v_add_f32 v26, 1.0, v26
 v_add_f32 v27, 1.0, v27
 MV 48,244,144
 RT 240,9,26112
 RT 242,9,26624
 MV 52,244,148
 buffer_load_dwordx4 v6, s[28:31], s70 offen offset:3264 lds
 v_rcp_f32 v24, v24
 MV 60,248,148
 RT 244,10,26112
 RT 246,10,26624
 MV 56,248,144
 v_rcp_f32 v25, v25
 v_rcp_f32 v26, v26
 MV 64,216,144
 RT 248,9,26176
 RT 250,9,26688
 MV 68,216,148
 v_rcp_f32 v27, v27
 ML 24,84,24
 MV 76,220,148
 WL 6
 RT 216,10,26176
 RT 218,10,26688
 MV 72,220,144
 s_add_u32 m0, s66, 0x13200
 s_add_u32 s70, s74, 0
 ML 25,85,25
 ML 26,86,26
 ML 27,87,27
 MV 48,224,152
 RT 220,9,30464
 RT 222,9,30976
 MV 52,224,156
 buffer_load_dwordx4 v3, s[28:31], s70 offen lds
 CV 84,24,25
 CV 86,26,27
 MV 60,228,156
 RT 224,10,30464
 RT 226,10,30976
 MV 56,228,152
 EX 28,92
 EX 29,93
 MV 64,232,152
 RT 228,9,30528
 RT 230,9,31040
 MV 68,232,156
 EX 30,94
 v_add_f32 v28, 1.0, v28
 MV 76,236,156
 WL 6
 RT 232,10,30528
 RT 234,10,31040
 MV 72,236,152
 s_add_u32 s3, s3, 0x80
 EX 31,95
 v_add_f32 v29, 1.0, v29
 MV 48,240,160
 RT 236,9,34816
 RT 238,9,35328
 MV 52,240,164
 buffer_load_dword v47, v8, s[28:31], s3 offen
 v_add_f32 v30, 1.0, v30
 v_add_f32 v31, 1.0, v31
 MV 60,244,164
 RT 240,10,34816
 RT 242,10,35328
 MV 56,244,160
 v_rcp_f32 v28, v28
 v_rcp_f32 v29, v29
 MV 64,248,160
 RT 244,9,34880
 RT 246,9,35392
 MV 68,248,164
 v_rcp_f32 v30, v30
 ML 28,92,28
 MV 76,216,164
 WL 6
 RT 248,10,34880
 RT 250,10,35392
 MV 72,216,160
 v_rcp_f32 v31, v31
 ML 29,93,29
 MV 48,220,168
 s_waitcnt vmcnt(11)
 s_barrier
 RT 216,9,39168
 RT 218,9,39680
 MV 52,220,172
 s_add_u32 m0, s65, 0x1cb00
 s_add_u32 s70, s73, 0x288000
 ML 30,94,30
 ML 31,95,31
 CV 92,28,29
 MV 60,224,172
 RT 220,10,39168
 RT 222,10,39680
 MV 56,224,168
 buffer_load_dwordx4 v3, s[28:31], s70 offen lds
 CV 94,30,31
 EX 16,96
 MV 64,228,168
 RT 224,9,43520
 RT 226,9,44032
 MV 68,228,172
 EX 17,97
 v_add_f32 v16, 1.0, v16
 MV 76,232,172
 WL 6
 RT 228,10,43520
 RT 230,10,44032
 MV 72,232,168
 EX 18,98
 v_add_f32 v17, 1.0, v17
 MV 48,236,176
 RT 232,9,47872
 RT 234,9,48384
 MV 52,236,180
 buffer_load_dwordx4 v4, s[28:31], s70 offen offset:1088 lds
 EX 19,99
 v_add_f32 v18, 1.0, v18
 MV 60,240,180
 RT 236,10,47872
 RT 238,10,48384
 MV 56,240,176
 v_add_f32 v19, 1.0, v19
 v_rcp_f32 v16, v16
 MV 64,244,176
 RT 240,9,52224
 RT 242,9,52736
 MV 68,244,180
 v_rcp_f32 v17, v17
 ML 16,96,16
 MV 76,248,180
 WL 6
 RT 244,10,52224
 RT 246,10,52736
 MV 72,248,176
 buffer_load_dwordx4 v5, s[28:31], s70 offen offset:2176 lds
 v_rcp_f32 v18, v18
 ML 17,97,17
 MV 48,216,184
 RT 248,9,56576
 RT 250,9,57088
 MV 52,216,188
 v_rcp_f32 v19, v19
 ML 18,98,18
 MV 60,220,188
 RT 216,10,56576
 RT 218,10,57088
 MV 56,220,184
 ML 19,99,19
 CV 96,16,17
 CV 98,18,19
 MV 48,224,192
 RT 220,9,60928
 RT 222,9,61440
 MV 52,224,196
 buffer_load_dwordx4 v6, s[28:31], s70 offen offset:3264 lds
 EX 20,104
 MV 60,228,196
 WL 6
 RT 224,10,60928
 RT 226,10,61440
 MV 56,228,192
 EX 21,105
 EX 22,106
 MV 48,232,200
 RT 228,9,65280
 RT 230,11,256
 MV 52,232,204
 EX 23,107
 v_add_f32 v20, 1.0, v20
 MV 60,236,204
 RT 232,10,65280
 RT 234,12,256
 MV 56,236,200
 s_add_u32 m0, m0, 0x1100
 s_add_u32 s70, s73, 0x2d0000
 v_add_f32 v21, 1.0, v21
 v_add_f32 v22, 1.0, v22
 v_add_f32 v23, 1.0, v23
 MV 48,240,208
 RT 236,11,4096
 RT 238,11,4608
 MV 52,240,212
 buffer_load_dwordx4 v3, s[28:31], s70 offen lds
 v_rcp_f32 v20, v20
 MV 60,244,212
 WL 6
 RT 240,12,4096
 RT 242,12,4608
 MV 56,244,208
 v_rcp_f32 v21, v21
 v_rcp_f32 v22, v22
 MV 48,248,216
 RT 244,11,8448
 RT 246,11,8960
 MV 52,248,220
 v_rcp_f32 v23, v23
 ML 20,104,20
 MV 60,216,220
 RT 248,12,8448
 RT 250,12,8960
 MV 56,216,216
 buffer_load_dwordx4 v4, s[28:31], s70 offen offset:1088 lds
 ML 21,105,21
 ML 22,106,22
 ML 23,107,23
 MV 48,220,224
 RT 216,9,39232
 RT 218,9,39744
 MV 52,220,228
 CV 104,20,21
 CV 106,22,23
 MV 60,224,228
 WL 6
 RT 220,10,39232
 RT 222,10,39744
 MV 56,224,224
 EX 24,100
 EX 25,101
 MV 48,228,232
 RT 224,9,43584
 RT 226,9,44096
 MV 52,228,236
 buffer_load_dwordx4 v5, s[28:31], s70 offen offset:2176 lds
 EX 26,102
 v_add_f32 v24, 1.0, v24
 MV 60,232,236
 RT 228,10,43584
 RT 230,10,44096
 MV 56,232,232
 EX 27,103
 v_add_f32 v25, 1.0, v25
 MV 48,236,240
 RT 232,9,47936
 RT 234,9,48448
 MV 52,236,244
 v_add_f32 v26, 1.0, v26
 v_add_f32 v27, 1.0, v27
 MV 60,240,244
 WL 6
 RT 236,10,47936
 RT 238,10,48448
 MV 56,240,240
 buffer_load_dwordx4 v6, s[28:31], s70 offen offset:3264 lds
 v_rcp_f32 v24, v24
 v_rcp_f32 v25, v25
 MV 48,244,248
 RT 240,9,52288
 RT 242,9,52800
 MV 52,244,252
 v_rcp_f32 v26, v26
 ML 24,100,24
 MV 60,248,252
 RT 244,10,52288
 RT 246,10,52800
 MV 56,248,248
 v_rcp_f32 v27, v27
 ML 25,101,25
 MV 64,216,184
 RT 248,9,56640
 RT 250,9,57152
 MV 68,216,188
 s_add_u32 m0, s66, 0x1cb00
 s_add_u32 s70, s74, 0x288000
 ML 26,102,26
 ML 27,103,27
 CV 100,24,25
 MV 76,220,188
 WL 6
 RT 216,10,56640
 RT 218,10,57152
 MV 72,220,184
 buffer_load_dwordx4 v3, s[28:31], s70 offen lds
 CV 102,26,27
 EX 28,108
 MV 64,224,192
 RT 220,9,60992
 RT 222,9,61504
 MV 68,224,196
 EX 29,109
 v_add_f32 v28, 1.0, v28
 MV 76,228,196
 RT 224,10,60992
 RT 226,10,61504
 MV 72,228,192
 EX 30,110
 v_add_f32 v29, 1.0, v29
 MV 64,232,200
 RT 228,9,65344
 RT 230,11,320
 MV 68,232,204
 v_min_u32 v39, 0xe9f80, v36
 v_add_u32 v36, 0x14000, v36
 EX 31,111
 v_add_f32 v30, 1.0, v30
 MV 76,236,204
 WL 6
 RT 232,10,65344
 RT 234,12,320
 MV 72,236,200
 buffer_load_dword v47, v39, s[32:35], s46 offen
 v_add_f32 v31, 1.0, v31
 v_rcp_f32 v28, v28
 MV 64,240,208
 RT 236,11,4160
 RT 238,11,4672
 MV 68,240,212
 v_rcp_f32 v29, v29
 ML 28,108,28
 MV 76,244,212
 RT 240,12,4160
 RT 242,12,4672
 MV 72,244,208
 v_rcp_f32 v30, v30
 ML 29,109,29
 MV 64,248,216
 RT 244,11,8512
 RT 246,11,9024
 MV 68,248,220
 v_rcp_f32 v31, v31
 ML 30,110,30
 MV 76,216,220
 WL 6
 RT 248,12,8512
 RT 250,12,9024
 MV 72,216,216
 ML 31,111,31
 CV 108,28,29
 CV 110,30,31
 MV 64,220,224
 s_setpc_b64 s[56:57]
.p2align 6
L_F_sub1:
 RT 248,11,21504
 RT 250,11,22016
 v_mfma_f32_16x16x32_bf16 v[84:87], a[216:219], v[116:119], 0
 buffer_load_dwordx4 v5, s[28:31], s70 offen offset:2176 lds
 EX 16,48
 EX 17,49
 v_mfma_f32_16x16x32_bf16 v[92:95], a[220:223], v[116:119], 0
 RT 216,12,21504
 RT 218,12,22016
 v_mfma_f32_16x16x32_bf16 v[88:91], a[220:223], v[112:115], 0
 EX 18,50
 EX 19,51
 v_mfma_f32_16x16x32_bf16 v[96:99], a[224:227], v[112:115], 0
 RT 220,11,21568
 RT 222,11,22080
 v_mfma_f32_16x16x32_bf16 v[100:103], a[224:227], v[116:119], 0
 v_add_f32 v16, 1.0, v16
 v_add_f32 v17, 1.0, v17
 v_add_f32 v18, 1.0, v18
 v_add_f32 v19, 1.0, v19
 v_mfma_f32_16x16x32_bf16 v[108:111], a[228:231], v[116:119], 0
 WL 6
 RT 224,12,21568
 RT 226,12,22080
 v_mfma_f32_16x16x32_bf16 v[104:107], a[228:231], v[112:115], 0
 buffer_load_dwordx4 v6, s[28:31], s70 offen offset:3264 lds
 v_rcp_f32 v16, v16
 v_rcp_f32 v17, v17
 MV 80,232,120
 RT 228,11,25856
 RT 230,11,26368
 MV 84,232,124
 v_rcp_f32 v18, v18
 v_rcp_f32 v19, v19
 MV 92,236,124
 RT 232,12,25856
 RT 234,12,26368
 MV 88,236,120
 ML 16,48,16
 ML 17,49,17
 ML 18,50,18
 ML 19,51,19
 MV 96,240,120
 RT 236,11,25920
 RT 238,11,26432
 MV 100,240,124
 s_add_u32 m0, m0, 0x1100
 s_add_u32 s70, s73, 0x48000
 CV 48,16,17
 CV 50,18,19
 EX 20,56
 MV 108,244,124
 WL 6
 RT 240,12,25920
 RT 242,12,26432
 MV 104,244,120
 buffer_load_dwordx4 v3, s[28:31], s70 offen lds
 EX 21,57
 EX 22,58
 MV 80,248,128
 RT 244,11,30208
 RT 246,11,30720
 MV 84,248,132
 EX 23,59
 v_add_f32 v20, 1.0, v20
 v_add_f32 v21, 1.0, v21
 MV 92,216,132
 RT 248,12,30208
 RT 250,12,30720
 MV 88,216,128
 v_add_f32 v22, 1.0, v22
 v_add_f32 v23, 1.0, v23
 v_rcp_f32 v20, v20
 MV 96,220,128
 RT 216,11,30272
 RT 218,11,30784
 MV 100,220,132
 buffer_load_dwordx4 v4, s[28:31], s70 offen offset:1088 lds
 v_rcp_f32 v21, v21
 v_rcp_f32 v22, v22
 MV 108,224,132
 WL 6
 RT 220,12,30272
 RT 222,12,30784
 MV 104,224,128
 v_rcp_f32 v23, v23
 ML 20,56,20
 ML 21,57,21
 MV 80,228,136
 RT 224,11,34560
 RT 226,11,35072
 MV 84,228,140
 ML 22,58,22
 ML 23,59,23
 CV 56,20,21
 CV 58,22,23
 MV 92,232,140
 RT 228,12,34560
 RT 230,12,35072
 MV 88,232,136
 buffer_load_dwordx4 v5, s[28:31], s70 offen offset:2176 lds
 EX 24,52
 EX 25,53
 MV 96,236,136
 RT 232,11,34624
 RT 234,11,35136
 MV 100,236,140
 EX 26,54
 EX 27,55
 MV 108,240,140
 WL 6
 RT 236,12,34624
 RT 238,12,35136
 MV 104,240,136
 v_add_f32 v24, 1.0, v24
 v_add_f32 v25, 1.0, v25
 v_add_f32 v26, 1.0, v26
 v_add_f32 v27, 1.0, v27
 MV 80,244,144
 RT 240,11,38912
 RT 242,11,39424
 MV 84,244,148
 buffer_load_dwordx4 v6, s[28:31], s70 offen offset:3264 lds
 v_rcp_f32 v24, v24
 MV 92,248,148
 RT 244,12,38912
 RT 246,12,39424
 MV 88,248,144
 v_rcp_f32 v25, v25
 v_rcp_f32 v26, v26
 MV 96,216,144
 RT 248,11,38976
 RT 250,11,39488
 MV 100,216,148
 v_rcp_f32 v27, v27
 ML 24,52,24
 MV 108,220,148
 WL 6
 RT 216,12,38976
 RT 218,12,39488
 MV 104,220,144
 s_add_u32 m0, s66, 0
 s_add_u32 s70, s74, 0
 ML 25,53,25
 ML 26,54,26
 ML 27,55,27
 MV 80,224,152
 RT 220,11,43264
 RT 222,11,43776
 MV 84,224,156
 buffer_load_dwordx4 v3, s[28:31], s70 offen lds
 CV 52,24,25
 CV 54,26,27
 MV 92,228,156
 RT 224,12,43264
 RT 226,12,43776
 MV 88,228,152
 EX 28,60
 EX 29,61
 MV 96,232,152
 RT 228,11,43328
 RT 230,11,43840
 MV 100,232,156
 EX 30,62
 v_add_f32 v28, 1.0, v28
 MV 108,236,156
 WL 6
 RT 232,12,43328
 RT 234,12,43840
 MV 104,236,152
 s_add_u32 s3, s3, 0x80
 EX 31,63
 v_add_f32 v29, 1.0, v29
 MV 80,240,160
 RT 236,11,47616
 RT 238,11,48128
 MV 84,240,164
 buffer_load_dword v47, v8, s[28:31], s3 offen
 v_add_f32 v30, 1.0, v30
 v_add_f32 v31, 1.0, v31
 MV 92,244,164
 RT 240,12,47616
 RT 242,12,48128
 MV 88,244,160
 v_rcp_f32 v28, v28
 v_rcp_f32 v29, v29
 MV 96,248,160
 RT 244,11,47680
 RT 246,11,48192
 MV 100,248,164
 v_rcp_f32 v30, v30
 ML 28,60,28
 MV 108,216,164
 WL 6
 RT 248,12,47680
 RT 250,12,48192
 MV 104,216,160
 v_rcp_f32 v31, v31
 ML 29,61,29
 MV 80,220,168
 s_waitcnt vmcnt(11)
 s_barrier
 RT 216,11,51968
 RT 218,11,52480
 MV 84,220,172
 s_add_u32 m0, s65, 0x9900
 s_add_u32 s70, s73, 0x288000
 ML 30,62,30
 ML 31,63,31
 CV 60,28,29
 MV 92,224,172
 RT 220,12,51968
 RT 222,12,52480
 MV 88,224,168
 buffer_load_dwordx4 v3, s[28:31], s70 offen lds
 CV 62,30,31
 EX 16,64
 MV 96,228,168
 RT 224,11,56320
 RT 226,11,56832
 MV 100,228,172
 EX 17,65
 v_add_f32 v16, 1.0, v16
 MV 108,232,172
 WL 6
 RT 228,12,56320
 RT 230,12,56832
 MV 104,232,168
 EX 18,66
 v_add_f32 v17, 1.0, v17
 MV 80,236,176
 RT 232,11,60672
 RT 234,11,61184
 MV 84,236,180
 buffer_load_dwordx4 v4, s[28:31], s70 offen offset:1088 lds
 EX 19,67
 v_add_f32 v18, 1.0, v18
 MV 92,240,180
 RT 236,12,60672
 RT 238,12,61184
 MV 88,240,176
 v_add_f32 v19, 1.0, v19
 v_rcp_f32 v16, v16
 MV 96,244,176
 RT 240,11,65024
 RT 242,13,0
 MV 100,244,180
 v_rcp_f32 v17, v17
 ML 16,64,16
 MV 108,248,180
 WL 6
 RT 244,12,65024
 RT 246,14,0
 MV 104,248,176
 buffer_load_dwordx4 v5, s[28:31], s70 offen offset:2176 lds
 v_rcp_f32 v18, v18
 ML 17,65,17
 MV 80,216,184
 RT 248,13,3840
 RT 250,13,4352
 MV 84,216,188
 v_rcp_f32 v19, v19
 ML 18,66,18
 MV 92,220,188
 RT 216,14,3840
 RT 218,14,4352
 MV 88,220,184
 ML 19,67,19
 CV 64,16,17
 CV 66,18,19
 MV 80,224,192
 RT 220,13,8192
 RT 222,13,8704
 MV 84,224,196
 buffer_load_dwordx4 v6, s[28:31], s70 offen offset:3264 lds
 EX 20,72
 MV 92,228,196
 WL 6
 RT 224,14,8192
 RT 226,14,8704
 MV 88,228,192
 EX 21,73
 EX 22,74
 MV 80,232,200
 RT 228,13,12544
 RT 230,13,13056
 MV 84,232,204
 EX 23,75
 v_add_f32 v20, 1.0, v20
 MV 92,236,204
 RT 232,14,12544
 RT 234,14,13056
 MV 88,236,200
 s_add_u32 m0, m0, 0x1100
 s_add_u32 s70, s73, 0x2d0000
 v_add_f32 v21, 1.0, v21
 v_add_f32 v22, 1.0, v22
 v_add_f32 v23, 1.0, v23
 MV 80,240,208
 RT 236,13,16896
 RT 238,13,17408
 MV 84,240,212
 buffer_load_dwordx4 v3, s[28:31], s70 offen lds
 v_rcp_f32 v20, v20
 MV 92,244,212
 WL 6
 RT 240,14,16896
 RT 242,14,17408
 MV 88,244,208
 v_rcp_f32 v21, v21
 v_rcp_f32 v22, v22
 MV 80,248,216
 RT 244,13,21248
 RT 246,13,21760
 MV 84,248,220
 v_rcp_f32 v23, v23
 ML 20,72,20
 MV 92,216,220
 RT 248,14,21248
 RT 250,14,21760
 MV 88,216,216
 buffer_load_dwordx4 v4, s[28:31], s70 offen offset:1088 lds
 ML 21,73,21
 ML 22,74,22
 ML 23,75,23
 MV 80,220,224
 RT 216,11,52032
 RT 218,11,52544
 MV 84,220,228
 CV 72,20,21
 CV 74,22,23
 MV 92,224,228
 WL 6
 RT 220,12,52032
 RT 222,12,52544
 MV 88,224,224
 EX 24,68
 EX 25,69
 MV 80,228,232
 RT 224,11,56384
 RT 226,11,56896
 MV 84,228,236
 buffer_load_dwordx4 v5, s[28:31], s70 offen offset:2176 lds
 EX 26,70
 v_add_f32 v24, 1.0, v24
 MV 92,232,236
 RT 228,12,56384
 RT 230,12,56896
 MV 88,232,232
 EX 27,71
 v_add_f32 v25, 1.0, v25
 MV 80,236,240
 RT 232,11,60736
 RT 234,11,61248
 MV 84,236,244
 v_add_f32 v26, 1.0, v26
 v_add_f32 v27, 1.0, v27
 MV 92,240,244
 WL 6
 RT 236,12,60736
 RT 238,12,61248
 MV 88,240,240
 buffer_load_dwordx4 v6, s[28:31], s70 offen offset:3264 lds
 v_rcp_f32 v24, v24
 v_rcp_f32 v25, v25
 MV 80,244,248
 RT 240,11,65088
 RT 242,13,64
 MV 84,244,252
 v_rcp_f32 v26, v26
 ML 24,68,24
 MV 92,248,252
 RT 244,12,65088
 RT 246,14,64
 MV 88,248,248
 v_rcp_f32 v27, v27
 ML 25,69,25
 MV 96,216,184
 RT 248,13,3904
 RT 250,13,4416
 MV 100,216,188
 s_add_u32 m0, s66, 0x9900
 s_add_u32 s70, s74, 0x288000
 ML 26,70,26
 ML 27,71,27
 CV 68,24,25
 MV 108,220,188
 WL 6
 RT 216,14,3904
 RT 218,14,4416
 MV 104,220,184
 buffer_load_dwordx4 v3, s[28:31], s70 offen lds
 CV 70,26,27
 EX 28,76
 MV 96,224,192
 RT 220,13,8256
 RT 222,13,8768
 MV 100,224,196
 EX 29,77
 v_add_f32 v28, 1.0, v28
 MV 108,228,196
 RT 224,14,8256
 RT 226,14,8768
 MV 104,228,192
 EX 30,78
 v_add_f32 v29, 1.0, v29
 MV 96,232,200
 RT 228,13,12608
 RT 230,13,13120
 MV 100,232,204
 v_min_u32 v39, 0xe9f80, v36
 v_add_u32 v36, 0x14000, v36
 EX 31,79
 v_add_f32 v30, 1.0, v30
 MV 108,236,204
 WL 6
 RT 232,14,12608
 RT 234,14,13120
 MV 104,236,200
 buffer_load_dword v47, v39, s[32:35], s46 offen
 v_add_f32 v31, 1.0, v31
 v_rcp_f32 v28, v28
 MV 96,240,208
 RT 236,13,16960
 RT 238,13,17472
 MV 100,240,212
 v_rcp_f32 v29, v29
 ML 28,76,28
 MV 108,244,212
 RT 240,14,16960
 RT 242,14,17472
 MV 104,244,208
 v_rcp_f32 v30, v30
 ML 29,77,29
 MV 96,248,216
 RT 244,13,21312
 RT 246,13,21824
 MV 100,248,220
 v_rcp_f32 v31, v31
 ML 30,78,30
 MV 108,216,220
 WL 6
 RT 248,14,21312
 RT 250,14,21824
 MV 104,216,216
 ML 31,79,31
 CV 76,28,29
 CV 78,30,31
 MV 96,220,224
 s_setpc_b64 s[56:57]
L_F_red:
 v_mov_b32 v23, 0x26400
 ds_read_b32 v24, v23
 WL 0
 v_readfirstlane_b32 s92, v24
 s_nop 1
 s_and_b32 s78, s92, 0xff
 s_bfe_u32 s79, s92, 0x80008
 s_lshr_b32 s58, s92, 16
 v_lshrrev_b32 v19, 4, v0
 v_and_b32 v20, 7, v19
 v_lshlrev_b32 v25, 4, v20
 s_mov_b32 s92, 0x480
 v_mul_u32_u24 v20, s92, v20
 v_lshrrev_b32 v18, 3, v19
 v_lshl_add_u32 v28, v18, 4, v20
 v_bfe_u32 v18, v19, 3, 2
 v_lshl_add_u32 v20, v18, 3, v20
 v_lshl_add_u32 v25, v18, 8, v25
 v_lshrrev_b32 v18, 5, v19
 v_lshl_add_u32 v20, v18, 6, v20
 v_lshl_add_u32 v25, v18, 11, v25
 s_mul_i32 s59, s62, 0x2400
 s_lshr_b32 s3, s62, 1
 s_lshl_b32 s3, s3, 10
 s_and_b32 s92, s62, 1
 s_lshl_b32 s92, s92, 7
 s_add_u32 s3, s3, s92
 s_mov_b32 s68, 0x3f80
 s_mov_b32 s69, 0x3f800000
 s_mov_b64 s[74:75], 0
 s_mov_b32 s92, 0xf12ff
 s_sub_u32 s93, s63, 11
 s_lshl_b32 s93, s93, 2
 s_lshr_b32 s92, s92, s93
 s_and_b32 s92, s92, 15
 s_add_u32 s42, s92, 25
 s_cmp_lt_u32 s42, 36
 s_cbranch_scc1 L_F_hi
 s_waitcnt vmcnt(0)
 buffer_load_dword v31, v21, s[36:39], s77 offen sc1
 s_waitcnt vmcnt(0)
 s_branch L_F_fin
L_F_hi:
 s_bitset1_b64 s[74:75], s42
 s_and_b32 s75, s75, 15
 s_and_b32 s92, s42, 3
 s_lshr_b32 s80, s42, 2
 s_lshl_b32 s93, s64, 2
 s_add_u32 s92, s92, s93
 s_mul_i32 s47, s92, 0x9000
 s_add_u32 s46, s47, s59
 s_lshl_b32 s93, s80, 12
 s_add_u32 s93, s93, s3
 s_add_u32 s47, s47, s93
 s_lshl_b32 s93, s80, 7
 s_add_u32 s46, s46, s93
 s_min_u32 s92, s78, s79
 s_cmp_lt_u32 s42, s92
 s_cbranch_scc0 L_F_sl
 s_mov_b32 s93, 0xffff0000
 buffer_load_dwordx2 v[140:141], v20, s[8:11], s46 offen
 buffer_load_dwordx2 v[142:143], v20, s[8:11], s46 offen offset:32
 s_add_u32 s92, s47, 0
 buffer_load_dwordx4 v[72:75], v25, s[36:39], s92 offen sc1
 s_add_u32 s92, s47, 0x240000
 buffer_load_dwordx4 v[76:79], v25, s[36:39], s92 offen sc1
 s_add_u32 s92, s47, 0x480000
 buffer_load_dwordx4 v[80:83], v25, s[36:39], s92 offen sc1
 s_add_u32 s92, s47, 0x6c0000
 buffer_load_dwordx4 v[84:87], v25, s[36:39], s92 offen sc1
 s_add_u32 s92, s47, 0x900000
 buffer_load_dwordx4 v[88:91], v25, s[36:39], s92 offen sc1
 s_add_u32 s92, s47, 0xb40000
 buffer_load_dwordx4 v[92:95], v25, s[36:39], s92 offen sc1
 s_add_u32 s92, s47, 0xd80000
 buffer_load_dwordx4 v[96:99], v25, s[36:39], s92 offen sc1
 s_add_u32 s92, s47, 0xfc0000
 buffer_load_dwordx4 v[100:103], v25, s[36:39], s92 offen sc1
 s_waitcnt vmcnt(7)
 v_lshlrev_b32 v48, 16, v72
 v_and_b32 v49, s93, v72
 v_lshlrev_b32 v50, 16, v73
 v_and_b32 v51, s93, v73
 v_lshlrev_b32 v52, 16, v74
 v_and_b32 v53, s93, v74
 v_lshlrev_b32 v54, 16, v75
 v_and_b32 v55, s93, v75
 s_add_u32 s92, s47, 0x1200000
 buffer_load_dwordx4 v[104:107], v25, s[36:39], s92 offen sc1
 s_waitcnt vmcnt(7)
 v_dot2c_f32_bf16 v48, s68, v76
 v_dot2c_f32_bf16 v49, s69, v76
 v_dot2c_f32_bf16 v50, s68, v77
 v_dot2c_f32_bf16 v51, s69, v77
 v_dot2c_f32_bf16 v52, s68, v78
 v_dot2c_f32_bf16 v53, s69, v78
 v_dot2c_f32_bf16 v54, s68, v79
 v_dot2c_f32_bf16 v55, s69, v79
 s_add_u32 s92, s47, 0x1440000
 buffer_load_dwordx4 v[108:111], v25, s[36:39], s92 offen sc1
 buffer_load_dword v31, v21, s[36:39], s77 offen sc1
 s_mov_b32 s93, 0xffff0000
 s_waitcnt vmcnt(8)
 v_dot2c_f32_bf16 v48, s68, v80
 v_dot2c_f32_bf16 v49, s69, v80
 v_dot2c_f32_bf16 v50, s68, v81
 v_dot2c_f32_bf16 v51, s69, v81
 v_dot2c_f32_bf16 v52, s68, v82
 v_dot2c_f32_bf16 v53, s69, v82
 v_dot2c_f32_bf16 v54, s68, v83
 v_dot2c_f32_bf16 v55, s69, v83
 s_add_u32 s92, s47, 0x1680000
 buffer_load_dwordx4 v[112:115], v25, s[36:39], s92 offen sc1
 s_waitcnt vmcnt(8)
 v_dot2c_f32_bf16 v48, s68, v84
 v_dot2c_f32_bf16 v49, s69, v84
 v_dot2c_f32_bf16 v50, s68, v85
 v_dot2c_f32_bf16 v51, s69, v85
 v_dot2c_f32_bf16 v52, s68, v86
 v_dot2c_f32_bf16 v53, s69, v86
 v_dot2c_f32_bf16 v54, s68, v87
 v_dot2c_f32_bf16 v55, s69, v87
 s_add_u32 s92, s47, 0x18c0000
 buffer_load_dwordx4 v[116:119], v25, s[36:39], s92 offen sc1
 s_waitcnt vmcnt(8)
 v_dot2c_f32_bf16 v48, s68, v88
 v_dot2c_f32_bf16 v49, s69, v88
 v_dot2c_f32_bf16 v50, s68, v89
 v_dot2c_f32_bf16 v51, s69, v89
 v_dot2c_f32_bf16 v52, s68, v90
 v_dot2c_f32_bf16 v53, s69, v90
 v_dot2c_f32_bf16 v54, s68, v91
 v_dot2c_f32_bf16 v55, s69, v91
 s_add_u32 s92, s47, 0x1b00000
 buffer_load_dwordx4 v[120:123], v25, s[36:39], s92 offen sc1
 s_waitcnt vmcnt(8)
 v_dot2c_f32_bf16 v48, s68, v92
 v_dot2c_f32_bf16 v49, s69, v92
 v_dot2c_f32_bf16 v50, s68, v93
 v_dot2c_f32_bf16 v51, s69, v93
 v_dot2c_f32_bf16 v52, s68, v94
 v_dot2c_f32_bf16 v53, s69, v94
 v_dot2c_f32_bf16 v54, s68, v95
 v_dot2c_f32_bf16 v55, s69, v95
 s_add_u32 s92, s47, 0x1d40000
 buffer_load_dwordx4 v[124:127], v25, s[36:39], s92 offen sc1
 s_waitcnt vmcnt(8)
 v_dot2c_f32_bf16 v48, s68, v96
 v_dot2c_f32_bf16 v49, s69, v96
 v_dot2c_f32_bf16 v50, s68, v97
 v_dot2c_f32_bf16 v51, s69, v97
 v_dot2c_f32_bf16 v52, s68, v98
 v_dot2c_f32_bf16 v53, s69, v98
 v_dot2c_f32_bf16 v54, s68, v99
 v_dot2c_f32_bf16 v55, s69, v99
 s_add_u32 s92, s47, 0x1f80000
 buffer_load_dwordx4 v[128:131], v25, s[36:39], s92 offen sc1
 s_waitcnt vmcnt(8)
 v_dot2c_f32_bf16 v48, s68, v100
 v_dot2c_f32_bf16 v49, s69, v100
 v_dot2c_f32_bf16 v50, s68, v101
 v_dot2c_f32_bf16 v51, s69, v101
 v_dot2c_f32_bf16 v52, s68, v102
 v_dot2c_f32_bf16 v53, s69, v102
 v_dot2c_f32_bf16 v54, s68, v103
 v_dot2c_f32_bf16 v55, s69, v103
 s_add_u32 s92, s47, 0x21c0000
 buffer_load_dwordx4 v[132:135], v25, s[36:39], s92 offen sc1
 s_waitcnt vmcnt(8)
 v_dot2c_f32_bf16 v48, s68, v104
 v_dot2c_f32_bf16 v49, s69, v104
 v_dot2c_f32_bf16 v50, s68, v105
 v_dot2c_f32_bf16 v51, s69, v105
 v_dot2c_f32_bf16 v52, s68, v106
 v_dot2c_f32_bf16 v53, s69, v106
 v_dot2c_f32_bf16 v54, s68, v107
 v_dot2c_f32_bf16 v55, s69, v107
 s_add_u32 s92, s47, 0x2400000
 buffer_load_dwordx4 v[136:139], v25, s[36:39], s92 offen sc1
 s_waitcnt vmcnt(8)
 v_dot2c_f32_bf16 v48, s68, v108
 v_dot2c_f32_bf16 v49, s69, v108
 v_dot2c_f32_bf16 v50, s68, v109
 v_dot2c_f32_bf16 v51, s69, v109
 v_dot2c_f32_bf16 v52, s68, v110
 v_dot2c_f32_bf16 v53, s69, v110
 v_dot2c_f32_bf16 v54, s68, v111
 v_dot2c_f32_bf16 v55, s69, v111
 s_waitcnt vmcnt(6)
 v_dot2c_f32_bf16 v48, s68, v112
 v_dot2c_f32_bf16 v49, s69, v112
 v_dot2c_f32_bf16 v50, s68, v113
 v_dot2c_f32_bf16 v51, s69, v113
 v_dot2c_f32_bf16 v52, s68, v114
 v_dot2c_f32_bf16 v53, s69, v114
 v_dot2c_f32_bf16 v54, s68, v115
 v_dot2c_f32_bf16 v55, s69, v115
 s_waitcnt vmcnt(5)
 v_lshlrev_b32 v56, 16, v116
 v_and_b32 v57, s93, v116
 v_lshlrev_b32 v58, 16, v117
 v_and_b32 v59, s93, v117
 v_lshlrev_b32 v60, 16, v118
 v_and_b32 v61, s93, v118
 v_lshlrev_b32 v62, 16, v119
 v_and_b32 v63, s93, v119
 s_waitcnt vmcnt(4)
 v_dot2c_f32_bf16 v56, s68, v120
 v_dot2c_f32_bf16 v57, s69, v120
 v_dot2c_f32_bf16 v58, s68, v121
 v_dot2c_f32_bf16 v59, s69, v121
 v_dot2c_f32_bf16 v60, s68, v122
 v_dot2c_f32_bf16 v61, s69, v122
 v_dot2c_f32_bf16 v62, s68, v123
 v_dot2c_f32_bf16 v63, s69, v123
 s_waitcnt vmcnt(3)
 v_dot2c_f32_bf16 v56, s68, v124
 v_dot2c_f32_bf16 v57, s69, v124
 v_dot2c_f32_bf16 v58, s68, v125
 v_dot2c_f32_bf16 v59, s69, v125
 v_dot2c_f32_bf16 v60, s68, v126
 v_dot2c_f32_bf16 v61, s69, v126
 v_dot2c_f32_bf16 v62, s68, v127
 v_dot2c_f32_bf16 v63, s69, v127
 s_waitcnt vmcnt(2)
 v_dot2c_f32_bf16 v56, s68, v128
 v_dot2c_f32_bf16 v57, s69, v128
 v_dot2c_f32_bf16 v58, s68, v129
 v_dot2c_f32_bf16 v59, s69, v129
 v_dot2c_f32_bf16 v60, s68, v130
 v_dot2c_f32_bf16 v61, s69, v130
 v_dot2c_f32_bf16 v62, s68, v131
 v_dot2c_f32_bf16 v63, s69, v131
 s_waitcnt vmcnt(1)
 v_dot2c_f32_bf16 v56, s68, v132
 v_dot2c_f32_bf16 v57, s69, v132
 v_dot2c_f32_bf16 v58, s68, v133
 v_dot2c_f32_bf16 v59, s69, v133
 v_dot2c_f32_bf16 v60, s68, v134
 v_dot2c_f32_bf16 v61, s69, v134
 v_dot2c_f32_bf16 v62, s68, v135
 v_dot2c_f32_bf16 v63, s69, v135
 s_waitcnt vmcnt(0)
 v_dot2c_f32_bf16 v56, s68, v136
 v_dot2c_f32_bf16 v57, s69, v136
 v_dot2c_f32_bf16 v58, s68, v137
 v_dot2c_f32_bf16 v59, s69, v137
 v_dot2c_f32_bf16 v60, s68, v138
 v_dot2c_f32_bf16 v61, s69, v138
 v_dot2c_f32_bf16 v62, s68, v139
 v_dot2c_f32_bf16 v63, s69, v139
 EX 64,56
 EX 65,57
 EX 66,58
 EX 67,59
 EX 68,60
 EX 69,61
 EX 70,62
 EX 71,63
 v_add_f32 v64, 1.0, v64
 v_add_f32 v65, 1.0, v65
 v_add_f32 v66, 1.0, v66
 v_add_f32 v67, 1.0, v67
 v_add_f32 v68, 1.0, v68
 v_add_f32 v69, 1.0, v69
 v_add_f32 v70, 1.0, v70
 v_add_f32 v71, 1.0, v71
 v_rcp_f32 v64, v64
 v_rcp_f32 v65, v65
 v_rcp_f32 v66, v66
 v_rcp_f32 v67, v67
 v_rcp_f32 v68, v68
 v_rcp_f32 v69, v69
 v_rcp_f32 v70, v70
 v_rcp_f32 v71, v71
 v_mul_f32 v56, 0xbf317218, v56
 v_mul_f32 v57, 0xbf317218, v57
 v_mul_f32 v58, 0xbf317218, v58
 v_mul_f32 v59, 0xbf317218, v59
 v_mul_f32 v60, 0xbf317218, v60
 v_mul_f32 v61, 0xbf317218, v61
 v_mul_f32 v62, 0xbf317218, v62
 v_mul_f32 v63, 0xbf317218, v63
 ML 56,56,64
 ML 57,57,65
 ML 58,58,66
 ML 59,59,67
 ML 60,60,68
 ML 61,61,69
 ML 62,62,70
 ML 63,63,71
 v_lshlrev_b32 v64, 16, v140
 v_and_b32 v65, s93, v140
 v_lshlrev_b32 v66, 16, v141
 v_and_b32 v67, s93, v141
 v_lshlrev_b32 v68, 16, v142
 v_and_b32 v69, s93, v142
 v_lshlrev_b32 v70, 16, v143
 v_and_b32 v71, s93, v143
 v_fma_f32 v64, v48, v56, v64
 v_fma_f32 v65, v49, v57, v65
 v_fma_f32 v66, v50, v58, v66
 v_fma_f32 v67, v51, v59, v67
 v_fma_f32 v68, v52, v60, v68
 v_fma_f32 v69, v53, v61, v69
 v_fma_f32 v70, v54, v62, v70
 v_fma_f32 v71, v55, v63, v71
 CV 140,64,65
 CV 141,66,67
 CV 142,68,69
 CV 143,70,71
 s_nop 0
 v_permlane16_swap_b32 v140, v142
 v_permlane16_swap_b32 v141, v143
 v_mov_b32 v64, v140
 v_mov_b32 v65, v141
 v_mov_b32_dpp v140, v142 row_ror:8 row_mask:0xf bank_mask:0xc
 v_mov_b32_dpp v141, v143 row_ror:8 row_mask:0xf bank_mask:0xc
 v_mov_b32_dpp v142, v64 row_ror:8 row_mask:0xf bank_mask:0x3
 v_mov_b32_dpp v143, v65 row_ror:8 row_mask:0xf bank_mask:0x3
 buffer_store_dwordx4 v[140:143], v28, s[48:51], s46 offen sc1
 v_mov_b32 v19, 0x10000000
 buffer_store_dword v19, v19, s[48:51], 0 offen
 s_branch L_F_j
L_F_sl:
 s_min_u32 s92, s78, s79
 s_cmp_lt_u32 s42, s92
 s_cbranch_scc1 L_F_en0
 s_mov_b32 s81, s42
 s_mov_b32 s80, 3
 s_call_b64 s[66:67], L_F_sync
 s_cmp_eq_u32 s58, 0
 s_cbranch_scc0 L_F_fb
L_F_en0:
 s_mov_b32 s93, 0xffff0000
 buffer_load_dwordx2 v[140:141], v20, s[8:11], s46 offen
 buffer_load_dwordx2 v[142:143], v20, s[8:11], s46 offen offset:32
 s_add_u32 s92, s47, 0
 buffer_load_dwordx4 v[72:75], v25, s[36:39], s92 offen sc1
 s_add_u32 s92, s47, 0x240000
 buffer_load_dwordx4 v[76:79], v25, s[36:39], s92 offen sc1
 s_add_u32 s92, s47, 0x480000
 buffer_load_dwordx4 v[80:83], v25, s[36:39], s92 offen sc1
 s_add_u32 s92, s47, 0x6c0000
 buffer_load_dwordx4 v[84:87], v25, s[36:39], s92 offen sc1
 s_add_u32 s92, s47, 0x900000
 buffer_load_dwordx4 v[88:91], v25, s[36:39], s92 offen sc1
 s_add_u32 s92, s47, 0xb40000
 buffer_load_dwordx4 v[92:95], v25, s[36:39], s92 offen sc1
 s_add_u32 s92, s47, 0xd80000
 buffer_load_dwordx4 v[96:99], v25, s[36:39], s92 offen sc1
 s_add_u32 s92, s47, 0xfc0000
 buffer_load_dwordx4 v[100:103], v25, s[36:39], s92 offen sc1
 s_waitcnt vmcnt(7)
 v_lshlrev_b32 v48, 16, v72
 v_and_b32 v49, s93, v72
 v_lshlrev_b32 v50, 16, v73
 v_and_b32 v51, s93, v73
 v_lshlrev_b32 v52, 16, v74
 v_and_b32 v53, s93, v74
 v_lshlrev_b32 v54, 16, v75
 v_and_b32 v55, s93, v75
 s_add_u32 s92, s47, 0x1200000
 buffer_load_dwordx4 v[104:107], v25, s[36:39], s92 offen sc1
 s_waitcnt vmcnt(7)
 v_dot2c_f32_bf16 v48, s68, v76
 v_dot2c_f32_bf16 v49, s69, v76
 v_dot2c_f32_bf16 v50, s68, v77
 v_dot2c_f32_bf16 v51, s69, v77
 v_dot2c_f32_bf16 v52, s68, v78
 v_dot2c_f32_bf16 v53, s69, v78
 v_dot2c_f32_bf16 v54, s68, v79
 v_dot2c_f32_bf16 v55, s69, v79
 s_add_u32 s92, s47, 0x1440000
 buffer_load_dwordx4 v[108:111], v25, s[36:39], s92 offen sc1
 buffer_load_dword v31, v21, s[36:39], s77 offen sc1
 s_mov_b32 s93, 0xffff0000
 s_waitcnt vmcnt(8)
 v_dot2c_f32_bf16 v48, s68, v80
 v_dot2c_f32_bf16 v49, s69, v80
 v_dot2c_f32_bf16 v50, s68, v81
 v_dot2c_f32_bf16 v51, s69, v81
 v_dot2c_f32_bf16 v52, s68, v82
 v_dot2c_f32_bf16 v53, s69, v82
 v_dot2c_f32_bf16 v54, s68, v83
 v_dot2c_f32_bf16 v55, s69, v83
 s_add_u32 s92, s47, 0x1680000
 buffer_load_dwordx4 v[112:115], v25, s[36:39], s92 offen sc1
 s_waitcnt vmcnt(8)
 v_dot2c_f32_bf16 v48, s68, v84
 v_dot2c_f32_bf16 v49, s69, v84
 v_dot2c_f32_bf16 v50, s68, v85
 v_dot2c_f32_bf16 v51, s69, v85
 v_dot2c_f32_bf16 v52, s68, v86
 v_dot2c_f32_bf16 v53, s69, v86
 v_dot2c_f32_bf16 v54, s68, v87
 v_dot2c_f32_bf16 v55, s69, v87
 s_add_u32 s92, s47, 0x18c0000
 buffer_load_dwordx4 v[116:119], v25, s[36:39], s92 offen sc1
 s_waitcnt vmcnt(8)
 v_dot2c_f32_bf16 v48, s68, v88
 v_dot2c_f32_bf16 v49, s69, v88
 v_dot2c_f32_bf16 v50, s68, v89
 v_dot2c_f32_bf16 v51, s69, v89
 v_dot2c_f32_bf16 v52, s68, v90
 v_dot2c_f32_bf16 v53, s69, v90
 v_dot2c_f32_bf16 v54, s68, v91
 v_dot2c_f32_bf16 v55, s69, v91
 s_add_u32 s92, s47, 0x1b00000
 buffer_load_dwordx4 v[120:123], v25, s[36:39], s92 offen sc1
 s_waitcnt vmcnt(8)
 v_dot2c_f32_bf16 v48, s68, v92
 v_dot2c_f32_bf16 v49, s69, v92
 v_dot2c_f32_bf16 v50, s68, v93
 v_dot2c_f32_bf16 v51, s69, v93
 v_dot2c_f32_bf16 v52, s68, v94
 v_dot2c_f32_bf16 v53, s69, v94
 v_dot2c_f32_bf16 v54, s68, v95
 v_dot2c_f32_bf16 v55, s69, v95
 s_add_u32 s92, s47, 0x1d40000
 buffer_load_dwordx4 v[124:127], v25, s[36:39], s92 offen sc1
 s_waitcnt vmcnt(8)
 v_dot2c_f32_bf16 v48, s68, v96
 v_dot2c_f32_bf16 v49, s69, v96
 v_dot2c_f32_bf16 v50, s68, v97
 v_dot2c_f32_bf16 v51, s69, v97
 v_dot2c_f32_bf16 v52, s68, v98
 v_dot2c_f32_bf16 v53, s69, v98
 v_dot2c_f32_bf16 v54, s68, v99
 v_dot2c_f32_bf16 v55, s69, v99
 s_add_u32 s92, s47, 0x1f80000
 buffer_load_dwordx4 v[128:131], v25, s[36:39], s92 offen sc1
 s_waitcnt vmcnt(8)
 v_dot2c_f32_bf16 v48, s68, v100
 v_dot2c_f32_bf16 v49, s69, v100
 v_dot2c_f32_bf16 v50, s68, v101
 v_dot2c_f32_bf16 v51, s69, v101
 v_dot2c_f32_bf16 v52, s68, v102
 v_dot2c_f32_bf16 v53, s69, v102
 v_dot2c_f32_bf16 v54, s68, v103
 v_dot2c_f32_bf16 v55, s69, v103
 s_add_u32 s92, s47, 0x21c0000
 buffer_load_dwordx4 v[132:135], v25, s[36:39], s92 offen sc1
 s_waitcnt vmcnt(8)
 v_dot2c_f32_bf16 v48, s68, v104
 v_dot2c_f32_bf16 v49, s69, v104
 v_dot2c_f32_bf16 v50, s68, v105
 v_dot2c_f32_bf16 v51, s69, v105
 v_dot2c_f32_bf16 v52, s68, v106
 v_dot2c_f32_bf16 v53, s69, v106
 v_dot2c_f32_bf16 v54, s68, v107
 v_dot2c_f32_bf16 v55, s69, v107
 s_add_u32 s92, s47, 0x2400000
 buffer_load_dwordx4 v[136:139], v25, s[36:39], s92 offen sc1
 s_waitcnt vmcnt(8)
 v_dot2c_f32_bf16 v48, s68, v108
 v_dot2c_f32_bf16 v49, s69, v108
 v_dot2c_f32_bf16 v50, s68, v109
 v_dot2c_f32_bf16 v51, s69, v109
 v_dot2c_f32_bf16 v52, s68, v110
 v_dot2c_f32_bf16 v53, s69, v110
 v_dot2c_f32_bf16 v54, s68, v111
 v_dot2c_f32_bf16 v55, s69, v111
 s_waitcnt vmcnt(6)
 v_dot2c_f32_bf16 v48, s68, v112
 v_dot2c_f32_bf16 v49, s69, v112
 v_dot2c_f32_bf16 v50, s68, v113
 v_dot2c_f32_bf16 v51, s69, v113
 v_dot2c_f32_bf16 v52, s68, v114
 v_dot2c_f32_bf16 v53, s69, v114
 v_dot2c_f32_bf16 v54, s68, v115
 v_dot2c_f32_bf16 v55, s69, v115
 s_waitcnt vmcnt(5)
 v_lshlrev_b32 v56, 16, v116
 v_and_b32 v57, s93, v116
 v_lshlrev_b32 v58, 16, v117
 v_and_b32 v59, s93, v117
 v_lshlrev_b32 v60, 16, v118
 v_and_b32 v61, s93, v118
 v_lshlrev_b32 v62, 16, v119
 v_and_b32 v63, s93, v119
 s_waitcnt vmcnt(4)
 v_dot2c_f32_bf16 v56, s68, v120
 v_dot2c_f32_bf16 v57, s69, v120
 v_dot2c_f32_bf16 v58, s68, v121
 v_dot2c_f32_bf16 v59, s69, v121
 v_dot2c_f32_bf16 v60, s68, v122
 v_dot2c_f32_bf16 v61, s69, v122
 v_dot2c_f32_bf16 v62, s68, v123
 v_dot2c_f32_bf16 v63, s69, v123
 s_waitcnt vmcnt(3)
 v_dot2c_f32_bf16 v56, s68, v124
 v_dot2c_f32_bf16 v57, s69, v124
 v_dot2c_f32_bf16 v58, s68, v125
 v_dot2c_f32_bf16 v59, s69, v125
 v_dot2c_f32_bf16 v60, s68, v126
 v_dot2c_f32_bf16 v61, s69, v126
 v_dot2c_f32_bf16 v62, s68, v127
 v_dot2c_f32_bf16 v63, s69, v127
 s_waitcnt vmcnt(2)
 v_dot2c_f32_bf16 v56, s68, v128
 v_dot2c_f32_bf16 v57, s69, v128
 v_dot2c_f32_bf16 v58, s68, v129
 v_dot2c_f32_bf16 v59, s69, v129
 v_dot2c_f32_bf16 v60, s68, v130
 v_dot2c_f32_bf16 v61, s69, v130
 v_dot2c_f32_bf16 v62, s68, v131
 v_dot2c_f32_bf16 v63, s69, v131
 s_waitcnt vmcnt(1)
 v_dot2c_f32_bf16 v56, s68, v132
 v_dot2c_f32_bf16 v57, s69, v132
 v_dot2c_f32_bf16 v58, s68, v133
 v_dot2c_f32_bf16 v59, s69, v133
 v_dot2c_f32_bf16 v60, s68, v134
 v_dot2c_f32_bf16 v61, s69, v134
 v_dot2c_f32_bf16 v62, s68, v135
 v_dot2c_f32_bf16 v63, s69, v135
 s_waitcnt vmcnt(0)
 v_dot2c_f32_bf16 v56, s68, v136
 v_dot2c_f32_bf16 v57, s69, v136
 v_dot2c_f32_bf16 v58, s68, v137
 v_dot2c_f32_bf16 v59, s69, v137
 v_dot2c_f32_bf16 v60, s68, v138
 v_dot2c_f32_bf16 v61, s69, v138
 v_dot2c_f32_bf16 v62, s68, v139
 v_dot2c_f32_bf16 v63, s69, v139
 EX 64,56
 EX 65,57
 EX 66,58
 EX 67,59
 EX 68,60
 EX 69,61
 EX 70,62
 EX 71,63
 v_add_f32 v64, 1.0, v64
 v_add_f32 v65, 1.0, v65
 v_add_f32 v66, 1.0, v66
 v_add_f32 v67, 1.0, v67
 v_add_f32 v68, 1.0, v68
 v_add_f32 v69, 1.0, v69
 v_add_f32 v70, 1.0, v70
 v_add_f32 v71, 1.0, v71
 v_rcp_f32 v64, v64
 v_rcp_f32 v65, v65
 v_rcp_f32 v66, v66
 v_rcp_f32 v67, v67
 v_rcp_f32 v68, v68
 v_rcp_f32 v69, v69
 v_rcp_f32 v70, v70
 v_rcp_f32 v71, v71
 v_mul_f32 v56, 0xbf317218, v56
 v_mul_f32 v57, 0xbf317218, v57
 v_mul_f32 v58, 0xbf317218, v58
 v_mul_f32 v59, 0xbf317218, v59
 v_mul_f32 v60, 0xbf317218, v60
 v_mul_f32 v61, 0xbf317218, v61
 v_mul_f32 v62, 0xbf317218, v62
 v_mul_f32 v63, 0xbf317218, v63
 ML 56,56,64
 ML 57,57,65
 ML 58,58,66
 ML 59,59,67
 ML 60,60,68
 ML 61,61,69
 ML 62,62,70
 ML 63,63,71
 v_lshlrev_b32 v64, 16, v140
 v_and_b32 v65, s93, v140
 v_lshlrev_b32 v66, 16, v141
 v_and_b32 v67, s93, v141
 v_lshlrev_b32 v68, 16, v142
 v_and_b32 v69, s93, v142
 v_lshlrev_b32 v70, 16, v143
 v_and_b32 v71, s93, v143
 v_fma_f32 v64, v48, v56, v64
 v_fma_f32 v65, v49, v57, v65
 v_fma_f32 v66, v50, v58, v66
 v_fma_f32 v67, v51, v59, v67
 v_fma_f32 v68, v52, v60, v68
 v_fma_f32 v69, v53, v61, v69
 v_fma_f32 v70, v54, v62, v70
 v_fma_f32 v71, v55, v63, v71
 CV 140,64,65
 CV 141,66,67
 CV 142,68,69
 CV 143,70,71
 s_nop 0
 v_permlane16_swap_b32 v140, v142
 v_permlane16_swap_b32 v141, v143
 v_mov_b32 v64, v140
 v_mov_b32 v65, v141
 v_mov_b32_dpp v140, v142 row_ror:8 row_mask:0xf bank_mask:0xc
 v_mov_b32_dpp v141, v143 row_ror:8 row_mask:0xf bank_mask:0xc
 v_mov_b32_dpp v142, v64 row_ror:8 row_mask:0xf bank_mask:0x3
 v_mov_b32_dpp v143, v65 row_ror:8 row_mask:0xf bank_mask:0x3
 buffer_store_dwordx4 v[140:143], v28, s[48:51], s46 offen sc1
 v_mov_b32 v19, 0x10000000
 buffer_store_dword v19, v19, s[48:51], 0 offen
 s_bitset0_b64 s[74:75], s42
L_F_j:
 s_bitset0_b64 s[74:75], s42
L_F_fin:
 s_cmp_eq_u32 s62, 0
 s_cbranch_scc0 L_F_b4
 v_cmp_ne_u32 vcc, 0, v31
 s_nop 1
 s_mov_b32 s72, vcc_lo
 s_and_b32 s73, vcc_hi, 15
 s_or_b32 s92, s72, s73
 s_cselect_b32 s58, 1, 0
 s_cmp_ge_u32 s40, 16
 s_cselect_b32 s58, s58, 1
 s_lshl_b32 s92, s79, 8
 s_or_b32 s92, s92, s78
 s_lshl_b32 s93, s58, 16
 s_or_b32 s92, s92, s93
 v_mov_b32 v24, s92
 v_mov_b32 v23, s41
 ds_write_b32 v23, v24
 WL 0
L_F_b4:
 s_barrier
 v_mov_b32 v23, s41
 ds_read_b32 v24, v23
 WL 0
 v_readfirstlane_b32 s92, v24
 s_nop 1
 s_and_b32 s78, s92, 0xff
 s_bfe_u32 s79, s92, 0x80008
 s_lshr_b32 s58, s92, 16
 s_xor_b32 s41, s41, 12
 s_cmp_eq_u32 s58, 0
 s_cbranch_scc1 L_F_exit
L_F_fb:
 s_waitcnt vmcnt(0)
 s_cmp_eq_u32 s62, 0
 s_cbranch_scc0 L_F_fb2
 s_mov_b64 s[98:99], s[74:75]
 v_mov_b32 v18, 1
 v_lshlrev_b32 v19, 4, v0
 v_mov_b32 v24, 0x10000000
 v_cmp_gt_u32 vcc, 0x100, v0
 s_nop 1
 v_cndmask_b32 v19, v24, v19, vcc
L_F_mk:
 s_cmp_eq_u64 s[98:99], 0
 s_cbranch_scc1 L_F_mk1
 s_ff1_i32_b64 s92, s[98:99]
 s_bitset0_b64 s[98:99], s92
 s_lshl2_add_u32 s92, s92, s82
 s_add_u32 s92, s92, 0x1000
 buffer_store_dword v18, v19, s[36:39], s92 offen sc1
 s_branch L_F_mk
L_F_mk1:
 s_waitcnt vmcnt(0)
 v_mov_b32 v17, 0
 buffer_atomic_add v17, v22, s[52:55], 0 offen sc0 sc1
 s_waitcnt vmcnt(0)
 v_mov_b32 v19, 0x10000000
 s_mov_b32 s92, 0x90
 v_writelane_b32 v19, s92, 1
 buffer_store_dword v18, v19, s[36:39], s77 offen sc1
 v_mov_b32 v24, 0
 v_mov_b32 v19, 0x10000000
 v_writelane_b32 v19, 0, 0
 buffer_atomic_add v24, v19, s[36:39], s77 offen sc1
 s_waitcnt vmcnt(0)
 buffer_load_dword v31, v21, s[36:39], s77 offen sc1
 buffer_store_dword v26, v26, s[36:39], s82 offen sc1
 buffer_load_dword v16, v21, s[36:39], s82 offen sc1
 s_waitcnt vmcnt(0)
 v_readfirstlane_b32 s40, v17
 v_cmp_ne_u32 vcc, 0, v16
 s_nop 1
 s_lshr_b64 s[72:73], vcc, 18
 s_and_b32 s73, s73, 15
 s_mov_b32 s78, 0
 s_mov_b32 s79, 0
 v_cmp_ge_u32 vcc, 0, v16
 s_nop 1
 s_and_b32 s92, vcc_lo, 0x7ff
 s_cselect_b32 s78, s78, 4
 s_and_b32 s92, vcc_lo, 0x1f800
 s_cselect_b32 s79, s79, 4
 v_cmp_ge_u32 vcc, 1, v16
 s_nop 1
 s_and_b32 s92, vcc_lo, 0x7ff
 s_cselect_b32 s78, s78, 8
 s_and_b32 s92, vcc_lo, 0x1f800
 s_cselect_b32 s79, s79, 8
 v_cmp_ge_u32 vcc, 2, v16
 s_nop 1
 s_and_b32 s92, vcc_lo, 0x7ff
 s_cselect_b32 s78, s78, 12
 s_and_b32 s92, vcc_lo, 0x1f800
 s_cselect_b32 s79, s79, 12
 v_cmp_ge_u32 vcc, 3, v16
 s_nop 1
 s_and_b32 s92, vcc_lo, 0x7ff
 s_cselect_b32 s78, s78, 16
 s_and_b32 s92, vcc_lo, 0x1f800
 s_cselect_b32 s79, s79, 16
 v_cmp_ge_u32 vcc, 4, v16
 s_nop 1
 s_and_b32 s92, vcc_lo, 0x7ff
 s_cselect_b32 s78, s78, 20
 s_and_b32 s92, vcc_lo, 0x1f800
 s_cselect_b32 s79, s79, 20
 v_cmp_ge_u32 vcc, 5, v16
 s_nop 1
 s_and_b32 s92, vcc_lo, 0x7ff
 s_cselect_b32 s78, s78, 24
 s_and_b32 s92, vcc_lo, 0x1f800
 s_cselect_b32 s79, s79, 24
 v_cmp_ge_u32 vcc, 6, v16
 s_nop 1
 s_and_b32 s92, vcc_lo, 0x7ff
 s_cselect_b32 s78, s78, 28
 s_and_b32 s92, vcc_lo, 0x1f800
 s_cselect_b32 s79, s79, 28
 v_cmp_ge_u32 vcc, 7, v16
 s_nop 1
 s_and_b32 s92, vcc_lo, 0x7ff
 s_cselect_b32 s78, s78, 32
 s_and_b32 s92, vcc_lo, 0x1f800
 s_cselect_b32 s79, s79, 32
 v_cmp_ge_u32 vcc, 8, v16
 s_nop 1
 s_and_b32 s92, vcc_lo, 0x7ff
 s_cselect_b32 s78, s78, 36
 s_and_b32 s92, vcc_lo, 0x1f800
 s_cselect_b32 s79, s79, 36
 v_cmp_ne_u32 vcc, 0, v31
 s_nop 1
 s_mov_b32 s72, vcc_lo
 s_and_b32 s73, vcc_hi, 15
 s_min_u32 s92, s78, s79
 s_cmp_ge_u32 s40, 16
 s_cselect_b32 s92, s92, 0
 s_bfm_b64 s[98:99], s92, 0
 s_or_b64 s[72:73], s[72:73], s[74:75]
 s_and_b64 s[72:73], s[72:73], s[98:99]
L_F_fb1:
 s_ff1_i32_b64 s78, s[72:73]
 s_and_b32 s78, s78, 0xff
 s_bitset0_b64 s[72:73], s78
 s_lshl_b32 s92, s79, 8
 s_or_b32 s92, s92, s78
 s_lshl_b32 s93, s58, 16
 s_or_b32 s92, s92, s93
 v_mov_b32 v24, s92
 v_mov_b32 v23, s41
 ds_write_b32 v23, v24
 WL 0
L_F_fb2:
 s_barrier
 v_mov_b32 v23, s41
 ds_read_b32 v24, v23
 WL 0
 v_readfirstlane_b32 s92, v24
 s_nop 1
 s_and_b32 s78, s92, 0xff
 s_bfe_u32 s79, s92, 0x80008
 s_lshr_b32 s58, s92, 16
 s_xor_b32 s41, s41, 12
 s_cmp_ge_u32 s78, 36
 s_cbranch_scc1 L_F_exit
 s_and_b32 s92, s78, 3
 s_lshr_b32 s80, s78, 2
 s_lshl_b32 s93, s64, 2
 s_add_u32 s92, s92, s93
 s_mul_i32 s47, s92, 0x9000
 s_add_u32 s46, s47, s59
 s_lshl_b32 s93, s80, 12
 s_add_u32 s93, s93, s3
 s_add_u32 s47, s47, s93
 s_lshl_b32 s93, s80, 7
 s_add_u32 s46, s46, s93
 s_add_u32 s92, s47, 0
 buffer_load_dwordx4 v[72:75], v25, s[36:39], s92 offen sc1
 s_add_u32 s92, s47, 0x240000
 buffer_load_dwordx4 v[76:79], v25, s[36:39], s92 offen sc1
 s_add_u32 s92, s47, 0x480000
 buffer_load_dwordx4 v[80:83], v25, s[36:39], s92 offen sc1
 s_add_u32 s92, s47, 0x6c0000
 buffer_load_dwordx4 v[84:87], v25, s[36:39], s92 offen sc1
 s_add_u32 s92, s47, 0x900000
 buffer_load_dwordx4 v[88:91], v25, s[36:39], s92 offen sc1
 s_add_u32 s92, s47, 0xb40000
 buffer_load_dwordx4 v[92:95], v25, s[36:39], s92 offen sc1
 s_add_u32 s92, s47, 0xd80000
 buffer_load_dwordx4 v[96:99], v25, s[36:39], s92 offen sc1
 s_add_u32 s92, s47, 0xfc0000
 buffer_load_dwordx4 v[100:103], v25, s[36:39], s92 offen sc1
 s_add_u32 s92, s47, 0x1200000
 buffer_load_dwordx4 v[104:107], v25, s[36:39], s92 offen sc1
 s_add_u32 s92, s47, 0x1440000
 buffer_load_dwordx4 v[108:111], v25, s[36:39], s92 offen sc1
 s_add_u32 s92, s47, 0x1680000
 buffer_load_dwordx4 v[112:115], v25, s[36:39], s92 offen sc1
 s_add_u32 s92, s47, 0x18c0000
 buffer_load_dwordx4 v[116:119], v25, s[36:39], s92 offen sc1
 s_add_u32 s92, s47, 0x1b00000
 buffer_load_dwordx4 v[120:123], v25, s[36:39], s92 offen sc1
 s_add_u32 s92, s47, 0x1d40000
 buffer_load_dwordx4 v[124:127], v25, s[36:39], s92 offen sc1
 s_add_u32 s92, s47, 0x1f80000
 buffer_load_dwordx4 v[128:131], v25, s[36:39], s92 offen sc1
 s_add_u32 s92, s47, 0x21c0000
 buffer_load_dwordx4 v[132:135], v25, s[36:39], s92 offen sc1
 s_add_u32 s92, s47, 0x2400000
 buffer_load_dwordx4 v[136:139], v25, s[36:39], s92 offen sc1
 buffer_load_dwordx2 v[140:141], v20, s[8:11], s46 offen
 buffer_load_dwordx2 v[142:143], v20, s[8:11], s46 offen offset:32
 s_waitcnt vmcnt(0)
 s_mov_b32 s93, 0xffff0000
 s_waitcnt vmcnt(18)
 v_lshlrev_b32 v48, 16, v72
 v_and_b32 v49, s93, v72
 v_lshlrev_b32 v50, 16, v73
 v_and_b32 v51, s93, v73
 v_lshlrev_b32 v52, 16, v74
 v_and_b32 v53, s93, v74
 v_lshlrev_b32 v54, 16, v75
 v_and_b32 v55, s93, v75
 s_waitcnt vmcnt(17)
 v_dot2c_f32_bf16 v48, s68, v76
 v_dot2c_f32_bf16 v49, s69, v76
 v_dot2c_f32_bf16 v50, s68, v77
 v_dot2c_f32_bf16 v51, s69, v77
 v_dot2c_f32_bf16 v52, s68, v78
 v_dot2c_f32_bf16 v53, s69, v78
 v_dot2c_f32_bf16 v54, s68, v79
 v_dot2c_f32_bf16 v55, s69, v79
 s_waitcnt vmcnt(16)
 v_dot2c_f32_bf16 v48, s68, v80
 v_dot2c_f32_bf16 v49, s69, v80
 v_dot2c_f32_bf16 v50, s68, v81
 v_dot2c_f32_bf16 v51, s69, v81
 v_dot2c_f32_bf16 v52, s68, v82
 v_dot2c_f32_bf16 v53, s69, v82
 v_dot2c_f32_bf16 v54, s68, v83
 v_dot2c_f32_bf16 v55, s69, v83
 s_waitcnt vmcnt(15)
 v_dot2c_f32_bf16 v48, s68, v84
 v_dot2c_f32_bf16 v49, s69, v84
 v_dot2c_f32_bf16 v50, s68, v85
 v_dot2c_f32_bf16 v51, s69, v85
 v_dot2c_f32_bf16 v52, s68, v86
 v_dot2c_f32_bf16 v53, s69, v86
 v_dot2c_f32_bf16 v54, s68, v87
 v_dot2c_f32_bf16 v55, s69, v87
 s_waitcnt vmcnt(14)
 v_dot2c_f32_bf16 v48, s68, v88
 v_dot2c_f32_bf16 v49, s69, v88
 v_dot2c_f32_bf16 v50, s68, v89
 v_dot2c_f32_bf16 v51, s69, v89
 v_dot2c_f32_bf16 v52, s68, v90
 v_dot2c_f32_bf16 v53, s69, v90
 v_dot2c_f32_bf16 v54, s68, v91
 v_dot2c_f32_bf16 v55, s69, v91
 s_waitcnt vmcnt(13)
 v_dot2c_f32_bf16 v48, s68, v92
 v_dot2c_f32_bf16 v49, s69, v92
 v_dot2c_f32_bf16 v50, s68, v93
 v_dot2c_f32_bf16 v51, s69, v93
 v_dot2c_f32_bf16 v52, s68, v94
 v_dot2c_f32_bf16 v53, s69, v94
 v_dot2c_f32_bf16 v54, s68, v95
 v_dot2c_f32_bf16 v55, s69, v95
 s_waitcnt vmcnt(12)
 v_dot2c_f32_bf16 v48, s68, v96
 v_dot2c_f32_bf16 v49, s69, v96
 v_dot2c_f32_bf16 v50, s68, v97
 v_dot2c_f32_bf16 v51, s69, v97
 v_dot2c_f32_bf16 v52, s68, v98
 v_dot2c_f32_bf16 v53, s69, v98
 v_dot2c_f32_bf16 v54, s68, v99
 v_dot2c_f32_bf16 v55, s69, v99
 s_waitcnt vmcnt(11)
 v_dot2c_f32_bf16 v48, s68, v100
 v_dot2c_f32_bf16 v49, s69, v100
 v_dot2c_f32_bf16 v50, s68, v101
 v_dot2c_f32_bf16 v51, s69, v101
 v_dot2c_f32_bf16 v52, s68, v102
 v_dot2c_f32_bf16 v53, s69, v102
 v_dot2c_f32_bf16 v54, s68, v103
 v_dot2c_f32_bf16 v55, s69, v103
 s_waitcnt vmcnt(10)
 v_dot2c_f32_bf16 v48, s68, v104
 v_dot2c_f32_bf16 v49, s69, v104
 v_dot2c_f32_bf16 v50, s68, v105
 v_dot2c_f32_bf16 v51, s69, v105
 v_dot2c_f32_bf16 v52, s68, v106
 v_dot2c_f32_bf16 v53, s69, v106
 v_dot2c_f32_bf16 v54, s68, v107
 v_dot2c_f32_bf16 v55, s69, v107
 s_waitcnt vmcnt(9)
 v_dot2c_f32_bf16 v48, s68, v108
 v_dot2c_f32_bf16 v49, s69, v108
 v_dot2c_f32_bf16 v50, s68, v109
 v_dot2c_f32_bf16 v51, s69, v109
 v_dot2c_f32_bf16 v52, s68, v110
 v_dot2c_f32_bf16 v53, s69, v110
 v_dot2c_f32_bf16 v54, s68, v111
 v_dot2c_f32_bf16 v55, s69, v111
 s_waitcnt vmcnt(8)
 v_dot2c_f32_bf16 v48, s68, v112
 v_dot2c_f32_bf16 v49, s69, v112
 v_dot2c_f32_bf16 v50, s68, v113
 v_dot2c_f32_bf16 v51, s69, v113
 v_dot2c_f32_bf16 v52, s68, v114
 v_dot2c_f32_bf16 v53, s69, v114
 v_dot2c_f32_bf16 v54, s68, v115
 v_dot2c_f32_bf16 v55, s69, v115
 s_waitcnt vmcnt(7)
 v_lshlrev_b32 v56, 16, v116
 v_and_b32 v57, s93, v116
 v_lshlrev_b32 v58, 16, v117
 v_and_b32 v59, s93, v117
 v_lshlrev_b32 v60, 16, v118
 v_and_b32 v61, s93, v118
 v_lshlrev_b32 v62, 16, v119
 v_and_b32 v63, s93, v119
 s_waitcnt vmcnt(6)
 v_dot2c_f32_bf16 v56, s68, v120
 v_dot2c_f32_bf16 v57, s69, v120
 v_dot2c_f32_bf16 v58, s68, v121
 v_dot2c_f32_bf16 v59, s69, v121
 v_dot2c_f32_bf16 v60, s68, v122
 v_dot2c_f32_bf16 v61, s69, v122
 v_dot2c_f32_bf16 v62, s68, v123
 v_dot2c_f32_bf16 v63, s69, v123
 s_waitcnt vmcnt(5)
 v_dot2c_f32_bf16 v56, s68, v124
 v_dot2c_f32_bf16 v57, s69, v124
 v_dot2c_f32_bf16 v58, s68, v125
 v_dot2c_f32_bf16 v59, s69, v125
 v_dot2c_f32_bf16 v60, s68, v126
 v_dot2c_f32_bf16 v61, s69, v126
 v_dot2c_f32_bf16 v62, s68, v127
 v_dot2c_f32_bf16 v63, s69, v127
 s_waitcnt vmcnt(4)
 v_dot2c_f32_bf16 v56, s68, v128
 v_dot2c_f32_bf16 v57, s69, v128
 v_dot2c_f32_bf16 v58, s68, v129
 v_dot2c_f32_bf16 v59, s69, v129
 v_dot2c_f32_bf16 v60, s68, v130
 v_dot2c_f32_bf16 v61, s69, v130
 v_dot2c_f32_bf16 v62, s68, v131
 v_dot2c_f32_bf16 v63, s69, v131
 s_waitcnt vmcnt(3)
 v_dot2c_f32_bf16 v56, s68, v132
 v_dot2c_f32_bf16 v57, s69, v132
 v_dot2c_f32_bf16 v58, s68, v133
 v_dot2c_f32_bf16 v59, s69, v133
 v_dot2c_f32_bf16 v60, s68, v134
 v_dot2c_f32_bf16 v61, s69, v134
 v_dot2c_f32_bf16 v62, s68, v135
 v_dot2c_f32_bf16 v63, s69, v135
 s_waitcnt vmcnt(2)
 v_dot2c_f32_bf16 v56, s68, v136
 v_dot2c_f32_bf16 v57, s69, v136
 v_dot2c_f32_bf16 v58, s68, v137
 v_dot2c_f32_bf16 v59, s69, v137
 v_dot2c_f32_bf16 v60, s68, v138
 v_dot2c_f32_bf16 v61, s69, v138
 v_dot2c_f32_bf16 v62, s68, v139
 v_dot2c_f32_bf16 v63, s69, v139
 EX 64,56
 EX 65,57
 EX 66,58
 EX 67,59
 EX 68,60
 EX 69,61
 EX 70,62
 EX 71,63
 v_add_f32 v64, 1.0, v64
 v_add_f32 v65, 1.0, v65
 v_add_f32 v66, 1.0, v66
 v_add_f32 v67, 1.0, v67
 v_add_f32 v68, 1.0, v68
 v_add_f32 v69, 1.0, v69
 v_add_f32 v70, 1.0, v70
 v_add_f32 v71, 1.0, v71
 v_rcp_f32 v64, v64
 v_rcp_f32 v65, v65
 v_rcp_f32 v66, v66
 v_rcp_f32 v67, v67
 v_rcp_f32 v68, v68
 v_rcp_f32 v69, v69
 v_rcp_f32 v70, v70
 v_rcp_f32 v71, v71
 v_mul_f32 v56, 0xbf317218, v56
 v_mul_f32 v57, 0xbf317218, v57
 v_mul_f32 v58, 0xbf317218, v58
 v_mul_f32 v59, 0xbf317218, v59
 v_mul_f32 v60, 0xbf317218, v60
 v_mul_f32 v61, 0xbf317218, v61
 v_mul_f32 v62, 0xbf317218, v62
 v_mul_f32 v63, 0xbf317218, v63
 ML 56,56,64
 ML 57,57,65
 ML 58,58,66
 ML 59,59,67
 ML 60,60,68
 ML 61,61,69
 ML 62,62,70
 ML 63,63,71
 s_waitcnt vmcnt(0)
 v_lshlrev_b32 v64, 16, v140
 v_and_b32 v65, s93, v140
 v_lshlrev_b32 v66, 16, v141
 v_and_b32 v67, s93, v141
 v_lshlrev_b32 v68, 16, v142
 v_and_b32 v69, s93, v142
 v_lshlrev_b32 v70, 16, v143
 v_and_b32 v71, s93, v143
 v_fma_f32 v64, v48, v56, v64
 v_fma_f32 v65, v49, v57, v65
 v_fma_f32 v66, v50, v58, v66
 v_fma_f32 v67, v51, v59, v67
 v_fma_f32 v68, v52, v60, v68
 v_fma_f32 v69, v53, v61, v69
 v_fma_f32 v70, v54, v62, v70
 v_fma_f32 v71, v55, v63, v71
 CV 140,64,65
 CV 141,66,67
 CV 142,68,69
 CV 143,70,71
 s_nop 0
 v_permlane16_swap_b32 v140, v142
 v_permlane16_swap_b32 v141, v143
 v_mov_b32 v64, v140
 v_mov_b32 v65, v141
 v_mov_b32_dpp v140, v142 row_ror:8 row_mask:0xf bank_mask:0xc
 v_mov_b32_dpp v141, v143 row_ror:8 row_mask:0xf bank_mask:0xc
 v_mov_b32_dpp v142, v64 row_ror:8 row_mask:0xf bank_mask:0x3
 v_mov_b32_dpp v143, v65 row_ror:8 row_mask:0xf bank_mask:0x3
 buffer_store_dwordx4 v[140:143], v28, s[48:51], s46 offen sc1
 v_mov_b32 v19, 0x10000000
 buffer_store_dword v19, v19, s[48:51], 0 offen
 s_cmp_eq_u32 s62, 0
 s_cbranch_scc1 L_F_fb1
 s_branch L_F_fb2
L_F_exit:
 s_endpgm
L_F_sync:
 s_cmp_eq_u32 s62, 0
 s_cbranch_scc0 L_F_sy2
 s_mov_b32 s71, 0
 buffer_store_dword v29, v29, s[36:39], s76 offen sc1
L_F_sy0:
 s_cmp_ge_u32 s40, 16
 s_cbranch_scc1 L_F_sy1
 v_mov_b32 v17, 0
 buffer_atomic_add v17, v22, s[52:55], 0 offen sc0 sc1
 s_waitcnt vmcnt(0)
 v_readfirstlane_b32 s40, v17
 s_nop 1
 s_cmp_ge_u32 s40, 16
 s_cbranch_scc0 L_F_syw
L_F_sy1:
 buffer_load_dword v16, v30, s[36:39], s76 offen sc1
 buffer_store_dword v29, v29, s[36:39], s76 offen sc1
 s_waitcnt vmcnt(1)
 v_cmp_ne_u32 vcc, 0, v16
 s_nop 1
 s_lshr_b64 s[72:73], vcc, 18
 s_and_b32 s73, s73, 15
 s_mov_b32 s78, 0
 s_mov_b32 s79, 0
 v_cmp_ge_u32 vcc, 0, v16
 s_nop 1
 s_and_b32 s92, vcc_lo, 0x7ff
 s_cselect_b32 s78, s78, 4
 s_and_b32 s92, vcc_lo, 0x1f800
 s_cselect_b32 s79, s79, 4
 v_cmp_ge_u32 vcc, 1, v16
 s_nop 1
 s_and_b32 s92, vcc_lo, 0x7ff
 s_cselect_b32 s78, s78, 8
 s_and_b32 s92, vcc_lo, 0x1f800
 s_cselect_b32 s79, s79, 8
 v_cmp_ge_u32 vcc, 2, v16
 s_nop 1
 s_and_b32 s92, vcc_lo, 0x7ff
 s_cselect_b32 s78, s78, 12
 s_and_b32 s92, vcc_lo, 0x1f800
 s_cselect_b32 s79, s79, 12
 v_cmp_ge_u32 vcc, 3, v16
 s_nop 1
 s_and_b32 s92, vcc_lo, 0x7ff
 s_cselect_b32 s78, s78, 16
 s_and_b32 s92, vcc_lo, 0x1f800
 s_cselect_b32 s79, s79, 16
 v_cmp_ge_u32 vcc, 4, v16
 s_nop 1
 s_and_b32 s92, vcc_lo, 0x7ff
 s_cselect_b32 s78, s78, 20
 s_and_b32 s92, vcc_lo, 0x1f800
 s_cselect_b32 s79, s79, 20
 v_cmp_ge_u32 vcc, 5, v16
 s_nop 1
 s_and_b32 s92, vcc_lo, 0x7ff
 s_cselect_b32 s78, s78, 24
 s_and_b32 s92, vcc_lo, 0x1f800
 s_cselect_b32 s79, s79, 24
 v_cmp_ge_u32 vcc, 6, v16
 s_nop 1
 s_and_b32 s92, vcc_lo, 0x7ff
 s_cselect_b32 s78, s78, 28
 s_and_b32 s92, vcc_lo, 0x1f800
 s_cselect_b32 s79, s79, 28
 v_cmp_ge_u32 vcc, 7, v16
 s_nop 1
 s_and_b32 s92, vcc_lo, 0x7ff
 s_cselect_b32 s78, s78, 32
 s_and_b32 s92, vcc_lo, 0x1f800
 s_cselect_b32 s79, s79, 32
 v_cmp_ge_u32 vcc, 8, v16
 s_nop 1
 s_and_b32 s92, vcc_lo, 0x7ff
 s_cselect_b32 s78, s78, 36
 s_and_b32 s92, vcc_lo, 0x1f800
 s_cselect_b32 s79, s79, 36
 s_bitcmp1_b32 s80, 0
 s_cselect_b32 s92, s78, 36
 s_bitcmp1_b32 s80, 1
 s_cselect_b32 s93, s79, 36
 s_min_u32 s92, s92, s93
 s_cmp_lt_u32 s81, s92
 s_cbranch_scc1 L_F_syp
L_F_syw:
 s_add_u32 s71, s71, 1
 s_cmp_gt_u32 s71, 0xfa0
 s_cselect_b32 s58, 1, 0
 s_cbranch_scc1 L_F_syp
 s_sleep 1
 s_branch L_F_sy0
L_F_syp:
 s_lshl_b32 s92, s79, 8
 s_or_b32 s92, s92, s78
 s_lshl_b32 s93, s58, 16
 s_or_b32 s92, s92, s93
 v_mov_b32 v24, s92
 v_mov_b32 v23, s41
 ds_write_b32 v23, v24
 WL 0
L_F_sy2:
 s_barrier
 v_mov_b32 v23, s41
 ds_read_b32 v24, v23
 WL 0
 v_readfirstlane_b32 s92, v24
 s_nop 1
 s_and_b32 s78, s92, 0xff
 s_bfe_u32 s79, s92, 0x80008
 s_lshr_b32 s58, s92, 16
 s_xor_b32 s41, s41, 12
 s_setpc_b64 s[66:67]
L_roleF_end:
.p2align 6
L_roleA:
 v_lshrrev_b32 v48, 4, v0
 v_and_b32 v49, 15, v0
 v_bfe_u32 v50, v0, 1, 3
 v_xor_b32 v50, v50, v48
 v_lshlrev_b32 v49, 7, v49
 v_add_u32 v49, s6, v49
 v_lshl_add_u32 v20, v50, 4, v49
 v_xor_b32 v21, 64, v20
 v_mov_b32 v56, 0
 v_mov_b32 v57, 0
 v_mov_b32 v58, 0
 v_mov_b32 v59, 0
 v_mov_b32 v60, 0
 v_mov_b32 v61, 0
 v_mov_b32 v62, 0
 v_mov_b32 v63, 0
 s_mov_b32 s97, 0x3f803f80
 s_waitcnt vmcnt(17)
 ds_read_b128 v[112:115], v20 offset:0
 ds_read_b128 v[116:119], v20 offset:2048
 ds_read_b128 v[120:123], v21 offset:0
 ds_read_b128 v[124:127], v21 offset:2048
 s_add_u32 m0, s6, 0x5000
 s_add_u32 s70, s7, 0x280
 buffer_load_dwordx4 v16, s[8:11], s70 offen lds
 buffer_load_dwordx4 v17, s[8:11], s70 offen offset:1024 lds
 buffer_load_dwordx4 v18, s[8:11], s70 offen offset:2048 lds
 buffer_load_dwordx4 v19, s[8:11], s70 offen offset:3072 lds
 s_lshl_b32 s92, s64, 2
 s_add_u32 s92, s92, s62
 s_lshl_b32 s92, s92, 16
 v_or_b32 v38, s92, v0
 s_mul_i32 s86, s63, 3
 s_mul_i32 s85, s63, 3
 s_and_b32 s4, s63, 1
 s_add_u32 s84, s85, s4
 s_lshl_b32 s4, s4, 1
 s_add_u32 s85, s85, 2
 s_sub_u32 s85, s85, s4
 s_sub_u32 s73, s85, s84
 s_lshl_b32 s73, s73, 8
 s_sub_u32 s73, s73, 0x180
 s_lshl_b32 s59, s84, 8
 s_mul_i32 s71, s62, 0x80000
 s_add_u32 s71, s71, s59
 s_lshl_b32 s72, s62, 16
 s_add_u32 s72, s72, s59
 s_add_u32 s72, s72, 0x200000
 s_lshr_b32 s3, s62, 1
 s_lshl_b32 s3, s3, 13
 s_and_b32 s4, s62, 1
 s_waitcnt vmcnt(17)
 ds_read_b128 v[128:131], v20 offset:4096
 ds_read_b128 v[132:135], v20 offset:6144
 ds_read_b128 v[136:139], v21 offset:4096
 ds_read_b128 v[140:143], v21 offset:6144
 s_add_u32 m0, s6, 0x6000
 s_add_u32 s70, s7, 0x300
 buffer_load_dwordx4 v16, s[8:11], s70 offen lds
 buffer_load_dwordx4 v17, s[8:11], s70 offen offset:1024 lds
 buffer_load_dwordx4 v18, s[8:11], s70 offen offset:2048 lds
 buffer_load_dwordx4 v19, s[8:11], s70 offen offset:3072 lds
 s_lshl_b32 s4, s4, 11
 s_add_u32 s3, s3, s4
 s_sub_u32 s3, s3, 64
 s_lshl_b32 s4, s62, 11
 s_lshr_b32 s40, s84, 1
 s_lshl_b32 s40, s40, 19
 s_add_u32 s40, s40, 0x60000
 s_add_u32 s77, s40, s4
 s_add_u32 s80, s40, s3
 s_lshr_b32 s41, s85, 1
 s_lshl_b32 s41, s41, 19
 s_add_u32 s41, s41, 0x60000
 s_add_u32 s78, s41, s4
 s_add_u32 s81, s41, s3
 s_mul_i32 s42, s63, 0x6c000
 s_mul_i32 s84, s84, 0x24000
 s_mul_i32 s85, s85, 0x24000
 s_mul_i32 s83, s62, 0x9000
 s_add_u32 s74, s83, s85
 s_add_u32 s83, s83, s84
 s_sub_u32 s74, s74, 0x12000
 s_add_u32 s93, s83, 0x36000
 s_cmp_lt_u32 s62, 2
 s_cselect_b32 s74, s93, s74
 WL 4
 v_dot2c_f32_bf16 v56, s97, v112
 v_dot2c_f32_bf16 v60, v112, v112
 v_dot2c_f32_bf16 v57, s97, v113
 v_dot2c_f32_bf16 v61, v113, v113
 v_dot2c_f32_bf16 v56, s97, v114
 v_dot2c_f32_bf16 v60, v114, v114
 v_dot2c_f32_bf16 v57, s97, v115
 v_dot2c_f32_bf16 v61, v115, v115
 v_dot2c_f32_bf16 v58, s97, v116
 v_dot2c_f32_bf16 v62, v116, v116
 v_dot2c_f32_bf16 v59, s97, v117
 v_dot2c_f32_bf16 v63, v117, v117
 v_dot2c_f32_bf16 v58, s97, v118
 v_dot2c_f32_bf16 v62, v118, v118
 v_dot2c_f32_bf16 v59, s97, v119
 v_dot2c_f32_bf16 v63, v119, v119
 v_dot2c_f32_bf16 v56, s97, v120
 v_dot2c_f32_bf16 v60, v120, v120
 v_dot2c_f32_bf16 v57, s97, v121
 v_dot2c_f32_bf16 v61, v121, v121
 v_dot2c_f32_bf16 v56, s97, v122
 v_dot2c_f32_bf16 v60, v122, v122
 v_dot2c_f32_bf16 v57, s97, v123
 v_dot2c_f32_bf16 v61, v123, v123
 v_dot2c_f32_bf16 v58, s97, v124
 v_dot2c_f32_bf16 v62, v124, v124
 v_dot2c_f32_bf16 v59, s97, v125
 v_dot2c_f32_bf16 v63, v125, v125
 v_dot2c_f32_bf16 v58, s97, v126
 v_dot2c_f32_bf16 v62, v126, v126
 v_dot2c_f32_bf16 v59, s97, v127
 v_dot2c_f32_bf16 v63, v127, v127
 s_waitcnt vmcnt(17)
 ds_read_b128 v[144:147], v20 offset:8192
 ds_read_b128 v[148:151], v20 offset:10240
 ds_read_b128 v[152:155], v21 offset:8192
 ds_read_b128 v[156:159], v21 offset:10240
 s_add_u32 m0, s6, 0x7000
 s_add_u32 s70, s7, 0x380
 buffer_load_dwordx4 v16, s[8:11], s70 offen lds
 buffer_load_dwordx4 v17, s[8:11], s70 offen offset:1024 lds
 buffer_load_dwordx4 v18, s[8:11], s70 offen offset:2048 lds
 buffer_load_dwordx4 v19, s[8:11], s70 offen offset:3072 lds
 s_lshr_b32 s3, s62, 1
 s_lshl_b32 s3, s3, 2
 s_and_b32 s4, s62, 1
 s_add_u32 s3, s3, s4
 s_mul_i32 s58, s3, 0x2400
 s_add_u32 s75, s58, s85
 s_add_u32 s75, s75, 0x12000
 s_add_u32 s58, s58, s84
 s_add_u32 s58, s58, 0x24000
 s_mov_b32 s93, s59
 v_bfe_u32 v40, v38, 16, 5
 v_and_b32 v7, 63, v38
 v_min_u32 v7, 17, v7
 v_mad_u32_u24 v7, v40, 18, v7
 s_mov_b32 s92, 0x2000
 v_mul_u32_u24 v7, s92, v7
 s_add_u32 s3, s93, 0
 s_add_u32 s93, s63, 0
 s_mul_i32 s90, s93, 0x240000
 s_lshl_b32 s93, s64, 2
 s_add_u32 s93, s93, s62
 s_mul_i32 s93, s93, 0x9000
 WL 4
 v_dot2c_f32_bf16 v56, s97, v128
 v_dot2c_f32_bf16 v60, v128, v128
 v_dot2c_f32_bf16 v57, s97, v129
 v_dot2c_f32_bf16 v61, v129, v129
 v_dot2c_f32_bf16 v56, s97, v130
 v_dot2c_f32_bf16 v60, v130, v130
 v_dot2c_f32_bf16 v57, s97, v131
 v_dot2c_f32_bf16 v61, v131, v131
 v_dot2c_f32_bf16 v58, s97, v132
 v_dot2c_f32_bf16 v62, v132, v132
 v_dot2c_f32_bf16 v59, s97, v133
 v_dot2c_f32_bf16 v63, v133, v133
 v_dot2c_f32_bf16 v58, s97, v134
 v_dot2c_f32_bf16 v62, v134, v134
 v_dot2c_f32_bf16 v59, s97, v135
 v_dot2c_f32_bf16 v63, v135, v135
 v_dot2c_f32_bf16 v56, s97, v136
 v_dot2c_f32_bf16 v60, v136, v136
 v_dot2c_f32_bf16 v57, s97, v137
 v_dot2c_f32_bf16 v61, v137, v137
 v_dot2c_f32_bf16 v56, s97, v138
 v_dot2c_f32_bf16 v60, v138, v138
 v_dot2c_f32_bf16 v57, s97, v139
 v_dot2c_f32_bf16 v61, v139, v139
 v_dot2c_f32_bf16 v58, s97, v140
 v_dot2c_f32_bf16 v62, v140, v140
 v_dot2c_f32_bf16 v59, s97, v141
 v_dot2c_f32_bf16 v63, v141, v141
 v_dot2c_f32_bf16 v58, s97, v142
 v_dot2c_f32_bf16 v62, v142, v142
 v_dot2c_f32_bf16 v59, s97, v143
 v_dot2c_f32_bf16 v63, v143, v143
 s_waitcnt vmcnt(17)
 ds_read_b128 v[160:163], v20 offset:12288
 ds_read_b128 v[164:167], v20 offset:14336
 ds_read_b128 v[168:171], v21 offset:12288
 ds_read_b128 v[172:175], v21 offset:14336
 s_add_u32 m0, s6, 0x8000
 s_add_u32 s70, s7, 0x400
 buffer_load_dwordx4 v16, s[8:11], s70 offen lds
 buffer_load_dwordx4 v17, s[8:11], s70 offen offset:1024 lds
 buffer_load_dwordx4 v18, s[8:11], s70 offen offset:2048 lds
 buffer_load_dwordx4 v19, s[8:11], s70 offen offset:3072 lds
 s_add_u32 s90, s90, s93
 s_lshl_b32 s92, s64, 14
 s_add_u32 s92, s92, 0x2f00000
 s_add_u32 s93, s63, 0
 s_lshl_b32 s93, s93, 2
 s_add_u32 s93, s93, s92
 s_cmp_eq_u32 s62, 0
 s_cselect_b32 s93, s93, 0x10000000
 s_cselect_b32 s92, s92, 0x10000000
 v_and_b32 v24, 15, v0
 v_lshlrev_b32 v25, 7, v24
 v_add_u32 v25, 0x80, v25
 v_cmp_eq_u32 vcc, 0, v24
 s_nop 1
 v_cndmask_b32 v25, v25, v24, vcc
 v_lshrrev_b32 v26, 4, v0
 v_lshl_add_u32 v25, v26, 2, v25
 v_add_u32 v25, s93, v25
 s_mov_b32 vcc_lo, 0xffff
 s_mov_b32 vcc_hi, 0
 v_mov_b32 v42, 0x10000000
 s_nop 1
 v_cndmask_b32 v42, v42, v25, vcc
 WL 4
 v_dot2c_f32_bf16 v56, s97, v144
 v_dot2c_f32_bf16 v60, v144, v144
 v_dot2c_f32_bf16 v57, s97, v145
 v_dot2c_f32_bf16 v61, v145, v145
 v_dot2c_f32_bf16 v56, s97, v146
 v_dot2c_f32_bf16 v60, v146, v146
 v_dot2c_f32_bf16 v57, s97, v147
 v_dot2c_f32_bf16 v61, v147, v147
 v_dot2c_f32_bf16 v58, s97, v148
 v_dot2c_f32_bf16 v62, v148, v148
 v_dot2c_f32_bf16 v59, s97, v149
 v_dot2c_f32_bf16 v63, v149, v149
 v_dot2c_f32_bf16 v58, s97, v150
 v_dot2c_f32_bf16 v62, v150, v150
 v_dot2c_f32_bf16 v59, s97, v151
 v_dot2c_f32_bf16 v63, v151, v151
 v_dot2c_f32_bf16 v56, s97, v152
 v_dot2c_f32_bf16 v60, v152, v152
 v_dot2c_f32_bf16 v57, s97, v153
 v_dot2c_f32_bf16 v61, v153, v153
 v_dot2c_f32_bf16 v56, s97, v154
 v_dot2c_f32_bf16 v60, v154, v154
 v_dot2c_f32_bf16 v57, s97, v155
 v_dot2c_f32_bf16 v61, v155, v155
 v_dot2c_f32_bf16 v58, s97, v156
 v_dot2c_f32_bf16 v62, v156, v156
 v_dot2c_f32_bf16 v59, s97, v157
 v_dot2c_f32_bf16 v63, v157, v157
 v_dot2c_f32_bf16 v58, s97, v158
 v_dot2c_f32_bf16 v62, v158, v158
 v_dot2c_f32_bf16 v59, s97, v159
 v_dot2c_f32_bf16 v63, v159, v159
 s_waitcnt vmcnt(17)
 ds_read_b128 v[176:179], v20 offset:16384
 ds_read_b128 v[180:183], v20 offset:18432
 ds_read_b128 v[184:187], v21 offset:16384
 ds_read_b128 v[188:191], v21 offset:18432
 v_mov_b32 v24, v42
 v_and_b32 v26, 15, v0
 v_lshlrev_b32 v26, 8, v26
 s_add_u32 s92, s92, 0x1000
 v_add_u32 v26, s92, v26
 v_mov_b32 v27, s63
 s_mov_b32 s98, 0x10795684
 s_mov_b32 s99, 50
 s_lshl_b32 s4, s63, 2
 s_lshr_b64 s[98:99], s[98:99], s4
 s_and_b32 s4, s98, 15
 s_add_u32 s4, s4, 10
 v_mov_b32 v25, s4
 v_cmp_lt_u32 vcc, 15, v0
 s_nop 1
 v_cndmask_b32 v27, v27, v25, vcc
 s_mov_b32 s98, 0xcb3a9287
 s_mov_b32 s99, 0xed
 s_lshl_b32 s4, s63, 2
 s_lshr_b64 s[98:99], s[98:99], s4
 s_and_b32 s4, s98, 15
 s_add_u32 s4, s4, 21
 v_mov_b32 v25, s4
 WL 4
 v_dot2c_f32_bf16 v56, s97, v160
 v_dot2c_f32_bf16 v60, v160, v160
 v_dot2c_f32_bf16 v57, s97, v161
 v_dot2c_f32_bf16 v61, v161, v161
 v_dot2c_f32_bf16 v56, s97, v162
 v_dot2c_f32_bf16 v60, v162, v162
 v_dot2c_f32_bf16 v57, s97, v163
 v_dot2c_f32_bf16 v61, v163, v163
 v_dot2c_f32_bf16 v58, s97, v164
 v_dot2c_f32_bf16 v62, v164, v164
 v_dot2c_f32_bf16 v59, s97, v165
 v_dot2c_f32_bf16 v63, v165, v165
 v_dot2c_f32_bf16 v58, s97, v166
 v_dot2c_f32_bf16 v62, v166, v166
 v_dot2c_f32_bf16 v59, s97, v167
 v_dot2c_f32_bf16 v63, v167, v167
 v_dot2c_f32_bf16 v56, s97, v168
 v_dot2c_f32_bf16 v60, v168, v168
 v_dot2c_f32_bf16 v57, s97, v169
 v_dot2c_f32_bf16 v61, v169, v169
 v_dot2c_f32_bf16 v56, s97, v170
 v_dot2c_f32_bf16 v60, v170, v170
 v_dot2c_f32_bf16 v57, s97, v171
 v_dot2c_f32_bf16 v61, v171, v171
 v_dot2c_f32_bf16 v58, s97, v172
 v_dot2c_f32_bf16 v62, v172, v172
 v_dot2c_f32_bf16 v59, s97, v173
 v_dot2c_f32_bf16 v63, v173, v173
 v_dot2c_f32_bf16 v58, s97, v174
 v_dot2c_f32_bf16 v62, v174, v174
 v_dot2c_f32_bf16 v59, s97, v175
 v_dot2c_f32_bf16 v63, v175, v175
 s_waitcnt vmcnt(12)
 ds_read_b128 v[192:195], v20 offset:20480
 ds_read_b128 v[196:199], v20 offset:22528
 ds_read_b128 v[200:203], v21 offset:20480
 ds_read_b128 v[204:207], v21 offset:22528
 v_cmp_lt_u32 vcc, 31, v0
 s_nop 1
 v_cndmask_b32 v27, v27, v25, vcc
 s_mov_b32 s98, 0x214ba398
 s_mov_b32 s99, 0xfe
 s_lshl_b32 s4, s63, 2
 s_lshr_b64 s[98:99], s[98:99], s4
 s_and_b32 s4, s98, 15
 s_add_u32 s4, s4, 20
 v_mov_b32 v25, s4
 v_cmp_lt_u32 vcc, 47, v0
 s_nop 1
 v_cndmask_b32 v27, v27, v25, vcc
 v_lshl_add_u32 v26, v27, 2, v26
 v_mov_b32 v25, 0
 buffer_store_dword v25, v26, s[36:39], 0 offen sc1
 v_mov_b32 v25, 0
 buffer_store_dword v25, v24, s[36:39], 0 offen sc1
 s_lshl_b32 s92, s64, 4
 s_cmp_eq_u32 s62, 0
 s_cselect_b32 s92, s92, 0x100
 v_mov_b32 v23, 0x100
 v_writelane_b32 v23, s92, 0
 v_lshrrev_b32 v24, 4, v0
 WL 4
 v_dot2c_f32_bf16 v56, s97, v176
 v_dot2c_f32_bf16 v60, v176, v176
 v_dot2c_f32_bf16 v57, s97, v177
 v_dot2c_f32_bf16 v61, v177, v177
 v_dot2c_f32_bf16 v56, s97, v178
 v_dot2c_f32_bf16 v60, v178, v178
 v_dot2c_f32_bf16 v57, s97, v179
 v_dot2c_f32_bf16 v61, v179, v179
 v_dot2c_f32_bf16 v58, s97, v180
 v_dot2c_f32_bf16 v62, v180, v180
 v_dot2c_f32_bf16 v59, s97, v181
 v_dot2c_f32_bf16 v63, v181, v181
 v_dot2c_f32_bf16 v58, s97, v182
 v_dot2c_f32_bf16 v62, v182, v182
 v_dot2c_f32_bf16 v59, s97, v183
 v_dot2c_f32_bf16 v63, v183, v183
 v_dot2c_f32_bf16 v56, s97, v184
 v_dot2c_f32_bf16 v60, v184, v184
 v_dot2c_f32_bf16 v57, s97, v185
 v_dot2c_f32_bf16 v61, v185, v185
 v_dot2c_f32_bf16 v56, s97, v186
 v_dot2c_f32_bf16 v60, v186, v186
 v_dot2c_f32_bf16 v57, s97, v187
 v_dot2c_f32_bf16 v61, v187, v187
 v_dot2c_f32_bf16 v58, s97, v188
 v_dot2c_f32_bf16 v62, v188, v188
 v_dot2c_f32_bf16 v59, s97, v189
 v_dot2c_f32_bf16 v63, v189, v189
 v_dot2c_f32_bf16 v58, s97, v190
 v_dot2c_f32_bf16 v62, v190, v190
 v_dot2c_f32_bf16 v59, s97, v191
 v_dot2c_f32_bf16 v63, v191, v191
 s_waitcnt vmcnt(10)
 ds_read_b128 v[208:211], v20 offset:24576
 ds_read_b128 v[212:215], v20 offset:26624
 ds_read_b128 v[216:219], v21 offset:24576
 ds_read_b128 v[220:223], v21 offset:26624
 v_bfe_u32 v25, v0, 2, 2
 v_and_b32 v26, 3, v0
 v_bfe_u32 v27, v0, 3, 1
 v_and_b32 v28, 7, v0
 v_bfe_u32 v29, v0, 4, 1
 v_lshlrev_b32 v29, 1, v29
 v_xor_b32 v28, v28, v29
 v_lshlrev_b32 v2, 4, v28
 v_lshrrev_b32 v28, 5, v0
 v_and_b32 v29, 3, v1
 v_lshl_add_u32 v41, v28, 4, v29
 s_mov_b32 s92, 0x440
 v_mul_u32_u24 v28, s92, v24
 v_lshl_add_u32 v28, v25, 7, v28
 v_lshl_add_u32 v28, v26, 3, v28
 v_lshl_add_u32 v9, v27, 5, v28
 v_mov_b32 v44, v9
 v_xor_b32 v10, 32, v9
 v_add_u32 v11, 0x10000, v9
 v_add_u32 v12, 0x10000, v10
 v_add_u32 v13, 0x20000, v9
 v_add_u32 v14, 0x20000, v10
 WL 4
 v_dot2c_f32_bf16 v56, s97, v192
 v_dot2c_f32_bf16 v60, v192, v192
 v_dot2c_f32_bf16 v57, s97, v193
 v_dot2c_f32_bf16 v61, v193, v193
 v_dot2c_f32_bf16 v56, s97, v194
 v_dot2c_f32_bf16 v60, v194, v194
 v_dot2c_f32_bf16 v57, s97, v195
 v_dot2c_f32_bf16 v61, v195, v195
 v_dot2c_f32_bf16 v58, s97, v196
 v_dot2c_f32_bf16 v62, v196, v196
 v_dot2c_f32_bf16 v59, s97, v197
 v_dot2c_f32_bf16 v63, v197, v197
 v_dot2c_f32_bf16 v58, s97, v198
 v_dot2c_f32_bf16 v62, v198, v198
 v_dot2c_f32_bf16 v59, s97, v199
 v_dot2c_f32_bf16 v63, v199, v199
 v_dot2c_f32_bf16 v56, s97, v200
 v_dot2c_f32_bf16 v60, v200, v200
 v_dot2c_f32_bf16 v57, s97, v201
 v_dot2c_f32_bf16 v61, v201, v201
 v_dot2c_f32_bf16 v56, s97, v202
 v_dot2c_f32_bf16 v60, v202, v202
 v_dot2c_f32_bf16 v57, s97, v203
 v_dot2c_f32_bf16 v61, v203, v203
 v_dot2c_f32_bf16 v58, s97, v204
 v_dot2c_f32_bf16 v62, v204, v204
 v_dot2c_f32_bf16 v59, s97, v205
 v_dot2c_f32_bf16 v63, v205, v205
 v_dot2c_f32_bf16 v58, s97, v206
 v_dot2c_f32_bf16 v62, v206, v206
 v_dot2c_f32_bf16 v59, s97, v207
 v_dot2c_f32_bf16 v63, v207, v207
 s_waitcnt vmcnt(6)
 ds_read_b128 v[224:227], v20 offset:28672
 ds_read_b128 v[228:231], v20 offset:30720
 ds_read_b128 v[232:235], v21 offset:28672
 ds_read_b128 v[236:239], v21 offset:30720
 v_and_b32 v28, 15, v0
 v_xor_b32 v28, v28, v24
 v_lshlrev_b32 v28, 4, v28
 v_lshl_add_u32 v8, v24, 8, v28
 s_mov_b32 s92, 0x2000
 v_mad_u32_u24 v3, v1, s92, v2
 v_add_u32 v4, 0xfbc0, v3
 v_add_u32 v5, 0xfbc0, v4
 v_add_u32 v6, 0xfbc0, v5
 v_and_b32 v28, 15, v0
 v_bfe_u32 v29, v0, 1, 3
 v_xor_b32 v29, v29, v24
 v_lshlrev_b32 v28, 7, v28
 v_add_u32 v28, s6, v28
 v_lshl_add_u32 v20, v29, 4, v28
 v_xor_b32 v21, 64, v20
 s_mov_b32 s92, 0x440
 v_mul_u32_u24 v22, s92, v25
 v_lshl_add_u32 v22, v26, 8, v22
 v_xor_b32 v28, v24, v26
 v_lshl_add_u32 v22, v28, 4, v22
 v_lshlrev_b32 v0, 4, v0
 WL 4
 v_dot2c_f32_bf16 v56, s97, v208
 v_dot2c_f32_bf16 v60, v208, v208
 v_dot2c_f32_bf16 v57, s97, v209
 v_dot2c_f32_bf16 v61, v209, v209
 v_dot2c_f32_bf16 v56, s97, v210
 v_dot2c_f32_bf16 v60, v210, v210
 v_dot2c_f32_bf16 v57, s97, v211
 v_dot2c_f32_bf16 v61, v211, v211
 v_dot2c_f32_bf16 v58, s97, v212
 v_dot2c_f32_bf16 v62, v212, v212
 v_dot2c_f32_bf16 v59, s97, v213
 v_dot2c_f32_bf16 v63, v213, v213
 v_dot2c_f32_bf16 v58, s97, v214
 v_dot2c_f32_bf16 v62, v214, v214
 v_dot2c_f32_bf16 v59, s97, v215
 v_dot2c_f32_bf16 v63, v215, v215
 v_dot2c_f32_bf16 v56, s97, v216
 v_dot2c_f32_bf16 v60, v216, v216
 v_dot2c_f32_bf16 v57, s97, v217
 v_dot2c_f32_bf16 v61, v217, v217
 v_dot2c_f32_bf16 v56, s97, v218
 v_dot2c_f32_bf16 v60, v218, v218
 v_dot2c_f32_bf16 v57, s97, v219
 v_dot2c_f32_bf16 v61, v219, v219
 v_dot2c_f32_bf16 v58, s97, v220
 v_dot2c_f32_bf16 v62, v220, v220
 v_dot2c_f32_bf16 v59, s97, v221
 v_dot2c_f32_bf16 v63, v221, v221
 v_dot2c_f32_bf16 v58, s97, v222
 v_dot2c_f32_bf16 v62, v222, v222
 v_dot2c_f32_bf16 v59, s97, v223
 v_dot2c_f32_bf16 v63, v223, v223
 s_waitcnt vmcnt(2)
 ds_read_b128 v[240:243], v20 offset:32768
 ds_read_b128 v[244:247], v20 offset:34816
 ds_read_b128 v[248:251], v21 offset:32768
 ds_read_b128 v[252:255], v21 offset:34816
 WL 4
 v_dot2c_f32_bf16 v56, s97, v224
 v_dot2c_f32_bf16 v60, v224, v224
 v_dot2c_f32_bf16 v57, s97, v225
 v_dot2c_f32_bf16 v61, v225, v225
 v_dot2c_f32_bf16 v56, s97, v226
 v_dot2c_f32_bf16 v60, v226, v226
 v_dot2c_f32_bf16 v57, s97, v227
 v_dot2c_f32_bf16 v61, v227, v227
 v_dot2c_f32_bf16 v58, s97, v228
 v_dot2c_f32_bf16 v62, v228, v228
 v_dot2c_f32_bf16 v59, s97, v229
 v_dot2c_f32_bf16 v63, v229, v229
 v_dot2c_f32_bf16 v58, s97, v230
 v_dot2c_f32_bf16 v62, v230, v230
 v_dot2c_f32_bf16 v59, s97, v231
 v_dot2c_f32_bf16 v63, v231, v231
 v_dot2c_f32_bf16 v56, s97, v232
 v_dot2c_f32_bf16 v60, v232, v232
 v_dot2c_f32_bf16 v57, s97, v233
 v_dot2c_f32_bf16 v61, v233, v233
 v_dot2c_f32_bf16 v56, s97, v234
 v_dot2c_f32_bf16 v60, v234, v234
 v_dot2c_f32_bf16 v57, s97, v235
 v_dot2c_f32_bf16 v61, v235, v235
 v_dot2c_f32_bf16 v58, s97, v236
 v_dot2c_f32_bf16 v62, v236, v236
 v_dot2c_f32_bf16 v59, s97, v237
 v_dot2c_f32_bf16 v63, v237, v237
 v_dot2c_f32_bf16 v58, s97, v238
 v_dot2c_f32_bf16 v62, v238, v238
 v_dot2c_f32_bf16 v59, s97, v239
 v_dot2c_f32_bf16 v63, v239, v239
 WL 0
 s_barrier
 s_add_u32 m0, s65, 0
 s_add_u32 s70, s71, 0
 buffer_load_dwordx4 v3, s[20:23], s70 offen lds
 buffer_load_dwordx4 v4, s[20:23], s70 offen offset:1088 lds
 buffer_load_dwordx4 v5, s[20:23], s70 offen offset:2176 lds
 v_dot2c_f32_bf16 v56, s97, v240
 v_dot2c_f32_bf16 v60, v240, v240
 v_dot2c_f32_bf16 v57, s97, v241
 v_dot2c_f32_bf16 v61, v241, v241
 v_dot2c_f32_bf16 v56, s97, v242
 v_dot2c_f32_bf16 v60, v242, v242
 v_dot2c_f32_bf16 v57, s97, v243
 v_dot2c_f32_bf16 v61, v243, v243
 v_dot2c_f32_bf16 v58, s97, v244
 v_dot2c_f32_bf16 v62, v244, v244
 v_dot2c_f32_bf16 v59, s97, v245
 v_dot2c_f32_bf16 v63, v245, v245
 v_dot2c_f32_bf16 v58, s97, v246
 v_dot2c_f32_bf16 v62, v246, v246
 v_dot2c_f32_bf16 v59, s97, v247
 v_dot2c_f32_bf16 v63, v247, v247
 v_dot2c_f32_bf16 v56, s97, v248
 v_dot2c_f32_bf16 v60, v248, v248
 v_dot2c_f32_bf16 v57, s97, v249
 v_dot2c_f32_bf16 v61, v249, v249
 v_dot2c_f32_bf16 v56, s97, v250
 v_dot2c_f32_bf16 v60, v250, v250
 v_dot2c_f32_bf16 v57, s97, v251
 v_dot2c_f32_bf16 v61, v251, v251
 v_dot2c_f32_bf16 v58, s97, v252
 v_dot2c_f32_bf16 v62, v252, v252
 v_dot2c_f32_bf16 v59, s97, v253
 v_dot2c_f32_bf16 v63, v253, v253
 v_dot2c_f32_bf16 v58, s97, v254
 v_dot2c_f32_bf16 v62, v254, v254
 v_dot2c_f32_bf16 v59, s97, v255
 v_dot2c_f32_bf16 v63, v255, v255
 AD 56,56,57
 s_nop 0
 AD 58,58,59
 AD 60,60,61
 AD 62,62,63
 v_mov_b32 v57, v56
 v_mov_b32 v59, v58
 v_mov_b32 v61, v60
 v_mov_b32 v63, v62
 v_permlane16_swap_b32 v56, v57
 v_permlane16_swap_b32 v58, v59
 v_permlane16_swap_b32 v60, v61
 v_permlane16_swap_b32 v62, v63
 AD 56,56,57
 AD 58,58,59
 AD 60,60,61
 AD 62,62,63
 v_mov_b32 v57, v56
 v_mov_b32 v59, v58
 v_mov_b32 v61, v60
 v_mov_b32 v63, v62
 v_permlane32_swap_b32 v56, v57
 v_permlane32_swap_b32 v58, v59
 v_permlane32_swap_b32 v60, v61
 v_permlane32_swap_b32 v62, v63
 AD 56,56,57
 AD 58,58,59
 AD 60,60,61
 AD 62,62,63
 v_mul_f32 v56, 0x3ae38e39, v56
 v_mul_f32 v58, 0x3ae38e39, v58
 v_mul_f32 v60, 0x3ae38e39, v60
 v_mul_f32 v62, 0x3ae38e39, v62
 v_fma_f32 v60, -v56, v56, v60
 v_fma_f32 v62, -v58, v58, v62
 v_max_f32 v60, 0, v60
 v_max_f32 v62, 0, v62
 v_add_f32 v60, 0x3727c5ac, v60
 v_add_f32 v62, 0x3727c5ac, v62
 v_rsq_f32 v60, v60
 v_rsq_f32 v62, v62
 v_mul_f32 v60, 0xbfb8aa3b, v60
 v_mul_f32 v62, 0xbfb8aa3b, v62
 v_mov_b32 v20, v56
 v_mov_b32 v21, v58
 v_mul_f32 v56, -v56, v60
 v_mul_f32 v58, -v58, v62
 s_mov_b32 s92, 0xffff0000
 v_cvt_pk_bf16_f32 v57, v60, 0
 v_cvt_pk_bf16_f32 v59, v62, 0
 v_lshlrev_b32 v61, 16, v57
 v_lshlrev_b32 v63, 16, v59
 v_mul_f32 v56, -v20, v61
 v_mul_f32 v58, -v21, v63
 v_dot2_f32_bf16 v24, v112, v57, v56
 v_dot2_f32_bf16 v25, v112, v61, v56
 v_dot2_f32_bf16 v26, v113, v57, v56
 v_dot2_f32_bf16 v27, v113, v61, v56
 v_dot2_f32_bf16 v16, v114, v57, v56
 v_dot2_f32_bf16 v17, v114, v61, v56
 v_dot2_f32_bf16 v18, v115, v57, v56
 v_dot2_f32_bf16 v19, v115, v61, v56
 CV 112,24,25
 CV 113,26,27
 CV 114,16,17
 CV 115,18,19
 buffer_load_dwordx4 v6, s[20:23], s70 offen offset:3264 lds
 v_dot2_f32_bf16 v24, v116, v59, v58
 v_dot2_f32_bf16 v25, v116, v63, v58
 v_dot2_f32_bf16 v26, v117, v59, v58
 v_dot2_f32_bf16 v27, v117, v63, v58
 v_dot2_f32_bf16 v16, v118, v59, v58
 v_dot2_f32_bf16 v17, v118, v63, v58
 v_dot2_f32_bf16 v18, v119, v59, v58
 v_dot2_f32_bf16 v19, v119, v63, v58
 CV 116,24,25
 CV 117,26,27
 CV 118,16,17
 CV 119,18,19
 s_add_u32 m0, m0, 0x1100
 s_add_u32 s70, s71, 0x40000
 buffer_load_dwordx4 v3, s[20:23], s70 offen lds
 v_dot2_f32_bf16 v24, v120, v57, v56
 v_dot2_f32_bf16 v25, v120, v61, v56
 v_dot2_f32_bf16 v26, v121, v57, v56
 v_dot2_f32_bf16 v27, v121, v61, v56
 v_dot2_f32_bf16 v16, v122, v57, v56
 v_dot2_f32_bf16 v17, v122, v61, v56
 v_dot2_f32_bf16 v18, v123, v57, v56
 v_dot2_f32_bf16 v19, v123, v61, v56
 CV 120,24,25
 CV 121,26,27
 CV 122,16,17
 CV 123,18,19
 buffer_load_dwordx4 v4, s[20:23], s70 offen offset:1088 lds
 v_dot2_f32_bf16 v24, v124, v59, v58
 v_dot2_f32_bf16 v25, v124, v63, v58
 v_dot2_f32_bf16 v26, v125, v59, v58
 v_dot2_f32_bf16 v27, v125, v63, v58
 v_dot2_f32_bf16 v16, v126, v59, v58
 v_dot2_f32_bf16 v17, v126, v63, v58
 v_dot2_f32_bf16 v18, v127, v59, v58
 v_dot2_f32_bf16 v19, v127, v63, v58
 CV 124,24,25
 CV 125,26,27
 CV 126,16,17
 CV 127,18,19
 buffer_load_dwordx4 v5, s[20:23], s70 offen offset:2176 lds
 v_dot2_f32_bf16 v24, v128, v57, v56
 v_dot2_f32_bf16 v25, v128, v61, v56
 v_dot2_f32_bf16 v26, v129, v57, v56
 v_dot2_f32_bf16 v27, v129, v61, v56
 v_dot2_f32_bf16 v16, v130, v57, v56
 v_dot2_f32_bf16 v17, v130, v61, v56
 v_dot2_f32_bf16 v18, v131, v57, v56
 v_dot2_f32_bf16 v19, v131, v61, v56
 CV 128,24,25
 CV 129,26,27
 CV 130,16,17
 CV 131,18,19
 buffer_load_dwordx4 v6, s[20:23], s70 offen offset:3264 lds
 v_dot2_f32_bf16 v24, v132, v59, v58
 v_dot2_f32_bf16 v25, v132, v63, v58
 v_dot2_f32_bf16 v26, v133, v59, v58
 v_dot2_f32_bf16 v27, v133, v63, v58
 v_dot2_f32_bf16 v16, v134, v59, v58
 v_dot2_f32_bf16 v17, v134, v63, v58
 v_dot2_f32_bf16 v18, v135, v59, v58
 v_dot2_f32_bf16 v19, v135, v63, v58
 CV 132,24,25
 CV 133,26,27
 CV 134,16,17
 CV 135,18,19
 s_add_u32 m0, s66, 0
 s_add_u32 s70, s72, 0
 buffer_load_dwordx4 v3, s[20:23], s70 offen lds
 v_dot2_f32_bf16 v24, v136, v57, v56
 v_dot2_f32_bf16 v25, v136, v61, v56
 v_dot2_f32_bf16 v26, v137, v57, v56
 v_dot2_f32_bf16 v27, v137, v61, v56
 v_dot2_f32_bf16 v16, v138, v57, v56
 v_dot2_f32_bf16 v17, v138, v61, v56
 v_dot2_f32_bf16 v18, v139, v57, v56
 v_dot2_f32_bf16 v19, v139, v61, v56
 CV 136,24,25
 CV 137,26,27
 CV 138,16,17
 CV 139,18,19
 s_add_u32 m0, s65, 0x9900
 s_add_u32 s70, s71, 0x240000
 buffer_load_dwordx4 v3, s[20:23], s70 offen lds
 v_dot2_f32_bf16 v24, v140, v59, v58
 v_dot2_f32_bf16 v25, v140, v63, v58
 v_dot2_f32_bf16 v26, v141, v59, v58
 v_dot2_f32_bf16 v27, v141, v63, v58
 v_dot2_f32_bf16 v16, v142, v59, v58
 v_dot2_f32_bf16 v17, v142, v63, v58
 v_dot2_f32_bf16 v18, v143, v59, v58
 v_dot2_f32_bf16 v19, v143, v63, v58
 CV 140,24,25
 CV 141,26,27
 CV 142,16,17
 CV 143,18,19
 buffer_load_dwordx4 v4, s[20:23], s70 offen offset:1088 lds
 v_dot2_f32_bf16 v24, v144, v57, v56
 v_dot2_f32_bf16 v25, v144, v61, v56
 v_dot2_f32_bf16 v26, v145, v57, v56
 v_dot2_f32_bf16 v27, v145, v61, v56
 v_dot2_f32_bf16 v16, v146, v57, v56
 v_dot2_f32_bf16 v17, v146, v61, v56
 v_dot2_f32_bf16 v18, v147, v57, v56
 v_dot2_f32_bf16 v19, v147, v61, v56
 CV 144,24,25
 CV 145,26,27
 CV 146,16,17
 CV 147,18,19
 buffer_load_dwordx4 v5, s[20:23], s70 offen offset:2176 lds
 v_dot2_f32_bf16 v24, v148, v59, v58
 v_dot2_f32_bf16 v25, v148, v63, v58
 v_dot2_f32_bf16 v26, v149, v59, v58
 v_dot2_f32_bf16 v27, v149, v63, v58
 v_dot2_f32_bf16 v16, v150, v59, v58
 v_dot2_f32_bf16 v17, v150, v63, v58
 v_dot2_f32_bf16 v18, v151, v59, v58
 v_dot2_f32_bf16 v19, v151, v63, v58
 CV 148,24,25
 CV 149,26,27
 CV 150,16,17
 CV 151,18,19
 buffer_load_dwordx4 v6, s[20:23], s70 offen offset:3264 lds
 v_dot2_f32_bf16 v24, v152, v57, v56
 v_dot2_f32_bf16 v25, v152, v61, v56
 v_dot2_f32_bf16 v26, v153, v57, v56
 v_dot2_f32_bf16 v27, v153, v61, v56
 v_dot2_f32_bf16 v16, v154, v57, v56
 v_dot2_f32_bf16 v17, v154, v61, v56
 v_dot2_f32_bf16 v18, v155, v57, v56
 v_dot2_f32_bf16 v19, v155, v61, v56
 CV 152,24,25
 CV 153,26,27
 CV 154,16,17
 CV 155,18,19
 s_add_u32 m0, m0, 0x1100
 s_add_u32 s70, s71, 0x280000
 buffer_load_dwordx4 v3, s[20:23], s70 offen lds
 v_dot2_f32_bf16 v24, v156, v59, v58
 v_dot2_f32_bf16 v25, v156, v63, v58
 v_dot2_f32_bf16 v26, v157, v59, v58
 v_dot2_f32_bf16 v27, v157, v63, v58
 v_dot2_f32_bf16 v16, v158, v59, v58
 v_dot2_f32_bf16 v17, v158, v63, v58
 v_dot2_f32_bf16 v18, v159, v59, v58
 v_dot2_f32_bf16 v19, v159, v63, v58
 CV 156,24,25
 CV 157,26,27
 CV 158,16,17
 CV 159,18,19
 buffer_load_dwordx4 v4, s[20:23], s70 offen offset:1088 lds
 v_dot2_f32_bf16 v24, v160, v57, v56
 v_dot2_f32_bf16 v25, v160, v61, v56
 v_dot2_f32_bf16 v26, v161, v57, v56
 v_dot2_f32_bf16 v27, v161, v61, v56
 v_dot2_f32_bf16 v16, v162, v57, v56
 v_dot2_f32_bf16 v17, v162, v61, v56
 v_dot2_f32_bf16 v18, v163, v57, v56
 v_dot2_f32_bf16 v19, v163, v61, v56
 CV 160,24,25
 CV 161,26,27
 CV 162,16,17
 CV 163,18,19
 buffer_load_dwordx4 v5, s[20:23], s70 offen offset:2176 lds
 v_dot2_f32_bf16 v24, v164, v59, v58
 v_dot2_f32_bf16 v25, v164, v63, v58
 v_dot2_f32_bf16 v26, v165, v59, v58
 v_dot2_f32_bf16 v27, v165, v63, v58
 v_dot2_f32_bf16 v16, v166, v59, v58
 v_dot2_f32_bf16 v17, v166, v63, v58
 v_dot2_f32_bf16 v18, v167, v59, v58
 v_dot2_f32_bf16 v19, v167, v63, v58
 CV 164,24,25
 CV 165,26,27
 CV 166,16,17
 CV 167,18,19
 buffer_load_dwordx4 v6, s[20:23], s70 offen offset:3264 lds
 v_dot2_f32_bf16 v24, v168, v57, v56
 v_dot2_f32_bf16 v25, v168, v61, v56
 v_dot2_f32_bf16 v26, v169, v57, v56
 v_dot2_f32_bf16 v27, v169, v61, v56
 v_dot2_f32_bf16 v16, v170, v57, v56
 v_dot2_f32_bf16 v17, v170, v61, v56
 v_dot2_f32_bf16 v18, v171, v57, v56
 v_dot2_f32_bf16 v19, v171, v61, v56
 CV 168,24,25
 CV 169,26,27
 CV 170,16,17
 CV 171,18,19
 s_add_u32 m0, s66, 0x9900
 s_add_u32 s70, s72, 0x240000
 buffer_load_dwordx4 v3, s[20:23], s70 offen lds
 v_dot2_f32_bf16 v24, v172, v59, v58
 v_dot2_f32_bf16 v25, v172, v63, v58
 v_dot2_f32_bf16 v26, v173, v59, v58
 v_dot2_f32_bf16 v27, v173, v63, v58
 v_dot2_f32_bf16 v16, v174, v59, v58
 v_dot2_f32_bf16 v17, v174, v63, v58
 v_dot2_f32_bf16 v18, v175, v59, v58
 v_dot2_f32_bf16 v19, v175, v63, v58
 CV 172,24,25
 CV 173,26,27
 CV 174,16,17
 CV 175,18,19
 s_add_u32 s3, s3, 0x80
 buffer_load_dword v47, v7, s[20:23], s3 offen
 v_dot2_f32_bf16 v24, v176, v57, v56
 v_dot2_f32_bf16 v25, v176, v61, v56
 v_dot2_f32_bf16 v26, v177, v57, v56
 v_dot2_f32_bf16 v27, v177, v61, v56
 v_dot2_f32_bf16 v16, v178, v57, v56
 v_dot2_f32_bf16 v17, v178, v61, v56
 v_dot2_f32_bf16 v18, v179, v57, v56
 v_dot2_f32_bf16 v19, v179, v61, v56
 CV 176,24,25
 CV 177,26,27
 CV 178,16,17
 CV 179,18,19
 s_add_u32 s3, s3, 0x80
 buffer_load_dword v47, v7, s[20:23], s3 offen
 v_dot2_f32_bf16 v24, v180, v59, v58
 v_dot2_f32_bf16 v25, v180, v63, v58
 v_dot2_f32_bf16 v26, v181, v59, v58
 v_dot2_f32_bf16 v27, v181, v63, v58
 v_dot2_f32_bf16 v16, v182, v59, v58
 v_dot2_f32_bf16 v17, v182, v63, v58
 v_dot2_f32_bf16 v18, v183, v59, v58
 v_dot2_f32_bf16 v19, v183, v63, v58
 CV 180,24,25
 CV 181,26,27
 CV 182,16,17
 CV 183,18,19
 v_dot2_f32_bf16 v24, v184, v57, v56
 v_dot2_f32_bf16 v25, v184, v61, v56
 v_dot2_f32_bf16 v26, v185, v57, v56
 v_dot2_f32_bf16 v27, v185, v61, v56
 v_dot2_f32_bf16 v16, v186, v57, v56
 v_dot2_f32_bf16 v17, v186, v61, v56
 v_dot2_f32_bf16 v18, v187, v57, v56
 v_dot2_f32_bf16 v19, v187, v61, v56
 CV 184,24,25
 CV 185,26,27
 CV 186,16,17
 CV 187,18,19
 v_dot2_f32_bf16 v24, v188, v59, v58
 v_dot2_f32_bf16 v25, v188, v63, v58
 v_dot2_f32_bf16 v26, v189, v59, v58
 v_dot2_f32_bf16 v27, v189, v63, v58
 v_dot2_f32_bf16 v16, v190, v59, v58
 v_dot2_f32_bf16 v17, v190, v63, v58
 v_dot2_f32_bf16 v18, v191, v59, v58
 v_dot2_f32_bf16 v19, v191, v63, v58
 CV 188,24,25
 CV 189,26,27
 CV 190,16,17
 CV 191,18,19
 v_dot2_f32_bf16 v24, v192, v57, v56
 v_dot2_f32_bf16 v25, v192, v61, v56
 v_dot2_f32_bf16 v26, v193, v57, v56
 v_dot2_f32_bf16 v27, v193, v61, v56
 v_dot2_f32_bf16 v16, v194, v57, v56
 v_dot2_f32_bf16 v17, v194, v61, v56
 v_dot2_f32_bf16 v18, v195, v57, v56
 v_dot2_f32_bf16 v19, v195, v61, v56
 CV 192,24,25
 CV 193,26,27
 CV 194,16,17
 CV 195,18,19
 v_dot2_f32_bf16 v24, v196, v59, v58
 v_dot2_f32_bf16 v25, v196, v63, v58
 v_dot2_f32_bf16 v26, v197, v59, v58
 v_dot2_f32_bf16 v27, v197, v63, v58
 v_dot2_f32_bf16 v16, v198, v59, v58
 v_dot2_f32_bf16 v17, v198, v63, v58
 v_dot2_f32_bf16 v18, v199, v59, v58
 v_dot2_f32_bf16 v19, v199, v63, v58
 CV 196,24,25
 CV 197,26,27
 CV 198,16,17
 CV 199,18,19
 v_dot2_f32_bf16 v24, v200, v57, v56
 v_dot2_f32_bf16 v25, v200, v61, v56
 v_dot2_f32_bf16 v26, v201, v57, v56
 v_dot2_f32_bf16 v27, v201, v61, v56
 v_dot2_f32_bf16 v16, v202, v57, v56
 v_dot2_f32_bf16 v17, v202, v61, v56
 v_dot2_f32_bf16 v18, v203, v57, v56
 v_dot2_f32_bf16 v19, v203, v61, v56
 CV 200,24,25
 CV 201,26,27
 CV 202,16,17
 CV 203,18,19
 v_dot2_f32_bf16 v24, v204, v59, v58
 v_dot2_f32_bf16 v25, v204, v63, v58
 v_dot2_f32_bf16 v26, v205, v59, v58
 v_dot2_f32_bf16 v27, v205, v63, v58
 v_dot2_f32_bf16 v16, v206, v59, v58
 v_dot2_f32_bf16 v17, v206, v63, v58
 v_dot2_f32_bf16 v18, v207, v59, v58
 v_dot2_f32_bf16 v19, v207, v63, v58
 CV 204,24,25
 CV 205,26,27
 CV 206,16,17
 CV 207,18,19
 v_dot2_f32_bf16 v24, v208, v57, v56
 v_dot2_f32_bf16 v25, v208, v61, v56
 v_dot2_f32_bf16 v26, v209, v57, v56
 v_dot2_f32_bf16 v27, v209, v61, v56
 v_dot2_f32_bf16 v16, v210, v57, v56
 v_dot2_f32_bf16 v17, v210, v61, v56
 v_dot2_f32_bf16 v18, v211, v57, v56
 v_dot2_f32_bf16 v19, v211, v61, v56
 CV 208,24,25
 CV 209,26,27
 CV 210,16,17
 CV 211,18,19
 v_dot2_f32_bf16 v24, v212, v59, v58
 v_dot2_f32_bf16 v25, v212, v63, v58
 v_dot2_f32_bf16 v26, v213, v59, v58
 v_dot2_f32_bf16 v27, v213, v63, v58
 v_dot2_f32_bf16 v16, v214, v59, v58
 v_dot2_f32_bf16 v17, v214, v63, v58
 v_dot2_f32_bf16 v18, v215, v59, v58
 v_dot2_f32_bf16 v19, v215, v63, v58
 CV 212,24,25
 CV 213,26,27
 CV 214,16,17
 CV 215,18,19
 v_dot2_f32_bf16 v24, v216, v57, v56
 v_dot2_f32_bf16 v25, v216, v61, v56
 v_dot2_f32_bf16 v26, v217, v57, v56
 v_dot2_f32_bf16 v27, v217, v61, v56
 v_dot2_f32_bf16 v16, v218, v57, v56
 v_dot2_f32_bf16 v17, v218, v61, v56
 v_dot2_f32_bf16 v18, v219, v57, v56
 v_dot2_f32_bf16 v19, v219, v61, v56
 CV 216,24,25
 CV 217,26,27
 CV 218,16,17
 CV 219,18,19
 v_dot2_f32_bf16 v24, v220, v59, v58
 v_dot2_f32_bf16 v25, v220, v63, v58
 v_dot2_f32_bf16 v26, v221, v59, v58
 v_dot2_f32_bf16 v27, v221, v63, v58
 v_dot2_f32_bf16 v16, v222, v59, v58
 v_dot2_f32_bf16 v17, v222, v63, v58
 v_dot2_f32_bf16 v18, v223, v59, v58
 v_dot2_f32_bf16 v19, v223, v63, v58
 CV 220,24,25
 CV 221,26,27
 CV 222,16,17
 CV 223,18,19
 v_dot2_f32_bf16 v24, v224, v57, v56
 v_dot2_f32_bf16 v25, v224, v61, v56
 v_dot2_f32_bf16 v26, v225, v57, v56
 v_dot2_f32_bf16 v27, v225, v61, v56
 v_dot2_f32_bf16 v16, v226, v57, v56
 v_dot2_f32_bf16 v17, v226, v61, v56
 v_dot2_f32_bf16 v18, v227, v57, v56
 v_dot2_f32_bf16 v19, v227, v61, v56
 CV 224,24,25
 CV 225,26,27
 CV 226,16,17
 CV 227,18,19
 v_dot2_f32_bf16 v24, v228, v59, v58
 v_dot2_f32_bf16 v25, v228, v63, v58
 v_dot2_f32_bf16 v26, v229, v59, v58
 v_dot2_f32_bf16 v27, v229, v63, v58
 v_dot2_f32_bf16 v16, v230, v59, v58
 v_dot2_f32_bf16 v17, v230, v63, v58
 v_dot2_f32_bf16 v18, v231, v59, v58
 v_dot2_f32_bf16 v19, v231, v63, v58
 CV 228,24,25
 CV 229,26,27
 CV 230,16,17
 CV 231,18,19
 v_dot2_f32_bf16 v24, v232, v57, v56
 v_dot2_f32_bf16 v25, v232, v61, v56
 v_dot2_f32_bf16 v26, v233, v57, v56
 v_dot2_f32_bf16 v27, v233, v61, v56
 v_dot2_f32_bf16 v16, v234, v57, v56
 v_dot2_f32_bf16 v17, v234, v61, v56
 v_dot2_f32_bf16 v18, v235, v57, v56
 v_dot2_f32_bf16 v19, v235, v61, v56
 CV 232,24,25
 CV 233,26,27
 CV 234,16,17
 CV 235,18,19
 v_dot2_f32_bf16 v24, v236, v59, v58
 v_dot2_f32_bf16 v25, v236, v63, v58
 v_dot2_f32_bf16 v26, v237, v59, v58
 v_dot2_f32_bf16 v27, v237, v63, v58
 v_dot2_f32_bf16 v16, v238, v59, v58
 v_dot2_f32_bf16 v17, v238, v63, v58
 v_dot2_f32_bf16 v18, v239, v59, v58
 v_dot2_f32_bf16 v19, v239, v63, v58
 CV 236,24,25
 CV 237,26,27
 CV 238,16,17
 CV 239,18,19
 v_dot2_f32_bf16 v24, v240, v57, v56
 v_dot2_f32_bf16 v25, v240, v61, v56
 v_dot2_f32_bf16 v26, v241, v57, v56
 v_dot2_f32_bf16 v27, v241, v61, v56
 v_dot2_f32_bf16 v16, v242, v57, v56
 v_dot2_f32_bf16 v17, v242, v61, v56
 v_dot2_f32_bf16 v18, v243, v57, v56
 v_dot2_f32_bf16 v19, v243, v61, v56
 CV 240,24,25
 CV 241,26,27
 CV 242,16,17
 CV 243,18,19
 v_dot2_f32_bf16 v24, v244, v59, v58
 v_dot2_f32_bf16 v25, v244, v63, v58
 v_dot2_f32_bf16 v26, v245, v59, v58
 v_dot2_f32_bf16 v27, v245, v63, v58
 v_dot2_f32_bf16 v16, v246, v59, v58
 v_dot2_f32_bf16 v17, v246, v63, v58
 v_dot2_f32_bf16 v18, v247, v59, v58
 v_dot2_f32_bf16 v19, v247, v63, v58
 CV 244,24,25
 CV 245,26,27
 CV 246,16,17
 CV 247,18,19
 v_dot2_f32_bf16 v24, v248, v57, v56
 v_dot2_f32_bf16 v25, v248, v61, v56
 v_dot2_f32_bf16 v26, v249, v57, v56
 v_dot2_f32_bf16 v27, v249, v61, v56
 v_dot2_f32_bf16 v16, v250, v57, v56
 v_dot2_f32_bf16 v17, v250, v61, v56
 v_dot2_f32_bf16 v18, v251, v57, v56
 v_dot2_f32_bf16 v19, v251, v61, v56
 CV 248,24,25
 CV 249,26,27
 CV 250,16,17
 CV 251,18,19
 v_dot2_f32_bf16 v24, v252, v59, v58
 v_dot2_f32_bf16 v25, v252, v63, v58
 v_dot2_f32_bf16 v26, v253, v59, v58
 v_dot2_f32_bf16 v27, v253, v63, v58
 v_dot2_f32_bf16 v16, v254, v59, v58
 v_dot2_f32_bf16 v17, v254, v63, v58
 v_dot2_f32_bf16 v18, v255, v59, v58
 v_dot2_f32_bf16 v19, v255, v63, v58
 CV 252,24,25
 CV 253,26,27
 CV 254,16,17
 CV 255,18,19
 v_mov_b32 v24, 1
 s_waitcnt vmcnt(20)
 buffer_atomic_add v24, v23, s[52:55], 0 offen sc1
 v_mov_b32 v32, v22
 v_add_u32 v33, 0x10000, v22
 v_add_u32 v34, 0x20000, v22
 v_lshrrev_b32 v40, 16, v38
 v_and_b32 v36, 63, v38
 v_min_u32 v36, 10, v36
 v_mad_u32_u24 v36, v40, 11, v36
 v_lshlrev_b32 v36, 7, v36
 s_mov_b32 s96, 0xbdb504f3
 s_waitcnt vmcnt(12)
 s_barrier
 RT 192,9,0
 RT 194,9,512
 RT 196,10,0
 RT 198,10,512
 RT 200,9,64
 RT 202,9,576
 RT 204,10,64
 RT 206,10,576
 RT 208,9,4352
 RT 210,9,4864
 RT 212,10,4352
 RT 214,10,4864
 RT 216,9,4416
 RT 218,9,4928
 RT 220,10,4416
 RT 222,10,4928
 WL 8
 v_mfma_f32_16x16x32_bf16 v[48:51], a[192:195], v[112:115], 0
 RT 224,9,8704
 RT 226,9,9216
 v_mfma_f32_16x16x32_bf16 v[52:55], a[192:195], v[116:119], 0
 s_add_u32 s71, s71, 0x80
 s_add_u32 s72, s72, 0x80
 v_mfma_f32_16x16x32_bf16 v[60:63], a[196:199], v[116:119], 0
 RT 228,10,8704
 RT 230,10,9216
 v_mfma_f32_16x16x32_bf16 v[56:59], a[196:199], v[112:115], 0
 s_add_u32 m0, s65, 0x13200
 s_add_u32 s70, s71, 0
 v_mfma_f32_16x16x32_bf16 v[64:67], a[200:203], v[112:115], 0
 RT 232,9,8768
 RT 234,9,9280
 v_mfma_f32_16x16x32_bf16 v[68:71], a[200:203], v[116:119], 0
 buffer_load_dwordx4 v3, s[20:23], s70 offen lds
 v_mfma_f32_16x16x32_bf16 v[76:79], a[204:207], v[116:119], 0
 WL 6
 RT 236,10,8768
 v_mfma_f32_16x16x32_bf16 v[72:75], a[204:207], v[112:115], 0
 RT 238,10,9280
 MV 48,208,120
 RT 240,9,13056
 MV 52,208,124
 RT 242,9,13568
 MV 60,212,124
 RT 244,10,13056
 RT 246,10,13568
 MV 56,212,120
 buffer_load_dwordx4 v4, s[20:23], s70 offen offset:1088 lds
 MV 64,216,120
 RT 248,9,13120
 MV 68,216,124
 RT 250,9,13632
 MV 76,220,124
 WL 6
 RT 252,10,13120
 MV 72,220,120
 RT 254,10,13632
 MV 48,224,128
 RT 192,9,17408
 RT 194,9,17920
 MV 52,224,132
 buffer_load_dwordx4 v5, s[20:23], s70 offen offset:2176 lds
 MV 60,228,132
 RT 196,10,17408
 MV 56,228,128
 RT 198,10,17920
 MV 64,232,128
 RT 200,9,17472
 MV 68,232,132
 RT 202,9,17984
 MV 76,236,132
 WL 6
 RT 204,10,17472
 RT 206,10,17984
 MV 72,236,128
 buffer_load_dwordx4 v6, s[20:23], s70 offen offset:3264 lds
 MV 48,240,136
 RT 208,9,21760
 MV 52,240,140
 RT 210,9,22272
 MV 60,244,140
 RT 212,10,21760
 MV 56,244,136
 RT 214,10,22272
 MV 64,248,136
 RT 216,9,21824
 RT 218,9,22336
 MV 68,248,140
 s_add_u32 m0, m0, 0x1100
 s_add_u32 s70, s71, 0x40000
 MV 76,252,140
 WL 6
 RT 220,10,21824
 RT 222,10,22336
 MV 72,252,136
 buffer_load_dwordx4 v3, s[20:23], s70 offen lds
 MV 48,192,144
 RT 224,9,26112
 MV 52,192,148
 RT 226,9,26624
 MV 60,196,148
 RT 228,10,26112
 MV 56,196,144
 RT 230,10,26624
 MV 64,200,144
 RT 232,9,26176
 RT 234,9,26688
 MV 68,200,148
 buffer_load_dwordx4 v4, s[20:23], s70 offen offset:1088 lds
 MV 76,204,148
 WL 6
 RT 236,10,26176
 MV 72,204,144
 RT 238,10,26688
 MV 48,208,152
 RT 240,9,30464
 MV 52,208,156
 RT 242,9,30976
 MV 60,212,156
 RT 244,10,30464
 RT 246,10,30976
 MV 56,212,152
 buffer_load_dwordx4 v5, s[20:23], s70 offen offset:2176 lds
 MV 64,216,152
 RT 248,9,30528
 MV 68,216,156
 RT 250,9,31040
 MV 76,220,156
 WL 6
 RT 252,10,30528
 MV 72,220,152
 RT 254,10,31040
 MV 48,224,160
 RT 192,9,34816
 RT 194,9,35328
 MV 52,224,164
 buffer_load_dwordx4 v6, s[20:23], s70 offen offset:3264 lds
 MV 60,228,164
 RT 196,10,34816
 MV 56,228,160
 RT 198,10,35328
 MV 64,232,160
 RT 200,9,34880
 MV 68,232,164
 RT 202,9,35392
 MV 76,236,164
 WL 6
 RT 204,10,34880
 RT 206,10,35392
 MV 72,236,160
 s_add_u32 m0, s66, 0x13200
 s_add_u32 s70, s72, 0
 MV 48,240,168
 buffer_load_dwordx4 v3, s[20:23], s70 offen lds
 s_add_u32 s3, s3, 0x80
 buffer_load_dword v47, v7, s[20:23], s3 offen
 s_waitcnt vmcnt(13)
 s_barrier
 RT 208,9,39168
 RT 210,9,39680
 MV 52,240,172
 s_add_u32 m0, s65, 0x1cb00
 s_add_u32 s70, s71, 0x240000
 MV 60,244,172
 RT 212,10,39168
 RT 214,10,39680
 MV 56,244,168
 buffer_load_dwordx4 v3, s[20:23], s70 offen lds
 MV 64,248,168
 RT 216,9,43520
 MV 68,248,172
 RT 218,9,44032
 MV 76,252,172
 WL 6
 RT 220,10,43520
 MV 72,252,168
 RT 222,10,44032
 MV 48,192,176
 RT 224,9,47872
 RT 226,9,48384
 MV 52,192,180
 buffer_load_dwordx4 v4, s[20:23], s70 offen offset:1088 lds
 MV 60,196,180
 RT 228,10,47872
 MV 56,196,176
 RT 230,10,48384
 MV 64,200,176
 RT 232,9,52224
 MV 68,200,180
 RT 234,9,52736
 MV 76,204,180
 WL 6
 RT 236,10,52224
 RT 238,10,52736
 MV 72,204,176
 buffer_load_dwordx4 v5, s[20:23], s70 offen offset:2176 lds
 MV 48,208,184
 RT 240,9,56576
 MV 52,208,188
 RT 242,9,57088
 MV 60,212,188
 RT 244,10,56576
 MV 56,212,184
 RT 246,10,57088
 MV 48,216,192
 RT 248,9,60928
 RT 250,9,61440
 MV 52,216,196
 buffer_load_dwordx4 v6, s[20:23], s70 offen offset:3264 lds
 MV 60,220,196
 WL 6
 RT 252,10,60928
 MV 56,220,192
 RT 254,10,61440
 MV 48,224,200
 RT 192,9,65280
 MV 52,224,204
 RT 194,11,256
 MV 60,228,204
 RT 196,10,65280
 RT 198,12,256
 MV 56,228,200
 s_add_u32 m0, m0, 0x1100
 s_add_u32 s70, s71, 0x280000
 MV 48,232,208
 RT 200,11,4096
 RT 202,11,4608
 MV 52,232,212
 buffer_load_dwordx4 v3, s[20:23], s70 offen lds
 MV 60,236,212
 WL 6
 RT 204,12,4096
 MV 56,236,208
 RT 206,12,4608
 MV 48,240,216
 RT 208,11,8448
 MV 52,240,220
 RT 210,11,8960
 MV 60,244,220
 RT 212,12,8448
 RT 214,12,8960
 MV 56,244,216
 buffer_load_dwordx4 v4, s[20:23], s70 offen offset:1088 lds
 MV 48,248,224
 RT 216,9,39232
 MV 52,248,228
 RT 218,9,39744
 MV 60,252,228
 WL 6
 RT 220,10,39232
 MV 56,252,224
 RT 222,10,39744
 MV 48,192,232
 RT 224,9,43584
 RT 226,9,44096
 MV 52,192,236
 buffer_load_dwordx4 v5, s[20:23], s70 offen offset:2176 lds
 MV 60,196,236
 RT 228,10,43584
 MV 56,196,232
 RT 230,10,44096
 MV 48,200,240
 RT 232,9,47936
 MV 52,200,244
 RT 234,9,48448
 MV 60,204,244
 WL 6
 RT 236,10,47936
 RT 238,10,48448
 MV 56,204,240
 buffer_load_dwordx4 v6, s[20:23], s70 offen offset:3264 lds
 MV 48,208,248
 RT 240,9,52288
 MV 52,208,252
 RT 242,9,52800
 MV 60,212,252
 RT 244,10,52288
 MV 56,212,248
 RT 246,10,52800
 MV 64,216,184
 RT 248,9,56640
 RT 250,9,57152
 MV 68,216,188
 s_add_u32 m0, s66, 0x1cb00
 s_add_u32 s70, s72, 0x240000
 MV 76,220,188
 WL 6
 RT 252,10,56640
 RT 254,10,57152
 MV 72,220,184
 buffer_load_dwordx4 v3, s[20:23], s70 offen lds
 MV 64,224,192
 RT 192,9,60992
 RT 194,9,61504
 MV 68,224,196
 v_mul_f32 v48, s96, v48
 v_mul_f32 v49, s96, v49
 MV 76,228,196
 RT 196,10,60992
 RT 198,10,61504
 MV 72,228,192
 v_mul_f32 v50, s96, v50
 v_mul_f32 v51, s96, v51
 MV 64,232,200
 RT 200,9,65344
 RT 202,11,320
 MV 68,232,204
 v_mul_f32 v56, s96, v56
 v_mul_f32 v57, s96, v57
 MV 76,236,204
 WL 6
 RT 204,10,65344
 RT 206,12,320
 MV 72,236,200
 v_mul_f32 v58, s96, v58
 v_mul_f32 v59, s96, v59
 MV 64,240,208
 RT 208,11,4160
 RT 210,11,4672
 MV 68,240,212
 CV 48,48,49
 CV 50,50,51
 MV 76,244,212
 RT 212,12,4160
 RT 214,12,4672
 MV 72,244,208
 CV 56,56,57
 CV 58,58,59
 MV 64,248,216
 RT 216,11,8512
 RT 218,11,9024
 MV 68,248,220
 v_permlane32_swap_b32 v48, v56
 v_permlane32_swap_b32 v50, v58
 MV 76,252,220
 WL 6
 RT 220,12,8512
 RT 222,12,9024
 MV 72,252,216
 v_permlane16_swap_b32 v48, v56
 v_permlane16_swap_b32 v50, v58
 MV 64,192,224
 s_waitcnt vmcnt(10)
 s_barrier
 RT 224,11,12800
 RT 226,11,13312
 MV 68,192,228
 s_add_u32 s71, s71, 0x80
 s_add_u32 s72, s72, 0x80
 MV 76,196,228
 RT 228,12,12800
 RT 230,12,13312
 MV 72,196,224
 s_add_u32 m0, s65, 0
 s_add_u32 s70, s71, 0
 MV 64,200,232
 RT 232,11,12864
 RT 234,11,13376
 MV 68,200,236
 buffer_load_dwordx4 v3, s[20:23], s70 offen lds
 MV 76,204,236
 WL 6
 RT 236,12,12864
 RT 238,12,13376
 MV 72,204,232
 MV 64,208,240
 RT 240,11,17152
 RT 242,11,17664
 MV 68,208,244
 MV 76,212,244
 RT 244,12,17152
 RT 246,12,17664
 MV 72,212,240
 buffer_load_dwordx4 v4, s[20:23], s70 offen offset:1088 lds
 MV 64,216,248
 RT 248,11,17216
 RT 250,11,17728
 MV 68,216,252
 MV 76,220,252
 WL 6
 RT 252,12,17216
 RT 254,12,17728
 MV 72,220,248
 v_mfma_f32_16x16x32_bf16 v[80:83], a[224:227], v[112:115], 0
 RT 192,11,21504
 RT 194,11,22016
 v_mfma_f32_16x16x32_bf16 v[84:87], a[224:227], v[116:119], 0
 buffer_load_dwordx4 v5, s[20:23], s70 offen offset:2176 lds
 v_mfma_f32_16x16x32_bf16 v[92:95], a[228:231], v[116:119], 0
 RT 196,12,21504
 RT 198,12,22016
 v_mfma_f32_16x16x32_bf16 v[88:91], a[228:231], v[112:115], 0
 v_mul_f32 v52, s96, v52
 v_mul_f32 v53, s96, v53
 v_mfma_f32_16x16x32_bf16 v[96:99], a[232:235], v[112:115], 0
 RT 200,11,21568
 RT 202,11,22080
 v_mfma_f32_16x16x32_bf16 v[100:103], a[232:235], v[116:119], 0
 v_mul_f32 v54, s96, v54
 v_mul_f32 v55, s96, v55
 v_mfma_f32_16x16x32_bf16 v[108:111], a[236:239], v[116:119], 0
 WL 6
 RT 204,12,21568
 RT 206,12,22080
 v_mfma_f32_16x16x32_bf16 v[104:107], a[236:239], v[112:115], 0
 buffer_load_dwordx4 v6, s[20:23], s70 offen offset:3264 lds
 MV 80,240,120
 RT 208,11,25856
 RT 210,11,26368
 MV 84,240,124
 v_mul_f32 v60, s96, v60
 v_mul_f32 v61, s96, v61
 MV 92,244,124
 RT 212,12,25856
 RT 214,12,26368
 MV 88,244,120
 v_mul_f32 v62, s96, v62
 v_mul_f32 v63, s96, v63
 MV 96,248,120
 RT 216,11,25920
 RT 218,11,26432
 MV 100,248,124
 s_add_u32 m0, m0, 0x1100
 s_add_u32 s70, s71, 0x40000
 MV 108,252,124
 WL 6
 RT 220,12,25920
 RT 222,12,26432
 MV 104,252,120
 buffer_load_dwordx4 v3, s[20:23], s70 offen lds
 MV 80,192,128
 RT 224,11,30208
 RT 226,11,30720
 MV 84,192,132
 CV 52,52,53
 CV 54,54,55
 MV 92,196,132
 RT 228,12,30208
 RT 230,12,30720
 MV 88,196,128
 CV 60,60,61
 CV 62,62,63
 MV 96,200,128
 RT 232,11,30272
 RT 234,11,30784
 MV 100,200,132
 buffer_load_dwordx4 v4, s[20:23], s70 offen offset:1088 lds
 MV 108,204,132
 WL 6
 RT 236,12,30272
 RT 238,12,30784
 MV 104,204,128
 v_permlane32_swap_b32 v52, v60
 v_permlane32_swap_b32 v54, v62
 MV 80,208,136
 RT 240,11,34560
 RT 242,11,35072
 MV 84,208,140
 v_permlane16_swap_b32 v52, v60
 v_permlane16_swap_b32 v54, v62
 MV 92,212,140
 RT 244,12,34560
 RT 246,12,35072
 MV 88,212,136
 buffer_load_dwordx4 v5, s[20:23], s70 offen offset:2176 lds
 MV 96,216,136
 RT 248,11,34624
 RT 250,11,35136
 MV 100,216,140
 v_mul_f32 v64, s96, v64
 v_mul_f32 v65, s96, v65
 MV 108,220,140
 WL 6
 RT 252,12,34624
 RT 254,12,35136
 MV 104,220,136
 v_mul_f32 v66, s96, v66
 v_mul_f32 v67, s96, v67
 MV 80,224,144
 RT 192,11,38912
 RT 194,11,39424
 MV 84,224,148
 buffer_load_dwordx4 v6, s[20:23], s70 offen offset:3264 lds
 MV 92,228,148
 RT 196,12,38912
 RT 198,12,39424
 MV 88,228,144
 v_mul_f32 v72, s96, v72
 v_mul_f32 v73, s96, v73
 MV 96,232,144
 RT 200,11,38976
 RT 202,11,39488
 MV 100,232,148
 v_mul_f32 v74, s96, v74
 v_mul_f32 v75, s96, v75
 MV 108,236,148
 WL 6
 RT 204,12,38976
 RT 206,12,39488
 MV 104,236,144
 s_add_u32 m0, s66, 0
 s_add_u32 s70, s72, 0
 MV 80,240,152
 RT 208,11,43264
 RT 210,11,43776
 MV 84,240,156
 buffer_load_dwordx4 v3, s[20:23], s70 offen lds
 MV 92,244,156
 RT 212,12,43264
 RT 214,12,43776
 MV 88,244,152
 CV 64,64,65
 CV 66,66,67
 MV 96,248,152
 RT 216,11,43328
 RT 218,11,43840
 MV 100,248,156
 CV 72,72,73
 CV 74,74,75
 MV 108,252,156
 WL 6
 RT 220,12,43328
 RT 222,12,43840
 MV 104,252,152
 s_add_u32 s3, s3, s73
 v_permlane32_swap_b32 v64, v72
 MV 80,192,160
 RT 224,11,47616
 RT 226,11,48128
 MV 84,192,164
 buffer_load_dword v47, v7, s[20:23], s3 offen
 MV 92,196,164
 RT 228,12,47616
 RT 230,12,48128
 MV 88,196,160
 v_permlane32_swap_b32 v66, v74
 v_permlane16_swap_b32 v64, v72
 MV 96,200,160
 RT 232,11,47680
 RT 234,11,48192
 MV 100,200,164
 v_permlane16_swap_b32 v66, v74
 v_mul_f32 v68, s96, v68
 MV 108,204,164
 WL 6
 RT 236,12,47680
 RT 238,12,48192
 MV 104,204,160
 v_mul_f32 v69, s96, v69
 v_mul_f32 v70, s96, v70
 MV 80,208,168
 s_waitcnt vmcnt(10)
 s_barrier
 RT 240,11,51968
 RT 242,11,52480
 MV 84,208,172
 s_add_u32 m0, s65, 0x9900
 s_add_u32 s70, s71, 0x240000
 MV 92,212,172
 RT 244,12,51968
 RT 246,12,52480
 MV 88,212,168
 buffer_load_dwordx4 v3, s[20:23], s70 offen lds
 MV 96,216,168
 RT 248,11,56320
 RT 250,11,56832
 MV 100,216,172
 v_mul_f32 v71, s96, v71
 v_mul_f32 v76, s96, v76
 MV 108,220,172
 WL 6
 RT 252,12,56320
 RT 254,12,56832
 MV 104,220,168
 v_mul_f32 v77, s96, v77
 v_mul_f32 v78, s96, v78
 MV 80,224,176
 RT 192,11,60672
 RT 194,11,61184
 MV 84,224,180
 buffer_load_dwordx4 v4, s[20:23], s70 offen offset:1088 lds
 MV 92,228,180
 RT 196,12,60672
 RT 198,12,61184
 MV 88,228,176
 v_mul_f32 v79, s96, v79
 CV 68,68,69
 MV 96,232,176
 RT 200,11,65024
 RT 202,13,0
 MV 100,232,180
 CV 70,70,71
 CV 76,76,77
 MV 108,236,180
 WL 6
 RT 204,12,65024
 RT 206,14,0
 MV 104,236,176
 buffer_load_dwordx4 v5, s[20:23], s70 offen offset:2176 lds
 MV 80,240,184
 RT 208,13,3840
 RT 210,13,4352
 MV 84,240,188
 CV 78,78,79
 v_permlane32_swap_b32 v68, v76
 MV 92,244,188
 RT 212,14,3840
 RT 214,14,4352
 MV 88,244,184
 v_permlane32_swap_b32 v70, v78
 v_permlane16_swap_b32 v68, v76
 MV 80,248,192
 RT 216,13,8192
 RT 218,13,8704
 MV 84,248,196
 buffer_load_dwordx4 v6, s[20:23], s70 offen offset:3264 lds
 MV 92,252,196
 WL 6
 RT 220,14,8192
 RT 222,14,8704
 MV 88,252,192
 v_permlane16_swap_b32 v70, v78
 MV 80,192,200
 RT 224,13,12544
 MV 84,192,204
 RT 226,13,13056
 MV 92,196,204
 RT 228,14,12544
 RT 230,14,13056
 MV 88,196,200
 s_add_u32 m0, m0, 0x1100
 s_add_u32 s70, s71, 0x280000
 MV 80,200,208
 RT 232,13,16896
 RT 234,13,17408
 MV 84,200,212
 buffer_load_dwordx4 v3, s[20:23], s70 offen lds
 MV 92,204,212
 WL 6
 RT 236,14,16896
 MV 88,204,208
 RT 238,14,17408
 MV 80,208,216
 RT 240,13,21248
 MV 84,208,220
 RT 242,13,21760
 MV 92,212,220
 RT 244,14,21248
 RT 246,14,21760
 MV 88,212,216
 buffer_load_dwordx4 v4, s[20:23], s70 offen offset:1088 lds
 MV 80,216,224
 RT 248,11,52032
 MV 84,216,228
 RT 250,11,52544
 MV 92,220,228
 WL 6
 RT 252,12,52032
 MV 88,220,224
 RT 254,12,52544
 MV 80,224,232
 RT 192,11,56384
 RT 194,11,56896
 MV 84,224,236
 buffer_load_dwordx4 v5, s[20:23], s70 offen offset:2176 lds
 MV 92,228,236
 RT 196,12,56384
 MV 88,228,232
 RT 198,12,56896
 MV 80,232,240
 RT 200,11,60736
 MV 84,232,244
 RT 202,11,61248
 MV 92,236,244
 WL 6
 RT 204,12,60736
 RT 206,12,61248
 MV 88,236,240
 buffer_load_dwordx4 v6, s[20:23], s70 offen offset:3264 lds
 MV 80,240,248
 RT 208,11,65088
 MV 84,240,252
 RT 210,13,64
 MV 92,244,252
 RT 212,12,65088
 MV 88,244,248
 RT 214,14,64
 MV 96,248,184
 RT 216,13,3904
 RT 218,13,4416
 MV 100,248,188
 s_add_u32 m0, s66, 0x9900
 s_add_u32 s70, s72, 0x240000
 MV 108,252,188
 WL 6
 RT 220,14,3904
 RT 222,14,4416
 MV 104,252,184
 buffer_load_dwordx4 v3, s[20:23], s70 offen lds
 MV 96,192,192
 RT 224,13,8256
 RT 226,13,8768
 MV 100,192,196
 v_mul_f32 v80, s96, v80
 v_mul_f32 v81, s96, v81
 MV 108,196,196
 RT 228,14,8256
 RT 230,14,8768
 MV 104,196,192
 v_mul_f32 v82, s96, v82
 v_mul_f32 v83, s96, v83
 MV 96,200,200
 RT 232,13,12608
 RT 234,13,13120
 MV 100,200,204
 v_min_u32 v39, 0x6bf80, v36
 v_add_u32 v36, 0x16000, v36
 MV 108,204,204
 WL 6
 RT 236,14,12608
 RT 238,14,13120
 MV 104,204,200
 buffer_load_dword v47, v39, s[24:27], s42 offen
 MV 96,208,208
 RT 240,13,16960
 RT 242,13,17472
 MV 100,208,212
 v_mul_f32 v88, s96, v88
 v_mul_f32 v89, s96, v89
 MV 108,212,212
 RT 244,14,16960
 RT 246,14,17472
 MV 104,212,208
 v_mul_f32 v90, s96, v90
 v_mul_f32 v91, s96, v91
 MV 96,216,216
 RT 248,13,21312
 RT 250,13,21824
 MV 100,216,220
 CV 80,80,81
 CV 82,82,83
 MV 108,220,220
 WL 6
 RT 252,14,21312
 RT 254,14,21824
 MV 104,220,216
 CV 88,88,89
 CV 90,90,91
 MV 96,224,224
 s_waitcnt vmcnt(11)
 s_barrier
 RT 192,9,0
 RT 194,9,512
 MV 100,224,228
 s_add_u32 s71, s71, 0x80
 s_add_u32 s72, s72, 0x80
 AW 0,48
 AW 1,50
 MV 108,228,228
 RT 196,10,0
 RT 198,10,512
 MV 104,228,224
 s_add_u32 m0, s65, 0x13200
 s_add_u32 s70, s71, 0
 AW 2,56
 AW 3,58
 MV 96,232,232
 RT 200,9,64
 RT 202,9,576
 MV 100,232,236
 buffer_load_dwordx4 v3, s[20:23], s70 offen lds
 AW 4,52
 AW 5,54
 MV 108,236,236
 WL 6
 RT 204,10,64
 RT 206,10,576
 MV 104,236,232
 AW 6,60
 AW 7,62
 MV 96,240,240
 RT 208,9,4352
 RT 210,9,4864
 MV 100,240,244
 AW 8,64
 AW 9,66
 MV 108,244,244
 RT 212,10,4352
 RT 214,10,4864
 MV 104,244,240
 buffer_load_dwordx4 v4, s[20:23], s70 offen offset:1088 lds
 AW 10,72
 AW 11,74
 MV 96,248,248
 RT 216,9,4416
 RT 218,9,4928
 MV 100,248,252
 AW 12,68
 AW 13,70
 MV 108,252,252
 WL 6
 RT 220,10,4416
 RT 222,10,4928
 MV 104,252,248
 AW 14,76
 AW 15,78
 v_mfma_f32_16x16x32_bf16 v[48:51], a[192:195], v[112:115], 0
 RT 224,9,8704
 RT 226,9,9216
 v_mfma_f32_16x16x32_bf16 v[52:55], a[192:195], v[116:119], 0
 buffer_load_dwordx4 v5, s[20:23], s70 offen offset:2176 lds
 v_mfma_f32_16x16x32_bf16 v[60:63], a[196:199], v[116:119], 0
 RT 228,10,8704
 RT 230,10,9216
 v_mfma_f32_16x16x32_bf16 v[56:59], a[196:199], v[112:115], 0
 v_permlane32_swap_b32 v80, v88
 v_permlane32_swap_b32 v82, v90
 v_mfma_f32_16x16x32_bf16 v[64:67], a[200:203], v[112:115], 0
 RT 232,9,8768
 RT 234,9,9280
 v_mfma_f32_16x16x32_bf16 v[68:71], a[200:203], v[116:119], 0
 v_permlane16_swap_b32 v80, v88
 v_permlane16_swap_b32 v82, v90
 v_mfma_f32_16x16x32_bf16 v[76:79], a[204:207], v[116:119], 0
 WL 6
 RT 236,10,8768
 RT 238,10,9280
 v_mfma_f32_16x16x32_bf16 v[72:75], a[204:207], v[112:115], 0
 buffer_load_dwordx4 v6, s[20:23], s70 offen offset:3264 lds
 MV 48,208,120
 RT 240,9,13056
 RT 242,9,13568
 MV 52,208,124
 v_mul_f32 v84, s96, v84
 v_mul_f32 v85, s96, v85
 MV 60,212,124
 RT 244,10,13056
 RT 246,10,13568
 MV 56,212,120
 v_mul_f32 v86, s96, v86
 v_mul_f32 v87, s96, v87
 MV 64,216,120
 RT 248,9,13120
 RT 250,9,13632
 MV 68,216,124
 s_add_u32 m0, m0, 0x1100
 s_add_u32 s70, s71, 0x40000
 MV 76,220,124
 WL 6
 RT 252,10,13120
 RT 254,10,13632
 MV 72,220,120
 buffer_load_dwordx4 v3, s[20:23], s70 offen lds
 MV 48,224,128
 RT 192,9,17408
 RT 194,9,17920
 MV 52,224,132
 v_mul_f32 v92, s96, v92
 v_mul_f32 v93, s96, v93
 MV 60,228,132
 RT 196,10,17408
 RT 198,10,17920
 MV 56,228,128
 v_mul_f32 v94, s96, v94
 v_mul_f32 v95, s96, v95
 MV 64,232,128
 RT 200,9,17472
 RT 202,9,17984
 MV 68,232,132
 buffer_load_dwordx4 v4, s[20:23], s70 offen offset:1088 lds
 MV 76,236,132
 WL 6
 RT 204,10,17472
 RT 206,10,17984
 MV 72,236,128
 CV 84,84,85
 CV 86,86,87
 MV 48,240,136
 RT 208,9,21760
 RT 210,9,22272
 MV 52,240,140
 CV 92,92,93
 CV 94,94,95
 MV 60,244,140
 RT 212,10,21760
 RT 214,10,22272
 MV 56,244,136
 buffer_load_dwordx4 v5, s[20:23], s70 offen offset:2176 lds
 MV 64,248,136
 RT 216,9,21824
 RT 218,9,22336
 MV 68,248,140
 v_permlane32_swap_b32 v84, v92
 v_permlane32_swap_b32 v86, v94
 MV 76,252,140
 WL 6
 RT 220,10,21824
 RT 222,10,22336
 MV 72,252,136
 v_permlane16_swap_b32 v84, v92
 v_permlane16_swap_b32 v86, v94
 MV 48,192,144
 RT 224,9,26112
 RT 226,9,26624
 MV 52,192,148
 buffer_load_dwordx4 v6, s[20:23], s70 offen offset:3264 lds
 MV 60,196,148
 RT 228,10,26112
 RT 230,10,26624
 MV 56,196,144
 v_mul_f32 v96, s96, v96
 v_mul_f32 v97, s96, v97
 MV 64,200,144
 RT 232,9,26176
 RT 234,9,26688
 MV 68,200,148
 v_mul_f32 v98, s96, v98
 v_mul_f32 v99, s96, v99
 MV 76,204,148
 WL 6
 RT 236,10,26176
 RT 238,10,26688
 MV 72,204,144
 s_add_u32 m0, s66, 0x13200
 s_add_u32 s70, s72, 0
 MV 48,208,152
 RT 240,9,30464
 RT 242,9,30976
 MV 52,208,156
 buffer_load_dwordx4 v3, s[20:23], s70 offen lds
 MV 60,212,156
 RT 244,10,30464
 RT 246,10,30976
 MV 56,212,152
 v_mul_f32 v104, s96, v104
 v_mul_f32 v105, s96, v105
 MV 64,216,152
 RT 248,9,30528
 RT 250,9,31040
 MV 68,216,156
 v_mul_f32 v106, s96, v106
 v_mul_f32 v107, s96, v107
 MV 76,220,156
 WL 6
 RT 252,10,30528
 RT 254,10,31040
 MV 72,220,152
 s_add_u32 s3, s3, 0x80
 CV 96,96,97
 MV 48,224,160
 RT 192,9,34816
 RT 194,9,35328
 MV 52,224,164
 buffer_load_dword v47, v7, s[20:23], s3 offen
 MV 60,228,164
 RT 196,10,34816
 RT 198,10,35328
 MV 56,228,160
 CV 98,98,99
 CV 104,104,105
 MV 64,232,160
 RT 200,9,34880
 RT 202,9,35392
 MV 68,232,164
 CV 106,106,107
 v_permlane32_swap_b32 v96, v104
 MV 76,236,164
 WL 6
 RT 204,10,34880
 RT 206,10,35392
 MV 72,236,160
 v_permlane32_swap_b32 v98, v106
 v_permlane16_swap_b32 v96, v104
 MV 48,240,168
 s_waitcnt vmcnt(11)
 s_barrier
 RT 208,9,39168
 RT 210,9,39680
 MV 52,240,172
 s_add_u32 m0, s65, 0x1cb00
 s_add_u32 s70, s71, 0x240000
 MV 60,244,172
 RT 212,10,39168
 RT 214,10,39680
 MV 56,244,168
 buffer_load_dwordx4 v3, s[20:23], s70 offen lds
 MV 64,248,168
 RT 216,9,43520
 RT 218,9,44032
 MV 68,248,172
 v_permlane16_swap_b32 v98, v106
 v_mul_f32 v100, s96, v100
 MV 76,252,172
 WL 6
 RT 220,10,43520
 RT 222,10,44032
 MV 72,252,168
 v_mul_f32 v101, s96, v101
 v_mul_f32 v102, s96, v102
 MV 48,192,176
 RT 224,9,47872
 RT 226,9,48384
 MV 52,192,180
 buffer_load_dwordx4 v4, s[20:23], s70 offen offset:1088 lds
 MV 60,196,180
 RT 228,10,47872
 RT 230,10,48384
 MV 56,196,176
 v_mul_f32 v103, s96, v103
 v_mul_f32 v108, s96, v108
 MV 64,200,176
 RT 232,9,52224
 RT 234,9,52736
 MV 68,200,180
 v_mul_f32 v109, s96, v109
 v_mul_f32 v110, s96, v110
 MV 76,204,180
 WL 6
 RT 236,10,52224
 RT 238,10,52736
 MV 72,204,176
 buffer_load_dwordx4 v5, s[20:23], s70 offen offset:2176 lds
 MV 48,208,184
 RT 240,9,56576
 RT 242,9,57088
 MV 52,208,188
 v_mul_f32 v111, s96, v111
 CV 100,100,101
 MV 60,212,188
 RT 244,10,56576
 RT 246,10,57088
 MV 56,212,184
 CV 102,102,103
 CV 108,108,109
 MV 48,216,192
 RT 248,9,60928
 RT 250,9,61440
 MV 52,216,196
 buffer_load_dwordx4 v6, s[20:23], s70 offen offset:3264 lds
 MV 60,220,196
 WL 6
 RT 252,10,60928
 RT 254,10,61440
 MV 56,220,192
 CV 110,110,111
 v_permlane32_swap_b32 v100, v108
 MV 48,224,200
 RT 192,9,65280
 RT 194,11,256
 MV 52,224,204
 v_permlane32_swap_b32 v102, v110
 v_permlane16_swap_b32 v100, v108
 MV 60,228,204
 RT 196,10,65280
 RT 198,12,256
 MV 56,228,200
 s_add_u32 m0, m0, 0x1100
 s_add_u32 s70, s71, 0x280000
 MV 48,232,208
 RT 200,11,4096
 RT 202,11,4608
 MV 52,232,212
 buffer_load_dwordx4 v3, s[20:23], s70 offen lds
 MV 60,236,212
 WL 6
 RT 204,12,4096
 RT 206,12,4608
 MV 56,236,208
 v_permlane16_swap_b32 v102, v110
 MV 48,240,216
 RT 208,11,8448
 MV 52,240,220
 RT 210,11,8960
 MV 60,244,220
 RT 212,12,8448
 RT 214,12,8960
 MV 56,244,216
 buffer_load_dwordx4 v4, s[20:23], s70 offen offset:1088 lds
 MV 48,248,224
 RT 216,9,39232
 MV 52,248,228
 RT 218,9,39744
 MV 60,252,228
 WL 6
 RT 220,10,39232
 MV 56,252,224
 RT 222,10,39744
 MV 48,192,232
 RT 224,9,43584
 RT 226,9,44096
 MV 52,192,236
 buffer_load_dwordx4 v5, s[20:23], s70 offen offset:2176 lds
 MV 60,196,236
 RT 228,10,43584
 MV 56,196,232
 RT 230,10,44096
 MV 48,200,240
 RT 232,9,47936
 MV 52,200,244
 RT 234,9,48448
 MV 60,204,244
 WL 6
 RT 236,10,47936
 RT 238,10,48448
 MV 56,204,240
 buffer_load_dwordx4 v6, s[20:23], s70 offen offset:3264 lds
 MV 48,208,248
 RT 240,9,52288
 MV 52,208,252
 RT 242,9,52800
 MV 60,212,252
 RT 244,10,52288
 MV 56,212,248
 RT 246,10,52800
 MV 64,216,184
 RT 248,9,56640
 RT 250,9,57152
 MV 68,216,188
 s_add_u32 m0, s66, 0x1cb00
 s_add_u32 s70, s72, 0x240000
 MV 76,220,188
 WL 6
 RT 252,10,56640
 RT 254,10,57152
 MV 72,220,184
 buffer_load_dwordx4 v3, s[20:23], s70 offen lds
 MV 64,224,192
 RT 192,9,60992
 RT 194,9,61504
 MV 68,224,196
 v_mul_f32 v48, s96, v48
 v_mul_f32 v49, s96, v49
 MV 76,228,196
 RT 196,10,60992
 RT 198,10,61504
 MV 72,228,192
 v_mul_f32 v50, s96, v50
 v_mul_f32 v51, s96, v51
 MV 64,232,200
 RT 200,9,65344
 RT 202,11,320
 MV 68,232,204
 v_min_u32 v39, 0x6bf80, v36
 v_add_u32 v36, 0x16000, v36
 MV 76,236,204
 WL 6
 RT 204,10,65344
 RT 206,12,320
 MV 72,236,200
 buffer_load_dword v47, v39, s[24:27], s42 offen
 MV 64,240,208
 RT 208,11,4160
 RT 210,11,4672
 MV 68,240,212
 v_mul_f32 v56, s96, v56
 v_mul_f32 v57, s96, v57
 MV 76,244,212
 RT 212,12,4160
 RT 214,12,4672
 MV 72,244,208
 v_mul_f32 v58, s96, v58
 v_mul_f32 v59, s96, v59
 MV 64,248,216
 RT 216,11,8512
 RT 218,11,9024
 MV 68,248,220
 CV 48,48,49
 CV 50,50,51
 MV 76,252,220
 WL 6
 RT 220,12,8512
 RT 222,12,9024
 MV 72,252,216
 CV 56,56,57
 CV 58,58,59
 MV 64,192,224
 s_waitcnt vmcnt(11)
 s_barrier
 RT 224,11,12800
 RT 226,11,13312
 MV 68,192,228
 s_add_u32 s71, s71, s73
 s_add_u32 s72, s72, s73
 AW 16,80
 AW 17,82
 MV 76,196,228
 RT 228,12,12800
 RT 230,12,13312
 MV 72,196,224
 s_add_u32 m0, s65, 0
 s_add_u32 s70, s71, 0
 AW 18,88
 AW 19,90
 MV 64,200,232
 RT 232,11,12864
 RT 234,11,13376
 MV 68,200,236
 buffer_load_dwordx4 v3, s[20:23], s70 offen lds
 AW 20,84
 AW 21,86
 MV 76,204,236
 WL 6
 RT 236,12,12864
 RT 238,12,13376
 MV 72,204,232
 AW 22,92
 AW 23,94
 MV 64,208,240
 RT 240,11,17152
 RT 242,11,17664
 MV 68,208,244
 AW 24,96
 AW 25,98
 MV 76,212,244
 RT 244,12,17152
 RT 246,12,17664
 MV 72,212,240
 buffer_load_dwordx4 v4, s[20:23], s70 offen offset:1088 lds
 AW 26,104
 AW 27,106
 MV 64,216,248
 RT 248,11,17216
 RT 250,11,17728
 MV 68,216,252
 AW 28,100
 AW 29,102
 MV 76,220,252
 WL 6
 RT 252,12,17216
 RT 254,12,17728
 MV 72,220,248
 AW 30,108
 AW 31,110
 v_mfma_f32_16x16x32_bf16 v[80:83], a[224:227], v[112:115], 0
 RT 192,11,21504
 RT 194,11,22016
 v_mfma_f32_16x16x32_bf16 v[84:87], a[224:227], v[116:119], 0
 buffer_load_dwordx4 v5, s[20:23], s70 offen offset:2176 lds
 v_mfma_f32_16x16x32_bf16 v[92:95], a[228:231], v[116:119], 0
 RT 196,12,21504
 RT 198,12,22016
 v_mfma_f32_16x16x32_bf16 v[88:91], a[228:231], v[112:115], 0
 v_permlane32_swap_b32 v48, v56
 v_permlane32_swap_b32 v50, v58
 v_mfma_f32_16x16x32_bf16 v[96:99], a[232:235], v[112:115], 0
 RT 200,11,21568
 RT 202,11,22080
 v_mfma_f32_16x16x32_bf16 v[100:103], a[232:235], v[116:119], 0
 v_permlane16_swap_b32 v48, v56
 v_permlane16_swap_b32 v50, v58
 v_mfma_f32_16x16x32_bf16 v[108:111], a[236:239], v[116:119], 0
 WL 6
 RT 204,12,21568
 RT 206,12,22080
 v_mfma_f32_16x16x32_bf16 v[104:107], a[236:239], v[112:115], 0
 buffer_load_dwordx4 v6, s[20:23], s70 offen offset:3264 lds
 MV 80,240,120
 RT 208,11,25856
 RT 210,11,26368
 MV 84,240,124
 v_mul_f32 v52, s96, v52
 v_mul_f32 v53, s96, v53
 MV 92,244,124
 RT 212,12,25856
 RT 214,12,26368
 MV 88,244,120
 v_mul_f32 v54, s96, v54
 v_mul_f32 v55, s96, v55
 MV 96,248,120
 RT 216,11,25920
 RT 218,11,26432
 MV 100,248,124
 s_add_u32 m0, m0, 0x1100
 s_add_u32 s70, s71, 0x40000
 MV 108,252,124
 WL 6
 RT 220,12,25920
 RT 222,12,26432
 MV 104,252,120
 buffer_load_dwordx4 v3, s[20:23], s70 offen lds
 MV 80,192,128
 RT 224,11,30208
 RT 226,11,30720
 MV 84,192,132
 v_mul_f32 v60, s96, v60
 v_mul_f32 v61, s96, v61
 MV 92,196,132
 RT 228,12,30208
 RT 230,12,30720
 MV 88,196,128
 v_mul_f32 v62, s96, v62
 v_mul_f32 v63, s96, v63
 MV 96,200,128
 RT 232,11,30272
 RT 234,11,30784
 MV 100,200,132
 buffer_load_dwordx4 v4, s[20:23], s70 offen offset:1088 lds
 MV 108,204,132
 WL 6
 RT 236,12,30272
 RT 238,12,30784
 MV 104,204,128
 CV 52,52,53
 CV 54,54,55
 MV 80,208,136
 RT 240,11,34560
 RT 242,11,35072
 MV 84,208,140
 CV 60,60,61
 CV 62,62,63
 MV 92,212,140
 RT 244,12,34560
 RT 246,12,35072
 MV 88,212,136
 buffer_load_dwordx4 v5, s[20:23], s70 offen offset:2176 lds
 MV 96,216,136
 RT 248,11,34624
 RT 250,11,35136
 MV 100,216,140
 v_permlane32_swap_b32 v52, v60
 v_permlane32_swap_b32 v54, v62
 MV 108,220,140
 WL 6
 RT 252,12,34624
 RT 254,12,35136
 MV 104,220,136
 v_permlane16_swap_b32 v52, v60
 v_permlane16_swap_b32 v54, v62
 MV 80,224,144
 RT 192,11,38912
 RT 194,11,39424
 MV 84,224,148
 buffer_load_dwordx4 v6, s[20:23], s70 offen offset:3264 lds
 MV 92,228,148
 RT 196,12,38912
 RT 198,12,39424
 MV 88,228,144
 v_mul_f32 v64, s96, v64
 v_mul_f32 v65, s96, v65
 MV 96,232,144
 RT 200,11,38976
 RT 202,11,39488
 MV 100,232,148
 v_mul_f32 v66, s96, v66
 v_mul_f32 v67, s96, v67
 MV 108,236,148
 WL 6
 RT 204,12,38976
 RT 206,12,39488
 MV 104,236,144
 s_add_u32 m0, s66, 0
 s_add_u32 s70, s72, 0
 MV 80,240,152
 RT 208,11,43264
 RT 210,11,43776
 MV 84,240,156
 buffer_load_dwordx4 v3, s[20:23], s70 offen lds
 MV 92,244,156
 RT 212,12,43264
 RT 214,12,43776
 MV 88,244,152
 v_mul_f32 v72, s96, v72
 v_mul_f32 v73, s96, v73
 MV 96,248,152
 RT 216,11,43328
 RT 218,11,43840
 MV 100,248,156
 v_mul_f32 v74, s96, v74
 v_mul_f32 v75, s96, v75
 MV 108,252,156
 WL 6
 RT 220,12,43328
 RT 222,12,43840
 MV 104,252,152
 CV 64,64,65
 CV 66,66,67
 MV 80,192,160
 RT 224,11,47616
 RT 226,11,48128
 MV 84,192,164
 CV 72,72,73
 CV 74,74,75
 MV 92,196,164
 RT 228,12,47616
 RT 230,12,48128
 MV 88,196,160
 v_permlane32_swap_b32 v64, v72
 v_permlane32_swap_b32 v66, v74
 MV 96,200,160
 RT 232,11,47680
 RT 234,11,48192
 MV 100,200,164
 v_permlane16_swap_b32 v64, v72
 v_permlane16_swap_b32 v66, v74
 MV 108,204,164
 WL 6
 RT 236,12,47680
 RT 238,12,48192
 MV 104,204,160
 v_mul_f32 v68, s96, v68
 v_mul_f32 v69, s96, v69
 MV 80,208,168
 s_waitcnt vmcnt(10)
 s_barrier
 RT 240,11,51968
 RT 242,11,52480
 MV 84,208,172
 s_add_u32 m0, s65, 0x9900
 s_add_u32 s70, s71, 0x240000
 MV 92,212,172
 RT 244,12,51968
 RT 246,12,52480
 MV 88,212,168
 buffer_load_dwordx4 v3, s[20:23], s70 offen lds
 MV 96,216,168
 RT 248,11,56320
 RT 250,11,56832
 MV 100,216,172
 v_mul_f32 v70, s96, v70
 v_mul_f32 v71, s96, v71
 MV 108,220,172
 WL 6
 RT 252,12,56320
 RT 254,12,56832
 MV 104,220,168
 v_mul_f32 v76, s96, v76
 v_mul_f32 v77, s96, v77
 MV 80,224,176
 RT 192,11,60672
 RT 194,11,61184
 MV 84,224,180
 buffer_load_dwordx4 v4, s[20:23], s70 offen offset:1088 lds
 MV 92,228,180
 RT 196,12,60672
 RT 198,12,61184
 MV 88,228,176
 v_mul_f32 v78, s96, v78
 v_mul_f32 v79, s96, v79
 MV 96,232,176
 RT 200,11,65024
 RT 202,13,0
 MV 100,232,180
 CV 68,68,69
 CV 70,70,71
 MV 108,236,180
 WL 6
 RT 204,12,65024
 RT 206,14,0
 MV 104,236,176
 buffer_load_dwordx4 v5, s[20:23], s70 offen offset:2176 lds
 MV 80,240,184
 RT 208,13,3840
 RT 210,13,4352
 MV 84,240,188
 CV 76,76,77
 CV 78,78,79
 MV 92,244,188
 RT 212,14,3840
 RT 214,14,4352
 MV 88,244,184
 v_permlane32_swap_b32 v68, v76
 v_permlane32_swap_b32 v70, v78
 MV 80,248,192
 RT 216,13,8192
 RT 218,13,8704
 MV 84,248,196
 buffer_load_dwordx4 v6, s[20:23], s70 offen offset:3264 lds
 MV 92,252,196
 WL 6
 RT 220,14,8192
 RT 222,14,8704
 MV 88,252,192
 v_permlane16_swap_b32 v68, v76
 v_permlane16_swap_b32 v70, v78
 MV 80,192,200
 RT 224,13,12544
 MV 84,192,204
 RT 226,13,13056
 MV 92,196,204
 RT 228,14,12544
 RT 230,14,13056
 MV 88,196,200
 s_add_u32 m0, m0, 0x1100
 s_add_u32 s70, s71, 0x280000
 MV 80,200,208
 RT 232,13,16896
 RT 234,13,17408
 MV 84,200,212
 buffer_load_dwordx4 v3, s[20:23], s70 offen lds
 MV 92,204,212
 WL 6
 RT 236,14,16896
 MV 88,204,208
 RT 238,14,17408
 MV 80,208,216
 RT 240,13,21248
 MV 84,208,220
 RT 242,13,21760
 MV 92,212,220
 RT 244,14,21248
 RT 246,14,21760
 MV 88,212,216
 buffer_load_dwordx4 v4, s[20:23], s70 offen offset:1088 lds
 MV 80,216,224
 RT 248,11,52032
 MV 84,216,228
 RT 250,11,52544
 MV 92,220,228
 WL 6
 RT 252,12,52032
 MV 88,220,224
 RT 254,12,52544
 MV 80,224,232
 RT 192,11,56384
 RT 194,11,56896
 MV 84,224,236
 buffer_load_dwordx4 v5, s[20:23], s70 offen offset:2176 lds
 MV 92,228,236
 RT 196,12,56384
 MV 88,228,232
 RT 198,12,56896
 MV 80,232,240
 RT 200,11,60736
 MV 84,232,244
 RT 202,11,61248
 MV 92,236,244
 WL 6
 RT 204,12,60736
 RT 206,12,61248
 MV 88,236,240
 buffer_load_dwordx4 v6, s[20:23], s70 offen offset:3264 lds
 MV 80,240,248
 RT 208,11,65088
 MV 84,240,252
 RT 210,13,64
 MV 92,244,252
 RT 212,12,65088
 MV 88,244,248
 RT 214,14,64
 MV 96,248,184
 RT 216,13,3904
 RT 218,13,4416
 MV 100,248,188
 s_add_u32 m0, s66, 0x9900
 s_add_u32 s70, s72, 0x240000
 MV 108,252,188
 WL 6
 RT 220,14,3904
 RT 222,14,4416
 MV 104,252,184
 buffer_load_dwordx4 v3, s[20:23], s70 offen lds
 MV 96,192,192
 RT 224,13,8256
 RT 226,13,8768
 MV 100,192,196
 v_mul_f32 v80, s96, v80
 v_mul_f32 v81, s96, v81
 MV 108,196,196
 RT 228,14,8256
 RT 230,14,8768
 MV 104,196,192
 v_mul_f32 v82, s96, v82
 v_mul_f32 v83, s96, v83
 MV 96,200,200
 RT 232,13,12608
 RT 234,13,13120
 MV 100,200,204
 v_min_u32 v39, 0x6bf80, v36
 v_add_u32 v36, 0x16000, v36
 MV 108,204,204
 WL 6
 RT 236,14,12608
 RT 238,14,13120
 MV 104,204,200
 buffer_load_dword v47, v39, s[24:27], s42 offen
 MV 96,208,208
 RT 240,13,16960
 RT 242,13,17472
 MV 100,208,212
 v_mul_f32 v88, s96, v88
 v_mul_f32 v89, s96, v89
 MV 108,212,212
 RT 244,14,16960
 RT 246,14,17472
 MV 104,212,208
 v_mul_f32 v90, s96, v90
 v_mul_f32 v91, s96, v91
 MV 96,216,216
 RT 248,13,21312
 RT 250,13,21824
 MV 100,216,220
 CV 80,80,81
 CV 82,82,83
 MV 108,220,220
 WL 6
 RT 252,14,21312
 RT 254,14,21824
 MV 104,220,216
 CV 88,88,89
 CV 90,90,91
 MV 96,224,224
 s_waitcnt vmcnt(10)
 s_barrier
 RT 192,9,0
 RT 194,9,512
 MV 100,224,228
 s_add_u32 s71, s71, 0x80
 s_add_u32 s72, s72, 0x80
 AW 32,48
 AW 33,50
 MV 108,228,228
 RT 196,10,0
 RT 198,10,512
 MV 104,228,224
 s_add_u32 m0, s65, 0x13200
 s_add_u32 s70, s71, 0
 AW 34,56
 AW 35,58
 MV 96,232,232
 RT 200,9,64
 RT 202,9,576
 MV 100,232,236
 buffer_load_dwordx4 v3, s[20:23], s70 offen lds
 AW 36,52
 AW 37,54
 MV 108,236,236
 WL 6
 RT 204,10,64
 RT 206,10,576
 MV 104,236,232
 AW 38,60
 AW 39,62
 MV 96,240,240
 RT 208,9,4352
 RT 210,9,4864
 MV 100,240,244
 AW 40,64
 AW 41,66
 MV 108,244,244
 RT 212,10,4352
 RT 214,10,4864
 MV 104,244,240
 buffer_load_dwordx4 v4, s[20:23], s70 offen offset:1088 lds
 AW 42,72
 AW 43,74
 MV 96,248,248
 RT 216,9,4416
 RT 218,9,4928
 MV 100,248,252
 AW 44,68
 AW 45,70
 MV 108,252,252
 WL 6
 RT 220,10,4416
 RT 222,10,4928
 MV 104,252,248
 AW 46,76
 AW 47,78
 v_mfma_f32_16x16x32_bf16 v[48:51], a[192:195], v[112:115], 0
 RT 224,9,8704
 RT 226,9,9216
 v_mfma_f32_16x16x32_bf16 v[52:55], a[192:195], v[116:119], 0
 buffer_load_dwordx4 v5, s[20:23], s70 offen offset:2176 lds
 v_mfma_f32_16x16x32_bf16 v[60:63], a[196:199], v[116:119], 0
 RT 228,10,8704
 RT 230,10,9216
 v_mfma_f32_16x16x32_bf16 v[56:59], a[196:199], v[112:115], 0
 v_permlane32_swap_b32 v80, v88
 v_permlane32_swap_b32 v82, v90
 v_mfma_f32_16x16x32_bf16 v[64:67], a[200:203], v[112:115], 0
 RT 232,9,8768
 RT 234,9,9280
 v_mfma_f32_16x16x32_bf16 v[68:71], a[200:203], v[116:119], 0
 v_permlane16_swap_b32 v80, v88
 v_permlane16_swap_b32 v82, v90
 v_mfma_f32_16x16x32_bf16 v[76:79], a[204:207], v[116:119], 0
 WL 6
 RT 236,10,8768
 RT 238,10,9280
 v_mfma_f32_16x16x32_bf16 v[72:75], a[204:207], v[112:115], 0
 buffer_load_dwordx4 v6, s[20:23], s70 offen offset:3264 lds
 MV 48,208,120
 RT 240,9,13056
 RT 242,9,13568
 MV 52,208,124
 v_mul_f32 v84, s96, v84
 v_mul_f32 v85, s96, v85
 MV 60,212,124
 RT 244,10,13056
 RT 246,10,13568
 MV 56,212,120
 v_mul_f32 v86, s96, v86
 v_mul_f32 v87, s96, v87
 MV 64,216,120
 RT 248,9,13120
 RT 250,9,13632
 MV 68,216,124
 s_add_u32 m0, m0, 0x1100
 s_add_u32 s70, s71, 0x40000
 MV 76,220,124
 WL 6
 RT 252,10,13120
 RT 254,10,13632
 MV 72,220,120
 buffer_load_dwordx4 v3, s[20:23], s70 offen lds
 MV 48,224,128
 RT 192,9,17408
 RT 194,9,17920
 MV 52,224,132
 v_mul_f32 v92, s96, v92
 v_mul_f32 v93, s96, v93
 MV 60,228,132
 RT 196,10,17408
 RT 198,10,17920
 MV 56,228,128
 v_mul_f32 v94, s96, v94
 v_mul_f32 v95, s96, v95
 MV 64,232,128
 RT 200,9,17472
 RT 202,9,17984
 MV 68,232,132
 buffer_load_dwordx4 v4, s[20:23], s70 offen offset:1088 lds
 MV 76,236,132
 WL 6
 RT 204,10,17472
 RT 206,10,17984
 MV 72,236,128
 CV 84,84,85
 CV 86,86,87
 MV 48,240,136
 RT 208,9,21760
 RT 210,9,22272
 MV 52,240,140
 CV 92,92,93
 CV 94,94,95
 MV 60,244,140
 RT 212,10,21760
 RT 214,10,22272
 MV 56,244,136
 buffer_load_dwordx4 v5, s[20:23], s70 offen offset:2176 lds
 MV 64,248,136
 RT 216,9,21824
 RT 218,9,22336
 MV 68,248,140
 v_permlane32_swap_b32 v84, v92
 v_permlane32_swap_b32 v86, v94
 MV 76,252,140
 WL 6
 RT 220,10,21824
 RT 222,10,22336
 MV 72,252,136
 v_permlane16_swap_b32 v84, v92
 v_permlane16_swap_b32 v86, v94
 MV 48,192,144
 RT 224,9,26112
 RT 226,9,26624
 MV 52,192,148
 buffer_load_dwordx4 v6, s[20:23], s70 offen offset:3264 lds
 MV 60,196,148
 RT 228,10,26112
 RT 230,10,26624
 MV 56,196,144
 v_mul_f32 v96, s96, v96
 v_mul_f32 v97, s96, v97
 MV 64,200,144
 RT 232,9,26176
 RT 234,9,26688
 MV 68,200,148
 v_mul_f32 v98, s96, v98
 v_mul_f32 v99, s96, v99
 MV 76,204,148
 WL 6
 RT 236,10,26176
 RT 238,10,26688
 MV 72,204,144
 s_add_u32 m0, s66, 0x13200
 s_add_u32 s70, s72, 0
 MV 48,208,152
 RT 240,9,30464
 RT 242,9,30976
 MV 52,208,156
 buffer_load_dwordx4 v3, s[20:23], s70 offen lds
 MV 60,212,156
 RT 244,10,30464
 RT 246,10,30976
 MV 56,212,152
 v_mul_f32 v104, s96, v104
 v_mul_f32 v105, s96, v105
 MV 64,216,152
 RT 248,9,30528
 RT 250,9,31040
 MV 68,216,156
 v_mul_f32 v106, s96, v106
 v_mul_f32 v107, s96, v107
 MV 76,220,156
 WL 6
 RT 252,10,30528
 RT 254,10,31040
 MV 72,220,152
 CV 96,96,97
 CV 98,98,99
 MV 48,224,160
 RT 192,9,34816
 RT 194,9,35328
 MV 52,224,164
 CV 104,104,105
 CV 106,106,107
 MV 60,228,164
 RT 196,10,34816
 RT 198,10,35328
 MV 56,228,160
 v_permlane32_swap_b32 v96, v104
 v_permlane32_swap_b32 v98, v106
 MV 64,232,160
 RT 200,9,34880
 RT 202,9,35392
 MV 68,232,164
 v_permlane16_swap_b32 v96, v104
 v_permlane16_swap_b32 v98, v106
 MV 76,236,164
 WL 6
 RT 204,10,34880
 RT 206,10,35392
 MV 72,236,160
 v_mul_f32 v100, s96, v100
 v_mul_f32 v101, s96, v101
 MV 48,240,168
 s_waitcnt vmcnt(10)
 s_barrier
 RT 208,9,39168
 RT 210,9,39680
 MV 52,240,172
 s_add_u32 m0, s65, 0x1cb00
 s_add_u32 s70, s71, 0x240000
 MV 60,244,172
 RT 212,10,39168
 RT 214,10,39680
 MV 56,244,168
 buffer_load_dwordx4 v3, s[20:23], s70 offen lds
 MV 64,248,168
 RT 216,9,43520
 RT 218,9,44032
 MV 68,248,172
 v_mul_f32 v102, s96, v102
 v_mul_f32 v103, s96, v103
 MV 76,252,172
 WL 6
 RT 220,10,43520
 RT 222,10,44032
 MV 72,252,168
 v_mul_f32 v108, s96, v108
 v_mul_f32 v109, s96, v109
 MV 48,192,176
 RT 224,9,47872
 RT 226,9,48384
 MV 52,192,180
 buffer_load_dwordx4 v4, s[20:23], s70 offen offset:1088 lds
 MV 60,196,180
 RT 228,10,47872
 RT 230,10,48384
 MV 56,196,176
 v_mul_f32 v110, s96, v110
 v_mul_f32 v111, s96, v111
 MV 64,200,176
 RT 232,9,52224
 RT 234,9,52736
 MV 68,200,180
 CV 100,100,101
 CV 102,102,103
 MV 76,204,180
 WL 6
 RT 236,10,52224
 RT 238,10,52736
 MV 72,204,176
 buffer_load_dwordx4 v5, s[20:23], s70 offen offset:2176 lds
 MV 48,208,184
 RT 240,9,56576
 RT 242,9,57088
 MV 52,208,188
 CV 108,108,109
 CV 110,110,111
 MV 60,212,188
 RT 244,10,56576
 RT 246,10,57088
 MV 56,212,184
 v_permlane32_swap_b32 v100, v108
 v_permlane32_swap_b32 v102, v110
 MV 48,216,192
 RT 248,9,60928
 RT 250,9,61440
 MV 52,216,196
 buffer_load_dwordx4 v6, s[20:23], s70 offen offset:3264 lds
 MV 60,220,196
 WL 6
 RT 252,10,60928
 RT 254,10,61440
 MV 56,220,192
 v_permlane16_swap_b32 v100, v108
 v_permlane16_swap_b32 v102, v110
 MV 48,224,200
 RT 192,9,65280
 MV 52,224,204
 RT 194,11,256
 MV 60,228,204
 RT 196,10,65280
 RT 198,12,256
 MV 56,228,200
 s_add_u32 m0, m0, 0x1100
 s_add_u32 s70, s71, 0x280000
 MV 48,232,208
 RT 200,11,4096
 RT 202,11,4608
 MV 52,232,212
 buffer_load_dwordx4 v3, s[20:23], s70 offen lds
 MV 60,236,212
 WL 6
 RT 204,12,4096
 MV 56,236,208
 RT 206,12,4608
 MV 48,240,216
 RT 208,11,8448
 MV 52,240,220
 RT 210,11,8960
 MV 60,244,220
 RT 212,12,8448
 RT 214,12,8960
 MV 56,244,216
 buffer_load_dwordx4 v4, s[20:23], s70 offen offset:1088 lds
 MV 48,248,224
 RT 216,9,39232
 MV 52,248,228
 RT 218,9,39744
 MV 60,252,228
 WL 6
 RT 220,10,39232
 MV 56,252,224
 RT 222,10,39744
 MV 48,192,232
 RT 224,9,43584
 RT 226,9,44096
 MV 52,192,236
 buffer_load_dwordx4 v5, s[20:23], s70 offen offset:2176 lds
 MV 60,196,236
 RT 228,10,43584
 MV 56,196,232
 RT 230,10,44096
 MV 48,200,240
 RT 232,9,47936
 MV 52,200,244
 RT 234,9,48448
 MV 60,204,244
 WL 6
 RT 236,10,47936
 RT 238,10,48448
 MV 56,204,240
 buffer_load_dwordx4 v6, s[20:23], s70 offen offset:3264 lds
 MV 48,208,248
 RT 240,9,52288
 MV 52,208,252
 RT 242,9,52800
 MV 60,212,252
 RT 244,10,52288
 MV 56,212,248
 RT 246,10,52800
 MV 64,216,184
 RT 248,9,56640
 RT 250,9,57152
 MV 68,216,188
 s_add_u32 m0, s66, 0x1cb00
 s_add_u32 s70, s72, 0x240000
 MV 76,220,188
 WL 6
 RT 252,10,56640
 RT 254,10,57152
 MV 72,220,184
 buffer_load_dwordx4 v3, s[20:23], s70 offen lds
 MV 64,224,192
 RT 192,9,60992
 RT 194,9,61504
 MV 68,224,196
 v_mul_f32 v48, s96, v48
 v_mul_f32 v49, s96, v49
 MV 76,228,196
 RT 196,10,60992
 RT 198,10,61504
 MV 72,228,192
 v_mul_f32 v50, s96, v50
 v_mul_f32 v51, s96, v51
 MV 64,232,200
 RT 200,9,65344
 RT 202,11,320
 MV 68,232,204
 v_min_u32 v39, 0x6bf80, v36
 v_add_u32 v36, 0x16000, v36
 MV 76,236,204
 WL 6
 RT 204,10,65344
 RT 206,12,320
 MV 72,236,200
 buffer_load_dword v47, v39, s[24:27], s42 offen
 MV 64,240,208
 RT 208,11,4160
 RT 210,11,4672
 MV 68,240,212
 v_mul_f32 v56, s96, v56
 v_mul_f32 v57, s96, v57
 MV 76,244,212
 RT 212,12,4160
 RT 214,12,4672
 MV 72,244,208
 v_mul_f32 v58, s96, v58
 v_mul_f32 v59, s96, v59
 MV 64,248,216
 RT 216,11,8512
 RT 218,11,9024
 MV 68,248,220
 CV 48,48,49
 CV 50,50,51
 MV 76,252,220
 WL 6
 RT 220,12,8512
 RT 222,12,9024
 MV 72,252,216
 CV 56,56,57
 CV 58,58,59
 MV 64,192,224
 s_waitcnt vmcnt(10)
 s_barrier
 RT 224,11,12800
 RT 226,11,13312
 MV 68,192,228
 s_mov_b32 s92, 0x100
 v_mad_u32_u24 v3, v41, s92, v2
 v_mov_b32 v4, v3
 v_add_u32 v3, 64, v3
 AW 48,80
 AW 49,82
 MV 76,196,228
 RT 228,12,12800
 RT 230,12,13312
 MV 72,196,224
 s_add_u32 m0, s69, 0
 s_add_u32 s70, s77, 0
 AW 50,88
 AW 51,90
 MV 64,200,232
 RT 232,11,12864
 RT 234,11,13376
 MV 68,200,236
 buffer_load_dwordx4 v8, s[12:15], s70 offen lds
 AW 52,84
 AW 53,86
 MV 76,204,236
 WL 6
 RT 236,12,12864
 RT 238,12,13376
 MV 72,204,232
 AW 54,92
 AW 55,94
 MV 64,208,240
 RT 240,11,17152
 RT 242,11,17664
 MV 68,208,244
 AW 56,96
 AW 57,98
 MV 76,212,244
 RT 244,12,17152
 RT 246,12,17664
 MV 72,212,240
 s_add_u32 m0, m0, 64
 AW 58,104
 AW 59,106
 MV 64,216,248
 RT 248,11,17216
 RT 250,11,17728
 MV 68,216,252
 buffer_load_dwordx4 v8, s[12:15], s70 offen offset:1024 lds
 AW 60,100
 AW 61,102
 MV 76,220,252
 WL 6
 RT 252,12,17216
 RT 254,12,17728
 MV 72,220,248
 AW 62,108
 AW 63,110
 v_mfma_f32_16x16x32_bf16 v[80:83], a[224:227], v[112:115], 0
 RT 192,11,21504
 RT 194,11,22016
 v_mfma_f32_16x16x32_bf16 v[84:87], a[224:227], v[116:119], 0
 v_permlane32_swap_b32 v48, v56
 v_permlane32_swap_b32 v50, v58
 v_mfma_f32_16x16x32_bf16 v[92:95], a[228:231], v[116:119], 0
 RT 196,12,21504
 RT 198,12,22016
 v_mfma_f32_16x16x32_bf16 v[88:91], a[228:231], v[112:115], 0
 v_lshrrev_b32 v40, 16, v38
 v_and_b32 v39, 63, v38
 v_min_u32 v39, 15, v39
 v_mad_u32_u24 v39, v40, 16, v39
 v_lshlrev_b32 v39, 7, v39
 v_add_u32 v39, 0, v39
 v_min_u32 v39, 0x1ff80, v39
 v_mfma_f32_16x16x32_bf16 v[96:99], a[232:235], v[112:115], 0
 RT 200,11,21568
 RT 202,11,22080
 v_mfma_f32_16x16x32_bf16 v[100:103], a[232:235], v[116:119], 0
 buffer_load_dword v47, v39, s[12:15], s40 offen
 v_mfma_f32_16x16x32_bf16 v[108:111], a[236:239], v[116:119], 0
 WL 6
 RT 204,12,21568
 RT 206,12,22080
 v_mfma_f32_16x16x32_bf16 v[104:107], a[236:239], v[112:115], 0
 v_permlane16_swap_b32 v48, v56
 v_permlane16_swap_b32 v50, v58
 MV 80,240,120
 RT 208,11,25856
 RT 210,11,26368
 MV 84,240,124
 v_mul_f32 v52, s96, v52
 v_mul_f32 v53, s96, v53
 MV 92,244,124
 RT 212,12,25856
 RT 214,12,26368
 MV 88,244,120
 v_lshrrev_b32 v40, 16, v38
 v_and_b32 v39, 63, v38
 v_min_u32 v39, 15, v39
 v_mad_u32_u24 v39, v40, 16, v39
 v_lshlrev_b32 v39, 7, v39
 v_add_u32 v39, 0, v39
 v_min_u32 v39, 0x1ff80, v39
 MV 96,248,120
 RT 216,11,25920
 RT 218,11,26432
 MV 100,248,124
 buffer_load_dword v47, v39, s[16:19], s40 offen
 MV 108,252,124
 WL 6
 RT 220,12,25920
 RT 222,12,26432
 MV 104,252,120
 v_mul_f32 v54, s96, v54
 v_mul_f32 v55, s96, v55
 MV 80,192,128
 RT 224,11,30208
 RT 226,11,30720
 MV 84,192,132
 v_mul_f32 v60, s96, v60
 v_mul_f32 v61, s96, v61
 MV 92,196,132
 RT 228,12,30208
 RT 230,12,30720
 MV 88,196,128
 v_mul_f32 v62, s96, v62
 v_mul_f32 v63, s96, v63
 MV 96,200,128
 RT 232,11,30272
 RT 234,11,30784
 MV 100,200,132
 CV 52,52,53
 CV 54,54,55
 MV 108,204,132
 WL 6
 RT 236,12,30272
 RT 238,12,30784
 MV 104,204,128
 CV 60,60,61
 CV 62,62,63
 MV 80,208,136
 RT 240,11,34560
 RT 242,11,35072
 MV 84,208,140
 v_permlane32_swap_b32 v52, v60
 v_permlane32_swap_b32 v54, v62
 MV 92,212,140
 RT 244,12,34560
 RT 246,12,35072
 MV 88,212,136
 v_permlane16_swap_b32 v52, v60
 v_permlane16_swap_b32 v54, v62
 MV 96,216,136
 RT 248,11,34624
 RT 250,11,35136
 MV 100,216,140
 v_mul_f32 v64, s96, v64
 v_mul_f32 v65, s96, v65
 MV 108,220,140
 WL 6
 RT 252,12,34624
 RT 254,12,35136
 MV 104,220,136
 v_mul_f32 v66, s96, v66
 v_mul_f32 v67, s96, v67
 MV 80,224,144
 RT 192,11,38912
 RT 194,11,39424
 MV 84,224,148
 v_mul_f32 v72, s96, v72
 v_mul_f32 v73, s96, v73
 MV 92,228,148
 RT 196,12,38912
 RT 198,12,39424
 MV 88,228,144
 v_mul_f32 v74, s96, v74
 v_mul_f32 v75, s96, v75
 MV 96,232,144
 RT 200,11,38976
 RT 202,11,39488
 MV 100,232,148
 CV 64,64,65
 CV 66,66,67
 MV 108,236,148
 WL 6
 RT 204,12,38976
 RT 206,12,39488
 MV 104,236,144
 CV 72,72,73
 CV 74,74,75
 MV 80,240,152
 RT 208,11,43264
 RT 210,11,43776
 MV 84,240,156
 v_permlane32_swap_b32 v64, v72
 v_permlane32_swap_b32 v66, v74
 MV 92,244,156
 RT 212,12,43264
 RT 214,12,43776
 MV 88,244,152
 v_permlane16_swap_b32 v64, v72
 v_permlane16_swap_b32 v66, v74
 MV 96,248,152
 RT 216,11,43328
 RT 218,11,43840
 MV 100,248,156
 v_mul_f32 v68, s96, v68
 v_mul_f32 v69, s96, v69
 MV 108,252,156
 WL 6
 RT 220,12,43328
 RT 222,12,43840
 MV 104,252,152
 v_mul_f32 v70, s96, v70
 v_mul_f32 v71, s96, v71
 MV 80,192,160
 RT 224,11,47616
 RT 226,11,48128
 MV 84,192,164
 v_mul_f32 v76, s96, v76
 v_mul_f32 v77, s96, v77
 MV 92,196,164
 RT 228,12,47616
 RT 230,12,48128
 MV 88,196,160
 v_mul_f32 v78, s96, v78
 v_mul_f32 v79, s96, v79
 MV 96,200,160
 RT 232,11,47680
 RT 234,11,48192
 MV 100,200,164
 CV 68,68,69
 CV 70,70,71
 MV 108,204,164
 WL 6
 RT 236,12,47680
 RT 238,12,48192
 MV 104,204,160
 CV 76,76,77
 CV 78,78,79
 MV 80,208,168
 s_waitcnt vmcnt(5)
 s_barrier
 RT 240,11,51968
 RT 242,11,52480
 MV 84,208,172
 s_add_u32 m0, s69, 0x9900
 s_add_u32 s70, s77, 0x2000
 MV 92,212,172
 RT 244,12,51968
 RT 246,12,52480
 MV 88,212,168
 buffer_load_dwordx4 v8, s[12:15], s70 offen lds
 MV 96,216,168
 RT 248,11,56320
 RT 250,11,56832
 MV 100,216,172
 v_permlane32_swap_b32 v68, v76
 v_permlane32_swap_b32 v70, v78
 MV 108,220,172
 WL 6
 RT 252,12,56320
 RT 254,12,56832
 MV 104,220,168
 v_permlane16_swap_b32 v68, v76
 v_permlane16_swap_b32 v70, v78
 MV 80,224,176
 RT 192,11,60672
 RT 194,11,61184
 MV 84,224,180
 s_add_u32 m0, m0, 64
 MV 92,228,180
 RT 196,12,60672
 RT 198,12,61184
 MV 88,228,176
 buffer_load_dwordx4 v8, s[12:15], s70 offen offset:1024 lds
 MV 96,232,176
 RT 200,11,65024
 MV 100,232,180
 RT 202,13,0
 MV 108,236,180
 WL 6
 RT 204,12,65024
 MV 104,236,176
 RT 206,14,0
 MV 80,240,184
 RT 208,13,3840
 RT 210,13,4352
 MV 84,240,188
 s_add_u32 m0, s69, 0xbb00
 s_add_u32 s70, s77, 0x4000
 MV 92,244,188
 RT 212,14,3840
 RT 214,14,4352
 MV 88,244,184
 buffer_load_dwordx4 v8, s[12:15], s70 offen lds
 MV 80,248,192
 RT 216,13,8192
 MV 84,248,196
 RT 218,13,8704
 MV 92,252,196
 WL 6
 RT 220,14,8192
 MV 88,252,192
 RT 222,14,8704
 MV 80,192,200
 RT 224,13,12544
 RT 226,13,13056
 MV 84,192,204
 s_add_u32 m0, m0, 64
 MV 92,196,204
 RT 228,14,12544
 RT 230,14,13056
 MV 88,196,200
 buffer_load_dwordx4 v8, s[12:15], s70 offen offset:1024 lds
 MV 80,200,208
 RT 232,13,16896
 MV 84,200,212
 RT 234,13,17408
 MV 92,204,212
 WL 6
 RT 236,14,16896
 MV 88,204,208
 RT 238,14,17408
 MV 80,208,216
 RT 240,13,21248
 RT 242,13,21760
 MV 84,208,220
 s_add_u32 m0, s69, 0xdd00
 s_add_u32 s70, s80, 0
 MV 92,212,220
 RT 244,14,21248
 RT 246,14,21760
 MV 88,212,216
 buffer_load_dwordx4 v3, s[16:19], s70 offen lds
 MV 80,216,224
 RT 248,11,52032
 MV 84,216,228
 RT 250,11,52544
 MV 92,220,228
 WL 6
 RT 252,12,52032
 MV 88,220,224
 RT 254,12,52544
 MV 80,224,232
 RT 192,11,56384
 RT 194,11,56896
 MV 84,224,236
 buffer_load_dwordx4 v4, s[16:19], s70 offen offset:1088 lds
 MV 92,228,236
 RT 196,12,56384
 MV 88,228,232
 RT 198,12,56896
 MV 80,232,240
 RT 200,11,60736
 MV 84,232,244
 RT 202,11,61248
 MV 92,236,244
 WL 6
 RT 204,12,60736
 RT 206,12,61248
 MV 88,236,240
 s_add_u32 m0, s69, 0xff00
 s_add_u32 s70, s80, 0x80
 MV 80,240,248
 RT 208,11,65088
 RT 210,13,64
 MV 84,240,252
 buffer_load_dwordx4 v3, s[16:19], s70 offen lds
 MV 92,244,252
 RT 212,12,65088
 MV 88,244,248
 RT 214,14,64
 MV 96,248,184
 RT 216,13,3904
 RT 218,13,4416
 MV 100,248,188
 v_mul_f32 v80, s96, v80
 v_mul_f32 v81, s96, v81
 v_mul_f32 v82, s96, v82
 MV 108,252,188
 WL 6
 RT 220,14,3904
 RT 222,14,4416
 MV 104,252,184
 buffer_load_dwordx4 v4, s[16:19], s70 offen offset:1088 lds
 v_mul_f32 v83, s96, v83
 v_mul_f32 v88, s96, v88
 v_mul_f32 v89, s96, v89
 MV 96,192,192
 RT 224,13,8256
 RT 226,13,8768
 MV 100,192,196
 v_mul_f32 v90, s96, v90
 v_mul_f32 v91, s96, v91
 CV 80,80,81
 MV 108,196,196
 RT 228,14,8256
 RT 230,14,8768
 MV 104,196,192
 CV 82,82,83
 CV 88,88,89
 CV 90,90,91
 MV 96,200,200
 RT 232,13,12608
 RT 234,13,13120
 MV 100,200,204
 v_min_u32 v39, 0x6bf80, v36
 v_add_u32 v36, 0x16000, v36
 v_permlane32_swap_b32 v80, v88
 v_permlane32_swap_b32 v82, v90
 MV 108,204,204
 WL 6
 RT 236,14,12608
 RT 238,14,13120
 MV 104,204,200
 buffer_load_dword v47, v39, s[24:27], s42 offen
 v_permlane16_swap_b32 v80, v88
 v_permlane16_swap_b32 v82, v90
 MV 96,208,208
 RT 240,13,16960
 RT 242,13,17472
 MV 100,208,212
 v_mul_f32 v84, s96, v84
 v_mul_f32 v85, s96, v85
 MV 108,212,212
 RT 244,14,16960
 RT 246,14,17472
 MV 104,212,208
 v_mul_f32 v86, s96, v86
 v_mul_f32 v87, s96, v87
 MV 96,216,216
 RT 248,13,21312
 RT 250,13,21824
 MV 100,216,220
 s_getpc_b64 s[94:95]
L_cp2:
 s_add_u32 s94, s94, L_A_pa-L_cp2
 s_addc_u32 s95, s95, 0
 v_bfe_u32 v40, v38, 16, 5
 v_and_b32 v39, 63, v38
 v_min_u32 v39, 7, v39
 v_mad_u32_u24 v39, v40, 8, v39
 v_lshlrev_b32 v39, 7, v39
 v_min_u32 v39, L_A_p2-L_A_pa-4, v39
 v_mul_f32 v92, s96, v92
 v_mul_f32 v93, s96, v93
 MV 108,220,220
 WL 6
 RT 252,14,21312
 RT 254,14,21824
 MV 104,220,216
 global_load_dword v47, v39, s[94:95]
 v_add_u32 v45, 0, v44
 v_xor_b32 v46, 32, v45
 v_add_u32 v35, 0, v32
 v_mul_f32 v94, s96, v94
 v_mul_f32 v95, s96, v95
 MV 96,224,224
L_A_pa:
 s_waitcnt vmcnt(12)
 s_barrier
 RB 192,35,0
 MV 100,224,228
 s_mov_b32 s89, 0x13200
 s_mov_b32 s88, 0x1cb00
 AW 64,48
 AW 65,50
 CV 84,84,85
 MV 108,228,228
 RB 196,35,4352
 CV 86,86,87
 MV 104,228,224
 s_mov_b32 s87, 0
 s_add_u32 s59, s89, s69
 AW 66,56
 AW 67,58
 CV 92,92,93
 MV 96,232,232
 RB 200,35,64
 CV 94,94,95
 MV 100,232,236
 s_add_u32 s77, s77, 0x4000
 s_add_u32 s80, s80, 0x4000
 AW 68,52
 AW 69,54
 v_permlane32_swap_b32 v84, v92
 MV 108,236,236
 WL 3
 RB 204,35,4416
 v_permlane32_swap_b32 v86, v94
 MV 104,236,232
 s_add_u32 m0, s59, 0
 s_add_u32 s70, s77, 0x2000
 AW 70,60
 AW 71,62
 v_permlane16_swap_b32 v84, v92
 MV 96,240,240
 RB 208,35,128
 v_permlane16_swap_b32 v86, v94
 MV 100,240,244
 buffer_load_dwordx4 v8, s[12:15], s70 offen lds
 AW 72,64
 AW 73,66
 AW 80,80
 MV 108,244,244
 RB 212,35,4480
 AW 81,82
 MV 104,244,240
 AW 74,72
 AW 75,74
 AW 82,88
 MV 96,248,248
 RB 216,35,192
 AW 83,90
 MV 100,248,252
 AW 76,68
 AW 77,70
 AW 84,84
 MV 108,252,252
 WL 3
 RB 220,35,4544
 AW 85,86
 MV 104,252,248
 s_add_u32 m0, m0, 64
 s_nop 0
 buffer_load_dwordx4 v8, s[12:15], s70 offen offset:1024 lds
 s_add_u32 s4, s87, 0x9900
 s_cmp_lt_u32 s4, 0x26400
 s_cselect_b32 s4, s4, 0
 s_add_u32 m0, s59, 0x2200
 s_add_u32 s70, s77, 0x4000
 buffer_load_dwordx4 v8, s[12:15], s70 offen lds
 s_add_u32 m0, m0, 64
 s_nop 0
 buffer_load_dwordx4 v8, s[12:15], s70 offen offset:1024 lds
 s_add_u32 m0, s59, 0x4400
 s_add_u32 s70, s80, 0
 buffer_load_dwordx4 v3, s[16:19], s70 offen lds
 buffer_load_dwordx4 v4, s[16:19], s70 offen offset:1088 lds
 s_add_u32 m0, s59, 0x6600
 s_add_u32 s70, s80, 0x80
 buffer_load_dwordx4 v3, s[16:19], s70 offen lds
 buffer_load_dwordx4 v4, s[16:19], s70 offen offset:1088 lds
 v_lshrrev_b32 v40, 16, v38
 v_and_b32 v39, 63, v38
 v_min_u32 v39, 15, v39
 v_mad_u32_u24 v39, v40, 16, v39
 v_lshlrev_b32 v39, 7, v39
 v_add_u32 v39, 0, v39
 v_min_u32 v39, 0x1ff80, v39
 buffer_load_dword v47, v39, s[12:15], s41 offen
 v_lshrrev_b32 v40, 16, v38
 v_and_b32 v39, 63, v38
 v_min_u32 v39, 15, v39
 v_mad_u32_u24 v39, v40, 16, v39
 v_lshlrev_b32 v39, 7, v39
 v_add_u32 v39, 0, v39
 v_min_u32 v39, 0x1ff80, v39
 buffer_load_dword v47, v39, s[16:19], s41 offen
 v_add_u32 v45, s4, v44
 v_xor_b32 v46, 32, v45
 v_add_u32 v35, s4, v32
 AW 78,76
 AW 79,78
 AW 86,92
 AW 87,94
 v_mfma_f32_16x16x32_bf16 v[112:115], a[192:195], a[0:3], 0
 s_waitcnt vmcnt(12)
 s_barrier
 RB 224,35,0
 v_mfma_f32_16x16x32_bf16 v[116:119], a[192:195], a[4:7], 0
 s_mov_b32 s89, s88
 s_mov_b32 s88, s87
 v_mfma_f32_16x16x32_bf16 v[52:55], a[192:195], a[36:39], 0
 v_mul_f32 v96, s96, v96
 v_mul_f32 v97, s96, v97
 v_mfma_f32_16x16x32_bf16 v[48:51], a[192:195], a[32:35], 0
 v_mul_f32 v98, s96, v98
 v_mul_f32 v99, s96, v99
 v_mfma_f32_16x16x32_bf16 v[124:127], a[196:199], a[4:7], 0
 RB 228,35,4352
 v_mul_f32 v104, s96, v104
 v_mfma_f32_16x16x32_bf16 v[120:123], a[196:199], a[0:3], 0
 s_mov_b32 s87, s4
 s_add_u32 s59, s89, s69
 v_mfma_f32_16x16x32_bf16 v[56:59], a[196:199], a[32:35], 0
 v_mul_f32 v105, s96, v105
 v_mul_f32 v106, s96, v106
 v_mfma_f32_16x16x32_bf16 v[60:63], a[196:199], a[36:39], 0
 v_mul_f32 v107, s96, v107
 CV 96,96,97
 MA 112,200,8
 RB 232,35,64
 CV 98,98,99
 MA 116,200,12
 s_add_u32 s77, s77, 0x4000
 s_add_u32 s80, s80, 0x4000
 MA 52,200,44
 CV 104,104,105
 CV 106,106,107
 MA 48,200,40
 v_permlane32_swap_b32 v96, v104
 v_permlane32_swap_b32 v98, v106
 MA 124,204,12
 WL 3
 RB 236,35,4416
 v_permlane16_swap_b32 v96, v104
 MA 120,204,8
 s_add_u32 m0, s59, 0
 s_add_u32 s70, s77, 0x2000
 MA 56,204,40
 v_permlane16_swap_b32 v98, v106
 v_mul_f32 v100, s96, v100
 MA 60,204,44
 v_mul_f32 v101, s96, v101
 v_mul_f32 v102, s96, v102
 MA 112,208,16
 RB 240,35,128
 v_mul_f32 v103, s96, v103
 MA 116,208,20
 buffer_load_dwordx4 v8, s[12:15], s70 offen lds
 MA 52,208,52
 v_mul_f32 v108, s96, v108
 v_mul_f32 v109, s96, v109
 MA 48,208,48
 v_mul_f32 v110, s96, v110
 v_mul_f32 v111, s96, v111
 MA 124,212,20
 RB 244,35,4480
 CV 100,100,101
 MA 120,212,16
 CV 102,102,103
 CV 108,108,109
 MA 56,212,48
 CV 110,110,111
 v_permlane32_swap_b32 v100, v108
 MA 60,212,52
 v_permlane32_swap_b32 v102, v110
 v_permlane16_swap_b32 v100, v108
 MA 112,216,24
 RB 248,35,192
 v_permlane16_swap_b32 v102, v110
 MA 116,216,28
 AW 88,96
 AW 89,98
 MA 52,216,60
 AW 90,104
 AW 91,106
 MA 48,216,56
 AW 92,100
 AW 93,102
 MA 124,220,28
 WL 3
 RB 252,35,4544
 AW 94,108
 MA 120,220,24
 s_add_u32 m0, m0, 64
 AW 95,110
 MA 56,220,56
 s_nop 0
 MA 60,220,60
 s_nop 0
 v_mfma_f32_16x16x32_bf16 v[128:131], a[224:227], a[0:3], 0
 RT 192,45,17408
 RT 194,45,17920
 v_mfma_f32_16x16x32_bf16 v[132:135], a[224:227], a[4:7], 0
 buffer_load_dwordx4 v8, s[12:15], s70 offen offset:1024 lds
 EX 112,112
 EX 113,113
 v_mfma_f32_16x16x32_bf16 v[68:71], a[224:227], a[36:39], 0
 EX 114,114
 CV 144,112,113
 v_mfma_f32_16x16x32_bf16 v[64:67], a[224:227], a[32:35], 0
 EX 115,115
 s_nop 0
 CV 145,114,115
 v_mfma_f32_16x16x32_bf16 v[140:143], a[228:231], a[4:7], 0
 RT 196,46,17408
 RT 198,46,17920
 v_mfma_f32_16x16x32_bf16 v[136:139], a[228:231], a[0:3], 0
 EX 120,120
 EX 121,121
 v_mfma_f32_16x16x32_bf16 v[72:75], a[228:231], a[32:35], 0
 EX 122,122
 CV 146,120,121
 v_mfma_f32_16x16x32_bf16 v[76:79], a[228:231], a[36:39], 0
 EX 123,123
 s_nop 0
 CV 147,122,123
 MA 128,232,8
 RT 200,45,17472
 RT 202,45,17984
 MA 132,232,12
 EX 116,116
 EX 117,117
 MA 68,232,44
 EX 118,118
 CV 148,116,117
 MA 64,232,40
 EX 119,119
 s_nop 0
 CV 149,118,119
 MA 140,236,12
 WL 6
 RT 204,46,17472
 RT 206,46,17984
 MA 136,236,8
 s_add_u32 s4, s87, 0x9900
 s_cmp_lt_u32 s4, 0x26400
 s_cselect_b32 s4, s4, 0
 EX 124,124
 EX 125,125
 MA 72,236,40
 EX 126,126
 CV 150,124,125
 MA 76,236,44
 EX 127,127
 s_nop 0
 CV 151,126,127
 MA 128,240,16
 RT 208,45,26112
 RT 210,45,26624
 MA 132,240,20
 s_add_u32 m0, s59, 0x2200
 s_add_u32 s70, s77, 0x4000
 EX 48,48
 EX 49,49
 MA 68,240,52
 EX 50,50
 CV 80,48,49
 MA 64,240,48
 EX 51,51
 s_nop 0
 CV 81,50,51
 MA 140,244,20
 RT 212,46,26112
 RT 214,46,26624
 MA 136,244,16
 buffer_load_dwordx4 v8, s[12:15], s70 offen lds
 EX 56,56
 EX 57,57
 MA 72,244,48
 EX 58,58
 CV 82,56,57
 MA 76,244,52
 EX 59,59
 s_nop 0
 CV 83,58,59
 MA 128,248,24
 RT 216,45,26176
 RT 218,45,26688
 MA 132,248,28
 EX 52,52
 EX 53,53
 MA 68,248,60
 EX 54,54
 CV 84,52,53
 MA 64,248,56
 EX 55,55
 s_nop 0
 CV 85,54,55
 MA 140,252,28
 WL 6
 RT 220,46,26176
 RT 222,46,26688
 MA 136,252,24
 EX 60,60
 EX 61,61
 MA 72,252,56
 EX 62,62
 CV 86,60,61
 MA 76,252,60
 EX 63,63
 s_nop 0
 CV 87,62,63
 v_mov_b32 v24, 0x3f803f80
 v_mov_b32 v25, 0x3f803f80
 v_mov_b32 v26, 0x3f803f80
 v_mov_b32 v27, 0x3f803f80
 v_mfma_f32_16x16x32_bf16 a[96:99], a[192:195], v[144:147], 0
 RB 224,35,8704
 v_mfma_f32_16x16x32_bf16 a[100:103], a[192:195], v[148:151], 0
 s_add_u32 m0, m0, 64
 v_mfma_f32_16x16x32_bf16 v[164:167], a[192:195], v[84:87], 0
 EX 128,128
 v_mfma_f32_16x16x32_bf16 v[160:163], a[192:195], v[80:83], 0
 EX 129,129
 v_mfma_f32_16x16x32_bf16 a[108:111], a[196:199], v[148:151], 0
 RB 228,35,13056
 CV 152,128,129
 v_mfma_f32_16x16x32_bf16 a[104:107], a[196:199], v[144:147], 0
 buffer_load_dwordx4 v8, s[12:15], s70 offen offset:1024 lds
 EX 130,130
 v_mfma_f32_16x16x32_bf16 v[168:171], a[196:199], v[80:83], 0
 EX 131,131
 v_mfma_f32_16x16x32_bf16 v[172:175], a[196:199], v[84:87], 0
 CV 153,130,131
 v_mfma_f32_16x16x32_bf16 v[230:233], v[24:27], v[144:147], 0
 EX 136,136
 v_mfma_f32_16x16x32_bf16 a[112:115], a[200:203], v[144:147], 0
 RB 232,35,8768
 v_mfma_f32_16x16x32_bf16 a[116:119], a[200:203], v[148:151], 0
 EX 137,137
 v_mfma_f32_16x16x32_bf16 v[180:183], a[200:203], v[84:87], 0
 EX 138,138
 v_mfma_f32_16x16x32_bf16 v[176:179], a[200:203], v[80:83], 0
 EX 139,139
 v_mfma_f32_16x16x32_bf16 a[124:127], a[204:207], v[148:151], 0
 WL 3
 RB 236,35,13120
 CV 154,136,137
 v_mfma_f32_16x16x32_bf16 a[120:123], a[204:207], v[144:147], 0
 CV 155,138,139
 v_mfma_f32_16x16x32_bf16 v[184:187], a[204:207], v[80:83], 0
 EX 132,132
 v_mfma_f32_16x16x32_bf16 v[188:191], a[204:207], v[84:87], 0
 EX 133,133
 v_mfma_f32_16x16x32_bf16 v[234:237], v[24:27], v[148:151], 0
 EX 134,134
 v_mfma_f32_16x16x32_bf16 a[128:131], a[208:211], v[144:147], 0
 RB 240,35,8832
 CV 156,132,133
 v_mfma_f32_16x16x32_bf16 a[132:135], a[208:211], v[148:151], 0
 s_add_u32 m0, s59, 0x4400
 s_add_u32 s70, s80, 0
 v_mfma_f32_16x16x32_bf16 v[196:199], a[208:211], v[84:87], 0
 EX 135,135
 v_mfma_f32_16x16x32_bf16 v[192:195], a[208:211], v[80:83], 0
 CV 157,134,135
 v_mfma_f32_16x16x32_bf16 a[140:143], a[212:215], v[148:151], 0
 RB 244,35,13184
 v_mfma_f32_16x16x32_bf16 a[136:139], a[212:215], v[144:147], 0
 buffer_load_dwordx4 v3, s[16:19], s70 offen lds
 v_mfma_f32_16x16x32_bf16 v[200:203], a[212:215], v[80:83], 0
 EX 140,140
 v_mfma_f32_16x16x32_bf16 v[204:207], a[212:215], v[84:87], 0
 EX 141,141
 v_mfma_f32_16x16x32_bf16 v[96:99], v[24:27], v[80:83], 0
 EX 142,142
 v_mfma_f32_16x16x32_bf16 a[144:147], a[216:219], v[144:147], 0
 RB 248,35,8896
 CV 158,140,141
 v_mfma_f32_16x16x32_bf16 a[148:151], a[216:219], v[148:151], 0
 EX 143,143
 v_mfma_f32_16x16x32_bf16 v[212:215], a[216:219], v[84:87], 0
 CV 159,142,143
 v_mfma_f32_16x16x32_bf16 v[208:211], a[216:219], v[80:83], 0
 EX 64,64
 v_mfma_f32_16x16x32_bf16 a[156:159], a[220:223], v[148:151], 0
 WL 3
 RB 252,35,13248
 v_mfma_f32_16x16x32_bf16 a[152:155], a[220:223], v[144:147], 0
 EX 65,65
 v_mfma_f32_16x16x32_bf16 v[216:219], a[220:223], v[80:83], 0
 EX 66,66
 v_mfma_f32_16x16x32_bf16 v[220:223], a[220:223], v[84:87], 0
 EX 67,67
 v_mfma_f32_16x16x32_bf16 v[100:103], v[24:27], v[84:87], 0
 CV 88,64,65
 CV 89,66,67
 v_mfma_f32_16x16x32_bf16 v[112:115], a[224:227], a[0:3], 0
 RT 192,45,21760
 RT 194,45,22272
 v_mfma_f32_16x16x32_bf16 v[116:119], a[224:227], a[4:7], 0
 buffer_load_dwordx4 v4, s[16:19], s70 offen offset:1088 lds
 v_mfma_f32_16x16x32_bf16 v[52:55], a[224:227], a[36:39], 0
 EX 72,72
 v_mfma_f32_16x16x32_bf16 v[48:51], a[224:227], a[32:35], 0
 EX 73,73
 v_mfma_f32_16x16x32_bf16 v[124:127], a[228:231], a[4:7], 0
 RT 196,46,21760
 RT 198,46,22272
 v_mfma_f32_16x16x32_bf16 v[120:123], a[228:231], a[0:3], 0
 EX 74,74
 v_mfma_f32_16x16x32_bf16 v[56:59], a[228:231], a[32:35], 0
 EX 75,75
 v_mfma_f32_16x16x32_bf16 v[60:63], a[228:231], a[36:39], 0
 CV 90,72,73
 CV 91,74,75
 MA 112,232,8
 RT 200,45,21824
 RT 202,45,22336
 MA 116,232,12
 EX 68,68
 MA 52,232,44
 EX 69,69
 MA 48,232,40
 EX 70,70
 MA 124,236,12
 WL 6
 RT 204,46,21824
 RT 206,46,22336
 MA 120,236,8
 s_add_u32 m0, s59, 0x6600
 s_add_u32 s70, s80, 0x80
 MA 56,236,40
 EX 71,71
 MA 60,236,44
 CV 92,68,69
 CV 93,70,71
 MA 112,240,16
 RT 208,45,30464
 RT 210,45,30976
 MA 116,240,20
 buffer_load_dwordx4 v3, s[16:19], s70 offen lds
 MA 52,240,52
 EX 76,76
 MA 48,240,48
 EX 77,77
 MA 124,244,20
 RT 212,46,30464
 RT 214,46,30976
 MA 120,244,16
 EX 78,78
 MA 56,244,48
 EX 79,79
 MA 60,244,52
 CV 94,76,77
 CV 95,78,79
 MA 112,248,24
 RT 216,45,30528
 RT 218,45,31040
 MA 116,248,28
 s_nop 0
 MA 52,248,60
 s_nop 0
 MA 48,248,56
 s_nop 0
 MA 124,252,28
 WL 6
 RT 220,46,30528
 RT 222,46,31040
 MA 120,252,24
 buffer_load_dwordx4 v4, s[16:19], s70 offen offset:1088 lds
 v_add_u32 v45, s4, v44
 v_xor_b32 v46, 32, v45
 v_add_u32 v35, s4, v32
 MA 56,252,56
 s_nop 0
 MA 60,252,60
 s_nop 0
 MC 96,192,152
 s_waitcnt vmcnt(10)
 s_barrier
 RB 224,35,0
 MC 100,192,156
 s_mov_b32 s89, s88
 s_mov_b32 s88, s87
 MV 164,192,92
 EX 112,112
 MV 160,192,88
 EX 113,113
 MC 108,196,156
 RB 228,35,4352
 CV 144,112,113
 MC 104,196,152
 s_mov_b32 s87, s4
 s_add_u32 s59, s89, s69
 EX 114,114
 MV 168,196,88
 EX 115,115
 MV 172,196,92
 CV 145,114,115
 v_mfma_f32_16x16x32_bf16 v[230:233], v[24:27], v[152:155], v[230:233]
 EX 120,120
 MC 112,200,152
 RB 232,35,64
 MC 116,200,156
 s_add_u32 s77, s77, 0x4000
 s_add_u32 s80, s80, 0x4000
 MV 180,200,92
 EX 121,121
 MV 176,200,88
 EX 122,122
 MC 124,204,156
 WL 3
 RB 236,35,4416
 CV 146,120,121
 MC 120,204,152
 s_add_u32 m0, s59, 0
 s_add_u32 s70, s77, 0x2000
 MV 184,204,88
 EX 123,123
 MV 188,204,92
 CV 147,122,123
 v_mfma_f32_16x16x32_bf16 v[234:237], v[24:27], v[156:159], v[234:237]
 EX 116,116
 MC 128,208,152
 RB 240,35,128
 MC 132,208,156
 buffer_load_dwordx4 v8, s[12:15], s70 offen lds
 MV 196,208,92
 EX 117,117
 MV 192,208,88
 EX 118,118
 MC 140,212,156
 RB 244,35,4480
 CV 148,116,117
 MC 136,212,152
 EX 119,119
 MV 200,212,88
 CV 149,118,119
 MV 204,212,92
 EX 124,124
 v_mfma_f32_16x16x32_bf16 v[96:99], v[24:27], v[88:91], v[96:99]
 EX 125,125
 MC 144,216,152
 RB 248,35,192
 CV 150,124,125
 MC 148,216,156
 EX 126,126
 MV 212,216,92
 EX 127,127
 MV 208,216,88
 CV 151,126,127
 MC 156,220,156
 WL 3
 RB 252,35,4544
 MC 152,220,152
 s_add_u32 m0, m0, 64
 MV 216,220,88
 EX 48,48
 MV 220,220,92
 EX 49,49
 v_mfma_f32_16x16x32_bf16 v[100:103], v[24:27], v[92:95], v[100:103]
 EX 50,50
 v_mfma_f32_16x16x32_bf16 v[128:131], a[224:227], a[0:3], 0
 RT 192,45,17408
 RT 194,45,17920
 v_mfma_f32_16x16x32_bf16 v[132:135], a[224:227], a[4:7], 0
 buffer_load_dwordx4 v8, s[12:15], s70 offen offset:1024 lds
 v_mfma_f32_16x16x32_bf16 v[68:71], a[224:227], a[36:39], 0
 EX 51,51
 v_mfma_f32_16x16x32_bf16 v[64:67], a[224:227], a[32:35], 0
 CV 80,48,49
 CV 81,50,51
 v_mfma_f32_16x16x32_bf16 v[140:143], a[228:231], a[4:7], 0
 RT 196,46,17408
 RT 198,46,17920
 v_mfma_f32_16x16x32_bf16 v[136:139], a[228:231], a[0:3], 0
 EX 56,56
 v_mfma_f32_16x16x32_bf16 v[72:75], a[228:231], a[32:35], 0
 EX 57,57
 v_mfma_f32_16x16x32_bf16 v[76:79], a[228:231], a[36:39], 0
 EX 58,58
 MA 128,232,8
 RT 200,45,17472
 RT 202,45,17984
 MA 132,232,12
 EX 59,59
 MA 68,232,44
 CV 82,56,57
 CV 83,58,59
 MA 64,232,40
 EX 52,52
 MA 140,236,12
 WL 6
 RT 204,46,17472
 RT 206,46,17984
 MA 136,236,8
 s_add_u32 s4, s87, 0x9900
 s_cmp_lt_u32 s4, 0x26400
 s_cselect_b32 s4, s4, 0
 MA 72,236,40
 EX 53,53
 MA 76,236,44
 EX 54,54
 MA 128,240,16
 RT 208,45,26112
 RT 210,45,26624
 MA 132,240,20
 s_add_u32 m0, s59, 0x2200
 s_add_u32 s70, s77, 0x4000
 MA 68,240,52
 EX 55,55
 MA 64,240,48
 CV 84,52,53
 CV 85,54,55
 MA 140,244,20
 RT 212,46,26112
 RT 214,46,26624
 MA 136,244,16
 buffer_load_dwordx4 v8, s[12:15], s70 offen lds
 MA 72,244,48
 EX 60,60
 MA 76,244,52
 EX 61,61
 MA 128,248,24
 RT 216,45,26176
 RT 218,45,26688
 MA 132,248,28
 EX 62,62
 MA 68,248,60
 EX 63,63
 MA 64,248,56
 CV 86,60,61
 CV 87,62,63
 MA 140,252,28
 WL 6
 RT 220,46,26176
 RT 222,46,26688
 MA 136,252,24
 s_nop 0
 MA 72,252,56
 s_nop 0
 MA 76,252,60
 s_nop 0
 MC 96,192,144
 RB 224,35,8704
 MC 100,192,148
 s_add_u32 m0, m0, 64
 MV 164,192,84
 EX 128,128
 MV 160,192,80
 EX 129,129
 MC 108,196,148
 RB 228,35,13056
 CV 152,128,129
 MC 104,196,144
 buffer_load_dwordx4 v8, s[12:15], s70 offen offset:1024 lds
 EX 130,130
 MV 168,196,80
 EX 131,131
 MV 172,196,84
 CV 153,130,131
 v_mfma_f32_16x16x32_bf16 v[230:233], v[24:27], v[144:147], v[230:233]
 EX 136,136
 MC 112,200,144
 RB 232,35,8768
 MC 116,200,148
 EX 137,137
 MV 180,200,84
 EX 138,138
 MV 176,200,80
 EX 139,139
 MC 124,204,148
 WL 3
 RB 236,35,13120
 CV 154,136,137
 MC 120,204,144
 CV 155,138,139
 MV 184,204,80
 EX 132,132
 MV 188,204,84
 EX 133,133
 v_mfma_f32_16x16x32_bf16 v[234:237], v[24:27], v[148:151], v[234:237]
 EX 134,134
 MC 128,208,144
 RB 240,35,8832
 CV 156,132,133
 MC 132,208,148
 s_add_u32 m0, s59, 0x4400
 s_add_u32 s70, s80, 0
 MV 196,208,84
 EX 135,135
 MV 192,208,80
 CV 157,134,135
 MC 140,212,148
 RB 244,35,13184
 MC 136,212,144
 buffer_load_dwordx4 v3, s[16:19], s70 offen lds
 MV 200,212,80
 EX 140,140
 MV 204,212,84
 EX 141,141
 v_mfma_f32_16x16x32_bf16 v[96:99], v[24:27], v[80:83], v[96:99]
 EX 142,142
 MC 144,216,144
 RB 248,35,8896
 CV 158,140,141
 MC 148,216,148
 EX 143,143
 MV 212,216,84
 CV 159,142,143
 MV 208,216,80
 EX 64,64
 MC 156,220,148
 WL 3
 RB 252,35,13248
 MC 152,220,144
 EX 65,65
 MV 216,220,80
 EX 66,66
 MV 220,220,84
 EX 67,67
 v_mfma_f32_16x16x32_bf16 v[100:103], v[24:27], v[84:87], v[100:103]
 CV 88,64,65
 CV 89,66,67
 v_mfma_f32_16x16x32_bf16 v[112:115], a[224:227], a[0:3], 0
 RT 192,45,21760
 RT 194,45,22272
 v_mfma_f32_16x16x32_bf16 v[116:119], a[224:227], a[4:7], 0
 buffer_load_dwordx4 v4, s[16:19], s70 offen offset:1088 lds
 v_mfma_f32_16x16x32_bf16 v[52:55], a[224:227], a[36:39], 0
 EX 72,72
 v_mfma_f32_16x16x32_bf16 v[48:51], a[224:227], a[32:35], 0
 EX 73,73
 v_mfma_f32_16x16x32_bf16 v[124:127], a[228:231], a[4:7], 0
 RT 196,46,21760
 RT 198,46,22272
 v_mfma_f32_16x16x32_bf16 v[120:123], a[228:231], a[0:3], 0
 EX 74,74
 v_mfma_f32_16x16x32_bf16 v[56:59], a[228:231], a[32:35], 0
 EX 75,75
 v_mfma_f32_16x16x32_bf16 v[60:63], a[228:231], a[36:39], 0
 CV 90,72,73
 CV 91,74,75
 MA 112,232,8
 RT 200,45,21824
 RT 202,45,22336
 MA 116,232,12
 EX 68,68
 MA 52,232,44
 EX 69,69
 MA 48,232,40
 EX 70,70
 MA 124,236,12
 WL 6
 RT 204,46,21824
 RT 206,46,22336
 MA 120,236,8
 s_add_u32 m0, s59, 0x6600
 s_add_u32 s70, s80, 0x80
 MA 56,236,40
 EX 71,71
 MA 60,236,44
 CV 92,68,69
 CV 93,70,71
 MA 112,240,16
 RT 208,45,30464
 RT 210,45,30976
 MA 116,240,20
 buffer_load_dwordx4 v3, s[16:19], s70 offen lds
 MA 52,240,52
 EX 76,76
 MA 48,240,48
 EX 77,77
 MA 124,244,20
 RT 212,46,30464
 RT 214,46,30976
 MA 120,244,16
 EX 78,78
 MA 56,244,48
 EX 79,79
 MA 60,244,52
 CV 94,76,77
 CV 95,78,79
 MA 112,248,24
 RT 216,45,30528
 RT 218,45,31040
 MA 116,248,28
 s_nop 0
 MA 52,248,60
 s_nop 0
 MA 48,248,56
 s_nop 0
 MA 124,252,28
 WL 6
 RT 220,46,30528
 RT 222,46,31040
 MA 120,252,24
 buffer_load_dwordx4 v4, s[16:19], s70 offen offset:1088 lds
 v_add_u32 v45, s4, v44
 v_xor_b32 v46, 32, v45
 v_add_u32 v35, s4, v32
 MA 56,252,56
 s_nop 0
 MA 60,252,60
 s_nop 0
 MC 96,192,152
 s_mov_b32 s91, 3
.p2align 3
L_A_loop0:
 s_waitcnt vmcnt(8)
 s_barrier
 RB 224,35,0
 MC 100,192,156
 s_mov_b32 s89, s88
 s_mov_b32 s88, s87
 MV 164,192,92
 EX 112,112
 MV 160,192,88
 EX 113,113
 MC 108,196,156
 RB 228,35,4352
 CV 144,112,113
 MC 104,196,152
 s_mov_b32 s87, s4
 s_add_u32 s59, s89, s69
 EX 114,114
 MV 168,196,88
 EX 115,115
 MV 172,196,92
 CV 145,114,115
 v_mfma_f32_16x16x32_bf16 v[230:233], v[24:27], v[152:155], v[230:233]
 EX 120,120
 MC 112,200,152
 RB 232,35,64
 MC 116,200,156
 s_add_u32 s77, s77, 0x4000
 s_add_u32 s80, s80, 0x4000
 MV 180,200,92
 EX 121,121
 MV 176,200,88
 EX 122,122
 MC 124,204,156
 WL 3
 RB 236,35,4416
 CV 146,120,121
 MC 120,204,152
 s_add_u32 m0, s59, 0
 s_add_u32 s70, s77, 0x2000
 MV 184,204,88
 EX 123,123
 MV 188,204,92
 CV 147,122,123
 v_mfma_f32_16x16x32_bf16 v[234:237], v[24:27], v[156:159], v[234:237]
 EX 116,116
 MC 128,208,152
 RB 240,35,128
 MC 132,208,156
 buffer_load_dwordx4 v8, s[12:15], s70 offen lds
 MV 196,208,92
 EX 117,117
 MV 192,208,88
 EX 118,118
 MC 140,212,156
 RB 244,35,4480
 CV 148,116,117
 MC 136,212,152
 EX 119,119
 MV 200,212,88
 CV 149,118,119
 MV 204,212,92
 EX 124,124
 v_mfma_f32_16x16x32_bf16 v[96:99], v[24:27], v[88:91], v[96:99]
 EX 125,125
 MC 144,216,152
 RB 248,35,192
 CV 150,124,125
 MC 148,216,156
 EX 126,126
 MV 212,216,92
 EX 127,127
 MV 208,216,88
 CV 151,126,127
 MC 156,220,156
 WL 3
 RB 252,35,4544
 MC 152,220,152
 s_add_u32 m0, m0, 64
 MV 216,220,88
 EX 48,48
 MV 220,220,92
 EX 49,49
 v_mfma_f32_16x16x32_bf16 v[100:103], v[24:27], v[92:95], v[100:103]
 EX 50,50
 v_mfma_f32_16x16x32_bf16 v[128:131], a[224:227], a[0:3], 0
 RT 192,45,17408
 RT 194,45,17920
 v_mfma_f32_16x16x32_bf16 v[132:135], a[224:227], a[4:7], 0
 buffer_load_dwordx4 v8, s[12:15], s70 offen offset:1024 lds
 v_mfma_f32_16x16x32_bf16 v[68:71], a[224:227], a[36:39], 0
 EX 51,51
 v_mfma_f32_16x16x32_bf16 v[64:67], a[224:227], a[32:35], 0
 CV 80,48,49
 CV 81,50,51
 v_mfma_f32_16x16x32_bf16 v[140:143], a[228:231], a[4:7], 0
 RT 196,46,17408
 RT 198,46,17920
 v_mfma_f32_16x16x32_bf16 v[136:139], a[228:231], a[0:3], 0
 EX 56,56
 v_mfma_f32_16x16x32_bf16 v[72:75], a[228:231], a[32:35], 0
 EX 57,57
 v_mfma_f32_16x16x32_bf16 v[76:79], a[228:231], a[36:39], 0
 EX 58,58
 MA 128,232,8
 RT 200,45,17472
 RT 202,45,17984
 MA 132,232,12
 EX 59,59
 MA 68,232,44
 CV 82,56,57
 CV 83,58,59
 MA 64,232,40
 EX 52,52
 MA 140,236,12
 WL 6
 RT 204,46,17472
 RT 206,46,17984
 MA 136,236,8
 s_add_u32 s4, s87, 0x9900
 s_cmp_lt_u32 s4, 0x26400
 s_cselect_b32 s4, s4, 0
 MA 72,236,40
 EX 53,53
 MA 76,236,44
 EX 54,54
 MA 128,240,16
 RT 208,45,26112
 RT 210,45,26624
 MA 132,240,20
 s_add_u32 m0, s59, 0x2200
 s_add_u32 s70, s77, 0x4000
 MA 68,240,52
 EX 55,55
 MA 64,240,48
 CV 84,52,53
 CV 85,54,55
 MA 140,244,20
 RT 212,46,26112
 RT 214,46,26624
 MA 136,244,16
 buffer_load_dwordx4 v8, s[12:15], s70 offen lds
 MA 72,244,48
 EX 60,60
 MA 76,244,52
 EX 61,61
 MA 128,248,24
 RT 216,45,26176
 RT 218,45,26688
 MA 132,248,28
 EX 62,62
 MA 68,248,60
 EX 63,63
 MA 64,248,56
 CV 86,60,61
 CV 87,62,63
 MA 140,252,28
 WL 6
 RT 220,46,26176
 RT 222,46,26688
 MA 136,252,24
 s_nop 0
 MA 72,252,56
 s_nop 0
 MA 76,252,60
 s_nop 0
 MC 96,192,144
 RB 224,35,8704
 MC 100,192,148
 s_add_u32 m0, m0, 64
 MV 164,192,84
 EX 128,128
 MV 160,192,80
 EX 129,129
 MC 108,196,148
 RB 228,35,13056
 CV 152,128,129
 MC 104,196,144
 buffer_load_dwordx4 v8, s[12:15], s70 offen offset:1024 lds
 EX 130,130
 MV 168,196,80
 EX 131,131
 MV 172,196,84
 CV 153,130,131
 v_mfma_f32_16x16x32_bf16 v[230:233], v[24:27], v[144:147], v[230:233]
 EX 136,136
 MC 112,200,144
 RB 232,35,8768
 MC 116,200,148
 EX 137,137
 MV 180,200,84
 EX 138,138
 MV 176,200,80
 EX 139,139
 MC 124,204,148
 WL 3
 RB 236,35,13120
 CV 154,136,137
 MC 120,204,144
 CV 155,138,139
 MV 184,204,80
 EX 132,132
 MV 188,204,84
 EX 133,133
 v_mfma_f32_16x16x32_bf16 v[234:237], v[24:27], v[148:151], v[234:237]
 EX 134,134
 MC 128,208,144
 RB 240,35,8832
 CV 156,132,133
 MC 132,208,148
 s_add_u32 m0, s59, 0x4400
 s_add_u32 s70, s80, 0
 MV 196,208,84
 EX 135,135
 MV 192,208,80
 CV 157,134,135
 MC 140,212,148
 RB 244,35,13184
 MC 136,212,144
 buffer_load_dwordx4 v3, s[16:19], s70 offen lds
 MV 200,212,80
 EX 140,140
 MV 204,212,84
 EX 141,141
 v_mfma_f32_16x16x32_bf16 v[96:99], v[24:27], v[80:83], v[96:99]
 EX 142,142
 MC 144,216,144
 RB 248,35,8896
 CV 158,140,141
 MC 148,216,148
 EX 143,143
 MV 212,216,84
 CV 159,142,143
 MV 208,216,80
 EX 64,64
 MC 156,220,148
 WL 3
 RB 252,35,13248
 MC 152,220,144
 EX 65,65
 MV 216,220,80
 EX 66,66
 MV 220,220,84
 EX 67,67
 v_mfma_f32_16x16x32_bf16 v[100:103], v[24:27], v[84:87], v[100:103]
 CV 88,64,65
 CV 89,66,67
 v_mfma_f32_16x16x32_bf16 v[112:115], a[224:227], a[0:3], 0
 RT 192,45,21760
 RT 194,45,22272
 v_mfma_f32_16x16x32_bf16 v[116:119], a[224:227], a[4:7], 0
 buffer_load_dwordx4 v4, s[16:19], s70 offen offset:1088 lds
 v_mfma_f32_16x16x32_bf16 v[52:55], a[224:227], a[36:39], 0
 EX 72,72
 v_mfma_f32_16x16x32_bf16 v[48:51], a[224:227], a[32:35], 0
 EX 73,73
 v_mfma_f32_16x16x32_bf16 v[124:127], a[228:231], a[4:7], 0
 RT 196,46,21760
 RT 198,46,22272
 v_mfma_f32_16x16x32_bf16 v[120:123], a[228:231], a[0:3], 0
 EX 74,74
 v_mfma_f32_16x16x32_bf16 v[56:59], a[228:231], a[32:35], 0
 EX 75,75
 v_mfma_f32_16x16x32_bf16 v[60:63], a[228:231], a[36:39], 0
 CV 90,72,73
 CV 91,74,75
 MA 112,232,8
 RT 200,45,21824
 RT 202,45,22336
 MA 116,232,12
 EX 68,68
 MA 52,232,44
 EX 69,69
 MA 48,232,40
 EX 70,70
 MA 124,236,12
 WL 6
 RT 204,46,21824
 RT 206,46,22336
 MA 120,236,8
 s_add_u32 m0, s59, 0x6600
 s_add_u32 s70, s80, 0x80
 MA 56,236,40
 EX 71,71
 MA 60,236,44
 CV 92,68,69
 CV 93,70,71
 MA 112,240,16
 RT 208,45,30464
 RT 210,45,30976
 MA 116,240,20
 buffer_load_dwordx4 v3, s[16:19], s70 offen lds
 MA 52,240,52
 EX 76,76
 MA 48,240,48
 EX 77,77
 MA 124,244,20
 RT 212,46,30464
 RT 214,46,30976
 MA 120,244,16
 EX 78,78
 MA 56,244,48
 EX 79,79
 MA 60,244,52
 CV 94,76,77
 CV 95,78,79
 MA 112,248,24
 RT 216,45,30528
 RT 218,45,31040
 MA 116,248,28
 s_nop 0
 MA 52,248,60
 s_nop 0
 MA 48,248,56
 s_nop 0
 MA 124,252,28
 WL 6
 RT 220,46,30528
 RT 222,46,31040
 MA 120,252,24
 buffer_load_dwordx4 v4, s[16:19], s70 offen offset:1088 lds
 v_add_u32 v45, s4, v44
 v_xor_b32 v46, 32, v45
 v_add_u32 v35, s4, v32
 MA 56,252,56
 s_nop 0
 MA 60,252,60
 s_nop 0
 MC 96,192,152
 s_sub_u32 s91, s91, 1
 s_cmp_lg_u32 s91, 0
 s_cbranch_scc1 L_A_loop0
 s_waitcnt vmcnt(8)
 s_barrier
 RB 224,35,0
 MC 100,192,156
 s_mov_b32 s89, s88
 s_mov_b32 s88, s87
 MV 164,192,92
 EX 112,112
 MV 160,192,88
 EX 113,113
 MC 108,196,156
 RB 228,35,4352
 CV 144,112,113
 MC 104,196,152
 s_mov_b32 s87, s4
 s_add_u32 s59, s89, s69
 EX 114,114
 MV 168,196,88
 EX 115,115
 MV 172,196,92
 CV 145,114,115
 v_mfma_f32_16x16x32_bf16 v[230:233], v[24:27], v[152:155], v[230:233]
 EX 120,120
 MC 112,200,152
 RB 232,35,64
 MC 116,200,156
 s_add_u32 s77, s77, 0x4000
 s_add_u32 s80, s80, 0x4000
 MV 180,200,92
 EX 121,121
 MV 176,200,88
 EX 122,122
 MC 124,204,156
 WL 3
 RB 236,35,4416
 CV 146,120,121
 MC 120,204,152
 s_add_u32 m0, s59, 0
 s_add_u32 s70, s77, 0x2000
 MV 184,204,88
 EX 123,123
 MV 188,204,92
 CV 147,122,123
 v_mfma_f32_16x16x32_bf16 v[234:237], v[24:27], v[156:159], v[234:237]
 EX 116,116
 MC 128,208,152
 RB 240,35,128
 MC 132,208,156
 buffer_load_dwordx4 v8, s[12:15], s70 offen lds
 MV 196,208,92
 EX 117,117
 MV 192,208,88
 EX 118,118
 MC 140,212,156
 RB 244,35,4480
 CV 148,116,117
 MC 136,212,152
 EX 119,119
 MV 200,212,88
 CV 149,118,119
 MV 204,212,92
 EX 124,124
 v_mfma_f32_16x16x32_bf16 v[96:99], v[24:27], v[88:91], v[96:99]
 EX 125,125
 MC 144,216,152
 RB 248,35,192
 CV 150,124,125
 MC 148,216,156
 EX 126,126
 MV 212,216,92
 EX 127,127
 MV 208,216,88
 CV 151,126,127
 MC 156,220,156
 WL 3
 RB 252,35,4544
 MC 152,220,152
 s_add_u32 m0, m0, 64
 MV 216,220,88
 EX 48,48
 MV 220,220,92
 EX 49,49
 v_mfma_f32_16x16x32_bf16 v[100:103], v[24:27], v[92:95], v[100:103]
 EX 50,50
 v_mfma_f32_16x16x32_bf16 v[128:131], a[224:227], a[0:3], 0
 RT 192,45,17408
 RT 194,45,17920
 v_mfma_f32_16x16x32_bf16 v[132:135], a[224:227], a[4:7], 0
 buffer_load_dwordx4 v8, s[12:15], s70 offen offset:1024 lds
 v_mfma_f32_16x16x32_bf16 v[68:71], a[224:227], a[36:39], 0
 EX 51,51
 v_mfma_f32_16x16x32_bf16 v[64:67], a[224:227], a[32:35], 0
 CV 80,48,49
 CV 81,50,51
 v_mfma_f32_16x16x32_bf16 v[140:143], a[228:231], a[4:7], 0
 RT 196,46,17408
 RT 198,46,17920
 v_mfma_f32_16x16x32_bf16 v[136:139], a[228:231], a[0:3], 0
 EX 56,56
 v_mfma_f32_16x16x32_bf16 v[72:75], a[228:231], a[32:35], 0
 EX 57,57
 v_mfma_f32_16x16x32_bf16 v[76:79], a[228:231], a[36:39], 0
 EX 58,58
 MA 128,232,8
 RT 200,45,17472
 RT 202,45,17984
 MA 132,232,12
 EX 59,59
 MA 68,232,44
 CV 82,56,57
 CV 83,58,59
 MA 64,232,40
 EX 52,52
 MA 140,236,12
 WL 6
 RT 204,46,17472
 RT 206,46,17984
 MA 136,236,8
 s_add_u32 s4, s87, 0x9900
 s_cmp_lt_u32 s4, 0x26400
 s_cselect_b32 s4, s4, 0
 MA 72,236,40
 EX 53,53
 MA 76,236,44
 EX 54,54
 MA 128,240,16
 RT 208,45,26112
 RT 210,45,26624
 MA 132,240,20
 s_add_u32 m0, s59, 0x2200
 s_add_u32 s70, s78, 0
 MA 68,240,52
 EX 55,55
 MA 64,240,48
 CV 84,52,53
 CV 85,54,55
 MA 140,244,20
 RT 212,46,26112
 RT 214,46,26624
 MA 136,244,16
 buffer_load_dwordx4 v8, s[12:15], s70 offen lds
 MA 72,244,48
 EX 60,60
 MA 76,244,52
 EX 61,61
 MA 128,248,24
 RT 216,45,26176
 RT 218,45,26688
 MA 132,248,28
 EX 62,62
 MA 68,248,60
 EX 63,63
 MA 64,248,56
 CV 86,60,61
 CV 87,62,63
 MA 140,252,28
 WL 6
 RT 220,46,26176
 RT 222,46,26688
 MA 136,252,24
 s_nop 0
 MA 72,252,56
 s_nop 0
 MA 76,252,60
 s_nop 0
 MC 96,192,144
 RB 224,35,8704
 MC 100,192,148
 s_add_u32 m0, m0, 64
 MV 164,192,84
 EX 128,128
 MV 160,192,80
 EX 129,129
 MC 108,196,148
 RB 228,35,13056
 CV 152,128,129
 MC 104,196,144
 buffer_load_dwordx4 v8, s[12:15], s70 offen offset:1024 lds
 EX 130,130
 MV 168,196,80
 EX 131,131
 MV 172,196,84
 CV 153,130,131
 v_mfma_f32_16x16x32_bf16 v[230:233], v[24:27], v[144:147], v[230:233]
 EX 136,136
 MC 112,200,144
 RB 232,35,8768
 MC 116,200,148
 EX 137,137
 MV 180,200,84
 EX 138,138
 MV 176,200,80
 EX 139,139
 MC 124,204,148
 WL 3
 RB 236,35,13120
 CV 154,136,137
 MC 120,204,144
 CV 155,138,139
 MV 184,204,80
 EX 132,132
 MV 188,204,84
 EX 133,133
 v_mfma_f32_16x16x32_bf16 v[234:237], v[24:27], v[148:151], v[234:237]
 EX 134,134
 MC 128,208,144
 RB 240,35,8832
 CV 156,132,133
 MC 132,208,148
 s_add_u32 m0, s59, 0x4400
 s_add_u32 s70, s80, 0
 MV 196,208,84
 EX 135,135
 MV 192,208,80
 CV 157,134,135
 MC 140,212,148
 RB 244,35,13184
 MC 136,212,144
 buffer_load_dwordx4 v3, s[16:19], s70 offen lds
 MV 200,212,80
 EX 140,140
 MV 204,212,84
 EX 141,141
 v_mfma_f32_16x16x32_bf16 v[96:99], v[24:27], v[80:83], v[96:99]
 EX 142,142
 MC 144,216,144
 RB 248,35,8896
 CV 158,140,141
 MC 148,216,148
 EX 143,143
 MV 212,216,84
 CV 159,142,143
 MV 208,216,80
 EX 64,64
 MC 156,220,148
 WL 3
 RB 252,35,13248
 MC 152,220,144
 EX 65,65
 MV 216,220,80
 EX 66,66
 MV 220,220,84
 EX 67,67
 v_mfma_f32_16x16x32_bf16 v[100:103], v[24:27], v[84:87], v[100:103]
 CV 88,64,65
 CV 89,66,67
 v_mfma_f32_16x16x32_bf16 v[112:115], a[224:227], a[0:3], 0
 RT 192,45,21760
 RT 194,45,22272
 v_mfma_f32_16x16x32_bf16 v[116:119], a[224:227], a[4:7], 0
 buffer_load_dwordx4 v4, s[16:19], s70 offen offset:1088 lds
 v_mfma_f32_16x16x32_bf16 v[52:55], a[224:227], a[36:39], 0
 EX 72,72
 v_mfma_f32_16x16x32_bf16 v[48:51], a[224:227], a[32:35], 0
 EX 73,73
 v_mfma_f32_16x16x32_bf16 v[124:127], a[228:231], a[4:7], 0
 RT 196,46,21760
 RT 198,46,22272
 v_mfma_f32_16x16x32_bf16 v[120:123], a[228:231], a[0:3], 0
 EX 74,74
 v_mfma_f32_16x16x32_bf16 v[56:59], a[228:231], a[32:35], 0
 EX 75,75
 v_mfma_f32_16x16x32_bf16 v[60:63], a[228:231], a[36:39], 0
 CV 90,72,73
 CV 91,74,75
 MA 112,232,8
 RT 200,45,21824
 RT 202,45,22336
 MA 116,232,12
 EX 68,68
 MA 52,232,44
 EX 69,69
 MA 48,232,40
 EX 70,70
 MA 124,236,12
 WL 6
 RT 204,46,21824
 RT 206,46,22336
 MA 120,236,8
 s_add_u32 m0, s59, 0x6600
 s_add_u32 s70, s80, 0x80
 MA 56,236,40
 EX 71,71
 MA 60,236,44
 CV 92,68,69
 CV 93,70,71
 MA 112,240,16
 RT 208,45,30464
 RT 210,45,30976
 MA 116,240,20
 buffer_load_dwordx4 v3, s[16:19], s70 offen lds
 MA 52,240,52
 EX 76,76
 MA 48,240,48
 EX 77,77
 MA 124,244,20
 RT 212,46,30464
 RT 214,46,30976
 MA 120,244,16
 EX 78,78
 MA 56,244,48
 EX 79,79
 MA 60,244,52
 CV 94,76,77
 CV 95,78,79
 MA 112,248,24
 RT 216,45,30528
 RT 218,45,31040
 MA 116,248,28
 s_nop 0
 MA 52,248,60
 s_nop 0
 MA 48,248,56
 s_nop 0
 MA 124,252,28
 WL 6
 RT 220,46,30528
 RT 222,46,31040
 MA 120,252,24
 buffer_load_dwordx4 v4, s[16:19], s70 offen offset:1088 lds
 v_add_u32 v45, s4, v44
 v_xor_b32 v46, 32, v45
 v_add_u32 v35, s4, v32
 MA 56,252,56
 s_nop 0
 MA 60,252,60
 s_nop 0
 MC 96,192,152
 s_waitcnt vmcnt(8)
 s_barrier
 RB 224,35,0
 MC 100,192,156
 s_mov_b32 s89, s88
 s_mov_b32 s88, s87
 MV 164,192,92
 EX 112,112
 MV 160,192,88
 EX 113,113
 MC 108,196,156
 RB 228,35,4352
 CV 144,112,113
 MC 104,196,152
 s_mov_b32 s87, s4
 s_add_u32 s59, s89, s69
 EX 114,114
 MV 168,196,88
 EX 115,115
 MV 172,196,92
 CV 145,114,115
 v_mfma_f32_16x16x32_bf16 v[230:233], v[24:27], v[152:155], v[230:233]
 EX 120,120
 MC 112,200,152
 RB 232,35,64
 MC 116,200,156
 s_add_u32 m0, s59, 0
 s_add_u32 s70, s78, 0x2000
 MV 180,200,92
 EX 121,121
 MV 176,200,88
 EX 122,122
 MC 124,204,156
 WL 3
 RB 236,35,4416
 CV 146,120,121
 MC 120,204,152
 buffer_load_dwordx4 v8, s[12:15], s70 offen lds
 MV 184,204,88
 EX 123,123
 MV 188,204,92
 CV 147,122,123
 v_mfma_f32_16x16x32_bf16 v[234:237], v[24:27], v[156:159], v[234:237]
 EX 116,116
 MC 128,208,152
 RB 240,35,128
 MC 132,208,156
 EX 117,117
 MV 196,208,92
 EX 118,118
 MV 192,208,88
 EX 119,119
 MC 140,212,156
 RB 244,35,4480
 CV 148,116,117
 MC 136,212,152
 CV 149,118,119
 MV 200,212,88
 EX 124,124
 MV 204,212,92
 EX 125,125
 v_mfma_f32_16x16x32_bf16 v[96:99], v[24:27], v[88:91], v[96:99]
 EX 126,126
 MC 144,216,152
 RB 248,35,192
 CV 150,124,125
 MC 148,216,156
 s_add_u32 m0, m0, 64
 MV 212,216,92
 EX 127,127
 MV 208,216,88
 CV 151,126,127
 MC 156,220,156
 WL 3
 RB 252,35,4544
 MC 152,220,152
 buffer_load_dwordx4 v8, s[12:15], s70 offen offset:1024 lds
 MV 216,220,88
 EX 48,48
 MV 220,220,92
 EX 49,49
 v_mfma_f32_16x16x32_bf16 v[100:103], v[24:27], v[92:95], v[100:103]
 EX 50,50
 v_mfma_f32_16x16x32_bf16 v[128:131], a[224:227], a[0:3], 0
 RT 192,45,17408
 RT 194,45,17920
 v_mfma_f32_16x16x32_bf16 v[132:135], a[224:227], a[4:7], 0
 EX 51,51
 v_mfma_f32_16x16x32_bf16 v[68:71], a[224:227], a[36:39], 0
 CV 80,48,49
 CV 81,50,51
 v_mfma_f32_16x16x32_bf16 v[64:67], a[224:227], a[32:35], 0
 EX 56,56
 v_mfma_f32_16x16x32_bf16 v[140:143], a[228:231], a[4:7], 0
 RT 196,46,17408
 RT 198,46,17920
 v_mfma_f32_16x16x32_bf16 v[136:139], a[228:231], a[0:3], 0
 EX 57,57
 v_mfma_f32_16x16x32_bf16 v[72:75], a[228:231], a[32:35], 0
 EX 58,58
 v_mfma_f32_16x16x32_bf16 v[76:79], a[228:231], a[36:39], 0
 EX 59,59
 MA 128,232,8
 RT 200,45,17472
 RT 202,45,17984
 MA 132,232,12
 s_add_u32 m0, s59, 0x2200
 s_add_u32 s70, s78, 0x4000
 MA 68,232,44
 CV 82,56,57
 CV 83,58,59
 MA 64,232,40
 EX 52,52
 MA 140,236,12
 WL 6
 RT 204,46,17472
 RT 206,46,17984
 MA 136,236,8
 buffer_load_dwordx4 v8, s[12:15], s70 offen lds
 MA 72,236,40
 EX 53,53
 MA 76,236,44
 EX 54,54
 MA 128,240,16
 RT 208,45,26112
 RT 210,45,26624
 MA 132,240,20
 EX 55,55
 MA 68,240,52
 CV 84,52,53
 CV 85,54,55
 MA 64,240,48
 EX 60,60
 MA 140,244,20
 RT 212,46,26112
 RT 214,46,26624
 MA 136,244,16
 EX 61,61
 MA 72,244,48
 EX 62,62
 MA 76,244,52
 EX 63,63
 MA 128,248,24
 RT 216,45,26176
 RT 218,45,26688
 MA 132,248,28
 s_add_u32 s4, s87, 0x9900
 s_cmp_lt_u32 s4, 0x26400
 s_cselect_b32 s4, s4, 0
 MA 68,248,60
 CV 86,60,61
 CV 87,62,63
 MA 64,248,56
 s_nop 0
 MA 140,252,28
 WL 6
 RT 220,46,26176
 RT 222,46,26688
 MA 136,252,24
 s_add_u32 m0, m0, 64
 MA 72,252,56
 s_nop 0
 MA 76,252,60
 s_nop 0
 MC 96,192,144
 RB 224,35,8704
 MC 100,192,148
 buffer_load_dwordx4 v8, s[12:15], s70 offen offset:1024 lds
 MV 164,192,84
 EX 128,128
 MV 160,192,80
 EX 129,129
 MC 108,196,148
 RB 228,35,13056
 CV 152,128,129
 MC 104,196,144
 EX 130,130
 MV 168,196,80
 EX 131,131
 MV 172,196,84
 CV 153,130,131
 v_mfma_f32_16x16x32_bf16 v[230:233], v[24:27], v[144:147], v[230:233]
 EX 136,136
 MC 112,200,144
 RB 232,35,8768
 MC 116,200,148
 EX 137,137
 MV 180,200,84
 EX 138,138
 MV 176,200,80
 EX 139,139
 MC 124,204,148
 WL 3
 RB 236,35,13120
 CV 154,136,137
 MC 120,204,144
 s_add_u32 m0, s59, 0x4400
 s_add_u32 s70, s81, 0
 MV 184,204,80
 CV 155,138,139
 MV 188,204,84
 EX 132,132
 v_mfma_f32_16x16x32_bf16 v[234:237], v[24:27], v[148:151], v[234:237]
 EX 133,133
 MC 128,208,144
 RB 240,35,8832
 CV 156,132,133
 MC 132,208,148
 buffer_load_dwordx4 v3, s[16:19], s70 offen lds
 MV 196,208,84
 EX 134,134
 MV 192,208,80
 EX 135,135
 MC 140,212,148
 RB 244,35,13184
 CV 157,134,135
 MC 136,212,144
 EX 140,140
 MV 200,212,80
 EX 141,141
 MV 204,212,84
 EX 142,142
 v_mfma_f32_16x16x32_bf16 v[96:99], v[24:27], v[80:83], v[96:99]
 EX 143,143
 MC 144,216,144
 RB 248,35,8896
 CV 158,140,141
 MC 148,216,148
 CV 159,142,143
 MV 212,216,84
 EX 64,64
 MV 208,216,80
 EX 65,65
 MC 156,220,148
 WL 3
 RB 252,35,13248
 CV 88,64,65
 MC 152,220,144
 buffer_load_dwordx4 v4, s[16:19], s70 offen offset:1088 lds
 MV 216,220,80
 EX 66,66
 MV 220,220,84
 EX 67,67
 v_mfma_f32_16x16x32_bf16 v[100:103], v[24:27], v[84:87], v[100:103]
 CV 89,66,67
 v_mfma_f32_16x16x32_bf16 v[112:115], a[224:227], a[0:3], 0
 RT 192,45,21760
 RT 194,45,22272
 v_mfma_f32_16x16x32_bf16 v[116:119], a[224:227], a[4:7], 0
 EX 72,72
 v_mfma_f32_16x16x32_bf16 v[52:55], a[224:227], a[36:39], 0
 EX 73,73
 v_mfma_f32_16x16x32_bf16 v[48:51], a[224:227], a[32:35], 0
 EX 74,74
 v_mfma_f32_16x16x32_bf16 v[124:127], a[228:231], a[4:7], 0
 RT 196,46,21760
 RT 198,46,22272
 v_mfma_f32_16x16x32_bf16 v[120:123], a[228:231], a[0:3], 0
 EX 75,75
 v_mfma_f32_16x16x32_bf16 v[56:59], a[228:231], a[32:35], 0
 CV 90,72,73
 CV 91,74,75
 v_mfma_f32_16x16x32_bf16 v[60:63], a[228:231], a[36:39], 0
 EX 68,68
 MA 112,232,8
 RT 200,45,21824
 RT 202,45,22336
 MA 116,232,12
 s_add_u32 m0, s59, 0x6600
 s_add_u32 s70, s81, 0x80
 MA 52,232,44
 EX 69,69
 MA 48,232,40
 EX 70,70
 MA 124,236,12
 WL 6
 RT 204,46,21824
 RT 206,46,22336
 MA 120,236,8
 buffer_load_dwordx4 v3, s[16:19], s70 offen lds
 MA 56,236,40
 EX 71,71
 MA 60,236,44
 CV 92,68,69
 CV 93,70,71
 MA 112,240,16
 RT 208,45,30464
 RT 210,45,30976
 MA 116,240,20
 EX 76,76
 MA 52,240,52
 EX 77,77
 MA 48,240,48
 EX 78,78
 MA 124,244,20
 RT 212,46,30464
 RT 214,46,30976
 MA 120,244,16
 EX 79,79
 MA 56,244,48
 CV 94,76,77
 CV 95,78,79
 MA 60,244,52
 s_nop 0
 MA 112,248,24
 RT 216,45,30528
 RT 218,45,31040
 MA 116,248,28
 buffer_load_dwordx4 v4, s[16:19], s70 offen offset:1088 lds
 MA 52,248,60
 s_nop 0
 MA 48,248,56
 s_nop 0
 MA 124,252,28
 WL 6
 RT 220,46,30528
 RT 222,46,31040
 MA 120,252,24
 v_add_u32 v45, s4, v44
 v_xor_b32 v46, 32, v45
 v_add_u32 v35, s4, v32
 MA 56,252,56
 s_nop 0
 MA 60,252,60
 s_nop 0
 MC 96,192,152
 s_waitcnt vmcnt(8)
 s_barrier
 RB 224,35,0
 MC 100,192,156
 s_mov_b32 s89, s88
 s_mov_b32 s88, s87
 MV 164,192,92
 EX 112,112
 MV 160,192,88
 EX 113,113
 MC 108,196,156
 RB 228,35,4352
 CV 144,112,113
 MC 104,196,152
 s_mov_b32 s87, s4
 s_add_u32 s59, s89, s69
 EX 114,114
 MV 168,196,88
 EX 115,115
 MV 172,196,92
 CV 145,114,115
 v_mfma_f32_16x16x32_bf16 v[230:233], v[24:27], v[152:155], v[230:233]
 EX 120,120
 MC 112,200,152
 RB 232,35,64
 MC 116,200,156
 s_add_u32 s78, s78, 0x4000
 s_add_u32 s81, s81, 0x4000
 MV 180,200,92
 EX 121,121
 MV 176,200,88
 EX 122,122
 MC 124,204,156
 WL 3
 RB 236,35,4416
 CV 146,120,121
 MC 120,204,152
 s_add_u32 m0, s59, 0
 s_add_u32 s70, s78, 0x2000
 MV 184,204,88
 EX 123,123
 MV 188,204,92
 CV 147,122,123
 v_mfma_f32_16x16x32_bf16 v[234:237], v[24:27], v[156:159], v[234:237]
 EX 116,116
 MC 128,208,152
 RB 240,35,128
 MC 132,208,156
 buffer_load_dwordx4 v8, s[12:15], s70 offen lds
 MV 196,208,92
 EX 117,117
 MV 192,208,88
 EX 118,118
 MC 140,212,156
 RB 244,35,4480
 CV 148,116,117
 MC 136,212,152
 EX 119,119
 MV 200,212,88
 CV 149,118,119
 MV 204,212,92
 EX 124,124
 v_mfma_f32_16x16x32_bf16 v[96:99], v[24:27], v[88:91], v[96:99]
 EX 125,125
 MC 144,216,152
 RB 248,35,192
 CV 150,124,125
 MC 148,216,156
 EX 126,126
 MV 212,216,92
 EX 127,127
 MV 208,216,88
 CV 151,126,127
 MC 156,220,156
 WL 3
 RB 252,35,4544
 MC 152,220,152
 s_add_u32 m0, m0, 64
 MV 216,220,88
 EX 48,48
 MV 220,220,92
 EX 49,49
 v_mfma_f32_16x16x32_bf16 v[100:103], v[24:27], v[92:95], v[100:103]
 EX 50,50
 v_mfma_f32_16x16x32_bf16 v[128:131], a[224:227], a[0:3], 0
 RT 192,45,17408
 RT 194,45,17920
 v_mfma_f32_16x16x32_bf16 v[132:135], a[224:227], a[4:7], 0
 buffer_load_dwordx4 v8, s[12:15], s70 offen offset:1024 lds
 v_mfma_f32_16x16x32_bf16 v[68:71], a[224:227], a[36:39], 0
 EX 51,51
 v_mfma_f32_16x16x32_bf16 v[64:67], a[224:227], a[32:35], 0
 CV 80,48,49
 CV 81,50,51
 v_mfma_f32_16x16x32_bf16 v[140:143], a[228:231], a[4:7], 0
 RT 196,46,17408
 RT 198,46,17920
 v_mfma_f32_16x16x32_bf16 v[136:139], a[228:231], a[0:3], 0
 EX 56,56
 v_mfma_f32_16x16x32_bf16 v[72:75], a[228:231], a[32:35], 0
 EX 57,57
 v_mfma_f32_16x16x32_bf16 v[76:79], a[228:231], a[36:39], 0
 EX 58,58
 MA 128,232,8
 RT 200,45,17472
 RT 202,45,17984
 MA 132,232,12
 EX 59,59
 MA 68,232,44
 CV 82,56,57
 CV 83,58,59
 MA 64,232,40
 EX 52,52
 MA 140,236,12
 WL 6
 RT 204,46,17472
 RT 206,46,17984
 MA 136,236,8
 s_add_u32 s4, s87, 0x9900
 s_cmp_lt_u32 s4, 0x26400
 s_cselect_b32 s4, s4, 0
 MA 72,236,40
 EX 53,53
 MA 76,236,44
 EX 54,54
 MA 128,240,16
 RT 208,45,26112
 RT 210,45,26624
 MA 132,240,20
 s_add_u32 m0, s59, 0x2200
 s_add_u32 s70, s78, 0x4000
 MA 68,240,52
 EX 55,55
 MA 64,240,48
 CV 84,52,53
 CV 85,54,55
 MA 140,244,20
 RT 212,46,26112
 RT 214,46,26624
 MA 136,244,16
 buffer_load_dwordx4 v8, s[12:15], s70 offen lds
 MA 72,244,48
 EX 60,60
 MA 76,244,52
 EX 61,61
 MA 128,248,24
 RT 216,45,26176
 RT 218,45,26688
 MA 132,248,28
 EX 62,62
 MA 68,248,60
 EX 63,63
 MA 64,248,56
 CV 86,60,61
 CV 87,62,63
 MA 140,252,28
 WL 6
 RT 220,46,26176
 RT 222,46,26688
 MA 136,252,24
 s_nop 0
 MA 72,252,56
 s_nop 0
 MA 76,252,60
 s_nop 0
 MC 96,192,144
 RB 224,35,8704
 MC 100,192,148
 s_add_u32 m0, m0, 64
 MV 164,192,84
 EX 128,128
 MV 160,192,80
 EX 129,129
 MC 108,196,148
 RB 228,35,13056
 CV 152,128,129
 MC 104,196,144
 buffer_load_dwordx4 v8, s[12:15], s70 offen offset:1024 lds
 EX 130,130
 MV 168,196,80
 EX 131,131
 MV 172,196,84
 CV 153,130,131
 v_mfma_f32_16x16x32_bf16 v[230:233], v[24:27], v[144:147], v[230:233]
 EX 136,136
 MC 112,200,144
 RB 232,35,8768
 MC 116,200,148
 EX 137,137
 MV 180,200,84
 EX 138,138
 MV 176,200,80
 EX 139,139
 MC 124,204,148
 WL 3
 RB 236,35,13120
 CV 154,136,137
 MC 120,204,144
 CV 155,138,139
 MV 184,204,80
 EX 132,132
 MV 188,204,84
 EX 133,133
 v_mfma_f32_16x16x32_bf16 v[234:237], v[24:27], v[148:151], v[234:237]
 EX 134,134
 MC 128,208,144
 RB 240,35,8832
 CV 156,132,133
 MC 132,208,148
 s_add_u32 m0, s59, 0x4400
 s_add_u32 s70, s81, 0
 MV 196,208,84
 EX 135,135
 MV 192,208,80
 CV 157,134,135
 MC 140,212,148
 RB 244,35,13184
 MC 136,212,144
 buffer_load_dwordx4 v3, s[16:19], s70 offen lds
 MV 200,212,80
 EX 140,140
 MV 204,212,84
 EX 141,141
 v_mfma_f32_16x16x32_bf16 v[96:99], v[24:27], v[80:83], v[96:99]
 EX 142,142
 MC 144,216,144
 RB 248,35,8896
 CV 158,140,141
 MC 148,216,148
 EX 143,143
 MV 212,216,84
 CV 159,142,143
 MV 208,216,80
 EX 64,64
 MC 156,220,148
 WL 3
 RB 252,35,13248
 MC 152,220,144
 EX 65,65
 MV 216,220,80
 EX 66,66
 MV 220,220,84
 EX 67,67
 v_mfma_f32_16x16x32_bf16 v[100:103], v[24:27], v[84:87], v[100:103]
 CV 88,64,65
 CV 89,66,67
 v_mfma_f32_16x16x32_bf16 v[112:115], a[224:227], a[64:67], 0
 RT 192,45,21760
 RT 194,45,22272
 v_mfma_f32_16x16x32_bf16 v[116:119], a[224:227], a[68:71], 0
 buffer_load_dwordx4 v4, s[16:19], s70 offen offset:1088 lds
 EX 72,72
 EX 73,73
 v_mfma_f32_16x16x32_bf16 v[124:127], a[228:231], a[68:71], 0
 RT 196,46,21760
 RT 198,46,22272
 v_mfma_f32_16x16x32_bf16 v[120:123], a[228:231], a[64:67], 0
 EX 74,74
 EX 75,75
 MA 112,232,72
 RT 200,45,21824
 RT 202,45,22336
 MA 116,232,76
 CV 90,72,73
 CV 91,74,75
 EX 68,68
 MA 124,236,76
 WL 6
 RT 204,46,21824
 RT 206,46,22336
 MA 120,236,72
 s_add_u32 m0, s59, 0x6600
 s_add_u32 s70, s81, 0x80
 EX 69,69
 EX 70,70
 MA 112,240,80
 RT 208,45,30464
 RT 210,45,30976
 MA 116,240,84
 buffer_load_dwordx4 v3, s[16:19], s70 offen lds
 EX 71,71
 CV 92,68,69
 CV 93,70,71
 MA 124,244,84
 RT 212,46,30464
 RT 214,46,30976
 MA 120,244,80
 EX 76,76
 EX 77,77
 MA 112,248,88
 RT 216,45,30528
 RT 218,45,31040
 MA 116,248,92
 EX 78,78
 CV 94,76,77
 MA 124,252,92
 WL 6
 RT 220,46,30528
 RT 222,46,31040
 MA 120,252,88
 buffer_load_dwordx4 v4, s[16:19], s70 offen offset:1088 lds
 v_add_u32 v45, s4, v44
 v_xor_b32 v46, 32, v45
 v_add_u32 v35, s4, v32
 EX 79,79
 s_nop 0
 CV 95,78,79
 MC 96,192,152
 s_waitcnt vmcnt(8)
 s_barrier
 RB 224,35,0
 MC 100,192,156
 s_mov_b32 s89, s88
 s_mov_b32 s88, s87
 MV 164,192,92
 EX 112,112
 MV 160,192,88
 EX 113,113
 MC 108,196,156
 RB 228,35,4352
 CV 144,112,113
 MC 104,196,152
 s_mov_b32 s87, s4
 s_add_u32 s59, s89, s69
 MV 168,196,88
 EX 114,114
 MV 172,196,92
 EX 115,115
 v_mfma_f32_16x16x32_bf16 v[230:233], v[24:27], v[152:155], v[230:233]
 CV 145,114,115
 MC 112,200,152
 RB 232,35,64
 MC 116,200,156
 s_add_u32 s78, s78, 0x4000
 s_add_u32 s81, s81, 0x4000
 MV 180,200,92
 EX 120,120
 MV 176,200,88
 EX 121,121
 MC 124,204,156
 WL 3
 RB 236,35,4416
 CV 146,120,121
 MC 120,204,152
 s_add_u32 m0, s59, 0
 s_add_u32 s70, s78, 0x2000
 MV 184,204,88
 EX 122,122
 MV 188,204,92
 EX 123,123
 v_mfma_f32_16x16x32_bf16 v[234:237], v[24:27], v[156:159], v[234:237]
 CV 147,122,123
 MC 128,208,152
 RB 240,35,128
 MC 132,208,156
 buffer_load_dwordx4 v8, s[12:15], s70 offen lds
 MV 196,208,92
 EX 116,116
 MV 192,208,88
 EX 117,117
 MC 140,212,156
 RB 244,35,4480
 CV 148,116,117
 MC 136,212,152
 EX 118,118
 MV 200,212,88
 EX 119,119
 MV 204,212,92
 CV 149,118,119
 v_mfma_f32_16x16x32_bf16 v[96:99], v[24:27], v[88:91], v[96:99]
 EX 124,124
 MC 144,216,152
 RB 248,35,192
 MC 148,216,156
 EX 125,125
 MV 212,216,92
 EX 126,126
 MV 208,216,88
 EX 127,127
 MC 156,220,156
 WL 3
 RB 252,35,4544
 CV 150,124,125
 MC 152,220,152
 s_add_u32 m0, m0, 64
 CV 151,126,127
 MV 216,220,88
 s_nop 0
 MV 220,220,92
 v_mfma_f32_16x16x32_bf16 v[100:103], v[24:27], v[92:95], v[100:103]
 s_nop 0
 v_mfma_f32_16x16x32_bf16 v[128:131], a[224:227], a[64:67], 0
 RT 192,45,17408
 RT 194,45,17920
 v_mfma_f32_16x16x32_bf16 v[132:135], a[224:227], a[68:71], 0
 buffer_load_dwordx4 v8, s[12:15], s70 offen offset:1024 lds
 v_mov_b32 v224, v230
 v_mov_b32 v225, v234
 v_mfma_f32_16x16x32_bf16 v[140:143], a[228:231], a[68:71], 0
 RT 196,46,17408
 RT 198,46,17920
 v_mfma_f32_16x16x32_bf16 v[136:139], a[228:231], a[64:67], 0
 v_mov_b32 v226, v96
 v_mov_b32 v227, v100
 MA 128,232,72
 RT 200,45,17472
 RT 202,45,17984
 MA 132,232,76
 v_rcp_f32 v250, v224
 MA 140,236,76
 WL 6
 RT 204,46,17472
 RT 206,46,17984
 MA 136,236,72
 s_add_u32 s4, s87, 0x9900
 s_cmp_lt_u32 s4, 0x26400
 s_cselect_b32 s4, s4, 0
 MA 128,240,80
 RT 208,45,26112
 RT 210,45,26624
 MA 132,240,84
 s_add_u32 m0, s59, 0x2200
 s_add_u32 s70, s78, 0x4000
 v_rcp_f32 v251, v225
 MA 140,244,84
 RT 212,46,26112
 RT 214,46,26624
 MA 136,244,80
 buffer_load_dwordx4 v8, s[12:15], s70 offen lds
 MA 128,248,88
 RT 216,45,26176
 RT 218,45,26688
 MA 132,248,92
 v_rcp_f32 v252, v226
 MA 140,252,92
 WL 6
 RT 220,46,26176
 RT 222,46,26688
 MA 136,252,88
 v_rcp_f32 v253, v227
 v_mfma_f32_16x16x32_bf16 v[48:51], a[192:195], v[144:147], 0
 RB 224,35,8704
 v_accvgpr_read_b32 v230, a96
 v_mfma_f32_16x16x32_bf16 v[52:55], a[192:195], v[148:151], 0
 s_add_u32 m0, m0, 64
 v_accvgpr_read_b32 v231, a97
 v_accvgpr_read_b32 v232, a98
 v_accvgpr_read_b32 v233, a99
 v_accvgpr_read_b32 v234, a100
 v_accvgpr_read_b32 v235, a101
 v_accvgpr_read_b32 v236, a102
 v_accvgpr_read_b32 v237, a103
 v_accvgpr_read_b32 v238, a104
 v_accvgpr_read_b32 v239, a105
 v_accvgpr_read_b32 v240, a106
 v_accvgpr_read_b32 v241, a107
 v_accvgpr_read_b32 v242, a108
 v_accvgpr_read_b32 v243, a109
 v_accvgpr_read_b32 v244, a110
 v_accvgpr_read_b32 v245, a111
 ML 230,230,250
 ML 231,231,250
 ML 232,232,250
 ML 233,233,250
 ML 234,234,251
 ML 235,235,251
 ML 236,236,251
 v_mfma_f32_16x16x32_bf16 v[60:63], a[196:199], v[148:151], 0
 RB 228,35,13056
 ML 237,237,251
 v_mfma_f32_16x16x32_bf16 v[56:59], a[196:199], v[144:147], 0
 buffer_load_dwordx4 v8, s[12:15], s70 offen offset:1024 lds
 ML 238,238,250
 ML 239,239,250
 ML 240,240,250
 ML 241,241,250
 ML 242,242,251
 ML 243,243,251
 ML 244,244,251
 ML 245,245,251
 CV 230,230,231
 CV 232,232,233
 CV 234,234,235
 CV 236,236,237
 CV 238,238,239
 CV 240,240,241
 CV 242,242,243
 CV 244,244,245
 AW 96,230
 AW 97,232
 AW 98,238
 AW 99,240
 AW 100,234
 AW 101,236
 v_mfma_f32_16x16x32_bf16 v[64:67], a[200:203], v[144:147], 0
 RB 232,35,8768
 AW 102,242
 v_mfma_f32_16x16x32_bf16 v[68:71], a[200:203], v[148:151], 0
 AW 103,244
 v_accvgpr_read_b32 v230, a112
 v_accvgpr_read_b32 v231, a113
 v_accvgpr_read_b32 v232, a114
 v_accvgpr_read_b32 v233, a115
 v_accvgpr_read_b32 v234, a116
 v_accvgpr_read_b32 v235, a117
 v_accvgpr_read_b32 v236, a118
 v_accvgpr_read_b32 v237, a119
 v_accvgpr_read_b32 v238, a120
 v_accvgpr_read_b32 v239, a121
 v_accvgpr_read_b32 v240, a122
 v_accvgpr_read_b32 v241, a123
 v_accvgpr_read_b32 v242, a124
 v_accvgpr_read_b32 v243, a125
 v_accvgpr_read_b32 v244, a126
 v_accvgpr_read_b32 v245, a127
 ML 230,230,250
 ML 231,231,250
 ML 232,232,250
 ML 233,233,250
 ML 234,234,251
 v_mfma_f32_16x16x32_bf16 v[16:19], v[24:27], v[144:147], 0
 ML 235,235,251
 ML 236,236,251
 v_mfma_f32_16x16x32_bf16 v[76:79], a[204:207], v[148:151], 0
 WL 3
 RB 236,35,13120
 ML 237,237,251
 v_mfma_f32_16x16x32_bf16 v[72:75], a[204:207], v[144:147], 0
 ML 238,238,250
 ML 239,239,250
 ML 240,240,250
 ML 241,241,250
 ML 242,242,251
 ML 243,243,251
 ML 244,244,251
 ML 245,245,251
 CV 230,230,231
 CV 232,232,233
 CV 234,234,235
 CV 236,236,237
 CV 238,238,239
 CV 240,240,241
 CV 242,242,243
 CV 244,244,245
 AW 112,230
 AW 113,232
 AW 114,238
 AW 115,240
 AW 116,234
 AW 117,236
 v_mfma_f32_16x16x32_bf16 v[80:83], a[208:211], v[144:147], 0
 RB 240,35,8832
 AW 118,242
 v_mfma_f32_16x16x32_bf16 v[84:87], a[208:211], v[148:151], 0
 s_add_u32 m0, s59, 0x4400
 s_add_u32 s70, s81, 0
 AW 119,244
 v_accvgpr_read_b32 v230, a128
 v_accvgpr_read_b32 v231, a129
 v_accvgpr_read_b32 v232, a130
 v_accvgpr_read_b32 v233, a131
 v_accvgpr_read_b32 v234, a132
 v_accvgpr_read_b32 v235, a133
 v_accvgpr_read_b32 v236, a134
 v_accvgpr_read_b32 v237, a135
 v_accvgpr_read_b32 v238, a136
 v_accvgpr_read_b32 v239, a137
 v_accvgpr_read_b32 v240, a138
 v_accvgpr_read_b32 v241, a139
 v_accvgpr_read_b32 v242, a140
 v_accvgpr_read_b32 v243, a141
 v_accvgpr_read_b32 v244, a142
 v_accvgpr_read_b32 v245, a143
 ML 230,230,250
 ML 231,231,250
 ML 232,232,250
 ML 233,233,250
 ML 234,234,251
 v_mfma_f32_16x16x32_bf16 v[92:95], a[212:215], v[148:151], 0
 RB 244,35,13184
 ML 235,235,251
 v_mfma_f32_16x16x32_bf16 v[88:91], a[212:215], v[144:147], 0
 buffer_load_dwordx4 v3, s[16:19], s70 offen lds
 ML 236,236,251
 ML 237,237,251
 ML 238,238,250
 ML 239,239,250
 ML 240,240,250
 ML 241,241,250
 ML 242,242,251
 ML 243,243,251
 ML 244,244,251
 ML 245,245,251
 CV 230,230,231
 CV 232,232,233
 CV 234,234,235
 CV 236,236,237
 CV 238,238,239
 CV 240,240,241
 CV 242,242,243
 CV 244,244,245
 AW 128,230
 AW 129,232
 AW 130,238
 AW 131,240
 v_mfma_f32_16x16x32_bf16 v[20:23], v[24:27], v[148:151], 0
 AW 132,234
 AW 133,236
 v_mfma_f32_16x16x32_bf16 v[96:99], a[216:219], v[144:147], 0
 RB 248,35,8896
 AW 134,242
 v_mfma_f32_16x16x32_bf16 v[100:103], a[216:219], v[148:151], 0
 AW 135,244
 v_accvgpr_read_b32 v230, a144
 v_accvgpr_read_b32 v231, a145
 v_accvgpr_read_b32 v232, a146
 v_accvgpr_read_b32 v233, a147
 v_accvgpr_read_b32 v234, a148
 v_accvgpr_read_b32 v235, a149
 v_accvgpr_read_b32 v236, a150
 v_accvgpr_read_b32 v237, a151
 v_accvgpr_read_b32 v238, a152
 v_accvgpr_read_b32 v239, a153
 v_accvgpr_read_b32 v240, a154
 v_accvgpr_read_b32 v241, a155
 v_accvgpr_read_b32 v242, a156
 v_accvgpr_read_b32 v243, a157
 v_accvgpr_read_b32 v244, a158
 v_accvgpr_read_b32 v245, a159
 ML 230,230,250
 ML 231,231,250
 ML 232,232,250
 ML 233,233,250
 v_mfma_f32_16x16x32_bf16 v[108:111], a[220:223], v[148:151], 0
 WL 3
 RB 252,35,13248
 ML 234,234,251
 v_mfma_f32_16x16x32_bf16 v[104:107], a[220:223], v[144:147], 0
 ML 235,235,251
 ML 236,236,251
 ML 237,237,251
 ML 238,238,250
 ML 239,239,250
 ML 240,240,250
 ML 241,241,250
 ML 242,242,251
 ML 243,243,251
 ML 244,244,251
 ML 245,245,251
 CV 230,230,231
 CV 232,232,233
 CV 234,234,235
 CV 236,236,237
 CV 238,238,239
 CV 240,240,241
 CV 242,242,243
 CV 244,244,245
 AW 144,230
 AW 145,232
 v_mfma_f32_16x16x32_bf16 v[112:115], a[224:227], a[64:67], 0
 RT 192,45,21760
 RT 194,45,22272
 v_mfma_f32_16x16x32_bf16 v[116:119], a[224:227], a[68:71], 0
 buffer_load_dwordx4 v4, s[16:19], s70 offen offset:1088 lds
 AW 146,238
 AW 147,240
 AW 148,234
 AW 149,236
 AW 150,242
 AW 151,244
 ML 230,160,252
 ML 231,161,252
 ML 232,162,252
 ML 233,163,252
 CV 230,230,231
 CV 232,232,233
 AW 104,230
 AW 105,232
 ML 234,168,252
 ML 235,169,252
 ML 236,170,252
 ML 237,171,252
 CV 234,234,235
 CV 236,236,237
 AW 106,234
 AW 107,236
 v_mfma_f32_16x16x32_bf16 v[124:127], a[228:231], a[68:71], 0
 RT 196,46,21760
 RT 198,46,22272
 v_mfma_f32_16x16x32_bf16 v[120:123], a[228:231], a[64:67], 0
 ML 238,164,253
 ML 239,165,253
 ML 240,166,253
 ML 241,167,253
 CV 238,238,239
 CV 240,240,241
 AW 108,238
 AW 109,240
 ML 242,172,253
 ML 243,173,253
 ML 244,174,253
 ML 245,175,253
 CV 242,242,243
 CV 244,244,245
 AW 110,242
 AW 111,244
 ML 230,176,252
 ML 231,177,252
 ML 232,178,252
 ML 233,179,252
 CV 230,230,231
 CV 232,232,233
 MA 112,232,72
 RT 200,45,21824
 RT 202,45,22336
 MA 116,232,76
 AW 120,230
 AW 121,232
 ML 234,184,252
 ML 235,185,252
 ML 236,186,252
 ML 237,187,252
 CV 234,234,235
 CV 236,236,237
 AW 122,234
 AW 123,236
 ML 238,180,253
 ML 239,181,253
 ML 240,182,253
 ML 241,183,253
 CV 238,238,239
 CV 240,240,241
 AW 124,238
 AW 125,240
 ML 242,188,253
 ML 243,189,253
 ML 244,190,253
 ML 245,191,253
 MA 124,236,76
 WL 6
 RT 204,46,21824
 RT 206,46,22336
 MA 120,236,72
 s_add_u32 m0, s59, 0x6600
 s_add_u32 s70, s81, 0x80
 CV 242,242,243
 CV 244,244,245
 AW 126,242
 AW 127,244
 ML 230,192,252
 ML 231,193,252
 ML 232,194,252
 ML 233,195,252
 CV 230,230,231
 CV 232,232,233
 AW 136,230
 AW 137,232
 ML 234,200,252
 ML 235,201,252
 ML 236,202,252
 ML 237,203,252
 CV 234,234,235
 CV 236,236,237
 AW 138,234
 AW 139,236
 ML 238,196,253
 ML 239,197,253
 MA 112,240,80
 RT 208,45,30464
 RT 210,45,30976
 MA 116,240,84
 buffer_load_dwordx4 v3, s[16:19], s70 offen lds
 ML 240,198,253
 ML 241,199,253
 CV 238,238,239
 CV 240,240,241
 AW 140,238
 AW 141,240
 ML 242,204,253
 ML 243,205,253
 ML 244,206,253
 ML 245,207,253
 CV 242,242,243
 CV 244,244,245
 AW 142,242
 AW 143,244
 ML 230,208,252
 ML 231,209,252
 ML 232,210,252
 ML 233,211,252
 CV 230,230,231
 CV 232,232,233
 AW 152,230
 AW 153,232
 MA 124,244,84
 RT 212,46,30464
 RT 214,46,30976
 MA 120,244,80
 ML 234,216,252
 ML 235,217,252
 ML 236,218,252
 ML 237,219,252
 CV 234,234,235
 CV 236,236,237
 AW 154,234
 AW 155,236
 ML 238,212,253
 ML 239,213,253
 ML 240,214,253
 ML 241,215,253
 CV 238,238,239
 CV 240,240,241
 AW 156,238
 AW 157,240
 ML 242,220,253
 ML 243,221,253
 ML 244,222,253
 ML 245,223,253
 CV 242,242,243
 CV 244,244,245
 MA 112,248,88
 RT 216,45,30528
 RT 218,45,31040
 MA 116,248,92
 AW 158,242
 AW 159,244
 EX 128,128
 EX 129,129
 EX 130,130
 EX 131,131
 CV 152,128,129
 CV 153,130,131
 EX 136,136
 EX 137,137
 EX 138,138
 EX 139,139
 CV 154,136,137
 MA 124,252,92
 WL 6
 RT 220,46,30528
 RT 222,46,31040
 MA 120,252,88
 buffer_load_dwordx4 v4, s[16:19], s70 offen offset:1088 lds
 v_add_u32 v45, s4, v44
 v_xor_b32 v46, 32, v45
 v_add_u32 v35, s4, v32
 CV 155,138,139
 EX 132,132
 EX 133,133
 EX 134,134
 EX 135,135
 CV 156,132,133
 CV 157,134,135
 EX 140,140
 EX 141,141
 EX 142,142
 EX 143,143
 CV 158,140,141
 CV 159,142,143
 MV 48,192,152
 s_mov_b32 s91, 4
.p2align 3
L_A_loop1:
 s_waitcnt vmcnt(8)
 s_barrier
 RB 224,35,0
 MV 52,192,156
 s_mov_b32 s89, s88
 s_mov_b32 s88, s87
 EX 112,112
 MV 60,196,156
 RB 228,35,4352
 MV 56,196,152
 s_mov_b32 s87, s4
 s_add_u32 s59, s89, s69
 EX 113,113
 MV 64,200,152
 RB 232,35,64
 CV 144,112,113
 MV 68,200,156
 s_add_u32 s78, s78, 0x4000
 s_add_u32 s81, s81, 0x4000
 EX 114,114
 v_mfma_f32_16x16x32_bf16 v[16:19], v[24:27], v[152:155], v[16:19]
 EX 115,115
 MV 76,204,156
 WL 3
 RB 236,35,4416
 CV 145,114,115
 MV 72,204,152
 s_add_u32 m0, s59, 0
 s_add_u32 s70, s78, 0x2000
 EX 120,120
 MV 80,208,152
 RB 240,35,128
 MV 84,208,156
 buffer_load_dwordx4 v8, s[12:15], s70 offen lds
 EX 121,121
 MV 92,212,156
 RB 244,35,4480
 CV 146,120,121
 MV 88,212,152
 EX 122,122
 v_mfma_f32_16x16x32_bf16 v[20:23], v[24:27], v[156:159], v[20:23]
 EX 123,123
 MV 96,216,152
 RB 248,35,192
 CV 147,122,123
 MV 100,216,156
 EX 116,116
 MV 108,220,156
 WL 3
 RB 252,35,4544
 MV 104,220,152
 s_add_u32 m0, m0, 64
 EX 117,117
 v_mfma_f32_16x16x32_bf16 v[128:131], a[224:227], a[64:67], 0
 RT 192,45,17408
 RT 194,45,17920
 v_mfma_f32_16x16x32_bf16 v[132:135], a[224:227], a[68:71], 0
 buffer_load_dwordx4 v8, s[12:15], s70 offen offset:1024 lds
 EX 118,118
 v_mfma_f32_16x16x32_bf16 v[140:143], a[228:231], a[68:71], 0
 RT 196,46,17408
 RT 198,46,17920
 v_mfma_f32_16x16x32_bf16 v[136:139], a[228:231], a[64:67], 0
 EX 119,119
 MA 128,232,72
 RT 200,45,17472
 RT 202,45,17984
 MA 132,232,76
 CV 148,116,117
 CV 149,118,119
 MA 140,236,76
 WL 6
 RT 204,46,17472
 RT 206,46,17984
 MA 136,236,72
 s_add_u32 s4, s87, 0x9900
 s_cmp_lt_u32 s4, 0x26400
 s_cselect_b32 s4, s4, 0
 EX 124,124
 MA 128,240,80
 RT 208,45,26112
 RT 210,45,26624
 MA 132,240,84
 s_add_u32 m0, s59, 0x2200
 s_add_u32 s70, s78, 0x4000
 EX 125,125
 MA 140,244,84
 RT 212,46,26112
 RT 214,46,26624
 MA 136,244,80
 buffer_load_dwordx4 v8, s[12:15], s70 offen lds
 EX 126,126
 MA 128,248,88
 RT 216,45,26176
 RT 218,45,26688
 MA 132,248,92
 EX 127,127
 MA 140,252,92
 WL 6
 RT 220,46,26176
 RT 222,46,26688
 MA 136,252,88
 CV 150,124,125
 CV 151,126,127
 MV 48,192,144
 RB 224,35,8704
 MV 52,192,148
 s_add_u32 m0, m0, 64
 EX 128,128
 MV 60,196,148
 RB 228,35,13056
 MV 56,196,144
 buffer_load_dwordx4 v8, s[12:15], s70 offen offset:1024 lds
 EX 129,129
 MV 64,200,144
 RB 232,35,8768
 CV 152,128,129
 MV 68,200,148
 EX 130,130
 v_mfma_f32_16x16x32_bf16 v[16:19], v[24:27], v[144:147], v[16:19]
 EX 131,131
 MV 76,204,148
 WL 3
 RB 236,35,13120
 CV 153,130,131
 MV 72,204,144
 EX 136,136
 MV 80,208,144
 RB 240,35,8832
 MV 84,208,148
 s_add_u32 m0, s59, 0x4400
 s_add_u32 s70, s81, 0
 EX 137,137
 MV 92,212,148
 RB 244,35,13184
 CV 154,136,137
 MV 88,212,144
 buffer_load_dwordx4 v3, s[16:19], s70 offen lds
 EX 138,138
 v_mfma_f32_16x16x32_bf16 v[20:23], v[24:27], v[148:151], v[20:23]
 EX 139,139
 MV 96,216,144
 RB 248,35,8896
 CV 155,138,139
 MV 100,216,148
 EX 132,132
 MV 108,220,148
 WL 3
 RB 252,35,13248
 MV 104,220,144
 EX 133,133
 v_mfma_f32_16x16x32_bf16 v[112:115], a[224:227], a[64:67], 0
 RT 192,45,21760
 RT 194,45,22272
 v_mfma_f32_16x16x32_bf16 v[116:119], a[224:227], a[68:71], 0
 buffer_load_dwordx4 v4, s[16:19], s70 offen offset:1088 lds
 EX 134,134
 v_mfma_f32_16x16x32_bf16 v[124:127], a[228:231], a[68:71], 0
 RT 196,46,21760
 RT 198,46,22272
 v_mfma_f32_16x16x32_bf16 v[120:123], a[228:231], a[64:67], 0
 EX 135,135
 MA 112,232,72
 RT 200,45,21824
 RT 202,45,22336
 MA 116,232,76
 CV 156,132,133
 CV 157,134,135
 MA 124,236,76
 WL 6
 RT 204,46,21824
 RT 206,46,22336
 MA 120,236,72
 s_add_u32 m0, s59, 0x6600
 s_add_u32 s70, s81, 0x80
 EX 140,140
 MA 112,240,80
 RT 208,45,30464
 RT 210,45,30976
 MA 116,240,84
 buffer_load_dwordx4 v3, s[16:19], s70 offen lds
 EX 141,141
 MA 124,244,84
 RT 212,46,30464
 RT 214,46,30976
 MA 120,244,80
 EX 142,142
 MA 112,248,88
 RT 216,45,30528
 RT 218,45,31040
 MA 116,248,92
 EX 143,143
 MA 124,252,92
 WL 6
 RT 220,46,30528
 RT 222,46,31040
 MA 120,252,88
 buffer_load_dwordx4 v4, s[16:19], s70 offen offset:1088 lds
 v_add_u32 v45, s4, v44
 v_xor_b32 v46, 32, v45
 v_add_u32 v35, s4, v32
 CV 158,140,141
 CV 159,142,143
 MV 48,192,152
 s_sub_u32 s91, s91, 1
 s_cmp_lg_u32 s91, 0
 s_cbranch_scc1 L_A_loop1
 s_waitcnt vmcnt(8)
 s_barrier
 RB 224,35,0
 MV 52,192,156
 s_mov_b32 s89, s88
 s_mov_b32 s88, s87
 EX 112,112
 MV 60,196,156
 RB 228,35,4352
 MV 56,196,152
 s_mov_b32 s87, s4
 s_add_u32 s59, s89, s69
 EX 113,113
 MV 64,200,152
 RB 232,35,64
 CV 144,112,113
 MV 68,200,156
 s_add_u32 s78, s78, 0x4000
 s_add_u32 s81, s81, 0x4000
 EX 114,114
 v_mfma_f32_16x16x32_bf16 v[16:19], v[24:27], v[152:155], v[16:19]
 EX 115,115
 MV 76,204,156
 WL 3
 RB 236,35,4416
 CV 145,114,115
 MV 72,204,152
 s_add_u32 m0, s59, 0
 s_add_u32 s70, s78, 0x2000
 EX 120,120
 MV 80,208,152
 RB 240,35,128
 MV 84,208,156
 buffer_load_dwordx4 v8, s[12:15], s70 offen lds
 EX 121,121
 MV 92,212,156
 RB 244,35,4480
 CV 146,120,121
 MV 88,212,152
 EX 122,122
 v_mfma_f32_16x16x32_bf16 v[20:23], v[24:27], v[156:159], v[20:23]
 EX 123,123
 MV 96,216,152
 RB 248,35,192
 CV 147,122,123
 MV 100,216,156
 EX 116,116
 MV 108,220,156
 WL 3
 RB 252,35,4544
 MV 104,220,152
 s_add_u32 m0, m0, 64
 EX 117,117
 v_mfma_f32_16x16x32_bf16 v[128:131], a[224:227], a[64:67], 0
 RT 192,45,17408
 RT 194,45,17920
 v_mfma_f32_16x16x32_bf16 v[132:135], a[224:227], a[68:71], 0
 buffer_load_dwordx4 v8, s[12:15], s70 offen offset:1024 lds
 EX 118,118
 v_mfma_f32_16x16x32_bf16 v[140:143], a[228:231], a[68:71], 0
 RT 196,46,17408
 RT 198,46,17920
 v_mfma_f32_16x16x32_bf16 v[136:139], a[228:231], a[64:67], 0
 EX 119,119
 MA 128,232,72
 RT 200,45,17472
 RT 202,45,17984
 MA 132,232,76
 CV 148,116,117
 CV 149,118,119
 MA 140,236,76
 WL 6
 RT 204,46,17472
 RT 206,46,17984
 MA 136,236,72
 s_add_u32 s4, s87, 0x9900
 s_cmp_lt_u32 s4, 0x26400
 s_cselect_b32 s4, s4, 0
 EX 124,124
 MA 128,240,80
 RT 208,45,26112
 RT 210,45,26624
 MA 132,240,84
 s_add_u32 m0, s59, 0x4400
 s_add_u32 s70, s81, 0
 EX 125,125
 MA 140,244,84
 RT 212,46,26112
 RT 214,46,26624
 MA 136,244,80
 buffer_load_dwordx4 v3, s[16:19], s70 offen lds
 EX 126,126
 MA 128,248,88
 RT 216,45,26176
 RT 218,45,26688
 MA 132,248,92
 EX 127,127
 MA 140,252,92
 WL 6
 RT 220,46,26176
 RT 222,46,26688
 MA 136,252,88
 CV 150,124,125
 CV 151,126,127
 MV 48,192,144
 RB 224,35,8704
 MV 52,192,148
 buffer_load_dwordx4 v4, s[16:19], s70 offen offset:1088 lds
 EX 128,128
 MV 60,196,148
 RB 228,35,13056
 MV 56,196,144
 EX 129,129
 MV 64,200,144
 RB 232,35,8768
 CV 152,128,129
 MV 68,200,148
 EX 130,130
 v_mfma_f32_16x16x32_bf16 v[16:19], v[24:27], v[144:147], v[16:19]
 EX 131,131
 MV 76,204,148
 WL 3
 RB 236,35,13120
 CV 153,130,131
 MV 72,204,144
 s_add_u32 m0, s59, 0x6600
 s_add_u32 s70, s81, 0x80
 EX 136,136
 MV 80,208,144
 RB 240,35,8832
 MV 84,208,148
 buffer_load_dwordx4 v3, s[16:19], s70 offen lds
 EX 137,137
 MV 92,212,148
 RB 244,35,13184
 CV 154,136,137
 MV 88,212,144
 EX 138,138
 v_mfma_f32_16x16x32_bf16 v[20:23], v[24:27], v[148:151], v[20:23]
 EX 139,139
 MV 96,216,144
 RB 248,35,8896
 CV 155,138,139
 MV 100,216,148
 EX 132,132
 MV 108,220,148
 WL 3
 RB 252,35,13248
 MV 104,220,144
 buffer_load_dwordx4 v4, s[16:19], s70 offen offset:1088 lds
 EX 133,133
 v_mfma_f32_16x16x32_bf16 v[112:115], a[224:227], a[64:67], 0
 RT 192,45,21760
 RT 194,45,22272
 v_mfma_f32_16x16x32_bf16 v[116:119], a[224:227], a[68:71], 0
 EX 134,134
 v_mfma_f32_16x16x32_bf16 v[124:127], a[228:231], a[68:71], 0
 RT 196,46,21760
 RT 198,46,22272
 v_mfma_f32_16x16x32_bf16 v[120:123], a[228:231], a[64:67], 0
 EX 135,135
 MA 112,232,72
 RT 200,45,21824
 RT 202,45,22336
 MA 116,232,76
 CV 156,132,133
 CV 157,134,135
 MA 124,236,76
 WL 6
 RT 204,46,21824
 RT 206,46,22336
 MA 120,236,72
 EX 140,140
 MA 112,240,80
 RT 208,45,30464
 RT 210,45,30976
 MA 116,240,84
 EX 141,141
 MA 124,244,84
 RT 212,46,30464
 RT 214,46,30976
 MA 120,244,80
 EX 142,142
 MA 112,248,88
 RT 216,45,30528
 RT 218,45,31040
 MA 116,248,92
 EX 143,143
 MA 124,252,92
 WL 6
 RT 220,46,30528
 RT 222,46,31040
 MA 120,252,88
 v_add_u32 v45, s4, v44
 v_xor_b32 v46, 32, v45
 v_add_u32 v35, s4, v32
 CV 158,140,141
 CV 159,142,143
 MV 48,192,152
 s_waitcnt vmcnt(6)
 s_barrier
 RB 224,35,0
 MV 52,192,156
 s_mov_b32 s89, s88
 s_mov_b32 s88, s87
 EX 112,112
 MV 60,196,156
 RB 228,35,4352
 MV 56,196,152
 s_mov_b32 s87, s4
 EX 113,113
 MV 64,200,152
 RB 232,35,64
 CV 144,112,113
 MV 68,200,156
 s_mov_b32 s92, 0x480
 v_mad_u32_u24 v3, v41, s92, v2
 v_add_u32 v4, 0xdc0, v3
 v_add_u32 v5, 0xdc0, v4
 v_add_u32 v6, 0xdc0, v5
 EX 114,114
 v_mfma_f32_16x16x32_bf16 v[16:19], v[24:27], v[152:155], v[16:19]
 EX 115,115
 MV 76,204,156
 WL 3
 RB 236,35,4416
 CV 145,114,115
 MV 72,204,152
 s_add_u32 m0, s89, s60
 s_add_u32 s70, s83, 0
 EX 120,120
 MV 80,208,152
 RB 240,35,128
 MV 84,208,156
 buffer_load_dwordx4 v3, s[24:27], s70 offen lds
 EX 121,121
 MV 92,212,156
 RB 244,35,4480
 CV 146,120,121
 MV 88,212,152
 EX 122,122
 v_mfma_f32_16x16x32_bf16 v[20:23], v[24:27], v[156:159], v[20:23]
 EX 123,123
 MV 96,216,152
 RB 248,35,192
 CV 147,122,123
 MV 100,216,156
 EX 116,116
 MV 108,220,156
 WL 3
 RB 252,35,4544
 MV 104,220,152
 buffer_load_dwordx4 v4, s[24:27], s70 offen offset:1088 lds
 EX 117,117
 v_mfma_f32_16x16x32_bf16 v[128:131], a[224:227], a[64:67], 0
 RT 192,45,17408
 RT 194,45,17920
 v_mfma_f32_16x16x32_bf16 v[132:135], a[224:227], a[68:71], 0
 EX 118,118
 v_mfma_f32_16x16x32_bf16 v[140:143], a[228:231], a[68:71], 0
 RT 196,46,17408
 RT 198,46,17920
 v_mfma_f32_16x16x32_bf16 v[136:139], a[228:231], a[64:67], 0
 EX 119,119
 MA 128,232,72
 RT 200,45,17472
 RT 202,45,17984
 MA 132,232,76
 s_add_u32 s4, s87, 0x9900
 s_cmp_lt_u32 s4, 0x26400
 s_cselect_b32 s4, s4, 0
 CV 148,116,117
 CV 149,118,119
 MA 140,236,76
 WL 6
 RT 204,46,17472
 RT 206,46,17984
 MA 136,236,72
 buffer_load_dwordx4 v5, s[24:27], s70 offen offset:2176 lds
 EX 124,124
 MA 128,240,80
 RT 208,45,26112
 RT 210,45,26624
 MA 132,240,84
 EX 125,125
 MA 140,244,84
 RT 212,46,26112
 RT 214,46,26624
 MA 136,244,80
 EX 126,126
 MA 128,248,88
 RT 216,45,26176
 RT 218,45,26688
 MA 132,248,92
 buffer_load_dwordx4 v6, s[24:27], s70 offen offset:3264 lds
 EX 127,127
 MA 140,252,92
 WL 6
 RT 220,46,26176
 RT 222,46,26688
 MA 136,252,88
 CV 150,124,125
 CV 151,126,127
 MV 48,192,144
 RB 224,35,8704
 MV 52,192,148
 EX 128,128
 MV 60,196,148
 RB 228,35,13056
 MV 56,196,144
 s_add_u32 m0, s89, s61
 s_add_u32 s70, s58, 0
 EX 129,129
 MV 64,200,144
 RB 232,35,8768
 CV 152,128,129
 MV 68,200,148
 buffer_load_dwordx4 v3, s[24:27], s70 offen lds
 EX 130,130
 v_mfma_f32_16x16x32_bf16 v[16:19], v[24:27], v[144:147], v[16:19]
 EX 131,131
 MV 76,204,148
 WL 3
 RB 236,35,13120
 CV 153,130,131
 MV 72,204,144
 EX 136,136
 MV 80,208,144
 RB 240,35,8832
 MV 84,208,148
 EX 137,137
 MV 92,212,148
 RB 244,35,13184
 CV 154,136,137
 MV 88,212,144
 buffer_load_dwordx4 v4, s[24:27], s70 offen offset:1088 lds
 EX 138,138
 v_mfma_f32_16x16x32_bf16 v[20:23], v[24:27], v[148:151], v[20:23]
 EX 139,139
 MV 96,216,144
 RB 248,35,8896
 CV 155,138,139
 MV 100,216,148
 EX 132,132
 MV 108,220,148
 WL 3
 RB 252,35,13248
 MV 104,220,144
 EX 133,133
 v_mfma_f32_16x16x32_bf16 v[112:115], a[224:227], a[64:67], 0
 RT 192,45,21760
 RT 194,45,22272
 v_mfma_f32_16x16x32_bf16 v[116:119], a[224:227], a[68:71], 0
 s_getpc_b64 s[94:95]
L_cp3:
 s_add_u32 s94, s94, L_A_p2-L_cp3
 s_addc_u32 s95, s95, 0
 v_bfe_u32 v40, v38, 16, 5
 v_and_b32 v39, 63, v38
 v_min_u32 v39, 4, v39
 v_mad_u32_u24 v39, v40, 5, v39
 v_lshlrev_b32 v39, 7, v39
 v_min_u32 v39, L_A_p2+20480-L_A_p2-4, v39
 EX 134,134
 v_mfma_f32_16x16x32_bf16 v[124:127], a[228:231], a[68:71], 0
 RT 196,46,21760
 RT 198,46,22272
 v_mfma_f32_16x16x32_bf16 v[120:123], a[228:231], a[64:67], 0
 global_load_dword v47, v39, s[94:95]
 EX 135,135
 MA 112,232,72
 RT 200,45,21824
 RT 202,45,22336
 MA 116,232,76
 CV 156,132,133
 CV 157,134,135
 MA 124,236,76
 WL 6
 RT 204,46,21824
 RT 206,46,22336
 MA 120,236,72
 EX 140,140
 MA 112,240,80
 RT 208,45,30464
 RT 210,45,30976
 MA 116,240,84
 EX 141,141
 MA 124,244,84
 RT 212,46,30464
 RT 214,46,30976
 MA 120,244,80
 EX 142,142
 MA 112,248,88
 RT 216,45,30528
 RT 218,45,31040
 MA 116,248,92
 EX 143,143
 MA 124,252,92
 WL 6
 RT 220,46,30528
 RT 222,46,31040
 MA 120,252,88
 v_add_u32 v45, s4, v44
 v_xor_b32 v46, 32, v45
 v_add_u32 v35, s4, v32
 CV 158,140,141
 CV 159,142,143
 MV 48,192,152
 s_waitcnt vmcnt(7)
 s_barrier
 RB 224,35,0
 MV 52,192,156
 s_mov_b32 s89, s88
 s_mov_b32 s88, s87
 EX 112,112
 MV 60,196,156
 RB 228,35,4352
 MV 56,196,152
 s_mov_b32 s87, s4
 EX 113,113
 MV 64,200,152
 RB 232,35,64
 CV 144,112,113
 MV 68,200,156
 s_add_u32 m0, s89, s60
 s_add_u32 s70, s74, 0
 EX 114,114
 v_mfma_f32_16x16x32_bf16 v[16:19], v[24:27], v[152:155], v[16:19]
 EX 115,115
 MV 76,204,156
 WL 3
 RB 236,35,4416
 CV 145,114,115
 MV 72,204,152
 buffer_load_dwordx4 v3, s[24:27], s70 offen lds
 EX 120,120
 MV 80,208,152
 RB 240,35,128
 MV 84,208,156
 EX 121,121
 MV 92,212,156
 RB 244,35,4480
 CV 146,120,121
 MV 88,212,152
 EX 122,122
 v_mfma_f32_16x16x32_bf16 v[20:23], v[24:27], v[156:159], v[20:23]
 EX 123,123
 MV 96,216,152
 RB 248,35,192
 CV 147,122,123
 MV 100,216,156
 buffer_load_dwordx4 v4, s[24:27], s70 offen offset:1088 lds
 EX 116,116
 MV 108,220,156
 WL 3
 RB 252,35,4544
 MV 104,220,152
 EX 117,117
 v_mfma_f32_16x16x32_bf16 v[128:131], a[224:227], a[64:67], 0
 RT 192,45,17408
 RT 194,45,17920
 v_mfma_f32_16x16x32_bf16 v[132:135], a[224:227], a[68:71], 0
 EX 118,118
 v_mfma_f32_16x16x32_bf16 v[140:143], a[228:231], a[68:71], 0
 RT 196,46,17408
 RT 198,46,17920
 v_mfma_f32_16x16x32_bf16 v[136:139], a[228:231], a[64:67], 0
 buffer_load_dwordx4 v5, s[24:27], s70 offen offset:2176 lds
 EX 119,119
 MA 128,232,72
 RT 200,45,17472
 RT 202,45,17984
 MA 132,232,76
 CV 148,116,117
 CV 149,118,119
 MA 140,236,76
 WL 6
 RT 204,46,17472
 RT 206,46,17984
 MA 136,236,72
 EX 124,124
 MA 128,240,80
 RT 208,45,26112
 RT 210,45,26624
 MA 132,240,84
 s_add_u32 s4, s87, 0x9900
 s_cmp_lt_u32 s4, 0x26400
 s_cselect_b32 s4, s4, 0
 EX 125,125
 MA 140,244,84
 RT 212,46,26112
 RT 214,46,26624
 MA 136,244,80
 buffer_load_dwordx4 v6, s[24:27], s70 offen offset:3264 lds
 EX 126,126
 MA 128,248,88
 RT 216,45,26176
 RT 218,45,26688
 MA 132,248,92
 EX 127,127
 MA 140,252,92
 WL 6
 RT 220,46,26176
 RT 222,46,26688
 MA 136,252,88
 CV 150,124,125
 CV 151,126,127
 MV 48,192,144
 RT 224,45,21760
 RT 226,45,22272
 MV 52,192,148
 s_add_u32 m0, s89, s61
 s_add_u32 s70, s75, 0
 EX 128,128
 EX 129,129
 MV 60,196,148
 RT 228,46,21760
 RT 230,46,22272
 MV 56,196,144
 buffer_load_dwordx4 v3, s[24:27], s70 offen lds
 EX 130,130
 EX 131,131
 CV 152,128,129
 CV 153,130,131
 MV 64,200,144
 RT 232,45,21824
 RT 234,45,22336
 MV 68,200,148
 EX 136,136
 EX 137,137
 v_mfma_f32_16x16x32_bf16 v[16:19], v[24:27], v[144:147], v[16:19]
 EX 138,138
 MV 76,204,148
 WL 6
 RT 236,46,21824
 RT 238,46,22336
 MV 72,204,144
 EX 139,139
 CV 154,136,137
 CV 155,138,139
 MV 80,208,144
 RT 240,45,30464
 RT 242,45,30976
 MV 84,208,148
 buffer_load_dwordx4 v4, s[24:27], s70 offen offset:1088 lds
 EX 132,132
 EX 133,133
 MV 92,212,148
 RT 244,46,30464
 RT 246,46,30976
 MV 88,212,144
 EX 134,134
 EX 135,135
 CV 156,132,133
 CV 157,134,135
 v_mfma_f32_16x16x32_bf16 v[20:23], v[24:27], v[148:151], v[20:23]
 EX 140,140
 MV 96,216,144
 RT 248,45,30528
 RT 250,45,31040
 MV 100,216,148
 EX 141,141
 EX 142,142
 MV 108,220,148
 WL 6
 RT 252,46,30528
 RT 254,46,31040
 MV 104,220,144
 v_add_u32 v45, s4, v44
 v_xor_b32 v46, 32, v45
 EX 143,143
 CV 158,140,141
 CV 159,142,143
 MV 48,224,152
L_A_p2:
 s_waitcnt vmcnt(7)
 s_barrier
 RT 192,45,0
 RT 194,45,512
 MV 52,224,156
 s_mov_b32 s89, s88
 s_mov_b32 s88, s87
 MV 60,228,156
 RT 196,46,0
 RT 198,46,512
 MV 56,228,152
 s_mov_b32 s87, s4
 MV 64,232,152
 RT 200,45,4352
 RT 202,45,4864
 MV 68,232,156
 v_mov_b32 v36, 0
 v_mfma_f32_16x16x32_bf16 v[16:19], v[24:27], v[152:155], v[16:19]
 s_nop 0
 MV 76,236,156
 WL 6
 RT 204,46,4352
 RT 206,46,4864
 MV 72,236,152
 s_add_u32 s83, s83, 0x80
 s_add_u32 s58, s58, 0x80
 s_add_u32 s74, s74, 0x80
 s_add_u32 s75, s75, 0x80
 MV 80,240,152
 RT 208,45,8704
 RT 210,45,9216
 MV 84,240,156
 s_add_u32 m0, s89, s60
 s_add_u32 s70, s83, 0
 MV 92,244,156
 RT 212,46,8704
 RT 214,46,9216
 MV 88,244,152
 buffer_load_dwordx4 v3, s[24:27], s70 offen lds
 v_mfma_f32_16x16x32_bf16 v[20:23], v[24:27], v[156:159], v[20:23]
 s_nop 0
 MV 96,248,152
 RT 216,45,13056
 MV 100,248,156
 RT 218,45,13568
 MV 108,252,156
 WL 6
 RT 220,46,13056
 MV 104,252,152
 RT 222,46,13568
 v_mov_b32 v255, 0x2b800000
 s_mov_b32 s93, 0x53800000
 v_med3_f32 v254, v224, s93, v255
 v_cmp_neq_f32 s[98:99], v254, v224
 v_med3_f32 v254, v225, s93, v255
 v_cmp_neq_f32 vcc, v254, v225
 s_nop 4
 s_or_b64 vcc, vcc, s[98:99]
 s_nop 1
 s_cbranch_vccz L_A_slow0_ret
 s_call_b64 s[56:57], L_A_slow0
L_A_slow0_ret:
 v_med3_f32 v254, v226, s93, v255
 v_cmp_neq_f32 s[98:99], v254, v226
 v_med3_f32 v254, v227, s93, v255
 v_cmp_neq_f32 vcc, v254, v227
 s_nop 4
 s_or_b64 vcc, vcc, s[98:99]
 s_nop 1
 s_cbranch_vccz L_A_slow1_ret
 s_call_b64 s[56:57], L_A_slow1
L_A_slow1_ret:
 s_nop 1
 v_mfma_f32_16x16x32_bf16 v[112:115], a[192:195], a[96:99], 0
 RT 224,45,17408
 RT 226,45,17920
 v_mfma_f32_16x16x32_bf16 v[116:119], a[192:195], a[100:103], 0
 s_add_u32 s4, s87, 0x9900
 s_cmp_lt_u32 s4, 0x26400
 s_cselect_b32 s4, s4, 0
 v_mov_b32 v228, v16
 v_mov_b32 v229, v20
 v_rcp_f32 v250, v228
 v_mfma_f32_16x16x32_bf16 v[124:127], a[196:199], a[100:103], 0
 RT 228,46,17408
 RT 230,46,17920
 v_mfma_f32_16x16x32_bf16 v[120:123], a[196:199], a[96:99], 0
 buffer_load_dwordx4 v4, s[24:27], s70 offen offset:1088 lds
 v_rcp_f32 v251, v229
 ML 230,48,250
 ML 231,49,250
 ML 232,50,250
 MA 112,200,112
 RT 232,45,21760
 RT 234,45,22272
 MA 116,200,116
 ML 233,51,250
 CV 230,230,231
 CV 232,232,233
 AW 160,230
 AW 161,232
 MA 124,204,116
 WL 6
 RT 236,46,21760
 RT 238,46,22272
 MA 120,204,112
 ML 234,56,250
 ML 235,57,250
 ML 236,58,250
 ML 237,59,250
 CV 234,234,235
 MA 112,208,128
 RT 240,45,64
 RT 242,45,576
 MA 116,208,132
 buffer_load_dwordx4 v5, s[24:27], s70 offen offset:2176 lds
 CV 236,236,237
 AW 162,234
 AW 163,236
 ML 238,52,251
 ML 239,53,251
 MA 124,212,132
 RT 244,46,64
 RT 246,46,576
 MA 120,212,128
 ML 240,54,251
 ML 241,55,251
 CV 238,238,239
 CV 240,240,241
 AW 164,238
 MA 112,216,144
 RT 248,45,4416
 RT 250,45,4928
 MA 116,216,148
 AW 165,240
 ML 242,60,251
 ML 243,61,251
 ML 244,62,251
 ML 245,63,251
 MA 124,220,148
 WL 6
 RT 252,46,4416
 RT 254,46,4928
 MA 120,220,144
 buffer_load_dwordx4 v6, s[24:27], s70 offen offset:3264 lds
 CV 242,242,243
 CV 244,244,245
 AW 166,242
 AW 167,244
 ML 230,64,250
 MA 112,224,104
 RT 192,45,8768
 RT 194,45,9280
 MA 116,224,108
 ML 231,65,250
 ML 232,66,250
 ML 233,67,250
 CV 230,230,231
 CV 232,232,233
 MA 124,228,108
 RT 196,46,8768
 RT 198,46,9280
 MA 120,228,104
 AW 168,230
 AW 169,232
 ML 234,72,250
 ML 235,73,250
 ML 236,74,250
 MA 112,232,120
 RT 200,45,13120
 RT 202,45,13632
 MA 116,232,124
 s_add_u32 m0, s89, s61
 s_add_u32 s70, s58, 0
 ML 237,75,250
 CV 234,234,235
 CV 236,236,237
 AW 170,234
 AW 171,236
 MA 124,236,124
 WL 6
 RT 204,46,13120
 RT 206,46,13632
 MA 120,236,120
 buffer_load_dwordx4 v3, s[24:27], s70 offen lds
 ML 238,68,251
 ML 239,69,251
 ML 240,70,251
 ML 241,71,251
 CV 238,238,239
 v_mfma_f32_16x16x32_bf16 v[128:131], a[240:243], a[96:99], 0
 RT 208,45,17472
 RT 210,45,17984
 v_mfma_f32_16x16x32_bf16 v[132:135], a[240:243], a[100:103], 0
 CV 240,240,241
 AW 172,238
 AW 173,240
 ML 242,76,251
 ML 243,77,251
 v_mfma_f32_16x16x32_bf16 v[140:143], a[244:247], a[100:103], 0
 RT 212,46,17472
 RT 214,46,17984
 v_mfma_f32_16x16x32_bf16 v[136:139], a[244:247], a[96:99], 0
 ML 244,78,251
 ML 245,79,251
 CV 242,242,243
 CV 244,244,245
 AW 174,242
 MA 128,248,112
 RT 216,45,21824
 RT 218,45,22336
 MA 132,248,116
 buffer_load_dwordx4 v4, s[24:27], s70 offen offset:1088 lds
 AW 175,244
 ML 230,80,250
 ML 231,81,250
 ML 232,82,250
 ML 233,83,250
 MA 140,252,116
 WL 6
 RT 220,46,21824
 RT 222,46,22336
 MA 136,252,112
 v_add_u32 v45, s4, v44
 v_xor_b32 v46, 32, v45
 CV 230,230,231
 CV 232,232,233
 AW 176,230
 AW 177,232
 ML 234,88,250
 MA 128,192,128
 s_waitcnt vmcnt(6)
 s_barrier
 RT 224,45,0
 RT 226,45,512
 MA 132,192,132
 s_mov_b32 s89, s88
 s_mov_b32 s88, s87
 ML 235,89,250
 ML 236,90,250
 ML 237,91,250
 CV 234,234,235
 CV 236,236,237
 MA 140,196,132
 RT 228,46,0
 RT 230,46,512
 MA 136,196,128
 s_mov_b32 s87, s4
 AW 178,234
 AW 179,236
 ML 238,84,251
 ML 239,85,251
 ML 240,86,251
 MA 128,200,144
 RT 232,45,4352
 RT 234,45,4864
 MA 132,200,148
 s_add_u32 m0, s89, s60
 s_add_u32 s70, s74, 0
 ML 241,87,251
 CV 238,238,239
 CV 240,240,241
 AW 180,238
 AW 181,240
 MA 140,204,148
 WL 6
 RT 236,46,4352
 RT 238,46,4864
 MA 136,204,144
 buffer_load_dwordx4 v3, s[24:27], s70 offen lds
 ML 242,92,251
 ML 243,93,251
 ML 244,94,251
 ML 245,95,251
 CV 242,242,243
 MA 128,208,104
 RT 240,45,8704
 RT 242,45,9216
 MA 132,208,108
 CV 244,244,245
 AW 182,242
 AW 183,244
 ML 230,96,250
 ML 231,97,250
 MA 140,212,108
 RT 244,46,8704
 RT 246,46,9216
 MA 136,212,104
 ML 232,98,250
 ML 233,99,250
 CV 230,230,231
 CV 232,232,233
 AW 184,230
 MA 128,216,120
 RT 248,45,13056
 RT 250,45,13568
 MA 132,216,124
 buffer_load_dwordx4 v4, s[24:27], s70 offen offset:1088 lds
 AW 185,232
 ML 234,104,250
 ML 235,105,250
 ML 236,106,250
 ML 237,107,250
 MA 140,220,124
 WL 6
 RT 252,46,13056
 RT 254,46,13568
 MA 136,220,120
 CV 234,234,235
 CV 236,236,237
 AW 186,234
 AW 187,236
 MA 112,224,136
 RT 192,45,17408
 RT 194,45,17920
 MA 116,224,140
 ML 238,100,251
 ML 239,101,251
 ML 240,102,251
 ML 241,103,251
 MA 124,228,140
 RT 196,46,17408
 RT 198,46,17920
 MA 120,228,136
 buffer_load_dwordx4 v5, s[24:27], s70 offen offset:2176 lds
 CV 238,238,239
 CV 240,240,241
 AW 188,238
 AW 189,240
 MA 112,232,152
 RT 200,45,21760
 RT 202,45,22272
 MA 116,232,156
 ML 242,108,251
 ML 243,109,251
 ML 244,110,251
 ML 245,111,251
 MA 124,236,156
 WL 6
 RT 204,46,21760
 RT 206,46,22272
 MA 120,236,152
 CV 242,242,243
 CV 244,244,245
 AW 190,242
 AW 191,244
 v_mov_b32 v255, 0x2b800000
 s_mov_b32 s93, 0x53800000
 v_med3_f32 v254, v228, s93, v255
 v_cmp_neq_f32 s[98:99], v254, v228
 v_med3_f32 v254, v229, s93, v255
 v_cmp_neq_f32 vcc, v254, v229
 s_nop 4
 s_or_b64 vcc, vcc, s[98:99]
 s_nop 1
 s_cbranch_vccz L_A_slow2_ret
 s_call_b64 s[56:57], L_A_slow2
L_A_slow2_ret:
 s_nop 1
 MA 112,240,160
 RT 208,45,64
 RT 210,45,576
 MA 116,240,164
 s_add_u32 s4, s87, 0x9900
 s_cmp_lt_u32 s4, 0x26400
 s_cselect_b32 s4, s4, 0
 MA 124,244,164
 RT 212,46,64
 RT 214,46,576
 MA 120,244,160
 buffer_load_dwordx4 v6, s[24:27], s70 offen offset:3264 lds
 MA 112,248,168
 RT 216,45,4416
 MA 116,248,172
 RT 218,45,4928
 MA 124,252,172
 WL 6
 RT 220,46,4416
 MA 120,252,168
 RT 222,46,4928
 MA 112,192,176
 RT 224,45,8768
 RT 226,45,9280
 MA 116,192,180
 s_add_u32 m0, s89, s61
 s_add_u32 s70, s75, 0
 MA 124,196,180
 RT 228,46,8768
 RT 230,46,9280
 MA 120,196,176
 buffer_load_dwordx4 v3, s[24:27], s70 offen lds
 MA 112,200,184
 RT 232,45,13120
 MA 116,200,188
 RT 234,45,13632
 MA 124,204,188
 WL 6
 RT 236,46,13120
 MA 120,204,184
 RT 238,46,13632
 MA 128,208,136
 RT 240,45,17472
 RT 242,45,17984
 MA 132,208,140
 buffer_load_dwordx4 v4, s[24:27], s70 offen offset:1088 lds
 MA 140,212,140
 RT 244,46,17472
 RT 246,46,17984
 MA 136,212,136
 CV 144,112,113
 CV 145,114,115
 MA 128,216,152
 RT 248,45,21824
 RT 250,45,22336
 MA 132,216,156
 CV 146,120,121
 CV 147,122,123
 MA 140,220,156
 WL 6
 RT 252,46,21824
 RT 254,46,22336
 MA 136,220,152
 s_lshl_b32 s82, s64, 14
 s_add_u32 s82, s82, 0x2f00000
 s_cmp_eq_u32 s62, 0
 s_cselect_b32 s93, 0, 0x10000000
 v_lshrrev_b32 v21, 2, v0
 v_add_u32 v21, s93, v21
 v_mov_b32 v26, 0x10000000
 s_add_u32 s92, s93, 0x44
 v_writelane_b32 v26, s92, 0
 v_mov_b32 v29, v26
 v_min_u32 v30, 0x110, v0
 v_lshrrev_b32 v30, 2, v30
 v_add_u32 v30, s93, v30
 s_add_u32 s92, s93, 0xfc
 v_writelane_b32 v26, s92, 1
 s_lshl_b32 s92, s64, 4
 s_add_u32 s92, s92, s93
 v_mov_b32 v22, 0x100
 v_writelane_b32 v22, s92, 0
 s_lshl_b32 s76, s63, 7
 s_add_u32 s76, s76, 0x100
 s_add_u32 s76, s76, s82
 s_lshl_b32 s77, s63, 8
 s_add_u32 s77, s77, 0x1000
 s_add_u32 s77, s77, s82
 v_mov_b32 v17, 0
 buffer_atomic_add v17, v22, s[52:55], 0 offen sc0 sc1
 v_add_u32 v45, s4, v44
 v_xor_b32 v46, 32, v45
 MA 128,224,160
 s_waitcnt vmcnt(7)
 s_barrier
 RT 192,45,0
 RT 194,45,512
 MA 132,224,164
 s_mov_b32 s89, s88
 s_mov_b32 s88, s87
 MA 140,228,164
 RT 196,46,0
 RT 198,46,512
 MA 136,228,160
 s_mov_b32 s87, s4
 buffer_store_dwordx4 v[144:147], v0, s[36:39], s90 offen sc1
 MA 128,232,168
 RT 200,45,4352
 RT 202,45,4864
 MA 132,232,172
 s_add_u32 s83, s83, 0x80
 s_add_u32 s58, s58, 0x80
 s_add_u32 s74, s74, 0x80
 s_add_u32 s75, s75, 0x80
 MA 140,236,172
 WL 6
 RT 204,46,4352
 RT 206,46,4864
 MA 136,236,168
 s_add_u32 m0, s89, s60
 s_add_u32 s70, s83, 0
 MA 128,240,176
 RT 208,45,8704
 RT 210,45,9216
 MA 132,240,180
 buffer_load_dwordx4 v3, s[24:27], s70 offen lds
 CV 148,116,117
 CV 149,118,119
 MA 140,244,180
 RT 212,46,8704
 RT 214,46,9216
 MA 136,244,176
 CV 150,124,125
 CV 151,126,127
 MA 128,248,184
 RT 216,45,13056
 RT 218,45,13568
 MA 132,248,188
 buffer_store_dwordx4 v[148:151], v0, s[36:39], s90 offen offset:1024 sc1
 MA 140,252,188
 WL 6
 RT 220,46,13056
 RT 222,46,13568
 MA 136,252,184
 buffer_load_dwordx4 v4, s[24:27], s70 offen offset:1088 lds
 v_mfma_f32_16x16x32_bf16 v[112:115], a[192:195], a[96:99], 0
 RT 224,45,17408
 RT 226,45,17920
 v_mfma_f32_16x16x32_bf16 v[116:119], a[192:195], a[100:103], 0
 CV 152,128,129
 CV 153,130,131
 v_mfma_f32_16x16x32_bf16 v[124:127], a[196:199], a[100:103], 0
 RT 228,46,17408
 RT 230,46,17920
 v_mfma_f32_16x16x32_bf16 v[120:123], a[196:199], a[96:99], 0
 CV 154,136,137
 CV 155,138,139
 MA 112,200,112
 RT 232,45,21760
 RT 234,45,22272
 MA 116,200,116
 s_add_u32 s4, s87, 0x9900
 s_cmp_lt_u32 s4, 0x26400
 s_cselect_b32 s4, s4, 0
 MA 124,204,116
 WL 6
 RT 236,46,21760
 RT 238,46,22272
 MA 120,204,112
 buffer_load_dwordx4 v5, s[24:27], s70 offen offset:2176 lds
 MA 112,208,128
 RT 240,45,64
 RT 242,45,576
 MA 116,208,132
 buffer_store_dwordx4 v[152:155], v0, s[36:39], s90 offen offset:2048 sc1
 MA 124,212,132
 RT 244,46,64
 RT 246,46,576
 MA 120,212,128
 CV 156,132,133
 CV 157,134,135
 MA 112,216,144
 RT 248,45,4416
 RT 250,45,4928
 MA 116,216,148
 buffer_load_dwordx4 v6, s[24:27], s70 offen offset:3264 lds
 MA 124,220,148
 WL 6
 RT 252,46,4416
 RT 254,46,4928
 MA 120,220,144
 CV 158,140,141
 CV 159,142,143
 MA 112,224,104
 RT 192,45,8768
 RT 194,45,9280
 MA 116,224,108
 buffer_store_dwordx4 v[156:159], v0, s[36:39], s90 offen offset:3072 sc1
 MA 124,228,108
 RT 196,46,8768
 RT 198,46,9280
 MA 120,228,104
 s_add_u32 m0, s89, s61
 s_add_u32 s70, s58, 0
 MA 112,232,120
 RT 200,45,13120
 RT 202,45,13632
 MA 116,232,124
 buffer_load_dwordx4 v3, s[24:27], s70 offen lds
 MA 124,236,124
 WL 6
 RT 204,46,13120
 RT 206,46,13632
 MA 120,236,120
 s_add_u32 s90, s90, 0x1000
 v_mfma_f32_16x16x32_bf16 v[128:131], a[240:243], a[96:99], 0
 RT 208,45,17472
 v_mfma_f32_16x16x32_bf16 v[132:135], a[240:243], a[100:103], 0
 RT 210,45,17984
 v_mfma_f32_16x16x32_bf16 v[140:143], a[244:247], a[100:103], 0
 RT 212,46,17472
 RT 214,46,17984
 v_mfma_f32_16x16x32_bf16 v[136:139], a[244:247], a[96:99], 0
 buffer_load_dwordx4 v4, s[24:27], s70 offen offset:1088 lds
 MA 128,248,112
 RT 216,45,21824
 MA 132,248,116
 RT 218,45,22336
 MA 140,252,116
 WL 6
 RT 220,46,21824
 RT 222,46,22336
 MA 136,252,112
 v_add_u32 v45, s4, v44
 v_xor_b32 v46, 32, v45
 MA 128,192,128
 s_waitcnt vmcnt(11)
 s_barrier
 RT 224,45,0
 RT 226,45,512
 MA 132,192,132
 s_mov_b32 s89, s88
 s_mov_b32 s88, s87
 MA 140,196,132
 RT 228,46,0
 RT 230,46,512
 MA 136,196,128
 s_mov_b32 s87, s4
 MA 128,200,144
 RT 232,45,4352
 RT 234,45,4864
 MA 132,200,148
 s_add_u32 m0, s89, s60
 s_add_u32 s70, s74, 0
 MA 140,204,148
 WL 6
 RT 236,46,4352
 RT 238,46,4864
 MA 136,204,144
 buffer_load_dwordx4 v3, s[24:27], s70 offen lds
 MA 128,208,104
 RT 240,45,8704
 MA 132,208,108
 RT 242,45,9216
 MA 140,212,108
 RT 244,46,8704
 MA 136,212,104
 RT 246,46,9216
 MA 128,216,120
 RT 248,45,13056
 RT 250,45,13568
 MA 132,216,124
 buffer_load_dwordx4 v4, s[24:27], s70 offen offset:1088 lds
 MA 140,220,124
 WL 6
 RT 252,46,13056
 MA 136,220,120
 RT 254,46,13568
 MA 112,224,136
 RT 192,45,17408
 MA 116,224,140
 RT 194,45,17920
 MA 124,228,140
 RT 196,46,17408
 RT 198,46,17920
 MA 120,228,136
 buffer_load_dwordx4 v5, s[24:27], s70 offen offset:2176 lds
 MA 112,232,152
 RT 200,45,21760
 MA 116,232,156
 RT 202,45,22272
 MA 124,236,156
 WL 6
 RT 204,46,21760
 MA 120,236,152
 RT 206,46,22272
 MA 112,240,160
 RT 208,45,64
 RT 210,45,576
 MA 116,240,164
 s_add_u32 s4, s87, 0x9900
 s_cmp_lt_u32 s4, 0x26400
 s_cselect_b32 s4, s4, 0
 MA 124,244,164
 RT 212,46,64
 RT 214,46,576
 MA 120,244,160
 buffer_load_dwordx4 v6, s[24:27], s70 offen offset:3264 lds
 MA 112,248,168
 RT 216,45,4416
 MA 116,248,172
 RT 218,45,4928
 MA 124,252,172
 WL 6
 RT 220,46,4416
 MA 120,252,168
 RT 222,46,4928
 MA 112,192,176
 RT 224,45,8768
 RT 226,45,9280
 MA 116,192,180
 s_add_u32 m0, s89, s61
 s_add_u32 s70, s75, 0
 MA 124,196,180
 RT 228,46,8768
 RT 230,46,9280
 MA 120,196,176
 buffer_load_dwordx4 v3, s[24:27], s70 offen lds
 MA 112,200,184
 RT 232,45,13120
 MA 116,200,188
 RT 234,45,13632
 MA 124,204,188
 WL 6
 RT 236,46,13120
 MA 120,204,184
 RT 238,46,13632
 MA 128,208,136
 RT 240,45,17472
 RT 242,45,17984
 MA 132,208,140
 buffer_load_dwordx4 v4, s[24:27], s70 offen offset:1088 lds
 MA 140,212,140
 RT 244,46,17472
 RT 246,46,17984
 MA 136,212,136
 CV 144,112,113
 CV 145,114,115
 MA 128,216,152
 RT 248,45,21824
 RT 250,45,22336
 MA 132,216,156
 CV 146,120,121
 CV 147,122,123
 MA 140,220,156
 WL 6
 RT 252,46,21824
 RT 254,46,22336
 MA 136,220,152
 v_add_u32 v45, s4, v44
 v_xor_b32 v46, 32, v45
 MA 128,224,160
 s_mov_b32 s91, 6
.p2align 3
L_A_loop2:
 s_waitcnt vmcnt(6)
 s_barrier
 RT 192,45,0
 RT 194,45,512
 MA 132,224,164
 s_mov_b32 s89, s88
 s_mov_b32 s88, s87
 MA 140,228,164
 RT 196,46,0
 RT 198,46,512
 MA 136,228,160
 s_mov_b32 s87, s4
 buffer_store_dwordx4 v[144:147], v0, s[36:39], s90 offen sc1
 MA 128,232,168
 RT 200,45,4352
 RT 202,45,4864
 MA 132,232,172
 v_add_u32 v36, 1, v36
 CV 148,116,117
 MA 140,236,172
 WL 6
 RT 204,46,4352
 RT 206,46,4864
 MA 136,236,168
 buffer_store_dword v36, v42, s[36:39], 0 offen sc1
 MA 128,240,176
 RT 208,45,8704
 RT 210,45,9216
 MA 132,240,180
 s_add_u32 s83, s83, 0x80
 s_add_u32 s58, s58, 0x80
 s_add_u32 s74, s74, 0x80
 s_add_u32 s75, s75, 0x80
 CV 149,118,119
 CV 150,124,125
 MA 140,244,180
 RT 212,46,8704
 RT 214,46,9216
 MA 136,244,176
 s_add_u32 m0, s89, s60
 s_add_u32 s70, s83, 0
 MA 128,248,184
 RT 216,45,13056
 RT 218,45,13568
 MA 132,248,188
 buffer_load_dwordx4 v3, s[24:27], s70 offen lds
 CV 151,126,127
 MA 140,252,188
 WL 6
 RT 220,46,13056
 RT 222,46,13568
 MA 136,252,184
 buffer_store_dwordx4 v[148:151], v0, s[36:39], s90 offen offset:1024 sc1
 v_mfma_f32_16x16x32_bf16 v[112:115], a[192:195], a[96:99], 0
 RT 224,45,17408
 RT 226,45,17920
 v_mfma_f32_16x16x32_bf16 v[116:119], a[192:195], a[100:103], 0
 CV 152,128,129
 CV 153,130,131
 v_mfma_f32_16x16x32_bf16 v[124:127], a[196:199], a[100:103], 0
 RT 228,46,17408
 RT 230,46,17920
 v_mfma_f32_16x16x32_bf16 v[120:123], a[196:199], a[96:99], 0
 s_add_u32 s4, s87, 0x9900
 s_cmp_lt_u32 s4, 0x26400
 s_cselect_b32 s4, s4, 0
 MA 112,200,112
 RT 232,45,21760
 RT 234,45,22272
 MA 116,200,116
 buffer_load_dwordx4 v4, s[24:27], s70 offen offset:1088 lds
 MA 124,204,116
 WL 6
 RT 236,46,21760
 RT 238,46,22272
 MA 120,204,112
 CV 154,136,137
 CV 155,138,139
 MA 112,208,128
 RT 240,45,64
 RT 242,45,576
 MA 116,208,132
 buffer_store_dwordx4 v[152:155], v0, s[36:39], s90 offen offset:2048 sc1
 MA 124,212,132
 RT 244,46,64
 RT 246,46,576
 MA 120,212,128
 buffer_load_dwordx4 v5, s[24:27], s70 offen offset:2176 lds
 MA 112,216,144
 RT 248,45,4416
 RT 250,45,4928
 MA 116,216,148
 CV 156,132,133
 CV 157,134,135
 MA 124,220,148
 WL 6
 RT 252,46,4416
 RT 254,46,4928
 MA 120,220,144
 CV 158,140,141
 CV 159,142,143
 MA 112,224,104
 RT 192,45,8768
 RT 194,45,9280
 MA 116,224,108
 buffer_load_dwordx4 v6, s[24:27], s70 offen offset:3264 lds
 MA 124,228,108
 RT 196,46,8768
 RT 198,46,9280
 MA 120,228,104
 buffer_store_dwordx4 v[156:159], v0, s[36:39], s90 offen offset:3072 sc1
 MA 112,232,120
 RT 200,45,13120
 RT 202,45,13632
 MA 116,232,124
 s_add_u32 s90, s90, 0x1000
 MA 124,236,124
 WL 6
 RT 204,46,13120
 RT 206,46,13632
 MA 120,236,120
 s_add_u32 m0, s89, s61
 s_add_u32 s70, s58, 0
 v_mfma_f32_16x16x32_bf16 v[128:131], a[240:243], a[96:99], 0
 RT 208,45,17472
 RT 210,45,17984
 v_mfma_f32_16x16x32_bf16 v[132:135], a[240:243], a[100:103], 0
 buffer_load_dwordx4 v3, s[24:27], s70 offen lds
 v_mfma_f32_16x16x32_bf16 v[140:143], a[244:247], a[100:103], 0
 RT 212,46,17472
 v_mfma_f32_16x16x32_bf16 v[136:139], a[244:247], a[96:99], 0
 RT 214,46,17984
 MA 128,248,112
 RT 216,45,21824
 MA 132,248,116
 RT 218,45,22336
 MA 140,252,116
 WL 6
 RT 220,46,21824
 RT 222,46,22336
 MA 136,252,112
 buffer_load_dwordx4 v4, s[24:27], s70 offen offset:1088 lds
 v_add_u32 v45, s4, v44
 v_xor_b32 v46, 32, v45
 MA 128,192,128
 s_waitcnt vmcnt(11)
 s_barrier
 RT 224,45,0
 RT 226,45,512
 MA 132,192,132
 s_mov_b32 s89, s88
 s_mov_b32 s88, s87
 MA 140,196,132
 RT 228,46,0
 RT 230,46,512
 MA 136,196,128
 s_mov_b32 s87, s4
 MA 128,200,144
 RT 232,45,4352
 RT 234,45,4864
 MA 132,200,148
 s_add_u32 m0, s89, s60
 s_add_u32 s70, s74, 0
 MA 140,204,148
 WL 6
 RT 236,46,4352
 RT 238,46,4864
 MA 136,204,144
 buffer_load_dwordx4 v3, s[24:27], s70 offen lds
 MA 128,208,104
 RT 240,45,8704
 MA 132,208,108
 RT 242,45,9216
 MA 140,212,108
 RT 244,46,8704
 MA 136,212,104
 RT 246,46,9216
 MA 128,216,120
 RT 248,45,13056
 RT 250,45,13568
 MA 132,216,124
 buffer_load_dwordx4 v4, s[24:27], s70 offen offset:1088 lds
 MA 140,220,124
 WL 6
 RT 252,46,13056
 MA 136,220,120
 RT 254,46,13568
 MA 112,224,136
 RT 192,45,17408
 MA 116,224,140
 RT 194,45,17920
 MA 124,228,140
 RT 196,46,17408
 RT 198,46,17920
 MA 120,228,136
 buffer_load_dwordx4 v5, s[24:27], s70 offen offset:2176 lds
 MA 112,232,152
 RT 200,45,21760
 MA 116,232,156
 RT 202,45,22272
 MA 124,236,156
 WL 6
 RT 204,46,21760
 MA 120,236,152
 RT 206,46,22272
 MA 112,240,160
 RT 208,45,64
 RT 210,45,576
 MA 116,240,164
 s_add_u32 s4, s87, 0x9900
 s_cmp_lt_u32 s4, 0x26400
 s_cselect_b32 s4, s4, 0
 MA 124,244,164
 RT 212,46,64
 RT 214,46,576
 MA 120,244,160
 buffer_load_dwordx4 v6, s[24:27], s70 offen offset:3264 lds
 MA 112,248,168
 RT 216,45,4416
 MA 116,248,172
 RT 218,45,4928
 MA 124,252,172
 WL 6
 RT 220,46,4416
 MA 120,252,168
 RT 222,46,4928
 MA 112,192,176
 RT 224,45,8768
 RT 226,45,9280
 MA 116,192,180
 s_add_u32 m0, s89, s61
 s_add_u32 s70, s75, 0
 MA 124,196,180
 RT 228,46,8768
 RT 230,46,9280
 MA 120,196,176
 buffer_load_dwordx4 v3, s[24:27], s70 offen lds
 MA 112,200,184
 RT 232,45,13120
 MA 116,200,188
 RT 234,45,13632
 MA 124,204,188
 WL 6
 RT 236,46,13120
 MA 120,204,184
 RT 238,46,13632
 MA 128,208,136
 RT 240,45,17472
 RT 242,45,17984
 MA 132,208,140
 buffer_load_dwordx4 v4, s[24:27], s70 offen offset:1088 lds
 MA 140,212,140
 RT 244,46,17472
 RT 246,46,17984
 MA 136,212,136
 CV 144,112,113
 CV 145,114,115
 MA 128,216,152
 RT 248,45,21824
 RT 250,45,22336
 MA 132,216,156
 CV 146,120,121
 CV 147,122,123
 MA 140,220,156
 WL 6
 RT 252,46,21824
 RT 254,46,22336
 MA 136,220,152
 v_add_u32 v45, s4, v44
 v_xor_b32 v46, 32, v45
 MA 128,224,160
 s_sub_u32 s91, s91, 1
 s_cmp_lg_u32 s91, 0
 s_cbranch_scc1 L_A_loop2
 s_waitcnt vmcnt(6)
 s_barrier
 RT 192,45,0
 RT 194,45,512
 MA 132,224,164
 s_mov_b32 s89, s88
 s_mov_b32 s88, s87
 MA 140,228,164
 RT 196,46,0
 RT 198,46,512
 MA 136,228,160
 s_mov_b32 s87, s4
 buffer_store_dwordx4 v[144:147], v0, s[36:39], s90 offen sc1
 MA 128,232,168
 RT 200,45,4352
 RT 202,45,4864
 MA 132,232,172
 v_add_u32 v36, 1, v36
 CV 148,116,117
 MA 140,236,172
 WL 6
 RT 204,46,4352
 RT 206,46,4864
 MA 136,236,168
 buffer_store_dword v36, v42, s[36:39], 0 offen sc1
 MA 128,240,176
 RT 208,45,8704
 RT 210,45,9216
 MA 132,240,180
 s_getpc_b64 s[94:95]
L_cp4:
 s_add_u32 s94, s94, L_A_red-L_cp4
 s_addc_u32 s95, s95, 0
 v_bfe_u32 v40, v38, 16, 5
 v_and_b32 v39, 63, v38
 v_min_u32 v39, 3, v39
 v_mad_u32_u24 v39, v40, 4, v39
 v_lshlrev_b32 v39, 7, v39
 v_min_u32 v39, L_roleA_end-L_A_red-4, v39
 CV 149,118,119
 CV 150,124,125
 MA 140,244,180
 RT 212,46,8704
 RT 214,46,9216
 MA 136,244,176
 global_load_dword v47, v39, s[94:95]
 MA 128,248,184
 RT 216,45,13056
 RT 218,45,13568
 MA 132,248,188
 CV 151,126,127
 MA 140,252,188
 WL 6
 RT 220,46,13056
 RT 222,46,13568
 MA 136,252,184
 buffer_store_dwordx4 v[148:151], v0, s[36:39], s90 offen offset:1024 sc1
 v_mfma_f32_16x16x32_bf16 v[112:115], a[192:195], a[96:99], 0
 RT 224,45,17408
 RT 226,45,17920
 v_mfma_f32_16x16x32_bf16 v[116:119], a[192:195], a[100:103], 0
 s_add_u32 s4, s87, 0x9900
 s_cmp_lt_u32 s4, 0x26400
 s_cselect_b32 s4, s4, 0
 v_mfma_f32_16x16x32_bf16 v[124:127], a[196:199], a[100:103], 0
 RT 228,46,17408
 RT 230,46,17920
 v_mfma_f32_16x16x32_bf16 v[120:123], a[196:199], a[96:99], 0
 CV 152,128,129
 CV 153,130,131
 MA 112,200,112
 RT 232,45,21760
 RT 234,45,22272
 MA 116,200,116
 CV 154,136,137
 CV 155,138,139
 MA 124,204,116
 WL 6
 RT 236,46,21760
 RT 238,46,22272
 MA 120,204,112
 buffer_store_dwordx4 v[152:155], v0, s[36:39], s90 offen offset:2048 sc1
 MA 112,208,128
 RT 240,45,64
 RT 242,45,576
 MA 116,208,132
 CV 156,132,133
 CV 157,134,135
 MA 124,212,132
 RT 244,46,64
 RT 246,46,576
 MA 120,212,128
 CV 158,140,141
 CV 159,142,143
 MA 112,216,144
 RT 248,45,4416
 RT 250,45,4928
 MA 116,216,148
 buffer_store_dwordx4 v[156:159], v0, s[36:39], s90 offen offset:3072 sc1
 MA 124,220,148
 WL 6
 RT 252,46,4416
 RT 254,46,4928
 MA 120,220,144
 s_add_u32 s90, s90, 0x1000
 MA 112,224,104
 RT 192,45,8768
 MA 116,224,108
 RT 194,45,9280
 MA 124,228,108
 RT 196,46,8768
 MA 120,228,104
 RT 198,46,9280
 MA 112,232,120
 RT 200,45,13120
 MA 116,232,124
 RT 202,45,13632
 MA 124,236,124
 WL 6
 RT 204,46,13120
 MA 120,236,120
 RT 206,46,13632
 v_mfma_f32_16x16x32_bf16 v[128:131], a[240:243], a[96:99], 0
 RT 208,45,17472
 v_mfma_f32_16x16x32_bf16 v[132:135], a[240:243], a[100:103], 0
 RT 210,45,17984
 v_mfma_f32_16x16x32_bf16 v[140:143], a[244:247], a[100:103], 0
 RT 212,46,17472
 v_mfma_f32_16x16x32_bf16 v[136:139], a[244:247], a[96:99], 0
 RT 214,46,17984
 MA 128,248,112
 RT 216,45,21824
 MA 132,248,116
 RT 218,45,22336
 MA 140,252,116
 WL 6
 RT 220,46,21824
 RT 222,46,22336
 MA 136,252,112
 v_add_u32 v45, s4, v44
 v_xor_b32 v46, 32, v45
 MA 128,192,128
 s_waitcnt vmcnt(6)
 s_barrier
 RT 224,45,0
 RT 226,45,512
 MA 132,192,132
 s_mov_b32 s89, s88
 s_mov_b32 s88, s87
 MA 140,196,132
 RT 228,46,0
 RT 230,46,512
 MA 136,196,128
 s_mov_b32 s87, s4
 MA 128,200,144
 RT 232,45,4352
 RT 234,45,4864
 MA 132,200,148
 buffer_load_dword v16, v30, s[36:39], s76 offen sc1
 MA 140,204,148
 WL 6
 RT 236,46,4352
 MA 136,204,144
 RT 238,46,4864
 MA 128,208,104
 RT 240,45,8704
 MA 132,208,108
 RT 242,45,9216
 MA 140,212,108
 RT 244,46,8704
 MA 136,212,104
 RT 246,46,9216
 MA 128,216,120
 RT 248,45,13056
 MA 132,216,124
 RT 250,45,13568
 MA 140,220,124
 WL 6
 RT 252,46,13056
 MA 136,220,120
 RT 254,46,13568
 MA 112,224,136
 RT 192,45,17408
 MA 116,224,140
 RT 194,45,17920
 MA 124,228,140
 RT 196,46,17408
 MA 120,228,136
 RT 198,46,17920
 MA 112,232,152
 RT 200,45,21760
 MA 116,232,156
 RT 202,45,22272
 MA 124,236,156
 WL 6
 RT 204,46,21760
 MA 120,236,152
 RT 206,46,22272
 MA 112,240,160
 RT 208,45,64
 MA 116,240,164
 RT 210,45,576
 MA 124,244,164
 RT 212,46,64
 MA 120,244,160
 RT 214,46,576
 MA 112,248,168
 RT 216,45,4416
 MA 116,248,172
 RT 218,45,4928
 MA 124,252,172
 WL 6
 RT 220,46,4416
 MA 120,252,168
 RT 222,46,4928
 MA 112,192,176
 RT 224,45,8768
 MA 116,192,180
 RT 226,45,9280
 MA 124,196,180
 RT 228,46,8768
 MA 120,196,176
 RT 230,46,9280
 MA 112,200,184
 RT 232,45,13120
 MA 116,200,188
 RT 234,45,13632
 MA 124,204,188
 WL 6
 RT 236,46,13120
 MA 120,204,184
 RT 238,46,13632
 MA 128,208,136
 RT 240,45,17472
 RT 242,45,17984
 MA 132,208,140
 CV 144,112,113
 CV 145,114,115
 MA 140,212,140
 RT 244,46,17472
 RT 246,46,17984
 MA 136,212,136
 CV 146,120,121
 CV 147,122,123
 MA 128,216,152
 RT 248,45,21824
 RT 250,45,22336
 MA 132,216,156
 buffer_store_dwordx4 v[144:147], v0, s[36:39], s90 offen sc1
 MA 140,220,156
 WL 6
 RT 252,46,21824
 RT 254,46,22336
 MA 136,220,152
 CV 148,116,117
 CV 149,118,119
 MA 128,224,160
 CV 150,124,125
 CV 151,126,127
 MA 132,224,164
 buffer_store_dwordx4 v[148:151], v0, s[36:39], s90 offen offset:1024 sc1
 MA 140,228,164
 MA 136,228,160
 s_nop 0
 MA 128,232,168
 MA 132,232,172
 s_nop 0
 MA 140,236,172
 WL 0
 MA 136,236,168
 s_nop 0
 MA 128,240,176
 MA 132,240,180
 s_nop 0
 MA 140,244,180
 MA 136,244,176
 s_nop 0
 MA 128,248,184
 MA 132,248,188
 s_nop 0
 MA 140,252,188
 MA 136,252,184
 s_nop 0
 s_nop 2
 CV 152,128,129
 CV 153,130,131
 s_nop 1
 CV 154,136,137
 CV 155,138,139
 buffer_store_dwordx4 v[152:155], v0, s[36:39], s90 offen offset:2048 sc1
 CV 156,132,133
 CV 157,134,135
 CV 158,140,141
 CV 159,142,143
 buffer_store_dwordx4 v[156:159], v0, s[36:39], s90 offen offset:3072 sc1
 s_add_u32 s90, s90, 0x1000
 s_mov_b32 s78, 0
 s_mov_b32 s79, 0
 s_mov_b32 s40, 0
 s_mov_b32 s58, 0
 s_mov_b32 s41, 0x26404
 s_nop 1
 s_cmp_eq_u32 s62, 0
 s_cbranch_scc0 L_A_e2
 s_waitcnt vmcnt(4)
 v_readfirstlane_b32 s40, v17
 s_nop 1
 s_cmp_ge_u32 s40, 16
 s_cbranch_scc0 L_A_e1
 v_cmp_ne_u32 vcc, 0, v16
 s_nop 1
 s_lshr_b64 s[72:73], vcc, 18
 s_and_b32 s73, s73, 15
 s_mov_b32 s78, 0
 s_mov_b32 s79, 0
 v_cmp_ge_u32 vcc, 0, v16
 s_nop 1
 s_and_b32 s92, vcc_lo, 0x7ff
 s_cselect_b32 s78, s78, 4
 s_and_b32 s92, vcc_lo, 0x1f800
 s_cselect_b32 s79, s79, 4
 v_cmp_ge_u32 vcc, 1, v16
 s_nop 1
 s_and_b32 s92, vcc_lo, 0x7ff
 s_cselect_b32 s78, s78, 8
 s_and_b32 s92, vcc_lo, 0x1f800
 s_cselect_b32 s79, s79, 8
 v_cmp_ge_u32 vcc, 2, v16
 s_nop 1
 s_and_b32 s92, vcc_lo, 0x7ff
 s_cselect_b32 s78, s78, 12
 s_and_b32 s92, vcc_lo, 0x1f800
 s_cselect_b32 s79, s79, 12
 v_cmp_ge_u32 vcc, 3, v16
 s_nop 1
 s_and_b32 s92, vcc_lo, 0x7ff
 s_cselect_b32 s78, s78, 16
 s_and_b32 s92, vcc_lo, 0x1f800
 s_cselect_b32 s79, s79, 16
 v_cmp_ge_u32 vcc, 4, v16
 s_nop 1
 s_and_b32 s92, vcc_lo, 0x7ff
 s_cselect_b32 s78, s78, 20
 s_and_b32 s92, vcc_lo, 0x1f800
 s_cselect_b32 s79, s79, 20
 v_cmp_ge_u32 vcc, 5, v16
 s_nop 1
 s_and_b32 s92, vcc_lo, 0x7ff
 s_cselect_b32 s78, s78, 24
 s_and_b32 s92, vcc_lo, 0x1f800
 s_cselect_b32 s79, s79, 24
 v_cmp_ge_u32 vcc, 6, v16
 s_nop 1
 s_and_b32 s92, vcc_lo, 0x7ff
 s_cselect_b32 s78, s78, 28
 s_and_b32 s92, vcc_lo, 0x1f800
 s_cselect_b32 s79, s79, 28
 v_cmp_ge_u32 vcc, 7, v16
 s_nop 1
 s_and_b32 s92, vcc_lo, 0x7ff
 s_cselect_b32 s78, s78, 32
 s_and_b32 s92, vcc_lo, 0x1f800
 s_cselect_b32 s79, s79, 32
 v_cmp_ge_u32 vcc, 8, v16
 s_nop 1
 s_and_b32 s92, vcc_lo, 0x7ff
 s_cselect_b32 s78, s78, 36
 s_and_b32 s92, vcc_lo, 0x1f800
 s_cselect_b32 s79, s79, 36
L_A_e1:
 s_lshl_b32 s92, s79, 8
 s_or_b32 s92, s92, s78
 s_lshl_b32 s93, s58, 16
 s_or_b32 s92, s92, s93
 v_mov_b32 v24, s92
 v_mov_b32 v23, 0x26400
 ds_write_b32 v23, v24
 WL 0
L_A_e2:
 s_barrier
 s_call_b64 s[56:57], L_A_red
 s_endpgm
.p2align 2
L_A_slow0:
 s_nop 7
 s_nop 7
 v_lshrrev_b32 v154, 4, v0
 v_and_b32 v155, 15, v154
 v_lshrrev_b32 v154, 4, v154
 v_lshlrev_b32 v152, 8, v155
 v_lshl_add_u32 v152, v154, 4, v152
 v_lshlrev_b32 v153, 1, v155
 v_lshl_add_u32 v153, v154, 10, v153
 s_mov_b32 s98, s40
 v_mov_b32 v156, 0xff800000
 v_mov_b32 v157, 0xff800000
 s_mov_b32 s99, 0
L_A_slow0_a:
 s_add_u32 s97, s98, s99
 buffer_load_dwordx4 v[136:139], v152, s[12:15], s97 offen
 buffer_load_dwordx4 v[140:143], v152, s[12:15], s97 offen offset:64
 buffer_load_dwordx4 v[144:147], v152, s[12:15], s97 offen offset:128
 buffer_load_dwordx4 v[148:151], v152, s[12:15], s97 offen offset:192
 s_waitcnt vmcnt(0)
 v_mfma_f32_16x16x32_bf16 v[112:115], v[136:139], a[0:3], 0
 v_mfma_f32_16x16x32_bf16 v[116:119], v[136:139], a[4:7], 0
 v_mfma_f32_16x16x32_bf16 v[112:115], v[140:143], a[8:11], v[112:115]
 v_mfma_f32_16x16x32_bf16 v[116:119], v[140:143], a[12:15], v[116:119]
 v_mfma_f32_16x16x32_bf16 v[112:115], v[144:147], a[16:19], v[112:115]
 v_mfma_f32_16x16x32_bf16 v[116:119], v[144:147], a[20:23], v[116:119]
 v_mfma_f32_16x16x32_bf16 v[112:115], v[148:151], a[24:27], v[112:115]
 v_mfma_f32_16x16x32_bf16 v[116:119], v[148:151], a[28:31], v[116:119]
 s_nop 7
 s_nop 3
 s_add_u32 s97, s97, 0x1000
 buffer_load_dwordx4 v[136:139], v152, s[12:15], s97 offen
 buffer_load_dwordx4 v[140:143], v152, s[12:15], s97 offen offset:64
 buffer_load_dwordx4 v[144:147], v152, s[12:15], s97 offen offset:128
 buffer_load_dwordx4 v[148:151], v152, s[12:15], s97 offen offset:192
 s_waitcnt vmcnt(0)
 v_mfma_f32_16x16x32_bf16 v[120:123], v[136:139], a[0:3], 0
 v_mfma_f32_16x16x32_bf16 v[124:127], v[136:139], a[4:7], 0
 v_mfma_f32_16x16x32_bf16 v[120:123], v[140:143], a[8:11], v[120:123]
 v_mfma_f32_16x16x32_bf16 v[124:127], v[140:143], a[12:15], v[124:127]
 v_mfma_f32_16x16x32_bf16 v[120:123], v[144:147], a[16:19], v[120:123]
 v_mfma_f32_16x16x32_bf16 v[124:127], v[144:147], a[20:23], v[124:127]
 v_mfma_f32_16x16x32_bf16 v[120:123], v[148:151], a[24:27], v[120:123]
 v_mfma_f32_16x16x32_bf16 v[124:127], v[148:151], a[28:31], v[124:127]
 s_nop 7
 s_nop 3
 v_max3_f32 v156, v156, v112, v113
 v_max3_f32 v156, v156, v114, v115
 v_max3_f32 v157, v157, v116, v117
 v_max3_f32 v157, v157, v118, v119
 v_max3_f32 v156, v156, v120, v121
 v_max3_f32 v156, v156, v122, v123
 v_max3_f32 v157, v157, v124, v125
 v_max3_f32 v157, v157, v126, v127
 s_add_u32 s99, s99, 0x2000
 s_cmp_lt_u32 s99, 0x20000
 s_cbranch_scc1 L_A_slow0_a
 v_mov_b32 v154, v156
 s_nop 1
 v_permlane16_swap_b32 v156, v154
 v_max_f32 v156, v156, v154
 v_mov_b32 v154, v156
 s_nop 1
 v_permlane32_swap_b32 v156, v154
 v_max_f32 v156, v156, v154
 v_mov_b32 v154, v157
 s_nop 1
 v_permlane16_swap_b32 v157, v154
 v_max_f32 v157, v157, v154
 v_mov_b32 v154, v157
 s_nop 1
 v_permlane32_swap_b32 v157, v154
 v_max_f32 v157, v157, v154
 v_mov_b32 v160, 0
 v_mov_b32 v161, 0
 v_mov_b32 v162, 0
 v_mov_b32 v163, 0
 v_mov_b32 v164, 0
 v_mov_b32 v165, 0
 v_mov_b32 v166, 0
 v_mov_b32 v167, 0
 v_mov_b32 v168, 0
 v_mov_b32 v169, 0
 v_mov_b32 v170, 0
 v_mov_b32 v171, 0
 v_mov_b32 v172, 0
 v_mov_b32 v173, 0
 v_mov_b32 v174, 0
 v_mov_b32 v175, 0
 v_mov_b32 v176, 0
 v_mov_b32 v177, 0
 v_mov_b32 v178, 0
 v_mov_b32 v179, 0
 v_mov_b32 v180, 0
 v_mov_b32 v181, 0
 v_mov_b32 v182, 0
 v_mov_b32 v183, 0
 v_mov_b32 v184, 0
 v_mov_b32 v185, 0
 v_mov_b32 v186, 0
 v_mov_b32 v187, 0
 v_mov_b32 v188, 0
 v_mov_b32 v189, 0
 v_mov_b32 v190, 0
 v_mov_b32 v191, 0
 v_mov_b32 v192, 0
 v_mov_b32 v193, 0
 v_mov_b32 v194, 0
 v_mov_b32 v195, 0
 v_mov_b32 v196, 0
 v_mov_b32 v197, 0
 v_mov_b32 v198, 0
 v_mov_b32 v199, 0
 v_mov_b32 v200, 0
 v_mov_b32 v201, 0
 v_mov_b32 v202, 0
 v_mov_b32 v203, 0
 v_mov_b32 v204, 0
 v_mov_b32 v205, 0
 v_mov_b32 v206, 0
 v_mov_b32 v207, 0
 v_mov_b32 v208, 0
 v_mov_b32 v209, 0
 v_mov_b32 v210, 0
 v_mov_b32 v211, 0
 v_mov_b32 v212, 0
 v_mov_b32 v213, 0
 v_mov_b32 v214, 0
 v_mov_b32 v215, 0
 v_mov_b32 v216, 0
 v_mov_b32 v217, 0
 v_mov_b32 v218, 0
 v_mov_b32 v219, 0
 v_mov_b32 v220, 0
 v_mov_b32 v221, 0
 v_mov_b32 v222, 0
 v_mov_b32 v223, 0
 v_mov_b32 v158, 0
 v_mov_b32 v159, 0
 s_mov_b32 s99, 0
L_A_slow0_b:
 s_add_u32 s97, s98, s99
 buffer_load_dwordx4 v[136:139], v152, s[12:15], s97 offen
 buffer_load_dwordx4 v[140:143], v152, s[12:15], s97 offen offset:64
 buffer_load_dwordx4 v[144:147], v152, s[12:15], s97 offen offset:128
 buffer_load_dwordx4 v[148:151], v152, s[12:15], s97 offen offset:192
 s_waitcnt vmcnt(0)
 v_mfma_f32_16x16x32_bf16 v[112:115], v[136:139], a[0:3], 0
 v_mfma_f32_16x16x32_bf16 v[116:119], v[136:139], a[4:7], 0
 v_mfma_f32_16x16x32_bf16 v[112:115], v[140:143], a[8:11], v[112:115]
 v_mfma_f32_16x16x32_bf16 v[116:119], v[140:143], a[12:15], v[116:119]
 v_mfma_f32_16x16x32_bf16 v[112:115], v[144:147], a[16:19], v[112:115]
 v_mfma_f32_16x16x32_bf16 v[116:119], v[144:147], a[20:23], v[116:119]
 v_mfma_f32_16x16x32_bf16 v[112:115], v[148:151], a[24:27], v[112:115]
 v_mfma_f32_16x16x32_bf16 v[116:119], v[148:151], a[28:31], v[116:119]
 s_nop 7
 s_nop 3
 s_add_u32 s97, s97, 0x1000
 buffer_load_dwordx4 v[136:139], v152, s[12:15], s97 offen
 buffer_load_dwordx4 v[140:143], v152, s[12:15], s97 offen offset:64
 buffer_load_dwordx4 v[144:147], v152, s[12:15], s97 offen offset:128
 buffer_load_dwordx4 v[148:151], v152, s[12:15], s97 offen offset:192
 s_waitcnt vmcnt(0)
 v_mfma_f32_16x16x32_bf16 v[120:123], v[136:139], a[0:3], 0
 v_mfma_f32_16x16x32_bf16 v[124:127], v[136:139], a[4:7], 0
 v_mfma_f32_16x16x32_bf16 v[120:123], v[140:143], a[8:11], v[120:123]
 v_mfma_f32_16x16x32_bf16 v[124:127], v[140:143], a[12:15], v[124:127]
 v_mfma_f32_16x16x32_bf16 v[120:123], v[144:147], a[16:19], v[120:123]
 v_mfma_f32_16x16x32_bf16 v[124:127], v[144:147], a[20:23], v[124:127]
 v_mfma_f32_16x16x32_bf16 v[120:123], v[148:151], a[24:27], v[120:123]
 v_mfma_f32_16x16x32_bf16 v[124:127], v[148:151], a[28:31], v[124:127]
 s_nop 7
 s_nop 3
 v_sub_f32 v112, v112, v156
 v_sub_f32 v113, v113, v156
 v_sub_f32 v114, v114, v156
 v_sub_f32 v115, v115, v156
 v_sub_f32 v116, v116, v157
 v_sub_f32 v117, v117, v157
 v_sub_f32 v118, v118, v157
 v_sub_f32 v119, v119, v157
 v_sub_f32 v120, v120, v156
 v_sub_f32 v121, v121, v156
 v_sub_f32 v122, v122, v156
 v_sub_f32 v123, v123, v156
 v_sub_f32 v124, v124, v157
 v_sub_f32 v125, v125, v157
 v_sub_f32 v126, v126, v157
 v_sub_f32 v127, v127, v157
 EX 112,112
 EX 113,113
 EX 114,114
 EX 115,115
 EX 116,116
 EX 117,117
 EX 118,118
 EX 119,119
 EX 120,120
 EX 121,121
 EX 122,122
 EX 123,123
 EX 124,124
 EX 125,125
 EX 126,126
 EX 127,127
 AD 158,158,112
 AD 158,158,113
 AD 158,158,114
 AD 158,158,115
 AD 159,159,116
 AD 159,159,117
 AD 159,159,118
 AD 159,159,119
 AD 158,158,120
 AD 158,158,121
 AD 158,158,122
 AD 158,158,123
 AD 159,159,124
 AD 159,159,125
 AD 159,159,126
 AD 159,159,127
 CV 128,112,113
 CV 129,114,115
 CV 130,120,121
 CV 131,122,123
 CV 132,116,117
 CV 133,118,119
 CV 134,124,125
 CV 135,126,127
 s_add_u32 s97, s98, s99
 buffer_load_ushort v136, v153, s[16:19], s97 offen
 buffer_load_ushort v144, v153, s[16:19], s97 offen offset:256
 buffer_load_ushort v137, v153, s[16:19], s97 offen offset:512
 buffer_load_ushort v145, v153, s[16:19], s97 offen offset:768
 buffer_load_ushort v140, v153, s[16:19], s97 offen offset:32
 buffer_load_ushort v148, v153, s[16:19], s97 offen offset:288
 buffer_load_ushort v141, v153, s[16:19], s97 offen offset:544
 buffer_load_ushort v149, v153, s[16:19], s97 offen offset:800
 s_add_u32 s97, s97, 0x1000
 buffer_load_ushort v138, v153, s[16:19], s97 offen
 buffer_load_ushort v146, v153, s[16:19], s97 offen offset:256
 buffer_load_ushort v139, v153, s[16:19], s97 offen offset:512
 buffer_load_ushort v147, v153, s[16:19], s97 offen offset:768
 buffer_load_ushort v142, v153, s[16:19], s97 offen offset:32
 buffer_load_ushort v150, v153, s[16:19], s97 offen offset:288
 buffer_load_ushort v143, v153, s[16:19], s97 offen offset:544
 buffer_load_ushort v151, v153, s[16:19], s97 offen offset:800
 s_waitcnt vmcnt(0)
 v_lshl_or_b32 v136, v144, 16, v136
 v_lshl_or_b32 v137, v145, 16, v137
 v_lshl_or_b32 v138, v146, 16, v138
 v_lshl_or_b32 v139, v147, 16, v139
 v_lshl_or_b32 v140, v148, 16, v140
 v_lshl_or_b32 v141, v149, 16, v141
 v_lshl_or_b32 v142, v150, 16, v142
 v_lshl_or_b32 v143, v151, 16, v143
 v_mfma_f32_16x16x32_bf16 v[160:163], v[136:139], v[128:131], v[160:163]
 v_mfma_f32_16x16x32_bf16 v[164:167], v[136:139], v[132:135], v[164:167]
 v_mfma_f32_16x16x32_bf16 v[168:171], v[140:143], v[128:131], v[168:171]
 v_mfma_f32_16x16x32_bf16 v[172:175], v[140:143], v[132:135], v[172:175]
 s_nop 7
 s_add_u32 s97, s98, s99
 buffer_load_ushort v136, v153, s[16:19], s97 offen offset:64
 buffer_load_ushort v144, v153, s[16:19], s97 offen offset:320
 buffer_load_ushort v137, v153, s[16:19], s97 offen offset:576
 buffer_load_ushort v145, v153, s[16:19], s97 offen offset:832
 buffer_load_ushort v140, v153, s[16:19], s97 offen offset:96
 buffer_load_ushort v148, v153, s[16:19], s97 offen offset:352
 buffer_load_ushort v141, v153, s[16:19], s97 offen offset:608
 buffer_load_ushort v149, v153, s[16:19], s97 offen offset:864
 s_add_u32 s97, s97, 0x1000
 buffer_load_ushort v138, v153, s[16:19], s97 offen offset:64
 buffer_load_ushort v146, v153, s[16:19], s97 offen offset:320
 buffer_load_ushort v139, v153, s[16:19], s97 offen offset:576
 buffer_load_ushort v147, v153, s[16:19], s97 offen offset:832
 buffer_load_ushort v142, v153, s[16:19], s97 offen offset:96
 buffer_load_ushort v150, v153, s[16:19], s97 offen offset:352
 buffer_load_ushort v143, v153, s[16:19], s97 offen offset:608
 buffer_load_ushort v151, v153, s[16:19], s97 offen offset:864
 s_waitcnt vmcnt(0)
 v_lshl_or_b32 v136, v144, 16, v136
 v_lshl_or_b32 v137, v145, 16, v137
 v_lshl_or_b32 v138, v146, 16, v138
 v_lshl_or_b32 v139, v147, 16, v139
 v_lshl_or_b32 v140, v148, 16, v140
 v_lshl_or_b32 v141, v149, 16, v141
 v_lshl_or_b32 v142, v150, 16, v142
 v_lshl_or_b32 v143, v151, 16, v143
 v_mfma_f32_16x16x32_bf16 v[176:179], v[136:139], v[128:131], v[176:179]
 v_mfma_f32_16x16x32_bf16 v[180:183], v[136:139], v[132:135], v[180:183]
 v_mfma_f32_16x16x32_bf16 v[184:187], v[140:143], v[128:131], v[184:187]
 v_mfma_f32_16x16x32_bf16 v[188:191], v[140:143], v[132:135], v[188:191]
 s_nop 7
 s_add_u32 s97, s98, s99
 buffer_load_ushort v136, v153, s[16:19], s97 offen offset:128
 buffer_load_ushort v144, v153, s[16:19], s97 offen offset:384
 buffer_load_ushort v137, v153, s[16:19], s97 offen offset:640
 buffer_load_ushort v145, v153, s[16:19], s97 offen offset:896
 buffer_load_ushort v140, v153, s[16:19], s97 offen offset:160
 buffer_load_ushort v148, v153, s[16:19], s97 offen offset:416
 buffer_load_ushort v141, v153, s[16:19], s97 offen offset:672
 buffer_load_ushort v149, v153, s[16:19], s97 offen offset:928
 s_add_u32 s97, s97, 0x1000
 buffer_load_ushort v138, v153, s[16:19], s97 offen offset:128
 buffer_load_ushort v146, v153, s[16:19], s97 offen offset:384
 buffer_load_ushort v139, v153, s[16:19], s97 offen offset:640
 buffer_load_ushort v147, v153, s[16:19], s97 offen offset:896
 buffer_load_ushort v142, v153, s[16:19], s97 offen offset:160
 buffer_load_ushort v150, v153, s[16:19], s97 offen offset:416
 buffer_load_ushort v143, v153, s[16:19], s97 offen offset:672
 buffer_load_ushort v151, v153, s[16:19], s97 offen offset:928
 s_waitcnt vmcnt(0)
 v_lshl_or_b32 v136, v144, 16, v136
 v_lshl_or_b32 v137, v145, 16, v137
 v_lshl_or_b32 v138, v146, 16, v138
 v_lshl_or_b32 v139, v147, 16, v139
 v_lshl_or_b32 v140, v148, 16, v140
 v_lshl_or_b32 v141, v149, 16, v141
 v_lshl_or_b32 v142, v150, 16, v142
 v_lshl_or_b32 v143, v151, 16, v143
 v_mfma_f32_16x16x32_bf16 v[192:195], v[136:139], v[128:131], v[192:195]
 v_mfma_f32_16x16x32_bf16 v[196:199], v[136:139], v[132:135], v[196:199]
 v_mfma_f32_16x16x32_bf16 v[200:203], v[140:143], v[128:131], v[200:203]
 v_mfma_f32_16x16x32_bf16 v[204:207], v[140:143], v[132:135], v[204:207]
 s_nop 7
 s_add_u32 s97, s98, s99
 buffer_load_ushort v136, v153, s[16:19], s97 offen offset:192
 buffer_load_ushort v144, v153, s[16:19], s97 offen offset:448
 buffer_load_ushort v137, v153, s[16:19], s97 offen offset:704
 buffer_load_ushort v145, v153, s[16:19], s97 offen offset:960
 buffer_load_ushort v140, v153, s[16:19], s97 offen offset:224
 buffer_load_ushort v148, v153, s[16:19], s97 offen offset:480
 buffer_load_ushort v141, v153, s[16:19], s97 offen offset:736
 buffer_load_ushort v149, v153, s[16:19], s97 offen offset:992
 s_add_u32 s97, s97, 0x1000
 buffer_load_ushort v138, v153, s[16:19], s97 offen offset:192
 buffer_load_ushort v146, v153, s[16:19], s97 offen offset:448
 buffer_load_ushort v139, v153, s[16:19], s97 offen offset:704
 buffer_load_ushort v147, v153, s[16:19], s97 offen offset:960
 buffer_load_ushort v142, v153, s[16:19], s97 offen offset:224
 buffer_load_ushort v150, v153, s[16:19], s97 offen offset:480
 buffer_load_ushort v143, v153, s[16:19], s97 offen offset:736
 buffer_load_ushort v151, v153, s[16:19], s97 offen offset:992
 s_waitcnt vmcnt(0)
 v_lshl_or_b32 v136, v144, 16, v136
 v_lshl_or_b32 v137, v145, 16, v137
 v_lshl_or_b32 v138, v146, 16, v138
 v_lshl_or_b32 v139, v147, 16, v139
 v_lshl_or_b32 v140, v148, 16, v140
 v_lshl_or_b32 v141, v149, 16, v141
 v_lshl_or_b32 v142, v150, 16, v142
 v_lshl_or_b32 v143, v151, 16, v143
 v_mfma_f32_16x16x32_bf16 v[208:211], v[136:139], v[128:131], v[208:211]
 v_mfma_f32_16x16x32_bf16 v[212:215], v[136:139], v[132:135], v[212:215]
 v_mfma_f32_16x16x32_bf16 v[216:219], v[140:143], v[128:131], v[216:219]
 v_mfma_f32_16x16x32_bf16 v[220:223], v[140:143], v[132:135], v[220:223]
 s_nop 7
 s_add_u32 s99, s99, 0x2000
 s_cmp_lt_u32 s99, 0x20000
 s_cbranch_scc1 L_A_slow0_b
 s_nop 7
 s_nop 3
 v_mov_b32 v154, v158
 s_nop 1
 v_permlane16_swap_b32 v158, v154
 AD 158,158,154
 v_mov_b32 v154, v158
 s_nop 1
 v_permlane32_swap_b32 v158, v154
 AD 158,158,154
 v_mov_b32 v154, v159
 s_nop 1
 v_permlane16_swap_b32 v159, v154
 AD 159,159,154
 v_mov_b32 v154, v159
 s_nop 1
 v_permlane32_swap_b32 v159, v154
 AD 159,159,154
 v_rcp_f32 v158, v158
 v_rcp_f32 v159, v159
 ML 160,160,158
 ML 161,161,158
 ML 162,162,158
 ML 163,163,158
 ML 164,164,159
 ML 165,165,159
 ML 166,166,159
 ML 167,167,159
 ML 168,168,158
 ML 169,169,158
 ML 170,170,158
 ML 171,171,158
 ML 172,172,159
 ML 173,173,159
 ML 174,174,159
 ML 175,175,159
 ML 176,176,158
 ML 177,177,158
 ML 178,178,158
 ML 179,179,158
 ML 180,180,159
 ML 181,181,159
 ML 182,182,159
 ML 183,183,159
 ML 184,184,158
 ML 185,185,158
 ML 186,186,158
 ML 187,187,158
 ML 188,188,159
 ML 189,189,159
 ML 190,190,159
 ML 191,191,159
 ML 192,192,158
 ML 193,193,158
 ML 194,194,158
 ML 195,195,158
 ML 196,196,159
 ML 197,197,159
 ML 198,198,159
 ML 199,199,159
 ML 200,200,158
 ML 201,201,158
 ML 202,202,158
 ML 203,203,158
 ML 204,204,159
 ML 205,205,159
 ML 206,206,159
 ML 207,207,159
 ML 208,208,158
 ML 209,209,158
 ML 210,210,158
 ML 211,211,158
 ML 212,212,159
 ML 213,213,159
 ML 214,214,159
 ML 215,215,159
 ML 216,216,158
 ML 217,217,158
 ML 218,218,158
 ML 219,219,158
 ML 220,220,159
 ML 221,221,159
 ML 222,222,159
 ML 223,223,159
 CV 160,160,161
 AW 96,160
 CV 162,162,163
 AW 97,162
 CV 168,168,169
 AW 98,168
 CV 170,170,171
 AW 99,170
 CV 164,164,165
 AW 100,164
 CV 166,166,167
 AW 101,166
 CV 172,172,173
 AW 102,172
 CV 174,174,175
 AW 103,174
 CV 176,176,177
 AW 112,176
 CV 178,178,179
 AW 113,178
 CV 184,184,185
 AW 114,184
 CV 186,186,187
 AW 115,186
 CV 180,180,181
 AW 116,180
 CV 182,182,183
 AW 117,182
 CV 188,188,189
 AW 118,188
 CV 190,190,191
 AW 119,190
 CV 192,192,193
 AW 128,192
 CV 194,194,195
 AW 129,194
 CV 200,200,201
 AW 130,200
 CV 202,202,203
 AW 131,202
 CV 196,196,197
 AW 132,196
 CV 198,198,199
 AW 133,198
 CV 204,204,205
 AW 134,204
 CV 206,206,207
 AW 135,206
 CV 208,208,209
 AW 144,208
 CV 210,210,211
 AW 145,210
 CV 216,216,217
 AW 146,216
 CV 218,218,219
 AW 147,218
 CV 212,212,213
 AW 148,212
 CV 214,214,215
 AW 149,214
 CV 220,220,221
 AW 150,220
 CV 222,222,223
 AW 151,222
 s_nop 1
 s_setpc_b64 s[56:57]
.p2align 2
L_A_slow1:
 s_nop 7
 s_nop 7
 v_lshrrev_b32 v154, 4, v0
 v_and_b32 v155, 15, v154
 v_lshrrev_b32 v154, 4, v154
 v_lshlrev_b32 v152, 8, v155
 v_lshl_add_u32 v152, v154, 4, v152
 v_lshlrev_b32 v153, 1, v155
 v_lshl_add_u32 v153, v154, 10, v153
 s_mov_b32 s98, s40
 v_mov_b32 v156, 0xff800000
 v_mov_b32 v157, 0xff800000
 s_mov_b32 s99, 0
L_A_slow1_a:
 s_add_u32 s97, s98, s99
 buffer_load_dwordx4 v[136:139], v152, s[12:15], s97 offen
 buffer_load_dwordx4 v[140:143], v152, s[12:15], s97 offen offset:64
 buffer_load_dwordx4 v[144:147], v152, s[12:15], s97 offen offset:128
 buffer_load_dwordx4 v[148:151], v152, s[12:15], s97 offen offset:192
 s_waitcnt vmcnt(0)
 v_mfma_f32_16x16x32_bf16 v[112:115], v[136:139], a[32:35], 0
 v_mfma_f32_16x16x32_bf16 v[116:119], v[136:139], a[36:39], 0
 v_mfma_f32_16x16x32_bf16 v[112:115], v[140:143], a[40:43], v[112:115]
 v_mfma_f32_16x16x32_bf16 v[116:119], v[140:143], a[44:47], v[116:119]
 v_mfma_f32_16x16x32_bf16 v[112:115], v[144:147], a[48:51], v[112:115]
 v_mfma_f32_16x16x32_bf16 v[116:119], v[144:147], a[52:55], v[116:119]
 v_mfma_f32_16x16x32_bf16 v[112:115], v[148:151], a[56:59], v[112:115]
 v_mfma_f32_16x16x32_bf16 v[116:119], v[148:151], a[60:63], v[116:119]
 s_nop 7
 s_nop 3
 s_add_u32 s97, s97, 0x1000
 buffer_load_dwordx4 v[136:139], v152, s[12:15], s97 offen
 buffer_load_dwordx4 v[140:143], v152, s[12:15], s97 offen offset:64
 buffer_load_dwordx4 v[144:147], v152, s[12:15], s97 offen offset:128
 buffer_load_dwordx4 v[148:151], v152, s[12:15], s97 offen offset:192
 s_waitcnt vmcnt(0)
 v_mfma_f32_16x16x32_bf16 v[120:123], v[136:139], a[32:35], 0
 v_mfma_f32_16x16x32_bf16 v[124:127], v[136:139], a[36:39], 0
 v_mfma_f32_16x16x32_bf16 v[120:123], v[140:143], a[40:43], v[120:123]
 v_mfma_f32_16x16x32_bf16 v[124:127], v[140:143], a[44:47], v[124:127]
 v_mfma_f32_16x16x32_bf16 v[120:123], v[144:147], a[48:51], v[120:123]
 v_mfma_f32_16x16x32_bf16 v[124:127], v[144:147], a[52:55], v[124:127]
 v_mfma_f32_16x16x32_bf16 v[120:123], v[148:151], a[56:59], v[120:123]
 v_mfma_f32_16x16x32_bf16 v[124:127], v[148:151], a[60:63], v[124:127]
 s_nop 7
 s_nop 3
 v_max3_f32 v156, v156, v112, v113
 v_max3_f32 v156, v156, v114, v115
 v_max3_f32 v157, v157, v116, v117
 v_max3_f32 v157, v157, v118, v119
 v_max3_f32 v156, v156, v120, v121
 v_max3_f32 v156, v156, v122, v123
 v_max3_f32 v157, v157, v124, v125
 v_max3_f32 v157, v157, v126, v127
 s_add_u32 s99, s99, 0x2000
 s_cmp_lt_u32 s99, 0x20000
 s_cbranch_scc1 L_A_slow1_a
 v_mov_b32 v154, v156
 s_nop 1
 v_permlane16_swap_b32 v156, v154
 v_max_f32 v156, v156, v154
 v_mov_b32 v154, v156
 s_nop 1
 v_permlane32_swap_b32 v156, v154
 v_max_f32 v156, v156, v154
 v_mov_b32 v154, v157
 s_nop 1
 v_permlane16_swap_b32 v157, v154
 v_max_f32 v157, v157, v154
 v_mov_b32 v154, v157
 s_nop 1
 v_permlane32_swap_b32 v157, v154
 v_max_f32 v157, v157, v154
 v_mov_b32 v160, 0
 v_mov_b32 v161, 0
 v_mov_b32 v162, 0
 v_mov_b32 v163, 0
 v_mov_b32 v164, 0
 v_mov_b32 v165, 0
 v_mov_b32 v166, 0
 v_mov_b32 v167, 0
 v_mov_b32 v168, 0
 v_mov_b32 v169, 0
 v_mov_b32 v170, 0
 v_mov_b32 v171, 0
 v_mov_b32 v172, 0
 v_mov_b32 v173, 0
 v_mov_b32 v174, 0
 v_mov_b32 v175, 0
 v_mov_b32 v176, 0
 v_mov_b32 v177, 0
 v_mov_b32 v178, 0
 v_mov_b32 v179, 0
 v_mov_b32 v180, 0
 v_mov_b32 v181, 0
 v_mov_b32 v182, 0
 v_mov_b32 v183, 0
 v_mov_b32 v184, 0
 v_mov_b32 v185, 0
 v_mov_b32 v186, 0
 v_mov_b32 v187, 0
 v_mov_b32 v188, 0
 v_mov_b32 v189, 0
 v_mov_b32 v190, 0
 v_mov_b32 v191, 0
 v_mov_b32 v192, 0
 v_mov_b32 v193, 0
 v_mov_b32 v194, 0
 v_mov_b32 v195, 0
 v_mov_b32 v196, 0
 v_mov_b32 v197, 0
 v_mov_b32 v198, 0
 v_mov_b32 v199, 0
 v_mov_b32 v200, 0
 v_mov_b32 v201, 0
 v_mov_b32 v202, 0
 v_mov_b32 v203, 0
 v_mov_b32 v204, 0
 v_mov_b32 v205, 0
 v_mov_b32 v206, 0
 v_mov_b32 v207, 0
 v_mov_b32 v208, 0
 v_mov_b32 v209, 0
 v_mov_b32 v210, 0
 v_mov_b32 v211, 0
 v_mov_b32 v212, 0
 v_mov_b32 v213, 0
 v_mov_b32 v214, 0
 v_mov_b32 v215, 0
 v_mov_b32 v216, 0
 v_mov_b32 v217, 0
 v_mov_b32 v218, 0
 v_mov_b32 v219, 0
 v_mov_b32 v220, 0
 v_mov_b32 v221, 0
 v_mov_b32 v222, 0
 v_mov_b32 v223, 0
 v_mov_b32 v158, 0
 v_mov_b32 v159, 0
 s_mov_b32 s99, 0
L_A_slow1_b:
 s_add_u32 s97, s98, s99
 buffer_load_dwordx4 v[136:139], v152, s[12:15], s97 offen
 buffer_load_dwordx4 v[140:143], v152, s[12:15], s97 offen offset:64
 buffer_load_dwordx4 v[144:147], v152, s[12:15], s97 offen offset:128
 buffer_load_dwordx4 v[148:151], v152, s[12:15], s97 offen offset:192
 s_waitcnt vmcnt(0)
 v_mfma_f32_16x16x32_bf16 v[112:115], v[136:139], a[32:35], 0
 v_mfma_f32_16x16x32_bf16 v[116:119], v[136:139], a[36:39], 0
 v_mfma_f32_16x16x32_bf16 v[112:115], v[140:143], a[40:43], v[112:115]
 v_mfma_f32_16x16x32_bf16 v[116:119], v[140:143], a[44:47], v[116:119]
 v_mfma_f32_16x16x32_bf16 v[112:115], v[144:147], a[48:51], v[112:115]
 v_mfma_f32_16x16x32_bf16 v[116:119], v[144:147], a[52:55], v[116:119]
 v_mfma_f32_16x16x32_bf16 v[112:115], v[148:151], a[56:59], v[112:115]
 v_mfma_f32_16x16x32_bf16 v[116:119], v[148:151], a[60:63], v[116:119]
 s_nop 7
 s_nop 3
 s_add_u32 s97, s97, 0x1000
 buffer_load_dwordx4 v[136:139], v152, s[12:15], s97 offen
 buffer_load_dwordx4 v[140:143], v152, s[12:15], s97 offen offset:64
 buffer_load_dwordx4 v[144:147], v152, s[12:15], s97 offen offset:128
 buffer_load_dwordx4 v[148:151], v152, s[12:15], s97 offen offset:192
 s_waitcnt vmcnt(0)
 v_mfma_f32_16x16x32_bf16 v[120:123], v[136:139], a[32:35], 0
 v_mfma_f32_16x16x32_bf16 v[124:127], v[136:139], a[36:39], 0
 v_mfma_f32_16x16x32_bf16 v[120:123], v[140:143], a[40:43], v[120:123]
 v_mfma_f32_16x16x32_bf16 v[124:127], v[140:143], a[44:47], v[124:127]
 v_mfma_f32_16x16x32_bf16 v[120:123], v[144:147], a[48:51], v[120:123]
 v_mfma_f32_16x16x32_bf16 v[124:127], v[144:147], a[52:55], v[124:127]
 v_mfma_f32_16x16x32_bf16 v[120:123], v[148:151], a[56:59], v[120:123]
 v_mfma_f32_16x16x32_bf16 v[124:127], v[148:151], a[60:63], v[124:127]
 s_nop 7
 s_nop 3
 v_sub_f32 v112, v112, v156
 v_sub_f32 v113, v113, v156
 v_sub_f32 v114, v114, v156
 v_sub_f32 v115, v115, v156
 v_sub_f32 v116, v116, v157
 v_sub_f32 v117, v117, v157
 v_sub_f32 v118, v118, v157
 v_sub_f32 v119, v119, v157
 v_sub_f32 v120, v120, v156
 v_sub_f32 v121, v121, v156
 v_sub_f32 v122, v122, v156
 v_sub_f32 v123, v123, v156
 v_sub_f32 v124, v124, v157
 v_sub_f32 v125, v125, v157
 v_sub_f32 v126, v126, v157
 v_sub_f32 v127, v127, v157
 EX 112,112
 EX 113,113
 EX 114,114
 EX 115,115
 EX 116,116
 EX 117,117
 EX 118,118
 EX 119,119
 EX 120,120
 EX 121,121
 EX 122,122
 EX 123,123
 EX 124,124
 EX 125,125
 EX 126,126
 EX 127,127
 AD 158,158,112
 AD 158,158,113
 AD 158,158,114
 AD 158,158,115
 AD 159,159,116
 AD 159,159,117
 AD 159,159,118
 AD 159,159,119
 AD 158,158,120
 AD 158,158,121
 AD 158,158,122
 AD 158,158,123
 AD 159,159,124
 AD 159,159,125
 AD 159,159,126
 AD 159,159,127
 CV 128,112,113
 CV 129,114,115
 CV 130,120,121
 CV 131,122,123
 CV 132,116,117
 CV 133,118,119
 CV 134,124,125
 CV 135,126,127
 s_add_u32 s97, s98, s99
 buffer_load_ushort v136, v153, s[16:19], s97 offen
 buffer_load_ushort v144, v153, s[16:19], s97 offen offset:256
 buffer_load_ushort v137, v153, s[16:19], s97 offen offset:512
 buffer_load_ushort v145, v153, s[16:19], s97 offen offset:768
 buffer_load_ushort v140, v153, s[16:19], s97 offen offset:32
 buffer_load_ushort v148, v153, s[16:19], s97 offen offset:288
 buffer_load_ushort v141, v153, s[16:19], s97 offen offset:544
 buffer_load_ushort v149, v153, s[16:19], s97 offen offset:800
 s_add_u32 s97, s97, 0x1000
 buffer_load_ushort v138, v153, s[16:19], s97 offen
 buffer_load_ushort v146, v153, s[16:19], s97 offen offset:256
 buffer_load_ushort v139, v153, s[16:19], s97 offen offset:512
 buffer_load_ushort v147, v153, s[16:19], s97 offen offset:768
 buffer_load_ushort v142, v153, s[16:19], s97 offen offset:32
 buffer_load_ushort v150, v153, s[16:19], s97 offen offset:288
 buffer_load_ushort v143, v153, s[16:19], s97 offen offset:544
 buffer_load_ushort v151, v153, s[16:19], s97 offen offset:800
 s_waitcnt vmcnt(0)
 v_lshl_or_b32 v136, v144, 16, v136
 v_lshl_or_b32 v137, v145, 16, v137
 v_lshl_or_b32 v138, v146, 16, v138
 v_lshl_or_b32 v139, v147, 16, v139
 v_lshl_or_b32 v140, v148, 16, v140
 v_lshl_or_b32 v141, v149, 16, v141
 v_lshl_or_b32 v142, v150, 16, v142
 v_lshl_or_b32 v143, v151, 16, v143
 v_mfma_f32_16x16x32_bf16 v[160:163], v[136:139], v[128:131], v[160:163]
 v_mfma_f32_16x16x32_bf16 v[164:167], v[136:139], v[132:135], v[164:167]
 v_mfma_f32_16x16x32_bf16 v[168:171], v[140:143], v[128:131], v[168:171]
 v_mfma_f32_16x16x32_bf16 v[172:175], v[140:143], v[132:135], v[172:175]
 s_nop 7
 s_add_u32 s97, s98, s99
 buffer_load_ushort v136, v153, s[16:19], s97 offen offset:64
 buffer_load_ushort v144, v153, s[16:19], s97 offen offset:320
 buffer_load_ushort v137, v153, s[16:19], s97 offen offset:576
 buffer_load_ushort v145, v153, s[16:19], s97 offen offset:832
 buffer_load_ushort v140, v153, s[16:19], s97 offen offset:96
 buffer_load_ushort v148, v153, s[16:19], s97 offen offset:352
 buffer_load_ushort v141, v153, s[16:19], s97 offen offset:608
 buffer_load_ushort v149, v153, s[16:19], s97 offen offset:864
 s_add_u32 s97, s97, 0x1000
 buffer_load_ushort v138, v153, s[16:19], s97 offen offset:64
 buffer_load_ushort v146, v153, s[16:19], s97 offen offset:320
 buffer_load_ushort v139, v153, s[16:19], s97 offen offset:576
 buffer_load_ushort v147, v153, s[16:19], s97 offen offset:832
 buffer_load_ushort v142, v153, s[16:19], s97 offen offset:96
 buffer_load_ushort v150, v153, s[16:19], s97 offen offset:352
 buffer_load_ushort v143, v153, s[16:19], s97 offen offset:608
 buffer_load_ushort v151, v153, s[16:19], s97 offen offset:864
 s_waitcnt vmcnt(0)
 v_lshl_or_b32 v136, v144, 16, v136
 v_lshl_or_b32 v137, v145, 16, v137
 v_lshl_or_b32 v138, v146, 16, v138
 v_lshl_or_b32 v139, v147, 16, v139
 v_lshl_or_b32 v140, v148, 16, v140
 v_lshl_or_b32 v141, v149, 16, v141
 v_lshl_or_b32 v142, v150, 16, v142
 v_lshl_or_b32 v143, v151, 16, v143
 v_mfma_f32_16x16x32_bf16 v[176:179], v[136:139], v[128:131], v[176:179]
 v_mfma_f32_16x16x32_bf16 v[180:183], v[136:139], v[132:135], v[180:183]
 v_mfma_f32_16x16x32_bf16 v[184:187], v[140:143], v[128:131], v[184:187]
 v_mfma_f32_16x16x32_bf16 v[188:191], v[140:143], v[132:135], v[188:191]
 s_nop 7
 s_add_u32 s97, s98, s99
 buffer_load_ushort v136, v153, s[16:19], s97 offen offset:128
 buffer_load_ushort v144, v153, s[16:19], s97 offen offset:384
 buffer_load_ushort v137, v153, s[16:19], s97 offen offset:640
 buffer_load_ushort v145, v153, s[16:19], s97 offen offset:896
 buffer_load_ushort v140, v153, s[16:19], s97 offen offset:160
 buffer_load_ushort v148, v153, s[16:19], s97 offen offset:416
 buffer_load_ushort v141, v153, s[16:19], s97 offen offset:672
 buffer_load_ushort v149, v153, s[16:19], s97 offen offset:928
 s_add_u32 s97, s97, 0x1000
 buffer_load_ushort v138, v153, s[16:19], s97 offen offset:128
 buffer_load_ushort v146, v153, s[16:19], s97 offen offset:384
 buffer_load_ushort v139, v153, s[16:19], s97 offen offset:640
 buffer_load_ushort v147, v153, s[16:19], s97 offen offset:896
 buffer_load_ushort v142, v153, s[16:19], s97 offen offset:160
 buffer_load_ushort v150, v153, s[16:19], s97 offen offset:416
 buffer_load_ushort v143, v153, s[16:19], s97 offen offset:672
 buffer_load_ushort v151, v153, s[16:19], s97 offen offset:928
 s_waitcnt vmcnt(0)
 v_lshl_or_b32 v136, v144, 16, v136
 v_lshl_or_b32 v137, v145, 16, v137
 v_lshl_or_b32 v138, v146, 16, v138
 v_lshl_or_b32 v139, v147, 16, v139
 v_lshl_or_b32 v140, v148, 16, v140
 v_lshl_or_b32 v141, v149, 16, v141
 v_lshl_or_b32 v142, v150, 16, v142
 v_lshl_or_b32 v143, v151, 16, v143
 v_mfma_f32_16x16x32_bf16 v[192:195], v[136:139], v[128:131], v[192:195]
 v_mfma_f32_16x16x32_bf16 v[196:199], v[136:139], v[132:135], v[196:199]
 v_mfma_f32_16x16x32_bf16 v[200:203], v[140:143], v[128:131], v[200:203]
 v_mfma_f32_16x16x32_bf16 v[204:207], v[140:143], v[132:135], v[204:207]
 s_nop 7
 s_add_u32 s97, s98, s99
 buffer_load_ushort v136, v153, s[16:19], s97 offen offset:192
 buffer_load_ushort v144, v153, s[16:19], s97 offen offset:448
 buffer_load_ushort v137, v153, s[16:19], s97 offen offset:704
 buffer_load_ushort v145, v153, s[16:19], s97 offen offset:960
 buffer_load_ushort v140, v153, s[16:19], s97 offen offset:224
 buffer_load_ushort v148, v153, s[16:19], s97 offen offset:480
 buffer_load_ushort v141, v153, s[16:19], s97 offen offset:736
 buffer_load_ushort v149, v153, s[16:19], s97 offen offset:992
 s_add_u32 s97, s97, 0x1000
 buffer_load_ushort v138, v153, s[16:19], s97 offen offset:192
 buffer_load_ushort v146, v153, s[16:19], s97 offen offset:448
 buffer_load_ushort v139, v153, s[16:19], s97 offen offset:704
 buffer_load_ushort v147, v153, s[16:19], s97 offen offset:960
 buffer_load_ushort v142, v153, s[16:19], s97 offen offset:224
 buffer_load_ushort v150, v153, s[16:19], s97 offen offset:480
 buffer_load_ushort v143, v153, s[16:19], s97 offen offset:736
 buffer_load_ushort v151, v153, s[16:19], s97 offen offset:992
 s_waitcnt vmcnt(0)
 v_lshl_or_b32 v136, v144, 16, v136
 v_lshl_or_b32 v137, v145, 16, v137
 v_lshl_or_b32 v138, v146, 16, v138
 v_lshl_or_b32 v139, v147, 16, v139
 v_lshl_or_b32 v140, v148, 16, v140
 v_lshl_or_b32 v141, v149, 16, v141
 v_lshl_or_b32 v142, v150, 16, v142
 v_lshl_or_b32 v143, v151, 16, v143
 v_mfma_f32_16x16x32_bf16 v[208:211], v[136:139], v[128:131], v[208:211]
 v_mfma_f32_16x16x32_bf16 v[212:215], v[136:139], v[132:135], v[212:215]
 v_mfma_f32_16x16x32_bf16 v[216:219], v[140:143], v[128:131], v[216:219]
 v_mfma_f32_16x16x32_bf16 v[220:223], v[140:143], v[132:135], v[220:223]
 s_nop 7
 s_add_u32 s99, s99, 0x2000
 s_cmp_lt_u32 s99, 0x20000
 s_cbranch_scc1 L_A_slow1_b
 s_nop 7
 s_nop 3
 v_mov_b32 v154, v158
 s_nop 1
 v_permlane16_swap_b32 v158, v154
 AD 158,158,154
 v_mov_b32 v154, v158
 s_nop 1
 v_permlane32_swap_b32 v158, v154
 AD 158,158,154
 v_mov_b32 v154, v159
 s_nop 1
 v_permlane16_swap_b32 v159, v154
 AD 159,159,154
 v_mov_b32 v154, v159
 s_nop 1
 v_permlane32_swap_b32 v159, v154
 AD 159,159,154
 v_rcp_f32 v158, v158
 v_rcp_f32 v159, v159
 ML 160,160,158
 ML 161,161,158
 ML 162,162,158
 ML 163,163,158
 ML 164,164,159
 ML 165,165,159
 ML 166,166,159
 ML 167,167,159
 ML 168,168,158
 ML 169,169,158
 ML 170,170,158
 ML 171,171,158
 ML 172,172,159
 ML 173,173,159
 ML 174,174,159
 ML 175,175,159
 ML 176,176,158
 ML 177,177,158
 ML 178,178,158
 ML 179,179,158
 ML 180,180,159
 ML 181,181,159
 ML 182,182,159
 ML 183,183,159
 ML 184,184,158
 ML 185,185,158
 ML 186,186,158
 ML 187,187,158
 ML 188,188,159
 ML 189,189,159
 ML 190,190,159
 ML 191,191,159
 ML 192,192,158
 ML 193,193,158
 ML 194,194,158
 ML 195,195,158
 ML 196,196,159
 ML 197,197,159
 ML 198,198,159
 ML 199,199,159
 ML 200,200,158
 ML 201,201,158
 ML 202,202,158
 ML 203,203,158
 ML 204,204,159
 ML 205,205,159
 ML 206,206,159
 ML 207,207,159
 ML 208,208,158
 ML 209,209,158
 ML 210,210,158
 ML 211,211,158
 ML 212,212,159
 ML 213,213,159
 ML 214,214,159
 ML 215,215,159
 ML 216,216,158
 ML 217,217,158
 ML 218,218,158
 ML 219,219,158
 ML 220,220,159
 ML 221,221,159
 ML 222,222,159
 ML 223,223,159
 CV 160,160,161
 AW 104,160
 CV 162,162,163
 AW 105,162
 CV 168,168,169
 AW 106,168
 CV 170,170,171
 AW 107,170
 CV 164,164,165
 AW 108,164
 CV 166,166,167
 AW 109,166
 CV 172,172,173
 AW 110,172
 CV 174,174,175
 AW 111,174
 CV 176,176,177
 AW 120,176
 CV 178,178,179
 AW 121,178
 CV 184,184,185
 AW 122,184
 CV 186,186,187
 AW 123,186
 CV 180,180,181
 AW 124,180
 CV 182,182,183
 AW 125,182
 CV 188,188,189
 AW 126,188
 CV 190,190,191
 AW 127,190
 CV 192,192,193
 AW 136,192
 CV 194,194,195
 AW 137,194
 CV 200,200,201
 AW 138,200
 CV 202,202,203
 AW 139,202
 CV 196,196,197
 AW 140,196
 CV 198,198,199
 AW 141,198
 CV 204,204,205
 AW 142,204
 CV 206,206,207
 AW 143,206
 CV 208,208,209
 AW 152,208
 CV 210,210,211
 AW 153,210
 CV 216,216,217
 AW 154,216
 CV 218,218,219
 AW 155,218
 CV 212,212,213
 AW 156,212
 CV 214,214,215
 AW 157,214
 CV 220,220,221
 AW 158,220
 CV 222,222,223
 AW 159,222
 s_nop 1
 s_setpc_b64 s[56:57]
.p2align 2
L_A_slow2:
 s_nop 7
 s_nop 7
 v_lshrrev_b32 v202, 4, v0
 v_and_b32 v203, 15, v202
 v_lshrrev_b32 v202, 4, v202
 v_lshlrev_b32 v200, 8, v203
 v_lshl_add_u32 v200, v202, 4, v200
 v_lshlrev_b32 v201, 1, v203
 v_lshl_add_u32 v201, v202, 10, v201
 s_mov_b32 s98, s41
 v_mov_b32 v204, 0xff800000
 v_mov_b32 v205, 0xff800000
 s_mov_b32 s99, 0
L_A_slow2_a:
 s_add_u32 s97, s98, s99
 buffer_load_dwordx4 v[184:187], v200, s[12:15], s97 offen
 buffer_load_dwordx4 v[188:191], v200, s[12:15], s97 offen offset:64
 buffer_load_dwordx4 v[192:195], v200, s[12:15], s97 offen offset:128
 buffer_load_dwordx4 v[196:199], v200, s[12:15], s97 offen offset:192
 s_waitcnt vmcnt(0)
 v_mfma_f32_16x16x32_bf16 v[160:163], v[184:187], a[64:67], 0
 v_mfma_f32_16x16x32_bf16 v[164:167], v[184:187], a[68:71], 0
 v_mfma_f32_16x16x32_bf16 v[160:163], v[188:191], a[72:75], v[160:163]
 v_mfma_f32_16x16x32_bf16 v[164:167], v[188:191], a[76:79], v[164:167]
 v_mfma_f32_16x16x32_bf16 v[160:163], v[192:195], a[80:83], v[160:163]
 v_mfma_f32_16x16x32_bf16 v[164:167], v[192:195], a[84:87], v[164:167]
 v_mfma_f32_16x16x32_bf16 v[160:163], v[196:199], a[88:91], v[160:163]
 v_mfma_f32_16x16x32_bf16 v[164:167], v[196:199], a[92:95], v[164:167]
 s_nop 7
 s_nop 3
 s_add_u32 s97, s97, 0x1000
 buffer_load_dwordx4 v[184:187], v200, s[12:15], s97 offen
 buffer_load_dwordx4 v[188:191], v200, s[12:15], s97 offen offset:64
 buffer_load_dwordx4 v[192:195], v200, s[12:15], s97 offen offset:128
 buffer_load_dwordx4 v[196:199], v200, s[12:15], s97 offen offset:192
 s_waitcnt vmcnt(0)
 v_mfma_f32_16x16x32_bf16 v[168:171], v[184:187], a[64:67], 0
 v_mfma_f32_16x16x32_bf16 v[172:175], v[184:187], a[68:71], 0
 v_mfma_f32_16x16x32_bf16 v[168:171], v[188:191], a[72:75], v[168:171]
 v_mfma_f32_16x16x32_bf16 v[172:175], v[188:191], a[76:79], v[172:175]
 v_mfma_f32_16x16x32_bf16 v[168:171], v[192:195], a[80:83], v[168:171]
 v_mfma_f32_16x16x32_bf16 v[172:175], v[192:195], a[84:87], v[172:175]
 v_mfma_f32_16x16x32_bf16 v[168:171], v[196:199], a[88:91], v[168:171]
 v_mfma_f32_16x16x32_bf16 v[172:175], v[196:199], a[92:95], v[172:175]
 s_nop 7
 s_nop 3
 v_max3_f32 v204, v204, v160, v161
 v_max3_f32 v204, v204, v162, v163
 v_max3_f32 v205, v205, v164, v165
 v_max3_f32 v205, v205, v166, v167
 v_max3_f32 v204, v204, v168, v169
 v_max3_f32 v204, v204, v170, v171
 v_max3_f32 v205, v205, v172, v173
 v_max3_f32 v205, v205, v174, v175
 s_add_u32 s99, s99, 0x2000
 s_cmp_lt_u32 s99, 0x20000
 s_cbranch_scc1 L_A_slow2_a
 v_mov_b32 v202, v204
 s_nop 1
 v_permlane16_swap_b32 v204, v202
 v_max_f32 v204, v204, v202
 v_mov_b32 v202, v204
 s_nop 1
 v_permlane32_swap_b32 v204, v202
 v_max_f32 v204, v204, v202
 v_mov_b32 v202, v205
 s_nop 1
 v_permlane16_swap_b32 v205, v202
 v_max_f32 v205, v205, v202
 v_mov_b32 v202, v205
 s_nop 1
 v_permlane32_swap_b32 v205, v202
 v_max_f32 v205, v205, v202
 v_mov_b32 v48, 0
 v_mov_b32 v49, 0
 v_mov_b32 v50, 0
 v_mov_b32 v51, 0
 v_mov_b32 v52, 0
 v_mov_b32 v53, 0
 v_mov_b32 v54, 0
 v_mov_b32 v55, 0
 v_mov_b32 v56, 0
 v_mov_b32 v57, 0
 v_mov_b32 v58, 0
 v_mov_b32 v59, 0
 v_mov_b32 v60, 0
 v_mov_b32 v61, 0
 v_mov_b32 v62, 0
 v_mov_b32 v63, 0
 v_mov_b32 v64, 0
 v_mov_b32 v65, 0
 v_mov_b32 v66, 0
 v_mov_b32 v67, 0
 v_mov_b32 v68, 0
 v_mov_b32 v69, 0
 v_mov_b32 v70, 0
 v_mov_b32 v71, 0
 v_mov_b32 v72, 0
 v_mov_b32 v73, 0
 v_mov_b32 v74, 0
 v_mov_b32 v75, 0
 v_mov_b32 v76, 0
 v_mov_b32 v77, 0
 v_mov_b32 v78, 0
 v_mov_b32 v79, 0
 v_mov_b32 v80, 0
 v_mov_b32 v81, 0
 v_mov_b32 v82, 0
 v_mov_b32 v83, 0
 v_mov_b32 v84, 0
 v_mov_b32 v85, 0
 v_mov_b32 v86, 0
 v_mov_b32 v87, 0
 v_mov_b32 v88, 0
 v_mov_b32 v89, 0
 v_mov_b32 v90, 0
 v_mov_b32 v91, 0
 v_mov_b32 v92, 0
 v_mov_b32 v93, 0
 v_mov_b32 v94, 0
 v_mov_b32 v95, 0
 v_mov_b32 v96, 0
 v_mov_b32 v97, 0
 v_mov_b32 v98, 0
 v_mov_b32 v99, 0
 v_mov_b32 v100, 0
 v_mov_b32 v101, 0
 v_mov_b32 v102, 0
 v_mov_b32 v103, 0
 v_mov_b32 v104, 0
 v_mov_b32 v105, 0
 v_mov_b32 v106, 0
 v_mov_b32 v107, 0
 v_mov_b32 v108, 0
 v_mov_b32 v109, 0
 v_mov_b32 v110, 0
 v_mov_b32 v111, 0
 v_mov_b32 v206, 0
 v_mov_b32 v207, 0
 s_mov_b32 s99, 0
L_A_slow2_b:
 s_add_u32 s97, s98, s99
 buffer_load_dwordx4 v[184:187], v200, s[12:15], s97 offen
 buffer_load_dwordx4 v[188:191], v200, s[12:15], s97 offen offset:64
 buffer_load_dwordx4 v[192:195], v200, s[12:15], s97 offen offset:128
 buffer_load_dwordx4 v[196:199], v200, s[12:15], s97 offen offset:192
 s_waitcnt vmcnt(0)
 v_mfma_f32_16x16x32_bf16 v[160:163], v[184:187], a[64:67], 0
 v_mfma_f32_16x16x32_bf16 v[164:167], v[184:187], a[68:71], 0
 v_mfma_f32_16x16x32_bf16 v[160:163], v[188:191], a[72:75], v[160:163]
 v_mfma_f32_16x16x32_bf16 v[164:167], v[188:191], a[76:79], v[164:167]
 v_mfma_f32_16x16x32_bf16 v[160:163], v[192:195], a[80:83], v[160:163]
 v_mfma_f32_16x16x32_bf16 v[164:167], v[192:195], a[84:87], v[164:167]
 v_mfma_f32_16x16x32_bf16 v[160:163], v[196:199], a[88:91], v[160:163]
 v_mfma_f32_16x16x32_bf16 v[164:167], v[196:199], a[92:95], v[164:167]
 s_nop 7
 s_nop 3
 s_add_u32 s97, s97, 0x1000
 buffer_load_dwordx4 v[184:187], v200, s[12:15], s97 offen
 buffer_load_dwordx4 v[188:191], v200, s[12:15], s97 offen offset:64
 buffer_load_dwordx4 v[192:195], v200, s[12:15], s97 offen offset:128
 buffer_load_dwordx4 v[196:199], v200, s[12:15], s97 offen offset:192
 s_waitcnt vmcnt(0)
 v_mfma_f32_16x16x32_bf16 v[168:171], v[184:187], a[64:67], 0
 v_mfma_f32_16x16x32_bf16 v[172:175], v[184:187], a[68:71], 0
 v_mfma_f32_16x16x32_bf16 v[168:171], v[188:191], a[72:75], v[168:171]
 v_mfma_f32_16x16x32_bf16 v[172:175], v[188:191], a[76:79], v[172:175]
 v_mfma_f32_16x16x32_bf16 v[168:171], v[192:195], a[80:83], v[168:171]
 v_mfma_f32_16x16x32_bf16 v[172:175], v[192:195], a[84:87], v[172:175]
 v_mfma_f32_16x16x32_bf16 v[168:171], v[196:199], a[88:91], v[168:171]
 v_mfma_f32_16x16x32_bf16 v[172:175], v[196:199], a[92:95], v[172:175]
 s_nop 7
 s_nop 3
 v_sub_f32 v160, v160, v204
 v_sub_f32 v161, v161, v204
 v_sub_f32 v162, v162, v204
 v_sub_f32 v163, v163, v204
 v_sub_f32 v164, v164, v205
 v_sub_f32 v165, v165, v205
 v_sub_f32 v166, v166, v205
 v_sub_f32 v167, v167, v205
 v_sub_f32 v168, v168, v204
 v_sub_f32 v169, v169, v204
 v_sub_f32 v170, v170, v204
 v_sub_f32 v171, v171, v204
 v_sub_f32 v172, v172, v205
 v_sub_f32 v173, v173, v205
 v_sub_f32 v174, v174, v205
 v_sub_f32 v175, v175, v205
 EX 160,160
 EX 161,161
 EX 162,162
 EX 163,163
 EX 164,164
 EX 165,165
 EX 166,166
 EX 167,167
 EX 168,168
 EX 169,169
 EX 170,170
 EX 171,171
 EX 172,172
 EX 173,173
 EX 174,174
 EX 175,175
 AD 206,206,160
 AD 206,206,161
 AD 206,206,162
 AD 206,206,163
 AD 207,207,164
 AD 207,207,165
 AD 207,207,166
 AD 207,207,167
 AD 206,206,168
 AD 206,206,169
 AD 206,206,170
 AD 206,206,171
 AD 207,207,172
 AD 207,207,173
 AD 207,207,174
 AD 207,207,175
 CV 176,160,161
 CV 177,162,163
 CV 178,168,169
 CV 179,170,171
 CV 180,164,165
 CV 181,166,167
 CV 182,172,173
 CV 183,174,175
 s_add_u32 s97, s98, s99
 buffer_load_ushort v184, v201, s[16:19], s97 offen
 buffer_load_ushort v192, v201, s[16:19], s97 offen offset:256
 buffer_load_ushort v185, v201, s[16:19], s97 offen offset:512
 buffer_load_ushort v193, v201, s[16:19], s97 offen offset:768
 buffer_load_ushort v188, v201, s[16:19], s97 offen offset:32
 buffer_load_ushort v196, v201, s[16:19], s97 offen offset:288
 buffer_load_ushort v189, v201, s[16:19], s97 offen offset:544
 buffer_load_ushort v197, v201, s[16:19], s97 offen offset:800
 s_add_u32 s97, s97, 0x1000
 buffer_load_ushort v186, v201, s[16:19], s97 offen
 buffer_load_ushort v194, v201, s[16:19], s97 offen offset:256
 buffer_load_ushort v187, v201, s[16:19], s97 offen offset:512
 buffer_load_ushort v195, v201, s[16:19], s97 offen offset:768
 buffer_load_ushort v190, v201, s[16:19], s97 offen offset:32
 buffer_load_ushort v198, v201, s[16:19], s97 offen offset:288
 buffer_load_ushort v191, v201, s[16:19], s97 offen offset:544
 buffer_load_ushort v199, v201, s[16:19], s97 offen offset:800
 s_waitcnt vmcnt(0)
 v_lshl_or_b32 v184, v192, 16, v184
 v_lshl_or_b32 v185, v193, 16, v185
 v_lshl_or_b32 v186, v194, 16, v186
 v_lshl_or_b32 v187, v195, 16, v187
 v_lshl_or_b32 v188, v196, 16, v188
 v_lshl_or_b32 v189, v197, 16, v189
 v_lshl_or_b32 v190, v198, 16, v190
 v_lshl_or_b32 v191, v199, 16, v191
 v_mfma_f32_16x16x32_bf16 v[48:51], v[184:187], v[176:179], v[48:51]
 v_mfma_f32_16x16x32_bf16 v[52:55], v[184:187], v[180:183], v[52:55]
 v_mfma_f32_16x16x32_bf16 v[56:59], v[188:191], v[176:179], v[56:59]
 v_mfma_f32_16x16x32_bf16 v[60:63], v[188:191], v[180:183], v[60:63]
 s_nop 7
 s_add_u32 s97, s98, s99
 buffer_load_ushort v184, v201, s[16:19], s97 offen offset:64
 buffer_load_ushort v192, v201, s[16:19], s97 offen offset:320
 buffer_load_ushort v185, v201, s[16:19], s97 offen offset:576
 buffer_load_ushort v193, v201, s[16:19], s97 offen offset:832
 buffer_load_ushort v188, v201, s[16:19], s97 offen offset:96
 buffer_load_ushort v196, v201, s[16:19], s97 offen offset:352
 buffer_load_ushort v189, v201, s[16:19], s97 offen offset:608
 buffer_load_ushort v197, v201, s[16:19], s97 offen offset:864
 s_add_u32 s97, s97, 0x1000
 buffer_load_ushort v186, v201, s[16:19], s97 offen offset:64
 buffer_load_ushort v194, v201, s[16:19], s97 offen offset:320
 buffer_load_ushort v187, v201, s[16:19], s97 offen offset:576
 buffer_load_ushort v195, v201, s[16:19], s97 offen offset:832
 buffer_load_ushort v190, v201, s[16:19], s97 offen offset:96
 buffer_load_ushort v198, v201, s[16:19], s97 offen offset:352
 buffer_load_ushort v191, v201, s[16:19], s97 offen offset:608
 buffer_load_ushort v199, v201, s[16:19], s97 offen offset:864
 s_waitcnt vmcnt(0)
 v_lshl_or_b32 v184, v192, 16, v184
 v_lshl_or_b32 v185, v193, 16, v185
 v_lshl_or_b32 v186, v194, 16, v186
 v_lshl_or_b32 v187, v195, 16, v187
 v_lshl_or_b32 v188, v196, 16, v188
 v_lshl_or_b32 v189, v197, 16, v189
 v_lshl_or_b32 v190, v198, 16, v190
 v_lshl_or_b32 v191, v199, 16, v191
 v_mfma_f32_16x16x32_bf16 v[64:67], v[184:187], v[176:179], v[64:67]
 v_mfma_f32_16x16x32_bf16 v[68:71], v[184:187], v[180:183], v[68:71]
 v_mfma_f32_16x16x32_bf16 v[72:75], v[188:191], v[176:179], v[72:75]
 v_mfma_f32_16x16x32_bf16 v[76:79], v[188:191], v[180:183], v[76:79]
 s_nop 7
 s_add_u32 s97, s98, s99
 buffer_load_ushort v184, v201, s[16:19], s97 offen offset:128
 buffer_load_ushort v192, v201, s[16:19], s97 offen offset:384
 buffer_load_ushort v185, v201, s[16:19], s97 offen offset:640
 buffer_load_ushort v193, v201, s[16:19], s97 offen offset:896
 buffer_load_ushort v188, v201, s[16:19], s97 offen offset:160
 buffer_load_ushort v196, v201, s[16:19], s97 offen offset:416
 buffer_load_ushort v189, v201, s[16:19], s97 offen offset:672
 buffer_load_ushort v197, v201, s[16:19], s97 offen offset:928
 s_add_u32 s97, s97, 0x1000
 buffer_load_ushort v186, v201, s[16:19], s97 offen offset:128
 buffer_load_ushort v194, v201, s[16:19], s97 offen offset:384
 buffer_load_ushort v187, v201, s[16:19], s97 offen offset:640
 buffer_load_ushort v195, v201, s[16:19], s97 offen offset:896
 buffer_load_ushort v190, v201, s[16:19], s97 offen offset:160
 buffer_load_ushort v198, v201, s[16:19], s97 offen offset:416
 buffer_load_ushort v191, v201, s[16:19], s97 offen offset:672
 buffer_load_ushort v199, v201, s[16:19], s97 offen offset:928
 s_waitcnt vmcnt(0)
 v_lshl_or_b32 v184, v192, 16, v184
 v_lshl_or_b32 v185, v193, 16, v185
 v_lshl_or_b32 v186, v194, 16, v186
 v_lshl_or_b32 v187, v195, 16, v187
 v_lshl_or_b32 v188, v196, 16, v188
 v_lshl_or_b32 v189, v197, 16, v189
 v_lshl_or_b32 v190, v198, 16, v190
 v_lshl_or_b32 v191, v199, 16, v191
 v_mfma_f32_16x16x32_bf16 v[80:83], v[184:187], v[176:179], v[80:83]
 v_mfma_f32_16x16x32_bf16 v[84:87], v[184:187], v[180:183], v[84:87]
 v_mfma_f32_16x16x32_bf16 v[88:91], v[188:191], v[176:179], v[88:91]
 v_mfma_f32_16x16x32_bf16 v[92:95], v[188:191], v[180:183], v[92:95]
 s_nop 7
 s_add_u32 s97, s98, s99
 buffer_load_ushort v184, v201, s[16:19], s97 offen offset:192
 buffer_load_ushort v192, v201, s[16:19], s97 offen offset:448
 buffer_load_ushort v185, v201, s[16:19], s97 offen offset:704
 buffer_load_ushort v193, v201, s[16:19], s97 offen offset:960
 buffer_load_ushort v188, v201, s[16:19], s97 offen offset:224
 buffer_load_ushort v196, v201, s[16:19], s97 offen offset:480
 buffer_load_ushort v189, v201, s[16:19], s97 offen offset:736
 buffer_load_ushort v197, v201, s[16:19], s97 offen offset:992
 s_add_u32 s97, s97, 0x1000
 buffer_load_ushort v186, v201, s[16:19], s97 offen offset:192
 buffer_load_ushort v194, v201, s[16:19], s97 offen offset:448
 buffer_load_ushort v187, v201, s[16:19], s97 offen offset:704
 buffer_load_ushort v195, v201, s[16:19], s97 offen offset:960
 buffer_load_ushort v190, v201, s[16:19], s97 offen offset:224
 buffer_load_ushort v198, v201, s[16:19], s97 offen offset:480
 buffer_load_ushort v191, v201, s[16:19], s97 offen offset:736
 buffer_load_ushort v199, v201, s[16:19], s97 offen offset:992
 s_waitcnt vmcnt(0)
 v_lshl_or_b32 v184, v192, 16, v184
 v_lshl_or_b32 v185, v193, 16, v185
 v_lshl_or_b32 v186, v194, 16, v186
 v_lshl_or_b32 v187, v195, 16, v187
 v_lshl_or_b32 v188, v196, 16, v188
 v_lshl_or_b32 v189, v197, 16, v189
 v_lshl_or_b32 v190, v198, 16, v190
 v_lshl_or_b32 v191, v199, 16, v191
 v_mfma_f32_16x16x32_bf16 v[96:99], v[184:187], v[176:179], v[96:99]
 v_mfma_f32_16x16x32_bf16 v[100:103], v[184:187], v[180:183], v[100:103]
 v_mfma_f32_16x16x32_bf16 v[104:107], v[188:191], v[176:179], v[104:107]
 v_mfma_f32_16x16x32_bf16 v[108:111], v[188:191], v[180:183], v[108:111]
 s_nop 7
 s_add_u32 s99, s99, 0x2000
 s_cmp_lt_u32 s99, 0x20000
 s_cbranch_scc1 L_A_slow2_b
 s_nop 7
 s_nop 3
 v_mov_b32 v202, v206
 s_nop 1
 v_permlane16_swap_b32 v206, v202
 AD 206,206,202
 v_mov_b32 v202, v206
 s_nop 1
 v_permlane32_swap_b32 v206, v202
 AD 206,206,202
 v_mov_b32 v202, v207
 s_nop 1
 v_permlane16_swap_b32 v207, v202
 AD 207,207,202
 v_mov_b32 v202, v207
 s_nop 1
 v_permlane32_swap_b32 v207, v202
 AD 207,207,202
 v_rcp_f32 v206, v206
 v_rcp_f32 v207, v207
 ML 48,48,206
 ML 49,49,206
 ML 50,50,206
 ML 51,51,206
 ML 52,52,207
 ML 53,53,207
 ML 54,54,207
 ML 55,55,207
 ML 56,56,206
 ML 57,57,206
 ML 58,58,206
 ML 59,59,206
 ML 60,60,207
 ML 61,61,207
 ML 62,62,207
 ML 63,63,207
 ML 64,64,206
 ML 65,65,206
 ML 66,66,206
 ML 67,67,206
 ML 68,68,207
 ML 69,69,207
 ML 70,70,207
 ML 71,71,207
 ML 72,72,206
 ML 73,73,206
 ML 74,74,206
 ML 75,75,206
 ML 76,76,207
 ML 77,77,207
 ML 78,78,207
 ML 79,79,207
 ML 80,80,206
 ML 81,81,206
 ML 82,82,206
 ML 83,83,206
 ML 84,84,207
 ML 85,85,207
 ML 86,86,207
 ML 87,87,207
 ML 88,88,206
 ML 89,89,206
 ML 90,90,206
 ML 91,91,206
 ML 92,92,207
 ML 93,93,207
 ML 94,94,207
 ML 95,95,207
 ML 96,96,206
 ML 97,97,206
 ML 98,98,206
 ML 99,99,206
 ML 100,100,207
 ML 101,101,207
 ML 102,102,207
 ML 103,103,207
 ML 104,104,206
 ML 105,105,206
 ML 106,106,206
 ML 107,107,206
 ML 108,108,207
 ML 109,109,207
 ML 110,110,207
 ML 111,111,207
 CV 48,48,49
 AW 160,48
 CV 50,50,51
 AW 161,50
 CV 56,56,57
 AW 162,56
 CV 58,58,59
 AW 163,58
 CV 52,52,53
 AW 164,52
 CV 54,54,55
 AW 165,54
 CV 60,60,61
 AW 166,60
 CV 62,62,63
 AW 167,62
 CV 64,64,65
 AW 168,64
 CV 66,66,67
 AW 169,66
 CV 72,72,73
 AW 170,72
 CV 74,74,75
 AW 171,74
 CV 68,68,69
 AW 172,68
 CV 70,70,71
 AW 173,70
 CV 76,76,77
 AW 174,76
 CV 78,78,79
 AW 175,78
 CV 80,80,81
 AW 176,80
 CV 82,82,83
 AW 177,82
 CV 88,88,89
 AW 178,88
 CV 90,90,91
 AW 179,90
 CV 84,84,85
 AW 180,84
 CV 86,86,87
 AW 181,86
 CV 92,92,93
 AW 182,92
 CV 94,94,95
 AW 183,94
 CV 96,96,97
 AW 184,96
 CV 98,98,99
 AW 185,98
 CV 104,104,105
 AW 186,104
 CV 106,106,107
 AW 187,106
 CV 100,100,101
 AW 188,100
 CV 102,102,103
 AW 189,102
 CV 108,108,109
 AW 190,108
 CV 110,110,111
 AW 191,110
 s_nop 1
 s_setpc_b64 s[56:57]
L_A_red:
 v_mov_b32 v23, 0x26400
 ds_read_b32 v24, v23
 WL 0
 v_readfirstlane_b32 s92, v24
 s_nop 1
 s_and_b32 s78, s92, 0xff
 s_bfe_u32 s79, s92, 0x80008
 s_lshr_b32 s58, s92, 16
 v_lshrrev_b32 v19, 4, v0
 v_and_b32 v20, 7, v19
 v_lshlrev_b32 v25, 4, v20
 s_mov_b32 s92, 0x480
 v_mul_u32_u24 v20, s92, v20
 v_lshrrev_b32 v18, 3, v19
 v_lshl_add_u32 v28, v18, 4, v20
 v_bfe_u32 v18, v19, 3, 2
 v_lshl_add_u32 v20, v18, 3, v20
 v_lshl_add_u32 v25, v18, 8, v25
 v_lshrrev_b32 v18, 5, v19
 v_lshl_add_u32 v20, v18, 6, v20
 v_lshl_add_u32 v25, v18, 11, v25
 s_mul_i32 s59, s62, 0x2400
 s_lshr_b32 s3, s62, 1
 s_lshl_b32 s3, s3, 10
 s_and_b32 s92, s62, 1
 s_lshl_b32 s92, s92, 7
 s_add_u32 s3, s3, s92
 s_mov_b32 s68, 0x3f80
 s_mov_b32 s69, 0x3f800000
 s_mov_b64 s[74:75], 0
 s_mov_b32 s42, s63
 s_add_u32 s44, s63, 10
 s_mov_b32 s98, 0x10795684
 s_mov_b32 s99, 50
 s_lshl_b32 s92, s63, 2
 s_lshr_b64 s[98:99], s[98:99], s92
 s_and_b32 s44, s98, 15
 s_cmp_eq_u32 s44, 15
 s_cselect_b32 s44, 53, s44
 s_add_u32 s44, s44, 10
 s_mov_b32 s98, 0xcb3a9287
 s_mov_b32 s99, 0xed
 s_lshl_b32 s92, s63, 2
 s_lshr_b64 s[98:99], s[98:99], s92
 s_and_b32 s45, s98, 15
 s_cmp_eq_u32 s45, 15
 s_cselect_b32 s45, 42, s45
 s_add_u32 s45, s45, 21
 s_mov_b32 s98, 0x21ffffff
 s_mov_b32 s99, 0xff
 s_lshl_b32 s92, s63, 2
 s_lshr_b64 s[98:99], s[98:99], s92
 s_and_b32 s83, s98, 15
 s_cmp_eq_u32 s83, 15
 s_cselect_b32 s83, 43, s83
 s_add_u32 s83, s83, 20
 s_bitset1_b64 s[74:75], s83
 s_bitset1_b64 s[74:75], s42
 s_bitset1_b64 s[74:75], s44
 s_bitset1_b64 s[74:75], s45
 s_and_b32 s75, s75, 15
 s_and_b32 s92, s45, 3
 s_lshr_b32 s80, s45, 2
 s_lshl_b32 s93, s64, 2
 s_add_u32 s92, s92, s93
 s_mul_i32 s47, s92, 0x9000
 s_add_u32 s61, s47, s59
 s_lshl_b32 s93, s80, 12
 s_add_u32 s93, s93, s3
 s_add_u32 s47, s47, s93
 s_lshl_b32 s93, s80, 7
 s_add_u32 s61, s61, s93
 s_mov_b32 s70, s47
 s_and_b32 s92, s44, 3
 s_lshr_b32 s80, s44, 2
 s_lshl_b32 s93, s64, 2
 s_add_u32 s92, s92, s93
 s_mul_i32 s47, s92, 0x9000
 s_add_u32 s60, s47, s59
 s_lshl_b32 s93, s80, 12
 s_add_u32 s93, s93, s3
 s_add_u32 s47, s47, s93
 s_lshl_b32 s93, s80, 7
 s_add_u32 s60, s60, s93
 s_mov_b32 s65, s47
 s_and_b32 s92, s42, 3
 s_lshr_b32 s80, s42, 2
 s_lshl_b32 s93, s64, 2
 s_add_u32 s92, s92, s93
 s_mul_i32 s47, s92, 0x9000
 s_add_u32 s46, s47, s59
 s_lshl_b32 s93, s80, 12
 s_add_u32 s93, s93, s3
 s_add_u32 s47, s47, s93
 s_lshl_b32 s93, s80, 7
 s_add_u32 s46, s46, s93
 s_min_u32 s92, s78, s79
 s_cmp_lt_u32 s44, s92
 s_cbranch_scc0 L_A_sl
 s_mov_b32 s93, 0xffff0000
 buffer_load_dwordx2 v[140:141], v20, s[8:11], s46 offen
 buffer_load_dwordx2 v[142:143], v20, s[8:11], s46 offen offset:32
 s_add_u32 s92, s47, 0
 buffer_load_dwordx4 v[72:75], v25, s[36:39], s92 offen sc1
 s_add_u32 s92, s47, 0x240000
 buffer_load_dwordx4 v[76:79], v25, s[36:39], s92 offen sc1
 s_add_u32 s92, s47, 0x480000
 buffer_load_dwordx4 v[80:83], v25, s[36:39], s92 offen sc1
 s_add_u32 s92, s47, 0x6c0000
 buffer_load_dwordx4 v[84:87], v25, s[36:39], s92 offen sc1
 s_add_u32 s92, s47, 0x900000
 buffer_load_dwordx4 v[88:91], v25, s[36:39], s92 offen sc1
 s_add_u32 s92, s47, 0xb40000
 buffer_load_dwordx4 v[92:95], v25, s[36:39], s92 offen sc1
 s_add_u32 s92, s47, 0xd80000
 buffer_load_dwordx4 v[96:99], v25, s[36:39], s92 offen sc1
 s_add_u32 s92, s47, 0xfc0000
 buffer_load_dwordx4 v[100:103], v25, s[36:39], s92 offen sc1
 s_waitcnt vmcnt(7)
 v_lshlrev_b32 v48, 16, v72
 v_and_b32 v49, s93, v72
 v_lshlrev_b32 v50, 16, v73
 v_and_b32 v51, s93, v73
 v_lshlrev_b32 v52, 16, v74
 v_and_b32 v53, s93, v74
 v_lshlrev_b32 v54, 16, v75
 v_and_b32 v55, s93, v75
 s_add_u32 s92, s47, 0x1200000
 buffer_load_dwordx4 v[104:107], v25, s[36:39], s92 offen sc1
 s_waitcnt vmcnt(11)
 s_barrier
 v_mov_b32 v36, 9
 buffer_store_dword v36, v42, s[36:39], 0 offen sc1
 s_mov_b32 s93, 0xffff0000
 s_waitcnt vmcnt(8)
 v_dot2c_f32_bf16 v48, s68, v76
 v_dot2c_f32_bf16 v49, s69, v76
 v_dot2c_f32_bf16 v50, s68, v77
 v_dot2c_f32_bf16 v51, s69, v77
 v_dot2c_f32_bf16 v52, s68, v78
 v_dot2c_f32_bf16 v53, s69, v78
 v_dot2c_f32_bf16 v54, s68, v79
 v_dot2c_f32_bf16 v55, s69, v79
 s_add_u32 s92, s47, 0x1440000
 buffer_load_dwordx4 v[108:111], v25, s[36:39], s92 offen sc1
 s_waitcnt vmcnt(8)
 v_dot2c_f32_bf16 v48, s68, v80
 v_dot2c_f32_bf16 v49, s69, v80
 v_dot2c_f32_bf16 v50, s68, v81
 v_dot2c_f32_bf16 v51, s69, v81
 v_dot2c_f32_bf16 v52, s68, v82
 v_dot2c_f32_bf16 v53, s69, v82
 v_dot2c_f32_bf16 v54, s68, v83
 v_dot2c_f32_bf16 v55, s69, v83
 s_add_u32 s92, s47, 0x1680000
 buffer_load_dwordx4 v[112:115], v25, s[36:39], s92 offen sc1
 s_waitcnt vmcnt(8)
 v_dot2c_f32_bf16 v48, s68, v84
 v_dot2c_f32_bf16 v49, s69, v84
 v_dot2c_f32_bf16 v50, s68, v85
 v_dot2c_f32_bf16 v51, s69, v85
 v_dot2c_f32_bf16 v52, s68, v86
 v_dot2c_f32_bf16 v53, s69, v86
 v_dot2c_f32_bf16 v54, s68, v87
 v_dot2c_f32_bf16 v55, s69, v87
 s_add_u32 s92, s47, 0x18c0000
 buffer_load_dwordx4 v[116:119], v25, s[36:39], s92 offen sc1
 s_waitcnt vmcnt(8)
 v_dot2c_f32_bf16 v48, s68, v88
 v_dot2c_f32_bf16 v49, s69, v88
 v_dot2c_f32_bf16 v50, s68, v89
 v_dot2c_f32_bf16 v51, s69, v89
 v_dot2c_f32_bf16 v52, s68, v90
 v_dot2c_f32_bf16 v53, s69, v90
 v_dot2c_f32_bf16 v54, s68, v91
 v_dot2c_f32_bf16 v55, s69, v91
 s_add_u32 s92, s47, 0x1b00000
 buffer_load_dwordx4 v[120:123], v25, s[36:39], s92 offen sc1
 s_waitcnt vmcnt(8)
 v_dot2c_f32_bf16 v48, s68, v92
 v_dot2c_f32_bf16 v49, s69, v92
 v_dot2c_f32_bf16 v50, s68, v93
 v_dot2c_f32_bf16 v51, s69, v93
 v_dot2c_f32_bf16 v52, s68, v94
 v_dot2c_f32_bf16 v53, s69, v94
 v_dot2c_f32_bf16 v54, s68, v95
 v_dot2c_f32_bf16 v55, s69, v95
 s_add_u32 s92, s47, 0x1d40000
 buffer_load_dwordx4 v[124:127], v25, s[36:39], s92 offen sc1
 s_waitcnt vmcnt(8)
 v_dot2c_f32_bf16 v48, s68, v96
 v_dot2c_f32_bf16 v49, s69, v96
 v_dot2c_f32_bf16 v50, s68, v97
 v_dot2c_f32_bf16 v51, s69, v97
 v_dot2c_f32_bf16 v52, s68, v98
 v_dot2c_f32_bf16 v53, s69, v98
 v_dot2c_f32_bf16 v54, s68, v99
 v_dot2c_f32_bf16 v55, s69, v99
 s_add_u32 s92, s47, 0x1f80000
 buffer_load_dwordx4 v[128:131], v25, s[36:39], s92 offen sc1
 s_waitcnt vmcnt(8)
 v_dot2c_f32_bf16 v48, s68, v100
 v_dot2c_f32_bf16 v49, s69, v100
 v_dot2c_f32_bf16 v50, s68, v101
 v_dot2c_f32_bf16 v51, s69, v101
 v_dot2c_f32_bf16 v52, s68, v102
 v_dot2c_f32_bf16 v53, s69, v102
 v_dot2c_f32_bf16 v54, s68, v103
 v_dot2c_f32_bf16 v55, s69, v103
 s_add_u32 s92, s47, 0x21c0000
 buffer_load_dwordx4 v[132:135], v25, s[36:39], s92 offen sc1
 s_waitcnt vmcnt(8)
 v_dot2c_f32_bf16 v48, s68, v104
 v_dot2c_f32_bf16 v49, s69, v104
 v_dot2c_f32_bf16 v50, s68, v105
 v_dot2c_f32_bf16 v51, s69, v105
 v_dot2c_f32_bf16 v52, s68, v106
 v_dot2c_f32_bf16 v53, s69, v106
 v_dot2c_f32_bf16 v54, s68, v107
 v_dot2c_f32_bf16 v55, s69, v107
 s_add_u32 s92, s47, 0x2400000
 buffer_load_dwordx4 v[136:139], v25, s[36:39], s92 offen sc1
 s_waitcnt vmcnt(7)
 v_dot2c_f32_bf16 v48, s68, v108
 v_dot2c_f32_bf16 v49, s69, v108
 v_dot2c_f32_bf16 v50, s68, v109
 v_dot2c_f32_bf16 v51, s69, v109
 v_dot2c_f32_bf16 v52, s68, v110
 v_dot2c_f32_bf16 v53, s69, v110
 v_dot2c_f32_bf16 v54, s68, v111
 v_dot2c_f32_bf16 v55, s69, v111
 buffer_load_dwordx2 v[212:213], v20, s[8:11], s60 offen
 s_waitcnt vmcnt(7)
 v_dot2c_f32_bf16 v48, s68, v112
 v_dot2c_f32_bf16 v49, s69, v112
 v_dot2c_f32_bf16 v50, s68, v113
 v_dot2c_f32_bf16 v51, s69, v113
 v_dot2c_f32_bf16 v52, s68, v114
 v_dot2c_f32_bf16 v53, s69, v114
 v_dot2c_f32_bf16 v54, s68, v115
 v_dot2c_f32_bf16 v55, s69, v115
 buffer_load_dwordx2 v[214:215], v20, s[8:11], s60 offen offset:32
 s_waitcnt vmcnt(7)
 v_lshlrev_b32 v56, 16, v116
 v_and_b32 v57, s93, v116
 v_lshlrev_b32 v58, 16, v117
 v_and_b32 v59, s93, v117
 v_lshlrev_b32 v60, 16, v118
 v_and_b32 v61, s93, v118
 v_lshlrev_b32 v62, 16, v119
 v_and_b32 v63, s93, v119
 s_add_u32 s92, s65, 0
 buffer_load_dwordx4 v[144:147], v25, s[36:39], s92 offen sc1
 buffer_load_dword v31, v21, s[36:39], s77 offen sc1
 s_mov_b32 s93, 0xffff0000
 s_waitcnt vmcnt(8)
 v_dot2c_f32_bf16 v56, s68, v120
 v_dot2c_f32_bf16 v57, s69, v120
 v_dot2c_f32_bf16 v58, s68, v121
 v_dot2c_f32_bf16 v59, s69, v121
 v_dot2c_f32_bf16 v60, s68, v122
 v_dot2c_f32_bf16 v61, s69, v122
 v_dot2c_f32_bf16 v62, s68, v123
 v_dot2c_f32_bf16 v63, s69, v123
 s_add_u32 s92, s65, 0x240000
 buffer_load_dwordx4 v[148:151], v25, s[36:39], s92 offen sc1
 s_waitcnt vmcnt(8)
 v_dot2c_f32_bf16 v56, s68, v124
 v_dot2c_f32_bf16 v57, s69, v124
 v_dot2c_f32_bf16 v58, s68, v125
 v_dot2c_f32_bf16 v59, s69, v125
 v_dot2c_f32_bf16 v60, s68, v126
 v_dot2c_f32_bf16 v61, s69, v126
 v_dot2c_f32_bf16 v62, s68, v127
 v_dot2c_f32_bf16 v63, s69, v127
 s_add_u32 s92, s65, 0x480000
 buffer_load_dwordx4 v[152:155], v25, s[36:39], s92 offen sc1
 s_waitcnt vmcnt(8)
 v_dot2c_f32_bf16 v56, s68, v128
 v_dot2c_f32_bf16 v57, s69, v128
 v_dot2c_f32_bf16 v58, s68, v129
 v_dot2c_f32_bf16 v59, s69, v129
 v_dot2c_f32_bf16 v60, s68, v130
 v_dot2c_f32_bf16 v61, s69, v130
 v_dot2c_f32_bf16 v62, s68, v131
 v_dot2c_f32_bf16 v63, s69, v131
 s_add_u32 s92, s65, 0x6c0000
 buffer_load_dwordx4 v[156:159], v25, s[36:39], s92 offen sc1
 s_waitcnt vmcnt(8)
 v_dot2c_f32_bf16 v56, s68, v132
 v_dot2c_f32_bf16 v57, s69, v132
 v_dot2c_f32_bf16 v58, s68, v133
 v_dot2c_f32_bf16 v59, s69, v133
 v_dot2c_f32_bf16 v60, s68, v134
 v_dot2c_f32_bf16 v61, s69, v134
 v_dot2c_f32_bf16 v62, s68, v135
 v_dot2c_f32_bf16 v63, s69, v135
 s_add_u32 s92, s65, 0x900000
 buffer_load_dwordx4 v[160:163], v25, s[36:39], s92 offen sc1
 s_waitcnt vmcnt(8)
 v_dot2c_f32_bf16 v56, s68, v136
 v_dot2c_f32_bf16 v57, s69, v136
 v_dot2c_f32_bf16 v58, s68, v137
 v_dot2c_f32_bf16 v59, s69, v137
 v_dot2c_f32_bf16 v60, s68, v138
 v_dot2c_f32_bf16 v61, s69, v138
 v_dot2c_f32_bf16 v62, s68, v139
 v_dot2c_f32_bf16 v63, s69, v139
 EX 64,56
 EX 65,57
 EX 66,58
 EX 67,59
 EX 68,60
 EX 69,61
 EX 70,62
 EX 71,63
 v_add_f32 v64, 1.0, v64
 v_add_f32 v65, 1.0, v65
 v_add_f32 v66, 1.0, v66
 v_add_f32 v67, 1.0, v67
 v_add_f32 v68, 1.0, v68
 v_add_f32 v69, 1.0, v69
 v_add_f32 v70, 1.0, v70
 v_add_f32 v71, 1.0, v71
 v_rcp_f32 v64, v64
 v_rcp_f32 v65, v65
 v_rcp_f32 v66, v66
 v_rcp_f32 v67, v67
 v_rcp_f32 v68, v68
 v_rcp_f32 v69, v69
 v_rcp_f32 v70, v70
 v_rcp_f32 v71, v71
 v_mul_f32 v56, 0xbf317218, v56
 v_mul_f32 v57, 0xbf317218, v57
 v_mul_f32 v58, 0xbf317218, v58
 v_mul_f32 v59, 0xbf317218, v59
 v_mul_f32 v60, 0xbf317218, v60
 v_mul_f32 v61, 0xbf317218, v61
 v_mul_f32 v62, 0xbf317218, v62
 v_mul_f32 v63, 0xbf317218, v63
 ML 56,56,64
 ML 57,57,65
 ML 58,58,66
 ML 59,59,67
 ML 60,60,68
 ML 61,61,69
 ML 62,62,70
 ML 63,63,71
 v_lshlrev_b32 v64, 16, v140
 v_and_b32 v65, s93, v140
 v_lshlrev_b32 v66, 16, v141
 v_and_b32 v67, s93, v141
 v_lshlrev_b32 v68, 16, v142
 v_and_b32 v69, s93, v142
 v_lshlrev_b32 v70, 16, v143
 v_and_b32 v71, s93, v143
 v_fma_f32 v64, v48, v56, v64
 v_fma_f32 v65, v49, v57, v65
 v_fma_f32 v66, v50, v58, v66
 v_fma_f32 v67, v51, v59, v67
 v_fma_f32 v68, v52, v60, v68
 v_fma_f32 v69, v53, v61, v69
 v_fma_f32 v70, v54, v62, v70
 v_fma_f32 v71, v55, v63, v71
 CV 140,64,65
 CV 141,66,67
 CV 142,68,69
 CV 143,70,71
 s_nop 0
 v_permlane16_swap_b32 v140, v142
 v_permlane16_swap_b32 v141, v143
 v_mov_b32 v64, v140
 v_mov_b32 v65, v141
 v_mov_b32_dpp v140, v142 row_ror:8 row_mask:0xf bank_mask:0xc
 v_mov_b32_dpp v141, v143 row_ror:8 row_mask:0xf bank_mask:0xc
 v_mov_b32_dpp v142, v64 row_ror:8 row_mask:0xf bank_mask:0x3
 v_mov_b32_dpp v143, v65 row_ror:8 row_mask:0xf bank_mask:0x3
 buffer_store_dwordx4 v[140:143], v28, s[48:51], s46 offen sc1
 v_mov_b32 v19, 0x10000000
 buffer_store_dword v19, v19, s[48:51], 0 offen
 s_add_u32 s92, s65, 0xb40000
 buffer_load_dwordx4 v[164:167], v25, s[36:39], s92 offen sc1
 s_add_u32 s92, s65, 0xd80000
 buffer_load_dwordx4 v[168:171], v25, s[36:39], s92 offen sc1
 s_add_u32 s92, s65, 0xfc0000
 buffer_load_dwordx4 v[172:175], v25, s[36:39], s92 offen sc1
 s_waitcnt vmcnt(10)
 v_lshlrev_b32 v48, 16, v144
 v_and_b32 v49, s93, v144
 v_lshlrev_b32 v50, 16, v145
 v_and_b32 v51, s93, v145
 v_lshlrev_b32 v52, 16, v146
 v_and_b32 v53, s93, v146
 v_lshlrev_b32 v54, 16, v147
 v_and_b32 v55, s93, v147
 s_add_u32 s92, s65, 0x1200000
 buffer_load_dwordx4 v[176:179], v25, s[36:39], s92 offen sc1
 s_waitcnt vmcnt(9)
 v_dot2c_f32_bf16 v48, s68, v148
 v_dot2c_f32_bf16 v49, s69, v148
 v_dot2c_f32_bf16 v50, s68, v149
 v_dot2c_f32_bf16 v51, s69, v149
 v_dot2c_f32_bf16 v52, s68, v150
 v_dot2c_f32_bf16 v53, s69, v150
 v_dot2c_f32_bf16 v54, s68, v151
 v_dot2c_f32_bf16 v55, s69, v151
 s_add_u32 s92, s65, 0x1440000
 buffer_load_dwordx4 v[180:183], v25, s[36:39], s92 offen sc1
 s_waitcnt vmcnt(9)
 v_dot2c_f32_bf16 v48, s68, v152
 v_dot2c_f32_bf16 v49, s69, v152
 v_dot2c_f32_bf16 v50, s68, v153
 v_dot2c_f32_bf16 v51, s69, v153
 v_dot2c_f32_bf16 v52, s68, v154
 v_dot2c_f32_bf16 v53, s69, v154
 v_dot2c_f32_bf16 v54, s68, v155
 v_dot2c_f32_bf16 v55, s69, v155
 s_add_u32 s92, s65, 0x1680000
 buffer_load_dwordx4 v[184:187], v25, s[36:39], s92 offen sc1
 s_waitcnt vmcnt(9)
 v_dot2c_f32_bf16 v48, s68, v156
 v_dot2c_f32_bf16 v49, s69, v156
 v_dot2c_f32_bf16 v50, s68, v157
 v_dot2c_f32_bf16 v51, s69, v157
 v_dot2c_f32_bf16 v52, s68, v158
 v_dot2c_f32_bf16 v53, s69, v158
 v_dot2c_f32_bf16 v54, s68, v159
 v_dot2c_f32_bf16 v55, s69, v159
 s_add_u32 s92, s65, 0x18c0000
 buffer_load_dwordx4 v[188:191], v25, s[36:39], s92 offen sc1
 s_waitcnt vmcnt(9)
 v_dot2c_f32_bf16 v48, s68, v160
 v_dot2c_f32_bf16 v49, s69, v160
 v_dot2c_f32_bf16 v50, s68, v161
 v_dot2c_f32_bf16 v51, s69, v161
 v_dot2c_f32_bf16 v52, s68, v162
 v_dot2c_f32_bf16 v53, s69, v162
 v_dot2c_f32_bf16 v54, s68, v163
 v_dot2c_f32_bf16 v55, s69, v163
 s_add_u32 s92, s65, 0x1b00000
 buffer_load_dwordx4 v[192:195], v25, s[36:39], s92 offen sc1
 s_waitcnt vmcnt(7)
 v_dot2c_f32_bf16 v48, s68, v164
 v_dot2c_f32_bf16 v49, s69, v164
 v_dot2c_f32_bf16 v50, s68, v165
 v_dot2c_f32_bf16 v51, s69, v165
 v_dot2c_f32_bf16 v52, s68, v166
 v_dot2c_f32_bf16 v53, s69, v166
 v_dot2c_f32_bf16 v54, s68, v167
 v_dot2c_f32_bf16 v55, s69, v167
 s_add_u32 s92, s65, 0x1d40000
 buffer_load_dwordx4 v[196:199], v25, s[36:39], s92 offen sc1
 s_waitcnt vmcnt(7)
 v_dot2c_f32_bf16 v48, s68, v168
 v_dot2c_f32_bf16 v49, s69, v168
 v_dot2c_f32_bf16 v50, s68, v169
 v_dot2c_f32_bf16 v51, s69, v169
 v_dot2c_f32_bf16 v52, s68, v170
 v_dot2c_f32_bf16 v53, s69, v170
 v_dot2c_f32_bf16 v54, s68, v171
 v_dot2c_f32_bf16 v55, s69, v171
 s_add_u32 s92, s65, 0x1f80000
 buffer_load_dwordx4 v[200:203], v25, s[36:39], s92 offen sc1
 s_waitcnt vmcnt(7)
 v_dot2c_f32_bf16 v48, s68, v172
 v_dot2c_f32_bf16 v49, s69, v172
 v_dot2c_f32_bf16 v50, s68, v173
 v_dot2c_f32_bf16 v51, s69, v173
 v_dot2c_f32_bf16 v52, s68, v174
 v_dot2c_f32_bf16 v53, s69, v174
 v_dot2c_f32_bf16 v54, s68, v175
 v_dot2c_f32_bf16 v55, s69, v175
 s_add_u32 s92, s65, 0x21c0000
 buffer_load_dwordx4 v[204:207], v25, s[36:39], s92 offen sc1
 s_waitcnt vmcnt(7)
 v_dot2c_f32_bf16 v48, s68, v176
 v_dot2c_f32_bf16 v49, s69, v176
 v_dot2c_f32_bf16 v50, s68, v177
 v_dot2c_f32_bf16 v51, s69, v177
 v_dot2c_f32_bf16 v52, s68, v178
 v_dot2c_f32_bf16 v53, s69, v178
 v_dot2c_f32_bf16 v54, s68, v179
 v_dot2c_f32_bf16 v55, s69, v179
 s_add_u32 s92, s65, 0x2400000
 buffer_load_dwordx4 v[208:211], v25, s[36:39], s92 offen sc1
 buffer_store_dword v29, v29, s[36:39], s76 offen sc1
 buffer_load_dword v16, v30, s[36:39], s76 offen sc1
 s_mov_b32 s93, 0xffff0000
 s_waitcnt vmcnt(9)
 v_dot2c_f32_bf16 v48, s68, v180
 v_dot2c_f32_bf16 v49, s69, v180
 v_dot2c_f32_bf16 v50, s68, v181
 v_dot2c_f32_bf16 v51, s69, v181
 v_dot2c_f32_bf16 v52, s68, v182
 v_dot2c_f32_bf16 v53, s69, v182
 v_dot2c_f32_bf16 v54, s68, v183
 v_dot2c_f32_bf16 v55, s69, v183
 s_waitcnt vmcnt(8)
 v_dot2c_f32_bf16 v48, s68, v184
 v_dot2c_f32_bf16 v49, s69, v184
 v_dot2c_f32_bf16 v50, s68, v185
 v_dot2c_f32_bf16 v51, s69, v185
 v_dot2c_f32_bf16 v52, s68, v186
 v_dot2c_f32_bf16 v53, s69, v186
 v_dot2c_f32_bf16 v54, s68, v187
 v_dot2c_f32_bf16 v55, s69, v187
 s_waitcnt vmcnt(7)
 v_lshlrev_b32 v56, 16, v188
 v_and_b32 v57, s93, v188
 v_lshlrev_b32 v58, 16, v189
 v_and_b32 v59, s93, v189
 v_lshlrev_b32 v60, 16, v190
 v_and_b32 v61, s93, v190
 v_lshlrev_b32 v62, 16, v191
 v_and_b32 v63, s93, v191
 s_waitcnt vmcnt(6)
 v_dot2c_f32_bf16 v56, s68, v192
 v_dot2c_f32_bf16 v57, s69, v192
 v_dot2c_f32_bf16 v58, s68, v193
 v_dot2c_f32_bf16 v59, s69, v193
 v_dot2c_f32_bf16 v60, s68, v194
 v_dot2c_f32_bf16 v61, s69, v194
 v_dot2c_f32_bf16 v62, s68, v195
 v_dot2c_f32_bf16 v63, s69, v195
 s_waitcnt vmcnt(5)
 v_dot2c_f32_bf16 v56, s68, v196
 v_dot2c_f32_bf16 v57, s69, v196
 v_dot2c_f32_bf16 v58, s68, v197
 v_dot2c_f32_bf16 v59, s69, v197
 v_dot2c_f32_bf16 v60, s68, v198
 v_dot2c_f32_bf16 v61, s69, v198
 v_dot2c_f32_bf16 v62, s68, v199
 v_dot2c_f32_bf16 v63, s69, v199
 s_waitcnt vmcnt(4)
 v_dot2c_f32_bf16 v56, s68, v200
 v_dot2c_f32_bf16 v57, s69, v200
 v_dot2c_f32_bf16 v58, s68, v201
 v_dot2c_f32_bf16 v59, s69, v201
 v_dot2c_f32_bf16 v60, s68, v202
 v_dot2c_f32_bf16 v61, s69, v202
 v_dot2c_f32_bf16 v62, s68, v203
 v_dot2c_f32_bf16 v63, s69, v203
 s_waitcnt vmcnt(3)
 v_dot2c_f32_bf16 v56, s68, v204
 v_dot2c_f32_bf16 v57, s69, v204
 v_dot2c_f32_bf16 v58, s68, v205
 v_dot2c_f32_bf16 v59, s69, v205
 v_dot2c_f32_bf16 v60, s68, v206
 v_dot2c_f32_bf16 v61, s69, v206
 v_dot2c_f32_bf16 v62, s68, v207
 v_dot2c_f32_bf16 v63, s69, v207
 s_waitcnt vmcnt(2)
 v_dot2c_f32_bf16 v56, s68, v208
 v_dot2c_f32_bf16 v57, s69, v208
 v_dot2c_f32_bf16 v58, s68, v209
 v_dot2c_f32_bf16 v59, s69, v209
 v_dot2c_f32_bf16 v60, s68, v210
 v_dot2c_f32_bf16 v61, s69, v210
 v_dot2c_f32_bf16 v62, s68, v211
 v_dot2c_f32_bf16 v63, s69, v211
 EX 64,56
 EX 65,57
 EX 66,58
 EX 67,59
 EX 68,60
 EX 69,61
 EX 70,62
 EX 71,63
 v_add_f32 v64, 1.0, v64
 v_add_f32 v65, 1.0, v65
 v_add_f32 v66, 1.0, v66
 v_add_f32 v67, 1.0, v67
 v_add_f32 v68, 1.0, v68
 v_add_f32 v69, 1.0, v69
 v_add_f32 v70, 1.0, v70
 v_add_f32 v71, 1.0, v71
 v_rcp_f32 v64, v64
 v_rcp_f32 v65, v65
 v_rcp_f32 v66, v66
 v_rcp_f32 v67, v67
 v_rcp_f32 v68, v68
 v_rcp_f32 v69, v69
 v_rcp_f32 v70, v70
 v_rcp_f32 v71, v71
 v_mul_f32 v56, 0xbf317218, v56
 v_mul_f32 v57, 0xbf317218, v57
 v_mul_f32 v58, 0xbf317218, v58
 v_mul_f32 v59, 0xbf317218, v59
 v_mul_f32 v60, 0xbf317218, v60
 v_mul_f32 v61, 0xbf317218, v61
 v_mul_f32 v62, 0xbf317218, v62
 v_mul_f32 v63, 0xbf317218, v63
 ML 56,56,64
 ML 57,57,65
 ML 58,58,66
 ML 59,59,67
 ML 60,60,68
 ML 61,61,69
 ML 62,62,70
 ML 63,63,71
 v_lshlrev_b32 v64, 16, v212
 v_and_b32 v65, s93, v212
 v_lshlrev_b32 v66, 16, v213
 v_and_b32 v67, s93, v213
 v_lshlrev_b32 v68, 16, v214
 v_and_b32 v69, s93, v214
 v_lshlrev_b32 v70, 16, v215
 v_and_b32 v71, s93, v215
 v_fma_f32 v64, v48, v56, v64
 v_fma_f32 v65, v49, v57, v65
 v_fma_f32 v66, v50, v58, v66
 v_fma_f32 v67, v51, v59, v67
 v_fma_f32 v68, v52, v60, v68
 v_fma_f32 v69, v53, v61, v69
 v_fma_f32 v70, v54, v62, v70
 v_fma_f32 v71, v55, v63, v71
 CV 212,64,65
 CV 213,66,67
 CV 214,68,69
 CV 215,70,71
 s_nop 0
 v_permlane16_swap_b32 v212, v214
 v_permlane16_swap_b32 v213, v215
 v_mov_b32 v64, v212
 v_mov_b32 v65, v213
 v_mov_b32_dpp v212, v214 row_ror:8 row_mask:0xf bank_mask:0xc
 v_mov_b32_dpp v213, v215 row_ror:8 row_mask:0xf bank_mask:0xc
 v_mov_b32_dpp v214, v64 row_ror:8 row_mask:0xf bank_mask:0x3
 v_mov_b32_dpp v215, v65 row_ror:8 row_mask:0xf bank_mask:0x3
 buffer_store_dwordx4 v[212:215], v28, s[48:51], s60 offen sc1
 v_mov_b32 v19, 0x10000000
 buffer_store_dword v19, v19, s[48:51], 0 offen
 s_branch L_A_j
L_A_sl:
 s_min_u32 s92, s78, s79
 s_cmp_lt_u32 s42, s92
 s_cbranch_scc0 L_A_s0
 s_mov_b32 s93, 0xffff0000
 buffer_load_dwordx2 v[140:141], v20, s[8:11], s46 offen
 buffer_load_dwordx2 v[142:143], v20, s[8:11], s46 offen offset:32
 s_add_u32 s92, s47, 0
 buffer_load_dwordx4 v[72:75], v25, s[36:39], s92 offen sc1
 s_add_u32 s92, s47, 0x240000
 buffer_load_dwordx4 v[76:79], v25, s[36:39], s92 offen sc1
 s_add_u32 s92, s47, 0x480000
 buffer_load_dwordx4 v[80:83], v25, s[36:39], s92 offen sc1
 s_add_u32 s92, s47, 0x6c0000
 buffer_load_dwordx4 v[84:87], v25, s[36:39], s92 offen sc1
 s_add_u32 s92, s47, 0x900000
 buffer_load_dwordx4 v[88:91], v25, s[36:39], s92 offen sc1
 s_add_u32 s92, s47, 0xb40000
 buffer_load_dwordx4 v[92:95], v25, s[36:39], s92 offen sc1
 s_add_u32 s92, s47, 0xd80000
 buffer_load_dwordx4 v[96:99], v25, s[36:39], s92 offen sc1
 s_add_u32 s92, s47, 0xfc0000
 buffer_load_dwordx4 v[100:103], v25, s[36:39], s92 offen sc1
 s_waitcnt vmcnt(7)
 v_lshlrev_b32 v48, 16, v72
 v_and_b32 v49, s93, v72
 v_lshlrev_b32 v50, 16, v73
 v_and_b32 v51, s93, v73
 v_lshlrev_b32 v52, 16, v74
 v_and_b32 v53, s93, v74
 v_lshlrev_b32 v54, 16, v75
 v_and_b32 v55, s93, v75
 s_add_u32 s92, s47, 0x1200000
 buffer_load_dwordx4 v[104:107], v25, s[36:39], s92 offen sc1
 s_waitcnt vmcnt(11)
 s_barrier
 v_mov_b32 v36, 9
 buffer_store_dword v36, v42, s[36:39], 0 offen sc1
 s_mov_b32 s93, 0xffff0000
 s_waitcnt vmcnt(8)
 v_dot2c_f32_bf16 v48, s68, v76
 v_dot2c_f32_bf16 v49, s69, v76
 v_dot2c_f32_bf16 v50, s68, v77
 v_dot2c_f32_bf16 v51, s69, v77
 v_dot2c_f32_bf16 v52, s68, v78
 v_dot2c_f32_bf16 v53, s69, v78
 v_dot2c_f32_bf16 v54, s68, v79
 v_dot2c_f32_bf16 v55, s69, v79
 s_add_u32 s92, s47, 0x1440000
 buffer_load_dwordx4 v[108:111], v25, s[36:39], s92 offen sc1
 s_waitcnt vmcnt(8)
 v_dot2c_f32_bf16 v48, s68, v80
 v_dot2c_f32_bf16 v49, s69, v80
 v_dot2c_f32_bf16 v50, s68, v81
 v_dot2c_f32_bf16 v51, s69, v81
 v_dot2c_f32_bf16 v52, s68, v82
 v_dot2c_f32_bf16 v53, s69, v82
 v_dot2c_f32_bf16 v54, s68, v83
 v_dot2c_f32_bf16 v55, s69, v83
 s_add_u32 s92, s47, 0x1680000
 buffer_load_dwordx4 v[112:115], v25, s[36:39], s92 offen sc1
 s_waitcnt vmcnt(8)
 v_dot2c_f32_bf16 v48, s68, v84
 v_dot2c_f32_bf16 v49, s69, v84
 v_dot2c_f32_bf16 v50, s68, v85
 v_dot2c_f32_bf16 v51, s69, v85
 v_dot2c_f32_bf16 v52, s68, v86
 v_dot2c_f32_bf16 v53, s69, v86
 v_dot2c_f32_bf16 v54, s68, v87
 v_dot2c_f32_bf16 v55, s69, v87
 s_add_u32 s92, s47, 0x18c0000
 buffer_load_dwordx4 v[116:119], v25, s[36:39], s92 offen sc1
 s_waitcnt vmcnt(8)
 v_dot2c_f32_bf16 v48, s68, v88
 v_dot2c_f32_bf16 v49, s69, v88
 v_dot2c_f32_bf16 v50, s68, v89
 v_dot2c_f32_bf16 v51, s69, v89
 v_dot2c_f32_bf16 v52, s68, v90
 v_dot2c_f32_bf16 v53, s69, v90
 v_dot2c_f32_bf16 v54, s68, v91
 v_dot2c_f32_bf16 v55, s69, v91
 s_add_u32 s92, s47, 0x1b00000
 buffer_load_dwordx4 v[120:123], v25, s[36:39], s92 offen sc1
 s_waitcnt vmcnt(8)
 v_dot2c_f32_bf16 v48, s68, v92
 v_dot2c_f32_bf16 v49, s69, v92
 v_dot2c_f32_bf16 v50, s68, v93
 v_dot2c_f32_bf16 v51, s69, v93
 v_dot2c_f32_bf16 v52, s68, v94
 v_dot2c_f32_bf16 v53, s69, v94
 v_dot2c_f32_bf16 v54, s68, v95
 v_dot2c_f32_bf16 v55, s69, v95
 s_add_u32 s92, s47, 0x1d40000
 buffer_load_dwordx4 v[124:127], v25, s[36:39], s92 offen sc1
 s_waitcnt vmcnt(8)
 v_dot2c_f32_bf16 v48, s68, v96
 v_dot2c_f32_bf16 v49, s69, v96
 v_dot2c_f32_bf16 v50, s68, v97
 v_dot2c_f32_bf16 v51, s69, v97
 v_dot2c_f32_bf16 v52, s68, v98
 v_dot2c_f32_bf16 v53, s69, v98
 v_dot2c_f32_bf16 v54, s68, v99
 v_dot2c_f32_bf16 v55, s69, v99
 s_add_u32 s92, s47, 0x1f80000
 buffer_load_dwordx4 v[128:131], v25, s[36:39], s92 offen sc1
 s_waitcnt vmcnt(8)
 v_dot2c_f32_bf16 v48, s68, v100
 v_dot2c_f32_bf16 v49, s69, v100
 v_dot2c_f32_bf16 v50, s68, v101
 v_dot2c_f32_bf16 v51, s69, v101
 v_dot2c_f32_bf16 v52, s68, v102
 v_dot2c_f32_bf16 v53, s69, v102
 v_dot2c_f32_bf16 v54, s68, v103
 v_dot2c_f32_bf16 v55, s69, v103
 s_add_u32 s92, s47, 0x21c0000
 buffer_load_dwordx4 v[132:135], v25, s[36:39], s92 offen sc1
 s_waitcnt vmcnt(8)
 v_dot2c_f32_bf16 v48, s68, v104
 v_dot2c_f32_bf16 v49, s69, v104
 v_dot2c_f32_bf16 v50, s68, v105
 v_dot2c_f32_bf16 v51, s69, v105
 v_dot2c_f32_bf16 v52, s68, v106
 v_dot2c_f32_bf16 v53, s69, v106
 v_dot2c_f32_bf16 v54, s68, v107
 v_dot2c_f32_bf16 v55, s69, v107
 s_add_u32 s92, s47, 0x2400000
 buffer_load_dwordx4 v[136:139], v25, s[36:39], s92 offen sc1
 s_waitcnt vmcnt(7)
 v_dot2c_f32_bf16 v48, s68, v108
 v_dot2c_f32_bf16 v49, s69, v108
 v_dot2c_f32_bf16 v50, s68, v109
 v_dot2c_f32_bf16 v51, s69, v109
 v_dot2c_f32_bf16 v52, s68, v110
 v_dot2c_f32_bf16 v53, s69, v110
 v_dot2c_f32_bf16 v54, s68, v111
 v_dot2c_f32_bf16 v55, s69, v111
 buffer_store_dword v29, v29, s[36:39], s76 offen sc1
 buffer_load_dword v16, v30, s[36:39], s76 offen sc1
 s_mov_b32 s93, 0xffff0000
 s_waitcnt vmcnt(8)
 v_dot2c_f32_bf16 v48, s68, v112
 v_dot2c_f32_bf16 v49, s69, v112
 v_dot2c_f32_bf16 v50, s68, v113
 v_dot2c_f32_bf16 v51, s69, v113
 v_dot2c_f32_bf16 v52, s68, v114
 v_dot2c_f32_bf16 v53, s69, v114
 v_dot2c_f32_bf16 v54, s68, v115
 v_dot2c_f32_bf16 v55, s69, v115
 s_waitcnt vmcnt(7)
 v_lshlrev_b32 v56, 16, v116
 v_and_b32 v57, s93, v116
 v_lshlrev_b32 v58, 16, v117
 v_and_b32 v59, s93, v117
 v_lshlrev_b32 v60, 16, v118
 v_and_b32 v61, s93, v118
 v_lshlrev_b32 v62, 16, v119
 v_and_b32 v63, s93, v119
 s_waitcnt vmcnt(6)
 v_dot2c_f32_bf16 v56, s68, v120
 v_dot2c_f32_bf16 v57, s69, v120
 v_dot2c_f32_bf16 v58, s68, v121
 v_dot2c_f32_bf16 v59, s69, v121
 v_dot2c_f32_bf16 v60, s68, v122
 v_dot2c_f32_bf16 v61, s69, v122
 v_dot2c_f32_bf16 v62, s68, v123
 v_dot2c_f32_bf16 v63, s69, v123
 s_waitcnt vmcnt(5)
 v_dot2c_f32_bf16 v56, s68, v124
 v_dot2c_f32_bf16 v57, s69, v124
 v_dot2c_f32_bf16 v58, s68, v125
 v_dot2c_f32_bf16 v59, s69, v125
 v_dot2c_f32_bf16 v60, s68, v126
 v_dot2c_f32_bf16 v61, s69, v126
 v_dot2c_f32_bf16 v62, s68, v127
 v_dot2c_f32_bf16 v63, s69, v127
 s_waitcnt vmcnt(4)
 v_dot2c_f32_bf16 v56, s68, v128
 v_dot2c_f32_bf16 v57, s69, v128
 v_dot2c_f32_bf16 v58, s68, v129
 v_dot2c_f32_bf16 v59, s69, v129
 v_dot2c_f32_bf16 v60, s68, v130
 v_dot2c_f32_bf16 v61, s69, v130
 v_dot2c_f32_bf16 v62, s68, v131
 v_dot2c_f32_bf16 v63, s69, v131
 s_waitcnt vmcnt(3)
 v_dot2c_f32_bf16 v56, s68, v132
 v_dot2c_f32_bf16 v57, s69, v132
 v_dot2c_f32_bf16 v58, s68, v133
 v_dot2c_f32_bf16 v59, s69, v133
 v_dot2c_f32_bf16 v60, s68, v134
 v_dot2c_f32_bf16 v61, s69, v134
 v_dot2c_f32_bf16 v62, s68, v135
 v_dot2c_f32_bf16 v63, s69, v135
 s_waitcnt vmcnt(2)
 v_dot2c_f32_bf16 v56, s68, v136
 v_dot2c_f32_bf16 v57, s69, v136
 v_dot2c_f32_bf16 v58, s68, v137
 v_dot2c_f32_bf16 v59, s69, v137
 v_dot2c_f32_bf16 v60, s68, v138
 v_dot2c_f32_bf16 v61, s69, v138
 v_dot2c_f32_bf16 v62, s68, v139
 v_dot2c_f32_bf16 v63, s69, v139
 EX 64,56
 EX 65,57
 EX 66,58
 EX 67,59
 EX 68,60
 EX 69,61
 EX 70,62
 EX 71,63
 v_add_f32 v64, 1.0, v64
 v_add_f32 v65, 1.0, v65
 v_add_f32 v66, 1.0, v66
 v_add_f32 v67, 1.0, v67
 v_add_f32 v68, 1.0, v68
 v_add_f32 v69, 1.0, v69
 v_add_f32 v70, 1.0, v70
 v_add_f32 v71, 1.0, v71
 v_rcp_f32 v64, v64
 v_rcp_f32 v65, v65
 v_rcp_f32 v66, v66
 v_rcp_f32 v67, v67
 v_rcp_f32 v68, v68
 v_rcp_f32 v69, v69
 v_rcp_f32 v70, v70
 v_rcp_f32 v71, v71
 v_mul_f32 v56, 0xbf317218, v56
 v_mul_f32 v57, 0xbf317218, v57
 v_mul_f32 v58, 0xbf317218, v58
 v_mul_f32 v59, 0xbf317218, v59
 v_mul_f32 v60, 0xbf317218, v60
 v_mul_f32 v61, 0xbf317218, v61
 v_mul_f32 v62, 0xbf317218, v62
 v_mul_f32 v63, 0xbf317218, v63
 ML 56,56,64
 ML 57,57,65
 ML 58,58,66
 ML 59,59,67
 ML 60,60,68
 ML 61,61,69
 ML 62,62,70
 ML 63,63,71
 v_lshlrev_b32 v64, 16, v140
 v_and_b32 v65, s93, v140
 v_lshlrev_b32 v66, 16, v141
 v_and_b32 v67, s93, v141
 v_lshlrev_b32 v68, 16, v142
 v_and_b32 v69, s93, v142
 v_lshlrev_b32 v70, 16, v143
 v_and_b32 v71, s93, v143
 v_fma_f32 v64, v48, v56, v64
 v_fma_f32 v65, v49, v57, v65
 v_fma_f32 v66, v50, v58, v66
 v_fma_f32 v67, v51, v59, v67
 v_fma_f32 v68, v52, v60, v68
 v_fma_f32 v69, v53, v61, v69
 v_fma_f32 v70, v54, v62, v70
 v_fma_f32 v71, v55, v63, v71
 CV 140,64,65
 CV 141,66,67
 CV 142,68,69
 CV 143,70,71
 s_nop 0
 v_permlane16_swap_b32 v140, v142
 v_permlane16_swap_b32 v141, v143
 v_mov_b32 v64, v140
 v_mov_b32 v65, v141
 v_mov_b32_dpp v140, v142 row_ror:8 row_mask:0xf bank_mask:0xc
 v_mov_b32_dpp v141, v143 row_ror:8 row_mask:0xf bank_mask:0xc
 v_mov_b32_dpp v142, v64 row_ror:8 row_mask:0xf bank_mask:0x3
 v_mov_b32_dpp v143, v65 row_ror:8 row_mask:0xf bank_mask:0x3
 buffer_store_dwordx4 v[140:143], v28, s[48:51], s46 offen sc1
 v_mov_b32 v19, 0x10000000
 buffer_store_dword v19, v19, s[48:51], 0 offen
 s_bitset0_b64 s[74:75], s42
 s_cmp_eq_u32 s62, 0
 s_cbranch_scc0 L_A_rf0
 s_waitcnt vmcnt(2)
 v_cmp_ne_u32 vcc, 0, v16
 s_nop 1
 s_lshr_b64 s[72:73], vcc, 18
 s_and_b32 s73, s73, 15
 s_mov_b32 s78, 0
 s_mov_b32 s79, 0
 v_cmp_ge_u32 vcc, 0, v16
 s_nop 1
 s_and_b32 s92, vcc_lo, 0x7ff
 s_cselect_b32 s78, s78, 4
 s_and_b32 s92, vcc_lo, 0x1f800
 s_cselect_b32 s79, s79, 4
 v_cmp_ge_u32 vcc, 1, v16
 s_nop 1
 s_and_b32 s92, vcc_lo, 0x7ff
 s_cselect_b32 s78, s78, 8
 s_and_b32 s92, vcc_lo, 0x1f800
 s_cselect_b32 s79, s79, 8
 v_cmp_ge_u32 vcc, 2, v16
 s_nop 1
 s_and_b32 s92, vcc_lo, 0x7ff
 s_cselect_b32 s78, s78, 12
 s_and_b32 s92, vcc_lo, 0x1f800
 s_cselect_b32 s79, s79, 12
 v_cmp_ge_u32 vcc, 3, v16
 s_nop 1
 s_and_b32 s92, vcc_lo, 0x7ff
 s_cselect_b32 s78, s78, 16
 s_and_b32 s92, vcc_lo, 0x1f800
 s_cselect_b32 s79, s79, 16
 v_cmp_ge_u32 vcc, 4, v16
 s_nop 1
 s_and_b32 s92, vcc_lo, 0x7ff
 s_cselect_b32 s78, s78, 20
 s_and_b32 s92, vcc_lo, 0x1f800
 s_cselect_b32 s79, s79, 20
 v_cmp_ge_u32 vcc, 5, v16
 s_nop 1
 s_and_b32 s92, vcc_lo, 0x7ff
 s_cselect_b32 s78, s78, 24
 s_and_b32 s92, vcc_lo, 0x1f800
 s_cselect_b32 s79, s79, 24
 v_cmp_ge_u32 vcc, 6, v16
 s_nop 1
 s_and_b32 s92, vcc_lo, 0x7ff
 s_cselect_b32 s78, s78, 28
 s_and_b32 s92, vcc_lo, 0x1f800
 s_cselect_b32 s79, s79, 28
 v_cmp_ge_u32 vcc, 7, v16
 s_nop 1
 s_and_b32 s92, vcc_lo, 0x7ff
 s_cselect_b32 s78, s78, 32
 s_and_b32 s92, vcc_lo, 0x1f800
 s_cselect_b32 s79, s79, 32
 v_cmp_ge_u32 vcc, 8, v16
 s_nop 1
 s_and_b32 s92, vcc_lo, 0x7ff
 s_cselect_b32 s78, s78, 36
 s_and_b32 s92, vcc_lo, 0x1f800
 s_cselect_b32 s79, s79, 36
 s_lshl_b32 s92, s79, 8
 s_or_b32 s92, s92, s78
 s_lshl_b32 s93, s58, 16
 s_or_b32 s92, s92, s93
 v_mov_b32 v24, s92
 v_mov_b32 v23, s41
 ds_write_b32 v23, v24
 WL 0
L_A_rf0:
 s_barrier
 v_mov_b32 v23, s41
 ds_read_b32 v24, v23
 WL 0
 v_readfirstlane_b32 s92, v24
 s_nop 1
 s_and_b32 s78, s92, 0xff
 s_bfe_u32 s79, s92, 0x80008
 s_lshr_b32 s58, s92, 16
 s_xor_b32 s41, s41, 12
 s_min_u32 s92, s78, s79
 s_cmp_lt_u32 s44, s92
 s_cbranch_scc1 L_A_en1
 s_mov_b32 s81, s44
 s_mov_b32 s80, 3
 s_call_b64 s[66:67], L_A_sync
 s_cmp_eq_u32 s58, 0
 s_cbranch_scc0 L_A_fb
L_A_en1:
 s_mov_b32 s93, 0xffff0000
 buffer_load_dwordx2 v[212:213], v20, s[8:11], s60 offen
 buffer_load_dwordx2 v[214:215], v20, s[8:11], s60 offen offset:32
 s_add_u32 s92, s65, 0
 buffer_load_dwordx4 v[144:147], v25, s[36:39], s92 offen sc1
 s_add_u32 s92, s65, 0x240000
 buffer_load_dwordx4 v[148:151], v25, s[36:39], s92 offen sc1
 s_add_u32 s92, s65, 0x480000
 buffer_load_dwordx4 v[152:155], v25, s[36:39], s92 offen sc1
 s_add_u32 s92, s65, 0x6c0000
 buffer_load_dwordx4 v[156:159], v25, s[36:39], s92 offen sc1
 s_add_u32 s92, s65, 0x900000
 buffer_load_dwordx4 v[160:163], v25, s[36:39], s92 offen sc1
 s_add_u32 s92, s65, 0xb40000
 buffer_load_dwordx4 v[164:167], v25, s[36:39], s92 offen sc1
 s_add_u32 s92, s65, 0xd80000
 buffer_load_dwordx4 v[168:171], v25, s[36:39], s92 offen sc1
 s_add_u32 s92, s65, 0xfc0000
 buffer_load_dwordx4 v[172:175], v25, s[36:39], s92 offen sc1
 s_waitcnt vmcnt(7)
 v_lshlrev_b32 v48, 16, v144
 v_and_b32 v49, s93, v144
 v_lshlrev_b32 v50, 16, v145
 v_and_b32 v51, s93, v145
 v_lshlrev_b32 v52, 16, v146
 v_and_b32 v53, s93, v146
 v_lshlrev_b32 v54, 16, v147
 v_and_b32 v55, s93, v147
 s_add_u32 s92, s65, 0x1200000
 buffer_load_dwordx4 v[176:179], v25, s[36:39], s92 offen sc1
 buffer_load_dword v31, v21, s[36:39], s77 offen sc1
 s_mov_b32 s93, 0xffff0000
 s_waitcnt vmcnt(8)
 v_dot2c_f32_bf16 v48, s68, v148
 v_dot2c_f32_bf16 v49, s69, v148
 v_dot2c_f32_bf16 v50, s68, v149
 v_dot2c_f32_bf16 v51, s69, v149
 v_dot2c_f32_bf16 v52, s68, v150
 v_dot2c_f32_bf16 v53, s69, v150
 v_dot2c_f32_bf16 v54, s68, v151
 v_dot2c_f32_bf16 v55, s69, v151
 s_add_u32 s92, s65, 0x1440000
 buffer_load_dwordx4 v[180:183], v25, s[36:39], s92 offen sc1
 s_waitcnt vmcnt(8)
 v_dot2c_f32_bf16 v48, s68, v152
 v_dot2c_f32_bf16 v49, s69, v152
 v_dot2c_f32_bf16 v50, s68, v153
 v_dot2c_f32_bf16 v51, s69, v153
 v_dot2c_f32_bf16 v52, s68, v154
 v_dot2c_f32_bf16 v53, s69, v154
 v_dot2c_f32_bf16 v54, s68, v155
 v_dot2c_f32_bf16 v55, s69, v155
 s_add_u32 s92, s65, 0x1680000
 buffer_load_dwordx4 v[184:187], v25, s[36:39], s92 offen sc1
 s_waitcnt vmcnt(8)
 v_dot2c_f32_bf16 v48, s68, v156
 v_dot2c_f32_bf16 v49, s69, v156
 v_dot2c_f32_bf16 v50, s68, v157
 v_dot2c_f32_bf16 v51, s69, v157
 v_dot2c_f32_bf16 v52, s68, v158
 v_dot2c_f32_bf16 v53, s69, v158
 v_dot2c_f32_bf16 v54, s68, v159
 v_dot2c_f32_bf16 v55, s69, v159
 s_add_u32 s92, s65, 0x18c0000
 buffer_load_dwordx4 v[188:191], v25, s[36:39], s92 offen sc1
 s_waitcnt vmcnt(8)
 v_dot2c_f32_bf16 v48, s68, v160
 v_dot2c_f32_bf16 v49, s69, v160
 v_dot2c_f32_bf16 v50, s68, v161
 v_dot2c_f32_bf16 v51, s69, v161
 v_dot2c_f32_bf16 v52, s68, v162
 v_dot2c_f32_bf16 v53, s69, v162
 v_dot2c_f32_bf16 v54, s68, v163
 v_dot2c_f32_bf16 v55, s69, v163
 s_add_u32 s92, s65, 0x1b00000
 buffer_load_dwordx4 v[192:195], v25, s[36:39], s92 offen sc1
 s_waitcnt vmcnt(8)
 v_dot2c_f32_bf16 v48, s68, v164
 v_dot2c_f32_bf16 v49, s69, v164
 v_dot2c_f32_bf16 v50, s68, v165
 v_dot2c_f32_bf16 v51, s69, v165
 v_dot2c_f32_bf16 v52, s68, v166
 v_dot2c_f32_bf16 v53, s69, v166
 v_dot2c_f32_bf16 v54, s68, v167
 v_dot2c_f32_bf16 v55, s69, v167
 s_add_u32 s92, s65, 0x1d40000
 buffer_load_dwordx4 v[196:199], v25, s[36:39], s92 offen sc1
 s_waitcnt vmcnt(8)
 v_dot2c_f32_bf16 v48, s68, v168
 v_dot2c_f32_bf16 v49, s69, v168
 v_dot2c_f32_bf16 v50, s68, v169
 v_dot2c_f32_bf16 v51, s69, v169
 v_dot2c_f32_bf16 v52, s68, v170
 v_dot2c_f32_bf16 v53, s69, v170
 v_dot2c_f32_bf16 v54, s68, v171
 v_dot2c_f32_bf16 v55, s69, v171
 s_add_u32 s92, s65, 0x1f80000
 buffer_load_dwordx4 v[200:203], v25, s[36:39], s92 offen sc1
 s_waitcnt vmcnt(8)
 v_dot2c_f32_bf16 v48, s68, v172
 v_dot2c_f32_bf16 v49, s69, v172
 v_dot2c_f32_bf16 v50, s68, v173
 v_dot2c_f32_bf16 v51, s69, v173
 v_dot2c_f32_bf16 v52, s68, v174
 v_dot2c_f32_bf16 v53, s69, v174
 v_dot2c_f32_bf16 v54, s68, v175
 v_dot2c_f32_bf16 v55, s69, v175
 s_add_u32 s92, s65, 0x21c0000
 buffer_load_dwordx4 v[204:207], v25, s[36:39], s92 offen sc1
 s_waitcnt vmcnt(8)
 v_dot2c_f32_bf16 v48, s68, v176
 v_dot2c_f32_bf16 v49, s69, v176
 v_dot2c_f32_bf16 v50, s68, v177
 v_dot2c_f32_bf16 v51, s69, v177
 v_dot2c_f32_bf16 v52, s68, v178
 v_dot2c_f32_bf16 v53, s69, v178
 v_dot2c_f32_bf16 v54, s68, v179
 v_dot2c_f32_bf16 v55, s69, v179
 s_add_u32 s92, s65, 0x2400000
 buffer_load_dwordx4 v[208:211], v25, s[36:39], s92 offen sc1
 buffer_store_dword v29, v29, s[36:39], s76 offen sc1
 buffer_load_dword v16, v30, s[36:39], s76 offen sc1
 s_mov_b32 s93, 0xffff0000
 s_waitcnt vmcnt(9)
 v_dot2c_f32_bf16 v48, s68, v180
 v_dot2c_f32_bf16 v49, s69, v180
 v_dot2c_f32_bf16 v50, s68, v181
 v_dot2c_f32_bf16 v51, s69, v181
 v_dot2c_f32_bf16 v52, s68, v182
 v_dot2c_f32_bf16 v53, s69, v182
 v_dot2c_f32_bf16 v54, s68, v183
 v_dot2c_f32_bf16 v55, s69, v183
 s_waitcnt vmcnt(8)
 v_dot2c_f32_bf16 v48, s68, v184
 v_dot2c_f32_bf16 v49, s69, v184
 v_dot2c_f32_bf16 v50, s68, v185
 v_dot2c_f32_bf16 v51, s69, v185
 v_dot2c_f32_bf16 v52, s68, v186
 v_dot2c_f32_bf16 v53, s69, v186
 v_dot2c_f32_bf16 v54, s68, v187
 v_dot2c_f32_bf16 v55, s69, v187
 s_waitcnt vmcnt(7)
 v_lshlrev_b32 v56, 16, v188
 v_and_b32 v57, s93, v188
 v_lshlrev_b32 v58, 16, v189
 v_and_b32 v59, s93, v189
 v_lshlrev_b32 v60, 16, v190
 v_and_b32 v61, s93, v190
 v_lshlrev_b32 v62, 16, v191
 v_and_b32 v63, s93, v191
 s_waitcnt vmcnt(6)
 v_dot2c_f32_bf16 v56, s68, v192
 v_dot2c_f32_bf16 v57, s69, v192
 v_dot2c_f32_bf16 v58, s68, v193
 v_dot2c_f32_bf16 v59, s69, v193
 v_dot2c_f32_bf16 v60, s68, v194
 v_dot2c_f32_bf16 v61, s69, v194
 v_dot2c_f32_bf16 v62, s68, v195
 v_dot2c_f32_bf16 v63, s69, v195
 s_waitcnt vmcnt(5)
 v_dot2c_f32_bf16 v56, s68, v196
 v_dot2c_f32_bf16 v57, s69, v196
 v_dot2c_f32_bf16 v58, s68, v197
 v_dot2c_f32_bf16 v59, s69, v197
 v_dot2c_f32_bf16 v60, s68, v198
 v_dot2c_f32_bf16 v61, s69, v198
 v_dot2c_f32_bf16 v62, s68, v199
 v_dot2c_f32_bf16 v63, s69, v199
 s_waitcnt vmcnt(4)
 v_dot2c_f32_bf16 v56, s68, v200
 v_dot2c_f32_bf16 v57, s69, v200
 v_dot2c_f32_bf16 v58, s68, v201
 v_dot2c_f32_bf16 v59, s69, v201
 v_dot2c_f32_bf16 v60, s68, v202
 v_dot2c_f32_bf16 v61, s69, v202
 v_dot2c_f32_bf16 v62, s68, v203
 v_dot2c_f32_bf16 v63, s69, v203
 s_waitcnt vmcnt(3)
 v_dot2c_f32_bf16 v56, s68, v204
 v_dot2c_f32_bf16 v57, s69, v204
 v_dot2c_f32_bf16 v58, s68, v205
 v_dot2c_f32_bf16 v59, s69, v205
 v_dot2c_f32_bf16 v60, s68, v206
 v_dot2c_f32_bf16 v61, s69, v206
 v_dot2c_f32_bf16 v62, s68, v207
 v_dot2c_f32_bf16 v63, s69, v207
 s_waitcnt vmcnt(2)
 v_dot2c_f32_bf16 v56, s68, v208
 v_dot2c_f32_bf16 v57, s69, v208
 v_dot2c_f32_bf16 v58, s68, v209
 v_dot2c_f32_bf16 v59, s69, v209
 v_dot2c_f32_bf16 v60, s68, v210
 v_dot2c_f32_bf16 v61, s69, v210
 v_dot2c_f32_bf16 v62, s68, v211
 v_dot2c_f32_bf16 v63, s69, v211
 EX 64,56
 EX 65,57
 EX 66,58
 EX 67,59
 EX 68,60
 EX 69,61
 EX 70,62
 EX 71,63
 v_add_f32 v64, 1.0, v64
 v_add_f32 v65, 1.0, v65
 v_add_f32 v66, 1.0, v66
 v_add_f32 v67, 1.0, v67
 v_add_f32 v68, 1.0, v68
 v_add_f32 v69, 1.0, v69
 v_add_f32 v70, 1.0, v70
 v_add_f32 v71, 1.0, v71
 v_rcp_f32 v64, v64
 v_rcp_f32 v65, v65
 v_rcp_f32 v66, v66
 v_rcp_f32 v67, v67
 v_rcp_f32 v68, v68
 v_rcp_f32 v69, v69
 v_rcp_f32 v70, v70
 v_rcp_f32 v71, v71
 v_mul_f32 v56, 0xbf317218, v56
 v_mul_f32 v57, 0xbf317218, v57
 v_mul_f32 v58, 0xbf317218, v58
 v_mul_f32 v59, 0xbf317218, v59
 v_mul_f32 v60, 0xbf317218, v60
 v_mul_f32 v61, 0xbf317218, v61
 v_mul_f32 v62, 0xbf317218, v62
 v_mul_f32 v63, 0xbf317218, v63
 ML 56,56,64
 ML 57,57,65
 ML 58,58,66
 ML 59,59,67
 ML 60,60,68
 ML 61,61,69
 ML 62,62,70
 ML 63,63,71
 v_lshlrev_b32 v64, 16, v212
 v_and_b32 v65, s93, v212
 v_lshlrev_b32 v66, 16, v213
 v_and_b32 v67, s93, v213
 v_lshlrev_b32 v68, 16, v214
 v_and_b32 v69, s93, v214
 v_lshlrev_b32 v70, 16, v215
 v_and_b32 v71, s93, v215
 v_fma_f32 v64, v48, v56, v64
 v_fma_f32 v65, v49, v57, v65
 v_fma_f32 v66, v50, v58, v66
 v_fma_f32 v67, v51, v59, v67
 v_fma_f32 v68, v52, v60, v68
 v_fma_f32 v69, v53, v61, v69
 v_fma_f32 v70, v54, v62, v70
 v_fma_f32 v71, v55, v63, v71
 CV 212,64,65
 CV 213,66,67
 CV 214,68,69
 CV 215,70,71
 s_nop 0
 v_permlane16_swap_b32 v212, v214
 v_permlane16_swap_b32 v213, v215
 v_mov_b32 v64, v212
 v_mov_b32 v65, v213
 v_mov_b32_dpp v212, v214 row_ror:8 row_mask:0xf bank_mask:0xc
 v_mov_b32_dpp v213, v215 row_ror:8 row_mask:0xf bank_mask:0xc
 v_mov_b32_dpp v214, v64 row_ror:8 row_mask:0xf bank_mask:0x3
 v_mov_b32_dpp v215, v65 row_ror:8 row_mask:0xf bank_mask:0x3
 buffer_store_dwordx4 v[212:215], v28, s[48:51], s60 offen sc1
 v_mov_b32 v19, 0x10000000
 buffer_store_dword v19, v19, s[48:51], 0 offen
 s_branch L_A_j
L_A_s0:
 s_waitcnt vmcnt(0)
 s_barrier
 v_mov_b32 v36, 9
 buffer_store_dword v36, v42, s[36:39], 0 offen sc1
 s_min_u32 s92, s78, s79
 s_cmp_lt_u32 s42, s92
 s_cbranch_scc1 L_A_en2
 s_mov_b32 s81, s42
 s_mov_b32 s80, 3
 s_call_b64 s[66:67], L_A_sync
 s_cmp_eq_u32 s58, 0
 s_cbranch_scc0 L_A_fb
L_A_en2:
 s_mov_b32 s93, 0xffff0000
 buffer_load_dwordx2 v[140:141], v20, s[8:11], s46 offen
 buffer_load_dwordx2 v[142:143], v20, s[8:11], s46 offen offset:32
 s_add_u32 s92, s47, 0
 buffer_load_dwordx4 v[72:75], v25, s[36:39], s92 offen sc1
 s_add_u32 s92, s47, 0x240000
 buffer_load_dwordx4 v[76:79], v25, s[36:39], s92 offen sc1
 s_add_u32 s92, s47, 0x480000
 buffer_load_dwordx4 v[80:83], v25, s[36:39], s92 offen sc1
 s_add_u32 s92, s47, 0x6c0000
 buffer_load_dwordx4 v[84:87], v25, s[36:39], s92 offen sc1
 s_add_u32 s92, s47, 0x900000
 buffer_load_dwordx4 v[88:91], v25, s[36:39], s92 offen sc1
 s_add_u32 s92, s47, 0xb40000
 buffer_load_dwordx4 v[92:95], v25, s[36:39], s92 offen sc1
 s_add_u32 s92, s47, 0xd80000
 buffer_load_dwordx4 v[96:99], v25, s[36:39], s92 offen sc1
 s_add_u32 s92, s47, 0xfc0000
 buffer_load_dwordx4 v[100:103], v25, s[36:39], s92 offen sc1
 s_waitcnt vmcnt(7)
 v_lshlrev_b32 v48, 16, v72
 v_and_b32 v49, s93, v72
 v_lshlrev_b32 v50, 16, v73
 v_and_b32 v51, s93, v73
 v_lshlrev_b32 v52, 16, v74
 v_and_b32 v53, s93, v74
 v_lshlrev_b32 v54, 16, v75
 v_and_b32 v55, s93, v75
 s_add_u32 s92, s47, 0x1200000
 buffer_load_dwordx4 v[104:107], v25, s[36:39], s92 offen sc1
 s_waitcnt vmcnt(7)
 v_dot2c_f32_bf16 v48, s68, v76
 v_dot2c_f32_bf16 v49, s69, v76
 v_dot2c_f32_bf16 v50, s68, v77
 v_dot2c_f32_bf16 v51, s69, v77
 v_dot2c_f32_bf16 v52, s68, v78
 v_dot2c_f32_bf16 v53, s69, v78
 v_dot2c_f32_bf16 v54, s68, v79
 v_dot2c_f32_bf16 v55, s69, v79
 s_add_u32 s92, s47, 0x1440000
 buffer_load_dwordx4 v[108:111], v25, s[36:39], s92 offen sc1
 s_waitcnt vmcnt(7)
 v_dot2c_f32_bf16 v48, s68, v80
 v_dot2c_f32_bf16 v49, s69, v80
 v_dot2c_f32_bf16 v50, s68, v81
 v_dot2c_f32_bf16 v51, s69, v81
 v_dot2c_f32_bf16 v52, s68, v82
 v_dot2c_f32_bf16 v53, s69, v82
 v_dot2c_f32_bf16 v54, s68, v83
 v_dot2c_f32_bf16 v55, s69, v83
 s_add_u32 s92, s47, 0x1680000
 buffer_load_dwordx4 v[112:115], v25, s[36:39], s92 offen sc1
 s_waitcnt vmcnt(7)
 v_dot2c_f32_bf16 v48, s68, v84
 v_dot2c_f32_bf16 v49, s69, v84
 v_dot2c_f32_bf16 v50, s68, v85
 v_dot2c_f32_bf16 v51, s69, v85
 v_dot2c_f32_bf16 v52, s68, v86
 v_dot2c_f32_bf16 v53, s69, v86
 v_dot2c_f32_bf16 v54, s68, v87
 v_dot2c_f32_bf16 v55, s69, v87
 s_add_u32 s92, s47, 0x18c0000
 buffer_load_dwordx4 v[116:119], v25, s[36:39], s92 offen sc1
 s_waitcnt vmcnt(7)
 v_dot2c_f32_bf16 v48, s68, v88
 v_dot2c_f32_bf16 v49, s69, v88
 v_dot2c_f32_bf16 v50, s68, v89
 v_dot2c_f32_bf16 v51, s69, v89
 v_dot2c_f32_bf16 v52, s68, v90
 v_dot2c_f32_bf16 v53, s69, v90
 v_dot2c_f32_bf16 v54, s68, v91
 v_dot2c_f32_bf16 v55, s69, v91
 s_add_u32 s92, s47, 0x1b00000
 buffer_load_dwordx4 v[120:123], v25, s[36:39], s92 offen sc1
 s_waitcnt vmcnt(7)
 v_dot2c_f32_bf16 v48, s68, v92
 v_dot2c_f32_bf16 v49, s69, v92
 v_dot2c_f32_bf16 v50, s68, v93
 v_dot2c_f32_bf16 v51, s69, v93
 v_dot2c_f32_bf16 v52, s68, v94
 v_dot2c_f32_bf16 v53, s69, v94
 v_dot2c_f32_bf16 v54, s68, v95
 v_dot2c_f32_bf16 v55, s69, v95
 s_add_u32 s92, s47, 0x1d40000
 buffer_load_dwordx4 v[124:127], v25, s[36:39], s92 offen sc1
 s_waitcnt vmcnt(7)
 v_dot2c_f32_bf16 v48, s68, v96
 v_dot2c_f32_bf16 v49, s69, v96
 v_dot2c_f32_bf16 v50, s68, v97
 v_dot2c_f32_bf16 v51, s69, v97
 v_dot2c_f32_bf16 v52, s68, v98
 v_dot2c_f32_bf16 v53, s69, v98
 v_dot2c_f32_bf16 v54, s68, v99
 v_dot2c_f32_bf16 v55, s69, v99
 s_add_u32 s92, s47, 0x1f80000
 buffer_load_dwordx4 v[128:131], v25, s[36:39], s92 offen sc1
 s_waitcnt vmcnt(7)
 v_dot2c_f32_bf16 v48, s68, v100
 v_dot2c_f32_bf16 v49, s69, v100
 v_dot2c_f32_bf16 v50, s68, v101
 v_dot2c_f32_bf16 v51, s69, v101
 v_dot2c_f32_bf16 v52, s68, v102
 v_dot2c_f32_bf16 v53, s69, v102
 v_dot2c_f32_bf16 v54, s68, v103
 v_dot2c_f32_bf16 v55, s69, v103
 s_add_u32 s92, s47, 0x21c0000
 buffer_load_dwordx4 v[132:135], v25, s[36:39], s92 offen sc1
 s_waitcnt vmcnt(7)
 v_dot2c_f32_bf16 v48, s68, v104
 v_dot2c_f32_bf16 v49, s69, v104
 v_dot2c_f32_bf16 v50, s68, v105
 v_dot2c_f32_bf16 v51, s69, v105
 v_dot2c_f32_bf16 v52, s68, v106
 v_dot2c_f32_bf16 v53, s69, v106
 v_dot2c_f32_bf16 v54, s68, v107
 v_dot2c_f32_bf16 v55, s69, v107
 s_add_u32 s92, s47, 0x2400000
 buffer_load_dwordx4 v[136:139], v25, s[36:39], s92 offen sc1
 s_waitcnt vmcnt(7)
 v_dot2c_f32_bf16 v48, s68, v108
 v_dot2c_f32_bf16 v49, s69, v108
 v_dot2c_f32_bf16 v50, s68, v109
 v_dot2c_f32_bf16 v51, s69, v109
 v_dot2c_f32_bf16 v52, s68, v110
 v_dot2c_f32_bf16 v53, s69, v110
 v_dot2c_f32_bf16 v54, s68, v111
 v_dot2c_f32_bf16 v55, s69, v111
 s_waitcnt vmcnt(6)
 v_dot2c_f32_bf16 v48, s68, v112
 v_dot2c_f32_bf16 v49, s69, v112
 v_dot2c_f32_bf16 v50, s68, v113
 v_dot2c_f32_bf16 v51, s69, v113
 v_dot2c_f32_bf16 v52, s68, v114
 v_dot2c_f32_bf16 v53, s69, v114
 v_dot2c_f32_bf16 v54, s68, v115
 v_dot2c_f32_bf16 v55, s69, v115
 s_waitcnt vmcnt(5)
 v_lshlrev_b32 v56, 16, v116
 v_and_b32 v57, s93, v116
 v_lshlrev_b32 v58, 16, v117
 v_and_b32 v59, s93, v117
 v_lshlrev_b32 v60, 16, v118
 v_and_b32 v61, s93, v118
 v_lshlrev_b32 v62, 16, v119
 v_and_b32 v63, s93, v119
 s_waitcnt vmcnt(4)
 v_dot2c_f32_bf16 v56, s68, v120
 v_dot2c_f32_bf16 v57, s69, v120
 v_dot2c_f32_bf16 v58, s68, v121
 v_dot2c_f32_bf16 v59, s69, v121
 v_dot2c_f32_bf16 v60, s68, v122
 v_dot2c_f32_bf16 v61, s69, v122
 v_dot2c_f32_bf16 v62, s68, v123
 v_dot2c_f32_bf16 v63, s69, v123
 s_waitcnt vmcnt(3)
 v_dot2c_f32_bf16 v56, s68, v124
 v_dot2c_f32_bf16 v57, s69, v124
 v_dot2c_f32_bf16 v58, s68, v125
 v_dot2c_f32_bf16 v59, s69, v125
 v_dot2c_f32_bf16 v60, s68, v126
 v_dot2c_f32_bf16 v61, s69, v126
 v_dot2c_f32_bf16 v62, s68, v127
 v_dot2c_f32_bf16 v63, s69, v127
 s_waitcnt vmcnt(2)
 v_dot2c_f32_bf16 v56, s68, v128
 v_dot2c_f32_bf16 v57, s69, v128
 v_dot2c_f32_bf16 v58, s68, v129
 v_dot2c_f32_bf16 v59, s69, v129
 v_dot2c_f32_bf16 v60, s68, v130
 v_dot2c_f32_bf16 v61, s69, v130
 v_dot2c_f32_bf16 v62, s68, v131
 v_dot2c_f32_bf16 v63, s69, v131
 s_waitcnt vmcnt(1)
 v_dot2c_f32_bf16 v56, s68, v132
 v_dot2c_f32_bf16 v57, s69, v132
 v_dot2c_f32_bf16 v58, s68, v133
 v_dot2c_f32_bf16 v59, s69, v133
 v_dot2c_f32_bf16 v60, s68, v134
 v_dot2c_f32_bf16 v61, s69, v134
 v_dot2c_f32_bf16 v62, s68, v135
 v_dot2c_f32_bf16 v63, s69, v135
 s_waitcnt vmcnt(0)
 v_dot2c_f32_bf16 v56, s68, v136
 v_dot2c_f32_bf16 v57, s69, v136
 v_dot2c_f32_bf16 v58, s68, v137
 v_dot2c_f32_bf16 v59, s69, v137
 v_dot2c_f32_bf16 v60, s68, v138
 v_dot2c_f32_bf16 v61, s69, v138
 v_dot2c_f32_bf16 v62, s68, v139
 v_dot2c_f32_bf16 v63, s69, v139
 EX 64,56
 EX 65,57
 EX 66,58
 EX 67,59
 EX 68,60
 EX 69,61
 EX 70,62
 EX 71,63
 v_add_f32 v64, 1.0, v64
 v_add_f32 v65, 1.0, v65
 v_add_f32 v66, 1.0, v66
 v_add_f32 v67, 1.0, v67
 v_add_f32 v68, 1.0, v68
 v_add_f32 v69, 1.0, v69
 v_add_f32 v70, 1.0, v70
 v_add_f32 v71, 1.0, v71
 v_rcp_f32 v64, v64
 v_rcp_f32 v65, v65
 v_rcp_f32 v66, v66
 v_rcp_f32 v67, v67
 v_rcp_f32 v68, v68
 v_rcp_f32 v69, v69
 v_rcp_f32 v70, v70
 v_rcp_f32 v71, v71
 v_mul_f32 v56, 0xbf317218, v56
 v_mul_f32 v57, 0xbf317218, v57
 v_mul_f32 v58, 0xbf317218, v58
 v_mul_f32 v59, 0xbf317218, v59
 v_mul_f32 v60, 0xbf317218, v60
 v_mul_f32 v61, 0xbf317218, v61
 v_mul_f32 v62, 0xbf317218, v62
 v_mul_f32 v63, 0xbf317218, v63
 ML 56,56,64
 ML 57,57,65
 ML 58,58,66
 ML 59,59,67
 ML 60,60,68
 ML 61,61,69
 ML 62,62,70
 ML 63,63,71
 v_lshlrev_b32 v64, 16, v140
 v_and_b32 v65, s93, v140
 v_lshlrev_b32 v66, 16, v141
 v_and_b32 v67, s93, v141
 v_lshlrev_b32 v68, 16, v142
 v_and_b32 v69, s93, v142
 v_lshlrev_b32 v70, 16, v143
 v_and_b32 v71, s93, v143
 v_fma_f32 v64, v48, v56, v64
 v_fma_f32 v65, v49, v57, v65
 v_fma_f32 v66, v50, v58, v66
 v_fma_f32 v67, v51, v59, v67
 v_fma_f32 v68, v52, v60, v68
 v_fma_f32 v69, v53, v61, v69
 v_fma_f32 v70, v54, v62, v70
 v_fma_f32 v71, v55, v63, v71
 CV 140,64,65
 CV 141,66,67
 CV 142,68,69
 CV 143,70,71
 s_nop 0
 v_permlane16_swap_b32 v140, v142
 v_permlane16_swap_b32 v141, v143
 v_mov_b32 v64, v140
 v_mov_b32 v65, v141
 v_mov_b32_dpp v140, v142 row_ror:8 row_mask:0xf bank_mask:0xc
 v_mov_b32_dpp v141, v143 row_ror:8 row_mask:0xf bank_mask:0xc
 v_mov_b32_dpp v142, v64 row_ror:8 row_mask:0xf bank_mask:0x3
 v_mov_b32_dpp v143, v65 row_ror:8 row_mask:0xf bank_mask:0x3
 buffer_store_dwordx4 v[140:143], v28, s[48:51], s46 offen sc1
 v_mov_b32 v19, 0x10000000
 buffer_store_dword v19, v19, s[48:51], 0 offen
 s_bitset0_b64 s[74:75], s42
 s_min_u32 s92, s78, s79
 s_cmp_lt_u32 s44, s92
 s_cbranch_scc1 L_A_en3
 s_mov_b32 s81, s44
 s_mov_b32 s80, 3
 s_call_b64 s[66:67], L_A_sync
 s_cmp_eq_u32 s58, 0
 s_cbranch_scc0 L_A_fb
L_A_en3:
 s_mov_b32 s93, 0xffff0000
 buffer_load_dwordx2 v[140:141], v20, s[8:11], s60 offen
 buffer_load_dwordx2 v[142:143], v20, s[8:11], s60 offen offset:32
 s_add_u32 s92, s65, 0
 buffer_load_dwordx4 v[72:75], v25, s[36:39], s92 offen sc1
 s_add_u32 s92, s65, 0x240000
 buffer_load_dwordx4 v[76:79], v25, s[36:39], s92 offen sc1
 s_add_u32 s92, s65, 0x480000
 buffer_load_dwordx4 v[80:83], v25, s[36:39], s92 offen sc1
 s_add_u32 s92, s65, 0x6c0000
 buffer_load_dwordx4 v[84:87], v25, s[36:39], s92 offen sc1
 s_add_u32 s92, s65, 0x900000
 buffer_load_dwordx4 v[88:91], v25, s[36:39], s92 offen sc1
 s_add_u32 s92, s65, 0xb40000
 buffer_load_dwordx4 v[92:95], v25, s[36:39], s92 offen sc1
 s_add_u32 s92, s65, 0xd80000
 buffer_load_dwordx4 v[96:99], v25, s[36:39], s92 offen sc1
 s_add_u32 s92, s65, 0xfc0000
 buffer_load_dwordx4 v[100:103], v25, s[36:39], s92 offen sc1
 s_waitcnt vmcnt(7)
 v_lshlrev_b32 v48, 16, v72
 v_and_b32 v49, s93, v72
 v_lshlrev_b32 v50, 16, v73
 v_and_b32 v51, s93, v73
 v_lshlrev_b32 v52, 16, v74
 v_and_b32 v53, s93, v74
 v_lshlrev_b32 v54, 16, v75
 v_and_b32 v55, s93, v75
 s_add_u32 s92, s65, 0x1200000
 buffer_load_dwordx4 v[104:107], v25, s[36:39], s92 offen sc1
 s_waitcnt vmcnt(7)
 v_dot2c_f32_bf16 v48, s68, v76
 v_dot2c_f32_bf16 v49, s69, v76
 v_dot2c_f32_bf16 v50, s68, v77
 v_dot2c_f32_bf16 v51, s69, v77
 v_dot2c_f32_bf16 v52, s68, v78
 v_dot2c_f32_bf16 v53, s69, v78
 v_dot2c_f32_bf16 v54, s68, v79
 v_dot2c_f32_bf16 v55, s69, v79
 s_add_u32 s92, s65, 0x1440000
 buffer_load_dwordx4 v[108:111], v25, s[36:39], s92 offen sc1
 buffer_load_dword v31, v21, s[36:39], s77 offen sc1
 s_mov_b32 s93, 0xffff0000
 s_waitcnt vmcnt(8)
 v_dot2c_f32_bf16 v48, s68, v80
 v_dot2c_f32_bf16 v49, s69, v80
 v_dot2c_f32_bf16 v50, s68, v81
 v_dot2c_f32_bf16 v51, s69, v81
 v_dot2c_f32_bf16 v52, s68, v82
 v_dot2c_f32_bf16 v53, s69, v82
 v_dot2c_f32_bf16 v54, s68, v83
 v_dot2c_f32_bf16 v55, s69, v83
 s_add_u32 s92, s65, 0x1680000
 buffer_load_dwordx4 v[112:115], v25, s[36:39], s92 offen sc1
 s_waitcnt vmcnt(8)
 v_dot2c_f32_bf16 v48, s68, v84
 v_dot2c_f32_bf16 v49, s69, v84
 v_dot2c_f32_bf16 v50, s68, v85
 v_dot2c_f32_bf16 v51, s69, v85
 v_dot2c_f32_bf16 v52, s68, v86
 v_dot2c_f32_bf16 v53, s69, v86
 v_dot2c_f32_bf16 v54, s68, v87
 v_dot2c_f32_bf16 v55, s69, v87
 s_add_u32 s92, s65, 0x18c0000
 buffer_load_dwordx4 v[116:119], v25, s[36:39], s92 offen sc1
 s_waitcnt vmcnt(8)
 v_dot2c_f32_bf16 v48, s68, v88
 v_dot2c_f32_bf16 v49, s69, v88
 v_dot2c_f32_bf16 v50, s68, v89
 v_dot2c_f32_bf16 v51, s69, v89
 v_dot2c_f32_bf16 v52, s68, v90
 v_dot2c_f32_bf16 v53, s69, v90
 v_dot2c_f32_bf16 v54, s68, v91
 v_dot2c_f32_bf16 v55, s69, v91
 s_add_u32 s92, s65, 0x1b00000
 buffer_load_dwordx4 v[120:123], v25, s[36:39], s92 offen sc1
 s_waitcnt vmcnt(8)
 v_dot2c_f32_bf16 v48, s68, v92
 v_dot2c_f32_bf16 v49, s69, v92
 v_dot2c_f32_bf16 v50, s68, v93
 v_dot2c_f32_bf16 v51, s69, v93
 v_dot2c_f32_bf16 v52, s68, v94
 v_dot2c_f32_bf16 v53, s69, v94
 v_dot2c_f32_bf16 v54, s68, v95
 v_dot2c_f32_bf16 v55, s69, v95
 s_add_u32 s92, s65, 0x1d40000
 buffer_load_dwordx4 v[124:127], v25, s[36:39], s92 offen sc1
 s_waitcnt vmcnt(8)
 v_dot2c_f32_bf16 v48, s68, v96
 v_dot2c_f32_bf16 v49, s69, v96
 v_dot2c_f32_bf16 v50, s68, v97
 v_dot2c_f32_bf16 v51, s69, v97
 v_dot2c_f32_bf16 v52, s68, v98
 v_dot2c_f32_bf16 v53, s69, v98
 v_dot2c_f32_bf16 v54, s68, v99
 v_dot2c_f32_bf16 v55, s69, v99
 s_add_u32 s92, s65, 0x1f80000
 buffer_load_dwordx4 v[128:131], v25, s[36:39], s92 offen sc1
 s_waitcnt vmcnt(8)
 v_dot2c_f32_bf16 v48, s68, v100
 v_dot2c_f32_bf16 v49, s69, v100
 v_dot2c_f32_bf16 v50, s68, v101
 v_dot2c_f32_bf16 v51, s69, v101
 v_dot2c_f32_bf16 v52, s68, v102
 v_dot2c_f32_bf16 v53, s69, v102
 v_dot2c_f32_bf16 v54, s68, v103
 v_dot2c_f32_bf16 v55, s69, v103
 s_add_u32 s92, s65, 0x21c0000
 buffer_load_dwordx4 v[132:135], v25, s[36:39], s92 offen sc1
 s_waitcnt vmcnt(8)
 v_dot2c_f32_bf16 v48, s68, v104
 v_dot2c_f32_bf16 v49, s69, v104
 v_dot2c_f32_bf16 v50, s68, v105
 v_dot2c_f32_bf16 v51, s69, v105
 v_dot2c_f32_bf16 v52, s68, v106
 v_dot2c_f32_bf16 v53, s69, v106
 v_dot2c_f32_bf16 v54, s68, v107
 v_dot2c_f32_bf16 v55, s69, v107
 s_add_u32 s92, s65, 0x2400000
 buffer_load_dwordx4 v[136:139], v25, s[36:39], s92 offen sc1
 buffer_store_dword v29, v29, s[36:39], s76 offen sc1
 buffer_load_dword v16, v30, s[36:39], s76 offen sc1
 s_mov_b32 s93, 0xffff0000
 s_waitcnt vmcnt(10)
 v_dot2c_f32_bf16 v48, s68, v108
 v_dot2c_f32_bf16 v49, s69, v108
 v_dot2c_f32_bf16 v50, s68, v109
 v_dot2c_f32_bf16 v51, s69, v109
 v_dot2c_f32_bf16 v52, s68, v110
 v_dot2c_f32_bf16 v53, s69, v110
 v_dot2c_f32_bf16 v54, s68, v111
 v_dot2c_f32_bf16 v55, s69, v111
 s_waitcnt vmcnt(8)
 v_dot2c_f32_bf16 v48, s68, v112
 v_dot2c_f32_bf16 v49, s69, v112
 v_dot2c_f32_bf16 v50, s68, v113
 v_dot2c_f32_bf16 v51, s69, v113
 v_dot2c_f32_bf16 v52, s68, v114
 v_dot2c_f32_bf16 v53, s69, v114
 v_dot2c_f32_bf16 v54, s68, v115
 v_dot2c_f32_bf16 v55, s69, v115
 s_waitcnt vmcnt(7)
 v_lshlrev_b32 v56, 16, v116
 v_and_b32 v57, s93, v116
 v_lshlrev_b32 v58, 16, v117
 v_and_b32 v59, s93, v117
 v_lshlrev_b32 v60, 16, v118
 v_and_b32 v61, s93, v118
 v_lshlrev_b32 v62, 16, v119
 v_and_b32 v63, s93, v119
 s_waitcnt vmcnt(6)
 v_dot2c_f32_bf16 v56, s68, v120
 v_dot2c_f32_bf16 v57, s69, v120
 v_dot2c_f32_bf16 v58, s68, v121
 v_dot2c_f32_bf16 v59, s69, v121
 v_dot2c_f32_bf16 v60, s68, v122
 v_dot2c_f32_bf16 v61, s69, v122
 v_dot2c_f32_bf16 v62, s68, v123
 v_dot2c_f32_bf16 v63, s69, v123
 s_waitcnt vmcnt(5)
 v_dot2c_f32_bf16 v56, s68, v124
 v_dot2c_f32_bf16 v57, s69, v124
 v_dot2c_f32_bf16 v58, s68, v125
 v_dot2c_f32_bf16 v59, s69, v125
 v_dot2c_f32_bf16 v60, s68, v126
 v_dot2c_f32_bf16 v61, s69, v126
 v_dot2c_f32_bf16 v62, s68, v127
 v_dot2c_f32_bf16 v63, s69, v127
 s_waitcnt vmcnt(4)
 v_dot2c_f32_bf16 v56, s68, v128
 v_dot2c_f32_bf16 v57, s69, v128
 v_dot2c_f32_bf16 v58, s68, v129
 v_dot2c_f32_bf16 v59, s69, v129
 v_dot2c_f32_bf16 v60, s68, v130
 v_dot2c_f32_bf16 v61, s69, v130
 v_dot2c_f32_bf16 v62, s68, v131
 v_dot2c_f32_bf16 v63, s69, v131
 s_waitcnt vmcnt(3)
 v_dot2c_f32_bf16 v56, s68, v132
 v_dot2c_f32_bf16 v57, s69, v132
 v_dot2c_f32_bf16 v58, s68, v133
 v_dot2c_f32_bf16 v59, s69, v133
 v_dot2c_f32_bf16 v60, s68, v134
 v_dot2c_f32_bf16 v61, s69, v134
 v_dot2c_f32_bf16 v62, s68, v135
 v_dot2c_f32_bf16 v63, s69, v135
 s_waitcnt vmcnt(2)
 v_dot2c_f32_bf16 v56, s68, v136
 v_dot2c_f32_bf16 v57, s69, v136
 v_dot2c_f32_bf16 v58, s68, v137
 v_dot2c_f32_bf16 v59, s69, v137
 v_dot2c_f32_bf16 v60, s68, v138
 v_dot2c_f32_bf16 v61, s69, v138
 v_dot2c_f32_bf16 v62, s68, v139
 v_dot2c_f32_bf16 v63, s69, v139
 EX 64,56
 EX 65,57
 EX 66,58
 EX 67,59
 EX 68,60
 EX 69,61
 EX 70,62
 EX 71,63
 v_add_f32 v64, 1.0, v64
 v_add_f32 v65, 1.0, v65
 v_add_f32 v66, 1.0, v66
 v_add_f32 v67, 1.0, v67
 v_add_f32 v68, 1.0, v68
 v_add_f32 v69, 1.0, v69
 v_add_f32 v70, 1.0, v70
 v_add_f32 v71, 1.0, v71
 v_rcp_f32 v64, v64
 v_rcp_f32 v65, v65
 v_rcp_f32 v66, v66
 v_rcp_f32 v67, v67
 v_rcp_f32 v68, v68
 v_rcp_f32 v69, v69
 v_rcp_f32 v70, v70
 v_rcp_f32 v71, v71
 v_mul_f32 v56, 0xbf317218, v56
 v_mul_f32 v57, 0xbf317218, v57
 v_mul_f32 v58, 0xbf317218, v58
 v_mul_f32 v59, 0xbf317218, v59
 v_mul_f32 v60, 0xbf317218, v60
 v_mul_f32 v61, 0xbf317218, v61
 v_mul_f32 v62, 0xbf317218, v62
 v_mul_f32 v63, 0xbf317218, v63
 ML 56,56,64
 ML 57,57,65
 ML 58,58,66
 ML 59,59,67
 ML 60,60,68
 ML 61,61,69
 ML 62,62,70
 ML 63,63,71
 v_lshlrev_b32 v64, 16, v140
 v_and_b32 v65, s93, v140
 v_lshlrev_b32 v66, 16, v141
 v_and_b32 v67, s93, v141
 v_lshlrev_b32 v68, 16, v142
 v_and_b32 v69, s93, v142
 v_lshlrev_b32 v70, 16, v143
 v_and_b32 v71, s93, v143
 v_fma_f32 v64, v48, v56, v64
 v_fma_f32 v65, v49, v57, v65
 v_fma_f32 v66, v50, v58, v66
 v_fma_f32 v67, v51, v59, v67
 v_fma_f32 v68, v52, v60, v68
 v_fma_f32 v69, v53, v61, v69
 v_fma_f32 v70, v54, v62, v70
 v_fma_f32 v71, v55, v63, v71
 CV 140,64,65
 CV 141,66,67
 CV 142,68,69
 CV 143,70,71
 s_nop 0
 v_permlane16_swap_b32 v140, v142
 v_permlane16_swap_b32 v141, v143
 v_mov_b32 v64, v140
 v_mov_b32 v65, v141
 v_mov_b32_dpp v140, v142 row_ror:8 row_mask:0xf bank_mask:0xc
 v_mov_b32_dpp v141, v143 row_ror:8 row_mask:0xf bank_mask:0xc
 v_mov_b32_dpp v142, v64 row_ror:8 row_mask:0xf bank_mask:0x3
 v_mov_b32_dpp v143, v65 row_ror:8 row_mask:0xf bank_mask:0x3
 buffer_store_dwordx4 v[140:143], v28, s[48:51], s60 offen sc1
 v_mov_b32 v19, 0x10000000
 buffer_store_dword v19, v19, s[48:51], 0 offen
 s_bitset0_b64 s[74:75], s44
L_A_j:
 s_bitset0_b64 s[74:75], s42
 s_bitset0_b64 s[74:75], s44
 s_cmp_gt_u32 s83, 35
 s_cbranch_scc1 L_A_nm
 s_cmp_eq_u32 s62, 0
 s_cbranch_scc0 L_A_rf4
 s_waitcnt vmcnt(2)
 v_cmp_ne_u32 vcc, 0, v16
 s_nop 1
 s_lshr_b64 s[72:73], vcc, 18
 s_and_b32 s73, s73, 15
 s_mov_b32 s78, 0
 s_mov_b32 s79, 0
 v_cmp_ge_u32 vcc, 0, v16
 s_nop 1
 s_and_b32 s92, vcc_lo, 0x7ff
 s_cselect_b32 s78, s78, 4
 s_and_b32 s92, vcc_lo, 0x1f800
 s_cselect_b32 s79, s79, 4
 v_cmp_ge_u32 vcc, 1, v16
 s_nop 1
 s_and_b32 s92, vcc_lo, 0x7ff
 s_cselect_b32 s78, s78, 8
 s_and_b32 s92, vcc_lo, 0x1f800
 s_cselect_b32 s79, s79, 8
 v_cmp_ge_u32 vcc, 2, v16
 s_nop 1
 s_and_b32 s92, vcc_lo, 0x7ff
 s_cselect_b32 s78, s78, 12
 s_and_b32 s92, vcc_lo, 0x1f800
 s_cselect_b32 s79, s79, 12
 v_cmp_ge_u32 vcc, 3, v16
 s_nop 1
 s_and_b32 s92, vcc_lo, 0x7ff
 s_cselect_b32 s78, s78, 16
 s_and_b32 s92, vcc_lo, 0x1f800
 s_cselect_b32 s79, s79, 16
 v_cmp_ge_u32 vcc, 4, v16
 s_nop 1
 s_and_b32 s92, vcc_lo, 0x7ff
 s_cselect_b32 s78, s78, 20
 s_and_b32 s92, vcc_lo, 0x1f800
 s_cselect_b32 s79, s79, 20
 v_cmp_ge_u32 vcc, 5, v16
 s_nop 1
 s_and_b32 s92, vcc_lo, 0x7ff
 s_cselect_b32 s78, s78, 24
 s_and_b32 s92, vcc_lo, 0x1f800
 s_cselect_b32 s79, s79, 24
 v_cmp_ge_u32 vcc, 6, v16
 s_nop 1
 s_and_b32 s92, vcc_lo, 0x7ff
 s_cselect_b32 s78, s78, 28
 s_and_b32 s92, vcc_lo, 0x1f800
 s_cselect_b32 s79, s79, 28
 v_cmp_ge_u32 vcc, 7, v16
 s_nop 1
 s_and_b32 s92, vcc_lo, 0x7ff
 s_cselect_b32 s78, s78, 32
 s_and_b32 s92, vcc_lo, 0x1f800
 s_cselect_b32 s79, s79, 32
 v_cmp_ge_u32 vcc, 8, v16
 s_nop 1
 s_and_b32 s92, vcc_lo, 0x7ff
 s_cselect_b32 s78, s78, 36
 s_and_b32 s92, vcc_lo, 0x1f800
 s_cselect_b32 s79, s79, 36
 s_lshl_b32 s92, s79, 8
 s_or_b32 s92, s92, s78
 s_lshl_b32 s93, s58, 16
 s_or_b32 s92, s92, s93
 v_mov_b32 v24, s92
 v_mov_b32 v23, s41
 ds_write_b32 v23, v24
 WL 0
L_A_rf4:
 s_barrier
 v_mov_b32 v23, s41
 ds_read_b32 v24, v23
 WL 0
 v_readfirstlane_b32 s92, v24
 s_nop 1
 s_and_b32 s78, s92, 0xff
 s_bfe_u32 s79, s92, 0x80008
 s_lshr_b32 s58, s92, 16
 s_xor_b32 s41, s41, 12
 s_min_u32 s92, s78, s79
 s_cmp_lt_u32 s83, s92
 s_cbranch_scc1 L_A_en5
 s_mov_b32 s81, s83
 s_mov_b32 s80, 3
 s_call_b64 s[66:67], L_A_sync
 s_cmp_eq_u32 s58, 0
 s_cbranch_scc0 L_A_fb
L_A_en5:
 s_and_b32 s92, s83, 3
 s_lshr_b32 s80, s83, 2
 s_lshl_b32 s93, s64, 2
 s_add_u32 s92, s92, s93
 s_mul_i32 s47, s92, 0x9000
 s_add_u32 s46, s47, s59
 s_lshl_b32 s93, s80, 12
 s_add_u32 s93, s93, s3
 s_add_u32 s47, s47, s93
 s_lshl_b32 s93, s80, 7
 s_add_u32 s46, s46, s93
 s_mov_b32 s93, 0xffff0000
 buffer_load_dwordx2 v[212:213], v20, s[8:11], s46 offen
 buffer_load_dwordx2 v[214:215], v20, s[8:11], s46 offen offset:32
 s_add_u32 s92, s47, 0
 buffer_load_dwordx4 v[144:147], v25, s[36:39], s92 offen sc1
 s_add_u32 s92, s47, 0x240000
 buffer_load_dwordx4 v[148:151], v25, s[36:39], s92 offen sc1
 s_add_u32 s92, s47, 0x480000
 buffer_load_dwordx4 v[152:155], v25, s[36:39], s92 offen sc1
 s_add_u32 s92, s47, 0x6c0000
 buffer_load_dwordx4 v[156:159], v25, s[36:39], s92 offen sc1
 s_add_u32 s92, s47, 0x900000
 buffer_load_dwordx4 v[160:163], v25, s[36:39], s92 offen sc1
 s_add_u32 s92, s47, 0xb40000
 buffer_load_dwordx4 v[164:167], v25, s[36:39], s92 offen sc1
 s_add_u32 s92, s47, 0xd80000
 buffer_load_dwordx4 v[168:171], v25, s[36:39], s92 offen sc1
 s_add_u32 s92, s47, 0xfc0000
 buffer_load_dwordx4 v[172:175], v25, s[36:39], s92 offen sc1
 s_waitcnt vmcnt(7)
 v_lshlrev_b32 v48, 16, v144
 v_and_b32 v49, s93, v144
 v_lshlrev_b32 v50, 16, v145
 v_and_b32 v51, s93, v145
 v_lshlrev_b32 v52, 16, v146
 v_and_b32 v53, s93, v146
 v_lshlrev_b32 v54, 16, v147
 v_and_b32 v55, s93, v147
 s_add_u32 s92, s47, 0x1200000
 buffer_load_dwordx4 v[176:179], v25, s[36:39], s92 offen sc1
 s_waitcnt vmcnt(7)
 v_dot2c_f32_bf16 v48, s68, v148
 v_dot2c_f32_bf16 v49, s69, v148
 v_dot2c_f32_bf16 v50, s68, v149
 v_dot2c_f32_bf16 v51, s69, v149
 v_dot2c_f32_bf16 v52, s68, v150
 v_dot2c_f32_bf16 v53, s69, v150
 v_dot2c_f32_bf16 v54, s68, v151
 v_dot2c_f32_bf16 v55, s69, v151
 s_add_u32 s92, s47, 0x1440000
 buffer_load_dwordx4 v[180:183], v25, s[36:39], s92 offen sc1
 s_waitcnt vmcnt(7)
 v_dot2c_f32_bf16 v48, s68, v152
 v_dot2c_f32_bf16 v49, s69, v152
 v_dot2c_f32_bf16 v50, s68, v153
 v_dot2c_f32_bf16 v51, s69, v153
 v_dot2c_f32_bf16 v52, s68, v154
 v_dot2c_f32_bf16 v53, s69, v154
 v_dot2c_f32_bf16 v54, s68, v155
 v_dot2c_f32_bf16 v55, s69, v155
 s_add_u32 s92, s47, 0x1680000
 buffer_load_dwordx4 v[184:187], v25, s[36:39], s92 offen sc1
 s_waitcnt vmcnt(7)
 v_dot2c_f32_bf16 v48, s68, v156
 v_dot2c_f32_bf16 v49, s69, v156
 v_dot2c_f32_bf16 v50, s68, v157
 v_dot2c_f32_bf16 v51, s69, v157
 v_dot2c_f32_bf16 v52, s68, v158
 v_dot2c_f32_bf16 v53, s69, v158
 v_dot2c_f32_bf16 v54, s68, v159
 v_dot2c_f32_bf16 v55, s69, v159
 s_add_u32 s92, s47, 0x18c0000
 buffer_load_dwordx4 v[188:191], v25, s[36:39], s92 offen sc1
 s_waitcnt vmcnt(7)
 v_dot2c_f32_bf16 v48, s68, v160
 v_dot2c_f32_bf16 v49, s69, v160
 v_dot2c_f32_bf16 v50, s68, v161
 v_dot2c_f32_bf16 v51, s69, v161
 v_dot2c_f32_bf16 v52, s68, v162
 v_dot2c_f32_bf16 v53, s69, v162
 v_dot2c_f32_bf16 v54, s68, v163
 v_dot2c_f32_bf16 v55, s69, v163
 s_add_u32 s92, s47, 0x1b00000
 buffer_load_dwordx4 v[192:195], v25, s[36:39], s92 offen sc1
 s_waitcnt vmcnt(7)
 v_dot2c_f32_bf16 v48, s68, v164
 v_dot2c_f32_bf16 v49, s69, v164
 v_dot2c_f32_bf16 v50, s68, v165
 v_dot2c_f32_bf16 v51, s69, v165
 v_dot2c_f32_bf16 v52, s68, v166
 v_dot2c_f32_bf16 v53, s69, v166
 v_dot2c_f32_bf16 v54, s68, v167
 v_dot2c_f32_bf16 v55, s69, v167
 s_add_u32 s92, s47, 0x1d40000
 buffer_load_dwordx4 v[196:199], v25, s[36:39], s92 offen sc1
 s_waitcnt vmcnt(7)
 v_dot2c_f32_bf16 v48, s68, v168
 v_dot2c_f32_bf16 v49, s69, v168
 v_dot2c_f32_bf16 v50, s68, v169
 v_dot2c_f32_bf16 v51, s69, v169
 v_dot2c_f32_bf16 v52, s68, v170
 v_dot2c_f32_bf16 v53, s69, v170
 v_dot2c_f32_bf16 v54, s68, v171
 v_dot2c_f32_bf16 v55, s69, v171
 s_add_u32 s92, s47, 0x1f80000
 buffer_load_dwordx4 v[200:203], v25, s[36:39], s92 offen sc1
 s_waitcnt vmcnt(7)
 v_dot2c_f32_bf16 v48, s68, v172
 v_dot2c_f32_bf16 v49, s69, v172
 v_dot2c_f32_bf16 v50, s68, v173
 v_dot2c_f32_bf16 v51, s69, v173
 v_dot2c_f32_bf16 v52, s68, v174
 v_dot2c_f32_bf16 v53, s69, v174
 v_dot2c_f32_bf16 v54, s68, v175
 v_dot2c_f32_bf16 v55, s69, v175
 s_add_u32 s92, s47, 0x21c0000
 buffer_load_dwordx4 v[204:207], v25, s[36:39], s92 offen sc1
 s_waitcnt vmcnt(7)
 v_dot2c_f32_bf16 v48, s68, v176
 v_dot2c_f32_bf16 v49, s69, v176
 v_dot2c_f32_bf16 v50, s68, v177
 v_dot2c_f32_bf16 v51, s69, v177
 v_dot2c_f32_bf16 v52, s68, v178
 v_dot2c_f32_bf16 v53, s69, v178
 v_dot2c_f32_bf16 v54, s68, v179
 v_dot2c_f32_bf16 v55, s69, v179
 s_add_u32 s92, s47, 0x2400000
 buffer_load_dwordx4 v[208:211], v25, s[36:39], s92 offen sc1
 s_waitcnt vmcnt(7)
 v_dot2c_f32_bf16 v48, s68, v180
 v_dot2c_f32_bf16 v49, s69, v180
 v_dot2c_f32_bf16 v50, s68, v181
 v_dot2c_f32_bf16 v51, s69, v181
 v_dot2c_f32_bf16 v52, s68, v182
 v_dot2c_f32_bf16 v53, s69, v182
 v_dot2c_f32_bf16 v54, s68, v183
 v_dot2c_f32_bf16 v55, s69, v183
 s_waitcnt vmcnt(6)
 v_dot2c_f32_bf16 v48, s68, v184
 v_dot2c_f32_bf16 v49, s69, v184
 v_dot2c_f32_bf16 v50, s68, v185
 v_dot2c_f32_bf16 v51, s69, v185
 v_dot2c_f32_bf16 v52, s68, v186
 v_dot2c_f32_bf16 v53, s69, v186
 v_dot2c_f32_bf16 v54, s68, v187
 v_dot2c_f32_bf16 v55, s69, v187
 buffer_store_dword v29, v29, s[36:39], s76 offen sc1
 buffer_load_dword v16, v30, s[36:39], s76 offen sc1
 s_mov_b32 s93, 0xffff0000
 s_waitcnt vmcnt(7)
 v_lshlrev_b32 v56, 16, v188
 v_and_b32 v57, s93, v188
 v_lshlrev_b32 v58, 16, v189
 v_and_b32 v59, s93, v189
 v_lshlrev_b32 v60, 16, v190
 v_and_b32 v61, s93, v190
 v_lshlrev_b32 v62, 16, v191
 v_and_b32 v63, s93, v191
 s_waitcnt vmcnt(6)
 v_dot2c_f32_bf16 v56, s68, v192
 v_dot2c_f32_bf16 v57, s69, v192
 v_dot2c_f32_bf16 v58, s68, v193
 v_dot2c_f32_bf16 v59, s69, v193
 v_dot2c_f32_bf16 v60, s68, v194
 v_dot2c_f32_bf16 v61, s69, v194
 v_dot2c_f32_bf16 v62, s68, v195
 v_dot2c_f32_bf16 v63, s69, v195
 s_waitcnt vmcnt(5)
 v_dot2c_f32_bf16 v56, s68, v196
 v_dot2c_f32_bf16 v57, s69, v196
 v_dot2c_f32_bf16 v58, s68, v197
 v_dot2c_f32_bf16 v59, s69, v197
 v_dot2c_f32_bf16 v60, s68, v198
 v_dot2c_f32_bf16 v61, s69, v198
 v_dot2c_f32_bf16 v62, s68, v199
 v_dot2c_f32_bf16 v63, s69, v199
 s_waitcnt vmcnt(4)
 v_dot2c_f32_bf16 v56, s68, v200
 v_dot2c_f32_bf16 v57, s69, v200
 v_dot2c_f32_bf16 v58, s68, v201
 v_dot2c_f32_bf16 v59, s69, v201
 v_dot2c_f32_bf16 v60, s68, v202
 v_dot2c_f32_bf16 v61, s69, v202
 v_dot2c_f32_bf16 v62, s68, v203
 v_dot2c_f32_bf16 v63, s69, v203
 s_waitcnt vmcnt(3)
 v_dot2c_f32_bf16 v56, s68, v204
 v_dot2c_f32_bf16 v57, s69, v204
 v_dot2c_f32_bf16 v58, s68, v205
 v_dot2c_f32_bf16 v59, s69, v205
 v_dot2c_f32_bf16 v60, s68, v206
 v_dot2c_f32_bf16 v61, s69, v206
 v_dot2c_f32_bf16 v62, s68, v207
 v_dot2c_f32_bf16 v63, s69, v207
 s_waitcnt vmcnt(2)
 v_dot2c_f32_bf16 v56, s68, v208
 v_dot2c_f32_bf16 v57, s69, v208
 v_dot2c_f32_bf16 v58, s68, v209
 v_dot2c_f32_bf16 v59, s69, v209
 v_dot2c_f32_bf16 v60, s68, v210
 v_dot2c_f32_bf16 v61, s69, v210
 v_dot2c_f32_bf16 v62, s68, v211
 v_dot2c_f32_bf16 v63, s69, v211
 EX 64,56
 EX 65,57
 EX 66,58
 EX 67,59
 EX 68,60
 EX 69,61
 EX 70,62
 EX 71,63
 v_add_f32 v64, 1.0, v64
 v_add_f32 v65, 1.0, v65
 v_add_f32 v66, 1.0, v66
 v_add_f32 v67, 1.0, v67
 v_add_f32 v68, 1.0, v68
 v_add_f32 v69, 1.0, v69
 v_add_f32 v70, 1.0, v70
 v_add_f32 v71, 1.0, v71
 v_rcp_f32 v64, v64
 v_rcp_f32 v65, v65
 v_rcp_f32 v66, v66
 v_rcp_f32 v67, v67
 v_rcp_f32 v68, v68
 v_rcp_f32 v69, v69
 v_rcp_f32 v70, v70
 v_rcp_f32 v71, v71
 v_mul_f32 v56, 0xbf317218, v56
 v_mul_f32 v57, 0xbf317218, v57
 v_mul_f32 v58, 0xbf317218, v58
 v_mul_f32 v59, 0xbf317218, v59
 v_mul_f32 v60, 0xbf317218, v60
 v_mul_f32 v61, 0xbf317218, v61
 v_mul_f32 v62, 0xbf317218, v62
 v_mul_f32 v63, 0xbf317218, v63
 ML 56,56,64
 ML 57,57,65
 ML 58,58,66
 ML 59,59,67
 ML 60,60,68
 ML 61,61,69
 ML 62,62,70
 ML 63,63,71
 v_lshlrev_b32 v64, 16, v212
 v_and_b32 v65, s93, v212
 v_lshlrev_b32 v66, 16, v213
 v_and_b32 v67, s93, v213
 v_lshlrev_b32 v68, 16, v214
 v_and_b32 v69, s93, v214
 v_lshlrev_b32 v70, 16, v215
 v_and_b32 v71, s93, v215
 v_fma_f32 v64, v48, v56, v64
 v_fma_f32 v65, v49, v57, v65
 v_fma_f32 v66, v50, v58, v66
 v_fma_f32 v67, v51, v59, v67
 v_fma_f32 v68, v52, v60, v68
 v_fma_f32 v69, v53, v61, v69
 v_fma_f32 v70, v54, v62, v70
 v_fma_f32 v71, v55, v63, v71
 CV 212,64,65
 CV 213,66,67
 CV 214,68,69
 CV 215,70,71
 s_nop 0
 v_permlane16_swap_b32 v212, v214
 v_permlane16_swap_b32 v213, v215
 v_mov_b32 v64, v212
 v_mov_b32 v65, v213
 v_mov_b32_dpp v212, v214 row_ror:8 row_mask:0xf bank_mask:0xc
 v_mov_b32_dpp v213, v215 row_ror:8 row_mask:0xf bank_mask:0xc
 v_mov_b32_dpp v214, v64 row_ror:8 row_mask:0xf bank_mask:0x3
 v_mov_b32_dpp v215, v65 row_ror:8 row_mask:0xf bank_mask:0x3
 buffer_store_dwordx4 v[212:215], v28, s[48:51], s46 offen sc1
 v_mov_b32 v19, 0x10000000
 buffer_store_dword v19, v19, s[48:51], 0 offen
 s_bitset0_b64 s[74:75], s83
L_A_nm:
 s_cmp_eq_u32 s62, 0
 s_cbranch_scc0 L_A_rf6
 s_waitcnt vmcnt(2)
 v_cmp_ne_u32 vcc, 0, v16
 s_nop 1
 s_lshr_b64 s[72:73], vcc, 18
 s_and_b32 s73, s73, 15
 s_mov_b32 s78, 0
 s_mov_b32 s79, 0
 v_cmp_ge_u32 vcc, 0, v16
 s_nop 1
 s_and_b32 s92, vcc_lo, 0x7ff
 s_cselect_b32 s78, s78, 4
 s_and_b32 s92, vcc_lo, 0x1f800
 s_cselect_b32 s79, s79, 4
 v_cmp_ge_u32 vcc, 1, v16
 s_nop 1
 s_and_b32 s92, vcc_lo, 0x7ff
 s_cselect_b32 s78, s78, 8
 s_and_b32 s92, vcc_lo, 0x1f800
 s_cselect_b32 s79, s79, 8
 v_cmp_ge_u32 vcc, 2, v16
 s_nop 1
 s_and_b32 s92, vcc_lo, 0x7ff
 s_cselect_b32 s78, s78, 12
 s_and_b32 s92, vcc_lo, 0x1f800
 s_cselect_b32 s79, s79, 12
 v_cmp_ge_u32 vcc, 3, v16
 s_nop 1
 s_and_b32 s92, vcc_lo, 0x7ff
 s_cselect_b32 s78, s78, 16
 s_and_b32 s92, vcc_lo, 0x1f800
 s_cselect_b32 s79, s79, 16
 v_cmp_ge_u32 vcc, 4, v16
 s_nop 1
 s_and_b32 s92, vcc_lo, 0x7ff
 s_cselect_b32 s78, s78, 20
 s_and_b32 s92, vcc_lo, 0x1f800
 s_cselect_b32 s79, s79, 20
 v_cmp_ge_u32 vcc, 5, v16
 s_nop 1
 s_and_b32 s92, vcc_lo, 0x7ff
 s_cselect_b32 s78, s78, 24
 s_and_b32 s92, vcc_lo, 0x1f800
 s_cselect_b32 s79, s79, 24
 v_cmp_ge_u32 vcc, 6, v16
 s_nop 1
 s_and_b32 s92, vcc_lo, 0x7ff
 s_cselect_b32 s78, s78, 28
 s_and_b32 s92, vcc_lo, 0x1f800
 s_cselect_b32 s79, s79, 28
 v_cmp_ge_u32 vcc, 7, v16
 s_nop 1
 s_and_b32 s92, vcc_lo, 0x7ff
 s_cselect_b32 s78, s78, 32
 s_and_b32 s92, vcc_lo, 0x1f800
 s_cselect_b32 s79, s79, 32
 v_cmp_ge_u32 vcc, 8, v16
 s_nop 1
 s_and_b32 s92, vcc_lo, 0x7ff
 s_cselect_b32 s78, s78, 36
 s_and_b32 s92, vcc_lo, 0x1f800
 s_cselect_b32 s79, s79, 36
 v_cmp_ne_u32 vcc, 0, v31
 s_nop 1
 s_mov_b32 s72, vcc_lo
 s_and_b32 s73, vcc_hi, 15
 s_or_b32 s92, s72, s73
 s_cselect_b32 s58, 1, 0
 s_lshl_b32 s92, s79, 8
 s_or_b32 s92, s92, s78
 s_lshl_b32 s93, s58, 16
 s_or_b32 s92, s92, s93
 v_mov_b32 v24, s92
 v_mov_b32 v23, s41
 ds_write_b32 v23, v24
 WL 0
L_A_rf6:
 s_barrier
 v_mov_b32 v23, s41
 ds_read_b32 v24, v23
 WL 0
 v_readfirstlane_b32 s92, v24
 s_nop 1
 s_and_b32 s78, s92, 0xff
 s_bfe_u32 s79, s92, 0x80008
 s_lshr_b32 s58, s92, 16
 s_xor_b32 s41, s41, 12
 s_mov_b32 s84, s58
 s_mov_b32 s58, 0
 s_cmp_eq_u32 s84, 0
 s_cbranch_scc0 L_A_old
 v_min_u32 v242, 0x110, v0
 v_lshrrev_b32 v242, 2, v242
 v_mov_b32 v243, 0x10000000
 s_mov_b32 s92, 0x44
 v_writelane_b32 v243, s92, 0
 s_lshr_b32 s80, s45, 2
 s_min_u32 s92, s78, s79
 s_cmp_lt_u32 s45, s92
 s_cbranch_scc1 L_A_f3
 s_cmp_lt_u32 s45, s78
 s_cbranch_scc1 L_A_ps
 s_mov_b32 s71, 0
L_A_ws0:
 buffer_load_dword v16, v242, s[36:39], s76 offen sc1
 s_and_b32 s92, s71, 3
 s_mul_i32 s93, s62, 1
 s_cmp_eq_u32 s92, s93
 s_cbranch_scc0 L_A_ws1
 buffer_store_dword v243, v243, s[36:39], s76 offen sc1
 s_waitcnt vmcnt(1)
 s_branch L_A_ws2
L_A_ws1:
 s_waitcnt vmcnt(0)
L_A_ws2:
 v_cmp_ge_u32 vcc, s80, v16
 s_nop 1
 s_and_b32 s81, vcc_lo, 0x1f800
 s_and_b32 s92, vcc_lo, 0x7ff
 s_cbranch_scc0 L_A_ws3
 s_add_u32 s71, s71, 1
 s_cmp_gt_u32 s71, 0x3e80
 s_cbranch_scc1 L_A_ws4
 s_sleep 2
 s_branch L_A_ws0
L_A_ws4:
 v_lshlrev_b32 v19, 4, v0
 v_mov_b32 v24, 0x10000000
 v_mov_b32 v18, 1
 v_cmp_gt_u32 vcc, 0x100, v0
 s_nop 1
 v_cndmask_b32 v19, v24, v19, vcc
 s_lshl2_add_u32 s92, s45, s82
 s_add_u32 s92, s92, 0x1000
 buffer_store_dword v18, v19, s[36:39], s92 offen sc1
 s_waitcnt vmcnt(0)
 buffer_store_dword v243, v243, s[36:39], s76 offen sc1
 s_waitcnt vmcnt(0)
 buffer_load_dword v16, v242, s[36:39], s76 offen sc1
 s_waitcnt vmcnt(0)
 v_cmp_ge_u32 vcc, s80, v16
 s_nop 1
 s_and_b32 s81, vcc_lo, 0x1f800
 s_and_b32 s92, vcc_lo, 0x1ffff
 s_cbranch_scc1 L_A_exit
L_A_ws3:
 s_cmp_eq_u32 s81, 0
 s_cbranch_scc1 L_A_f3
L_A_ps:
 s_mov_b32 s93, 0xffff0000
 buffer_load_dwordx2 v[140:141], v20, s[8:11], s61 offen
 buffer_load_dwordx2 v[142:143], v20, s[8:11], s61 offen offset:32
 s_add_u32 s92, s70, 0
 buffer_load_dwordx4 v[72:75], v25, s[36:39], s92 offen sc1
 s_add_u32 s92, s70, 0x240000
 buffer_load_dwordx4 v[76:79], v25, s[36:39], s92 offen sc1
 s_add_u32 s92, s70, 0x480000
 buffer_load_dwordx4 v[80:83], v25, s[36:39], s92 offen sc1
 s_add_u32 s92, s70, 0x6c0000
 buffer_load_dwordx4 v[84:87], v25, s[36:39], s92 offen sc1
 s_add_u32 s92, s70, 0x900000
 buffer_load_dwordx4 v[88:91], v25, s[36:39], s92 offen sc1
 s_add_u32 s92, s70, 0xb40000
 buffer_load_dwordx4 v[92:95], v25, s[36:39], s92 offen sc1
 s_add_u32 s92, s70, 0xd80000
 buffer_load_dwordx4 v[96:99], v25, s[36:39], s92 offen sc1
 s_add_u32 s92, s70, 0xfc0000
 buffer_load_dwordx4 v[100:103], v25, s[36:39], s92 offen sc1
 s_waitcnt vmcnt(7)
 v_lshlrev_b32 v48, 16, v72
 v_and_b32 v49, s93, v72
 v_lshlrev_b32 v50, 16, v73
 v_and_b32 v51, s93, v73
 v_lshlrev_b32 v52, 16, v74
 v_and_b32 v53, s93, v74
 v_lshlrev_b32 v54, 16, v75
 v_and_b32 v55, s93, v75
 s_add_u32 s92, s70, 0x1200000
 buffer_load_dwordx4 v[104:107], v25, s[36:39], s92 offen sc1
 s_waitcnt vmcnt(7)
 v_dot2c_f32_bf16 v48, s68, v76
 v_dot2c_f32_bf16 v49, s69, v76
 v_dot2c_f32_bf16 v50, s68, v77
 v_dot2c_f32_bf16 v51, s69, v77
 v_dot2c_f32_bf16 v52, s68, v78
 v_dot2c_f32_bf16 v53, s69, v78
 v_dot2c_f32_bf16 v54, s68, v79
 v_dot2c_f32_bf16 v55, s69, v79
 s_add_u32 s92, s70, 0x1440000
 buffer_load_dwordx4 v[108:111], v25, s[36:39], s92 offen sc1
 s_waitcnt vmcnt(7)
 v_dot2c_f32_bf16 v48, s68, v80
 v_dot2c_f32_bf16 v49, s69, v80
 v_dot2c_f32_bf16 v50, s68, v81
 v_dot2c_f32_bf16 v51, s69, v81
 v_dot2c_f32_bf16 v52, s68, v82
 v_dot2c_f32_bf16 v53, s69, v82
 v_dot2c_f32_bf16 v54, s68, v83
 v_dot2c_f32_bf16 v55, s69, v83
 s_add_u32 s92, s70, 0x1680000
 buffer_load_dwordx4 v[112:115], v25, s[36:39], s92 offen sc1
 buffer_store_dword v243, v243, s[36:39], s76 offen sc1
 s_mov_b32 s93, 0xffff0000
 s_waitcnt vmcnt(8)
 v_dot2c_f32_bf16 v48, s68, v84
 v_dot2c_f32_bf16 v49, s69, v84
 v_dot2c_f32_bf16 v50, s68, v85
 v_dot2c_f32_bf16 v51, s69, v85
 v_dot2c_f32_bf16 v52, s68, v86
 v_dot2c_f32_bf16 v53, s69, v86
 v_dot2c_f32_bf16 v54, s68, v87
 v_dot2c_f32_bf16 v55, s69, v87
 s_waitcnt vmcnt(7)
 v_dot2c_f32_bf16 v48, s68, v88
 v_dot2c_f32_bf16 v49, s69, v88
 v_dot2c_f32_bf16 v50, s68, v89
 v_dot2c_f32_bf16 v51, s69, v89
 v_dot2c_f32_bf16 v52, s68, v90
 v_dot2c_f32_bf16 v53, s69, v90
 v_dot2c_f32_bf16 v54, s68, v91
 v_dot2c_f32_bf16 v55, s69, v91
 s_waitcnt vmcnt(6)
 v_dot2c_f32_bf16 v48, s68, v92
 v_dot2c_f32_bf16 v49, s69, v92
 v_dot2c_f32_bf16 v50, s68, v93
 v_dot2c_f32_bf16 v51, s69, v93
 v_dot2c_f32_bf16 v52, s68, v94
 v_dot2c_f32_bf16 v53, s69, v94
 v_dot2c_f32_bf16 v54, s68, v95
 v_dot2c_f32_bf16 v55, s69, v95
 s_waitcnt vmcnt(5)
 v_dot2c_f32_bf16 v48, s68, v96
 v_dot2c_f32_bf16 v49, s69, v96
 v_dot2c_f32_bf16 v50, s68, v97
 v_dot2c_f32_bf16 v51, s69, v97
 v_dot2c_f32_bf16 v52, s68, v98
 v_dot2c_f32_bf16 v53, s69, v98
 v_dot2c_f32_bf16 v54, s68, v99
 v_dot2c_f32_bf16 v55, s69, v99
 s_waitcnt vmcnt(4)
 v_dot2c_f32_bf16 v48, s68, v100
 v_dot2c_f32_bf16 v49, s69, v100
 v_dot2c_f32_bf16 v50, s68, v101
 v_dot2c_f32_bf16 v51, s69, v101
 v_dot2c_f32_bf16 v52, s68, v102
 v_dot2c_f32_bf16 v53, s69, v102
 v_dot2c_f32_bf16 v54, s68, v103
 v_dot2c_f32_bf16 v55, s69, v103
 s_waitcnt vmcnt(3)
 v_dot2c_f32_bf16 v48, s68, v104
 v_dot2c_f32_bf16 v49, s69, v104
 v_dot2c_f32_bf16 v50, s68, v105
 v_dot2c_f32_bf16 v51, s69, v105
 v_dot2c_f32_bf16 v52, s68, v106
 v_dot2c_f32_bf16 v53, s69, v106
 v_dot2c_f32_bf16 v54, s68, v107
 v_dot2c_f32_bf16 v55, s69, v107
 s_waitcnt vmcnt(2)
 v_dot2c_f32_bf16 v48, s68, v108
 v_dot2c_f32_bf16 v49, s69, v108
 v_dot2c_f32_bf16 v50, s68, v109
 v_dot2c_f32_bf16 v51, s69, v109
 v_dot2c_f32_bf16 v52, s68, v110
 v_dot2c_f32_bf16 v53, s69, v110
 v_dot2c_f32_bf16 v54, s68, v111
 v_dot2c_f32_bf16 v55, s69, v111
 s_waitcnt vmcnt(1)
 v_dot2c_f32_bf16 v48, s68, v112
 v_dot2c_f32_bf16 v49, s69, v112
 v_dot2c_f32_bf16 v50, s68, v113
 v_dot2c_f32_bf16 v51, s69, v113
 v_dot2c_f32_bf16 v52, s68, v114
 v_dot2c_f32_bf16 v53, s69, v114
 v_dot2c_f32_bf16 v54, s68, v115
 v_dot2c_f32_bf16 v55, s69, v115
 s_mov_b32 s71, 0
L_A_wf0:
 buffer_load_dword v16, v242, s[36:39], s76 offen sc1
 s_and_b32 s92, s71, 3
 s_mul_i32 s93, s62, 1
 s_cmp_eq_u32 s92, s93
 s_cbranch_scc0 L_A_wf1
 buffer_store_dword v243, v243, s[36:39], s76 offen sc1
 s_waitcnt vmcnt(1)
 s_branch L_A_wf2
L_A_wf1:
 s_waitcnt vmcnt(0)
L_A_wf2:
 v_cmp_ge_u32 vcc, s80, v16
 s_nop 1
 s_and_b32 s81, vcc_lo, 0x1f800
 s_and_b32 s92, vcc_lo, 0x1f800
 s_cbranch_scc0 L_A_wf3
 s_add_u32 s71, s71, 1
 s_cmp_gt_u32 s71, 0x3e80
 s_cbranch_scc1 L_A_wf4
 s_sleep 2
 s_branch L_A_wf0
L_A_wf4:
 v_lshlrev_b32 v19, 4, v0
 v_mov_b32 v24, 0x10000000
 v_mov_b32 v18, 1
 v_cmp_gt_u32 vcc, 0x100, v0
 s_nop 1
 v_cndmask_b32 v19, v24, v19, vcc
 s_lshl2_add_u32 s92, s45, s82
 s_add_u32 s92, s92, 0x1000
 buffer_store_dword v18, v19, s[36:39], s92 offen sc1
 s_waitcnt vmcnt(0)
 buffer_store_dword v243, v243, s[36:39], s76 offen sc1
 s_waitcnt vmcnt(0)
 buffer_load_dword v16, v242, s[36:39], s76 offen sc1
 s_waitcnt vmcnt(0)
 v_cmp_ge_u32 vcc, s80, v16
 s_nop 1
 s_and_b32 s81, vcc_lo, 0x1f800
 s_and_b32 s92, vcc_lo, 0x1ffff
 s_cbranch_scc1 L_A_exit
L_A_wf3:
 s_call_b64 s[66:67], L_A_ft
 s_branch L_A_exit
L_A_ft:
 s_mov_b32 s93, 0xffff0000
 s_add_u32 s92, s70, 0x18c0000
 buffer_load_dwordx4 v[116:119], v25, s[36:39], s92 offen sc1
 s_add_u32 s92, s70, 0x1b00000
 buffer_load_dwordx4 v[120:123], v25, s[36:39], s92 offen sc1
 s_add_u32 s92, s70, 0x1d40000
 buffer_load_dwordx4 v[124:127], v25, s[36:39], s92 offen sc1
 s_add_u32 s92, s70, 0x1f80000
 buffer_load_dwordx4 v[128:131], v25, s[36:39], s92 offen sc1
 s_add_u32 s92, s70, 0x21c0000
 buffer_load_dwordx4 v[132:135], v25, s[36:39], s92 offen sc1
 s_add_u32 s92, s70, 0x2400000
 buffer_load_dwordx4 v[136:139], v25, s[36:39], s92 offen sc1
 s_waitcnt vmcnt(5)
 v_lshlrev_b32 v56, 16, v116
 v_and_b32 v57, s93, v116
 v_lshlrev_b32 v58, 16, v117
 v_and_b32 v59, s93, v117
 v_lshlrev_b32 v60, 16, v118
 v_and_b32 v61, s93, v118
 v_lshlrev_b32 v62, 16, v119
 v_and_b32 v63, s93, v119
 s_waitcnt vmcnt(4)
 v_dot2c_f32_bf16 v56, s68, v120
 v_dot2c_f32_bf16 v57, s69, v120
 v_dot2c_f32_bf16 v58, s68, v121
 v_dot2c_f32_bf16 v59, s69, v121
 v_dot2c_f32_bf16 v60, s68, v122
 v_dot2c_f32_bf16 v61, s69, v122
 v_dot2c_f32_bf16 v62, s68, v123
 v_dot2c_f32_bf16 v63, s69, v123
 s_waitcnt vmcnt(3)
 v_dot2c_f32_bf16 v56, s68, v124
 v_dot2c_f32_bf16 v57, s69, v124
 v_dot2c_f32_bf16 v58, s68, v125
 v_dot2c_f32_bf16 v59, s69, v125
 v_dot2c_f32_bf16 v60, s68, v126
 v_dot2c_f32_bf16 v61, s69, v126
 v_dot2c_f32_bf16 v62, s68, v127
 v_dot2c_f32_bf16 v63, s69, v127
 s_waitcnt vmcnt(2)
 v_dot2c_f32_bf16 v56, s68, v128
 v_dot2c_f32_bf16 v57, s69, v128
 v_dot2c_f32_bf16 v58, s68, v129
 v_dot2c_f32_bf16 v59, s69, v129
 v_dot2c_f32_bf16 v60, s68, v130
 v_dot2c_f32_bf16 v61, s69, v130
 v_dot2c_f32_bf16 v62, s68, v131
 v_dot2c_f32_bf16 v63, s69, v131
 s_waitcnt vmcnt(1)
 v_dot2c_f32_bf16 v56, s68, v132
 v_dot2c_f32_bf16 v57, s69, v132
 v_dot2c_f32_bf16 v58, s68, v133
 v_dot2c_f32_bf16 v59, s69, v133
 v_dot2c_f32_bf16 v60, s68, v134
 v_dot2c_f32_bf16 v61, s69, v134
 v_dot2c_f32_bf16 v62, s68, v135
 v_dot2c_f32_bf16 v63, s69, v135
 s_waitcnt vmcnt(0)
 v_dot2c_f32_bf16 v56, s68, v136
 v_dot2c_f32_bf16 v57, s69, v136
 v_dot2c_f32_bf16 v58, s68, v137
 v_dot2c_f32_bf16 v59, s69, v137
 v_dot2c_f32_bf16 v60, s68, v138
 v_dot2c_f32_bf16 v61, s69, v138
 v_dot2c_f32_bf16 v62, s68, v139
 v_dot2c_f32_bf16 v63, s69, v139
 EX 64,56
 EX 65,57
 EX 66,58
 EX 67,59
 EX 68,60
 EX 69,61
 EX 70,62
 EX 71,63
 v_add_f32 v64, 1.0, v64
 v_add_f32 v65, 1.0, v65
 v_add_f32 v66, 1.0, v66
 v_add_f32 v67, 1.0, v67
 v_add_f32 v68, 1.0, v68
 v_add_f32 v69, 1.0, v69
 v_add_f32 v70, 1.0, v70
 v_add_f32 v71, 1.0, v71
 v_rcp_f32 v64, v64
 v_rcp_f32 v65, v65
 v_rcp_f32 v66, v66
 v_rcp_f32 v67, v67
 v_rcp_f32 v68, v68
 v_rcp_f32 v69, v69
 v_rcp_f32 v70, v70
 v_rcp_f32 v71, v71
 v_mul_f32 v56, 0xbf317218, v56
 v_mul_f32 v57, 0xbf317218, v57
 v_mul_f32 v58, 0xbf317218, v58
 v_mul_f32 v59, 0xbf317218, v59
 v_mul_f32 v60, 0xbf317218, v60
 v_mul_f32 v61, 0xbf317218, v61
 v_mul_f32 v62, 0xbf317218, v62
 v_mul_f32 v63, 0xbf317218, v63
 ML 56,56,64
 ML 57,57,65
 ML 58,58,66
 ML 59,59,67
 ML 60,60,68
 ML 61,61,69
 ML 62,62,70
 ML 63,63,71
 v_lshlrev_b32 v64, 16, v140
 v_and_b32 v65, s93, v140
 v_lshlrev_b32 v66, 16, v141
 v_and_b32 v67, s93, v141
 v_lshlrev_b32 v68, 16, v142
 v_and_b32 v69, s93, v142
 v_lshlrev_b32 v70, 16, v143
 v_and_b32 v71, s93, v143
 v_fma_f32 v64, v48, v56, v64
 v_fma_f32 v65, v49, v57, v65
 v_fma_f32 v66, v50, v58, v66
 v_fma_f32 v67, v51, v59, v67
 v_fma_f32 v68, v52, v60, v68
 v_fma_f32 v69, v53, v61, v69
 v_fma_f32 v70, v54, v62, v70
 v_fma_f32 v71, v55, v63, v71
 CV 140,64,65
 CV 141,66,67
 CV 142,68,69
 CV 143,70,71
 s_nop 0
 v_permlane16_swap_b32 v140, v142
 v_permlane16_swap_b32 v141, v143
 v_mov_b32 v64, v140
 v_mov_b32 v65, v141
 v_mov_b32_dpp v140, v142 row_ror:8 row_mask:0xf bank_mask:0xc
 v_mov_b32_dpp v141, v143 row_ror:8 row_mask:0xf bank_mask:0xc
 v_mov_b32_dpp v142, v64 row_ror:8 row_mask:0xf bank_mask:0x3
 v_mov_b32_dpp v143, v65 row_ror:8 row_mask:0xf bank_mask:0x3
 buffer_store_dwordx4 v[140:143], v28, s[48:51], s61 offen sc1
 v_mov_b32 v19, 0x10000000
 buffer_store_dword v19, v19, s[48:51], 0 offen
 s_setpc_b64 s[66:67]
L_A_old:
 s_min_u32 s92, s78, s79
 s_cmp_lt_u32 s45, s92
 s_cbranch_scc1 L_A_en7
 s_mov_b32 s81, s45
 s_mov_b32 s80, 3
 s_call_b64 s[66:67], L_A_sync
 s_cmp_eq_u32 s58, 0
 s_cbranch_scc0 L_A_fb
L_A_en7:
L_A_f3:
 s_mov_b32 s93, 0xffff0000
 buffer_load_dwordx2 v[140:141], v20, s[8:11], s61 offen
 buffer_load_dwordx2 v[142:143], v20, s[8:11], s61 offen offset:32
 s_add_u32 s92, s70, 0
 buffer_load_dwordx4 v[72:75], v25, s[36:39], s92 offen sc1
 s_add_u32 s92, s70, 0x240000
 buffer_load_dwordx4 v[76:79], v25, s[36:39], s92 offen sc1
 s_add_u32 s92, s70, 0x480000
 buffer_load_dwordx4 v[80:83], v25, s[36:39], s92 offen sc1
 s_add_u32 s92, s70, 0x6c0000
 buffer_load_dwordx4 v[84:87], v25, s[36:39], s92 offen sc1
 s_add_u32 s92, s70, 0x900000
 buffer_load_dwordx4 v[88:91], v25, s[36:39], s92 offen sc1
 s_add_u32 s92, s70, 0xb40000
 buffer_load_dwordx4 v[92:95], v25, s[36:39], s92 offen sc1
 s_add_u32 s92, s70, 0xd80000
 buffer_load_dwordx4 v[96:99], v25, s[36:39], s92 offen sc1
 s_add_u32 s92, s70, 0xfc0000
 buffer_load_dwordx4 v[100:103], v25, s[36:39], s92 offen sc1
 s_waitcnt vmcnt(7)
 v_lshlrev_b32 v48, 16, v72
 v_and_b32 v49, s93, v72
 v_lshlrev_b32 v50, 16, v73
 v_and_b32 v51, s93, v73
 v_lshlrev_b32 v52, 16, v74
 v_and_b32 v53, s93, v74
 v_lshlrev_b32 v54, 16, v75
 v_and_b32 v55, s93, v75
 s_add_u32 s92, s70, 0x1200000
 buffer_load_dwordx4 v[104:107], v25, s[36:39], s92 offen sc1
 s_waitcnt vmcnt(7)
 v_dot2c_f32_bf16 v48, s68, v76
 v_dot2c_f32_bf16 v49, s69, v76
 v_dot2c_f32_bf16 v50, s68, v77
 v_dot2c_f32_bf16 v51, s69, v77
 v_dot2c_f32_bf16 v52, s68, v78
 v_dot2c_f32_bf16 v53, s69, v78
 v_dot2c_f32_bf16 v54, s68, v79
 v_dot2c_f32_bf16 v55, s69, v79
 s_add_u32 s92, s70, 0x1440000
 buffer_load_dwordx4 v[108:111], v25, s[36:39], s92 offen sc1
 s_waitcnt vmcnt(7)
 v_dot2c_f32_bf16 v48, s68, v80
 v_dot2c_f32_bf16 v49, s69, v80
 v_dot2c_f32_bf16 v50, s68, v81
 v_dot2c_f32_bf16 v51, s69, v81
 v_dot2c_f32_bf16 v52, s68, v82
 v_dot2c_f32_bf16 v53, s69, v82
 v_dot2c_f32_bf16 v54, s68, v83
 v_dot2c_f32_bf16 v55, s69, v83
 s_add_u32 s92, s70, 0x1680000
 buffer_load_dwordx4 v[112:115], v25, s[36:39], s92 offen sc1
 s_waitcnt vmcnt(7)
 v_dot2c_f32_bf16 v48, s68, v84
 v_dot2c_f32_bf16 v49, s69, v84
 v_dot2c_f32_bf16 v50, s68, v85
 v_dot2c_f32_bf16 v51, s69, v85
 v_dot2c_f32_bf16 v52, s68, v86
 v_dot2c_f32_bf16 v53, s69, v86
 v_dot2c_f32_bf16 v54, s68, v87
 v_dot2c_f32_bf16 v55, s69, v87
 s_add_u32 s92, s70, 0x18c0000
 buffer_load_dwordx4 v[116:119], v25, s[36:39], s92 offen sc1
 s_waitcnt vmcnt(7)
 v_dot2c_f32_bf16 v48, s68, v88
 v_dot2c_f32_bf16 v49, s69, v88
 v_dot2c_f32_bf16 v50, s68, v89
 v_dot2c_f32_bf16 v51, s69, v89
 v_dot2c_f32_bf16 v52, s68, v90
 v_dot2c_f32_bf16 v53, s69, v90
 v_dot2c_f32_bf16 v54, s68, v91
 v_dot2c_f32_bf16 v55, s69, v91
 s_add_u32 s92, s70, 0x1b00000
 buffer_load_dwordx4 v[120:123], v25, s[36:39], s92 offen sc1
 s_waitcnt vmcnt(7)
 v_dot2c_f32_bf16 v48, s68, v92
 v_dot2c_f32_bf16 v49, s69, v92
 v_dot2c_f32_bf16 v50, s68, v93
 v_dot2c_f32_bf16 v51, s69, v93
 v_dot2c_f32_bf16 v52, s68, v94
 v_dot2c_f32_bf16 v53, s69, v94
 v_dot2c_f32_bf16 v54, s68, v95
 v_dot2c_f32_bf16 v55, s69, v95
 s_add_u32 s92, s70, 0x1d40000
 buffer_load_dwordx4 v[124:127], v25, s[36:39], s92 offen sc1
 s_waitcnt vmcnt(7)
 v_dot2c_f32_bf16 v48, s68, v96
 v_dot2c_f32_bf16 v49, s69, v96
 v_dot2c_f32_bf16 v50, s68, v97
 v_dot2c_f32_bf16 v51, s69, v97
 v_dot2c_f32_bf16 v52, s68, v98
 v_dot2c_f32_bf16 v53, s69, v98
 v_dot2c_f32_bf16 v54, s68, v99
 v_dot2c_f32_bf16 v55, s69, v99
 s_add_u32 s92, s70, 0x1f80000
 buffer_load_dwordx4 v[128:131], v25, s[36:39], s92 offen sc1
 s_waitcnt vmcnt(7)
 v_dot2c_f32_bf16 v48, s68, v100
 v_dot2c_f32_bf16 v49, s69, v100
 v_dot2c_f32_bf16 v50, s68, v101
 v_dot2c_f32_bf16 v51, s69, v101
 v_dot2c_f32_bf16 v52, s68, v102
 v_dot2c_f32_bf16 v53, s69, v102
 v_dot2c_f32_bf16 v54, s68, v103
 v_dot2c_f32_bf16 v55, s69, v103
 s_add_u32 s92, s70, 0x21c0000
 buffer_load_dwordx4 v[132:135], v25, s[36:39], s92 offen sc1
 s_waitcnt vmcnt(7)
 v_dot2c_f32_bf16 v48, s68, v104
 v_dot2c_f32_bf16 v49, s69, v104
 v_dot2c_f32_bf16 v50, s68, v105
 v_dot2c_f32_bf16 v51, s69, v105
 v_dot2c_f32_bf16 v52, s68, v106
 v_dot2c_f32_bf16 v53, s69, v106
 v_dot2c_f32_bf16 v54, s68, v107
 v_dot2c_f32_bf16 v55, s69, v107
 s_add_u32 s92, s70, 0x2400000
 buffer_load_dwordx4 v[136:139], v25, s[36:39], s92 offen sc1
 s_waitcnt vmcnt(7)
 v_dot2c_f32_bf16 v48, s68, v108
 v_dot2c_f32_bf16 v49, s69, v108
 v_dot2c_f32_bf16 v50, s68, v109
 v_dot2c_f32_bf16 v51, s69, v109
 v_dot2c_f32_bf16 v52, s68, v110
 v_dot2c_f32_bf16 v53, s69, v110
 v_dot2c_f32_bf16 v54, s68, v111
 v_dot2c_f32_bf16 v55, s69, v111
 s_waitcnt vmcnt(6)
 v_dot2c_f32_bf16 v48, s68, v112
 v_dot2c_f32_bf16 v49, s69, v112
 v_dot2c_f32_bf16 v50, s68, v113
 v_dot2c_f32_bf16 v51, s69, v113
 v_dot2c_f32_bf16 v52, s68, v114
 v_dot2c_f32_bf16 v53, s69, v114
 v_dot2c_f32_bf16 v54, s68, v115
 v_dot2c_f32_bf16 v55, s69, v115
 s_waitcnt vmcnt(5)
 v_lshlrev_b32 v56, 16, v116
 v_and_b32 v57, s93, v116
 v_lshlrev_b32 v58, 16, v117
 v_and_b32 v59, s93, v117
 v_lshlrev_b32 v60, 16, v118
 v_and_b32 v61, s93, v118
 v_lshlrev_b32 v62, 16, v119
 v_and_b32 v63, s93, v119
 s_waitcnt vmcnt(4)
 v_dot2c_f32_bf16 v56, s68, v120
 v_dot2c_f32_bf16 v57, s69, v120
 v_dot2c_f32_bf16 v58, s68, v121
 v_dot2c_f32_bf16 v59, s69, v121
 v_dot2c_f32_bf16 v60, s68, v122
 v_dot2c_f32_bf16 v61, s69, v122
 v_dot2c_f32_bf16 v62, s68, v123
 v_dot2c_f32_bf16 v63, s69, v123
 s_waitcnt vmcnt(3)
 v_dot2c_f32_bf16 v56, s68, v124
 v_dot2c_f32_bf16 v57, s69, v124
 v_dot2c_f32_bf16 v58, s68, v125
 v_dot2c_f32_bf16 v59, s69, v125
 v_dot2c_f32_bf16 v60, s68, v126
 v_dot2c_f32_bf16 v61, s69, v126
 v_dot2c_f32_bf16 v62, s68, v127
 v_dot2c_f32_bf16 v63, s69, v127
 s_waitcnt vmcnt(2)
 v_dot2c_f32_bf16 v56, s68, v128
 v_dot2c_f32_bf16 v57, s69, v128
 v_dot2c_f32_bf16 v58, s68, v129
 v_dot2c_f32_bf16 v59, s69, v129
 v_dot2c_f32_bf16 v60, s68, v130
 v_dot2c_f32_bf16 v61, s69, v130
 v_dot2c_f32_bf16 v62, s68, v131
 v_dot2c_f32_bf16 v63, s69, v131
 s_waitcnt vmcnt(1)
 v_dot2c_f32_bf16 v56, s68, v132
 v_dot2c_f32_bf16 v57, s69, v132
 v_dot2c_f32_bf16 v58, s68, v133
 v_dot2c_f32_bf16 v59, s69, v133
 v_dot2c_f32_bf16 v60, s68, v134
 v_dot2c_f32_bf16 v61, s69, v134
 v_dot2c_f32_bf16 v62, s68, v135
 v_dot2c_f32_bf16 v63, s69, v135
 s_waitcnt vmcnt(0)
 v_dot2c_f32_bf16 v56, s68, v136
 v_dot2c_f32_bf16 v57, s69, v136
 v_dot2c_f32_bf16 v58, s68, v137
 v_dot2c_f32_bf16 v59, s69, v137
 v_dot2c_f32_bf16 v60, s68, v138
 v_dot2c_f32_bf16 v61, s69, v138
 v_dot2c_f32_bf16 v62, s68, v139
 v_dot2c_f32_bf16 v63, s69, v139
 EX 64,56
 EX 65,57
 EX 66,58
 EX 67,59
 EX 68,60
 EX 69,61
 EX 70,62
 EX 71,63
 v_add_f32 v64, 1.0, v64
 v_add_f32 v65, 1.0, v65
 v_add_f32 v66, 1.0, v66
 v_add_f32 v67, 1.0, v67
 v_add_f32 v68, 1.0, v68
 v_add_f32 v69, 1.0, v69
 v_add_f32 v70, 1.0, v70
 v_add_f32 v71, 1.0, v71
 v_rcp_f32 v64, v64
 v_rcp_f32 v65, v65
 v_rcp_f32 v66, v66
 v_rcp_f32 v67, v67
 v_rcp_f32 v68, v68
 v_rcp_f32 v69, v69
 v_rcp_f32 v70, v70
 v_rcp_f32 v71, v71
 v_mul_f32 v56, 0xbf317218, v56
 v_mul_f32 v57, 0xbf317218, v57
 v_mul_f32 v58, 0xbf317218, v58
 v_mul_f32 v59, 0xbf317218, v59
 v_mul_f32 v60, 0xbf317218, v60
 v_mul_f32 v61, 0xbf317218, v61
 v_mul_f32 v62, 0xbf317218, v62
 v_mul_f32 v63, 0xbf317218, v63
 ML 56,56,64
 ML 57,57,65
 ML 58,58,66
 ML 59,59,67
 ML 60,60,68
 ML 61,61,69
 ML 62,62,70
 ML 63,63,71
 v_lshlrev_b32 v64, 16, v140
 v_and_b32 v65, s93, v140
 v_lshlrev_b32 v66, 16, v141
 v_and_b32 v67, s93, v141
 v_lshlrev_b32 v68, 16, v142
 v_and_b32 v69, s93, v142
 v_lshlrev_b32 v70, 16, v143
 v_and_b32 v71, s93, v143
 v_fma_f32 v64, v48, v56, v64
 v_fma_f32 v65, v49, v57, v65
 v_fma_f32 v66, v50, v58, v66
 v_fma_f32 v67, v51, v59, v67
 v_fma_f32 v68, v52, v60, v68
 v_fma_f32 v69, v53, v61, v69
 v_fma_f32 v70, v54, v62, v70
 v_fma_f32 v71, v55, v63, v71
 CV 140,64,65
 CV 141,66,67
 CV 142,68,69
 CV 143,70,71
 s_nop 0
 v_permlane16_swap_b32 v140, v142
 v_permlane16_swap_b32 v141, v143
 v_mov_b32 v64, v140
 v_mov_b32 v65, v141
 v_mov_b32_dpp v140, v142 row_ror:8 row_mask:0xf bank_mask:0xc
 v_mov_b32_dpp v141, v143 row_ror:8 row_mask:0xf bank_mask:0xc
 v_mov_b32_dpp v142, v64 row_ror:8 row_mask:0xf bank_mask:0x3
 v_mov_b32_dpp v143, v65 row_ror:8 row_mask:0xf bank_mask:0x3
 buffer_store_dwordx4 v[140:143], v28, s[48:51], s61 offen sc1
 v_mov_b32 v19, 0x10000000
 buffer_store_dword v19, v19, s[48:51], 0 offen
 s_bitset0_b64 s[74:75], s45
 s_cmp_eq_u32 s84, 0
 s_cbranch_scc1 L_A_exit
 s_branch L_A_fb
L_A_fin:
 s_cmp_eq_u32 s62, 0
 s_cbranch_scc0 L_A_b4
 v_cmp_ne_u32 vcc, 0, v31
 s_nop 1
 s_mov_b32 s72, vcc_lo
 s_and_b32 s73, vcc_hi, 15
 s_or_b32 s92, s72, s73
 s_cselect_b32 s58, 1, 0
 s_cmp_ge_u32 s40, 16
 s_cselect_b32 s58, s58, 1
 s_lshl_b32 s92, s79, 8
 s_or_b32 s92, s92, s78
 s_lshl_b32 s93, s58, 16
 s_or_b32 s92, s92, s93
 v_mov_b32 v24, s92
 v_mov_b32 v23, s41
 ds_write_b32 v23, v24
 WL 0
L_A_b4:
 s_barrier
 v_mov_b32 v23, s41
 ds_read_b32 v24, v23
 WL 0
 v_readfirstlane_b32 s92, v24
 s_nop 1
 s_and_b32 s78, s92, 0xff
 s_bfe_u32 s79, s92, 0x80008
 s_lshr_b32 s58, s92, 16
 s_xor_b32 s41, s41, 12
 s_cmp_eq_u32 s58, 0
 s_cbranch_scc1 L_A_exit
L_A_fb:
 s_waitcnt vmcnt(0)
 s_cmp_eq_u32 s62, 0
 s_cbranch_scc0 L_A_fb2
 s_mov_b64 s[98:99], s[74:75]
 v_mov_b32 v18, 1
 v_lshlrev_b32 v19, 4, v0
 v_mov_b32 v24, 0x10000000
 v_cmp_gt_u32 vcc, 0x100, v0
 s_nop 1
 v_cndmask_b32 v19, v24, v19, vcc
L_A_mk:
 s_cmp_eq_u64 s[98:99], 0
 s_cbranch_scc1 L_A_mk1
 s_ff1_i32_b64 s92, s[98:99]
 s_bitset0_b64 s[98:99], s92
 s_lshl2_add_u32 s92, s92, s82
 s_add_u32 s92, s92, 0x1000
 buffer_store_dword v18, v19, s[36:39], s92 offen sc1
 s_branch L_A_mk
L_A_mk1:
 s_waitcnt vmcnt(0)
 v_mov_b32 v17, 0
 buffer_atomic_add v17, v22, s[52:55], 0 offen sc0 sc1
 s_waitcnt vmcnt(0)
 v_mov_b32 v19, 0x10000000
 s_mov_b32 s92, 0x90
 v_writelane_b32 v19, s92, 1
 buffer_store_dword v18, v19, s[36:39], s77 offen sc1
 v_mov_b32 v24, 0
 v_mov_b32 v19, 0x10000000
 v_writelane_b32 v19, 0, 0
 buffer_atomic_add v24, v19, s[36:39], s77 offen sc1
 s_waitcnt vmcnt(0)
 buffer_load_dword v31, v21, s[36:39], s77 offen sc1
 buffer_store_dword v26, v26, s[36:39], s82 offen sc1
 buffer_load_dword v16, v21, s[36:39], s82 offen sc1
 s_waitcnt vmcnt(0)
 v_readfirstlane_b32 s40, v17
 v_cmp_ne_u32 vcc, 0, v16
 s_nop 1
 s_lshr_b64 s[72:73], vcc, 18
 s_and_b32 s73, s73, 15
 s_mov_b32 s78, 0
 s_mov_b32 s79, 0
 v_cmp_ge_u32 vcc, 0, v16
 s_nop 1
 s_and_b32 s92, vcc_lo, 0x7ff
 s_cselect_b32 s78, s78, 4
 s_and_b32 s92, vcc_lo, 0x1f800
 s_cselect_b32 s79, s79, 4
 v_cmp_ge_u32 vcc, 1, v16
 s_nop 1
 s_and_b32 s92, vcc_lo, 0x7ff
 s_cselect_b32 s78, s78, 8
 s_and_b32 s92, vcc_lo, 0x1f800
 s_cselect_b32 s79, s79, 8
 v_cmp_ge_u32 vcc, 2, v16
 s_nop 1
 s_and_b32 s92, vcc_lo, 0x7ff
 s_cselect_b32 s78, s78, 12
 s_and_b32 s92, vcc_lo, 0x1f800
 s_cselect_b32 s79, s79, 12
 v_cmp_ge_u32 vcc, 3, v16
 s_nop 1
 s_and_b32 s92, vcc_lo, 0x7ff
 s_cselect_b32 s78, s78, 16
 s_and_b32 s92, vcc_lo, 0x1f800
 s_cselect_b32 s79, s79, 16
 v_cmp_ge_u32 vcc, 4, v16
 s_nop 1
 s_and_b32 s92, vcc_lo, 0x7ff
 s_cselect_b32 s78, s78, 20
 s_and_b32 s92, vcc_lo, 0x1f800
 s_cselect_b32 s79, s79, 20
 v_cmp_ge_u32 vcc, 5, v16
 s_nop 1
 s_and_b32 s92, vcc_lo, 0x7ff
 s_cselect_b32 s78, s78, 24
 s_and_b32 s92, vcc_lo, 0x1f800
 s_cselect_b32 s79, s79, 24
 v_cmp_ge_u32 vcc, 6, v16
 s_nop 1
 s_and_b32 s92, vcc_lo, 0x7ff
 s_cselect_b32 s78, s78, 28
 s_and_b32 s92, vcc_lo, 0x1f800
 s_cselect_b32 s79, s79, 28
 v_cmp_ge_u32 vcc, 7, v16
 s_nop 1
 s_and_b32 s92, vcc_lo, 0x7ff
 s_cselect_b32 s78, s78, 32
 s_and_b32 s92, vcc_lo, 0x1f800
 s_cselect_b32 s79, s79, 32
 v_cmp_ge_u32 vcc, 8, v16
 s_nop 1
 s_and_b32 s92, vcc_lo, 0x7ff
 s_cselect_b32 s78, s78, 36
 s_and_b32 s92, vcc_lo, 0x1f800
 s_cselect_b32 s79, s79, 36
 v_cmp_ne_u32 vcc, 0, v31
 s_nop 1
 s_mov_b32 s72, vcc_lo
 s_and_b32 s73, vcc_hi, 15
 s_min_u32 s92, s78, s79
 s_cmp_ge_u32 s40, 16
 s_cselect_b32 s92, s92, 0
 s_bfm_b64 s[98:99], s92, 0
 s_or_b64 s[72:73], s[72:73], s[74:75]
 s_and_b64 s[72:73], s[72:73], s[98:99]
L_A_fb1:
 s_ff1_i32_b64 s78, s[72:73]
 s_and_b32 s78, s78, 0xff
 s_bitset0_b64 s[72:73], s78
 s_lshl_b32 s92, s79, 8
 s_or_b32 s92, s92, s78
 s_lshl_b32 s93, s58, 16
 s_or_b32 s92, s92, s93
 v_mov_b32 v24, s92
 v_mov_b32 v23, s41
 ds_write_b32 v23, v24
 WL 0
L_A_fb2:
 s_barrier
 v_mov_b32 v23, s41
 ds_read_b32 v24, v23
 WL 0
 v_readfirstlane_b32 s92, v24
 s_nop 1
 s_and_b32 s78, s92, 0xff
 s_bfe_u32 s79, s92, 0x80008
 s_lshr_b32 s58, s92, 16
 s_xor_b32 s41, s41, 12
 s_cmp_ge_u32 s78, 36
 s_cbranch_scc1 L_A_exit
 s_and_b32 s92, s78, 3
 s_lshr_b32 s80, s78, 2
 s_lshl_b32 s93, s64, 2
 s_add_u32 s92, s92, s93
 s_mul_i32 s47, s92, 0x9000
 s_add_u32 s46, s47, s59
 s_lshl_b32 s93, s80, 12
 s_add_u32 s93, s93, s3
 s_add_u32 s47, s47, s93
 s_lshl_b32 s93, s80, 7
 s_add_u32 s46, s46, s93
 s_add_u32 s92, s47, 0
 buffer_load_dwordx4 v[72:75], v25, s[36:39], s92 offen sc1
 s_add_u32 s92, s47, 0x240000
 buffer_load_dwordx4 v[76:79], v25, s[36:39], s92 offen sc1
 s_add_u32 s92, s47, 0x480000
 buffer_load_dwordx4 v[80:83], v25, s[36:39], s92 offen sc1
 s_add_u32 s92, s47, 0x6c0000
 buffer_load_dwordx4 v[84:87], v25, s[36:39], s92 offen sc1
 s_add_u32 s92, s47, 0x900000
 buffer_load_dwordx4 v[88:91], v25, s[36:39], s92 offen sc1
 s_add_u32 s92, s47, 0xb40000
 buffer_load_dwordx4 v[92:95], v25, s[36:39], s92 offen sc1
 s_add_u32 s92, s47, 0xd80000
 buffer_load_dwordx4 v[96:99], v25, s[36:39], s92 offen sc1
 s_add_u32 s92, s47, 0xfc0000
 buffer_load_dwordx4 v[100:103], v25, s[36:39], s92 offen sc1
 s_add_u32 s92, s47, 0x1200000
 buffer_load_dwordx4 v[104:107], v25, s[36:39], s92 offen sc1
 s_add_u32 s92, s47, 0x1440000
 buffer_load_dwordx4 v[108:111], v25, s[36:39], s92 offen sc1
 s_add_u32 s92, s47, 0x1680000
 buffer_load_dwordx4 v[112:115], v25, s[36:39], s92 offen sc1
 s_add_u32 s92, s47, 0x18c0000
 buffer_load_dwordx4 v[116:119], v25, s[36:39], s92 offen sc1
 s_add_u32 s92, s47, 0x1b00000
 buffer_load_dwordx4 v[120:123], v25, s[36:39], s92 offen sc1
 s_add_u32 s92, s47, 0x1d40000
 buffer_load_dwordx4 v[124:127], v25, s[36:39], s92 offen sc1
 s_add_u32 s92, s47, 0x1f80000
 buffer_load_dwordx4 v[128:131], v25, s[36:39], s92 offen sc1
 s_add_u32 s92, s47, 0x21c0000
 buffer_load_dwordx4 v[132:135], v25, s[36:39], s92 offen sc1
 s_add_u32 s92, s47, 0x2400000
 buffer_load_dwordx4 v[136:139], v25, s[36:39], s92 offen sc1
 buffer_load_dwordx2 v[140:141], v20, s[8:11], s46 offen
 buffer_load_dwordx2 v[142:143], v20, s[8:11], s46 offen offset:32
 s_waitcnt vmcnt(0)
 s_mov_b32 s93, 0xffff0000
 s_waitcnt vmcnt(18)
 v_lshlrev_b32 v48, 16, v72
 v_and_b32 v49, s93, v72
 v_lshlrev_b32 v50, 16, v73
 v_and_b32 v51, s93, v73
 v_lshlrev_b32 v52, 16, v74
 v_and_b32 v53, s93, v74
 v_lshlrev_b32 v54, 16, v75
 v_and_b32 v55, s93, v75
 s_waitcnt vmcnt(17)
 v_dot2c_f32_bf16 v48, s68, v76
 v_dot2c_f32_bf16 v49, s69, v76
 v_dot2c_f32_bf16 v50, s68, v77
 v_dot2c_f32_bf16 v51, s69, v77
 v_dot2c_f32_bf16 v52, s68, v78
 v_dot2c_f32_bf16 v53, s69, v78
 v_dot2c_f32_bf16 v54, s68, v79
 v_dot2c_f32_bf16 v55, s69, v79
 s_waitcnt vmcnt(16)
 v_dot2c_f32_bf16 v48, s68, v80
 v_dot2c_f32_bf16 v49, s69, v80
 v_dot2c_f32_bf16 v50, s68, v81
 v_dot2c_f32_bf16 v51, s69, v81
 v_dot2c_f32_bf16 v52, s68, v82
 v_dot2c_f32_bf16 v53, s69, v82
 v_dot2c_f32_bf16 v54, s68, v83
 v_dot2c_f32_bf16 v55, s69, v83
 s_waitcnt vmcnt(15)
 v_dot2c_f32_bf16 v48, s68, v84
 v_dot2c_f32_bf16 v49, s69, v84
 v_dot2c_f32_bf16 v50, s68, v85
 v_dot2c_f32_bf16 v51, s69, v85
 v_dot2c_f32_bf16 v52, s68, v86
 v_dot2c_f32_bf16 v53, s69, v86
 v_dot2c_f32_bf16 v54, s68, v87
 v_dot2c_f32_bf16 v55, s69, v87
 s_waitcnt vmcnt(14)
 v_dot2c_f32_bf16 v48, s68, v88
 v_dot2c_f32_bf16 v49, s69, v88
 v_dot2c_f32_bf16 v50, s68, v89
 v_dot2c_f32_bf16 v51, s69, v89
 v_dot2c_f32_bf16 v52, s68, v90
 v_dot2c_f32_bf16 v53, s69, v90
 v_dot2c_f32_bf16 v54, s68, v91
 v_dot2c_f32_bf16 v55, s69, v91
 s_waitcnt vmcnt(13)
 v_dot2c_f32_bf16 v48, s68, v92
 v_dot2c_f32_bf16 v49, s69, v92
 v_dot2c_f32_bf16 v50, s68, v93
 v_dot2c_f32_bf16 v51, s69, v93
 v_dot2c_f32_bf16 v52, s68, v94
 v_dot2c_f32_bf16 v53, s69, v94
 v_dot2c_f32_bf16 v54, s68, v95
 v_dot2c_f32_bf16 v55, s69, v95
 s_waitcnt vmcnt(12)
 v_dot2c_f32_bf16 v48, s68, v96
 v_dot2c_f32_bf16 v49, s69, v96
 v_dot2c_f32_bf16 v50, s68, v97
 v_dot2c_f32_bf16 v51, s69, v97
 v_dot2c_f32_bf16 v52, s68, v98
 v_dot2c_f32_bf16 v53, s69, v98
 v_dot2c_f32_bf16 v54, s68, v99
 v_dot2c_f32_bf16 v55, s69, v99
 s_waitcnt vmcnt(11)
 v_dot2c_f32_bf16 v48, s68, v100
 v_dot2c_f32_bf16 v49, s69, v100
 v_dot2c_f32_bf16 v50, s68, v101
 v_dot2c_f32_bf16 v51, s69, v101
 v_dot2c_f32_bf16 v52, s68, v102
 v_dot2c_f32_bf16 v53, s69, v102
 v_dot2c_f32_bf16 v54, s68, v103
 v_dot2c_f32_bf16 v55, s69, v103
 s_waitcnt vmcnt(10)
 v_dot2c_f32_bf16 v48, s68, v104
 v_dot2c_f32_bf16 v49, s69, v104
 v_dot2c_f32_bf16 v50, s68, v105
 v_dot2c_f32_bf16 v51, s69, v105
 v_dot2c_f32_bf16 v52, s68, v106
 v_dot2c_f32_bf16 v53, s69, v106
 v_dot2c_f32_bf16 v54, s68, v107
 v_dot2c_f32_bf16 v55, s69, v107
 s_waitcnt vmcnt(9)
 v_dot2c_f32_bf16 v48, s68, v108
 v_dot2c_f32_bf16 v49, s69, v108
 v_dot2c_f32_bf16 v50, s68, v109
 v_dot2c_f32_bf16 v51, s69, v109
 v_dot2c_f32_bf16 v52, s68, v110
 v_dot2c_f32_bf16 v53, s69, v110
 v_dot2c_f32_bf16 v54, s68, v111
 v_dot2c_f32_bf16 v55, s69, v111
 s_waitcnt vmcnt(8)
 v_dot2c_f32_bf16 v48, s68, v112
 v_dot2c_f32_bf16 v49, s69, v112
 v_dot2c_f32_bf16 v50, s68, v113
 v_dot2c_f32_bf16 v51, s69, v113
 v_dot2c_f32_bf16 v52, s68, v114
 v_dot2c_f32_bf16 v53, s69, v114
 v_dot2c_f32_bf16 v54, s68, v115
 v_dot2c_f32_bf16 v55, s69, v115
 s_waitcnt vmcnt(7)
 v_lshlrev_b32 v56, 16, v116
 v_and_b32 v57, s93, v116
 v_lshlrev_b32 v58, 16, v117
 v_and_b32 v59, s93, v117
 v_lshlrev_b32 v60, 16, v118
 v_and_b32 v61, s93, v118
 v_lshlrev_b32 v62, 16, v119
 v_and_b32 v63, s93, v119
 s_waitcnt vmcnt(6)
 v_dot2c_f32_bf16 v56, s68, v120
 v_dot2c_f32_bf16 v57, s69, v120
 v_dot2c_f32_bf16 v58, s68, v121
 v_dot2c_f32_bf16 v59, s69, v121
 v_dot2c_f32_bf16 v60, s68, v122
 v_dot2c_f32_bf16 v61, s69, v122
 v_dot2c_f32_bf16 v62, s68, v123
 v_dot2c_f32_bf16 v63, s69, v123
 s_waitcnt vmcnt(5)
 v_dot2c_f32_bf16 v56, s68, v124
 v_dot2c_f32_bf16 v57, s69, v124
 v_dot2c_f32_bf16 v58, s68, v125
 v_dot2c_f32_bf16 v59, s69, v125
 v_dot2c_f32_bf16 v60, s68, v126
 v_dot2c_f32_bf16 v61, s69, v126
 v_dot2c_f32_bf16 v62, s68, v127
 v_dot2c_f32_bf16 v63, s69, v127
 s_waitcnt vmcnt(4)
 v_dot2c_f32_bf16 v56, s68, v128
 v_dot2c_f32_bf16 v57, s69, v128
 v_dot2c_f32_bf16 v58, s68, v129
 v_dot2c_f32_bf16 v59, s69, v129
 v_dot2c_f32_bf16 v60, s68, v130
 v_dot2c_f32_bf16 v61, s69, v130
 v_dot2c_f32_bf16 v62, s68, v131
 v_dot2c_f32_bf16 v63, s69, v131
 s_waitcnt vmcnt(3)
 v_dot2c_f32_bf16 v56, s68, v132
 v_dot2c_f32_bf16 v57, s69, v132
 v_dot2c_f32_bf16 v58, s68, v133
 v_dot2c_f32_bf16 v59, s69, v133
 v_dot2c_f32_bf16 v60, s68, v134
 v_dot2c_f32_bf16 v61, s69, v134
 v_dot2c_f32_bf16 v62, s68, v135
 v_dot2c_f32_bf16 v63, s69, v135
 s_waitcnt vmcnt(2)
 v_dot2c_f32_bf16 v56, s68, v136
 v_dot2c_f32_bf16 v57, s69, v136
 v_dot2c_f32_bf16 v58, s68, v137
 v_dot2c_f32_bf16 v59, s69, v137
 v_dot2c_f32_bf16 v60, s68, v138
 v_dot2c_f32_bf16 v61, s69, v138
 v_dot2c_f32_bf16 v62, s68, v139
 v_dot2c_f32_bf16 v63, s69, v139
 EX 64,56
 EX 65,57
 EX 66,58
 EX 67,59
 EX 68,60
 EX 69,61
 EX 70,62
 EX 71,63
 v_add_f32 v64, 1.0, v64
 v_add_f32 v65, 1.0, v65
 v_add_f32 v66, 1.0, v66
 v_add_f32 v67, 1.0, v67
 v_add_f32 v68, 1.0, v68
 v_add_f32 v69, 1.0, v69
 v_add_f32 v70, 1.0, v70
 v_add_f32 v71, 1.0, v71
 v_rcp_f32 v64, v64
 v_rcp_f32 v65, v65
 v_rcp_f32 v66, v66
 v_rcp_f32 v67, v67
 v_rcp_f32 v68, v68
 v_rcp_f32 v69, v69
 v_rcp_f32 v70, v70
 v_rcp_f32 v71, v71
 v_mul_f32 v56, 0xbf317218, v56
 v_mul_f32 v57, 0xbf317218, v57
 v_mul_f32 v58, 0xbf317218, v58
 v_mul_f32 v59, 0xbf317218, v59
 v_mul_f32 v60, 0xbf317218, v60
 v_mul_f32 v61, 0xbf317218, v61
 v_mul_f32 v62, 0xbf317218, v62
 v_mul_f32 v63, 0xbf317218, v63
 ML 56,56,64
 ML 57,57,65
 ML 58,58,66
 ML 59,59,67
 ML 60,60,68
 ML 61,61,69
 ML 62,62,70
 ML 63,63,71
 s_waitcnt vmcnt(0)
 v_lshlrev_b32 v64, 16, v140
 v_and_b32 v65, s93, v140
 v_lshlrev_b32 v66, 16, v141
 v_and_b32 v67, s93, v141
 v_lshlrev_b32 v68, 16, v142
 v_and_b32 v69, s93, v142
 v_lshlrev_b32 v70, 16, v143
 v_and_b32 v71, s93, v143
 v_fma_f32 v64, v48, v56, v64
 v_fma_f32 v65, v49, v57, v65
 v_fma_f32 v66, v50, v58, v66
 v_fma_f32 v67, v51, v59, v67
 v_fma_f32 v68, v52, v60, v68
 v_fma_f32 v69, v53, v61, v69
 v_fma_f32 v70, v54, v62, v70
 v_fma_f32 v71, v55, v63, v71
 CV 140,64,65
 CV 141,66,67
 CV 142,68,69
 CV 143,70,71
 s_nop 0
 v_permlane16_swap_b32 v140, v142
 v_permlane16_swap_b32 v141, v143
 v_mov_b32 v64, v140
 v_mov_b32 v65, v141
 v_mov_b32_dpp v140, v142 row_ror:8 row_mask:0xf bank_mask:0xc
 v_mov_b32_dpp v141, v143 row_ror:8 row_mask:0xf bank_mask:0xc
 v_mov_b32_dpp v142, v64 row_ror:8 row_mask:0xf bank_mask:0x3
 v_mov_b32_dpp v143, v65 row_ror:8 row_mask:0xf bank_mask:0x3
 buffer_store_dwordx4 v[140:143], v28, s[48:51], s46 offen sc1
 v_mov_b32 v19, 0x10000000
 buffer_store_dword v19, v19, s[48:51], 0 offen
 s_cmp_eq_u32 s62, 0
 s_cbranch_scc1 L_A_fb1
 s_branch L_A_fb2
L_A_exit:
 s_endpgm
L_A_sync:
 s_cmp_eq_u32 s62, 0
 s_cbranch_scc0 L_A_sy2
 s_mov_b32 s71, 0
 buffer_store_dword v29, v29, s[36:39], s76 offen sc1
L_A_sy0:
 s_cmp_ge_u32 s40, 16
 s_cbranch_scc1 L_A_sy1
 v_mov_b32 v17, 0
 buffer_atomic_add v17, v22, s[52:55], 0 offen sc0 sc1
 s_waitcnt vmcnt(0)
 v_readfirstlane_b32 s40, v17
 s_nop 1
 s_cmp_ge_u32 s40, 16
 s_cbranch_scc0 L_A_syw
L_A_sy1:
 buffer_load_dword v16, v30, s[36:39], s76 offen sc1
 buffer_store_dword v29, v29, s[36:39], s76 offen sc1
 s_waitcnt vmcnt(1)
 v_cmp_ne_u32 vcc, 0, v16
 s_nop 1
 s_lshr_b64 s[72:73], vcc, 18
 s_and_b32 s73, s73, 15
 s_mov_b32 s78, 0
 s_mov_b32 s79, 0
 v_cmp_ge_u32 vcc, 0, v16
 s_nop 1
 s_and_b32 s92, vcc_lo, 0x7ff
 s_cselect_b32 s78, s78, 4
 s_and_b32 s92, vcc_lo, 0x1f800
 s_cselect_b32 s79, s79, 4
 v_cmp_ge_u32 vcc, 1, v16
 s_nop 1
 s_and_b32 s92, vcc_lo, 0x7ff
 s_cselect_b32 s78, s78, 8
 s_and_b32 s92, vcc_lo, 0x1f800
 s_cselect_b32 s79, s79, 8
 v_cmp_ge_u32 vcc, 2, v16
 s_nop 1
 s_and_b32 s92, vcc_lo, 0x7ff
 s_cselect_b32 s78, s78, 12
 s_and_b32 s92, vcc_lo, 0x1f800
 s_cselect_b32 s79, s79, 12
 v_cmp_ge_u32 vcc, 3, v16
 s_nop 1
 s_and_b32 s92, vcc_lo, 0x7ff
 s_cselect_b32 s78, s78, 16
 s_and_b32 s92, vcc_lo, 0x1f800
 s_cselect_b32 s79, s79, 16
 v_cmp_ge_u32 vcc, 4, v16
 s_nop 1
 s_and_b32 s92, vcc_lo, 0x7ff
 s_cselect_b32 s78, s78, 20
 s_and_b32 s92, vcc_lo, 0x1f800
 s_cselect_b32 s79, s79, 20
 v_cmp_ge_u32 vcc, 5, v16
 s_nop 1
 s_and_b32 s92, vcc_lo, 0x7ff
 s_cselect_b32 s78, s78, 24
 s_and_b32 s92, vcc_lo, 0x1f800
 s_cselect_b32 s79, s79, 24
 v_cmp_ge_u32 vcc, 6, v16
 s_nop 1
 s_and_b32 s92, vcc_lo, 0x7ff
 s_cselect_b32 s78, s78, 28
 s_and_b32 s92, vcc_lo, 0x1f800
 s_cselect_b32 s79, s79, 28
 v_cmp_ge_u32 vcc, 7, v16
 s_nop 1
 s_and_b32 s92, vcc_lo, 0x7ff
 s_cselect_b32 s78, s78, 32
 s_and_b32 s92, vcc_lo, 0x1f800
 s_cselect_b32 s79, s79, 32
 v_cmp_ge_u32 vcc, 8, v16
 s_nop 1
 s_and_b32 s92, vcc_lo, 0x7ff
 s_cselect_b32 s78, s78, 36
 s_and_b32 s92, vcc_lo, 0x1f800
 s_cselect_b32 s79, s79, 36
 s_bitcmp1_b32 s80, 0
 s_cselect_b32 s92, s78, 36
 s_bitcmp1_b32 s80, 1
 s_cselect_b32 s93, s79, 36
 s_min_u32 s92, s92, s93
 s_cmp_lt_u32 s81, s92
 s_cbranch_scc1 L_A_syp
L_A_syw:
 s_add_u32 s71, s71, 1
 s_cmp_gt_u32 s71, 0xfa0
 s_cselect_b32 s58, 1, 0
 s_cbranch_scc1 L_A_syp
 s_sleep 1
 s_branch L_A_sy0
L_A_syp:
 s_lshl_b32 s92, s79, 8
 s_or_b32 s92, s92, s78
 s_lshl_b32 s93, s58, 16
 s_or_b32 s92, s92, s93
 v_mov_b32 v24, s92
 v_mov_b32 v23, s41
 ds_write_b32 v23, v24
 WL 0
L_A_sy2:
 s_barrier
 v_mov_b32 v23, s41
 ds_read_b32 v24, v23
 WL 0
 v_readfirstlane_b32 s92, v24
 s_nop 1
 s_and_b32 s78, s92, 0xff
 s_bfe_u32 s79, s92, 0x80008
 s_lshr_b32 s58, s92, 16
 s_xor_b32 s41, s41, 12
 s_setpc_b64 s[66:67]
L_roleA_end:
.p2align 6
L_roleM:
 v_lshrrev_b32 v48, 4, v0
 v_and_b32 v49, 15, v0
 v_bfe_u32 v50, v0, 1, 3
 v_xor_b32 v50, v50, v48
 v_lshlrev_b32 v49, 7, v49
 v_add_u32 v49, s6, v49
 v_lshl_add_u32 v20, v50, 4, v49
 v_xor_b32 v21, 64, v20
 v_mov_b32 v56, 0
 v_mov_b32 v57, 0
 v_mov_b32 v58, 0
 v_mov_b32 v59, 0
 v_mov_b32 v60, 0
 v_mov_b32 v61, 0
 v_mov_b32 v62, 0
 v_mov_b32 v63, 0
 s_mov_b32 s97, 0x3f803f80
 s_waitcnt vmcnt(17)
 ds_read_b128 v[112:115], v20 offset:0
 ds_read_b128 v[116:119], v20 offset:2048
 ds_read_b128 v[120:123], v21 offset:0
 ds_read_b128 v[124:127], v21 offset:2048
 s_add_u32 m0, s6, 0x5000
 s_add_u32 s70, s7, 0x280
 buffer_load_dwordx4 v16, s[8:11], s70 offen lds
 buffer_load_dwordx4 v17, s[8:11], s70 offen offset:1024 lds
 buffer_load_dwordx4 v18, s[8:11], s70 offen offset:2048 lds
 buffer_load_dwordx4 v19, s[8:11], s70 offen offset:3072 lds
 s_lshl_b32 s92, s64, 2
 s_add_u32 s92, s92, s62
 s_lshl_b32 s92, s92, 16
 v_or_b32 v38, s92, v0
 s_mul_i32 s86, s63, 3
 s_lshl_b32 s59, s86, 8
 s_mul_i32 s71, s62, 0x80000
 s_add_u32 s71, s71, s59
 s_lshl_b32 s72, s62, 16
 s_add_u32 s72, s72, s59
 s_add_u32 s72, s72, 0x200000
 s_lshr_b32 s3, s62, 1
 s_lshl_b32 s3, s3, 13
 s_and_b32 s4, s62, 1
 s_lshl_b32 s4, s4, 11
 s_add_u32 s3, s3, s4
 s_sub_u32 s3, s3, 64
 s_lshl_b32 s4, s62, 11
 s_lshr_b32 s40, s86, 1
 s_lshl_b32 s40, s40, 19
 s_waitcnt vmcnt(17)
 ds_read_b128 v[128:131], v20 offset:4096
 ds_read_b128 v[132:135], v20 offset:6144
 ds_read_b128 v[136:139], v21 offset:4096
 ds_read_b128 v[140:143], v21 offset:6144
 s_add_u32 m0, s6, 0x6000
 s_add_u32 s70, s7, 0x300
 buffer_load_dwordx4 v16, s[8:11], s70 offen lds
 buffer_load_dwordx4 v17, s[8:11], s70 offen offset:1024 lds
 buffer_load_dwordx4 v18, s[8:11], s70 offen offset:2048 lds
 buffer_load_dwordx4 v19, s[8:11], s70 offen offset:3072 lds
 s_add_u32 s40, s40, 0x60000
 s_add_u32 s77, s40, s4
 s_add_u32 s80, s40, s3
 s_mul_i32 s42, s86, 0x24000
 s_mul_i32 s83, s62, 0x12000
 s_add_u32 s83, s83, s42
 s_mov_b32 s44, 0x2080
 s_mov_b32 s45, 0x23c0
 s_mul_i32 s73, s62, 0x90000
 s_add_u32 s73, s73, s44
 s_mul_i32 s74, s62, 0x12000
 s_add_u32 s74, s74, s44
 s_add_u32 s74, s74, 0x240000
 s_mul_i32 s75, s62, 0x120000
 s_add_u32 s75, s75, s45
 s_mul_i32 s76, s62, 0x24000
 s_add_u32 s76, s76, s45
 s_add_u32 s76, s76, 0x480000
 s_mul_i32 s46, s44, 0x240
 s_mul_i32 s47, s45, 0x240
 WL 4
 v_dot2c_f32_bf16 v56, s97, v112
 v_dot2c_f32_bf16 v60, v112, v112
 v_dot2c_f32_bf16 v57, s97, v113
 v_dot2c_f32_bf16 v61, v113, v113
 v_dot2c_f32_bf16 v56, s97, v114
 v_dot2c_f32_bf16 v60, v114, v114
 v_dot2c_f32_bf16 v57, s97, v115
 v_dot2c_f32_bf16 v61, v115, v115
 v_dot2c_f32_bf16 v58, s97, v116
 v_dot2c_f32_bf16 v62, v116, v116
 v_dot2c_f32_bf16 v59, s97, v117
 v_dot2c_f32_bf16 v63, v117, v117
 v_dot2c_f32_bf16 v58, s97, v118
 v_dot2c_f32_bf16 v62, v118, v118
 v_dot2c_f32_bf16 v59, s97, v119
 v_dot2c_f32_bf16 v63, v119, v119
 v_dot2c_f32_bf16 v56, s97, v120
 v_dot2c_f32_bf16 v60, v120, v120
 v_dot2c_f32_bf16 v57, s97, v121
 v_dot2c_f32_bf16 v61, v121, v121
 v_dot2c_f32_bf16 v56, s97, v122
 v_dot2c_f32_bf16 v60, v122, v122
 v_dot2c_f32_bf16 v57, s97, v123
 v_dot2c_f32_bf16 v61, v123, v123
 v_dot2c_f32_bf16 v58, s97, v124
 v_dot2c_f32_bf16 v62, v124, v124
 v_dot2c_f32_bf16 v59, s97, v125
 v_dot2c_f32_bf16 v63, v125, v125
 v_dot2c_f32_bf16 v58, s97, v126
 v_dot2c_f32_bf16 v62, v126, v126
 v_dot2c_f32_bf16 v59, s97, v127
 v_dot2c_f32_bf16 v63, v127, v127
 s_waitcnt vmcnt(17)
 ds_read_b128 v[144:147], v20 offset:8192
 ds_read_b128 v[148:151], v20 offset:10240
 ds_read_b128 v[152:155], v21 offset:8192
 ds_read_b128 v[156:159], v21 offset:10240
 s_add_u32 m0, s6, 0x7000
 s_add_u32 s70, s7, 0x380
 buffer_load_dwordx4 v16, s[8:11], s70 offen lds
 buffer_load_dwordx4 v17, s[8:11], s70 offen offset:1024 lds
 buffer_load_dwordx4 v18, s[8:11], s70 offen offset:2048 lds
 buffer_load_dwordx4 v19, s[8:11], s70 offen offset:3072 lds
 s_mul_i32 s84, s62, 0x12000
 s_add_u32 s84, s84, s46
 s_mul_i32 s85, s62, 0x1200
 s_add_u32 s86, s85, s47
 s_add_u32 s85, s85, s46
 s_add_u32 s85, s85, 0x48000
 s_mov_b32 s93, s59
 v_bfe_u32 v40, v38, 16, 5
 v_and_b32 v36, 63, v38
 v_min_u32 v36, 17, v36
 v_mad_u32_u24 v36, v40, 18, v36
 s_mov_b32 s92, 0x2000
 v_mul_u32_u24 v36, s92, v36
 s_add_u32 s3, s93, 0
 s_add_u32 s93, s63, 0
 s_mul_i32 s90, s93, 0x240000
 s_lshl_b32 s93, s64, 2
 s_add_u32 s93, s93, s62
 s_mul_i32 s93, s93, 0x9000
 s_add_u32 s90, s90, s93
 WL 4
 v_dot2c_f32_bf16 v56, s97, v128
 v_dot2c_f32_bf16 v60, v128, v128
 v_dot2c_f32_bf16 v57, s97, v129
 v_dot2c_f32_bf16 v61, v129, v129
 v_dot2c_f32_bf16 v56, s97, v130
 v_dot2c_f32_bf16 v60, v130, v130
 v_dot2c_f32_bf16 v57, s97, v131
 v_dot2c_f32_bf16 v61, v131, v131
 v_dot2c_f32_bf16 v58, s97, v132
 v_dot2c_f32_bf16 v62, v132, v132
 v_dot2c_f32_bf16 v59, s97, v133
 v_dot2c_f32_bf16 v63, v133, v133
 v_dot2c_f32_bf16 v58, s97, v134
 v_dot2c_f32_bf16 v62, v134, v134
 v_dot2c_f32_bf16 v59, s97, v135
 v_dot2c_f32_bf16 v63, v135, v135
 v_dot2c_f32_bf16 v56, s97, v136
 v_dot2c_f32_bf16 v60, v136, v136
 v_dot2c_f32_bf16 v57, s97, v137
 v_dot2c_f32_bf16 v61, v137, v137
 v_dot2c_f32_bf16 v56, s97, v138
 v_dot2c_f32_bf16 v60, v138, v138
 v_dot2c_f32_bf16 v57, s97, v139
 v_dot2c_f32_bf16 v61, v139, v139
 v_dot2c_f32_bf16 v58, s97, v140
 v_dot2c_f32_bf16 v62, v140, v140
 v_dot2c_f32_bf16 v59, s97, v141
 v_dot2c_f32_bf16 v63, v141, v141
 v_dot2c_f32_bf16 v58, s97, v142
 v_dot2c_f32_bf16 v62, v142, v142
 v_dot2c_f32_bf16 v59, s97, v143
 v_dot2c_f32_bf16 v63, v143, v143
 s_waitcnt vmcnt(17)
 ds_read_b128 v[160:163], v20 offset:12288
 ds_read_b128 v[164:167], v20 offset:14336
 ds_read_b128 v[168:171], v21 offset:12288
 ds_read_b128 v[172:175], v21 offset:14336
 s_add_u32 m0, s6, 0x8000
 s_add_u32 s70, s7, 0x400
 buffer_load_dwordx4 v16, s[8:11], s70 offen lds
 buffer_load_dwordx4 v17, s[8:11], s70 offen offset:1024 lds
 buffer_load_dwordx4 v18, s[8:11], s70 offen offset:2048 lds
 buffer_load_dwordx4 v19, s[8:11], s70 offen offset:3072 lds
 s_add_u32 s5, s90, 0x240000
 s_lshl_b32 s92, s64, 14
 s_add_u32 s92, s92, 0x2f00000
 s_add_u32 s93, s63, 0
 s_lshl_b32 s93, s93, 2
 s_add_u32 s93, s93, s92
 s_cmp_eq_u32 s62, 0
 s_cselect_b32 s93, s93, 0x10000000
 s_cselect_b32 s92, s92, 0x10000000
 v_and_b32 v24, 15, v0
 v_lshlrev_b32 v25, 7, v24
 v_add_u32 v25, 0x80, v25
 v_cmp_eq_u32 vcc, 0, v24
 s_nop 1
 v_cndmask_b32 v25, v25, v24, vcc
 v_lshrrev_b32 v26, 4, v0
 v_lshl_add_u32 v25, v26, 2, v25
 v_add_u32 v25, s93, v25
 s_mov_b32 vcc_lo, 0xffffffff
 s_mov_b32 vcc_hi, 0
 v_mov_b32 v42, 0x10000000
 WL 4
 v_dot2c_f32_bf16 v56, s97, v144
 v_dot2c_f32_bf16 v60, v144, v144
 v_dot2c_f32_bf16 v57, s97, v145
 v_dot2c_f32_bf16 v61, v145, v145
 v_dot2c_f32_bf16 v56, s97, v146
 v_dot2c_f32_bf16 v60, v146, v146
 v_dot2c_f32_bf16 v57, s97, v147
 v_dot2c_f32_bf16 v61, v147, v147
 v_dot2c_f32_bf16 v58, s97, v148
 v_dot2c_f32_bf16 v62, v148, v148
 v_dot2c_f32_bf16 v59, s97, v149
 v_dot2c_f32_bf16 v63, v149, v149
 v_dot2c_f32_bf16 v58, s97, v150
 v_dot2c_f32_bf16 v62, v150, v150
 v_dot2c_f32_bf16 v59, s97, v151
 v_dot2c_f32_bf16 v63, v151, v151
 v_dot2c_f32_bf16 v56, s97, v152
 v_dot2c_f32_bf16 v60, v152, v152
 v_dot2c_f32_bf16 v57, s97, v153
 v_dot2c_f32_bf16 v61, v153, v153
 v_dot2c_f32_bf16 v56, s97, v154
 v_dot2c_f32_bf16 v60, v154, v154
 v_dot2c_f32_bf16 v57, s97, v155
 v_dot2c_f32_bf16 v61, v155, v155
 v_dot2c_f32_bf16 v58, s97, v156
 v_dot2c_f32_bf16 v62, v156, v156
 v_dot2c_f32_bf16 v59, s97, v157
 v_dot2c_f32_bf16 v63, v157, v157
 v_dot2c_f32_bf16 v58, s97, v158
 v_dot2c_f32_bf16 v62, v158, v158
 v_dot2c_f32_bf16 v59, s97, v159
 v_dot2c_f32_bf16 v63, v159, v159
 s_waitcnt vmcnt(17)
 ds_read_b128 v[176:179], v20 offset:16384
 ds_read_b128 v[180:183], v20 offset:18432
 ds_read_b128 v[184:187], v21 offset:16384
 ds_read_b128 v[188:191], v21 offset:18432
 s_nop 1
 v_cndmask_b32 v42, v42, v25, vcc
 v_mov_b32 v24, v42
 v_and_b32 v26, 15, v0
 v_lshlrev_b32 v26, 8, v26
 s_add_u32 s92, s92, 0x1000
 v_add_u32 v26, s92, v26
 v_mov_b32 v27, 20
 v_mov_b32 v25, 25
 v_cmp_lt_u32 vcc, 15, v0
 s_nop 1
 v_cndmask_b32 v27, v27, v25, vcc
 v_lshl_add_u32 v26, v27, 2, v26
 v_mov_b32 v25, 0
 buffer_store_dword v25, v26, s[36:39], 0 offen sc1
 v_mov_b32 v25, 0
 buffer_store_dword v25, v24, s[36:39], 0 offen sc1
 s_lshl_b32 s92, s64, 4
 s_cmp_eq_u32 s62, 0
 s_cselect_b32 s92, s92, 0x100
 v_mov_b32 v23, 0x100
 WL 4
 v_dot2c_f32_bf16 v56, s97, v160
 v_dot2c_f32_bf16 v60, v160, v160
 v_dot2c_f32_bf16 v57, s97, v161
 v_dot2c_f32_bf16 v61, v161, v161
 v_dot2c_f32_bf16 v56, s97, v162
 v_dot2c_f32_bf16 v60, v162, v162
 v_dot2c_f32_bf16 v57, s97, v163
 v_dot2c_f32_bf16 v61, v163, v163
 v_dot2c_f32_bf16 v58, s97, v164
 v_dot2c_f32_bf16 v62, v164, v164
 v_dot2c_f32_bf16 v59, s97, v165
 v_dot2c_f32_bf16 v63, v165, v165
 v_dot2c_f32_bf16 v58, s97, v166
 v_dot2c_f32_bf16 v62, v166, v166
 v_dot2c_f32_bf16 v59, s97, v167
 v_dot2c_f32_bf16 v63, v167, v167
 v_dot2c_f32_bf16 v56, s97, v168
 v_dot2c_f32_bf16 v60, v168, v168
 v_dot2c_f32_bf16 v57, s97, v169
 v_dot2c_f32_bf16 v61, v169, v169
 v_dot2c_f32_bf16 v56, s97, v170
 v_dot2c_f32_bf16 v60, v170, v170
 v_dot2c_f32_bf16 v57, s97, v171
 v_dot2c_f32_bf16 v61, v171, v171
 v_dot2c_f32_bf16 v58, s97, v172
 v_dot2c_f32_bf16 v62, v172, v172
 v_dot2c_f32_bf16 v59, s97, v173
 v_dot2c_f32_bf16 v63, v173, v173
 v_dot2c_f32_bf16 v58, s97, v174
 v_dot2c_f32_bf16 v62, v174, v174
 v_dot2c_f32_bf16 v59, s97, v175
 v_dot2c_f32_bf16 v63, v175, v175
 s_waitcnt vmcnt(14)
 ds_read_b128 v[192:195], v20 offset:20480
 ds_read_b128 v[196:199], v20 offset:22528
 ds_read_b128 v[200:203], v21 offset:20480
 ds_read_b128 v[204:207], v21 offset:22528
 v_writelane_b32 v23, s92, 0
 v_lshrrev_b32 v24, 4, v0
 v_bfe_u32 v25, v0, 2, 2
 v_and_b32 v26, 3, v0
 v_bfe_u32 v27, v0, 3, 1
 v_and_b32 v28, 7, v0
 v_bfe_u32 v29, v0, 4, 1
 v_lshlrev_b32 v29, 1, v29
 v_xor_b32 v28, v28, v29
 v_lshlrev_b32 v2, 4, v28
 v_lshrrev_b32 v28, 5, v0
 v_and_b32 v29, 3, v1
 v_lshl_add_u32 v41, v28, 4, v29
 s_mov_b32 s92, 0x440
 v_mul_u32_u24 v28, s92, v24
 v_lshl_add_u32 v28, v25, 7, v28
 v_lshl_add_u32 v28, v26, 3, v28
 v_lshl_add_u32 v9, v27, 5, v28
 v_mov_b32 v44, v9
 v_xor_b32 v10, 32, v9
 WL 4
 v_dot2c_f32_bf16 v56, s97, v176
 v_dot2c_f32_bf16 v60, v176, v176
 v_dot2c_f32_bf16 v57, s97, v177
 v_dot2c_f32_bf16 v61, v177, v177
 v_dot2c_f32_bf16 v56, s97, v178
 v_dot2c_f32_bf16 v60, v178, v178
 v_dot2c_f32_bf16 v57, s97, v179
 v_dot2c_f32_bf16 v61, v179, v179
 v_dot2c_f32_bf16 v58, s97, v180
 v_dot2c_f32_bf16 v62, v180, v180
 v_dot2c_f32_bf16 v59, s97, v181
 v_dot2c_f32_bf16 v63, v181, v181
 v_dot2c_f32_bf16 v58, s97, v182
 v_dot2c_f32_bf16 v62, v182, v182
 v_dot2c_f32_bf16 v59, s97, v183
 v_dot2c_f32_bf16 v63, v183, v183
 v_dot2c_f32_bf16 v56, s97, v184
 v_dot2c_f32_bf16 v60, v184, v184
 v_dot2c_f32_bf16 v57, s97, v185
 v_dot2c_f32_bf16 v61, v185, v185
 v_dot2c_f32_bf16 v56, s97, v186
 v_dot2c_f32_bf16 v60, v186, v186
 v_dot2c_f32_bf16 v57, s97, v187
 v_dot2c_f32_bf16 v61, v187, v187
 v_dot2c_f32_bf16 v58, s97, v188
 v_dot2c_f32_bf16 v62, v188, v188
 v_dot2c_f32_bf16 v59, s97, v189
 v_dot2c_f32_bf16 v63, v189, v189
 v_dot2c_f32_bf16 v58, s97, v190
 v_dot2c_f32_bf16 v62, v190, v190
 v_dot2c_f32_bf16 v59, s97, v191
 v_dot2c_f32_bf16 v63, v191, v191
 s_waitcnt vmcnt(10)
 ds_read_b128 v[208:211], v20 offset:24576
 ds_read_b128 v[212:215], v20 offset:26624
 ds_read_b128 v[216:219], v21 offset:24576
 ds_read_b128 v[220:223], v21 offset:26624
 v_add_u32 v11, 0x10000, v9
 v_add_u32 v12, 0x10000, v10
 v_add_u32 v13, 0x20000, v9
 v_add_u32 v14, 0x20000, v10
 v_lshlrev_b32 v28, 9, v24
 v_lshl_add_u32 v28, v25, 6, v28
 v_lshl_add_u32 v28, v26, 3, v28
 v_and_b32 v29, 1, v24
 v_lshl_add_u32 v15, v29, 5, v28
 v_xor_b32 v37, 32, v15
 v_lshrrev_b32 v28, 5, v0
 v_lshlrev_b32 v28, 1, v28
 v_xor_b32 v28, v28, v26
 v_lshlrev_b32 v28, 4, v28
 v_lshrrev_b32 v29, 2, v0
 s_mov_b32 s92, 0x2400
 v_mad_u32_u24 v7, v29, s92, v28
 v_and_b32 v28, 15, v0
 v_xor_b32 v28, v28, v24
 v_lshlrev_b32 v28, 4, v28
 WL 4
 v_dot2c_f32_bf16 v56, s97, v192
 v_dot2c_f32_bf16 v60, v192, v192
 v_dot2c_f32_bf16 v57, s97, v193
 v_dot2c_f32_bf16 v61, v193, v193
 v_dot2c_f32_bf16 v56, s97, v194
 v_dot2c_f32_bf16 v60, v194, v194
 v_dot2c_f32_bf16 v57, s97, v195
 v_dot2c_f32_bf16 v61, v195, v195
 v_dot2c_f32_bf16 v58, s97, v196
 v_dot2c_f32_bf16 v62, v196, v196
 v_dot2c_f32_bf16 v59, s97, v197
 v_dot2c_f32_bf16 v63, v197, v197
 v_dot2c_f32_bf16 v58, s97, v198
 v_dot2c_f32_bf16 v62, v198, v198
 v_dot2c_f32_bf16 v59, s97, v199
 v_dot2c_f32_bf16 v63, v199, v199
 v_dot2c_f32_bf16 v56, s97, v200
 v_dot2c_f32_bf16 v60, v200, v200
 v_dot2c_f32_bf16 v57, s97, v201
 v_dot2c_f32_bf16 v61, v201, v201
 v_dot2c_f32_bf16 v56, s97, v202
 v_dot2c_f32_bf16 v60, v202, v202
 v_dot2c_f32_bf16 v57, s97, v203
 v_dot2c_f32_bf16 v61, v203, v203
 v_dot2c_f32_bf16 v58, s97, v204
 v_dot2c_f32_bf16 v62, v204, v204
 v_dot2c_f32_bf16 v59, s97, v205
 v_dot2c_f32_bf16 v63, v205, v205
 v_dot2c_f32_bf16 v58, s97, v206
 v_dot2c_f32_bf16 v62, v206, v206
 v_dot2c_f32_bf16 v59, s97, v207
 v_dot2c_f32_bf16 v63, v207, v207
 s_waitcnt vmcnt(6)
 ds_read_b128 v[224:227], v20 offset:28672
 ds_read_b128 v[228:231], v20 offset:30720
 ds_read_b128 v[232:235], v21 offset:28672
 ds_read_b128 v[236:239], v21 offset:30720
 v_lshl_add_u32 v8, v24, 8, v28
 s_mov_b32 s92, 0x2000
 v_mad_u32_u24 v3, v1, s92, v2
 v_add_u32 v4, 0xfbc0, v3
 v_add_u32 v5, 0xfbc0, v4
 v_add_u32 v6, 0xfbc0, v5
 v_and_b32 v28, 15, v0
 v_bfe_u32 v29, v0, 1, 3
 v_xor_b32 v29, v29, v24
 v_lshlrev_b32 v28, 7, v28
 v_add_u32 v28, s6, v28
 v_lshl_add_u32 v20, v29, 4, v28
 v_xor_b32 v21, 64, v20
 s_mov_b32 s92, 0x440
 v_mul_u32_u24 v22, s92, v25
 v_lshl_add_u32 v22, v26, 8, v22
 v_xor_b32 v28, v24, v26
 v_lshl_add_u32 v22, v28, 4, v22
 v_lshlrev_b32 v0, 4, v0
 WL 4
 v_dot2c_f32_bf16 v56, s97, v208
 v_dot2c_f32_bf16 v60, v208, v208
 v_dot2c_f32_bf16 v57, s97, v209
 v_dot2c_f32_bf16 v61, v209, v209
 v_dot2c_f32_bf16 v56, s97, v210
 v_dot2c_f32_bf16 v60, v210, v210
 v_dot2c_f32_bf16 v57, s97, v211
 v_dot2c_f32_bf16 v61, v211, v211
 v_dot2c_f32_bf16 v58, s97, v212
 v_dot2c_f32_bf16 v62, v212, v212
 v_dot2c_f32_bf16 v59, s97, v213
 v_dot2c_f32_bf16 v63, v213, v213
 v_dot2c_f32_bf16 v58, s97, v214
 v_dot2c_f32_bf16 v62, v214, v214
 v_dot2c_f32_bf16 v59, s97, v215
 v_dot2c_f32_bf16 v63, v215, v215
 v_dot2c_f32_bf16 v56, s97, v216
 v_dot2c_f32_bf16 v60, v216, v216
 v_dot2c_f32_bf16 v57, s97, v217
 v_dot2c_f32_bf16 v61, v217, v217
 v_dot2c_f32_bf16 v56, s97, v218
 v_dot2c_f32_bf16 v60, v218, v218
 v_dot2c_f32_bf16 v57, s97, v219
 v_dot2c_f32_bf16 v61, v219, v219
 v_dot2c_f32_bf16 v58, s97, v220
 v_dot2c_f32_bf16 v62, v220, v220
 v_dot2c_f32_bf16 v59, s97, v221
 v_dot2c_f32_bf16 v63, v221, v221
 v_dot2c_f32_bf16 v58, s97, v222
 v_dot2c_f32_bf16 v62, v222, v222
 v_dot2c_f32_bf16 v59, s97, v223
 v_dot2c_f32_bf16 v63, v223, v223
 s_waitcnt vmcnt(2)
 ds_read_b128 v[240:243], v20 offset:32768
 ds_read_b128 v[244:247], v20 offset:34816
 ds_read_b128 v[248:251], v21 offset:32768
 ds_read_b128 v[252:255], v21 offset:34816
 WL 4
 v_dot2c_f32_bf16 v56, s97, v224
 v_dot2c_f32_bf16 v60, v224, v224
 v_dot2c_f32_bf16 v57, s97, v225
 v_dot2c_f32_bf16 v61, v225, v225
 v_dot2c_f32_bf16 v56, s97, v226
 v_dot2c_f32_bf16 v60, v226, v226
 v_dot2c_f32_bf16 v57, s97, v227
 v_dot2c_f32_bf16 v61, v227, v227
 v_dot2c_f32_bf16 v58, s97, v228
 v_dot2c_f32_bf16 v62, v228, v228
 v_dot2c_f32_bf16 v59, s97, v229
 v_dot2c_f32_bf16 v63, v229, v229
 v_dot2c_f32_bf16 v58, s97, v230
 v_dot2c_f32_bf16 v62, v230, v230
 v_dot2c_f32_bf16 v59, s97, v231
 v_dot2c_f32_bf16 v63, v231, v231
 v_dot2c_f32_bf16 v56, s97, v232
 v_dot2c_f32_bf16 v60, v232, v232
 v_dot2c_f32_bf16 v57, s97, v233
 v_dot2c_f32_bf16 v61, v233, v233
 v_dot2c_f32_bf16 v56, s97, v234
 v_dot2c_f32_bf16 v60, v234, v234
 v_dot2c_f32_bf16 v57, s97, v235
 v_dot2c_f32_bf16 v61, v235, v235
 v_dot2c_f32_bf16 v58, s97, v236
 v_dot2c_f32_bf16 v62, v236, v236
 v_dot2c_f32_bf16 v59, s97, v237
 v_dot2c_f32_bf16 v63, v237, v237
 v_dot2c_f32_bf16 v58, s97, v238
 v_dot2c_f32_bf16 v62, v238, v238
 v_dot2c_f32_bf16 v59, s97, v239
 v_dot2c_f32_bf16 v63, v239, v239
 WL 0
 s_barrier
 s_add_u32 m0, s65, 0
 s_add_u32 s70, s71, 0
 buffer_load_dwordx4 v3, s[20:23], s70 offen lds
 buffer_load_dwordx4 v4, s[20:23], s70 offen offset:1088 lds
 buffer_load_dwordx4 v5, s[20:23], s70 offen offset:2176 lds
 v_dot2c_f32_bf16 v56, s97, v240
 v_dot2c_f32_bf16 v60, v240, v240
 v_dot2c_f32_bf16 v57, s97, v241
 v_dot2c_f32_bf16 v61, v241, v241
 v_dot2c_f32_bf16 v56, s97, v242
 v_dot2c_f32_bf16 v60, v242, v242
 v_dot2c_f32_bf16 v57, s97, v243
 v_dot2c_f32_bf16 v61, v243, v243
 v_dot2c_f32_bf16 v58, s97, v244
 v_dot2c_f32_bf16 v62, v244, v244
 v_dot2c_f32_bf16 v59, s97, v245
 v_dot2c_f32_bf16 v63, v245, v245
 v_dot2c_f32_bf16 v58, s97, v246
 v_dot2c_f32_bf16 v62, v246, v246
 v_dot2c_f32_bf16 v59, s97, v247
 v_dot2c_f32_bf16 v63, v247, v247
 v_dot2c_f32_bf16 v56, s97, v248
 v_dot2c_f32_bf16 v60, v248, v248
 v_dot2c_f32_bf16 v57, s97, v249
 v_dot2c_f32_bf16 v61, v249, v249
 v_dot2c_f32_bf16 v56, s97, v250
 v_dot2c_f32_bf16 v60, v250, v250
 v_dot2c_f32_bf16 v57, s97, v251
 v_dot2c_f32_bf16 v61, v251, v251
 v_dot2c_f32_bf16 v58, s97, v252
 v_dot2c_f32_bf16 v62, v252, v252
 v_dot2c_f32_bf16 v59, s97, v253
 v_dot2c_f32_bf16 v63, v253, v253
 v_dot2c_f32_bf16 v58, s97, v254
 v_dot2c_f32_bf16 v62, v254, v254
 v_dot2c_f32_bf16 v59, s97, v255
 v_dot2c_f32_bf16 v63, v255, v255
 AD 56,56,57
 s_nop 0
 AD 58,58,59
 AD 60,60,61
 AD 62,62,63
 v_mov_b32 v57, v56
 v_mov_b32 v59, v58
 v_mov_b32 v61, v60
 v_mov_b32 v63, v62
 v_permlane16_swap_b32 v56, v57
 v_permlane16_swap_b32 v58, v59
 v_permlane16_swap_b32 v60, v61
 v_permlane16_swap_b32 v62, v63
 AD 56,56,57
 AD 58,58,59
 AD 60,60,61
 AD 62,62,63
 v_mov_b32 v57, v56
 v_mov_b32 v59, v58
 v_mov_b32 v61, v60
 v_mov_b32 v63, v62
 v_permlane32_swap_b32 v56, v57
 v_permlane32_swap_b32 v58, v59
 v_permlane32_swap_b32 v60, v61
 v_permlane32_swap_b32 v62, v63
 AD 56,56,57
 AD 58,58,59
 AD 60,60,61
 AD 62,62,63
 v_mul_f32 v56, 0x3ae38e39, v56
 v_mul_f32 v58, 0x3ae38e39, v58
 v_mul_f32 v60, 0x3ae38e39, v60
 v_mul_f32 v62, 0x3ae38e39, v62
 v_fma_f32 v60, -v56, v56, v60
 v_fma_f32 v62, -v58, v58, v62
 v_max_f32 v60, 0, v60
 v_max_f32 v62, 0, v62
 v_add_f32 v60, 0x3727c5ac, v60
 v_add_f32 v62, 0x3727c5ac, v62
 v_rsq_f32 v60, v60
 v_rsq_f32 v62, v62
 v_mul_f32 v60, 0xbfb8aa3b, v60
 v_mul_f32 v62, 0xbfb8aa3b, v62
 v_mov_b32 v20, v56
 v_mov_b32 v21, v58
 v_mul_f32 v56, -v56, v60
 v_mul_f32 v58, -v58, v62
 s_mov_b32 s92, 0xffff0000
 v_cvt_pk_bf16_f32 v57, v60, 0
 v_cvt_pk_bf16_f32 v59, v62, 0
 v_lshlrev_b32 v61, 16, v57
 v_lshlrev_b32 v63, 16, v59
 v_mul_f32 v56, -v20, v61
 v_mul_f32 v58, -v21, v63
 v_dot2_f32_bf16 v24, v112, v57, v56
 v_dot2_f32_bf16 v25, v112, v61, v56
 v_dot2_f32_bf16 v26, v113, v57, v56
 v_dot2_f32_bf16 v27, v113, v61, v56
 v_dot2_f32_bf16 v16, v114, v57, v56
 v_dot2_f32_bf16 v17, v114, v61, v56
 v_dot2_f32_bf16 v18, v115, v57, v56
 v_dot2_f32_bf16 v19, v115, v61, v56
 CV 112,24,25
 CV 113,26,27
 CV 114,16,17
 CV 115,18,19
 buffer_load_dwordx4 v6, s[20:23], s70 offen offset:3264 lds
 v_dot2_f32_bf16 v24, v116, v59, v58
 v_dot2_f32_bf16 v25, v116, v63, v58
 v_dot2_f32_bf16 v26, v117, v59, v58
 v_dot2_f32_bf16 v27, v117, v63, v58
 v_dot2_f32_bf16 v16, v118, v59, v58
 v_dot2_f32_bf16 v17, v118, v63, v58
 v_dot2_f32_bf16 v18, v119, v59, v58
 v_dot2_f32_bf16 v19, v119, v63, v58
 CV 116,24,25
 CV 117,26,27
 CV 118,16,17
 CV 119,18,19
 s_add_u32 m0, m0, 0x1100
 s_add_u32 s70, s71, 0x40000
 buffer_load_dwordx4 v3, s[20:23], s70 offen lds
 v_dot2_f32_bf16 v24, v120, v57, v56
 v_dot2_f32_bf16 v25, v120, v61, v56
 v_dot2_f32_bf16 v26, v121, v57, v56
 v_dot2_f32_bf16 v27, v121, v61, v56
 v_dot2_f32_bf16 v16, v122, v57, v56
 v_dot2_f32_bf16 v17, v122, v61, v56
 v_dot2_f32_bf16 v18, v123, v57, v56
 v_dot2_f32_bf16 v19, v123, v61, v56
 CV 120,24,25
 CV 121,26,27
 CV 122,16,17
 CV 123,18,19
 buffer_load_dwordx4 v4, s[20:23], s70 offen offset:1088 lds
 v_dot2_f32_bf16 v24, v124, v59, v58
 v_dot2_f32_bf16 v25, v124, v63, v58
 v_dot2_f32_bf16 v26, v125, v59, v58
 v_dot2_f32_bf16 v27, v125, v63, v58
 v_dot2_f32_bf16 v16, v126, v59, v58
 v_dot2_f32_bf16 v17, v126, v63, v58
 v_dot2_f32_bf16 v18, v127, v59, v58
 v_dot2_f32_bf16 v19, v127, v63, v58
 CV 124,24,25
 CV 125,26,27
 CV 126,16,17
 CV 127,18,19
 buffer_load_dwordx4 v5, s[20:23], s70 offen offset:2176 lds
 v_dot2_f32_bf16 v24, v128, v57, v56
 v_dot2_f32_bf16 v25, v128, v61, v56
 v_dot2_f32_bf16 v26, v129, v57, v56
 v_dot2_f32_bf16 v27, v129, v61, v56
 v_dot2_f32_bf16 v16, v130, v57, v56
 v_dot2_f32_bf16 v17, v130, v61, v56
 v_dot2_f32_bf16 v18, v131, v57, v56
 v_dot2_f32_bf16 v19, v131, v61, v56
 CV 128,24,25
 CV 129,26,27
 CV 130,16,17
 CV 131,18,19
 buffer_load_dwordx4 v6, s[20:23], s70 offen offset:3264 lds
 v_dot2_f32_bf16 v24, v132, v59, v58
 v_dot2_f32_bf16 v25, v132, v63, v58
 v_dot2_f32_bf16 v26, v133, v59, v58
 v_dot2_f32_bf16 v27, v133, v63, v58
 v_dot2_f32_bf16 v16, v134, v59, v58
 v_dot2_f32_bf16 v17, v134, v63, v58
 v_dot2_f32_bf16 v18, v135, v59, v58
 v_dot2_f32_bf16 v19, v135, v63, v58
 CV 132,24,25
 CV 133,26,27
 CV 134,16,17
 CV 135,18,19
 s_add_u32 m0, s66, 0
 s_add_u32 s70, s72, 0
 buffer_load_dwordx4 v3, s[20:23], s70 offen lds
 v_dot2_f32_bf16 v24, v136, v57, v56
 v_dot2_f32_bf16 v25, v136, v61, v56
 v_dot2_f32_bf16 v26, v137, v57, v56
 v_dot2_f32_bf16 v27, v137, v61, v56
 v_dot2_f32_bf16 v16, v138, v57, v56
 v_dot2_f32_bf16 v17, v138, v61, v56
 v_dot2_f32_bf16 v18, v139, v57, v56
 v_dot2_f32_bf16 v19, v139, v61, v56
 CV 136,24,25
 CV 137,26,27
 CV 138,16,17
 CV 139,18,19
 s_add_u32 m0, s65, 0x9900
 s_add_u32 s70, s71, 0x240000
 buffer_load_dwordx4 v3, s[20:23], s70 offen lds
 v_dot2_f32_bf16 v24, v140, v59, v58
 v_dot2_f32_bf16 v25, v140, v63, v58
 v_dot2_f32_bf16 v26, v141, v59, v58
 v_dot2_f32_bf16 v27, v141, v63, v58
 v_dot2_f32_bf16 v16, v142, v59, v58
 v_dot2_f32_bf16 v17, v142, v63, v58
 v_dot2_f32_bf16 v18, v143, v59, v58
 v_dot2_f32_bf16 v19, v143, v63, v58
 CV 140,24,25
 CV 141,26,27
 CV 142,16,17
 CV 143,18,19
 buffer_load_dwordx4 v4, s[20:23], s70 offen offset:1088 lds
 v_dot2_f32_bf16 v24, v144, v57, v56
 v_dot2_f32_bf16 v25, v144, v61, v56
 v_dot2_f32_bf16 v26, v145, v57, v56
 v_dot2_f32_bf16 v27, v145, v61, v56
 v_dot2_f32_bf16 v16, v146, v57, v56
 v_dot2_f32_bf16 v17, v146, v61, v56
 v_dot2_f32_bf16 v18, v147, v57, v56
 v_dot2_f32_bf16 v19, v147, v61, v56
 CV 144,24,25
 CV 145,26,27
 CV 146,16,17
 CV 147,18,19
 buffer_load_dwordx4 v5, s[20:23], s70 offen offset:2176 lds
 v_dot2_f32_bf16 v24, v148, v59, v58
 v_dot2_f32_bf16 v25, v148, v63, v58
 v_dot2_f32_bf16 v26, v149, v59, v58
 v_dot2_f32_bf16 v27, v149, v63, v58
 v_dot2_f32_bf16 v16, v150, v59, v58
 v_dot2_f32_bf16 v17, v150, v63, v58
 v_dot2_f32_bf16 v18, v151, v59, v58
 v_dot2_f32_bf16 v19, v151, v63, v58
 CV 148,24,25
 CV 149,26,27
 CV 150,16,17
 CV 151,18,19
 buffer_load_dwordx4 v6, s[20:23], s70 offen offset:3264 lds
 v_dot2_f32_bf16 v24, v152, v57, v56
 v_dot2_f32_bf16 v25, v152, v61, v56
 v_dot2_f32_bf16 v26, v153, v57, v56
 v_dot2_f32_bf16 v27, v153, v61, v56
 v_dot2_f32_bf16 v16, v154, v57, v56
 v_dot2_f32_bf16 v17, v154, v61, v56
 v_dot2_f32_bf16 v18, v155, v57, v56
 v_dot2_f32_bf16 v19, v155, v61, v56
 CV 152,24,25
 CV 153,26,27
 CV 154,16,17
 CV 155,18,19
 s_add_u32 m0, m0, 0x1100
 s_add_u32 s70, s71, 0x280000
 buffer_load_dwordx4 v3, s[20:23], s70 offen lds
 v_dot2_f32_bf16 v24, v156, v59, v58
 v_dot2_f32_bf16 v25, v156, v63, v58
 v_dot2_f32_bf16 v26, v157, v59, v58
 v_dot2_f32_bf16 v27, v157, v63, v58
 v_dot2_f32_bf16 v16, v158, v59, v58
 v_dot2_f32_bf16 v17, v158, v63, v58
 v_dot2_f32_bf16 v18, v159, v59, v58
 v_dot2_f32_bf16 v19, v159, v63, v58
 CV 156,24,25
 CV 157,26,27
 CV 158,16,17
 CV 159,18,19
 buffer_load_dwordx4 v4, s[20:23], s70 offen offset:1088 lds
 v_dot2_f32_bf16 v24, v160, v57, v56
 v_dot2_f32_bf16 v25, v160, v61, v56
 v_dot2_f32_bf16 v26, v161, v57, v56
 v_dot2_f32_bf16 v27, v161, v61, v56
 v_dot2_f32_bf16 v16, v162, v57, v56
 v_dot2_f32_bf16 v17, v162, v61, v56
 v_dot2_f32_bf16 v18, v163, v57, v56
 v_dot2_f32_bf16 v19, v163, v61, v56
 CV 160,24,25
 CV 161,26,27
 CV 162,16,17
 CV 163,18,19
 buffer_load_dwordx4 v5, s[20:23], s70 offen offset:2176 lds
 v_dot2_f32_bf16 v24, v164, v59, v58
 v_dot2_f32_bf16 v25, v164, v63, v58
 v_dot2_f32_bf16 v26, v165, v59, v58
 v_dot2_f32_bf16 v27, v165, v63, v58
 v_dot2_f32_bf16 v16, v166, v59, v58
 v_dot2_f32_bf16 v17, v166, v63, v58
 v_dot2_f32_bf16 v18, v167, v59, v58
 v_dot2_f32_bf16 v19, v167, v63, v58
 CV 164,24,25
 CV 165,26,27
 CV 166,16,17
 CV 167,18,19
 buffer_load_dwordx4 v6, s[20:23], s70 offen offset:3264 lds
 v_dot2_f32_bf16 v24, v168, v57, v56
 v_dot2_f32_bf16 v25, v168, v61, v56
 v_dot2_f32_bf16 v26, v169, v57, v56
 v_dot2_f32_bf16 v27, v169, v61, v56
 v_dot2_f32_bf16 v16, v170, v57, v56
 v_dot2_f32_bf16 v17, v170, v61, v56
 v_dot2_f32_bf16 v18, v171, v57, v56
 v_dot2_f32_bf16 v19, v171, v61, v56
 CV 168,24,25
 CV 169,26,27
 CV 170,16,17
 CV 171,18,19
 s_add_u32 m0, s66, 0x9900
 s_add_u32 s70, s72, 0x240000
 buffer_load_dwordx4 v3, s[20:23], s70 offen lds
 v_dot2_f32_bf16 v24, v172, v59, v58
 v_dot2_f32_bf16 v25, v172, v63, v58
 v_dot2_f32_bf16 v26, v173, v59, v58
 v_dot2_f32_bf16 v27, v173, v63, v58
 v_dot2_f32_bf16 v16, v174, v59, v58
 v_dot2_f32_bf16 v17, v174, v63, v58
 v_dot2_f32_bf16 v18, v175, v59, v58
 v_dot2_f32_bf16 v19, v175, v63, v58
 CV 172,24,25
 CV 173,26,27
 CV 174,16,17
 CV 175,18,19
 s_add_u32 s3, s3, 0x80
 buffer_load_dword v47, v36, s[20:23], s3 offen
 v_dot2_f32_bf16 v24, v176, v57, v56
 v_dot2_f32_bf16 v25, v176, v61, v56
 v_dot2_f32_bf16 v26, v177, v57, v56
 v_dot2_f32_bf16 v27, v177, v61, v56
 v_dot2_f32_bf16 v16, v178, v57, v56
 v_dot2_f32_bf16 v17, v178, v61, v56
 v_dot2_f32_bf16 v18, v179, v57, v56
 v_dot2_f32_bf16 v19, v179, v61, v56
 CV 176,24,25
 CV 177,26,27
 CV 178,16,17
 CV 179,18,19
 s_add_u32 s3, s3, 0x80
 buffer_load_dword v47, v36, s[20:23], s3 offen
 v_dot2_f32_bf16 v24, v180, v59, v58
 v_dot2_f32_bf16 v25, v180, v63, v58
 v_dot2_f32_bf16 v26, v181, v59, v58
 v_dot2_f32_bf16 v27, v181, v63, v58
 v_dot2_f32_bf16 v16, v182, v59, v58
 v_dot2_f32_bf16 v17, v182, v63, v58
 v_dot2_f32_bf16 v18, v183, v59, v58
 v_dot2_f32_bf16 v19, v183, v63, v58
 CV 180,24,25
 CV 181,26,27
 CV 182,16,17
 CV 183,18,19
 v_dot2_f32_bf16 v24, v184, v57, v56
 v_dot2_f32_bf16 v25, v184, v61, v56
 v_dot2_f32_bf16 v26, v185, v57, v56
 v_dot2_f32_bf16 v27, v185, v61, v56
 v_dot2_f32_bf16 v16, v186, v57, v56
 v_dot2_f32_bf16 v17, v186, v61, v56
 v_dot2_f32_bf16 v18, v187, v57, v56
 v_dot2_f32_bf16 v19, v187, v61, v56
 CV 184,24,25
 CV 185,26,27
 CV 186,16,17
 CV 187,18,19
 v_dot2_f32_bf16 v24, v188, v59, v58
 v_dot2_f32_bf16 v25, v188, v63, v58
 v_dot2_f32_bf16 v26, v189, v59, v58
 v_dot2_f32_bf16 v27, v189, v63, v58
 v_dot2_f32_bf16 v16, v190, v59, v58
 v_dot2_f32_bf16 v17, v190, v63, v58
 v_dot2_f32_bf16 v18, v191, v59, v58
 v_dot2_f32_bf16 v19, v191, v63, v58
 CV 188,24,25
 CV 189,26,27
 CV 190,16,17
 CV 191,18,19
 v_dot2_f32_bf16 v24, v192, v57, v56
 v_dot2_f32_bf16 v25, v192, v61, v56
 v_dot2_f32_bf16 v26, v193, v57, v56
 v_dot2_f32_bf16 v27, v193, v61, v56
 v_dot2_f32_bf16 v16, v194, v57, v56
 v_dot2_f32_bf16 v17, v194, v61, v56
 v_dot2_f32_bf16 v18, v195, v57, v56
 v_dot2_f32_bf16 v19, v195, v61, v56
 CV 192,24,25
 CV 193,26,27
 CV 194,16,17
 CV 195,18,19
 v_dot2_f32_bf16 v24, v196, v59, v58
 v_dot2_f32_bf16 v25, v196, v63, v58
 v_dot2_f32_bf16 v26, v197, v59, v58
 v_dot2_f32_bf16 v27, v197, v63, v58
 v_dot2_f32_bf16 v16, v198, v59, v58
 v_dot2_f32_bf16 v17, v198, v63, v58
 v_dot2_f32_bf16 v18, v199, v59, v58
 v_dot2_f32_bf16 v19, v199, v63, v58
 CV 196,24,25
 CV 197,26,27
 CV 198,16,17
 CV 199,18,19
 v_dot2_f32_bf16 v24, v200, v57, v56
 v_dot2_f32_bf16 v25, v200, v61, v56
 v_dot2_f32_bf16 v26, v201, v57, v56
 v_dot2_f32_bf16 v27, v201, v61, v56
 v_dot2_f32_bf16 v16, v202, v57, v56
 v_dot2_f32_bf16 v17, v202, v61, v56
 v_dot2_f32_bf16 v18, v203, v57, v56
 v_dot2_f32_bf16 v19, v203, v61, v56
 CV 200,24,25
 CV 201,26,27
 CV 202,16,17
 CV 203,18,19
 v_dot2_f32_bf16 v24, v204, v59, v58
 v_dot2_f32_bf16 v25, v204, v63, v58
 v_dot2_f32_bf16 v26, v205, v59, v58
 v_dot2_f32_bf16 v27, v205, v63, v58
 v_dot2_f32_bf16 v16, v206, v59, v58
 v_dot2_f32_bf16 v17, v206, v63, v58
 v_dot2_f32_bf16 v18, v207, v59, v58
 v_dot2_f32_bf16 v19, v207, v63, v58
 CV 204,24,25
 CV 205,26,27
 CV 206,16,17
 CV 207,18,19
 v_dot2_f32_bf16 v24, v208, v57, v56
 v_dot2_f32_bf16 v25, v208, v61, v56
 v_dot2_f32_bf16 v26, v209, v57, v56
 v_dot2_f32_bf16 v27, v209, v61, v56
 v_dot2_f32_bf16 v16, v210, v57, v56
 v_dot2_f32_bf16 v17, v210, v61, v56
 v_dot2_f32_bf16 v18, v211, v57, v56
 v_dot2_f32_bf16 v19, v211, v61, v56
 CV 208,24,25
 CV 209,26,27
 CV 210,16,17
 CV 211,18,19
 v_dot2_f32_bf16 v24, v212, v59, v58
 v_dot2_f32_bf16 v25, v212, v63, v58
 v_dot2_f32_bf16 v26, v213, v59, v58
 v_dot2_f32_bf16 v27, v213, v63, v58
 v_dot2_f32_bf16 v16, v214, v59, v58
 v_dot2_f32_bf16 v17, v214, v63, v58
 v_dot2_f32_bf16 v18, v215, v59, v58
 v_dot2_f32_bf16 v19, v215, v63, v58
 CV 212,24,25
 CV 213,26,27
 CV 214,16,17
 CV 215,18,19
 v_dot2_f32_bf16 v24, v216, v57, v56
 v_dot2_f32_bf16 v25, v216, v61, v56
 v_dot2_f32_bf16 v26, v217, v57, v56
 v_dot2_f32_bf16 v27, v217, v61, v56
 v_dot2_f32_bf16 v16, v218, v57, v56
 v_dot2_f32_bf16 v17, v218, v61, v56
 v_dot2_f32_bf16 v18, v219, v57, v56
 v_dot2_f32_bf16 v19, v219, v61, v56
 CV 216,24,25
 CV 217,26,27
 CV 218,16,17
 CV 219,18,19
 v_dot2_f32_bf16 v24, v220, v59, v58
 v_dot2_f32_bf16 v25, v220, v63, v58
 v_dot2_f32_bf16 v26, v221, v59, v58
 v_dot2_f32_bf16 v27, v221, v63, v58
 v_dot2_f32_bf16 v16, v222, v59, v58
 v_dot2_f32_bf16 v17, v222, v63, v58
 v_dot2_f32_bf16 v18, v223, v59, v58
 v_dot2_f32_bf16 v19, v223, v63, v58
 CV 220,24,25
 CV 221,26,27
 CV 222,16,17
 CV 223,18,19
 v_dot2_f32_bf16 v24, v224, v57, v56
 v_dot2_f32_bf16 v25, v224, v61, v56
 v_dot2_f32_bf16 v26, v225, v57, v56
 v_dot2_f32_bf16 v27, v225, v61, v56
 v_dot2_f32_bf16 v16, v226, v57, v56
 v_dot2_f32_bf16 v17, v226, v61, v56
 v_dot2_f32_bf16 v18, v227, v57, v56
 v_dot2_f32_bf16 v19, v227, v61, v56
 CV 224,24,25
 CV 225,26,27
 CV 226,16,17
 CV 227,18,19
 v_dot2_f32_bf16 v24, v228, v59, v58
 v_dot2_f32_bf16 v25, v228, v63, v58
 v_dot2_f32_bf16 v26, v229, v59, v58
 v_dot2_f32_bf16 v27, v229, v63, v58
 v_dot2_f32_bf16 v16, v230, v59, v58
 v_dot2_f32_bf16 v17, v230, v63, v58
 v_dot2_f32_bf16 v18, v231, v59, v58
 v_dot2_f32_bf16 v19, v231, v63, v58
 CV 228,24,25
 CV 229,26,27
 CV 230,16,17
 CV 231,18,19
 v_dot2_f32_bf16 v24, v232, v57, v56
 v_dot2_f32_bf16 v25, v232, v61, v56
 v_dot2_f32_bf16 v26, v233, v57, v56
 v_dot2_f32_bf16 v27, v233, v61, v56
 v_dot2_f32_bf16 v16, v234, v57, v56
 v_dot2_f32_bf16 v17, v234, v61, v56
 v_dot2_f32_bf16 v18, v235, v57, v56
 v_dot2_f32_bf16 v19, v235, v61, v56
 CV 232,24,25
 CV 233,26,27
 CV 234,16,17
 CV 235,18,19
 v_dot2_f32_bf16 v24, v236, v59, v58
 v_dot2_f32_bf16 v25, v236, v63, v58
 v_dot2_f32_bf16 v26, v237, v59, v58
 v_dot2_f32_bf16 v27, v237, v63, v58
 v_dot2_f32_bf16 v16, v238, v59, v58
 v_dot2_f32_bf16 v17, v238, v63, v58
 v_dot2_f32_bf16 v18, v239, v59, v58
 v_dot2_f32_bf16 v19, v239, v63, v58
 CV 236,24,25
 CV 237,26,27
 CV 238,16,17
 CV 239,18,19
 v_dot2_f32_bf16 v24, v240, v57, v56
 v_dot2_f32_bf16 v25, v240, v61, v56
 v_dot2_f32_bf16 v26, v241, v57, v56
 v_dot2_f32_bf16 v27, v241, v61, v56
 v_dot2_f32_bf16 v16, v242, v57, v56
 v_dot2_f32_bf16 v17, v242, v61, v56
 v_dot2_f32_bf16 v18, v243, v57, v56
 v_dot2_f32_bf16 v19, v243, v61, v56
 CV 240,24,25
 CV 241,26,27
 CV 242,16,17
 CV 243,18,19
 v_dot2_f32_bf16 v24, v244, v59, v58
 v_dot2_f32_bf16 v25, v244, v63, v58
 v_dot2_f32_bf16 v26, v245, v59, v58
 v_dot2_f32_bf16 v27, v245, v63, v58
 v_dot2_f32_bf16 v16, v246, v59, v58
 v_dot2_f32_bf16 v17, v246, v63, v58
 v_dot2_f32_bf16 v18, v247, v59, v58
 v_dot2_f32_bf16 v19, v247, v63, v58
 CV 244,24,25
 CV 245,26,27
 CV 246,16,17
 CV 247,18,19
 v_dot2_f32_bf16 v24, v248, v57, v56
 v_dot2_f32_bf16 v25, v248, v61, v56
 v_dot2_f32_bf16 v26, v249, v57, v56
 v_dot2_f32_bf16 v27, v249, v61, v56
 v_dot2_f32_bf16 v16, v250, v57, v56
 v_dot2_f32_bf16 v17, v250, v61, v56
 v_dot2_f32_bf16 v18, v251, v57, v56
 v_dot2_f32_bf16 v19, v251, v61, v56
 CV 248,24,25
 CV 249,26,27
 CV 250,16,17
 CV 251,18,19
 v_dot2_f32_bf16 v24, v252, v59, v58
 v_dot2_f32_bf16 v25, v252, v63, v58
 v_dot2_f32_bf16 v26, v253, v59, v58
 v_dot2_f32_bf16 v27, v253, v63, v58
 v_dot2_f32_bf16 v16, v254, v59, v58
 v_dot2_f32_bf16 v17, v254, v63, v58
 v_dot2_f32_bf16 v18, v255, v59, v58
 v_dot2_f32_bf16 v19, v255, v63, v58
 CV 252,24,25
 CV 253,26,27
 CV 254,16,17
 CV 255,18,19
 v_mov_b32 v24, 1
 s_waitcnt vmcnt(20)
 buffer_atomic_add v24, v23, s[52:55], 0 offen sc1
 v_mov_b32 v32, v22
 v_add_u32 v33, 0x10000, v22
 v_add_u32 v34, 0x20000, v22
 s_mov_b32 s96, 0xbdb504f3
 s_waitcnt vmcnt(12)
 s_barrier
 RT 200,9,0
 RT 202,9,512
 RT 204,10,0
 RT 206,10,512
 RT 208,9,64
 RT 210,9,576
 RT 212,10,64
 RT 214,10,576
 RT 216,9,4352
 RT 218,9,4864
 RT 220,10,4352
 RT 222,10,4864
 RT 224,9,4416
 RT 226,9,4928
 WL 6
 v_mfma_f32_16x16x32_bf16 v[48:51], a[200:203], v[112:115], 0
 RT 228,10,4416
 RT 230,10,4928
 v_mfma_f32_16x16x32_bf16 v[52:55], a[200:203], v[116:119], 0
 s_add_u32 s71, s71, 0x80
 s_add_u32 s72, s72, 0x80
 v_mfma_f32_16x16x32_bf16 v[60:63], a[204:207], v[116:119], 0
 RT 200,9,8704
 RT 202,9,9216
 v_mfma_f32_16x16x32_bf16 v[56:59], a[204:207], v[112:115], 0
 s_add_u32 m0, s65, 0x13200
 s_add_u32 s70, s71, 0
 v_mfma_f32_16x16x32_bf16 v[64:67], a[208:211], v[112:115], 0
 RT 204,10,8704
 RT 206,10,9216
 v_mfma_f32_16x16x32_bf16 v[68:71], a[208:211], v[116:119], 0
 buffer_load_dwordx4 v3, s[20:23], s70 offen lds
 v_mfma_f32_16x16x32_bf16 v[76:79], a[212:215], v[116:119], 0
 WL 4
 RT 208,9,8768
 v_mfma_f32_16x16x32_bf16 v[72:75], a[212:215], v[112:115], 0
 RT 210,9,9280
 MV 48,216,120
 RT 212,10,8768
 MV 52,216,124
 RT 214,10,9280
 MV 60,220,124
 RT 216,9,13056
 RT 218,9,13568
 MV 56,220,120
 buffer_load_dwordx4 v4, s[20:23], s70 offen offset:1088 lds
 MV 64,224,120
 RT 220,10,13056
 MV 68,224,124
 RT 222,10,13568
 MV 76,228,124
 WL 4
 RT 224,9,13120
 MV 72,228,120
 RT 226,9,13632
 MV 48,200,128
 RT 228,10,13120
 RT 230,10,13632
 MV 52,200,132
 buffer_load_dwordx4 v5, s[20:23], s70 offen offset:2176 lds
 MV 60,204,132
 RT 200,9,17408
 MV 56,204,128
 RT 202,9,17920
 MV 64,208,128
 RT 204,10,17408
 MV 68,208,132
 RT 206,10,17920
 MV 76,212,132
 WL 4
 RT 208,9,17472
 RT 210,9,17984
 MV 72,212,128
 buffer_load_dwordx4 v6, s[20:23], s70 offen offset:3264 lds
 MV 48,216,136
 RT 212,10,17472
 MV 52,216,140
 RT 214,10,17984
 MV 60,220,140
 RT 216,9,21760
 MV 56,220,136
 RT 218,9,22272
 MV 64,224,136
 RT 220,10,21760
 RT 222,10,22272
 MV 68,224,140
 s_add_u32 m0, m0, 0x1100
 s_add_u32 s70, s71, 0x40000
 MV 76,228,140
 WL 4
 RT 224,9,21824
 RT 226,9,22336
 MV 72,228,136
 buffer_load_dwordx4 v3, s[20:23], s70 offen lds
 MV 48,200,144
 RT 228,10,21824
 MV 52,200,148
 RT 230,10,22336
 MV 60,204,148
 RT 200,9,26112
 MV 56,204,144
 RT 202,9,26624
 MV 64,208,144
 RT 204,10,26112
 RT 206,10,26624
 MV 68,208,148
 buffer_load_dwordx4 v4, s[20:23], s70 offen offset:1088 lds
 MV 76,212,148
 WL 4
 RT 208,9,26176
 MV 72,212,144
 RT 210,9,26688
 MV 48,216,152
 RT 212,10,26176
 MV 52,216,156
 RT 214,10,26688
 MV 60,220,156
 RT 216,9,30464
 RT 218,9,30976
 MV 56,220,152
 buffer_load_dwordx4 v5, s[20:23], s70 offen offset:2176 lds
 MV 64,224,152
 RT 220,10,30464
 MV 68,224,156
 RT 222,10,30976
 MV 76,228,156
 WL 4
 RT 224,9,30528
 MV 72,228,152
 RT 226,9,31040
 MV 48,200,160
 RT 228,10,30528
 RT 230,10,31040
 MV 52,200,164
 buffer_load_dwordx4 v6, s[20:23], s70 offen offset:3264 lds
 MV 60,204,164
 RT 200,9,34816
 MV 56,204,160
 RT 202,9,35328
 MV 64,208,160
 RT 204,10,34816
 MV 68,208,164
 RT 206,10,35328
 MV 76,212,164
 WL 4
 RT 208,9,34880
 RT 210,9,35392
 MV 72,212,160
 s_add_u32 m0, s66, 0x13200
 s_add_u32 s70, s72, 0
 MV 48,216,168
 RT 212,10,34880
 RT 214,10,35392
 MV 52,216,172
 buffer_load_dwordx4 v3, s[20:23], s70 offen lds
 MV 60,220,172
 s_add_u32 s3, s3, 0x80
 buffer_load_dword v47, v36, s[20:23], s3 offen
 s_waitcnt vmcnt(13)
 s_barrier
 RT 216,9,39168
 RT 218,9,39680
 MV 56,220,168
 s_add_u32 m0, s65, 0x1cb00
 s_add_u32 s70, s71, 0x240000
 MV 64,224,168
 RT 220,10,39168
 RT 222,10,39680
 MV 68,224,172
 buffer_load_dwordx4 v3, s[20:23], s70 offen lds
 MV 76,228,172
 WL 4
 RT 224,9,43520
 MV 72,228,168
 RT 226,9,44032
 MV 48,200,176
 RT 228,10,43520
 MV 52,200,180
 RT 230,10,44032
 MV 60,204,180
 RT 200,9,47872
 RT 202,9,48384
 MV 56,204,176
 buffer_load_dwordx4 v4, s[20:23], s70 offen offset:1088 lds
 MV 64,208,176
 RT 204,10,47872
 MV 68,208,180
 RT 206,10,48384
 MV 76,212,180
 WL 4
 RT 208,9,52224
 MV 72,212,176
 RT 210,9,52736
 MV 48,216,184
 RT 212,10,52224
 RT 214,10,52736
 MV 52,216,188
 buffer_load_dwordx4 v5, s[20:23], s70 offen offset:2176 lds
 MV 60,220,188
 RT 216,9,56576
 MV 56,220,184
 RT 218,9,57088
 MV 48,224,192
 RT 220,10,56576
 MV 52,224,196
 RT 222,10,57088
 MV 60,228,196
 WL 4
 RT 224,9,60928
 RT 226,9,61440
 MV 56,228,192
 buffer_load_dwordx4 v6, s[20:23], s70 offen offset:3264 lds
 MV 48,200,200
 RT 228,10,60928
 MV 52,200,204
 RT 230,10,61440
 MV 60,204,204
 RT 200,9,65280
 MV 56,204,200
 RT 202,11,256
 MV 48,208,208
 RT 204,10,65280
 RT 206,12,256
 MV 52,208,212
 s_add_u32 m0, m0, 0x1100
 s_add_u32 s70, s71, 0x280000
 MV 60,212,212
 WL 4
 RT 208,11,4096
 RT 210,11,4608
 MV 56,212,208
 buffer_load_dwordx4 v3, s[20:23], s70 offen lds
 MV 48,216,216
 RT 212,12,4096
 MV 52,216,220
 RT 214,12,4608
 MV 60,220,220
 RT 216,11,8448
 MV 56,220,216
 RT 218,11,8960
 MV 48,224,224
 RT 220,12,8448
 RT 222,12,8960
 MV 52,224,228
 buffer_load_dwordx4 v4, s[20:23], s70 offen offset:1088 lds
 MV 60,228,228
 WL 4
 RT 224,9,39232
 MV 56,228,224
 RT 226,9,39744
 MV 48,200,232
 RT 228,10,39232
 MV 52,200,236
 RT 230,10,39744
 MV 60,204,236
 RT 200,9,43584
 RT 202,9,44096
 MV 56,204,232
 buffer_load_dwordx4 v5, s[20:23], s70 offen offset:2176 lds
 MV 48,208,240
 RT 204,10,43584
 MV 52,208,244
 RT 206,10,44096
 MV 60,212,244
 WL 4
 RT 208,9,47936
 MV 56,212,240
 RT 210,9,48448
 MV 48,216,248
 RT 212,10,47936
 RT 214,10,48448
 MV 52,216,252
 buffer_load_dwordx4 v6, s[20:23], s70 offen offset:3264 lds
 MV 60,220,252
 RT 216,9,52288
 MV 56,220,248
 RT 218,9,52800
 MV 64,224,184
 RT 220,10,52288
 RT 222,10,52800
 MV 68,224,188
 v_mul_f32 v48, s96, v48
 v_mul_f32 v49, s96, v49
 MV 76,228,188
 WL 4
 RT 224,9,56640
 RT 226,9,57152
 MV 72,228,184
 s_add_u32 m0, s66, 0x1cb00
 s_add_u32 s70, s72, 0x240000
 MV 64,200,192
 RT 228,10,56640
 RT 230,10,57152
 MV 68,200,196
 buffer_load_dwordx4 v3, s[20:23], s70 offen lds
 MV 76,204,196
 RT 200,9,60992
 RT 202,9,61504
 MV 72,204,192
 v_mul_f32 v50, s96, v50
 v_mul_f32 v51, s96, v51
 MV 64,208,200
 RT 204,10,60992
 RT 206,10,61504
 MV 68,208,204
 v_mul_f32 v56, s96, v56
 v_mul_f32 v57, s96, v57
 MV 76,212,204
 WL 4
 RT 208,9,65344
 RT 210,11,320
 MV 72,212,200
 v_mul_f32 v58, s96, v58
 v_mul_f32 v59, s96, v59
 MV 64,216,208
 RT 212,10,65344
 RT 214,12,320
 MV 68,216,212
 CV 48,48,49
 CV 50,50,51
 MV 76,220,212
 RT 216,11,4160
 RT 218,11,4672
 MV 72,220,208
 CV 56,56,57
 CV 58,58,59
 MV 64,224,216
 RT 220,12,4160
 RT 222,12,4672
 MV 68,224,220
 v_permlane32_swap_b32 v48, v56
 v_permlane32_swap_b32 v50, v58
 MV 76,228,220
 WL 4
 RT 224,11,8512
 RT 226,11,9024
 MV 72,228,216
 v_permlane16_swap_b32 v48, v56
 v_permlane16_swap_b32 v50, v58
 MV 64,200,224
 RT 228,12,8512
 RT 230,12,9024
 MV 68,200,228
 MV 76,204,228
 s_waitcnt vmcnt(10)
 s_barrier
 RT 200,11,12800
 RT 202,11,13312
 MV 72,204,224
 s_add_u32 s71, s71, 0x80
 s_add_u32 s72, s72, 0x80
 MV 64,208,232
 RT 204,12,12800
 RT 206,12,13312
 MV 68,208,236
 s_add_u32 m0, s65, 0
 s_add_u32 s70, s71, 0
 MV 76,212,236
 WL 4
 RT 208,11,12864
 RT 210,11,13376
 MV 72,212,232
 buffer_load_dwordx4 v3, s[20:23], s70 offen lds
 MV 64,216,240
 RT 212,12,12864
 RT 214,12,13376
 MV 68,216,244
 MV 76,220,244
 RT 216,11,17152
 RT 218,11,17664
 MV 72,220,240
 MV 64,224,248
 RT 220,12,17152
 RT 222,12,17664
 MV 68,224,252
 buffer_load_dwordx4 v4, s[20:23], s70 offen offset:1088 lds
 MV 76,228,252
 WL 4
 RT 224,11,17216
 RT 226,11,17728
 MV 72,228,248
 v_mfma_f32_16x16x32_bf16 v[80:83], a[200:203], v[112:115], 0
 RT 228,12,17216
 RT 230,12,17728
 v_mfma_f32_16x16x32_bf16 v[84:87], a[200:203], v[116:119], 0
 v_mul_f32 v52, s96, v52
 v_mul_f32 v53, s96, v53
 v_mfma_f32_16x16x32_bf16 v[92:95], a[204:207], v[116:119], 0
 RT 200,11,21504
 RT 202,11,22016
 v_mfma_f32_16x16x32_bf16 v[88:91], a[204:207], v[112:115], 0
 buffer_load_dwordx4 v5, s[20:23], s70 offen offset:2176 lds
 v_mfma_f32_16x16x32_bf16 v[96:99], a[208:211], v[112:115], 0
 RT 204,12,21504
 RT 206,12,22016
 v_mfma_f32_16x16x32_bf16 v[100:103], a[208:211], v[116:119], 0
 v_mul_f32 v54, s96, v54
 v_mul_f32 v55, s96, v55
 v_mfma_f32_16x16x32_bf16 v[108:111], a[212:215], v[116:119], 0
 WL 4
 RT 208,11,21568
 RT 210,11,22080
 v_mfma_f32_16x16x32_bf16 v[104:107], a[212:215], v[112:115], 0
 v_mul_f32 v60, s96, v60
 v_mul_f32 v61, s96, v61
 MV 80,216,120
 RT 212,12,21568
 RT 214,12,22080
 MV 84,216,124
 buffer_load_dwordx4 v6, s[20:23], s70 offen offset:3264 lds
 MV 92,220,124
 RT 216,11,25856
 RT 218,11,26368
 MV 88,220,120
 v_mul_f32 v62, s96, v62
 v_mul_f32 v63, s96, v63
 MV 96,224,120
 RT 220,12,25856
 RT 222,12,26368
 MV 100,224,124
 CV 52,52,53
 CV 54,54,55
 MV 108,228,124
 WL 4
 RT 224,11,25920
 RT 226,11,26432
 MV 104,228,120
 s_add_u32 m0, m0, 0x1100
 s_add_u32 s70, s71, 0x40000
 MV 80,200,128
 RT 228,12,25920
 RT 230,12,26432
 MV 84,200,132
 buffer_load_dwordx4 v3, s[20:23], s70 offen lds
 MV 92,204,132
 RT 200,11,30208
 RT 202,11,30720
 MV 88,204,128
 CV 60,60,61
 CV 62,62,63
 MV 96,208,128
 RT 204,12,30208
 RT 206,12,30720
 MV 100,208,132
 v_permlane32_swap_b32 v52, v60
 v_permlane32_swap_b32 v54, v62
 MV 108,212,132
 WL 4
 RT 208,11,30272
 RT 210,11,30784
 MV 104,212,128
 buffer_load_dwordx4 v4, s[20:23], s70 offen offset:1088 lds
 MV 80,216,136
 RT 212,12,30272
 RT 214,12,30784
 MV 84,216,140
 v_permlane16_swap_b32 v52, v60
 v_permlane16_swap_b32 v54, v62
 MV 92,220,140
 RT 216,11,34560
 RT 218,11,35072
 MV 88,220,136
 v_mul_f32 v64, s96, v64
 v_mul_f32 v65, s96, v65
 MV 96,224,136
 RT 220,12,34560
 RT 222,12,35072
 MV 100,224,140
 buffer_load_dwordx4 v5, s[20:23], s70 offen offset:2176 lds
 MV 108,228,140
 WL 4
 RT 224,11,34624
 RT 226,11,35136
 MV 104,228,136
 v_mul_f32 v66, s96, v66
 v_mul_f32 v67, s96, v67
 MV 80,200,144
 RT 228,12,34624
 RT 230,12,35136
 MV 84,200,148
 v_mul_f32 v72, s96, v72
 v_mul_f32 v73, s96, v73
 MV 92,204,148
 RT 200,11,38912
 RT 202,11,39424
 MV 88,204,144
 buffer_load_dwordx4 v6, s[20:23], s70 offen offset:3264 lds
 MV 96,208,144
 RT 204,12,38912
 RT 206,12,39424
 MV 100,208,148
 v_mul_f32 v74, s96, v74
 v_mul_f32 v75, s96, v75
 MV 108,212,148
 WL 4
 RT 208,11,38976
 RT 210,11,39488
 MV 104,212,144
 CV 64,64,65
 CV 66,66,67
 MV 80,216,152
 RT 212,12,38976
 RT 214,12,39488
 MV 84,216,156
 s_add_u32 m0, s66, 0
 s_add_u32 s70, s72, 0
 MV 92,220,156
 RT 216,11,43264
 RT 218,11,43776
 MV 88,220,152
 buffer_load_dwordx4 v3, s[20:23], s70 offen lds
 MV 96,224,152
 RT 220,12,43264
 RT 222,12,43776
 MV 100,224,156
 CV 72,72,73
 CV 74,74,75
 MV 108,228,156
 WL 4
 RT 224,11,43328
 RT 226,11,43840
 MV 104,228,152
 v_permlane32_swap_b32 v64, v72
 v_permlane32_swap_b32 v66, v74
 MV 80,200,160
 RT 228,12,43328
 RT 230,12,43840
 MV 84,200,164
 v_bfe_u32 v40, v38, 16, 5
 v_and_b32 v36, 63, v38
 v_min_u32 v36, 17, v36
 v_mad_u32_u24 v36, v40, 18, v36
 s_mov_b32 s92, 0x2400
 v_mul_u32_u24 v36, s92, v36
 s_add_u32 s3, s44, 0
 MV 92,204,164
 RT 200,11,47616
 RT 202,11,48128
 MV 88,204,160
 buffer_load_dword v47, v36, s[28:31], s3 offen
 MV 96,208,160
 RT 204,12,47616
 RT 206,12,48128
 MV 100,208,164
 v_permlane16_swap_b32 v64, v72
 v_permlane16_swap_b32 v66, v74
 MV 108,212,164
 WL 4
 RT 208,11,47680
 RT 210,11,48192
 MV 104,212,160
 v_mul_f32 v68, s96, v68
 v_mul_f32 v69, s96, v69
 MV 80,216,168
 RT 212,12,47680
 RT 214,12,48192
 MV 84,216,172
 v_mul_f32 v70, s96, v70
 v_mul_f32 v71, s96, v71
 MV 92,220,172
 s_waitcnt vmcnt(10)
 s_barrier
 RT 216,11,51968
 RT 218,11,52480
 MV 88,220,168
 s_add_u32 m0, s65, 0x9900
 s_add_u32 s70, s71, 0x240000
 MV 96,224,168
 RT 220,12,51968
 RT 222,12,52480
 MV 100,224,172
 buffer_load_dwordx4 v3, s[20:23], s70 offen lds
 MV 108,228,172
 WL 4
 RT 224,11,56320
 RT 226,11,56832
 MV 104,228,168
 v_mul_f32 v76, s96, v76
 v_mul_f32 v77, s96, v77
 MV 80,200,176
 RT 228,12,56320
 RT 230,12,56832
 MV 84,200,180
 v_mul_f32 v78, s96, v78
 v_mul_f32 v79, s96, v79
 MV 92,204,180
 RT 200,11,60672
 RT 202,11,61184
 MV 88,204,176
 buffer_load_dwordx4 v4, s[20:23], s70 offen offset:1088 lds
 MV 96,208,176
 RT 204,12,60672
 RT 206,12,61184
 MV 100,208,180
 CV 68,68,69
 CV 70,70,71
 MV 108,212,180
 WL 4
 RT 208,11,65024
 RT 210,13,0
 MV 104,212,176
 CV 76,76,77
 CV 78,78,79
 MV 80,216,184
 RT 212,12,65024
 RT 214,14,0
 MV 84,216,188
 buffer_load_dwordx4 v5, s[20:23], s70 offen offset:2176 lds
 MV 92,220,188
 RT 216,13,3840
 RT 218,13,4352
 MV 88,220,184
 v_permlane32_swap_b32 v68, v76
 v_permlane32_swap_b32 v70, v78
 MV 80,224,192
 RT 220,14,3840
 RT 222,14,4352
 MV 84,224,196
 v_permlane16_swap_b32 v68, v76
 v_permlane16_swap_b32 v70, v78
 MV 92,228,196
 WL 4
 RT 224,13,8192
 RT 226,13,8704
 MV 88,228,192
 buffer_load_dwordx4 v6, s[20:23], s70 offen offset:3264 lds
 MV 80,200,200
 RT 228,14,8192
 MV 84,200,204
 RT 230,14,8704
 MV 92,204,204
 RT 200,13,12544
 MV 88,204,200
 RT 202,13,13056
 MV 80,208,208
 RT 204,14,12544
 RT 206,14,13056
 MV 84,208,212
 s_add_u32 m0, m0, 0x1100
 s_add_u32 s70, s71, 0x280000
 MV 92,212,212
 WL 4
 RT 208,13,16896
 RT 210,13,17408
 MV 88,212,208
 buffer_load_dwordx4 v3, s[20:23], s70 offen lds
 MV 80,216,216
 RT 212,14,16896
 MV 84,216,220
 RT 214,14,17408
 MV 92,220,220
 RT 216,13,21248
 MV 88,220,216
 RT 218,13,21760
 MV 80,224,224
 RT 220,14,21248
 RT 222,14,21760
 MV 84,224,228
 buffer_load_dwordx4 v4, s[20:23], s70 offen offset:1088 lds
 MV 92,228,228
 WL 4
 RT 224,11,52032
 MV 88,228,224
 RT 226,11,52544
 MV 80,200,232
 RT 228,12,52032
 MV 84,200,236
 RT 230,12,52544
 MV 92,204,236
 RT 200,11,56384
 RT 202,11,56896
 MV 88,204,232
 buffer_load_dwordx4 v5, s[20:23], s70 offen offset:2176 lds
 MV 80,208,240
 RT 204,12,56384
 MV 84,208,244
 RT 206,12,56896
 MV 92,212,244
 WL 4
 RT 208,11,60736
 MV 88,212,240
 RT 210,11,61248
 MV 80,216,248
 RT 212,12,60736
 RT 214,12,61248
 MV 84,216,252
 buffer_load_dwordx4 v6, s[20:23], s70 offen offset:3264 lds
 MV 92,220,252
 RT 216,11,65088
 MV 88,220,248
 RT 218,13,64
 MV 96,224,184
 RT 220,12,65088
 RT 222,14,64
 MV 100,224,188
 v_mul_f32 v80, s96, v80
 v_mul_f32 v81, s96, v81
 MV 108,228,188
 WL 4
 RT 224,13,3904
 RT 226,13,4416
 MV 104,228,184
 s_add_u32 m0, s66, 0x9900
 s_add_u32 s70, s72, 0x240000
 MV 96,200,192
 RT 228,14,3904
 RT 230,14,4416
 MV 100,200,196
 buffer_load_dwordx4 v3, s[20:23], s70 offen lds
 MV 108,204,196
 RT 200,13,8256
 RT 202,13,8768
 MV 104,204,192
 v_mul_f32 v82, s96, v82
 v_mul_f32 v83, s96, v83
 MV 96,208,200
 RT 204,14,8256
 RT 206,14,8768
 MV 100,208,204
 v_mul_f32 v88, s96, v88
 v_mul_f32 v89, s96, v89
 MV 108,212,204
 WL 4
 RT 208,13,12608
 RT 210,13,13120
 MV 104,212,200
 v_mul_f32 v90, s96, v90
 v_mul_f32 v91, s96, v91
 MV 96,216,208
 RT 212,14,12608
 RT 214,14,13120
 MV 100,216,212
 CV 80,80,81
 CV 82,82,83
 MV 108,220,212
 RT 216,13,16960
 RT 218,13,17472
 MV 104,220,208
 CV 88,88,89
 CV 90,90,91
 MV 96,224,216
 RT 220,14,16960
 RT 222,14,17472
 MV 100,224,220
 v_permlane32_swap_b32 v80, v88
 v_permlane32_swap_b32 v82, v90
 MV 108,228,220
 WL 4
 RT 224,13,21312
 RT 226,13,21824
 MV 104,228,216
 v_permlane16_swap_b32 v80, v88
 v_permlane16_swap_b32 v82, v90
 MV 96,200,224
 RT 228,14,21312
 RT 230,14,21824
 MV 100,200,228
 AW 136,48
 AW 137,50
 MV 108,204,228
 s_waitcnt vmcnt(10)
 s_barrier
 RT 200,9,0
 RT 202,9,512
 MV 104,204,224
 s_add_u32 s71, s71, 0x80
 s_add_u32 s72, s72, 0x80
 AW 138,56
 AW 139,58
 MV 96,208,232
 RT 204,10,0
 RT 206,10,512
 MV 100,208,236
 s_add_u32 m0, s65, 0x13200
 s_add_u32 s70, s71, 0
 AW 140,52
 AW 141,54
 MV 108,212,236
 WL 4
 RT 208,9,64
 RT 210,9,576
 MV 104,212,232
 buffer_load_dwordx4 v3, s[20:23], s70 offen lds
 AW 142,60
 AW 143,62
 MV 96,216,240
 RT 212,10,64
 RT 214,10,576
 MV 100,216,244
 AW 144,64
 AW 145,66
 MV 108,220,244
 RT 216,9,4352
 RT 218,9,4864
 MV 104,220,240
 AW 146,72
 AW 147,74
 MV 96,224,248
 RT 220,10,4352
 RT 222,10,4864
 MV 100,224,252
 buffer_load_dwordx4 v4, s[20:23], s70 offen offset:1088 lds
 AW 148,68
 AW 149,70
 MV 108,228,252
 WL 4
 RT 224,9,4416
 RT 226,9,4928
 MV 104,228,248
 AW 150,76
 AW 151,78
 v_mfma_f32_16x16x32_bf16 v[48:51], a[200:203], v[112:115], 0
 RT 228,10,4416
 RT 230,10,4928
 v_mfma_f32_16x16x32_bf16 v[52:55], a[200:203], v[116:119], 0
 v_mul_f32 v84, s96, v84
 v_mul_f32 v85, s96, v85
 v_mfma_f32_16x16x32_bf16 v[60:63], a[204:207], v[116:119], 0
 RT 200,9,8704
 RT 202,9,9216
 v_mfma_f32_16x16x32_bf16 v[56:59], a[204:207], v[112:115], 0
 buffer_load_dwordx4 v5, s[20:23], s70 offen offset:2176 lds
 v_mfma_f32_16x16x32_bf16 v[64:67], a[208:211], v[112:115], 0
 RT 204,10,8704
 RT 206,10,9216
 v_mfma_f32_16x16x32_bf16 v[68:71], a[208:211], v[116:119], 0
 v_mul_f32 v86, s96, v86
 v_mul_f32 v87, s96, v87
 v_mfma_f32_16x16x32_bf16 v[76:79], a[212:215], v[116:119], 0
 WL 4
 RT 208,9,8768
 RT 210,9,9280
 v_mfma_f32_16x16x32_bf16 v[72:75], a[212:215], v[112:115], 0
 v_mul_f32 v92, s96, v92
 v_mul_f32 v93, s96, v93
 MV 48,216,120
 RT 212,10,8768
 RT 214,10,9280
 MV 52,216,124
 buffer_load_dwordx4 v6, s[20:23], s70 offen offset:3264 lds
 MV 60,220,124
 RT 216,9,13056
 RT 218,9,13568
 MV 56,220,120
 v_mul_f32 v94, s96, v94
 v_mul_f32 v95, s96, v95
 MV 64,224,120
 RT 220,10,13056
 RT 222,10,13568
 MV 68,224,124
 CV 84,84,85
 CV 86,86,87
 MV 76,228,124
 WL 4
 RT 224,9,13120
 RT 226,9,13632
 MV 72,228,120
 s_add_u32 m0, m0, 0x1100
 s_add_u32 s70, s71, 0x40000
 MV 48,200,128
 RT 228,10,13120
 RT 230,10,13632
 MV 52,200,132
 buffer_load_dwordx4 v3, s[20:23], s70 offen lds
 MV 60,204,132
 RT 200,9,17408
 RT 202,9,17920
 MV 56,204,128
 CV 92,92,93
 CV 94,94,95
 MV 64,208,128
 RT 204,10,17408
 RT 206,10,17920
 MV 68,208,132
 v_permlane32_swap_b32 v84, v92
 v_permlane32_swap_b32 v86, v94
 MV 76,212,132
 WL 4
 RT 208,9,17472
 RT 210,9,17984
 MV 72,212,128
 buffer_load_dwordx4 v4, s[20:23], s70 offen offset:1088 lds
 MV 48,216,136
 RT 212,10,17472
 RT 214,10,17984
 MV 52,216,140
 v_permlane16_swap_b32 v84, v92
 v_permlane16_swap_b32 v86, v94
 MV 60,220,140
 RT 216,9,21760
 RT 218,9,22272
 MV 56,220,136
 v_mul_f32 v96, s96, v96
 v_mul_f32 v97, s96, v97
 MV 64,224,136
 RT 220,10,21760
 RT 222,10,22272
 MV 68,224,140
 buffer_load_dwordx4 v5, s[20:23], s70 offen offset:2176 lds
 MV 76,228,140
 WL 4
 RT 224,9,21824
 RT 226,9,22336
 MV 72,228,136
 v_mul_f32 v98, s96, v98
 v_mul_f32 v99, s96, v99
 MV 48,200,144
 RT 228,10,21824
 RT 230,10,22336
 MV 52,200,148
 v_mul_f32 v104, s96, v104
 v_mul_f32 v105, s96, v105
 MV 60,204,148
 RT 200,9,26112
 RT 202,9,26624
 MV 56,204,144
 buffer_load_dwordx4 v6, s[20:23], s70 offen offset:3264 lds
 MV 64,208,144
 RT 204,10,26112
 RT 206,10,26624
 MV 68,208,148
 v_mul_f32 v106, s96, v106
 v_mul_f32 v107, s96, v107
 MV 76,212,148
 WL 4
 RT 208,9,26176
 RT 210,9,26688
 MV 72,212,144
 CV 96,96,97
 CV 98,98,99
 MV 48,216,152
 RT 212,10,26176
 RT 214,10,26688
 MV 52,216,156
 s_add_u32 m0, s66, 0x13200
 s_add_u32 s70, s72, 0
 MV 60,220,156
 RT 216,9,30464
 RT 218,9,30976
 MV 56,220,152
 buffer_load_dwordx4 v3, s[20:23], s70 offen lds
 MV 64,224,152
 RT 220,10,30464
 RT 222,10,30976
 MV 68,224,156
 CV 104,104,105
 CV 106,106,107
 MV 76,228,156
 WL 4
 RT 224,9,30528
 RT 226,9,31040
 MV 72,228,152
 v_permlane32_swap_b32 v96, v104
 v_permlane32_swap_b32 v98, v106
 MV 48,200,160
 RT 228,10,30528
 RT 230,10,31040
 MV 52,200,164
 s_add_u32 s3, s3, 0x80
 v_permlane16_swap_b32 v96, v104
 MV 60,204,164
 RT 200,9,34816
 RT 202,9,35328
 MV 56,204,160
 buffer_load_dword v47, v36, s[28:31], s3 offen
 MV 64,208,160
 RT 204,10,34816
 RT 206,10,35328
 MV 68,208,164
 v_permlane16_swap_b32 v98, v106
 v_mul_f32 v100, s96, v100
 MV 76,212,164
 WL 4
 RT 208,9,34880
 RT 210,9,35392
 MV 72,212,160
 v_mul_f32 v101, s96, v101
 v_mul_f32 v102, s96, v102
 MV 48,216,168
 RT 212,10,34880
 RT 214,10,35392
 MV 52,216,172
 v_mul_f32 v103, s96, v103
 v_mul_f32 v108, s96, v108
 MV 60,220,172
 s_waitcnt vmcnt(10)
 s_barrier
 RT 216,9,39168
 RT 218,9,39680
 MV 56,220,168
 s_add_u32 m0, s65, 0x1cb00
 s_add_u32 s70, s71, 0x240000
 MV 64,224,168
 RT 220,10,39168
 RT 222,10,39680
 MV 68,224,172
 buffer_load_dwordx4 v3, s[20:23], s70 offen lds
 MV 76,228,172
 WL 4
 RT 224,9,43520
 RT 226,9,44032
 MV 72,228,168
 v_mul_f32 v109, s96, v109
 v_mul_f32 v110, s96, v110
 MV 48,200,176
 RT 228,10,43520
 RT 230,10,44032
 MV 52,200,180
 v_mul_f32 v111, s96, v111
 CV 100,100,101
 MV 60,204,180
 RT 200,9,47872
 RT 202,9,48384
 MV 56,204,176
 buffer_load_dwordx4 v4, s[20:23], s70 offen offset:1088 lds
 MV 64,208,176
 RT 204,10,47872
 RT 206,10,48384
 MV 68,208,180
 CV 102,102,103
 CV 108,108,109
 MV 76,212,180
 WL 4
 RT 208,9,52224
 RT 210,9,52736
 MV 72,212,176
 CV 110,110,111
 v_permlane32_swap_b32 v100, v108
 MV 48,216,184
 RT 212,10,52224
 RT 214,10,52736
 MV 52,216,188
 buffer_load_dwordx4 v5, s[20:23], s70 offen offset:2176 lds
 MV 60,220,188
 RT 216,9,56576
 RT 218,9,57088
 MV 56,220,184
 v_permlane32_swap_b32 v102, v110
 v_permlane16_swap_b32 v100, v108
 MV 48,224,192
 RT 220,10,56576
 RT 222,10,57088
 MV 52,224,196
 v_permlane16_swap_b32 v102, v110
 MV 60,228,196
 WL 4
 RT 224,9,60928
 RT 226,9,61440
 MV 56,228,192
 buffer_load_dwordx4 v6, s[20:23], s70 offen offset:3264 lds
 MV 48,200,200
 RT 228,10,60928
 MV 52,200,204
 RT 230,10,61440
 MV 60,204,204
 RT 200,9,65280
 MV 56,204,200
 RT 202,11,256
 MV 48,208,208
 RT 204,10,65280
 RT 206,12,256
 MV 52,208,212
 s_add_u32 m0, m0, 0x1100
 s_add_u32 s70, s71, 0x280000
 MV 60,212,212
 WL 4
 RT 208,11,4096
 RT 210,11,4608
 MV 56,212,208
 buffer_load_dwordx4 v3, s[20:23], s70 offen lds
 MV 48,216,216
 RT 212,12,4096
 MV 52,216,220
 RT 214,12,4608
 MV 60,220,220
 RT 216,11,8448
 MV 56,220,216
 RT 218,11,8960
 MV 48,224,224
 RT 220,12,8448
 RT 222,12,8960
 MV 52,224,228
 buffer_load_dwordx4 v4, s[20:23], s70 offen offset:1088 lds
 MV 60,228,228
 WL 4
 RT 224,9,39232
 MV 56,228,224
 RT 226,9,39744
 MV 48,200,232
 RT 228,10,39232
 MV 52,200,236
 RT 230,10,39744
 MV 60,204,236
 RT 200,9,43584
 RT 202,9,44096
 MV 56,204,232
 buffer_load_dwordx4 v5, s[20:23], s70 offen offset:2176 lds
 MV 48,208,240
 RT 204,10,43584
 MV 52,208,244
 RT 206,10,44096
 MV 60,212,244
 WL 4
 RT 208,9,47936
 MV 56,212,240
 RT 210,9,48448
 MV 48,216,248
 RT 212,10,47936
 RT 214,10,48448
 MV 52,216,252
 buffer_load_dwordx4 v6, s[20:23], s70 offen offset:3264 lds
 MV 60,220,252
 RT 216,9,52288
 MV 56,220,248
 RT 218,9,52800
 MV 64,224,184
 RT 220,10,52288
 RT 222,10,52800
 MV 68,224,188
 v_mul_f32 v48, s96, v48
 v_mul_f32 v49, s96, v49
 MV 76,228,188
 WL 4
 RT 224,9,56640
 RT 226,9,57152
 MV 72,228,184
 s_add_u32 m0, s66, 0x1cb00
 s_add_u32 s70, s72, 0x240000
 MV 64,200,192
 RT 228,10,56640
 RT 230,10,57152
 MV 68,200,196
 buffer_load_dwordx4 v3, s[20:23], s70 offen lds
 MV 76,204,196
 RT 200,9,60992
 RT 202,9,61504
 MV 72,204,192
 v_mul_f32 v50, s96, v50
 v_mul_f32 v51, s96, v51
 MV 64,208,200
 RT 204,10,60992
 RT 206,10,61504
 MV 68,208,204
 v_mul_f32 v56, s96, v56
 v_mul_f32 v57, s96, v57
 MV 76,212,204
 WL 4
 RT 208,9,65344
 RT 210,11,320
 MV 72,212,200
 v_mul_f32 v58, s96, v58
 v_mul_f32 v59, s96, v59
 MV 64,216,208
 RT 212,10,65344
 RT 214,12,320
 MV 68,216,212
 CV 48,48,49
 CV 50,50,51
 MV 76,220,212
 RT 216,11,4160
 RT 218,11,4672
 MV 72,220,208
 CV 56,56,57
 CV 58,58,59
 MV 64,224,216
 RT 220,12,4160
 RT 222,12,4672
 MV 68,224,220
 v_permlane32_swap_b32 v48, v56
 v_permlane32_swap_b32 v50, v58
 MV 76,228,220
 WL 4
 RT 224,11,8512
 RT 226,11,9024
 MV 72,228,216
 v_permlane16_swap_b32 v48, v56
 v_permlane16_swap_b32 v50, v58
 MV 64,200,224
 RT 228,12,8512
 RT 230,12,9024
 MV 68,200,228
 AW 152,80
 AW 153,82
 MV 76,204,228
 s_waitcnt vmcnt(10)
 s_barrier
 RT 200,11,12800
 RT 202,11,13312
 MV 72,204,224
 s_mov_b32 s92, 0x2400
 v_mad_u32_u24 v3, v1, s92, v2
 v_add_u32 v4, 0x11bc0, v3
 v_add_u32 v5, 0x11bc0, v4
 v_add_u32 v6, 0x11bc0, v5
 AW 154,88
 AW 155,90
 MV 64,208,232
 RT 204,12,12800
 RT 206,12,13312
 MV 68,208,236
 s_add_u32 m0, s65, 0
 s_add_u32 s70, s73, 0
 AW 156,84
 AW 157,86
 MV 76,212,236
 WL 4
 RT 208,11,12864
 RT 210,11,13376
 MV 72,212,232
 buffer_load_dwordx4 v3, s[28:31], s70 offen lds
 AW 158,92
 AW 159,94
 MV 64,216,240
 RT 212,12,12864
 RT 214,12,13376
 MV 68,216,244
 AW 160,96
 AW 161,98
 MV 76,220,244
 RT 216,11,17152
 RT 218,11,17664
 MV 72,220,240
 AW 162,104
 AW 163,106
 MV 64,224,248
 RT 220,12,17152
 RT 222,12,17664
 MV 68,224,252
 buffer_load_dwordx4 v4, s[28:31], s70 offen offset:1088 lds
 AW 164,100
 AW 165,102
 MV 76,228,252
 WL 4
 RT 224,11,17216
 RT 226,11,17728
 MV 72,228,248
 AW 166,108
 AW 167,110
 v_mfma_f32_16x16x32_bf16 v[80:83], a[200:203], v[112:115], 0
 RT 228,12,17216
 RT 230,12,17728
 v_mfma_f32_16x16x32_bf16 v[84:87], a[200:203], v[116:119], 0
 v_mul_f32 v52, s96, v52
 v_mul_f32 v53, s96, v53
 v_mfma_f32_16x16x32_bf16 v[92:95], a[204:207], v[116:119], 0
 RT 200,11,21504
 RT 202,11,22016
 v_mfma_f32_16x16x32_bf16 v[88:91], a[204:207], v[112:115], 0
 buffer_load_dwordx4 v5, s[28:31], s70 offen offset:2176 lds
 v_mfma_f32_16x16x32_bf16 v[96:99], a[208:211], v[112:115], 0
 RT 204,12,21504
 RT 206,12,22016
 v_mfma_f32_16x16x32_bf16 v[100:103], a[208:211], v[116:119], 0
 v_mul_f32 v54, s96, v54
 v_mul_f32 v55, s96, v55
 v_mfma_f32_16x16x32_bf16 v[108:111], a[212:215], v[116:119], 0
 WL 4
 RT 208,11,21568
 RT 210,11,22080
 v_mfma_f32_16x16x32_bf16 v[104:107], a[212:215], v[112:115], 0
 v_mul_f32 v60, s96, v60
 v_mul_f32 v61, s96, v61
 MV 80,216,120
 RT 212,12,21568
 RT 214,12,22080
 MV 84,216,124
 buffer_load_dwordx4 v6, s[28:31], s70 offen offset:3264 lds
 MV 92,220,124
 RT 216,11,25856
 RT 218,11,26368
 MV 88,220,120
 v_mul_f32 v62, s96, v62
 v_mul_f32 v63, s96, v63
 MV 96,224,120
 RT 220,12,25856
 RT 222,12,26368
 MV 100,224,124
 CV 52,52,53
 CV 54,54,55
 MV 108,228,124
 WL 4
 RT 224,11,25920
 RT 226,11,26432
 MV 104,228,120
 s_add_u32 m0, m0, 0x1100
 s_add_u32 s70, s73, 0x48000
 MV 80,200,128
 RT 228,12,25920
 RT 230,12,26432
 MV 84,200,132
 buffer_load_dwordx4 v3, s[28:31], s70 offen lds
 MV 92,204,132
 RT 200,11,30208
 RT 202,11,30720
 MV 88,204,128
 CV 60,60,61
 CV 62,62,63
 MV 96,208,128
 RT 204,12,30208
 RT 206,12,30720
 MV 100,208,132
 v_permlane32_swap_b32 v52, v60
 v_permlane32_swap_b32 v54, v62
 MV 108,212,132
 WL 4
 RT 208,11,30272
 RT 210,11,30784
 MV 104,212,128
 buffer_load_dwordx4 v4, s[28:31], s70 offen offset:1088 lds
 MV 80,216,136
 RT 212,12,30272
 RT 214,12,30784
 MV 84,216,140
 v_permlane16_swap_b32 v52, v60
 v_permlane16_swap_b32 v54, v62
 MV 92,220,140
 RT 216,11,34560
 RT 218,11,35072
 MV 88,220,136
 v_mul_f32 v64, s96, v64
 v_mul_f32 v65, s96, v65
 MV 96,224,136
 RT 220,12,34560
 RT 222,12,35072
 MV 100,224,140
 buffer_load_dwordx4 v5, s[28:31], s70 offen offset:2176 lds
 MV 108,228,140
 WL 4
 RT 224,11,34624
 RT 226,11,35136
 MV 104,228,136
 v_mul_f32 v66, s96, v66
 v_mul_f32 v67, s96, v67
 MV 80,200,144
 RT 228,12,34624
 RT 230,12,35136
 MV 84,200,148
 v_mul_f32 v72, s96, v72
 v_mul_f32 v73, s96, v73
 MV 92,204,148
 RT 200,11,38912
 RT 202,11,39424
 MV 88,204,144
 buffer_load_dwordx4 v6, s[28:31], s70 offen offset:3264 lds
 MV 96,208,144
 RT 204,12,38912
 RT 206,12,39424
 MV 100,208,148
 v_mul_f32 v74, s96, v74
 v_mul_f32 v75, s96, v75
 MV 108,212,148
 WL 4
 RT 208,11,38976
 RT 210,11,39488
 MV 104,212,144
 CV 64,64,65
 CV 66,66,67
 MV 80,216,152
 RT 212,12,38976
 RT 214,12,39488
 MV 84,216,156
 s_add_u32 m0, s66, 0
 s_add_u32 s70, s74, 0
 MV 92,220,156
 RT 216,11,43264
 RT 218,11,43776
 MV 88,220,152
 buffer_load_dwordx4 v3, s[28:31], s70 offen lds
 MV 96,224,152
 RT 220,12,43264
 RT 222,12,43776
 MV 100,224,156
 CV 72,72,73
 CV 74,74,75
 MV 108,228,156
 WL 4
 RT 224,11,43328
 RT 226,11,43840
 MV 104,228,152
 v_permlane32_swap_b32 v64, v72
 v_permlane32_swap_b32 v66, v74
 MV 80,200,160
 RT 228,12,43328
 RT 230,12,43840
 MV 84,200,164
 s_add_u32 s3, s3, 0x80
 v_permlane16_swap_b32 v64, v72
 MV 92,204,164
 RT 200,11,47616
 RT 202,11,48128
 MV 88,204,160
 buffer_load_dword v47, v36, s[28:31], s3 offen
 MV 96,208,160
 RT 204,12,47616
 RT 206,12,48128
 MV 100,208,164
 v_permlane16_swap_b32 v66, v74
 v_mul_f32 v68, s96, v68
 MV 108,212,164
 WL 4
 RT 208,11,47680
 RT 210,11,48192
 MV 104,212,160
 v_mul_f32 v69, s96, v69
 v_mul_f32 v70, s96, v70
 MV 80,216,168
 RT 212,12,47680
 RT 214,12,48192
 MV 84,216,172
 v_mul_f32 v71, s96, v71
 v_mul_f32 v76, s96, v76
 MV 92,220,172
 s_waitcnt vmcnt(10)
 s_barrier
 RT 216,11,51968
 RT 218,11,52480
 MV 88,220,168
 s_add_u32 m0, s65, 0x9900
 s_add_u32 s70, s73, 0x288000
 MV 96,224,168
 RT 220,12,51968
 RT 222,12,52480
 MV 100,224,172
 buffer_load_dwordx4 v3, s[28:31], s70 offen lds
 MV 108,228,172
 WL 4
 RT 224,11,56320
 RT 226,11,56832
 MV 104,228,168
 v_mul_f32 v77, s96, v77
 v_mul_f32 v78, s96, v78
 MV 80,200,176
 RT 228,12,56320
 RT 230,12,56832
 MV 84,200,180
 v_mul_f32 v79, s96, v79
 CV 68,68,69
 MV 92,204,180
 RT 200,11,60672
 RT 202,11,61184
 MV 88,204,176
 buffer_load_dwordx4 v4, s[28:31], s70 offen offset:1088 lds
 MV 96,208,176
 RT 204,12,60672
 RT 206,12,61184
 MV 100,208,180
 CV 70,70,71
 CV 76,76,77
 MV 108,212,180
 WL 4
 RT 208,11,65024
 RT 210,13,0
 MV 104,212,176
 CV 78,78,79
 v_permlane32_swap_b32 v68, v76
 MV 80,216,184
 RT 212,12,65024
 RT 214,14,0
 MV 84,216,188
 buffer_load_dwordx4 v5, s[28:31], s70 offen offset:2176 lds
 MV 92,220,188
 RT 216,13,3840
 RT 218,13,4352
 MV 88,220,184
 v_permlane32_swap_b32 v70, v78
 v_permlane16_swap_b32 v68, v76
 MV 80,224,192
 RT 220,14,3840
 RT 222,14,4352
 MV 84,224,196
 v_permlane16_swap_b32 v70, v78
 MV 92,228,196
 WL 4
 RT 224,13,8192
 RT 226,13,8704
 MV 88,228,192
 buffer_load_dwordx4 v6, s[28:31], s70 offen offset:3264 lds
 MV 80,200,200
 RT 228,14,8192
 MV 84,200,204
 RT 230,14,8704
 MV 92,204,204
 RT 200,13,12544
 MV 88,204,200
 RT 202,13,13056
 MV 80,208,208
 RT 204,14,12544
 RT 206,14,13056
 MV 84,208,212
 s_add_u32 m0, m0, 0x1100
 s_add_u32 s70, s73, 0x2d0000
 MV 92,212,212
 WL 4
 RT 208,13,16896
 RT 210,13,17408
 MV 88,212,208
 buffer_load_dwordx4 v3, s[28:31], s70 offen lds
 MV 80,216,216
 RT 212,14,16896
 MV 84,216,220
 RT 214,14,17408
 MV 92,220,220
 RT 216,13,21248
 MV 88,220,216
 RT 218,13,21760
 MV 80,224,224
 RT 220,14,21248
 RT 222,14,21760
 MV 84,224,228
 buffer_load_dwordx4 v4, s[28:31], s70 offen offset:1088 lds
 MV 92,228,228
 WL 4
 RT 224,11,52032
 MV 88,228,224
 RT 226,11,52544
 MV 80,200,232
 RT 228,12,52032
 MV 84,200,236
 RT 230,12,52544
 MV 92,204,236
 RT 200,11,56384
 RT 202,11,56896
 MV 88,204,232
 buffer_load_dwordx4 v5, s[28:31], s70 offen offset:2176 lds
 MV 80,208,240
 RT 204,12,56384
 MV 84,208,244
 RT 206,12,56896
 MV 92,212,244
 WL 4
 RT 208,11,60736
 MV 88,212,240
 RT 210,11,61248
 MV 80,216,248
 RT 212,12,60736
 RT 214,12,61248
 MV 84,216,252
 buffer_load_dwordx4 v6, s[28:31], s70 offen offset:3264 lds
 MV 92,220,252
 RT 216,11,65088
 MV 88,220,248
 RT 218,13,64
 MV 96,224,184
 RT 220,12,65088
 RT 222,14,64
 MV 100,224,188
 v_mul_f32 v80, s96, v80
 v_mul_f32 v81, s96, v81
 MV 108,228,188
 WL 4
 RT 224,13,3904
 RT 226,13,4416
 MV 104,228,184
 s_add_u32 m0, s66, 0x9900
 s_add_u32 s70, s74, 0x288000
 MV 96,200,192
 RT 228,14,3904
 RT 230,14,4416
 MV 100,200,196
 buffer_load_dwordx4 v3, s[28:31], s70 offen lds
 MV 108,204,196
 RT 200,13,8256
 RT 202,13,8768
 MV 104,204,192
 v_mul_f32 v82, s96, v82
 v_mul_f32 v83, s96, v83
 MV 96,208,200
 RT 204,14,8256
 RT 206,14,8768
 MV 100,208,204
 v_mul_f32 v88, s96, v88
 v_mul_f32 v89, s96, v89
 MV 108,212,204
 WL 4
 RT 208,13,12608
 RT 210,13,13120
 MV 104,212,200
 v_mul_f32 v90, s96, v90
 v_mul_f32 v91, s96, v91
 MV 96,216,208
 RT 212,14,12608
 RT 214,14,13120
 MV 100,216,212
 CV 80,80,81
 CV 82,82,83
 MV 108,220,212
 RT 216,13,16960
 RT 218,13,17472
 MV 104,220,208
 CV 88,88,89
 CV 90,90,91
 MV 96,224,216
 RT 220,14,16960
 RT 222,14,17472
 MV 100,224,220
 v_permlane32_swap_b32 v80, v88
 v_permlane32_swap_b32 v82, v90
 MV 108,228,220
 WL 4
 RT 224,13,21312
 RT 226,13,21824
 MV 104,228,216
 v_permlane16_swap_b32 v80, v88
 v_permlane16_swap_b32 v82, v90
 MV 96,200,224
 RT 228,14,21312
 RT 230,14,21824
 MV 100,200,228
 AW 168,48
 AW 169,50
 MV 108,204,228
 s_waitcnt vmcnt(10)
 s_barrier
 RT 200,9,0
 RT 202,9,512
 MV 104,204,224
 s_add_u32 s73, s73, 0x80
 s_add_u32 s74, s74, 0x80
 AW 170,56
 AW 171,58
 MV 96,208,232
 RT 204,10,0
 RT 206,10,512
 MV 100,208,236
 s_add_u32 m0, s65, 0x13200
 s_add_u32 s70, s73, 0
 AW 172,52
 AW 173,54
 MV 108,212,236
 WL 4
 RT 208,9,64
 RT 210,9,576
 MV 104,212,232
 buffer_load_dwordx4 v3, s[28:31], s70 offen lds
 AW 174,60
 AW 175,62
 MV 96,216,240
 RT 212,10,64
 RT 214,10,576
 MV 100,216,244
 AW 176,64
 AW 177,66
 MV 108,220,244
 RT 216,9,4352
 RT 218,9,4864
 MV 104,220,240
 AW 178,72
 AW 179,74
 MV 96,224,248
 RT 220,10,4352
 RT 222,10,4864
 MV 100,224,252
 buffer_load_dwordx4 v4, s[28:31], s70 offen offset:1088 lds
 AW 180,68
 AW 181,70
 MV 108,228,252
 WL 4
 RT 224,9,4416
 RT 226,9,4928
 MV 104,228,248
 AW 182,76
 AW 183,78
 v_mfma_f32_16x16x32_bf16 v[48:51], a[200:203], v[112:115], 0
 RT 228,10,4416
 RT 230,10,4928
 v_mfma_f32_16x16x32_bf16 v[52:55], a[200:203], v[116:119], 0
 v_mul_f32 v84, s96, v84
 v_mul_f32 v85, s96, v85
 v_mfma_f32_16x16x32_bf16 v[60:63], a[204:207], v[116:119], 0
 RT 200,9,8704
 RT 202,9,9216
 v_mfma_f32_16x16x32_bf16 v[56:59], a[204:207], v[112:115], 0
 buffer_load_dwordx4 v5, s[28:31], s70 offen offset:2176 lds
 v_mfma_f32_16x16x32_bf16 v[64:67], a[208:211], v[112:115], 0
 RT 204,10,8704
 RT 206,10,9216
 v_mfma_f32_16x16x32_bf16 v[68:71], a[208:211], v[116:119], 0
 v_mul_f32 v86, s96, v86
 v_mul_f32 v87, s96, v87
 v_mfma_f32_16x16x32_bf16 v[76:79], a[212:215], v[116:119], 0
 WL 4
 RT 208,9,8768
 RT 210,9,9280
 v_mfma_f32_16x16x32_bf16 v[72:75], a[212:215], v[112:115], 0
 v_mul_f32 v92, s96, v92
 v_mul_f32 v93, s96, v93
 MV 48,216,120
 RT 212,10,8768
 RT 214,10,9280
 MV 52,216,124
 buffer_load_dwordx4 v6, s[28:31], s70 offen offset:3264 lds
 MV 60,220,124
 RT 216,9,13056
 RT 218,9,13568
 MV 56,220,120
 v_mul_f32 v94, s96, v94
 v_mul_f32 v95, s96, v95
 MV 64,224,120
 RT 220,10,13056
 RT 222,10,13568
 MV 68,224,124
 CV 84,84,85
 CV 86,86,87
 MV 76,228,124
 WL 4
 RT 224,9,13120
 RT 226,9,13632
 MV 72,228,120
 s_add_u32 m0, m0, 0x1100
 s_add_u32 s70, s73, 0x48000
 MV 48,200,128
 RT 228,10,13120
 RT 230,10,13632
 MV 52,200,132
 buffer_load_dwordx4 v3, s[28:31], s70 offen lds
 MV 60,204,132
 RT 200,9,17408
 RT 202,9,17920
 MV 56,204,128
 CV 92,92,93
 CV 94,94,95
 MV 64,208,128
 RT 204,10,17408
 RT 206,10,17920
 MV 68,208,132
 v_permlane32_swap_b32 v84, v92
 v_permlane32_swap_b32 v86, v94
 MV 76,212,132
 WL 4
 RT 208,9,17472
 RT 210,9,17984
 MV 72,212,128
 buffer_load_dwordx4 v4, s[28:31], s70 offen offset:1088 lds
 MV 48,216,136
 RT 212,10,17472
 RT 214,10,17984
 MV 52,216,140
 v_permlane16_swap_b32 v84, v92
 v_permlane16_swap_b32 v86, v94
 MV 60,220,140
 RT 216,9,21760
 RT 218,9,22272
 MV 56,220,136
 v_mul_f32 v96, s96, v96
 v_mul_f32 v97, s96, v97
 MV 64,224,136
 RT 220,10,21760
 RT 222,10,22272
 MV 68,224,140
 buffer_load_dwordx4 v5, s[28:31], s70 offen offset:2176 lds
 MV 76,228,140
 WL 4
 RT 224,9,21824
 RT 226,9,22336
 MV 72,228,136
 v_mul_f32 v98, s96, v98
 v_mul_f32 v99, s96, v99
 MV 48,200,144
 RT 228,10,21824
 RT 230,10,22336
 MV 52,200,148
 v_mul_f32 v104, s96, v104
 v_mul_f32 v105, s96, v105
 MV 60,204,148
 RT 200,9,26112
 RT 202,9,26624
 MV 56,204,144
 buffer_load_dwordx4 v6, s[28:31], s70 offen offset:3264 lds
 MV 64,208,144
 RT 204,10,26112
 RT 206,10,26624
 MV 68,208,148
 v_mul_f32 v106, s96, v106
 v_mul_f32 v107, s96, v107
 MV 76,212,148
 WL 4
 RT 208,9,26176
 RT 210,9,26688
 MV 72,212,144
 CV 96,96,97
 CV 98,98,99
 MV 48,216,152
 RT 212,10,26176
 RT 214,10,26688
 MV 52,216,156
 s_add_u32 m0, s66, 0x13200
 s_add_u32 s70, s74, 0
 MV 60,220,156
 RT 216,9,30464
 RT 218,9,30976
 MV 56,220,152
 buffer_load_dwordx4 v3, s[28:31], s70 offen lds
 MV 64,224,152
 RT 220,10,30464
 RT 222,10,30976
 MV 68,224,156
 CV 104,104,105
 CV 106,106,107
 MV 76,228,156
 WL 4
 RT 224,9,30528
 RT 226,9,31040
 MV 72,228,152
 v_permlane32_swap_b32 v96, v104
 v_permlane32_swap_b32 v98, v106
 MV 48,200,160
 RT 228,10,30528
 RT 230,10,31040
 MV 52,200,164
 s_add_u32 s3, s3, 0x80
 v_permlane16_swap_b32 v96, v104
 MV 60,204,164
 RT 200,9,34816
 RT 202,9,35328
 MV 56,204,160
 buffer_load_dword v47, v36, s[28:31], s3 offen
 MV 64,208,160
 RT 204,10,34816
 RT 206,10,35328
 MV 68,208,164
 v_permlane16_swap_b32 v98, v106
 v_mul_f32 v100, s96, v100
 MV 76,212,164
 WL 4
 RT 208,9,34880
 RT 210,9,35392
 MV 72,212,160
 v_mul_f32 v101, s96, v101
 v_mul_f32 v102, s96, v102
 MV 48,216,168
 RT 212,10,34880
 RT 214,10,35392
 MV 52,216,172
 v_mul_f32 v103, s96, v103
 v_mul_f32 v108, s96, v108
 MV 60,220,172
 s_waitcnt vmcnt(10)
 s_barrier
 RT 216,9,39168
 RT 218,9,39680
 MV 56,220,168
 s_add_u32 m0, s65, 0x1cb00
 s_add_u32 s70, s73, 0x288000
 MV 64,224,168
 RT 220,10,39168
 RT 222,10,39680
 MV 68,224,172
 buffer_load_dwordx4 v3, s[28:31], s70 offen lds
 MV 76,228,172
 WL 4
 RT 224,9,43520
 RT 226,9,44032
 MV 72,228,168
 v_mul_f32 v109, s96, v109
 v_mul_f32 v110, s96, v110
 MV 48,200,176
 RT 228,10,43520
 RT 230,10,44032
 MV 52,200,180
 v_mul_f32 v111, s96, v111
 CV 100,100,101
 MV 60,204,180
 RT 200,9,47872
 RT 202,9,48384
 MV 56,204,176
 buffer_load_dwordx4 v4, s[28:31], s70 offen offset:1088 lds
 MV 64,208,176
 RT 204,10,47872
 RT 206,10,48384
 MV 68,208,180
 CV 102,102,103
 CV 108,108,109
 MV 76,212,180
 WL 4
 RT 208,9,52224
 RT 210,9,52736
 MV 72,212,176
 CV 110,110,111
 v_permlane32_swap_b32 v100, v108
 MV 48,216,184
 RT 212,10,52224
 RT 214,10,52736
 MV 52,216,188
 buffer_load_dwordx4 v5, s[28:31], s70 offen offset:2176 lds
 MV 60,220,188
 RT 216,9,56576
 RT 218,9,57088
 MV 56,220,184
 v_permlane32_swap_b32 v102, v110
 v_permlane16_swap_b32 v100, v108
 MV 48,224,192
 RT 220,10,56576
 RT 222,10,57088
 MV 52,224,196
 v_permlane16_swap_b32 v102, v110
 MV 60,228,196
 WL 4
 RT 224,9,60928
 RT 226,9,61440
 MV 56,228,192
 buffer_load_dwordx4 v6, s[28:31], s70 offen offset:3264 lds
 MV 48,200,200
 RT 228,10,60928
 MV 52,200,204
 RT 230,10,61440
 MV 60,204,204
 RT 200,9,65280
 MV 56,204,200
 RT 202,11,256
 MV 48,208,208
 RT 204,10,65280
 RT 206,12,256
 MV 52,208,212
 s_add_u32 m0, m0, 0x1100
 s_add_u32 s70, s73, 0x2d0000
 MV 60,212,212
 WL 4
 RT 208,11,4096
 RT 210,11,4608
 MV 56,212,208
 buffer_load_dwordx4 v3, s[28:31], s70 offen lds
 MV 48,216,216
 RT 212,12,4096
 MV 52,216,220
 RT 214,12,4608
 MV 60,220,220
 RT 216,11,8448
 MV 56,220,216
 RT 218,11,8960
 MV 48,224,224
 RT 220,12,8448
 RT 222,12,8960
 MV 52,224,228
 buffer_load_dwordx4 v4, s[28:31], s70 offen offset:1088 lds
 MV 60,228,228
 WL 4
 RT 224,9,39232
 MV 56,228,224
 RT 226,9,39744
 MV 48,200,232
 RT 228,10,39232
 MV 52,200,236
 RT 230,10,39744
 MV 60,204,236
 RT 200,9,43584
 RT 202,9,44096
 MV 56,204,232
 buffer_load_dwordx4 v5, s[28:31], s70 offen offset:2176 lds
 MV 48,208,240
 RT 204,10,43584
 MV 52,208,244
 RT 206,10,44096
 MV 60,212,244
 WL 4
 RT 208,9,47936
 MV 56,212,240
 RT 210,9,48448
 MV 48,216,248
 RT 212,10,47936
 RT 214,10,48448
 MV 52,216,252
 buffer_load_dwordx4 v6, s[28:31], s70 offen offset:3264 lds
 MV 60,220,252
 RT 216,9,52288
 MV 56,220,248
 RT 218,9,52800
 MV 64,224,184
 RT 220,10,52288
 RT 222,10,52800
 MV 68,224,188
 EX 16,48
 MV 76,228,188
 WL 4
 RT 224,9,56640
 RT 226,9,57152
 MV 72,228,184
 s_add_u32 m0, s66, 0x1cb00
 s_add_u32 s70, s74, 0x288000
 MV 64,200,192
 RT 228,10,56640
 RT 230,10,57152
 MV 68,200,196
 buffer_load_dwordx4 v3, s[28:31], s70 offen lds
 MV 76,204,196
 RT 200,9,60992
 RT 202,9,61504
 MV 72,204,192
 EX 17,49
 MV 64,208,200
 RT 204,10,60992
 RT 206,10,61504
 MV 68,208,204
 EX 18,50
 MV 76,212,204
 WL 4
 RT 208,9,65344
 RT 210,11,320
 MV 72,212,200
 EX 19,51
 MV 64,216,208
 RT 212,10,65344
 RT 214,12,320
 MV 68,216,212
 v_add_f32 v16, 1.0, v16
 v_add_f32 v17, 1.0, v17
 MV 76,220,212
 RT 216,11,4160
 RT 218,11,4672
 MV 72,220,208
 v_add_f32 v18, 1.0, v18
 v_add_f32 v19, 1.0, v19
 MV 64,224,216
 RT 220,12,4160
 RT 222,12,4672
 MV 68,224,220
 v_rcp_f32 v16, v16
 MV 76,228,220
 WL 4
 RT 224,11,8512
 RT 226,11,9024
 MV 72,228,216
 v_rcp_f32 v17, v17
 MV 64,200,224
 RT 228,12,8512
 RT 230,12,9024
 MV 68,200,228
 AW 184,80
 AW 185,82
 MV 76,204,228
 s_waitcnt vmcnt(10)
 s_barrier
 RT 200,11,12800
 RT 202,11,13312
 MV 72,204,224
 s_add_u32 s73, s73, 0x80
 s_add_u32 s74, s74, 0x80
 AW 186,88
 AW 187,90
 MV 64,208,232
 RT 204,12,12800
 RT 206,12,13312
 MV 68,208,236
 s_add_u32 m0, s65, 0
 s_add_u32 s70, s73, 0
 AW 188,84
 AW 189,86
 MV 76,212,236
 WL 4
 RT 208,11,12864
 RT 210,11,13376
 MV 72,212,232
 buffer_load_dwordx4 v3, s[28:31], s70 offen lds
 AW 190,92
 AW 191,94
 MV 64,216,240
 RT 212,12,12864
 RT 214,12,13376
 MV 68,216,244
 AW 192,96
 AW 193,98
 MV 76,220,244
 RT 216,11,17152
 RT 218,11,17664
 MV 72,220,240
 AW 194,104
 AW 195,106
 MV 64,224,248
 RT 220,12,17152
 RT 222,12,17664
 MV 68,224,252
 buffer_load_dwordx4 v4, s[28:31], s70 offen offset:1088 lds
 AW 196,100
 AW 197,102
 MV 76,228,252
 WL 4
 RT 224,11,17216
 RT 226,11,17728
 MV 72,228,248
 AW 198,108
 AW 199,110
 v_mfma_f32_16x16x32_bf16 v[80:83], a[200:203], v[112:115], 0
 RT 228,12,17216
 RT 230,12,17728
 v_mfma_f32_16x16x32_bf16 v[84:87], a[200:203], v[116:119], 0
 v_rcp_f32 v18, v18
 ML 16,48,16
 v_mfma_f32_16x16x32_bf16 v[92:95], a[204:207], v[116:119], 0
 RT 200,11,21504
 RT 202,11,22016
 v_mfma_f32_16x16x32_bf16 v[88:91], a[204:207], v[112:115], 0
 buffer_load_dwordx4 v5, s[28:31], s70 offen offset:2176 lds
 v_rcp_f32 v19, v19
 ML 17,49,17
 v_mfma_f32_16x16x32_bf16 v[96:99], a[208:211], v[112:115], 0
 RT 204,12,21504
 RT 206,12,22016
 v_mfma_f32_16x16x32_bf16 v[100:103], a[208:211], v[116:119], 0
 ML 18,50,18
 ML 19,51,19
 CV 48,16,17
 v_mfma_f32_16x16x32_bf16 v[108:111], a[212:215], v[116:119], 0
 WL 4
 RT 208,11,21568
 RT 210,11,22080
 v_mfma_f32_16x16x32_bf16 v[104:107], a[212:215], v[112:115], 0
 CV 50,18,19
 EX 20,56
 MV 80,216,120
 RT 212,12,21568
 RT 214,12,22080
 MV 84,216,124
 buffer_load_dwordx4 v6, s[28:31], s70 offen offset:3264 lds
 EX 21,57
 v_add_f32 v20, 1.0, v20
 MV 92,220,124
 RT 216,11,25856
 RT 218,11,26368
 MV 88,220,120
 EX 22,58
 v_add_f32 v21, 1.0, v21
 MV 96,224,120
 RT 220,12,25856
 RT 222,12,26368
 MV 100,224,124
 EX 23,59
 v_add_f32 v22, 1.0, v22
 MV 108,228,124
 WL 4
 RT 224,11,25920
 RT 226,11,26432
 MV 104,228,120
 s_add_u32 m0, m0, 0x1100
 s_add_u32 s70, s73, 0x48000
 v_add_f32 v23, 1.0, v23
 v_rcp_f32 v20, v20
 MV 80,200,128
 RT 228,12,25920
 RT 230,12,26432
 MV 84,200,132
 buffer_load_dwordx4 v3, s[28:31], s70 offen lds
 v_rcp_f32 v21, v21
 ML 20,56,20
 MV 92,204,132
 RT 200,11,30208
 RT 202,11,30720
 MV 88,204,128
 v_rcp_f32 v22, v22
 ML 21,57,21
 MV 96,208,128
 RT 204,12,30208
 RT 206,12,30720
 MV 100,208,132
 v_rcp_f32 v23, v23
 ML 22,58,22
 MV 108,212,132
 WL 4
 RT 208,11,30272
 RT 210,11,30784
 MV 104,212,128
 buffer_load_dwordx4 v4, s[28:31], s70 offen offset:1088 lds
 ML 23,59,23
 CV 56,20,21
 CV 58,22,23
 MV 80,216,136
 RT 212,12,30272
 RT 214,12,30784
 MV 84,216,140
 EX 24,52
 MV 92,220,140
 RT 216,11,34560
 RT 218,11,35072
 MV 88,220,136
 EX 25,53
 EX 26,54
 MV 96,224,136
 RT 220,12,34560
 RT 222,12,35072
 MV 100,224,140
 buffer_load_dwordx4 v5, s[28:31], s70 offen offset:2176 lds
 EX 27,55
 v_add_f32 v24, 1.0, v24
 MV 108,228,140
 WL 4
 RT 224,11,34624
 RT 226,11,35136
 MV 104,228,136
 v_add_f32 v25, 1.0, v25
 v_add_f32 v26, 1.0, v26
 v_add_f32 v27, 1.0, v27
 MV 80,200,144
 RT 228,12,34624
 RT 230,12,35136
 MV 84,200,148
 v_rcp_f32 v24, v24
 MV 92,204,148
 RT 200,11,38912
 RT 202,11,39424
 MV 88,204,144
 buffer_load_dwordx4 v6, s[28:31], s70 offen offset:3264 lds
 v_rcp_f32 v25, v25
 v_rcp_f32 v26, v26
 MV 96,208,144
 RT 204,12,38912
 RT 206,12,39424
 MV 100,208,148
 v_rcp_f32 v27, v27
 ML 24,52,24
 MV 108,212,148
 WL 4
 RT 208,11,38976
 RT 210,11,39488
 MV 104,212,144
 ML 25,53,25
 ML 26,54,26
 ML 27,55,27
 MV 80,216,152
 RT 212,12,38976
 RT 214,12,39488
 MV 84,216,156
 s_add_u32 m0, s66, 0
 s_add_u32 s70, s74, 0
 CV 52,24,25
 CV 54,26,27
 MV 92,220,156
 RT 216,11,43264
 RT 218,11,43776
 MV 88,220,152
 buffer_load_dwordx4 v3, s[28:31], s70 offen lds
 EX 28,60
 EX 29,61
 MV 96,224,152
 RT 220,12,43264
 RT 222,12,43776
 MV 100,224,156
 EX 30,62
 v_add_f32 v28, 1.0, v28
 MV 108,228,156
 WL 4
 RT 224,11,43328
 RT 226,11,43840
 MV 104,228,152
 EX 31,63
 v_add_f32 v29, 1.0, v29
 MV 80,200,160
 RT 228,12,43328
 RT 230,12,43840
 MV 84,200,164
 s_mov_b32 s3, s45
 v_add_f32 v30, 1.0, v30
 v_add_f32 v31, 1.0, v31
 MV 92,204,164
 RT 200,11,47616
 RT 202,11,48128
 MV 88,204,160
 buffer_load_dword v47, v36, s[28:31], s3 offen
 v_rcp_f32 v28, v28
 v_rcp_f32 v29, v29
 MV 96,208,160
 RT 204,12,47616
 RT 206,12,48128
 MV 100,208,164
 v_rcp_f32 v30, v30
 ML 28,60,28
 MV 108,212,164
 WL 4
 RT 208,11,47680
 RT 210,11,48192
 MV 104,212,160
 v_rcp_f32 v31, v31
 ML 29,61,29
 MV 80,216,168
 RT 212,12,47680
 RT 214,12,48192
 MV 84,216,172
 ML 30,62,30
 ML 31,63,31
 CV 60,28,29
 MV 92,220,172
 s_waitcnt vmcnt(10)
 s_barrier
 RT 216,11,51968
 RT 218,11,52480
 MV 88,220,168
 s_add_u32 m0, s65, 0x9900
 s_add_u32 s70, s73, 0x288000
 CV 62,30,31
 EX 16,64
 MV 96,224,168
 RT 220,12,51968
 RT 222,12,52480
 MV 100,224,172
 buffer_load_dwordx4 v3, s[28:31], s70 offen lds
 EX 17,65
 v_add_f32 v16, 1.0, v16
 MV 108,228,172
 WL 4
 RT 224,11,56320
 RT 226,11,56832
 MV 104,228,168
 EX 18,66
 v_add_f32 v17, 1.0, v17
 MV 80,200,176
 RT 228,12,56320
 RT 230,12,56832
 MV 84,200,180
 EX 19,67
 v_add_f32 v18, 1.0, v18
 MV 92,204,180
 RT 200,11,60672
 RT 202,11,61184
 MV 88,204,176
 buffer_load_dwordx4 v4, s[28:31], s70 offen offset:1088 lds
 v_add_f32 v19, 1.0, v19
 v_rcp_f32 v16, v16
 MV 96,208,176
 RT 204,12,60672
 RT 206,12,61184
 MV 100,208,180
 v_rcp_f32 v17, v17
 ML 16,64,16
 MV 108,212,180
 WL 4
 RT 208,11,65024
 RT 210,13,0
 MV 104,212,176
 v_rcp_f32 v18, v18
 ML 17,65,17
 MV 80,216,184
 RT 212,12,65024
 RT 214,14,0
 MV 84,216,188
 buffer_load_dwordx4 v5, s[28:31], s70 offen offset:2176 lds
 v_rcp_f32 v19, v19
 ML 18,66,18
 MV 92,220,188
 RT 216,13,3840
 RT 218,13,4352
 MV 88,220,184
 ML 19,67,19
 CV 64,16,17
 CV 66,18,19
 MV 80,224,192
 RT 220,14,3840
 RT 222,14,4352
 MV 84,224,196
 EX 20,72
 MV 92,228,196
 WL 4
 RT 224,13,8192
 RT 226,13,8704
 MV 88,228,192
 buffer_load_dwordx4 v6, s[28:31], s70 offen offset:3264 lds
 EX 21,73
 EX 22,74
 MV 80,200,200
 RT 228,14,8192
 RT 230,14,8704
 MV 84,200,204
 EX 23,75
 v_add_f32 v20, 1.0, v20
 MV 92,204,204
 RT 200,13,12544
 RT 202,13,13056
 MV 88,204,200
 v_add_f32 v21, 1.0, v21
 v_add_f32 v22, 1.0, v22
 v_add_f32 v23, 1.0, v23
 MV 80,208,208
 RT 204,14,12544
 RT 206,14,13056
 MV 84,208,212
 s_add_u32 m0, m0, 0x1100
 s_add_u32 s70, s73, 0x2d0000
 v_rcp_f32 v20, v20
 MV 92,212,212
 WL 4
 RT 208,13,16896
 RT 210,13,17408
 MV 88,212,208
 buffer_load_dwordx4 v3, s[28:31], s70 offen lds
 v_rcp_f32 v21, v21
 v_rcp_f32 v22, v22
 MV 80,216,216
 RT 212,14,16896
 RT 214,14,17408
 MV 84,216,220
 v_rcp_f32 v23, v23
 ML 20,72,20
 MV 92,220,220
 RT 216,13,21248
 RT 218,13,21760
 MV 88,220,216
 ML 21,73,21
 ML 22,74,22
 ML 23,75,23
 MV 80,224,224
 RT 220,14,21248
 RT 222,14,21760
 MV 84,224,228
 buffer_load_dwordx4 v4, s[28:31], s70 offen offset:1088 lds
 CV 72,20,21
 CV 74,22,23
 MV 92,228,228
 WL 4
 RT 224,11,52032
 RT 226,11,52544
 MV 88,228,224
 EX 24,68
 EX 25,69
 MV 80,200,232
 RT 228,12,52032
 RT 230,12,52544
 MV 84,200,236
 EX 26,70
 v_add_f32 v24, 1.0, v24
 MV 92,204,236
 RT 200,11,56384
 RT 202,11,56896
 MV 88,204,232
 buffer_load_dwordx4 v5, s[28:31], s70 offen offset:2176 lds
 EX 27,71
 v_add_f32 v25, 1.0, v25
 MV 80,208,240
 RT 204,12,56384
 RT 206,12,56896
 MV 84,208,244
 v_add_f32 v26, 1.0, v26
 v_add_f32 v27, 1.0, v27
 MV 92,212,244
 WL 4
 RT 208,11,60736
 RT 210,11,61248
 MV 88,212,240
 v_rcp_f32 v24, v24
 v_rcp_f32 v25, v25
 MV 80,216,248
 RT 212,12,60736
 RT 214,12,61248
 MV 84,216,252
 buffer_load_dwordx4 v6, s[28:31], s70 offen offset:3264 lds
 v_rcp_f32 v26, v26
 ML 24,68,24
 MV 92,220,252
 RT 216,11,65088
 RT 218,13,64
 MV 88,220,248
 v_rcp_f32 v27, v27
 ML 25,69,25
 MV 96,224,184
 RT 220,12,65088
 RT 222,14,64
 MV 100,224,188
 ML 26,70,26
 ML 27,71,27
 CV 68,24,25
 MV 108,228,188
 WL 4
 RT 224,13,3904
 RT 226,13,4416
 MV 104,228,184
 s_add_u32 m0, s66, 0x9900
 s_add_u32 s70, s74, 0x288000
 CV 70,26,27
 EX 28,76
 MV 96,200,192
 RT 228,14,3904
 RT 230,14,4416
 MV 100,200,196
 buffer_load_dwordx4 v3, s[28:31], s70 offen lds
 EX 29,77
 v_add_f32 v28, 1.0, v28
 MV 108,204,196
 RT 200,13,8256
 RT 202,13,8768
 MV 104,204,192
 EX 30,78
 v_add_f32 v29, 1.0, v29
 MV 96,208,200
 RT 204,14,8256
 RT 206,14,8768
 MV 100,208,204
 EX 31,79
 v_add_f32 v30, 1.0, v30
 MV 108,212,204
 WL 4
 RT 208,13,12608
 RT 210,13,13120
 MV 104,212,200
 v_add_f32 v31, 1.0, v31
 v_rcp_f32 v28, v28
 MV 96,216,208
 RT 212,14,12608
 RT 214,14,13120
 MV 100,216,212
 v_rcp_f32 v29, v29
 ML 28,76,28
 MV 108,220,212
 RT 216,13,16960
 RT 218,13,17472
 MV 104,220,208
 v_rcp_f32 v30, v30
 ML 29,77,29
 MV 96,224,216
 RT 220,14,16960
 RT 222,14,17472
 MV 100,224,220
 v_rcp_f32 v31, v31
 ML 30,78,30
 MV 108,228,220
 WL 4
 RT 224,13,21312
 RT 226,13,21824
 MV 104,228,216
 ML 31,79,31
 CV 76,28,29
 CV 78,30,31
 MV 96,200,224
 RT 228,14,21312
 RT 230,14,21824
 MV 100,200,228
 AW 0,48
 AW 1,50
 MV 108,204,228
 s_waitcnt vmcnt(10)
 s_barrier
 RT 200,9,0
 RT 202,9,512
 MV 104,204,224
 s_add_u32 s73, s73, 0x80
 s_add_u32 s74, s74, 0x80
 AW 2,56
 AW 3,58
 MV 96,208,232
 RT 204,10,0
 RT 206,10,512
 MV 100,208,236
 s_add_u32 m0, s65, 0x13200
 s_add_u32 s70, s73, 0
 AW 4,52
 AW 5,54
 MV 108,212,236
 WL 4
 RT 208,9,64
 RT 210,9,576
 MV 104,212,232
 buffer_load_dwordx4 v3, s[28:31], s70 offen lds
 AW 6,60
 AW 7,62
 MV 96,216,240
 RT 212,10,64
 RT 214,10,576
 MV 100,216,244
 AW 8,64
 AW 9,66
 MV 108,220,244
 RT 216,9,4352
 RT 218,9,4864
 MV 104,220,240
 AW 10,72
 AW 11,74
 MV 96,224,248
 RT 220,10,4352
 RT 222,10,4864
 MV 100,224,252
 buffer_load_dwordx4 v4, s[28:31], s70 offen offset:1088 lds
 AW 12,68
 AW 13,70
 MV 108,228,252
 WL 4
 RT 224,9,4416
 RT 226,9,4928
 MV 104,228,248
 AW 14,76
 AW 15,78
 v_mfma_f32_16x16x32_bf16 v[48:51], a[200:203], v[112:115], 0
 RT 228,10,4416
 RT 230,10,4928
 v_mfma_f32_16x16x32_bf16 v[52:55], a[200:203], v[116:119], 0
 EX 16,80
 EX 17,81
 v_mfma_f32_16x16x32_bf16 v[60:63], a[204:207], v[116:119], 0
 RT 200,9,8704
 RT 202,9,9216
 v_mfma_f32_16x16x32_bf16 v[56:59], a[204:207], v[112:115], 0
 buffer_load_dwordx4 v5, s[28:31], s70 offen offset:2176 lds
 EX 18,82
 EX 19,83
 v_mfma_f32_16x16x32_bf16 v[64:67], a[208:211], v[112:115], 0
 RT 204,10,8704
 RT 206,10,9216
 v_mfma_f32_16x16x32_bf16 v[68:71], a[208:211], v[116:119], 0
 v_add_f32 v16, 1.0, v16
 v_add_f32 v17, 1.0, v17
 v_add_f32 v18, 1.0, v18
 v_add_f32 v19, 1.0, v19
 v_mfma_f32_16x16x32_bf16 v[76:79], a[212:215], v[116:119], 0
 WL 4
 RT 208,9,8768
 RT 210,9,9280
 v_mfma_f32_16x16x32_bf16 v[72:75], a[212:215], v[112:115], 0
 v_rcp_f32 v16, v16
 v_rcp_f32 v17, v17
 MV 48,216,120
 RT 212,10,8768
 RT 214,10,9280
 MV 52,216,124
 buffer_load_dwordx4 v6, s[28:31], s70 offen offset:3264 lds
 v_rcp_f32 v18, v18
 v_rcp_f32 v19, v19
 MV 60,220,124
 RT 216,9,13056
 RT 218,9,13568
 MV 56,220,120
 ML 16,80,16
 ML 17,81,17
 ML 18,82,18
 ML 19,83,19
 MV 64,224,120
 RT 220,10,13056
 RT 222,10,13568
 MV 68,224,124
 CV 80,16,17
 CV 82,18,19
 EX 20,88
 MV 76,228,124
 WL 4
 RT 224,9,13120
 RT 226,9,13632
 MV 72,228,120
 s_add_u32 m0, m0, 0x1100
 s_add_u32 s70, s73, 0x48000
 EX 21,89
 EX 22,90
 MV 48,200,128
 RT 228,10,13120
 RT 230,10,13632
 MV 52,200,132
 buffer_load_dwordx4 v3, s[28:31], s70 offen lds
 EX 23,91
 v_add_f32 v20, 1.0, v20
 v_add_f32 v21, 1.0, v21
 MV 60,204,132
 RT 200,9,17408
 RT 202,9,17920
 MV 56,204,128
 v_add_f32 v22, 1.0, v22
 v_add_f32 v23, 1.0, v23
 v_rcp_f32 v20, v20
 MV 64,208,128
 RT 204,10,17408
 RT 206,10,17920
 MV 68,208,132
 v_rcp_f32 v21, v21
 v_rcp_f32 v22, v22
 MV 76,212,132
 WL 4
 RT 208,9,17472
 RT 210,9,17984
 MV 72,212,128
 buffer_load_dwordx4 v4, s[28:31], s70 offen offset:1088 lds
 v_rcp_f32 v23, v23
 ML 20,88,20
 ML 21,89,21
 MV 48,216,136
 RT 212,10,17472
 RT 214,10,17984
 MV 52,216,140
 ML 22,90,22
 ML 23,91,23
 CV 88,20,21
 CV 90,22,23
 MV 60,220,140
 RT 216,9,21760
 RT 218,9,22272
 MV 56,220,136
 EX 24,84
 EX 25,85
 MV 64,224,136
 RT 220,10,21760
 RT 222,10,22272
 MV 68,224,140
 buffer_load_dwordx4 v5, s[28:31], s70 offen offset:2176 lds
 EX 26,86
 EX 27,87
 MV 76,228,140
 WL 4
 RT 224,9,21824
 RT 226,9,22336
 MV 72,228,136
 v_add_f32 v24, 1.0, v24
 v_add_f32 v25, 1.0, v25
 v_add_f32 v26, 1.0, v26
 v_add_f32 v27, 1.0, v27
 MV 48,200,144
 RT 228,10,21824
 RT 230,10,22336
 MV 52,200,148
 v_rcp_f32 v24, v24
 MV 60,204,148
 RT 200,9,26112
 RT 202,9,26624
 MV 56,204,144
 buffer_load_dwordx4 v6, s[28:31], s70 offen offset:3264 lds
 v_rcp_f32 v25, v25
 v_rcp_f32 v26, v26
 MV 64,208,144
 RT 204,10,26112
 RT 206,10,26624
 MV 68,208,148
 v_rcp_f32 v27, v27
 ML 24,84,24
 MV 76,212,148
 WL 4
 RT 208,9,26176
 RT 210,9,26688
 MV 72,212,144
 ML 25,85,25
 ML 26,86,26
 ML 27,87,27
 MV 48,216,152
 RT 212,10,26176
 RT 214,10,26688
 MV 52,216,156
 s_add_u32 m0, s66, 0x13200
 s_add_u32 s70, s74, 0
 CV 84,24,25
 CV 86,26,27
 MV 60,220,156
 RT 216,9,30464
 RT 218,9,30976
 MV 56,220,152
 buffer_load_dwordx4 v3, s[28:31], s70 offen lds
 EX 28,92
 EX 29,93
 MV 64,224,152
 RT 220,10,30464
 RT 222,10,30976
 MV 68,224,156
 EX 30,94
 v_add_f32 v28, 1.0, v28
 MV 76,228,156
 WL 4
 RT 224,9,30528
 RT 226,9,31040
 MV 72,228,152
 EX 31,95
 v_add_f32 v29, 1.0, v29
 MV 48,200,160
 RT 228,10,30528
 RT 230,10,31040
 MV 52,200,164
 v_add_f32 v30, 1.0, v30
 v_add_f32 v31, 1.0, v31
 MV 60,204,164
 RT 200,9,34816
 RT 202,9,35328
 MV 56,204,160
 v_rcp_f32 v28, v28
 v_rcp_f32 v29, v29
 MV 64,208,160
 RT 204,10,34816
 RT 206,10,35328
 MV 68,208,164
 v_rcp_f32 v30, v30
 ML 28,92,28
 MV 76,212,164
 WL 4
 RT 208,9,34880
 RT 210,9,35392
 MV 72,212,160
 v_rcp_f32 v31, v31
 ML 29,93,29
 MV 48,216,168
 RT 212,10,34880
 RT 214,10,35392
 MV 52,216,172
 ML 30,94,30
 ML 31,95,31
 CV 92,28,29
 MV 60,220,172
 s_waitcnt vmcnt(9)
 s_barrier
 RT 216,9,39168
 RT 218,9,39680
 MV 56,220,168
 s_add_u32 m0, s65, 0x1cb00
 s_add_u32 s70, s73, 0x288000
 CV 94,30,31
 EX 16,96
 MV 64,224,168
 RT 220,10,39168
 RT 222,10,39680
 MV 68,224,172
 buffer_load_dwordx4 v3, s[28:31], s70 offen lds
 EX 17,97
 v_add_f32 v16, 1.0, v16
 MV 76,228,172
 WL 4
 RT 224,9,43520
 RT 226,9,44032
 MV 72,228,168
 EX 18,98
 v_add_f32 v17, 1.0, v17
 MV 48,200,176
 RT 228,10,43520
 RT 230,10,44032
 MV 52,200,180
 EX 19,99
 v_add_f32 v18, 1.0, v18
 MV 60,204,180
 RT 200,9,47872
 RT 202,9,48384
 MV 56,204,176
 buffer_load_dwordx4 v4, s[28:31], s70 offen offset:1088 lds
 v_add_f32 v19, 1.0, v19
 v_rcp_f32 v16, v16
 MV 64,208,176
 RT 204,10,47872
 RT 206,10,48384
 MV 68,208,180
 v_rcp_f32 v17, v17
 ML 16,96,16
 MV 76,212,180
 WL 4
 RT 208,9,52224
 RT 210,9,52736
 MV 72,212,176
 v_rcp_f32 v18, v18
 ML 17,97,17
 MV 48,216,184
 RT 212,10,52224
 RT 214,10,52736
 MV 52,216,188
 buffer_load_dwordx4 v5, s[28:31], s70 offen offset:2176 lds
 v_rcp_f32 v19, v19
 ML 18,98,18
 MV 60,220,188
 RT 216,9,56576
 RT 218,9,57088
 MV 56,220,184
 ML 19,99,19
 CV 96,16,17
 CV 98,18,19
 MV 48,224,192
 RT 220,10,56576
 RT 222,10,57088
 MV 52,224,196
 EX 20,104
 MV 60,228,196
 WL 4
 RT 224,9,60928
 RT 226,9,61440
 MV 56,228,192
 buffer_load_dwordx4 v6, s[28:31], s70 offen offset:3264 lds
 EX 21,105
 EX 22,106
 MV 48,200,200
 RT 228,10,60928
 RT 230,10,61440
 MV 52,200,204
 EX 23,107
 v_add_f32 v20, 1.0, v20
 MV 60,204,204
 RT 200,9,65280
 RT 202,11,256
 MV 56,204,200
 v_add_f32 v21, 1.0, v21
 v_add_f32 v22, 1.0, v22
 v_add_f32 v23, 1.0, v23
 MV 48,208,208
 RT 204,10,65280
 RT 206,12,256
 MV 52,208,212
 s_add_u32 m0, m0, 0x1100
 s_add_u32 s70, s73, 0x2d0000
 v_rcp_f32 v20, v20
 MV 60,212,212
 WL 4
 RT 208,11,4096
 RT 210,11,4608
 MV 56,212,208
 buffer_load_dwordx4 v3, s[28:31], s70 offen lds
 v_rcp_f32 v21, v21
 v_rcp_f32 v22, v22
 MV 48,216,216
 RT 212,12,4096
 RT 214,12,4608
 MV 52,216,220
 v_rcp_f32 v23, v23
 ML 20,104,20
 MV 60,220,220
 RT 216,11,8448
 RT 218,11,8960
 MV 56,220,216
 ML 21,105,21
 ML 22,106,22
 ML 23,107,23
 MV 48,224,224
 RT 220,12,8448
 RT 222,12,8960
 MV 52,224,228
 buffer_load_dwordx4 v4, s[28:31], s70 offen offset:1088 lds
 CV 104,20,21
 CV 106,22,23
 MV 60,228,228
 WL 4
 RT 224,9,39232
 RT 226,9,39744
 MV 56,228,224
 EX 24,100
 EX 25,101
 MV 48,200,232
 RT 228,10,39232
 RT 230,10,39744
 MV 52,200,236
 EX 26,102
 v_add_f32 v24, 1.0, v24
 MV 60,204,236
 RT 200,9,43584
 RT 202,9,44096
 MV 56,204,232
 buffer_load_dwordx4 v5, s[28:31], s70 offen offset:2176 lds
 EX 27,103
 v_add_f32 v25, 1.0, v25
 MV 48,208,240
 RT 204,10,43584
 RT 206,10,44096
 MV 52,208,244
 v_add_f32 v26, 1.0, v26
 v_add_f32 v27, 1.0, v27
 MV 60,212,244
 WL 4
 RT 208,9,47936
 RT 210,9,48448
 MV 56,212,240
 v_rcp_f32 v24, v24
 v_rcp_f32 v25, v25
 MV 48,216,248
 RT 212,10,47936
 RT 214,10,48448
 MV 52,216,252
 buffer_load_dwordx4 v6, s[28:31], s70 offen offset:3264 lds
 v_rcp_f32 v26, v26
 ML 24,100,24
 MV 60,220,252
 RT 216,9,52288
 RT 218,9,52800
 MV 56,220,248
 v_rcp_f32 v27, v27
 ML 25,101,25
 MV 64,224,184
 RT 220,10,52288
 RT 222,10,52800
 MV 68,224,188
 ML 26,102,26
 ML 27,103,27
 CV 100,24,25
 MV 76,228,188
 WL 4
 RT 224,9,56640
 RT 226,9,57152
 MV 72,228,184
 s_add_u32 m0, s66, 0x1cb00
 s_add_u32 s70, s74, 0x288000
 CV 102,26,27
 EX 28,108
 MV 64,200,192
 RT 228,10,56640
 RT 230,10,57152
 MV 68,200,196
 buffer_load_dwordx4 v3, s[28:31], s70 offen lds
 EX 29,109
 v_add_f32 v28, 1.0, v28
 MV 76,204,196
 RT 200,9,60992
 RT 202,9,61504
 MV 72,204,192
 EX 30,110
 v_add_f32 v29, 1.0, v29
 MV 64,208,200
 RT 204,10,60992
 RT 206,10,61504
 MV 68,208,204
 EX 31,111
 v_add_f32 v30, 1.0, v30
 MV 76,212,204
 WL 4
 RT 208,9,65344
 RT 210,11,320
 MV 72,212,200
 v_add_f32 v31, 1.0, v31
 v_rcp_f32 v28, v28
 MV 64,216,208
 RT 212,10,65344
 RT 214,12,320
 MV 68,216,212
 v_rcp_f32 v29, v29
 ML 28,108,28
 MV 76,220,212
 RT 216,11,4160
 RT 218,11,4672
 MV 72,220,208
 v_rcp_f32 v30, v30
 ML 29,109,29
 MV 64,224,216
 RT 220,12,4160
 RT 222,12,4672
 MV 68,224,220
 v_rcp_f32 v31, v31
 ML 30,110,30
 MV 76,228,220
 WL 4
 RT 224,11,8512
 RT 226,11,9024
 MV 72,228,216
 ML 31,111,31
 CV 108,28,29
 CV 110,30,31
 MV 64,200,224
 RT 228,12,8512
 RT 230,12,9024
 MV 68,200,228
 AW 16,80
 AW 17,82
 MV 76,204,228
 s_waitcnt vmcnt(9)
 s_barrier
 RT 200,11,12800
 RT 202,11,13312
 MV 72,204,224
 s_add_u32 m0, s67, 0
 s_add_u32 s70, s75, 0
 AW 18,88
 AW 19,90
 MV 64,208,232
 RT 204,12,12800
 RT 206,12,13312
 MV 68,208,236
 buffer_load_dwordx4 v7, s[28:31], s70 offen lds
 AW 20,84
 AW 21,86
 MV 76,212,236
 WL 4
 RT 208,11,12864
 RT 210,11,13376
 MV 72,212,232
 AW 22,92
 AW 23,94
 MV 64,216,240
 RT 212,12,12864
 RT 214,12,13376
 MV 68,216,244
 AW 24,96
 AW 25,98
 MV 76,220,244
 RT 216,11,17152
 RT 218,11,17664
 MV 72,220,240
 s_add_u32 s70, s75, 0x23c00
 AW 26,104
 AW 27,106
 MV 64,224,248
 RT 220,12,17152
 RT 222,12,17664
 MV 68,224,252
 buffer_load_dwordx4 v7, s[28:31], s70 offen offset:1024 lds
 AW 28,100
 AW 29,102
 MV 76,228,252
 WL 4
 RT 224,11,17216
 RT 226,11,17728
 MV 72,228,248
 AW 30,108
 AW 31,110
 v_mfma_f32_16x16x32_bf16 v[80:83], a[200:203], v[112:115], 0
 RT 228,12,17216
 RT 230,12,17728
 v_mfma_f32_16x16x32_bf16 v[84:87], a[200:203], v[116:119], 0
 EX 16,48
 EX 17,49
 v_mfma_f32_16x16x32_bf16 v[92:95], a[204:207], v[116:119], 0
 RT 200,11,21504
 RT 202,11,22016
 v_mfma_f32_16x16x32_bf16 v[88:91], a[204:207], v[112:115], 0
 s_add_u32 s70, s75, 0x47800
 EX 18,50
 EX 19,51
 v_mfma_f32_16x16x32_bf16 v[96:99], a[208:211], v[112:115], 0
 RT 204,12,21504
 RT 206,12,22016
 v_mfma_f32_16x16x32_bf16 v[100:103], a[208:211], v[116:119], 0
 buffer_load_dwordx4 v7, s[28:31], s70 offen offset:2048 lds
 v_add_f32 v16, 1.0, v16
 v_add_f32 v17, 1.0, v17
 v_add_f32 v18, 1.0, v18
 v_add_f32 v19, 1.0, v19
 v_mfma_f32_16x16x32_bf16 v[108:111], a[212:215], v[116:119], 0
 WL 4
 RT 208,11,21568
 RT 210,11,22080
 v_mfma_f32_16x16x32_bf16 v[104:107], a[212:215], v[112:115], 0
 v_rcp_f32 v16, v16
 v_rcp_f32 v17, v17
 MV 80,216,120
 RT 212,12,21568
 RT 214,12,22080
 MV 84,216,124
 v_rcp_f32 v18, v18
 v_rcp_f32 v19, v19
 MV 92,220,124
 RT 216,11,25856
 RT 218,11,26368
 MV 88,220,120
 s_add_u32 s70, s75, 0x6b400
 ML 16,48,16
 ML 17,49,17
 ML 18,50,18
 ML 19,51,19
 MV 96,224,120
 RT 220,12,25856
 RT 222,12,26368
 MV 100,224,124
 buffer_load_dwordx4 v7, s[28:31], s70 offen offset:3072 lds
 CV 48,16,17
 CV 50,18,19
 EX 20,56
 MV 108,228,124
 WL 4
 RT 224,11,25920
 RT 226,11,26432
 MV 104,228,120
 EX 21,57
 EX 22,58
 MV 80,200,128
 RT 228,12,25920
 RT 230,12,26432
 MV 84,200,132
 EX 23,59
 v_add_f32 v20, 1.0, v20
 v_add_f32 v21, 1.0, v21
 MV 92,204,132
 RT 200,11,30208
 RT 202,11,30720
 MV 88,204,128
 s_add_u32 m0, m0, 0x1000
 s_add_u32 s70, s75, 0x90000
 v_add_f32 v22, 1.0, v22
 v_add_f32 v23, 1.0, v23
 v_rcp_f32 v20, v20
 MV 96,208,128
 RT 204,12,30208
 RT 206,12,30720
 MV 100,208,132
 buffer_load_dwordx4 v7, s[28:31], s70 offen lds
 v_rcp_f32 v21, v21
 v_rcp_f32 v22, v22
 MV 108,212,132
 WL 4
 RT 208,11,30272
 RT 210,11,30784
 MV 104,212,128
 v_rcp_f32 v23, v23
 ML 20,56,20
 ML 21,57,21
 MV 80,216,136
 RT 212,12,30272
 RT 214,12,30784
 MV 84,216,140
 ML 22,58,22
 ML 23,59,23
 CV 56,20,21
 CV 58,22,23
 MV 92,220,140
 RT 216,11,34560
 RT 218,11,35072
 MV 88,220,136
 s_add_u32 s70, s75, 0xb3c00
 EX 24,52
 EX 25,53
 MV 96,224,136
 RT 220,12,34560
 RT 222,12,35072
 MV 100,224,140
 buffer_load_dwordx4 v7, s[28:31], s70 offen offset:1024 lds
 EX 26,54
 EX 27,55
 MV 108,228,140
 WL 4
 RT 224,11,34624
 RT 226,11,35136
 MV 104,228,136
 v_add_f32 v24, 1.0, v24
 v_add_f32 v25, 1.0, v25
 v_add_f32 v26, 1.0, v26
 v_add_f32 v27, 1.0, v27
 MV 80,200,144
 RT 228,12,34624
 RT 230,12,35136
 MV 84,200,148
 v_rcp_f32 v24, v24
 MV 92,204,148
 RT 200,11,38912
 RT 202,11,39424
 MV 88,204,144
 s_add_u32 s70, s75, 0xd7800
 v_rcp_f32 v25, v25
 v_rcp_f32 v26, v26
 MV 96,208,144
 RT 204,12,38912
 RT 206,12,39424
 MV 100,208,148
 buffer_load_dwordx4 v7, s[28:31], s70 offen offset:2048 lds
 v_rcp_f32 v27, v27
 ML 24,52,24
 MV 108,212,148
 WL 4
 RT 208,11,38976
 RT 210,11,39488
 MV 104,212,144
 ML 25,53,25
 ML 26,54,26
 ML 27,55,27
 MV 80,216,152
 RT 212,12,38976
 RT 214,12,39488
 MV 84,216,156
 CV 52,24,25
 CV 54,26,27
 MV 92,220,156
 RT 216,11,43264
 RT 218,11,43776
 MV 88,220,152
 s_add_u32 s70, s75, 0xfb400
 EX 28,60
 EX 29,61
 MV 96,224,152
 RT 220,12,43264
 RT 222,12,43776
 MV 100,224,156
 buffer_load_dwordx4 v7, s[28:31], s70 offen offset:3072 lds
 EX 30,62
 v_add_f32 v28, 1.0, v28
 MV 108,228,156
 WL 4
 RT 224,11,43328
 RT 226,11,43840
 MV 104,228,152
 EX 31,63
 v_add_f32 v29, 1.0, v29
 MV 80,200,160
 RT 228,12,43328
 RT 230,12,43840
 MV 84,200,164
 v_add_f32 v30, 1.0, v30
 v_add_f32 v31, 1.0, v31
 MV 92,204,164
 RT 200,11,47616
 RT 202,11,48128
 MV 88,204,160
 s_add_u32 m0, s68, 0
 v_rcp_f32 v28, v28
 v_rcp_f32 v29, v29
 MV 96,208,160
 RT 204,12,47616
 RT 206,12,48128
 MV 100,208,164
 buffer_load_dwordx4 v7, s[28:31], s76 offen lds
 v_rcp_f32 v30, v30
 ML 28,60,28
 MV 108,212,164
 WL 4
 RT 208,11,47680
 RT 210,11,48192
 MV 104,212,160
 v_rcp_f32 v31, v31
 ML 29,61,29
 MV 80,216,168
 RT 212,12,47680
 RT 214,12,48192
 MV 84,216,172
 ML 30,62,30
 ML 31,63,31
 CV 60,28,29
 MV 92,220,172
 v_lshrrev_b32 v40, 16, v38
 v_and_b32 v39, 63, v38
 v_min_u32 v39, 15, v39
 v_mad_u32_u24 v39, v40, 16, v39
 v_lshlrev_b32 v39, 7, v39
 v_add_u32 v39, 0, v39
 v_min_u32 v39, 0x1ff80, v39
 buffer_load_dword v47, v39, s[12:15], s40 offen
 s_waitcnt vmcnt(10)
 s_barrier
 RT 216,11,51968
 RT 218,11,52480
 MV 88,220,168
 s_mov_b32 s92, 0x100
 v_mad_u32_u24 v3, v41, s92, v2
 v_mov_b32 v4, v3
 v_add_u32 v3, 64, v3
 CV 62,30,31
 EX 16,64
 MV 96,224,168
 RT 220,12,51968
 RT 222,12,52480
 MV 100,224,172
 s_add_u32 m0, s69, 0x9900
 s_add_u32 s70, s77, 0
 EX 17,65
 v_add_f32 v16, 1.0, v16
 MV 108,228,172
 WL 4
 RT 224,11,56320
 RT 226,11,56832
 MV 104,228,168
 buffer_load_dwordx4 v8, s[12:15], s70 offen lds
 EX 18,66
 v_add_f32 v17, 1.0, v17
 MV 80,200,176
 RT 228,12,56320
 RT 230,12,56832
 MV 84,200,180
 EX 19,67
 v_add_f32 v18, 1.0, v18
 MV 92,204,180
 RT 200,11,60672
 RT 202,11,61184
 MV 88,204,176
 v_add_f32 v19, 1.0, v19
 v_rcp_f32 v16, v16
 MV 96,208,176
 RT 204,12,60672
 RT 206,12,61184
 MV 100,208,180
 s_add_u32 m0, m0, 64
 v_rcp_f32 v17, v17
 ML 16,64,16
 MV 108,212,180
 WL 4
 RT 208,11,65024
 RT 210,13,0
 MV 104,212,176
 buffer_load_dwordx4 v8, s[12:15], s70 offen offset:1024 lds
 v_rcp_f32 v18, v18
 ML 17,65,17
 MV 80,216,184
 RT 212,12,65024
 RT 214,14,0
 MV 84,216,188
 v_rcp_f32 v19, v19
 ML 18,66,18
 MV 92,220,188
 RT 216,13,3840
 RT 218,13,4352
 MV 88,220,184
 ML 19,67,19
 CV 64,16,17
 CV 66,18,19
 MV 80,224,192
 RT 220,14,3840
 RT 222,14,4352
 MV 84,224,196
 v_lshrrev_b32 v40, 16, v38
 v_and_b32 v39, 63, v38
 v_min_u32 v39, 15, v39
 v_mad_u32_u24 v39, v40, 16, v39
 v_lshlrev_b32 v39, 7, v39
 v_add_u32 v39, 0, v39
 v_min_u32 v39, 0x1ff80, v39
 EX 20,72
 MV 92,228,196
 WL 4
 RT 224,13,8192
 RT 226,13,8704
 MV 88,228,192
 buffer_load_dword v47, v39, s[16:19], s40 offen
 EX 21,73
 EX 22,74
 MV 80,200,200
 RT 228,14,8192
 RT 230,14,8704
 MV 84,200,204
 EX 23,75
 v_add_f32 v20, 1.0, v20
 MV 92,204,204
 RT 200,13,12544
 RT 202,13,13056
 MV 88,204,200
 v_add_f32 v21, 1.0, v21
 v_add_f32 v22, 1.0, v22
 v_add_f32 v23, 1.0, v23
 MV 80,208,208
 RT 204,14,12544
 RT 206,14,13056
 MV 84,208,212
 v_rcp_f32 v20, v20
 MV 92,212,212
 WL 4
 RT 208,13,16896
 RT 210,13,17408
 MV 88,212,208
 v_rcp_f32 v21, v21
 v_rcp_f32 v22, v22
 MV 80,216,216
 RT 212,14,16896
 RT 214,14,17408
 MV 84,216,220
 v_rcp_f32 v23, v23
 ML 20,72,20
 MV 92,220,220
 RT 216,13,21248
 RT 218,13,21760
 MV 88,220,216
 ML 21,73,21
 ML 22,74,22
 ML 23,75,23
 MV 80,224,224
 RT 220,14,21248
 RT 222,14,21760
 MV 84,224,228
 CV 72,20,21
 CV 74,22,23
 MV 92,228,228
 WL 4
 RT 224,11,52032
 RT 226,11,52544
 MV 88,228,224
 EX 24,68
 EX 25,69
 MV 80,200,232
 RT 228,12,52032
 RT 230,12,52544
 MV 84,200,236
 EX 26,70
 v_add_f32 v24, 1.0, v24
 MV 92,204,236
 RT 200,11,56384
 RT 202,11,56896
 MV 88,204,232
 EX 27,71
 v_add_f32 v25, 1.0, v25
 MV 80,208,240
 RT 204,12,56384
 RT 206,12,56896
 MV 84,208,244
 v_add_f32 v26, 1.0, v26
 v_add_f32 v27, 1.0, v27
 MV 92,212,244
 WL 4
 RT 208,11,60736
 RT 210,11,61248
 MV 88,212,240
 v_rcp_f32 v24, v24
 v_rcp_f32 v25, v25
 MV 80,216,248
 RT 212,12,60736
 RT 214,12,61248
 MV 84,216,252
 v_rcp_f32 v26, v26
 ML 24,68,24
 MV 92,220,252
 RT 216,11,65088
 RT 218,13,64
 MV 88,220,248
 v_rcp_f32 v27, v27
 ML 25,69,25
 MV 96,224,184
 RT 220,12,65088
 RT 222,14,64
 MV 100,224,188
 ML 26,70,26
 ML 27,71,27
 CV 68,24,25
 MV 108,228,188
 WL 4
 RT 224,13,3904
 RT 226,13,4416
 MV 104,228,184
 CV 70,26,27
 EX 28,76
 MV 96,200,192
 RT 228,14,3904
 RT 230,14,4416
 MV 100,200,196
 EX 29,77
 v_add_f32 v28, 1.0, v28
 MV 108,204,196
 RT 200,13,8256
 RT 202,13,8768
 MV 104,204,192
 EX 30,78
 v_add_f32 v29, 1.0, v29
 MV 96,208,200
 RT 204,14,8256
 RT 206,14,8768
 MV 100,208,204
 EX 31,79
 v_add_f32 v30, 1.0, v30
 MV 108,212,204
 WL 4
 RT 208,13,12608
 RT 210,13,13120
 MV 104,212,200
 v_add_f32 v31, 1.0, v31
 v_rcp_f32 v28, v28
 MV 96,216,208
 RT 212,14,12608
 RT 214,14,13120
 MV 100,216,212
 v_rcp_f32 v29, v29
 ML 28,76,28
 MV 108,220,212
 RT 216,13,16960
 RT 218,13,17472
 MV 104,220,208
 v_rcp_f32 v30, v30
 ML 29,77,29
 MV 96,224,216
 RT 220,14,16960
 RT 222,14,17472
 MV 100,224,220
 v_rcp_f32 v31, v31
 ML 30,78,30
 MV 108,228,220
 WL 4
 RT 224,13,21312
 RT 226,13,21824
 MV 104,228,216
 ML 31,79,31
 CV 76,28,29
 CV 78,30,31
 MV 96,200,224
 RT 228,14,21312
 RT 230,14,21824
 MV 100,200,228
 v_add_u32 v15, 0, v15
 v_add_u32 v37, 0, v37
 AW 32,48
 AW 33,50
 EX 16,80
 MV 108,204,228
 s_waitcnt vmcnt(4)
 s_barrier
 RT 200,15,0
 RT 202,15,256
 MV 104,204,224
 s_add_u32 m0, s69, 0x13200
 s_add_u32 s70, s77, 0x2000
 AW 34,56
 AW 35,58
 EX 17,81
 MV 96,208,232
 RT 204,37,0
 RT 206,37,256
 MV 100,208,236
 buffer_load_dwordx4 v8, s[12:15], s70 offen lds
 AW 36,52
 AW 37,54
 EX 18,82
 MV 108,212,236
 WL 4
 RT 208,15,2048
 RT 210,15,2304
 MV 104,212,232
 AW 38,60
 AW 39,62
 EX 19,83
 MV 96,216,240
 RT 212,37,2048
 RT 214,37,2304
 MV 100,216,244
 AW 40,64
 AW 41,66
 v_add_f32 v16, 1.0, v16
 v_add_f32 v17, 1.0, v17
 MV 108,220,244
 RT 216,15,4096
 RT 218,15,4352
 MV 104,220,240
 s_add_u32 m0, m0, 64
 AW 42,72
 AW 43,74
 v_add_f32 v18, 1.0, v18
 v_add_f32 v19, 1.0, v19
 MV 96,224,248
 RT 220,37,4096
 RT 222,37,4352
 MV 100,224,252
 buffer_load_dwordx4 v8, s[12:15], s70 offen offset:1024 lds
 AW 44,68
 AW 45,70
 v_rcp_f32 v16, v16
 MV 108,228,252
 WL 4
 RT 224,15,6144
 RT 226,15,6400
 MV 104,228,248
 AW 46,76
 AW 47,78
 v_rcp_f32 v17, v17
 v_mfma_f32_16x16x32_bf16 v[48:51], a[200:203], v[112:115], 0
 RT 228,37,6144
 RT 230,37,6400
 v_mfma_f32_16x16x32_bf16 v[52:55], a[200:203], v[116:119], 0
 v_rcp_f32 v18, v18
 v_rcp_f32 v19, v19
 v_mfma_f32_16x16x32_bf16 v[60:63], a[204:207], v[116:119], 0
 RT 200,15,8192
 RT 202,15,8448
 v_mfma_f32_16x16x32_bf16 v[56:59], a[204:207], v[112:115], 0
 s_add_u32 m0, s69, 0x15400
 s_add_u32 s70, s77, 0x4000
 ML 16,80,16
 ML 17,81,17
 ML 18,82,18
 ML 19,83,19
 MV 48,208,120
 RT 204,37,8192
 RT 206,37,8448
 MV 52,208,124
 buffer_load_dwordx4 v8, s[12:15], s70 offen lds
 CV 80,16,17
 CV 82,18,19
 EX 20,88
 MV 60,212,124
 WL 4
 RT 208,15,10240
 RT 210,15,10496
 MV 56,212,120
 EX 21,89
 EX 22,90
 MV 48,216,128
 RT 212,37,10240
 RT 214,37,10496
 MV 52,216,132
 EX 23,91
 v_add_f32 v20, 1.0, v20
 v_add_f32 v21, 1.0, v21
 MV 60,220,132
 RT 216,15,12288
 RT 218,15,12544
 MV 56,220,128
 s_add_u32 m0, m0, 64
 v_add_f32 v22, 1.0, v22
 v_add_f32 v23, 1.0, v23
 v_rcp_f32 v20, v20
 MV 48,224,136
 RT 220,37,12288
 RT 222,37,12544
 MV 52,224,140
 buffer_load_dwordx4 v8, s[12:15], s70 offen offset:1024 lds
 v_rcp_f32 v21, v21
 v_rcp_f32 v22, v22
 MV 60,228,140
 WL 4
 RT 224,15,14336
 RT 226,15,14592
 MV 56,228,136
 v_rcp_f32 v23, v23
 ML 20,88,20
 ML 21,89,21
 MV 48,200,144
 RT 228,37,14336
 RT 230,37,14592
 MV 52,200,148
 ML 22,90,22
 ML 23,91,23
 CV 88,20,21
 CV 90,22,23
 MV 60,204,148
 RT 200,15,16384
 RT 202,15,16640
 MV 56,204,144
 s_add_u32 m0, s69, 0x17600
 s_add_u32 s70, s80, 0
 EX 24,84
 EX 25,85
 MV 48,208,152
 RT 204,37,16384
 RT 206,37,16640
 MV 52,208,156
 buffer_load_dwordx4 v3, s[16:19], s70 offen lds
 EX 26,86
 EX 27,87
 MV 60,212,156
 WL 4
 RT 208,15,18432
 RT 210,15,18688
 MV 56,212,152
 v_add_f32 v24, 1.0, v24
 v_add_f32 v25, 1.0, v25
 v_add_f32 v26, 1.0, v26
 v_add_f32 v27, 1.0, v27
 MV 48,216,160
 RT 212,37,18432
 RT 214,37,18688
 MV 52,216,164
 v_rcp_f32 v24, v24
 v_rcp_f32 v25, v25
 MV 60,220,164
 RT 216,15,20480
 RT 218,15,20736
 MV 56,220,160
 buffer_load_dwordx4 v4, s[16:19], s70 offen offset:1088 lds
 v_rcp_f32 v26, v26
 v_rcp_f32 v27, v27
 MV 48,224,168
 RT 220,37,20480
 RT 222,37,20736
 MV 52,224,172
 ML 24,84,24
 ML 25,85,25
 ML 26,86,26
 ML 27,87,27
 MV 60,228,172
 WL 4
 RT 224,15,22528
 RT 226,15,22784
 MV 56,228,168
 CV 84,24,25
 CV 86,26,27
 EX 28,92
 MV 48,200,176
 RT 228,37,22528
 RT 230,37,22784
 MV 52,200,180
 s_add_u32 m0, s69, 0x19800
 s_add_u32 s70, s80, 0x80
 EX 29,93
 EX 30,94
 MV 60,204,180
 RT 200,15,24576
 RT 202,15,24832
 MV 56,204,176
 buffer_load_dwordx4 v3, s[16:19], s70 offen lds
 EX 31,95
 v_add_f32 v28, 1.0, v28
 v_add_f32 v29, 1.0, v29
 MV 48,208,184
 RT 204,37,24576
 RT 206,37,24832
 MV 52,208,188
 v_add_f32 v30, 1.0, v30
 v_add_f32 v31, 1.0, v31
 v_rcp_f32 v28, v28
 MV 60,212,188
 WL 4
 RT 208,15,26624
 RT 210,15,26880
 MV 56,212,184
 v_rcp_f32 v29, v29
 v_rcp_f32 v30, v30
 MV 48,216,192
 RT 212,37,26624
 RT 214,37,26880
 MV 52,216,196
 buffer_load_dwordx4 v4, s[16:19], s70 offen offset:1088 lds
 v_rcp_f32 v31, v31
 ML 28,92,28
 ML 29,93,29
 MV 60,220,196
 RT 216,15,28672
 RT 218,15,28928
 MV 56,220,192
 ML 30,94,30
 ML 31,95,31
 CV 92,28,29
 CV 94,30,31
 MV 48,224,200
 RT 220,37,28672
 RT 222,37,28928
 MV 52,224,204
 AW 48,80
 AW 49,82
 AW 50,88
 AW 51,90
 MV 60,228,204
 WL 4
 RT 224,15,30720
 RT 226,15,30976
 MV 56,228,200
 v_lshrrev_b32 v40, 16, v38
 v_and_b32 v39, 63, v38
 v_min_u32 v39, 35, v39
 v_mad_u32_u24 v39, v40, 36, v39
 v_lshlrev_b32 v39, 7, v39
 v_add_u32 v39, 0, v39
 v_min_u32 v39, 0x47f80, v39
 AW 52,84
 AW 53,86
 AW 54,92
 AW 55,94
 MV 48,200,208
 RT 228,37,30720
 RT 230,37,30976
 MV 52,200,212
 buffer_load_dword v47, v39, s[24:27], s42 offen
 EX 16,96
 EX 17,97
 MV 60,204,212
 RT 200,15,32768
 RT 202,15,33024
 MV 56,204,208
 EX 18,98
 EX 19,99
 MV 48,208,216
 RT 204,37,32768
 RT 206,37,33024
 MV 52,208,220
 v_add_f32 v16, 1.0, v16
 v_add_f32 v17, 1.0, v17
 v_add_f32 v18, 1.0, v18
 v_add_f32 v19, 1.0, v19
 MV 60,212,220
 WL 4
 RT 208,15,34816
 RT 210,15,35072
 MV 56,212,216
 s_getpc_b64 s[94:95]
L_cp5:
 s_add_u32 s94, s94, L_M_pa-L_cp5
 s_addc_u32 s95, s95, 0
 v_bfe_u32 v40, v38, 16, 5
 v_and_b32 v39, 63, v38
 v_min_u32 v39, 7, v39
 v_mad_u32_u24 v39, v40, 8, v39
 v_lshlrev_b32 v39, 7, v39
 v_min_u32 v39, L_M_p2-L_M_pa-4, v39
 v_rcp_f32 v16, v16
 v_rcp_f32 v17, v17
 MV 48,216,224
 RT 212,37,34816
 RT 214,37,35072
 MV 52,216,228
 global_load_dword v47, v39, s[94:95]
 v_add_u32 v45, 0x9900, v44
 v_xor_b32 v46, 32, v45
 v_add_u32 v35, 0x9900, v32
 v_rcp_f32 v18, v18
 v_rcp_f32 v19, v19
 MV 60,220,228
L_M_pa:
 s_waitcnt vmcnt(11)
 s_barrier
 RB 216,35,0
 MV 56,220,224
 s_mov_b32 s89, 0x1cb00
 s_mov_b32 s88, 0
 ML 16,96,16
 ML 17,97,17
 ML 18,98,18
 ML 19,99,19
 MV 48,224,232
 RB 220,35,4352
 CV 96,16,17
 MV 52,224,236
 s_mov_b32 s87, 0x9900
 s_add_u32 s59, s89, s69
 CV 98,18,19
 EX 20,104
 MV 60,228,236
 WL 2
 RB 224,35,64
 v_add_f32 v20, 1.0, v20
 MV 56,228,232
 s_add_u32 s77, s77, 0x4000
 s_add_u32 s80, s80, 0x4000
 EX 21,105
 MV 48,200,240
 RB 228,35,4416
 v_add_f32 v21, 1.0, v21
 MV 52,200,244
 s_add_u32 m0, s59, 0
 s_add_u32 s70, s77, 0x2000
 EX 22,106
 EX 23,107
 MV 60,204,244
 RB 200,35,128
 v_add_f32 v22, 1.0, v22
 MV 56,204,240
 buffer_load_dwordx4 v8, s[12:15], s70 offen lds
 v_add_f32 v23, 1.0, v23
 v_rcp_f32 v20, v20
 MV 48,208,248
 RB 204,35,4480
 ML 20,104,20
 MV 52,208,252
 v_rcp_f32 v21, v21
 MV 60,212,252
 WL 2
 RB 208,35,192
 ML 21,105,21
 MV 56,212,248
 v_rcp_f32 v22, v22
 v_rcp_f32 v23, v23
 ML 22,106,22
 ML 23,107,23
 CV 104,20,21
 CV 106,22,23
 EX 24,100
 EX 25,101
 EX 26,102
 EX 27,103
 v_add_f32 v24, 1.0, v24
 v_add_f32 v25, 1.0, v25
 v_add_f32 v26, 1.0, v26
 v_add_f32 v27, 1.0, v27
 v_rcp_f32 v24, v24
 v_rcp_f32 v25, v25
 v_rcp_f32 v26, v26
 v_rcp_f32 v27, v27
 ML 24,100,24
 ML 25,101,25
 ML 26,102,26
 ML 27,103,27
 CV 100,24,25
 CV 102,26,27
 EX 28,108
 EX 29,109
 EX 30,110
 EX 31,111
 v_add_f32 v28, 1.0, v28
 v_add_f32 v29, 1.0, v29
 v_add_f32 v30, 1.0, v30
 v_add_f32 v31, 1.0, v31
 v_rcp_f32 v28, v28
 v_rcp_f32 v29, v29
 v_rcp_f32 v30, v30
 v_rcp_f32 v31, v31
 ML 28,108,28
 ML 29,109,29
 ML 30,110,30
 ML 31,111,31
 CV 108,28,29
 CV 110,30,31
 AW 56,96
 AW 57,98
 AW 58,104
 AW 59,106
 AW 60,100
 AW 61,102
 AW 62,108
 AW 63,110
 EX 16,48
 EX 17,49
 EX 18,50
 EX 19,51
 v_add_f32 v16, 1.0, v16
 v_add_f32 v17, 1.0, v17
 v_add_f32 v18, 1.0, v18
 v_add_f32 v19, 1.0, v19
 v_rcp_f32 v16, v16
 v_rcp_f32 v17, v17
 v_rcp_f32 v18, v18
 v_rcp_f32 v19, v19
 ML 16,48,16
 ML 17,49,17
 ML 18,50,18
 ML 19,51,19
 CV 48,16,17
 CV 50,18,19
 EX 20,56
 EX 21,57
 EX 22,58
 EX 23,59
 v_add_f32 v20, 1.0, v20
 v_add_f32 v21, 1.0, v21
 v_add_f32 v22, 1.0, v22
 v_add_f32 v23, 1.0, v23
 v_rcp_f32 v20, v20
 v_rcp_f32 v21, v21
 v_rcp_f32 v22, v22
 v_rcp_f32 v23, v23
 ML 20,56,20
 ML 21,57,21
 ML 22,58,22
 ML 23,59,23
 CV 56,20,21
 CV 58,22,23
 EX 24,52
 EX 25,53
 EX 26,54
 EX 27,55
 v_add_f32 v24, 1.0, v24
 v_add_f32 v25, 1.0, v25
 v_add_f32 v26, 1.0, v26
 v_add_f32 v27, 1.0, v27
 v_rcp_f32 v24, v24
 v_rcp_f32 v25, v25
 v_rcp_f32 v26, v26
 v_rcp_f32 v27, v27
 ML 24,52,24
 ML 25,53,25
 ML 26,54,26
 ML 27,55,27
 CV 52,24,25
 CV 54,26,27
 EX 28,60
 EX 29,61
 EX 30,62
 EX 31,63
 v_add_f32 v28, 1.0, v28
 v_add_f32 v29, 1.0, v29
 v_add_f32 v30, 1.0, v30
 v_add_f32 v31, 1.0, v31
 v_rcp_f32 v28, v28
 v_rcp_f32 v29, v29
 v_rcp_f32 v30, v30
 v_rcp_f32 v31, v31
 ML 28,60,28
 ML 29,61,29
 ML 30,62,30
 ML 31,63,31
 CV 60,28,29
 CV 62,30,31
 AW 64,48
 AW 65,50
 AW 66,56
 AW 67,58
 AW 68,52
 AW 69,54
 AW 70,60
 AW 71,62
 v_mfma_f32_16x16x32_bf16 v[112:115], a[216:219], a[136:139], 0
 RB 212,35,4544
 v_mfma_f32_16x16x32_bf16 v[116:119], a[216:219], a[140:143], 0
 s_add_u32 m0, m0, 64
 s_nop 0
 buffer_load_dwordx4 v8, s[12:15], s70 offen offset:1024 lds
 s_add_u32 s4, s87, 0x9900
 s_cmp_lt_u32 s4, 0x26400
 s_cselect_b32 s4, s4, 0
 s_add_u32 m0, s59, 0x2200
 s_add_u32 s70, s77, 0x4000
 buffer_load_dwordx4 v8, s[12:15], s70 offen lds
 s_add_u32 m0, m0, 64
 s_nop 0
 buffer_load_dwordx4 v8, s[12:15], s70 offen offset:1024 lds
 s_add_u32 m0, s59, 0x4400
 s_add_u32 s70, s80, 0
 buffer_load_dwordx4 v3, s[16:19], s70 offen lds
 buffer_load_dwordx4 v4, s[16:19], s70 offen offset:1088 lds
 s_add_u32 m0, s59, 0x6600
 s_add_u32 s70, s80, 0x80
 buffer_load_dwordx4 v3, s[16:19], s70 offen lds
 buffer_load_dwordx4 v4, s[16:19], s70 offen offset:1088 lds
 v_lshrrev_b32 v40, 16, v38
 v_and_b32 v39, 63, v38
 v_min_u32 v39, 35, v39
 v_mad_u32_u24 v39, v40, 36, v39
 v_lshlrev_b32 v39, 7, v39
 v_add_u32 v39, 0, v39
 v_min_u32 v39, 0x47f80, v39
 buffer_load_dword v47, v39, s[32:35], s46 offen
 v_lshrrev_b32 v40, 16, v38
 v_and_b32 v39, 63, v38
 v_min_u32 v39, 7, v39
 v_mad_u32_u24 v39, v40, 8, v39
 v_lshlrev_b32 v39, 7, v39
 v_add_u32 v39, 0, v39
 v_min_u32 v39, 0x8f80, v39
 buffer_load_dword v47, v39, s[32:35], s47 offen
 v_add_u32 v45, s4, v44
 v_xor_b32 v46, 32, v45
 v_add_u32 v35, s4, v32
 v_mfma_f32_16x16x32_bf16 v[68:71], a[216:219], a[172:175], 0
 s_nop 0
 v_mfma_f32_16x16x32_bf16 v[64:67], a[216:219], a[168:171], 0
 s_nop 0
 v_mfma_f32_16x16x32_bf16 v[124:127], a[220:223], a[140:143], 0
 s_waitcnt vmcnt(12)
 s_barrier
 RB 216,35,0
 v_mfma_f32_16x16x32_bf16 v[120:123], a[220:223], a[136:139], 0
 s_mov_b32 s89, s88
 s_mov_b32 s88, s87
 v_mfma_f32_16x16x32_bf16 v[72:75], a[220:223], a[168:171], 0
 s_nop 0
 v_mfma_f32_16x16x32_bf16 v[76:79], a[220:223], a[172:175], 0
 s_nop 0
 MA 112,224,144
 RB 220,35,4352
 MA 116,224,148
 s_mov_b32 s87, s4
 s_add_u32 s59, s89, s69
 MA 68,224,180
 s_nop 0
 MA 64,224,176
 s_nop 0
 MA 124,228,148
 WL 2
 RB 224,35,64
 MA 120,228,144
 s_add_u32 s77, s77, 0x4000
 s_add_u32 s80, s80, 0x4000
 MA 72,228,176
 s_nop 0
 MA 76,228,180
 s_nop 0
 MA 112,200,152
 RB 228,35,4416
 MA 116,200,156
 s_add_u32 m0, s59, 0
 s_add_u32 s70, s77, 0x2000
 MA 68,200,188
 s_nop 0
 MA 64,200,184
 s_nop 0
 MA 124,204,156
 RB 200,35,128
 MA 120,204,152
 buffer_load_dwordx4 v8, s[12:15], s70 offen lds
 MA 72,204,184
 s_nop 0
 MA 76,204,188
 s_nop 0
 MA 112,208,160
 RB 204,35,4480
 MA 116,208,164
 s_nop 0
 MA 68,208,196
 s_nop 0
 MA 64,208,192
 s_nop 0
 MA 124,212,164
 WL 2
 RB 208,35,192
 MA 120,212,160
 s_nop 0
 MA 72,212,192
 s_nop 0
 MA 76,212,196
 s_nop 0
 v_mfma_f32_16x16x32_bf16 v[128:131], a[216:219], a[136:139], 0
 RB 212,35,4544
 v_mfma_f32_16x16x32_bf16 v[132:135], a[216:219], a[140:143], 0
 s_add_u32 m0, m0, 64
 EX 112,112
 EX 113,113
 v_mfma_f32_16x16x32_bf16 v[52:55], a[216:219], a[172:175], 0
 EX 114,114
 CV 144,112,113
 v_mfma_f32_16x16x32_bf16 v[48:51], a[216:219], a[168:171], 0
 EX 115,115
 s_nop 0
 CV 145,114,115
 v_mfma_f32_16x16x32_bf16 v[140:143], a[220:223], a[140:143], 0
 RT 216,45,17408
 RT 218,45,17920
 v_mfma_f32_16x16x32_bf16 v[136:139], a[220:223], a[136:139], 0
 buffer_load_dwordx4 v8, s[12:15], s70 offen offset:1024 lds
 EX 120,120
 EX 121,121
 v_mfma_f32_16x16x32_bf16 v[56:59], a[220:223], a[168:171], 0
 EX 122,122
 CV 146,120,121
 v_mfma_f32_16x16x32_bf16 v[60:63], a[220:223], a[172:175], 0
 EX 123,123
 s_nop 0
 CV 147,122,123
 MA 128,224,144
 RT 220,46,17408
 RT 222,46,17920
 MA 132,224,148
 EX 116,116
 EX 117,117
 MA 52,224,180
 EX 118,118
 CV 148,116,117
 MA 48,224,176
 EX 119,119
 s_nop 0
 CV 149,118,119
 MA 140,228,148
 WL 4
 RT 224,45,17472
 RT 226,45,17984
 MA 136,228,144
 EX 124,124
 EX 125,125
 MA 56,228,176
 EX 126,126
 CV 150,124,125
 MA 60,228,180
 EX 127,127
 s_nop 0
 CV 151,126,127
 MA 128,200,152
 RT 228,46,17472
 RT 230,46,17984
 MA 132,200,156
 s_add_u32 s4, s87, 0x9900
 s_cmp_lt_u32 s4, 0x26400
 s_cselect_b32 s4, s4, 0
 EX 64,64
 EX 65,65
 MA 52,200,188
 EX 66,66
 CV 80,64,65
 MA 48,200,184
 EX 67,67
 s_nop 0
 CV 81,66,67
 MA 140,204,156
 RT 200,45,26112
 RT 202,45,26624
 MA 136,204,152
 s_add_u32 m0, s59, 0x2200
 s_add_u32 s70, s77, 0x4000
 EX 72,72
 EX 73,73
 MA 56,204,184
 EX 74,74
 CV 82,72,73
 MA 60,204,188
 EX 75,75
 s_nop 0
 CV 83,74,75
 MA 128,208,160
 RT 204,46,26112
 RT 206,46,26624
 MA 132,208,164
 buffer_load_dwordx4 v8, s[12:15], s70 offen lds
 EX 68,68
 EX 69,69
 MA 52,208,196
 EX 70,70
 CV 84,68,69
 MA 48,208,192
 EX 71,71
 s_nop 0
 CV 85,70,71
 MA 140,212,164
 WL 4
 RT 208,45,26176
 RT 210,45,26688
 MA 136,212,160
 EX 76,76
 EX 77,77
 MA 56,212,192
 EX 78,78
 CV 86,76,77
 MA 60,212,196
 EX 79,79
 s_nop 0
 CV 87,78,79
 v_mov_b32 v24, 0x3f803f80
 v_mov_b32 v25, 0x3f803f80
 v_mov_b32 v26, 0x3f803f80
 v_mov_b32 v27, 0x3f803f80
 v_mfma_f32_16x16x32_bf16 a[72:75], a[216:219], v[144:147], 0
 RT 212,46,26176
 RT 214,46,26688
 v_mfma_f32_16x16x32_bf16 a[76:79], a[216:219], v[148:151], 0
 EX 128,128
 v_mfma_f32_16x16x32_bf16 v[164:167], a[216:219], v[84:87], 0
 EX 129,129
 v_mfma_f32_16x16x32_bf16 v[160:163], a[216:219], v[80:83], 0
 EX 130,130
 v_mfma_f32_16x16x32_bf16 a[84:87], a[220:223], v[148:151], 0
 RB 216,35,8704
 CV 152,128,129
 v_mfma_f32_16x16x32_bf16 a[80:83], a[220:223], v[144:147], 0
 s_add_u32 m0, m0, 64
 v_mfma_f32_16x16x32_bf16 v[168:171], a[220:223], v[80:83], 0
 EX 131,131
 v_mfma_f32_16x16x32_bf16 v[172:175], a[220:223], v[84:87], 0
 CV 153,130,131
 v_mfma_f32_16x16x32_bf16 v[230:233], v[24:27], v[144:147], 0
 EX 136,136
 v_mfma_f32_16x16x32_bf16 a[88:91], a[224:227], v[144:147], 0
 RB 220,35,13056
 v_mfma_f32_16x16x32_bf16 a[92:95], a[224:227], v[148:151], 0
 buffer_load_dwordx4 v8, s[12:15], s70 offen offset:1024 lds
 v_mfma_f32_16x16x32_bf16 v[180:183], a[224:227], v[84:87], 0
 EX 137,137
 v_mfma_f32_16x16x32_bf16 v[176:179], a[224:227], v[80:83], 0
 EX 138,138
 v_mfma_f32_16x16x32_bf16 a[100:103], a[228:231], v[148:151], 0
 WL 2
 RB 224,35,8768
 CV 154,136,137
 v_mfma_f32_16x16x32_bf16 a[96:99], a[228:231], v[144:147], 0
 EX 139,139
 v_mfma_f32_16x16x32_bf16 v[184:187], a[228:231], v[80:83], 0
 CV 155,138,139
 v_mfma_f32_16x16x32_bf16 v[188:191], a[228:231], v[84:87], 0
 EX 132,132
 v_mfma_f32_16x16x32_bf16 v[234:237], v[24:27], v[148:151], 0
 EX 133,133
 v_mfma_f32_16x16x32_bf16 a[104:107], a[200:203], v[144:147], 0
 RB 228,35,13120
 CV 156,132,133
 v_mfma_f32_16x16x32_bf16 a[108:111], a[200:203], v[148:151], 0
 EX 134,134
 v_mfma_f32_16x16x32_bf16 v[196:199], a[200:203], v[84:87], 0
 EX 135,135
 v_mfma_f32_16x16x32_bf16 v[192:195], a[200:203], v[80:83], 0
 CV 157,134,135
 v_mfma_f32_16x16x32_bf16 a[116:119], a[204:207], v[148:151], 0
 RB 200,35,8832
 v_mfma_f32_16x16x32_bf16 a[112:115], a[204:207], v[144:147], 0
 s_add_u32 m0, s59, 0x4400
 s_add_u32 s70, s80, 0
 v_mfma_f32_16x16x32_bf16 v[200:203], a[204:207], v[80:83], 0
 EX 140,140
 v_mfma_f32_16x16x32_bf16 v[204:207], a[204:207], v[84:87], 0
 EX 141,141
 v_mfma_f32_16x16x32_bf16 v[96:99], v[24:27], v[80:83], 0
 EX 142,142
 v_mfma_f32_16x16x32_bf16 a[120:123], a[208:211], v[144:147], 0
 RB 204,35,13184
 CV 158,140,141
 v_mfma_f32_16x16x32_bf16 a[124:127], a[208:211], v[148:151], 0
 buffer_load_dwordx4 v3, s[16:19], s70 offen lds
 v_mfma_f32_16x16x32_bf16 v[212:215], a[208:211], v[84:87], 0
 EX 143,143
 v_mfma_f32_16x16x32_bf16 v[208:211], a[208:211], v[80:83], 0
 CV 159,142,143
 v_mfma_f32_16x16x32_bf16 a[132:135], a[212:215], v[148:151], 0
 WL 2
 RB 208,35,8896
 v_mfma_f32_16x16x32_bf16 a[128:131], a[212:215], v[144:147], 0
 EX 48,48
 v_mfma_f32_16x16x32_bf16 v[216:219], a[212:215], v[80:83], 0
 EX 49,49
 v_mfma_f32_16x16x32_bf16 v[220:223], a[212:215], v[84:87], 0
 EX 50,50
 v_mfma_f32_16x16x32_bf16 v[100:103], v[24:27], v[84:87], 0
 EX 51,51
 v_mfma_f32_16x16x32_bf16 v[112:115], a[216:219], a[136:139], 0
 RB 212,35,13248
 CV 88,48,49
 v_mfma_f32_16x16x32_bf16 v[116:119], a[216:219], a[140:143], 0
 CV 89,50,51
 v_mfma_f32_16x16x32_bf16 v[68:71], a[216:219], a[172:175], 0
 EX 56,56
 v_mfma_f32_16x16x32_bf16 v[64:67], a[216:219], a[168:171], 0
 EX 57,57
 v_mfma_f32_16x16x32_bf16 v[124:127], a[220:223], a[140:143], 0
 RT 216,45,21760
 RT 218,45,22272
 v_mfma_f32_16x16x32_bf16 v[120:123], a[220:223], a[136:139], 0
 buffer_load_dwordx4 v4, s[16:19], s70 offen offset:1088 lds
 v_mfma_f32_16x16x32_bf16 v[72:75], a[220:223], a[168:171], 0
 EX 58,58
 v_mfma_f32_16x16x32_bf16 v[76:79], a[220:223], a[172:175], 0
 EX 59,59
 MA 112,224,144
 RT 220,46,21760
 RT 222,46,22272
 MA 116,224,148
 CV 90,56,57
 CV 91,58,59
 MA 68,224,180
 EX 52,52
 MA 64,224,176
 EX 53,53
 MA 124,228,148
 WL 4
 RT 224,45,21824
 RT 226,45,22336
 MA 120,228,144
 EX 54,54
 MA 72,228,176
 EX 55,55
 MA 76,228,180
 CV 92,52,53
 CV 93,54,55
 MA 112,200,152
 RT 228,46,21824
 RT 230,46,22336
 MA 116,200,156
 s_add_u32 m0, s59, 0x6600
 s_add_u32 s70, s80, 0x80
 MA 68,200,188
 EX 60,60
 MA 64,200,184
 EX 61,61
 MA 124,204,156
 RT 200,45,30464
 RT 202,45,30976
 MA 120,204,152
 buffer_load_dwordx4 v3, s[16:19], s70 offen lds
 MA 72,204,184
 EX 62,62
 MA 76,204,188
 EX 63,63
 MA 112,208,160
 RT 204,46,30464
 RT 206,46,30976
 MA 116,208,164
 CV 94,60,61
 CV 95,62,63
 MA 68,208,196
 s_nop 0
 MA 64,208,192
 s_nop 0
 MA 124,212,164
 WL 4
 RT 208,45,30528
 RT 210,45,31040
 MA 120,212,160
 s_nop 0
 MA 72,212,192
 s_nop 0
 MA 76,212,196
 s_nop 0
 MC 72,216,152
 RT 212,46,30528
 RT 214,46,31040
 MC 76,216,156
 buffer_load_dwordx4 v4, s[16:19], s70 offen offset:1088 lds
 v_add_u32 v45, s4, v44
 v_xor_b32 v46, 32, v45
 v_add_u32 v35, s4, v32
 MV 164,216,92
 EX 112,112
 MV 160,216,88
 EX 113,113
 MC 84,220,156
 s_waitcnt vmcnt(10)
 s_barrier
 RB 216,35,0
 MC 80,220,152
 s_mov_b32 s89, s88
 s_mov_b32 s88, s87
 EX 114,114
 MV 168,220,88
 EX 115,115
 MV 172,220,92
 CV 144,112,113
 CV 145,114,115
 v_mfma_f32_16x16x32_bf16 v[230:233], v[24:27], v[152:155], v[230:233]
 EX 120,120
 MC 88,224,152
 RB 220,35,4352
 MC 92,224,156
 s_mov_b32 s87, s4
 s_add_u32 s59, s89, s69
 MV 180,224,92
 EX 121,121
 MV 176,224,88
 EX 122,122
 MC 100,228,156
 WL 2
 RB 224,35,64
 CV 146,120,121
 MC 96,228,152
 s_add_u32 s77, s77, 0x4000
 s_add_u32 s80, s80, 0x4000
 MV 184,228,88
 EX 123,123
 MV 188,228,92
 CV 147,122,123
 v_mfma_f32_16x16x32_bf16 v[234:237], v[24:27], v[156:159], v[234:237]
 EX 116,116
 MC 104,200,152
 RB 228,35,4416
 MC 108,200,156
 s_add_u32 m0, s59, 0
 s_add_u32 s70, s77, 0x2000
 MV 196,200,92
 EX 117,117
 MV 192,200,88
 EX 118,118
 MC 116,204,156
 RB 200,35,128
 CV 148,116,117
 MC 112,204,152
 buffer_load_dwordx4 v8, s[12:15], s70 offen lds
 MV 200,204,88
 EX 119,119
 MV 204,204,92
 CV 149,118,119
 v_mfma_f32_16x16x32_bf16 v[96:99], v[24:27], v[88:91], v[96:99]
 EX 124,124
 MC 120,208,152
 RB 204,35,4480
 MC 124,208,156
 EX 125,125
 MV 212,208,92
 EX 126,126
 MV 208,208,88
 EX 127,127
 MC 132,212,156
 WL 2
 RB 208,35,192
 CV 150,124,125
 MC 128,212,152
 CV 151,126,127
 MV 216,212,88
 EX 64,64
 MV 220,212,92
 EX 65,65
 v_mfma_f32_16x16x32_bf16 v[100:103], v[24:27], v[92:95], v[100:103]
 EX 66,66
 v_mfma_f32_16x16x32_bf16 v[128:131], a[216:219], a[136:139], 0
 RB 212,35,4544
 CV 80,64,65
 v_mfma_f32_16x16x32_bf16 v[132:135], a[216:219], a[140:143], 0
 s_add_u32 m0, m0, 64
 v_mfma_f32_16x16x32_bf16 v[52:55], a[216:219], a[172:175], 0
 EX 67,67
 v_mfma_f32_16x16x32_bf16 v[48:51], a[216:219], a[168:171], 0
 CV 81,66,67
 v_mfma_f32_16x16x32_bf16 v[140:143], a[220:223], a[140:143], 0
 RT 216,45,17408
 RT 218,45,17920
 v_mfma_f32_16x16x32_bf16 v[136:139], a[220:223], a[136:139], 0
 buffer_load_dwordx4 v8, s[12:15], s70 offen offset:1024 lds
 v_mfma_f32_16x16x32_bf16 v[56:59], a[220:223], a[168:171], 0
 EX 72,72
 v_mfma_f32_16x16x32_bf16 v[60:63], a[220:223], a[172:175], 0
 EX 73,73
 MA 128,224,144
 RT 220,46,17408
 RT 222,46,17920
 MA 132,224,148
 EX 74,74
 MA 52,224,180
 EX 75,75
 MA 48,224,176
 CV 82,72,73
 CV 83,74,75
 MA 140,228,148
 WL 4
 RT 224,45,17472
 RT 226,45,17984
 MA 136,228,144
 EX 68,68
 MA 56,228,176
 EX 69,69
 MA 60,228,180
 EX 70,70
 MA 128,200,152
 RT 228,46,17472
 RT 230,46,17984
 MA 132,200,156
 s_add_u32 s4, s87, 0x9900
 s_cmp_lt_u32 s4, 0x26400
 s_cselect_b32 s4, s4, 0
 MA 52,200,188
 EX 71,71
 MA 48,200,184
 CV 84,68,69
 CV 85,70,71
 MA 140,204,156
 RT 200,45,26112
 RT 202,45,26624
 MA 136,204,152
 s_add_u32 m0, s59, 0x2200
 s_add_u32 s70, s77, 0x4000
 MA 56,204,184
 EX 76,76
 MA 60,204,188
 EX 77,77
 MA 128,208,160
 RT 204,46,26112
 RT 206,46,26624
 MA 132,208,164
 buffer_load_dwordx4 v8, s[12:15], s70 offen lds
 MA 52,208,196
 EX 78,78
 MA 48,208,192
 EX 79,79
 MA 140,212,164
 WL 4
 RT 208,45,26176
 RT 210,45,26688
 MA 136,212,160
 CV 86,76,77
 CV 87,78,79
 MA 56,212,192
 s_nop 0
 MA 60,212,196
 s_nop 0
 MC 72,216,144
 RT 212,46,26176
 RT 214,46,26688
 MC 76,216,148
 EX 128,128
 MV 164,216,84
 EX 129,129
 MV 160,216,80
 EX 130,130
 MC 84,220,148
 RB 216,35,8704
 CV 152,128,129
 MC 80,220,144
 s_add_u32 m0, m0, 64
 MV 168,220,80
 EX 131,131
 MV 172,220,84
 CV 153,130,131
 v_mfma_f32_16x16x32_bf16 v[230:233], v[24:27], v[144:147], v[230:233]
 EX 136,136
 MC 88,224,144
 RB 220,35,13056
 MC 92,224,148
 buffer_load_dwordx4 v8, s[12:15], s70 offen offset:1024 lds
 MV 180,224,84
 EX 137,137
 MV 176,224,80
 EX 138,138
 MC 100,228,148
 WL 2
 RB 224,35,8768
 CV 154,136,137
 MC 96,228,144
 EX 139,139
 MV 184,228,80
 CV 155,138,139
 MV 188,228,84
 EX 132,132
 v_mfma_f32_16x16x32_bf16 v[234:237], v[24:27], v[148:151], v[234:237]
 EX 133,133
 MC 104,200,144
 RB 228,35,13120
 CV 156,132,133
 MC 108,200,148
 EX 134,134
 MV 196,200,84
 EX 135,135
 MV 192,200,80
 CV 157,134,135
 MC 116,204,148
 RB 200,35,8832
 MC 112,204,144
 s_add_u32 m0, s59, 0x4400
 s_add_u32 s70, s80, 0
 MV 200,204,80
 EX 140,140
 MV 204,204,84
 EX 141,141
 v_mfma_f32_16x16x32_bf16 v[96:99], v[24:27], v[80:83], v[96:99]
 EX 142,142
 MC 120,208,144
 RB 204,35,13184
 CV 158,140,141
 MC 124,208,148
 buffer_load_dwordx4 v3, s[16:19], s70 offen lds
 MV 212,208,84
 EX 143,143
 MV 208,208,80
 CV 159,142,143
 MC 132,212,148
 WL 2
 RB 208,35,8896
 MC 128,212,144
 EX 48,48
 MV 216,212,80
 EX 49,49
 MV 220,212,84
 EX 50,50
 v_mfma_f32_16x16x32_bf16 v[100:103], v[24:27], v[84:87], v[100:103]
 EX 51,51
 v_mfma_f32_16x16x32_bf16 v[112:115], a[216:219], a[136:139], 0
 RB 212,35,13248
 CV 88,48,49
 v_mfma_f32_16x16x32_bf16 v[116:119], a[216:219], a[140:143], 0
 CV 89,50,51
 v_mfma_f32_16x16x32_bf16 v[68:71], a[216:219], a[172:175], 0
 EX 56,56
 v_mfma_f32_16x16x32_bf16 v[64:67], a[216:219], a[168:171], 0
 EX 57,57
 v_mfma_f32_16x16x32_bf16 v[124:127], a[220:223], a[140:143], 0
 RT 216,45,21760
 RT 218,45,22272
 v_mfma_f32_16x16x32_bf16 v[120:123], a[220:223], a[136:139], 0
 buffer_load_dwordx4 v4, s[16:19], s70 offen offset:1088 lds
 v_mfma_f32_16x16x32_bf16 v[72:75], a[220:223], a[168:171], 0
 EX 58,58
 v_mfma_f32_16x16x32_bf16 v[76:79], a[220:223], a[172:175], 0
 EX 59,59
 MA 112,224,144
 RT 220,46,21760
 RT 222,46,22272
 MA 116,224,148
 CV 90,56,57
 CV 91,58,59
 MA 68,224,180
 EX 52,52
 MA 64,224,176
 EX 53,53
 MA 124,228,148
 WL 4
 RT 224,45,21824
 RT 226,45,22336
 MA 120,228,144
 EX 54,54
 MA 72,228,176
 EX 55,55
 MA 76,228,180
 CV 92,52,53
 CV 93,54,55
 MA 112,200,152
 RT 228,46,21824
 RT 230,46,22336
 MA 116,200,156
 s_add_u32 m0, s59, 0x6600
 s_add_u32 s70, s80, 0x80
 MA 68,200,188
 EX 60,60
 MA 64,200,184
 EX 61,61
 MA 124,204,156
 RT 200,45,30464
 RT 202,45,30976
 MA 120,204,152
 buffer_load_dwordx4 v3, s[16:19], s70 offen lds
 MA 72,204,184
 EX 62,62
 MA 76,204,188
 EX 63,63
 MA 112,208,160
 RT 204,46,30464
 RT 206,46,30976
 MA 116,208,164
 CV 94,60,61
 CV 95,62,63
 MA 68,208,196
 s_nop 0
 MA 64,208,192
 s_nop 0
 MA 124,212,164
 WL 4
 RT 208,45,30528
 RT 210,45,31040
 MA 120,212,160
 s_nop 0
 MA 72,212,192
 s_nop 0
 MA 76,212,196
 s_nop 0
 MC 72,216,152
 RT 212,46,30528
 RT 214,46,31040
 MC 76,216,156
 buffer_load_dwordx4 v4, s[16:19], s70 offen offset:1088 lds
 v_add_u32 v45, s4, v44
 v_xor_b32 v46, 32, v45
 v_add_u32 v35, s4, v32
 MV 164,216,92
 EX 112,112
 MV 160,216,88
 EX 113,113
 MC 84,220,156
 s_mov_b32 s91, 3
.p2align 3
L_M_loop0:
 s_waitcnt vmcnt(8)
 s_barrier
 RB 216,35,0
 MC 80,220,152
 s_mov_b32 s89, s88
 s_mov_b32 s88, s87
 EX 114,114
 MV 168,220,88
 EX 115,115
 MV 172,220,92
 CV 144,112,113
 CV 145,114,115
 v_mfma_f32_16x16x32_bf16 v[230:233], v[24:27], v[152:155], v[230:233]
 EX 120,120
 MC 88,224,152
 RB 220,35,4352
 MC 92,224,156
 s_mov_b32 s87, s4
 s_add_u32 s59, s89, s69
 MV 180,224,92
 EX 121,121
 MV 176,224,88
 EX 122,122
 MC 100,228,156
 WL 2
 RB 224,35,64
 CV 146,120,121
 MC 96,228,152
 s_add_u32 s77, s77, 0x4000
 s_add_u32 s80, s80, 0x4000
 MV 184,228,88
 EX 123,123
 MV 188,228,92
 CV 147,122,123
 v_mfma_f32_16x16x32_bf16 v[234:237], v[24:27], v[156:159], v[234:237]
 EX 116,116
 MC 104,200,152
 RB 228,35,4416
 MC 108,200,156
 s_add_u32 m0, s59, 0
 s_add_u32 s70, s77, 0x2000
 MV 196,200,92
 EX 117,117
 MV 192,200,88
 EX 118,118
 MC 116,204,156
 RB 200,35,128
 CV 148,116,117
 MC 112,204,152
 buffer_load_dwordx4 v8, s[12:15], s70 offen lds
 MV 200,204,88
 EX 119,119
 MV 204,204,92
 CV 149,118,119
 v_mfma_f32_16x16x32_bf16 v[96:99], v[24:27], v[88:91], v[96:99]
 EX 124,124
 MC 120,208,152
 RB 204,35,4480
 MC 124,208,156
 EX 125,125
 MV 212,208,92
 EX 126,126
 MV 208,208,88
 EX 127,127
 MC 132,212,156
 WL 2
 RB 208,35,192
 CV 150,124,125
 MC 128,212,152
 CV 151,126,127
 MV 216,212,88
 EX 64,64
 MV 220,212,92
 EX 65,65
 v_mfma_f32_16x16x32_bf16 v[100:103], v[24:27], v[92:95], v[100:103]
 EX 66,66
 v_mfma_f32_16x16x32_bf16 v[128:131], a[216:219], a[136:139], 0
 RB 212,35,4544
 CV 80,64,65
 v_mfma_f32_16x16x32_bf16 v[132:135], a[216:219], a[140:143], 0
 s_add_u32 m0, m0, 64
 v_mfma_f32_16x16x32_bf16 v[52:55], a[216:219], a[172:175], 0
 EX 67,67
 v_mfma_f32_16x16x32_bf16 v[48:51], a[216:219], a[168:171], 0
 CV 81,66,67
 v_mfma_f32_16x16x32_bf16 v[140:143], a[220:223], a[140:143], 0
 RT 216,45,17408
 RT 218,45,17920
 v_mfma_f32_16x16x32_bf16 v[136:139], a[220:223], a[136:139], 0
 buffer_load_dwordx4 v8, s[12:15], s70 offen offset:1024 lds
 v_mfma_f32_16x16x32_bf16 v[56:59], a[220:223], a[168:171], 0
 EX 72,72
 v_mfma_f32_16x16x32_bf16 v[60:63], a[220:223], a[172:175], 0
 EX 73,73
 MA 128,224,144
 RT 220,46,17408
 RT 222,46,17920
 MA 132,224,148
 EX 74,74
 MA 52,224,180
 EX 75,75
 MA 48,224,176
 CV 82,72,73
 CV 83,74,75
 MA 140,228,148
 WL 4
 RT 224,45,17472
 RT 226,45,17984
 MA 136,228,144
 EX 68,68
 MA 56,228,176
 EX 69,69
 MA 60,228,180
 EX 70,70
 MA 128,200,152
 RT 228,46,17472
 RT 230,46,17984
 MA 132,200,156
 s_add_u32 s4, s87, 0x9900
 s_cmp_lt_u32 s4, 0x26400
 s_cselect_b32 s4, s4, 0
 MA 52,200,188
 EX 71,71
 MA 48,200,184
 CV 84,68,69
 CV 85,70,71
 MA 140,204,156
 RT 200,45,26112
 RT 202,45,26624
 MA 136,204,152
 s_add_u32 m0, s59, 0x2200
 s_add_u32 s70, s77, 0x4000
 MA 56,204,184
 EX 76,76
 MA 60,204,188
 EX 77,77
 MA 128,208,160
 RT 204,46,26112
 RT 206,46,26624
 MA 132,208,164
 buffer_load_dwordx4 v8, s[12:15], s70 offen lds
 MA 52,208,196
 EX 78,78
 MA 48,208,192
 EX 79,79
 MA 140,212,164
 WL 4
 RT 208,45,26176
 RT 210,45,26688
 MA 136,212,160
 CV 86,76,77
 CV 87,78,79
 MA 56,212,192
 s_nop 0
 MA 60,212,196
 s_nop 0
 MC 72,216,144
 RT 212,46,26176
 RT 214,46,26688
 MC 76,216,148
 EX 128,128
 MV 164,216,84
 EX 129,129
 MV 160,216,80
 EX 130,130
 MC 84,220,148
 RB 216,35,8704
 CV 152,128,129
 MC 80,220,144
 s_add_u32 m0, m0, 64
 MV 168,220,80
 EX 131,131
 MV 172,220,84
 CV 153,130,131
 v_mfma_f32_16x16x32_bf16 v[230:233], v[24:27], v[144:147], v[230:233]
 EX 136,136
 MC 88,224,144
 RB 220,35,13056
 MC 92,224,148
 buffer_load_dwordx4 v8, s[12:15], s70 offen offset:1024 lds
 MV 180,224,84
 EX 137,137
 MV 176,224,80
 EX 138,138
 MC 100,228,148
 WL 2
 RB 224,35,8768
 CV 154,136,137
 MC 96,228,144
 EX 139,139
 MV 184,228,80
 CV 155,138,139
 MV 188,228,84
 EX 132,132
 v_mfma_f32_16x16x32_bf16 v[234:237], v[24:27], v[148:151], v[234:237]
 EX 133,133
 MC 104,200,144
 RB 228,35,13120
 CV 156,132,133
 MC 108,200,148
 EX 134,134
 MV 196,200,84
 EX 135,135
 MV 192,200,80
 CV 157,134,135
 MC 116,204,148
 RB 200,35,8832
 MC 112,204,144
 s_add_u32 m0, s59, 0x4400
 s_add_u32 s70, s80, 0
 MV 200,204,80
 EX 140,140
 MV 204,204,84
 EX 141,141
 v_mfma_f32_16x16x32_bf16 v[96:99], v[24:27], v[80:83], v[96:99]
 EX 142,142
 MC 120,208,144
 RB 204,35,13184
 CV 158,140,141
 MC 124,208,148
 buffer_load_dwordx4 v3, s[16:19], s70 offen lds
 MV 212,208,84
 EX 143,143
 MV 208,208,80
 CV 159,142,143
 MC 132,212,148
 WL 2
 RB 208,35,8896
 MC 128,212,144
 EX 48,48
 MV 216,212,80
 EX 49,49
 MV 220,212,84
 EX 50,50
 v_mfma_f32_16x16x32_bf16 v[100:103], v[24:27], v[84:87], v[100:103]
 EX 51,51
 v_mfma_f32_16x16x32_bf16 v[112:115], a[216:219], a[136:139], 0
 RB 212,35,13248
 CV 88,48,49
 v_mfma_f32_16x16x32_bf16 v[116:119], a[216:219], a[140:143], 0
 CV 89,50,51
 v_mfma_f32_16x16x32_bf16 v[68:71], a[216:219], a[172:175], 0
 EX 56,56
 v_mfma_f32_16x16x32_bf16 v[64:67], a[216:219], a[168:171], 0
 EX 57,57
 v_mfma_f32_16x16x32_bf16 v[124:127], a[220:223], a[140:143], 0
 RT 216,45,21760
 RT 218,45,22272
 v_mfma_f32_16x16x32_bf16 v[120:123], a[220:223], a[136:139], 0
 buffer_load_dwordx4 v4, s[16:19], s70 offen offset:1088 lds
 v_mfma_f32_16x16x32_bf16 v[72:75], a[220:223], a[168:171], 0
 EX 58,58
 v_mfma_f32_16x16x32_bf16 v[76:79], a[220:223], a[172:175], 0
 EX 59,59
 MA 112,224,144
 RT 220,46,21760
 RT 222,46,22272
 MA 116,224,148
 CV 90,56,57
 CV 91,58,59
 MA 68,224,180
 EX 52,52
 MA 64,224,176
 EX 53,53
 MA 124,228,148
 WL 4
 RT 224,45,21824
 RT 226,45,22336
 MA 120,228,144
 EX 54,54
 MA 72,228,176
 EX 55,55
 MA 76,228,180
 CV 92,52,53
 CV 93,54,55
 MA 112,200,152
 RT 228,46,21824
 RT 230,46,22336
 MA 116,200,156
 s_add_u32 m0, s59, 0x6600
 s_add_u32 s70, s80, 0x80
 MA 68,200,188
 EX 60,60
 MA 64,200,184
 EX 61,61
 MA 124,204,156
 RT 200,45,30464
 RT 202,45,30976
 MA 120,204,152
 buffer_load_dwordx4 v3, s[16:19], s70 offen lds
 MA 72,204,184
 EX 62,62
 MA 76,204,188
 EX 63,63
 MA 112,208,160
 RT 204,46,30464
 RT 206,46,30976
 MA 116,208,164
 CV 94,60,61
 CV 95,62,63
 MA 68,208,196
 s_nop 0
 MA 64,208,192
 s_nop 0
 MA 124,212,164
 WL 4
 RT 208,45,30528
 RT 210,45,31040
 MA 120,212,160
 s_nop 0
 MA 72,212,192
 s_nop 0
 MA 76,212,196
 s_nop 0
 MC 72,216,152
 RT 212,46,30528
 RT 214,46,31040
 MC 76,216,156
 buffer_load_dwordx4 v4, s[16:19], s70 offen offset:1088 lds
 v_add_u32 v45, s4, v44
 v_xor_b32 v46, 32, v45
 v_add_u32 v35, s4, v32
 MV 164,216,92
 EX 112,112
 MV 160,216,88
 EX 113,113
 MC 84,220,156
 s_sub_u32 s91, s91, 1
 s_cmp_lg_u32 s91, 0
 s_cbranch_scc1 L_M_loop0
 s_waitcnt vmcnt(8)
 s_barrier
 RB 216,35,0
 MC 80,220,152
 s_mov_b32 s89, s88
 s_mov_b32 s88, s87
 EX 114,114
 MV 168,220,88
 EX 115,115
 MV 172,220,92
 CV 144,112,113
 CV 145,114,115
 v_mfma_f32_16x16x32_bf16 v[230:233], v[24:27], v[152:155], v[230:233]
 EX 120,120
 MC 88,224,152
 RB 220,35,4352
 MC 92,224,156
 s_mov_b32 s87, s4
 s_add_u32 s59, s89, s69
 MV 180,224,92
 EX 121,121
 MV 176,224,88
 EX 122,122
 MC 100,228,156
 WL 2
 RB 224,35,64
 CV 146,120,121
 MC 96,228,152
 s_add_u32 s77, s77, 0x4000
 s_add_u32 s80, s80, 0x4000
 MV 184,228,88
 EX 123,123
 MV 188,228,92
 CV 147,122,123
 v_mfma_f32_16x16x32_bf16 v[234:237], v[24:27], v[156:159], v[234:237]
 EX 116,116
 MC 104,200,152
 RB 228,35,4416
 MC 108,200,156
 s_add_u32 m0, s59, 0
 s_add_u32 s70, s77, 0x2000
 MV 196,200,92
 EX 117,117
 MV 192,200,88
 EX 118,118
 MC 116,204,156
 RB 200,35,128
 CV 148,116,117
 MC 112,204,152
 buffer_load_dwordx4 v8, s[12:15], s70 offen lds
 MV 200,204,88
 EX 119,119
 MV 204,204,92
 CV 149,118,119
 v_mfma_f32_16x16x32_bf16 v[96:99], v[24:27], v[88:91], v[96:99]
 EX 124,124
 MC 120,208,152
 RB 204,35,4480
 MC 124,208,156
 EX 125,125
 MV 212,208,92
 EX 126,126
 MV 208,208,88
 EX 127,127
 MC 132,212,156
 WL 2
 RB 208,35,192
 CV 150,124,125
 MC 128,212,152
 CV 151,126,127
 MV 216,212,88
 EX 64,64
 MV 220,212,92
 EX 65,65
 v_mfma_f32_16x16x32_bf16 v[100:103], v[24:27], v[92:95], v[100:103]
 EX 66,66
 v_mfma_f32_16x16x32_bf16 v[128:131], a[216:219], a[136:139], 0
 RB 212,35,4544
 CV 80,64,65
 v_mfma_f32_16x16x32_bf16 v[132:135], a[216:219], a[140:143], 0
 s_add_u32 m0, m0, 64
 v_mfma_f32_16x16x32_bf16 v[52:55], a[216:219], a[172:175], 0
 EX 67,67
 v_mfma_f32_16x16x32_bf16 v[48:51], a[216:219], a[168:171], 0
 CV 81,66,67
 v_mfma_f32_16x16x32_bf16 v[140:143], a[220:223], a[140:143], 0
 RT 216,45,17408
 RT 218,45,17920
 v_mfma_f32_16x16x32_bf16 v[136:139], a[220:223], a[136:139], 0
 buffer_load_dwordx4 v8, s[12:15], s70 offen offset:1024 lds
 v_mfma_f32_16x16x32_bf16 v[56:59], a[220:223], a[168:171], 0
 EX 72,72
 v_mfma_f32_16x16x32_bf16 v[60:63], a[220:223], a[172:175], 0
 EX 73,73
 MA 128,224,144
 RT 220,46,17408
 RT 222,46,17920
 MA 132,224,148
 EX 74,74
 MA 52,224,180
 EX 75,75
 MA 48,224,176
 CV 82,72,73
 CV 83,74,75
 MA 140,228,148
 WL 4
 RT 224,45,17472
 RT 226,45,17984
 MA 136,228,144
 EX 68,68
 MA 56,228,176
 EX 69,69
 MA 60,228,180
 EX 70,70
 MA 128,200,152
 RT 228,46,17472
 RT 230,46,17984
 MA 132,200,156
 s_add_u32 s4, s87, 0x9900
 s_cmp_lt_u32 s4, 0x26400
 s_cselect_b32 s4, s4, 0
 MA 52,200,188
 EX 71,71
 MA 48,200,184
 CV 84,68,69
 CV 85,70,71
 MA 140,204,156
 RT 200,45,26112
 RT 202,45,26624
 MA 136,204,152
 s_add_u32 m0, s59, 0x4400
 s_add_u32 s70, s80, 0
 MA 56,204,184
 EX 76,76
 MA 60,204,188
 EX 77,77
 MA 128,208,160
 RT 204,46,26112
 RT 206,46,26624
 MA 132,208,164
 buffer_load_dwordx4 v3, s[16:19], s70 offen lds
 MA 52,208,196
 EX 78,78
 MA 48,208,192
 EX 79,79
 MA 140,212,164
 WL 4
 RT 208,45,26176
 RT 210,45,26688
 MA 136,212,160
 CV 86,76,77
 CV 87,78,79
 MA 56,212,192
 s_nop 0
 MA 60,212,196
 s_nop 0
 MC 72,216,144
 RT 212,46,26176
 RT 214,46,26688
 MC 76,216,148
 EX 128,128
 MV 164,216,84
 EX 129,129
 MV 160,216,80
 EX 130,130
 MC 84,220,148
 RB 216,35,8704
 CV 152,128,129
 MC 80,220,144
 buffer_load_dwordx4 v4, s[16:19], s70 offen offset:1088 lds
 MV 168,220,80
 EX 131,131
 MV 172,220,84
 CV 153,130,131
 v_mfma_f32_16x16x32_bf16 v[230:233], v[24:27], v[144:147], v[230:233]
 EX 136,136
 MC 88,224,144
 RB 220,35,13056
 MC 92,224,148
 EX 137,137
 MV 180,224,84
 EX 138,138
 MV 176,224,80
 EX 139,139
 MC 100,228,148
 WL 2
 RB 224,35,8768
 CV 154,136,137
 MC 96,228,144
 CV 155,138,139
 MV 184,228,80
 EX 132,132
 MV 188,228,84
 EX 133,133
 v_mfma_f32_16x16x32_bf16 v[234:237], v[24:27], v[148:151], v[234:237]
 EX 134,134
 MC 104,200,144
 RB 228,35,13120
 CV 156,132,133
 MC 108,200,148
 s_add_u32 m0, s59, 0x6600
 s_add_u32 s70, s80, 0x80
 MV 196,200,84
 EX 135,135
 MV 192,200,80
 CV 157,134,135
 MC 116,204,148
 RB 200,35,8832
 MC 112,204,144
 buffer_load_dwordx4 v3, s[16:19], s70 offen lds
 MV 200,204,80
 EX 140,140
 MV 204,204,84
 EX 141,141
 v_mfma_f32_16x16x32_bf16 v[96:99], v[24:27], v[80:83], v[96:99]
 EX 142,142
 MC 120,208,144
 RB 204,35,13184
 CV 158,140,141
 MC 124,208,148
 EX 143,143
 MV 212,208,84
 CV 159,142,143
 MV 208,208,80
 EX 48,48
 MC 132,212,148
 WL 2
 RB 208,35,8896
 MC 128,212,144
 EX 49,49
 MV 216,212,80
 EX 50,50
 MV 220,212,84
 EX 51,51
 v_mfma_f32_16x16x32_bf16 v[100:103], v[24:27], v[84:87], v[100:103]
 CV 88,48,49
 CV 89,50,51
 v_mfma_f32_16x16x32_bf16 v[112:115], a[216:219], a[136:139], 0
 RB 212,35,13248
 v_mfma_f32_16x16x32_bf16 v[116:119], a[216:219], a[140:143], 0
 buffer_load_dwordx4 v4, s[16:19], s70 offen offset:1088 lds
 v_mfma_f32_16x16x32_bf16 v[68:71], a[216:219], a[172:175], 0
 EX 56,56
 v_mfma_f32_16x16x32_bf16 v[64:67], a[216:219], a[168:171], 0
 EX 57,57
 v_mfma_f32_16x16x32_bf16 v[124:127], a[220:223], a[140:143], 0
 RT 216,45,21760
 RT 218,45,22272
 v_mfma_f32_16x16x32_bf16 v[120:123], a[220:223], a[136:139], 0
 EX 58,58
 v_mfma_f32_16x16x32_bf16 v[72:75], a[220:223], a[168:171], 0
 EX 59,59
 v_mfma_f32_16x16x32_bf16 v[76:79], a[220:223], a[172:175], 0
 CV 90,56,57
 CV 91,58,59
 MA 112,224,144
 RT 220,46,21760
 RT 222,46,22272
 MA 116,224,148
 EX 52,52
 MA 68,224,180
 EX 53,53
 MA 64,224,176
 EX 54,54
 MA 124,228,148
 WL 4
 RT 224,45,21824
 RT 226,45,22336
 MA 120,228,144
 EX 55,55
 MA 72,228,176
 CV 92,52,53
 CV 93,54,55
 MA 76,228,180
 EX 60,60
 MA 112,200,152
 RT 228,46,21824
 RT 230,46,22336
 MA 116,200,156
 EX 61,61
 MA 68,200,188
 EX 62,62
 MA 64,200,184
 EX 63,63
 MA 124,204,156
 RT 200,45,30464
 RT 202,45,30976
 MA 120,204,152
 CV 94,60,61
 CV 95,62,63
 MA 72,204,184
 s_nop 0
 MA 76,204,188
 s_nop 0
 MA 112,208,160
 RT 204,46,30464
 RT 206,46,30976
 MA 116,208,164
 s_nop 0
 MA 68,208,196
 s_nop 0
 MA 64,208,192
 s_nop 0
 MA 124,212,164
 WL 4
 RT 208,45,30528
 RT 210,45,31040
 MA 120,212,160
 s_nop 0
 MA 72,212,192
 s_nop 0
 MA 76,212,196
 s_nop 0
 MC 72,216,152
 RT 212,46,30528
 RT 214,46,31040
 MC 76,216,156
 v_add_u32 v45, s4, v44
 v_xor_b32 v46, 32, v45
 v_add_u32 v35, s4, v32
 MV 164,216,92
 EX 112,112
 MV 160,216,88
 EX 113,113
 MC 84,220,156
 s_waitcnt vmcnt(6)
 s_barrier
 RB 216,35,0
 MC 80,220,152
 s_mov_b32 s89, s88
 s_mov_b32 s88, s87
 EX 114,114
 MV 168,220,88
 EX 115,115
 MV 172,220,92
 CV 144,112,113
 CV 145,114,115
 v_mfma_f32_16x16x32_bf16 v[230:233], v[24:27], v[152:155], v[230:233]
 EX 120,120
 MC 88,224,152
 RB 220,35,4352
 MC 92,224,156
 s_mov_b32 s87, s4
 MV 180,224,92
 EX 121,121
 MV 176,224,88
 EX 122,122
 MC 100,228,156
 WL 2
 RB 224,35,64
 CV 146,120,121
 MC 96,228,152
 s_mov_b32 s92, 0x480
 v_mad_u32_u24 v3, v41, s92, v2
 v_add_u32 v4, 0xdc0, v3
 v_add_u32 v5, 0xdc0, v4
 v_add_u32 v6, 0xdc0, v5
 MV 184,228,88
 EX 123,123
 MV 188,228,92
 CV 147,122,123
 v_mfma_f32_16x16x32_bf16 v[234:237], v[24:27], v[156:159], v[234:237]
 EX 116,116
 MC 104,200,152
 RB 228,35,4416
 MC 108,200,156
 s_add_u32 m0, s89, s65
 s_add_u32 s70, s84, 0
 MV 196,200,92
 EX 117,117
 MV 192,200,88
 EX 118,118
 MC 116,204,156
 RB 200,35,128
 CV 148,116,117
 MC 112,204,152
 buffer_load_dwordx4 v3, s[32:35], s70 offen lds
 MV 200,204,88
 EX 119,119
 MV 204,204,92
 CV 149,118,119
 v_mfma_f32_16x16x32_bf16 v[96:99], v[24:27], v[88:91], v[96:99]
 EX 124,124
 MC 120,208,152
 RB 204,35,4480
 MC 124,208,156
 EX 125,125
 MV 212,208,92
 EX 126,126
 MV 208,208,88
 EX 127,127
 MC 132,212,156
 WL 2
 RB 208,35,192
 CV 150,124,125
 MC 128,212,152
 CV 151,126,127
 MV 216,212,88
 EX 64,64
 MV 220,212,92
 EX 65,65
 v_mfma_f32_16x16x32_bf16 v[100:103], v[24:27], v[92:95], v[100:103]
 EX 66,66
 v_mfma_f32_16x16x32_bf16 v[128:131], a[216:219], a[136:139], 0
 RB 212,35,4544
 CV 80,64,65
 v_mfma_f32_16x16x32_bf16 v[132:135], a[216:219], a[140:143], 0
 buffer_load_dwordx4 v4, s[32:35], s70 offen offset:1088 lds
 v_mfma_f32_16x16x32_bf16 v[52:55], a[216:219], a[172:175], 0
 EX 67,67
 v_mfma_f32_16x16x32_bf16 v[48:51], a[216:219], a[168:171], 0
 CV 81,66,67
 v_mfma_f32_16x16x32_bf16 v[140:143], a[220:223], a[140:143], 0
 RT 216,45,17408
 RT 218,45,17920
 v_mfma_f32_16x16x32_bf16 v[136:139], a[220:223], a[136:139], 0
 EX 72,72
 v_mfma_f32_16x16x32_bf16 v[56:59], a[220:223], a[168:171], 0
 EX 73,73
 v_mfma_f32_16x16x32_bf16 v[60:63], a[220:223], a[172:175], 0
 EX 74,74
 MA 128,224,144
 RT 220,46,17408
 RT 222,46,17920
 MA 132,224,148
 EX 75,75
 MA 52,224,180
 CV 82,72,73
 CV 83,74,75
 MA 48,224,176
 EX 68,68
 MA 140,228,148
 WL 4
 RT 224,45,17472
 RT 226,45,17984
 MA 136,228,144
 s_add_u32 s4, s87, 0x9900
 s_cmp_lt_u32 s4, 0x26400
 s_cselect_b32 s4, s4, 0
 MA 56,228,176
 EX 69,69
 MA 60,228,180
 EX 70,70
 MA 128,200,152
 RT 228,46,17472
 RT 230,46,17984
 MA 132,200,156
 buffer_load_dwordx4 v5, s[32:35], s70 offen offset:2176 lds
 MA 52,200,188
 EX 71,71
 MA 48,200,184
 CV 84,68,69
 CV 85,70,71
 MA 140,204,156
 RT 200,45,26112
 RT 202,45,26624
 MA 136,204,152
 EX 76,76
 MA 56,204,184
 EX 77,77
 MA 60,204,188
 EX 78,78
 MA 128,208,160
 RT 204,46,26112
 RT 206,46,26624
 MA 132,208,164
 EX 79,79
 MA 52,208,196
 CV 86,76,77
 CV 87,78,79
 MA 48,208,192
 s_nop 0
 MA 140,212,164
 WL 4
 RT 208,45,26176
 RT 210,45,26688
 MA 136,212,160
 buffer_load_dwordx4 v6, s[32:35], s70 offen offset:3264 lds
 MA 56,212,192
 s_nop 0
 MA 60,212,196
 s_nop 0
 MC 72,216,144
 RT 212,46,26176
 RT 214,46,26688
 MC 76,216,148
 EX 128,128
 MV 164,216,84
 EX 129,129
 MV 160,216,80
 EX 130,130
 MC 84,220,148
 RB 216,35,8704
 CV 152,128,129
 MC 80,220,144
 EX 131,131
 MV 168,220,80
 CV 153,130,131
 MV 172,220,84
 EX 136,136
 v_mfma_f32_16x16x32_bf16 v[230:233], v[24:27], v[144:147], v[230:233]
 EX 137,137
 MC 88,224,144
 RB 220,35,13056
 CV 154,136,137
 MC 92,224,148
 s_add_u32 m0, m0, 0x1100
 s_add_u32 s70, s84, 0x9000
 MV 180,224,84
 EX 138,138
 MV 176,224,80
 EX 139,139
 MC 100,228,148
 WL 2
 RB 224,35,8768
 CV 155,138,139
 MC 96,228,144
 buffer_load_dwordx4 v3, s[32:35], s70 offen lds
 MV 184,228,80
 EX 132,132
 MV 188,228,84
 EX 133,133
 v_mfma_f32_16x16x32_bf16 v[234:237], v[24:27], v[148:151], v[234:237]
 EX 134,134
 MC 104,200,144
 RB 228,35,13120
 CV 156,132,133
 MC 108,200,148
 EX 135,135
 MV 196,200,84
 CV 157,134,135
 MV 192,200,80
 EX 140,140
 MC 116,204,148
 RB 200,35,8832
 MC 112,204,144
 EX 141,141
 MV 200,204,80
 EX 142,142
 MV 204,204,84
 EX 143,143
 v_mfma_f32_16x16x32_bf16 v[96:99], v[24:27], v[80:83], v[96:99]
 CV 158,140,141
 CV 159,142,143
 MC 120,208,144
 RB 204,35,13184
 MC 124,208,148
 buffer_load_dwordx4 v4, s[32:35], s70 offen offset:1088 lds
 MV 212,208,84
 EX 48,48
 MV 208,208,80
 EX 49,49
 MC 132,212,148
 WL 2
 RB 208,35,8896
 CV 88,48,49
 MC 128,212,144
 EX 50,50
 MV 216,212,80
 EX 51,51
 MV 220,212,84
 CV 89,50,51
 v_mfma_f32_16x16x32_bf16 v[100:103], v[24:27], v[84:87], v[100:103]
 EX 56,56
 v_mfma_f32_16x16x32_bf16 v[112:115], a[216:219], a[136:139], 0
 RB 212,35,13248
 v_mfma_f32_16x16x32_bf16 v[116:119], a[216:219], a[140:143], 0
 EX 57,57
 v_mfma_f32_16x16x32_bf16 v[68:71], a[216:219], a[172:175], 0
 EX 58,58
 v_mfma_f32_16x16x32_bf16 v[64:67], a[216:219], a[168:171], 0
 EX 59,59
 v_mfma_f32_16x16x32_bf16 v[124:127], a[220:223], a[140:143], 0
 RT 216,45,21760
 RT 218,45,22272
 v_mfma_f32_16x16x32_bf16 v[120:123], a[220:223], a[136:139], 0
 buffer_load_dwordx4 v5, s[32:35], s70 offen offset:2176 lds
 v_mfma_f32_16x16x32_bf16 v[72:75], a[220:223], a[168:171], 0
 CV 90,56,57
 CV 91,58,59
 v_mfma_f32_16x16x32_bf16 v[76:79], a[220:223], a[172:175], 0
 EX 52,52
 MA 112,224,144
 RT 220,46,21760
 RT 222,46,22272
 MA 116,224,148
 EX 53,53
 MA 68,224,180
 EX 54,54
 MA 64,224,176
 EX 55,55
 MA 124,228,148
 WL 4
 RT 224,45,21824
 RT 226,45,22336
 MA 120,228,144
 CV 92,52,53
 CV 93,54,55
 MA 72,228,176
 EX 60,60
 MA 76,228,180
 EX 61,61
 MA 112,200,152
 RT 228,46,21824
 RT 230,46,22336
 MA 116,200,156
 buffer_load_dwordx4 v6, s[32:35], s70 offen offset:3264 lds
 MA 68,200,188
 EX 62,62
 MA 64,200,184
 EX 63,63
 MA 124,204,156
 RT 200,45,30464
 RT 202,45,30976
 MA 120,204,152
 CV 94,60,61
 CV 95,62,63
 MA 72,204,184
 s_nop 0
 MA 76,204,188
 s_nop 0
 MA 112,208,160
 RT 204,46,30464
 RT 206,46,30976
 MA 116,208,164
 s_nop 0
 MA 68,208,196
 s_nop 0
 MA 64,208,192
 s_nop 0
 MA 124,212,164
 WL 4
 RT 208,45,30528
 RT 210,45,31040
 MA 120,212,160
 s_add_u32 m0, s89, s66
 s_add_u32 s70, s86, 0
 MA 72,212,192
 s_nop 0
 MA 76,212,196
 s_nop 0
 MC 72,216,152
 RT 212,46,30528
 RT 214,46,31040
 MC 76,216,156
 buffer_load_dwordx4 v3, s[32:35], s70 offen lds
 s_getpc_b64 s[94:95]
L_cp6:
 s_add_u32 s94, s94, L_M_p2-L_cp6
 s_addc_u32 s95, s95, 0
 v_bfe_u32 v40, v38, 16, 5
 v_and_b32 v39, 63, v38
 v_min_u32 v39, 4, v39
 v_mad_u32_u24 v39, v40, 5, v39
 v_lshlrev_b32 v39, 7, v39
 v_min_u32 v39, L_M_p2+20480-L_M_p2-4, v39
 global_load_dword v47, v39, s[94:95]
 v_add_u32 v45, s4, v44
 v_xor_b32 v46, 32, v45
 v_add_u32 v35, s4, v32
 MV 164,216,92
 EX 112,112
 MV 160,216,88
 EX 113,113
 MC 84,220,156
 s_waitcnt vmcnt(10)
 s_barrier
 RB 216,35,0
 MC 80,220,152
 s_mov_b32 s89, s88
 s_mov_b32 s88, s87
 EX 114,114
 MV 168,220,88
 EX 115,115
 MV 172,220,92
 CV 144,112,113
 CV 145,114,115
 v_mfma_f32_16x16x32_bf16 v[230:233], v[24:27], v[152:155], v[230:233]
 EX 120,120
 MC 88,224,152
 RB 220,35,4352
 MC 92,224,156
 s_mov_b32 s87, s4
 MV 180,224,92
 EX 121,121
 MV 176,224,88
 EX 122,122
 MC 100,228,156
 WL 2
 RB 224,35,64
 CV 146,120,121
 MC 96,228,152
 s_add_u32 m0, s89, s65
 s_add_u32 s70, s83, 0
 MV 184,228,88
 EX 123,123
 MV 188,228,92
 CV 147,122,123
 v_mfma_f32_16x16x32_bf16 v[234:237], v[24:27], v[156:159], v[234:237]
 EX 116,116
 MC 104,200,152
 RB 228,35,4416
 MC 108,200,156
 buffer_load_dwordx4 v3, s[24:27], s70 offen lds
 MV 196,200,92
 EX 117,117
 MV 192,200,88
 EX 118,118
 MC 116,204,156
 RB 200,35,128
 CV 148,116,117
 MC 112,204,152
 EX 119,119
 MV 200,204,88
 CV 149,118,119
 MV 204,204,92
 EX 124,124
 v_mfma_f32_16x16x32_bf16 v[96:99], v[24:27], v[88:91], v[96:99]
 EX 125,125
 MC 120,208,152
 RB 204,35,4480
 CV 150,124,125
 MC 124,208,156
 EX 126,126
 MV 212,208,92
 EX 127,127
 MV 208,208,88
 CV 151,126,127
 MC 132,212,156
 WL 2
 RB 208,35,192
 MC 128,212,152
 buffer_load_dwordx4 v4, s[24:27], s70 offen offset:1088 lds
 MV 216,212,88
 EX 64,64
 MV 220,212,92
 EX 65,65
 v_mfma_f32_16x16x32_bf16 v[100:103], v[24:27], v[92:95], v[100:103]
 EX 66,66
 v_mfma_f32_16x16x32_bf16 v[128:131], a[216:219], a[136:139], 0
 RB 212,35,4544
 CV 80,64,65
 v_mfma_f32_16x16x32_bf16 v[132:135], a[216:219], a[140:143], 0
 EX 67,67
 v_mfma_f32_16x16x32_bf16 v[52:55], a[216:219], a[172:175], 0
 CV 81,66,67
 v_mfma_f32_16x16x32_bf16 v[48:51], a[216:219], a[168:171], 0
 EX 72,72
 v_mfma_f32_16x16x32_bf16 v[140:143], a[220:223], a[140:143], 0
 RT 216,45,17408
 RT 218,45,17920
 v_mfma_f32_16x16x32_bf16 v[136:139], a[220:223], a[136:139], 0
 EX 73,73
 v_mfma_f32_16x16x32_bf16 v[56:59], a[220:223], a[168:171], 0
 EX 74,74
 v_mfma_f32_16x16x32_bf16 v[60:63], a[220:223], a[172:175], 0
 EX 75,75
 MA 128,224,144
 RT 220,46,17408
 RT 222,46,17920
 MA 132,224,148
 buffer_load_dwordx4 v5, s[24:27], s70 offen offset:2176 lds
 MA 52,224,180
 CV 82,72,73
 CV 83,74,75
 MA 48,224,176
 EX 68,68
 MA 140,228,148
 WL 4
 RT 224,45,17472
 RT 226,45,17984
 MA 136,228,144
 EX 69,69
 MA 56,228,176
 EX 70,70
 MA 60,228,180
 EX 71,71
 MA 128,200,152
 RT 228,46,17472
 RT 230,46,17984
 MA 132,200,156
 CV 84,68,69
 CV 85,70,71
 MA 52,200,188
 EX 76,76
 MA 48,200,184
 EX 77,77
 MA 140,204,156
 RT 200,45,26112
 RT 202,45,26624
 MA 136,204,152
 s_add_u32 s4, s87, 0x9900
 s_cmp_lt_u32 s4, 0x26400
 s_cselect_b32 s4, s4, 0
 MA 56,204,184
 EX 78,78
 MA 60,204,188
 EX 79,79
 MA 128,208,160
 RT 204,46,26112
 RT 206,46,26624
 MA 132,208,164
 buffer_load_dwordx4 v6, s[24:27], s70 offen offset:3264 lds
 MA 52,208,196
 CV 86,76,77
 CV 87,78,79
 MA 48,208,192
 s_nop 0
 MA 140,212,164
 WL 4
 RT 208,45,26176
 RT 210,45,26688
 MA 136,212,160
 s_nop 0
 MA 56,212,192
 s_nop 0
 MA 60,212,196
 s_nop 0
 MC 72,216,144
 RT 212,46,26176
 RT 214,46,26688
 MC 76,216,148
 EX 128,128
 EX 129,129
 MV 164,216,84
 EX 130,130
 CV 152,128,129
 MV 160,216,80
 EX 131,131
 s_nop 0
 CV 153,130,131
 MC 84,220,148
 RT 216,45,21760
 RT 218,45,22272
 MC 80,220,144
 s_add_u32 m0, m0, 0x1100
 s_add_u32 s70, s83, 0x9000
 EX 136,136
 EX 137,137
 MV 168,220,80
 EX 138,138
 CV 154,136,137
 MV 172,220,84
 EX 139,139
 s_nop 0
 CV 155,138,139
 v_mfma_f32_16x16x32_bf16 v[230:233], v[24:27], v[144:147], v[230:233]
 EX 132,132
 MC 88,224,144
 RT 220,46,21760
 RT 222,46,22272
 MC 92,224,148
 buffer_load_dwordx4 v3, s[24:27], s70 offen lds
 EX 133,133
 EX 134,134
 MV 180,224,84
 EX 135,135
 CV 156,132,133
 MV 176,224,80
 CV 157,134,135
 EX 140,140
 MC 100,228,148
 WL 4
 RT 224,45,21824
 RT 226,45,22336
 MC 96,228,144
 EX 141,141
 EX 142,142
 MV 184,228,80
 EX 143,143
 CV 158,140,141
 MV 188,228,84
 CV 159,142,143
 EX 48,48
 v_mfma_f32_16x16x32_bf16 v[234:237], v[24:27], v[148:151], v[234:237]
 EX 49,49
 MC 104,200,144
 RT 228,46,21824
 RT 230,46,22336
 MC 108,200,148
 EX 50,50
 CV 88,48,49
 MV 196,200,84
 EX 51,51
 s_nop 0
 CV 89,50,51
 MV 192,200,80
 EX 56,56
 MC 116,204,148
 RT 200,45,30464
 RT 202,45,30976
 MC 112,204,144
 buffer_load_dwordx4 v4, s[24:27], s70 offen offset:1088 lds
 EX 57,57
 EX 58,58
 MV 200,204,80
 EX 59,59
 CV 90,56,57
 MV 204,204,84
 CV 91,58,59
 EX 52,52
 v_mfma_f32_16x16x32_bf16 v[96:99], v[24:27], v[80:83], v[96:99]
 EX 53,53
 MC 120,208,144
 RT 204,46,30464
 RT 206,46,30976
 MC 124,208,148
 EX 54,54
 CV 92,52,53
 MV 212,208,84
 EX 55,55
 s_nop 0
 CV 93,54,55
 MV 208,208,80
 EX 60,60
 MC 132,212,148
 WL 4
 RT 208,45,30528
 RT 210,45,31040
 MC 128,212,144
 EX 61,61
 MV 216,212,80
 EX 62,62
 CV 94,60,61
 MV 220,212,84
 EX 63,63
 s_nop 0
 CV 95,62,63
 v_mfma_f32_16x16x32_bf16 v[100:103], v[24:27], v[84:87], v[100:103]
 s_nop 0
 MC 72,216,152
 RT 212,46,30528
 RT 214,46,31040
 MC 76,216,156
 buffer_load_dwordx4 v5, s[24:27], s70 offen offset:2176 lds
 buffer_load_dwordx4 v6, s[24:27], s70 offen offset:3264 lds
 v_add_u32 v45, s4, v44
 v_xor_b32 v46, 32, v45
 MV 164,216,92
 s_nop 0
 MV 160,216,88
 s_nop 0
 MC 84,220,156
L_M_p2:
 s_waitcnt vmcnt(9)
 s_barrier
 RT 240,45,0
 RT 242,45,512
 MC 80,220,152
 s_mov_b32 s89, s88
 s_mov_b32 s88, s87
 MV 168,220,88
 s_nop 0
 MV 172,220,92
 v_mfma_f32_16x16x32_bf16 v[230:233], v[24:27], v[152:155], v[230:233]
 s_nop 0
 MC 88,224,152
 RT 244,46,0
 RT 246,46,512
 MC 92,224,156
 s_mov_b32 s87, s4
 MV 180,224,92
 s_nop 0
 MV 176,224,88
 s_nop 0
 MC 100,228,156
 WL 4
 RT 248,45,4352
 RT 250,45,4864
 MC 96,228,152
 v_mov_b32 v36, 0
 MV 184,228,88
 s_nop 0
 MV 188,228,92
 v_mfma_f32_16x16x32_bf16 v[234:237], v[24:27], v[156:159], v[234:237]
 s_nop 0
 MC 104,200,152
 RT 252,46,4352
 RT 254,46,4864
 MC 108,200,156
 s_add_u32 s83, s83, 0x80
 s_add_u32 s84, s84, 0x80
 s_add_u32 s86, s86, 0x80
 MV 196,200,92
 s_nop 0
 MV 192,200,88
 s_nop 0
 MC 116,204,156
 RT 200,45,8704
 RT 202,45,9216
 MC 112,204,152
 s_add_u32 m0, s89, s65
 s_add_u32 s70, s84, 0
 MV 200,204,88
 s_nop 0
 MV 204,204,92
 v_mfma_f32_16x16x32_bf16 v[96:99], v[24:27], v[88:91], v[96:99]
 s_nop 0
 MC 120,208,152
 RT 204,46,8704
 RT 206,46,9216
 MC 124,208,156
 buffer_load_dwordx4 v3, s[32:35], s70 offen lds
 MV 212,208,92
 s_nop 0
 MV 208,208,88
 s_nop 0
 MC 132,212,156
 WL 4
 RT 208,45,13056
 RT 210,45,13568
 MC 128,212,152
 s_nop 0
 MV 216,212,88
 s_nop 0
 MV 220,212,92
 v_mfma_f32_16x16x32_bf16 v[100:103], v[24:27], v[92:95], v[100:103]
 s_nop 0
 v_mfma_f32_16x16x32_bf16 v[112:115], a[240:243], a[0:3], 0
 RT 212,46,13056
 RT 214,46,13568
 v_mfma_f32_16x16x32_bf16 v[116:119], a[240:243], a[4:7], 0
 v_mov_b32 v224, v230
 v_mov_b32 v225, v234
 v_mov_b32 v226, v96
 v_mov_b32 v227, v100
 v_rcp_f32 v250, v224
 v_rcp_f32 v251, v225
 v_rcp_f32 v252, v226
 v_mfma_f32_16x16x32_bf16 v[124:127], a[244:247], a[4:7], 0
 RT 216,45,17408
 RT 218,45,17920
 v_mfma_f32_16x16x32_bf16 v[120:123], a[244:247], a[0:3], 0
 s_add_u32 s4, s87, 0x9900
 s_cmp_lt_u32 s4, 0x26400
 s_cselect_b32 s4, s4, 0
 v_rcp_f32 v253, v227
 v_accvgpr_read_b32 v230, a72
 v_accvgpr_read_b32 v231, a73
 v_accvgpr_read_b32 v232, a74
 v_accvgpr_read_b32 v233, a75
 v_accvgpr_read_b32 v234, a76
 v_accvgpr_read_b32 v235, a77
 v_accvgpr_read_b32 v236, a78
 v_accvgpr_read_b32 v237, a79
 MA 112,248,8
 RT 220,46,17408
 RT 222,46,17920
 MA 116,248,12
 buffer_load_dwordx4 v4, s[32:35], s70 offen offset:1088 lds
 v_accvgpr_read_b32 v238, a80
 v_accvgpr_read_b32 v239, a81
 v_accvgpr_read_b32 v240, a82
 v_accvgpr_read_b32 v241, a83
 v_accvgpr_read_b32 v242, a84
 v_accvgpr_read_b32 v243, a85
 v_accvgpr_read_b32 v244, a86
 v_accvgpr_read_b32 v245, a87
 ML 230,230,250
 ML 231,231,250
 MA 124,252,12
 WL 4
 RT 224,45,21760
 RT 226,45,22272
 MA 120,252,8
 ML 232,232,250
 ML 233,233,250
 ML 234,234,251
 ML 235,235,251
 ML 236,236,251
 ML 237,237,251
 ML 238,238,250
 ML 239,239,250
 ML 240,240,250
 ML 241,241,250
 MA 112,200,16
 RT 228,46,21760
 RT 230,46,22272
 MA 116,200,20
 ML 242,242,251
 ML 243,243,251
 ML 244,244,251
 ML 245,245,251
 CV 230,230,231
 CV 232,232,233
 CV 234,234,235
 CV 236,236,237
 CV 238,238,239
 CV 240,240,241
 MA 124,204,20
 RT 232,45,26112
 RT 234,45,26624
 MA 120,204,16
 buffer_load_dwordx4 v5, s[32:35], s70 offen offset:2176 lds
 CV 242,242,243
 CV 244,244,245
 AW 72,230
 AW 73,232
 AW 74,238
 AW 75,240
 AW 76,234
 AW 77,236
 AW 78,242
 AW 79,244
 MA 112,208,24
 RT 236,46,26112
 RT 238,46,26624
 MA 116,208,28
 v_accvgpr_read_b32 v230, a88
 v_accvgpr_read_b32 v231, a89
 v_accvgpr_read_b32 v232, a90
 v_accvgpr_read_b32 v233, a91
 v_accvgpr_read_b32 v234, a92
 v_accvgpr_read_b32 v235, a93
 v_accvgpr_read_b32 v236, a94
 v_accvgpr_read_b32 v237, a95
 v_accvgpr_read_b32 v238, a96
 v_accvgpr_read_b32 v239, a97
 MA 124,212,28
 WL 4
 RT 240,45,30464
 RT 242,45,30976
 MA 120,212,24
 v_accvgpr_read_b32 v240, a98
 v_accvgpr_read_b32 v241, a99
 v_accvgpr_read_b32 v242, a100
 v_accvgpr_read_b32 v243, a101
 v_accvgpr_read_b32 v244, a102
 v_accvgpr_read_b32 v245, a103
 ML 230,230,250
 ML 231,231,250
 ML 232,232,250
 ML 233,233,250
 MA 112,216,32
 RT 244,46,30464
 RT 246,46,30976
 MA 116,216,36
 buffer_load_dwordx4 v6, s[32:35], s70 offen offset:3264 lds
 ML 234,234,251
 ML 235,235,251
 ML 236,236,251
 ML 237,237,251
 ML 238,238,250
 ML 239,239,250
 ML 240,240,250
 ML 241,241,250
 ML 242,242,251
 MA 124,220,36
 RT 248,45,34816
 RT 250,45,35328
 MA 120,220,32
 ML 243,243,251
 ML 244,244,251
 ML 245,245,251
 CV 230,230,231
 CV 232,232,233
 CV 234,234,235
 CV 236,236,237
 CV 238,238,239
 CV 240,240,241
 MA 112,224,40
 RT 252,46,34816
 RT 254,46,35328
 MA 116,224,44
 CV 242,242,243
 CV 244,244,245
 AW 88,230
 AW 89,232
 AW 90,238
 AW 91,240
 AW 92,234
 AW 93,236
 AW 94,242
 MA 124,228,44
 WL 4
 RT 200,45,64
 RT 202,45,576
 MA 120,228,40
 s_add_u32 m0, m0, 0x1100
 s_add_u32 s70, s84, 0x9000
 AW 95,244
 v_accvgpr_read_b32 v230, a104
 v_accvgpr_read_b32 v231, a105
 v_accvgpr_read_b32 v232, a106
 v_accvgpr_read_b32 v233, a107
 v_accvgpr_read_b32 v234, a108
 v_accvgpr_read_b32 v235, a109
 v_accvgpr_read_b32 v236, a110
 v_accvgpr_read_b32 v237, a111
 MA 112,232,48
 RT 204,46,64
 RT 206,46,576
 MA 116,232,52
 buffer_load_dwordx4 v3, s[32:35], s70 offen lds
 v_accvgpr_read_b32 v238, a112
 v_accvgpr_read_b32 v239, a113
 v_accvgpr_read_b32 v240, a114
 v_accvgpr_read_b32 v241, a115
 v_accvgpr_read_b32 v242, a116
 v_accvgpr_read_b32 v243, a117
 v_accvgpr_read_b32 v244, a118
 v_accvgpr_read_b32 v245, a119
 ML 230,230,250
 MA 124,236,52
 RT 208,45,4416
 RT 210,45,4928
 MA 120,236,48
 ML 231,231,250
 ML 232,232,250
 ML 233,233,250
 ML 234,234,251
 ML 235,235,251
 ML 236,236,251
 ML 237,237,251
 ML 238,238,250
 ML 239,239,250
 MA 112,240,56
 RT 212,46,4416
 RT 214,46,4928
 MA 116,240,60
 ML 240,240,250
 ML 241,241,250
 ML 242,242,251
 ML 243,243,251
 ML 244,244,251
 ML 245,245,251
 CV 230,230,231
 CV 232,232,233
 CV 234,234,235
 MA 124,244,60
 WL 4
 RT 216,45,8768
 RT 218,45,9280
 MA 120,244,56
 buffer_load_dwordx4 v4, s[32:35], s70 offen offset:1088 lds
 CV 236,236,237
 CV 238,238,239
 CV 240,240,241
 CV 242,242,243
 CV 244,244,245
 AW 104,230
 AW 105,232
 AW 106,238
 AW 107,240
 MA 112,248,64
 RT 220,46,8768
 RT 222,46,9280
 MA 116,248,68
 AW 108,234
 AW 109,236
 AW 110,242
 AW 111,244
 v_accvgpr_read_b32 v230, a120
 v_accvgpr_read_b32 v231, a121
 v_accvgpr_read_b32 v232, a122
 v_accvgpr_read_b32 v233, a123
 v_accvgpr_read_b32 v234, a124
 MA 124,252,68
 RT 224,45,13120
 RT 226,45,13632
 MA 120,252,64
 v_accvgpr_read_b32 v235, a125
 v_accvgpr_read_b32 v236, a126
 v_accvgpr_read_b32 v237, a127
 v_accvgpr_read_b32 v238, a128
 v_accvgpr_read_b32 v239, a129
 v_accvgpr_read_b32 v240, a130
 v_accvgpr_read_b32 v241, a131
 v_accvgpr_read_b32 v242, a132
 v_accvgpr_read_b32 v243, a133
 v_mfma_f32_16x16x32_bf16 v[128:131], a[200:203], a[0:3], 0
 RT 228,46,13120
 RT 230,46,13632
 v_mfma_f32_16x16x32_bf16 v[132:135], a[200:203], a[4:7], 0
 buffer_load_dwordx4 v5, s[32:35], s70 offen offset:2176 lds
 v_accvgpr_read_b32 v244, a134
 v_accvgpr_read_b32 v245, a135
 ML 230,230,250
 ML 231,231,250
 ML 232,232,250
 ML 233,233,250
 ML 234,234,251
 ML 235,235,251
 ML 236,236,251
 ML 237,237,251
 v_mfma_f32_16x16x32_bf16 v[140:143], a[204:207], a[4:7], 0
 WL 4
 RT 232,45,17472
 RT 234,45,17984
 v_mfma_f32_16x16x32_bf16 v[136:139], a[204:207], a[0:3], 0
 ML 238,238,250
 ML 239,239,250
 ML 240,240,250
 ML 241,241,250
 ML 242,242,251
 ML 243,243,251
 ML 244,244,251
 ML 245,245,251
 CV 230,230,231
 CV 232,232,233
 MA 128,208,8
 RT 236,46,17472
 RT 238,46,17984
 MA 132,208,12
 CV 234,234,235
 CV 236,236,237
 CV 238,238,239
 CV 240,240,241
 CV 242,242,243
 CV 244,244,245
 AW 120,230
 AW 121,232
 AW 122,238
 AW 123,240
 MA 140,212,12
 RT 240,45,21824
 RT 242,45,22336
 MA 136,212,8
 buffer_load_dwordx4 v6, s[32:35], s70 offen offset:3264 lds
 AW 124,234
 AW 125,236
 AW 126,242
 AW 127,244
 ML 230,160,252
 ML 231,161,252
 ML 232,162,252
 ML 233,163,252
 CV 230,230,231
 CV 232,232,233
 MA 128,216,16
 RT 244,46,21824
 RT 246,46,22336
 MA 132,216,20
 AW 80,230
 AW 81,232
 ML 234,168,252
 ML 235,169,252
 ML 236,170,252
 ML 237,171,252
 CV 234,234,235
 CV 236,236,237
 AW 82,234
 AW 83,236
 MA 140,220,20
 WL 4
 RT 248,45,26176
 RT 250,45,26688
 MA 136,220,16
 ML 238,164,253
 ML 239,165,253
 ML 240,166,253
 ML 241,167,253
 CV 238,238,239
 CV 240,240,241
 AW 84,238
 AW 85,240
 ML 242,172,253
 ML 243,173,253
 MA 128,224,24
 RT 252,46,26176
 RT 254,46,26688
 MA 132,224,28
 s_add_u32 m0, s89, s66
 s_add_u32 s70, s86, 0
 ML 244,174,253
 ML 245,175,253
 CV 242,242,243
 CV 244,244,245
 AW 86,242
 AW 87,244
 ML 230,176,252
 ML 231,177,252
 ML 232,178,252
 ML 233,179,252
 MA 140,228,28
 RT 200,45,30528
 RT 202,45,31040
 MA 136,228,24
 buffer_load_dwordx4 v3, s[32:35], s70 offen lds
 CV 230,230,231
 CV 232,232,233
 AW 96,230
 AW 97,232
 ML 234,184,252
 ML 235,185,252
 ML 236,186,252
 ML 237,187,252
 CV 234,234,235
 CV 236,236,237
 MA 128,232,32
 RT 204,46,30528
 RT 206,46,31040
 MA 132,232,36
 AW 98,234
 AW 99,236
 ML 238,180,253
 ML 239,181,253
 ML 240,182,253
 ML 241,183,253
 CV 238,238,239
 CV 240,240,241
 AW 100,238
 AW 101,240
 MA 140,236,36
 WL 4
 RT 208,45,34880
 RT 210,45,35392
 MA 136,236,32
 ML 242,188,253
 ML 243,189,253
 ML 244,190,253
 ML 245,191,253
 CV 242,242,243
 CV 244,244,245
 AW 102,242
 AW 103,244
 ML 230,192,252
 ML 231,193,252
 MA 128,240,40
 RT 212,46,34880
 RT 214,46,35392
 MA 132,240,44
 v_add_u32 v45, s4, v44
 v_xor_b32 v46, 32, v45
 ML 232,194,252
 ML 233,195,252
 CV 230,230,231
 CV 232,232,233
 AW 112,230
 AW 113,232
 ML 234,200,252
 ML 235,201,252
 ML 236,202,252
 ML 237,203,252
 MA 140,244,44
 s_waitcnt vmcnt(9)
 s_barrier
 RT 216,45,0
 RT 218,45,512
 MA 136,244,40
 s_mov_b32 s89, s88
 s_mov_b32 s88, s87
 CV 234,234,235
 CV 236,236,237
 AW 114,234
 AW 115,236
 ML 238,196,253
 ML 239,197,253
 ML 240,198,253
 ML 241,199,253
 CV 238,238,239
 CV 240,240,241
 MA 128,248,48
 RT 220,46,0
 RT 222,46,512
 MA 132,248,52
 s_mov_b32 s87, s4
 AW 116,238
 AW 117,240
 ML 242,204,253
 ML 243,205,253
 ML 244,206,253
 ML 245,207,253
 CV 242,242,243
 CV 244,244,245
 AW 118,242
 AW 119,244
 MA 140,252,52
 WL 4
 RT 224,45,4352
 RT 226,45,4864
 MA 136,252,48
 s_add_u32 m0, s89, s65
 s_add_u32 s70, s83, 0
 ML 230,208,252
 ML 231,209,252
 ML 232,210,252
 ML 233,211,252
 CV 230,230,231
 CV 232,232,233
 AW 128,230
 AW 129,232
 ML 234,216,252
 ML 235,217,252
 MA 128,200,56
 RT 228,46,4352
 RT 230,46,4864
 MA 132,200,60
 buffer_load_dwordx4 v3, s[24:27], s70 offen lds
 ML 236,218,252
 ML 237,219,252
 CV 234,234,235
 CV 236,236,237
 AW 130,234
 AW 131,236
 ML 238,212,253
 ML 239,213,253
 ML 240,214,253
 MA 140,204,60
 RT 232,45,8704
 RT 234,45,9216
 MA 136,204,56
 ML 241,215,253
 CV 238,238,239
 CV 240,240,241
 AW 132,238
 AW 133,240
 ML 242,220,253
 ML 243,221,253
 ML 244,222,253
 ML 245,223,253
 MA 128,208,64
 RT 236,46,8704
 RT 238,46,9216
 MA 132,208,68
 CV 242,242,243
 CV 244,244,245
 AW 134,242
 AW 135,244
 CV 144,112,113
 CV 145,114,115
 CV 146,120,121
 CV 147,122,123
 CV 148,116,117
 MA 140,212,68
 WL 4
 RT 240,45,13056
 RT 242,45,13568
 MA 136,212,64
 buffer_load_dwordx4 v4, s[24:27], s70 offen offset:1088 lds
 buffer_store_dwordx4 v[144:147], v0, s[36:39], s5 offen sc1
 CV 149,118,119
 CV 150,124,125
 CV 151,126,127
 buffer_store_dwordx4 v[148:151], v0, s[36:39], s5 offen offset:1024 sc1
 v_mov_b32 v255, 0x2b800000
 s_mov_b32 s93, 0x53800000
 v_med3_f32 v254, v224, s93, v255
 v_cmp_neq_f32 s[98:99], v254, v224
 v_med3_f32 v254, v225, s93, v255
 v_cmp_neq_f32 vcc, v254, v225
 s_nop 4
 s_or_b64 vcc, vcc, s[98:99]
 s_nop 1
 s_cbranch_vccz L_M_slow0_ret
 s_call_b64 s[56:57], L_M_slow0
L_M_slow0_ret:
 v_med3_f32 v254, v226, s93, v255
 v_cmp_neq_f32 s[98:99], v254, v226
 v_med3_f32 v254, v227, s93, v255
 v_cmp_neq_f32 vcc, v254, v227
 s_nop 4
 s_or_b64 vcc, vcc, s[98:99]
 s_nop 1
 s_cbranch_vccz L_M_slow1_ret
 s_call_b64 s[56:57], L_M_slow1
L_M_slow1_ret:
 s_nop 1
 v_mfma_f32_16x16x32_bf16 v[112:115], a[216:219], a[72:75], 0
 RT 244,46,13056
 RT 246,46,13568
 v_mfma_f32_16x16x32_bf16 v[116:119], a[216:219], a[76:79], 0
 CV 152,128,129
 CV 153,130,131
 v_mfma_f32_16x16x32_bf16 v[124:127], a[220:223], a[76:79], 0
 RT 248,45,17408
 RT 250,45,17920
 v_mfma_f32_16x16x32_bf16 v[120:123], a[220:223], a[72:75], 0
 CV 154,136,137
 CV 155,138,139
 MA 112,224,88
 RT 252,46,17408
 RT 254,46,17920
 MA 116,224,92
 buffer_load_dwordx4 v5, s[24:27], s70 offen offset:2176 lds
 MA 124,228,92
 WL 4
 RT 200,45,21760
 RT 202,45,22272
 MA 120,228,88
 buffer_store_dwordx4 v[152:155], v0, s[36:39], s5 offen offset:2048 sc1
 MA 112,232,104
 RT 204,46,21760
 RT 206,46,22272
 MA 116,232,108
 CV 156,132,133
 CV 157,134,135
 MA 124,236,108
 RT 208,45,26112
 RT 210,45,26624
 MA 120,236,104
 s_add_u32 s4, s87, 0x9900
 s_cmp_lt_u32 s4, 0x26400
 s_cselect_b32 s4, s4, 0
 MA 112,240,120
 RT 212,46,26112
 RT 214,46,26624
 MA 116,240,124
 buffer_load_dwordx4 v6, s[24:27], s70 offen offset:3264 lds
 MA 124,244,124
 WL 4
 RT 216,45,30464
 RT 218,45,30976
 MA 120,244,120
 CV 158,140,141
 CV 159,142,143
 MA 112,248,80
 RT 220,46,30464
 RT 222,46,30976
 MA 116,248,84
 buffer_store_dwordx4 v[156:159], v0, s[36:39], s5 offen offset:3072 sc1
 MA 124,252,84
 RT 224,45,64
 RT 226,45,576
 MA 120,252,80
 s_add_u32 m0, m0, 0x1100
 s_add_u32 s70, s83, 0x9000
 MA 112,200,96
 RT 228,46,64
 RT 230,46,576
 MA 116,200,100
 buffer_load_dwordx4 v3, s[24:27], s70 offen lds
 MA 124,204,100
 WL 4
 RT 232,45,4416
 RT 234,45,4928
 MA 120,204,96
 s_add_u32 s5, s5, 0x1000
 MA 112,208,112
 RT 236,46,4416
 MA 116,208,116
 RT 238,46,4928
 MA 124,212,116
 RT 240,45,8768
 RT 242,45,9280
 MA 120,212,112
 buffer_load_dwordx4 v4, s[24:27], s70 offen offset:1088 lds
 MA 112,216,128
 RT 244,46,8768
 MA 116,216,132
 RT 246,46,9280
 MA 124,220,132
 WL 4
 RT 248,45,13120
 MA 120,220,128
 RT 250,45,13632
 v_mfma_f32_16x16x32_bf16 v[128:131], a[224:227], a[72:75], 0
 RT 252,46,13120
 RT 254,46,13632
 v_mfma_f32_16x16x32_bf16 v[132:135], a[224:227], a[76:79], 0
 buffer_load_dwordx4 v5, s[24:27], s70 offen offset:2176 lds
 v_mfma_f32_16x16x32_bf16 v[140:143], a[228:231], a[76:79], 0
 RT 200,45,17472
 RT 202,45,17984
 v_mfma_f32_16x16x32_bf16 v[136:139], a[228:231], a[72:75], 0
 CV 144,112,113
 CV 145,114,115
 MA 128,232,88
 RT 204,46,17472
 RT 206,46,17984
 MA 132,232,92
 CV 146,120,121
 CV 147,122,123
 MA 140,236,92
 WL 4
 RT 208,45,21824
 RT 210,45,22336
 MA 136,236,88
 buffer_load_dwordx4 v6, s[24:27], s70 offen offset:3264 lds
 MA 128,240,104
 RT 212,46,21824
 RT 214,46,22336
 MA 132,240,108
 buffer_store_dwordx4 v[144:147], v0, s[36:39], s90 offen sc1
 MA 140,244,108
 RT 216,45,26176
 RT 218,45,26688
 MA 136,244,104
 CV 148,116,117
 CV 149,118,119
 MA 128,248,120
 RT 220,46,26176
 RT 222,46,26688
 MA 132,248,124
 s_lshl_b32 s82, s64, 14
 s_add_u32 s82, s82, 0x2f00000
 s_cmp_eq_u32 s62, 0
 s_cselect_b32 s93, 0, 0x10000000
 v_lshrrev_b32 v21, 2, v0
 v_add_u32 v21, s93, v21
 v_mov_b32 v26, 0x10000000
 s_add_u32 s92, s93, 0x44
 v_writelane_b32 v26, s92, 0
 v_mov_b32 v29, v26
 v_min_u32 v30, 0x110, v0
 v_lshrrev_b32 v30, 2, v30
 v_add_u32 v30, s93, v30
 s_add_u32 s92, s93, 0xfc
 v_writelane_b32 v26, s92, 1
 s_lshl_b32 s92, s64, 4
 s_add_u32 s92, s92, s93
 v_mov_b32 v22, 0x100
 v_writelane_b32 v22, s92, 0
 s_lshl_b32 s76, s63, 7
 s_add_u32 s76, s76, 0x100
 s_add_u32 s76, s76, s82
 s_lshl_b32 s77, s63, 8
 s_add_u32 s77, s77, 0x1000
 s_add_u32 s77, s77, s82
 v_mov_b32 v17, 0
 MA 140,252,124
 WL 4
 RT 224,45,30528
 RT 226,45,31040
 MA 136,252,120
 buffer_atomic_add v17, v22, s[52:55], 0 offen sc0 sc1
 MA 128,200,80
 RT 228,46,30528
 RT 230,46,31040
 MA 132,200,84
 v_add_u32 v45, s4, v44
 v_xor_b32 v46, 32, v45
 MA 140,204,84
 s_waitcnt vmcnt(14)
 s_barrier
 RT 200,45,0
 RT 202,45,512
 MA 136,204,80
 s_mov_b32 s89, s88
 s_mov_b32 s88, s87
 MA 128,208,96
 RT 204,46,0
 RT 206,46,512
 MA 132,208,100
 s_mov_b32 s87, s4
 CV 150,124,125
 MA 140,212,100
 WL 4
 RT 208,45,4352
 RT 210,45,4864
 MA 136,212,96
 s_add_u32 s83, s83, 0x80
 s_add_u32 s84, s84, 0x80
 s_add_u32 s86, s86, 0x80
 MA 128,216,112
 RT 212,46,4352
 RT 214,46,4864
 MA 132,216,116
 s_add_u32 m0, s89, s65
 s_add_u32 s70, s84, 0
 MA 140,220,116
 RT 216,45,8704
 RT 218,45,9216
 MA 136,220,112
 buffer_load_dwordx4 v3, s[32:35], s70 offen lds
 MA 128,224,128
 RT 220,46,8704
 RT 222,46,9216
 MA 132,224,132
 CV 151,126,127
 MA 140,228,132
 WL 4
 RT 224,45,13056
 RT 226,45,13568
 MA 136,228,128
 buffer_store_dwordx4 v[148:151], v0, s[36:39], s90 offen offset:1024 sc1
 v_mfma_f32_16x16x32_bf16 v[112:115], a[200:203], a[0:3], 0
 RT 228,46,13056
 RT 230,46,13568
 v_mfma_f32_16x16x32_bf16 v[116:119], a[200:203], a[4:7], 0
 buffer_load_dwordx4 v4, s[32:35], s70 offen offset:1088 lds
 v_mfma_f32_16x16x32_bf16 v[124:127], a[204:207], a[4:7], 0
 RT 232,45,17408
 RT 234,45,17920
 v_mfma_f32_16x16x32_bf16 v[120:123], a[204:207], a[0:3], 0
 CV 152,128,129
 CV 153,130,131
 MA 112,208,8
 RT 236,46,17408
 RT 238,46,17920
 MA 116,208,12
 CV 154,136,137
 CV 155,138,139
 MA 124,212,12
 WL 4
 RT 240,45,21760
 RT 242,45,22272
 MA 120,212,8
 s_add_u32 s4, s87, 0x9900
 s_cmp_lt_u32 s4, 0x26400
 s_cselect_b32 s4, s4, 0
 MA 112,216,16
 RT 244,46,21760
 RT 246,46,22272
 MA 116,216,20
 buffer_load_dwordx4 v5, s[32:35], s70 offen offset:2176 lds
 MA 124,220,20
 RT 248,45,26112
 RT 250,45,26624
 MA 120,220,16
 buffer_store_dwordx4 v[152:155], v0, s[36:39], s90 offen offset:2048 sc1
 MA 112,224,24
 RT 252,46,26112
 RT 254,46,26624
 MA 116,224,28
 CV 156,132,133
 CV 157,134,135
 MA 124,228,28
 WL 4
 RT 200,45,30464
 RT 202,45,30976
 MA 120,228,24
 buffer_load_dwordx4 v6, s[32:35], s70 offen offset:3264 lds
 MA 112,232,32
 RT 204,46,30464
 RT 206,46,30976
 MA 116,232,36
 CV 158,140,141
 CV 159,142,143
 MA 124,236,36
 RT 208,45,34816
 RT 210,45,35328
 MA 120,236,32
 buffer_store_dwordx4 v[156:159], v0, s[36:39], s90 offen offset:3072 sc1
 MA 112,240,40
 RT 212,46,34816
 RT 214,46,35328
 MA 116,240,44
 s_add_u32 m0, m0, 0x1100
 s_add_u32 s70, s84, 0x9000
 MA 124,244,44
 WL 4
 RT 216,45,64
 RT 218,45,576
 MA 120,244,40
 buffer_load_dwordx4 v3, s[32:35], s70 offen lds
 MA 112,248,48
 RT 220,46,64
 RT 222,46,576
 MA 116,248,52
 s_add_u32 s90, s90, 0x1000
 MA 124,252,52
 RT 224,45,4416
 MA 120,252,48
 RT 226,45,4928
 MA 112,200,56
 RT 228,46,4416
 RT 230,46,4928
 MA 116,200,60
 buffer_load_dwordx4 v4, s[32:35], s70 offen offset:1088 lds
 MA 124,204,60
 WL 4
 RT 232,45,8768
 MA 120,204,56
 RT 234,45,9280
 MA 112,208,64
 RT 236,46,8768
 MA 116,208,68
 RT 238,46,9280
 MA 124,212,68
 RT 240,45,13120
 RT 242,45,13632
 MA 120,212,64
 buffer_load_dwordx4 v5, s[32:35], s70 offen offset:2176 lds
 v_mfma_f32_16x16x32_bf16 v[128:131], a[216:219], a[0:3], 0
 RT 244,46,13120
 RT 246,46,13632
 v_mfma_f32_16x16x32_bf16 v[132:135], a[216:219], a[4:7], 0
 CV 144,112,113
 CV 145,114,115
 v_mfma_f32_16x16x32_bf16 v[140:143], a[220:223], a[4:7], 0
 WL 4
 RT 248,45,17472
 RT 250,45,17984
 v_mfma_f32_16x16x32_bf16 v[136:139], a[220:223], a[0:3], 0
 CV 146,120,121
 CV 147,122,123
 MA 128,224,8
 RT 252,46,17472
 RT 254,46,17984
 MA 132,224,12
 buffer_load_dwordx4 v6, s[32:35], s70 offen offset:3264 lds
 MA 140,228,12
 RT 200,45,21824
 RT 202,45,22336
 MA 136,228,8
 buffer_store_dwordx4 v[144:147], v0, s[36:39], s5 offen sc1
 MA 128,232,16
 RT 204,46,21824
 RT 206,46,22336
 MA 132,232,20
 CV 148,116,117
 CV 149,118,119
 MA 140,236,20
 WL 4
 RT 208,45,26176
 RT 210,45,26688
 MA 136,236,16
 s_add_u32 m0, s89, s66
 s_add_u32 s70, s86, 0
 MA 128,240,24
 RT 212,46,26176
 RT 214,46,26688
 MA 132,240,28
 buffer_load_dwordx4 v3, s[32:35], s70 offen lds
 MA 140,244,28
 RT 216,45,30528
 RT 218,45,31040
 MA 136,244,24
 CV 150,124,125
 CV 151,126,127
 MA 128,248,32
 RT 220,46,30528
 RT 222,46,31040
 MA 132,248,36
 buffer_store_dwordx4 v[148:151], v0, s[36:39], s5 offen offset:1024 sc1
 MA 140,252,36
 WL 4
 RT 224,45,34880
 MA 136,252,32
 RT 226,45,35392
 MA 128,200,40
 RT 228,46,34880
 RT 230,46,35392
 MA 132,200,44
 v_add_u32 v45, s4, v44
 v_xor_b32 v46, 32, v45
 MA 140,204,44
 s_waitcnt vmcnt(16)
 s_barrier
 RT 232,45,0
 RT 234,45,512
 MA 136,204,40
 s_mov_b32 s89, s88
 s_mov_b32 s88, s87
 MA 128,208,48
 RT 236,46,0
 RT 238,46,512
 MA 132,208,52
 s_mov_b32 s87, s4
 MA 140,212,52
 WL 4
 RT 240,45,4352
 RT 242,45,4864
 MA 136,212,48
 s_add_u32 m0, s89, s65
 s_add_u32 s70, s83, 0
 MA 128,216,56
 RT 244,46,4352
 RT 246,46,4864
 MA 132,216,60
 buffer_load_dwordx4 v3, s[24:27], s70 offen lds
 MA 140,220,60
 RT 248,45,8704
 MA 136,220,56
 RT 250,45,9216
 MA 128,224,64
 RT 252,46,8704
 MA 132,224,68
 RT 254,46,9216
 MA 140,228,68
 WL 4
 RT 200,45,13056
 RT 202,45,13568
 MA 136,228,64
 buffer_load_dwordx4 v4, s[24:27], s70 offen offset:1088 lds
 v_mfma_f32_16x16x32_bf16 v[112:115], a[232:235], a[72:75], 0
 RT 204,46,13056
 RT 206,46,13568
 v_mfma_f32_16x16x32_bf16 v[116:119], a[232:235], a[76:79], 0
 CV 152,128,129
 CV 153,130,131
 v_mfma_f32_16x16x32_bf16 v[124:127], a[236:239], a[76:79], 0
 RT 208,45,17408
 RT 210,45,17920
 v_mfma_f32_16x16x32_bf16 v[120:123], a[236:239], a[72:75], 0
 CV 154,136,137
 CV 155,138,139
 MA 112,240,88
 RT 212,46,17408
 RT 214,46,17920
 MA 116,240,92
 buffer_load_dwordx4 v5, s[24:27], s70 offen offset:2176 lds
 MA 124,244,92
 WL 4
 RT 216,45,21760
 RT 218,45,22272
 MA 120,244,88
 buffer_store_dwordx4 v[152:155], v0, s[36:39], s5 offen offset:2048 sc1
 MA 112,248,104
 RT 220,46,21760
 RT 222,46,22272
 MA 116,248,108
 CV 156,132,133
 CV 157,134,135
 MA 124,252,108
 RT 224,45,26112
 RT 226,45,26624
 MA 120,252,104
 s_add_u32 s4, s87, 0x9900
 s_cmp_lt_u32 s4, 0x26400
 s_cselect_b32 s4, s4, 0
 MA 112,200,120
 RT 228,46,26112
 RT 230,46,26624
 MA 116,200,124
 buffer_load_dwordx4 v6, s[24:27], s70 offen offset:3264 lds
 MA 124,204,124
 WL 4
 RT 232,45,30464
 RT 234,45,30976
 MA 120,204,120
 CV 158,140,141
 CV 159,142,143
 MA 112,208,80
 RT 236,46,30464
 RT 238,46,30976
 MA 116,208,84
 buffer_store_dwordx4 v[156:159], v0, s[36:39], s5 offen offset:3072 sc1
 MA 124,212,84
 RT 240,45,64
 RT 242,45,576
 MA 120,212,80
 s_add_u32 m0, m0, 0x1100
 s_add_u32 s70, s83, 0x9000
 MA 112,216,96
 RT 244,46,64
 RT 246,46,576
 MA 116,216,100
 buffer_load_dwordx4 v3, s[24:27], s70 offen lds
 MA 124,220,100
 WL 4
 RT 248,45,4416
 RT 250,45,4928
 MA 120,220,96
 s_add_u32 s5, s5, 0x1000
 MA 112,224,112
 RT 252,46,4416
 MA 116,224,116
 RT 254,46,4928
 MA 124,228,116
 RT 200,45,8768
 RT 202,45,9280
 MA 120,228,112
 buffer_load_dwordx4 v4, s[24:27], s70 offen offset:1088 lds
 MA 112,232,128
 RT 204,46,8768
 MA 116,232,132
 RT 206,46,9280
 MA 124,236,132
 WL 4
 RT 208,45,13120
 MA 120,236,128
 RT 210,45,13632
 v_mfma_f32_16x16x32_bf16 v[128:131], a[240:243], a[72:75], 0
 RT 212,46,13120
 RT 214,46,13632
 v_mfma_f32_16x16x32_bf16 v[132:135], a[240:243], a[76:79], 0
 buffer_load_dwordx4 v5, s[24:27], s70 offen offset:2176 lds
 v_mfma_f32_16x16x32_bf16 v[140:143], a[244:247], a[76:79], 0
 RT 216,45,17472
 RT 218,45,17984
 v_mfma_f32_16x16x32_bf16 v[136:139], a[244:247], a[72:75], 0
 CV 144,112,113
 CV 145,114,115
 MA 128,248,88
 RT 220,46,17472
 RT 222,46,17984
 MA 132,248,92
 CV 146,120,121
 CV 147,122,123
 MA 140,252,92
 WL 4
 RT 224,45,21824
 RT 226,45,22336
 MA 136,252,88
 buffer_load_dwordx4 v6, s[24:27], s70 offen offset:3264 lds
 MA 128,200,104
 RT 228,46,21824
 RT 230,46,22336
 MA 132,200,108
 buffer_store_dwordx4 v[144:147], v0, s[36:39], s90 offen sc1
 MA 140,204,108
 RT 232,45,26176
 RT 234,45,26688
 MA 136,204,104
 CV 148,116,117
 CV 149,118,119
 MA 128,208,120
 RT 236,46,26176
 RT 238,46,26688
 MA 132,208,124
 CV 150,124,125
 CV 151,126,127
 MA 140,212,124
 WL 4
 RT 240,45,30528
 RT 242,45,31040
 MA 136,212,120
 buffer_store_dwordx4 v[148:151], v0, s[36:39], s90 offen offset:1024 sc1
 MA 128,216,80
 RT 244,46,30528
 RT 246,46,31040
 MA 132,216,84
 v_add_u32 v45, s4, v44
 v_xor_b32 v46, 32, v45
 MA 140,220,84
 s_mov_b32 s91, 6
.p2align 3
L_M_loop1:
 s_waitcnt vmcnt(13)
 s_barrier
 RT 200,45,0
 RT 202,45,512
 MA 136,220,80
 s_mov_b32 s89, s88
 s_mov_b32 s88, s87
 MA 128,224,96
 RT 204,46,0
 RT 206,46,512
 MA 132,224,100
 s_mov_b32 s87, s4
 MA 140,228,100
 WL 4
 RT 208,45,4352
 RT 210,45,4864
 MA 136,228,96
 v_add_u32 v36, 1, v36
 MA 128,232,112
 RT 212,46,4352
 RT 214,46,4864
 MA 132,232,116
 buffer_store_dword v36, v42, s[36:39], 0 offen sc1
 MA 140,236,116
 RT 216,45,8704
 RT 218,45,9216
 MA 136,236,112
 s_add_u32 s83, s83, 0x80
 s_add_u32 s84, s84, 0x80
 s_add_u32 s86, s86, 0x80
 MA 128,240,128
 RT 220,46,8704
 RT 222,46,9216
 MA 132,240,132
 s_add_u32 m0, s89, s65
 s_add_u32 s70, s84, 0
 MA 140,244,132
 WL 4
 RT 224,45,13056
 RT 226,45,13568
 MA 136,244,128
 buffer_load_dwordx4 v3, s[32:35], s70 offen lds
 v_mfma_f32_16x16x32_bf16 v[112:115], a[200:203], a[0:3], 0
 RT 228,46,13056
 RT 230,46,13568
 v_mfma_f32_16x16x32_bf16 v[116:119], a[200:203], a[4:7], 0
 CV 152,128,129
 CV 153,130,131
 v_mfma_f32_16x16x32_bf16 v[124:127], a[204:207], a[4:7], 0
 RT 232,45,17408
 RT 234,45,17920
 v_mfma_f32_16x16x32_bf16 v[120:123], a[204:207], a[0:3], 0
 CV 154,136,137
 CV 155,138,139
 MA 112,208,8
 RT 236,46,17408
 RT 238,46,17920
 MA 116,208,12
 s_add_u32 s4, s87, 0x9900
 s_cmp_lt_u32 s4, 0x26400
 s_cselect_b32 s4, s4, 0
 MA 124,212,12
 WL 4
 RT 240,45,21760
 RT 242,45,22272
 MA 120,212,8
 buffer_load_dwordx4 v4, s[32:35], s70 offen offset:1088 lds
 MA 112,216,16
 RT 244,46,21760
 RT 246,46,22272
 MA 116,216,20
 buffer_store_dwordx4 v[152:155], v0, s[36:39], s90 offen offset:2048 sc1
 MA 124,220,20
 RT 248,45,26112
 RT 250,45,26624
 MA 120,220,16
 CV 156,132,133
 CV 157,134,135
 MA 112,224,24
 RT 252,46,26112
 RT 254,46,26624
 MA 116,224,28
 buffer_load_dwordx4 v5, s[32:35], s70 offen offset:2176 lds
 MA 124,228,28
 WL 4
 RT 200,45,30464
 RT 202,45,30976
 MA 120,228,24
 CV 158,140,141
 CV 159,142,143
 MA 112,232,32
 RT 204,46,30464
 RT 206,46,30976
 MA 116,232,36
 buffer_store_dwordx4 v[156:159], v0, s[36:39], s90 offen offset:3072 sc1
 MA 124,236,36
 RT 208,45,34816
 RT 210,45,35328
 MA 120,236,32
 buffer_load_dwordx4 v6, s[32:35], s70 offen offset:3264 lds
 MA 112,240,40
 RT 212,46,34816
 RT 214,46,35328
 MA 116,240,44
 s_add_u32 s90, s90, 0x1000
 MA 124,244,44
 WL 4
 RT 216,45,64
 MA 120,244,40
 RT 218,45,576
 MA 112,248,48
 RT 220,46,64
 RT 222,46,576
 MA 116,248,52
 s_add_u32 m0, m0, 0x1100
 s_add_u32 s70, s84, 0x9000
 MA 124,252,52
 RT 224,45,4416
 RT 226,45,4928
 MA 120,252,48
 buffer_load_dwordx4 v3, s[32:35], s70 offen lds
 MA 112,200,56
 RT 228,46,4416
 MA 116,200,60
 RT 230,46,4928
 MA 124,204,60
 WL 4
 RT 232,45,8768
 MA 120,204,56
 RT 234,45,9280
 MA 112,208,64
 RT 236,46,8768
 RT 238,46,9280
 MA 116,208,68
 buffer_load_dwordx4 v4, s[32:35], s70 offen offset:1088 lds
 MA 124,212,68
 RT 240,45,13120
 MA 120,212,64
 RT 242,45,13632
 v_mfma_f32_16x16x32_bf16 v[128:131], a[216:219], a[0:3], 0
 RT 244,46,13120
 RT 246,46,13632
 v_mfma_f32_16x16x32_bf16 v[132:135], a[216:219], a[4:7], 0
 CV 144,112,113
 CV 145,114,115
 v_mfma_f32_16x16x32_bf16 v[140:143], a[220:223], a[4:7], 0
 WL 4
 RT 248,45,17472
 RT 250,45,17984
 v_mfma_f32_16x16x32_bf16 v[136:139], a[220:223], a[0:3], 0
 buffer_load_dwordx4 v5, s[32:35], s70 offen offset:2176 lds
 MA 128,224,8
 RT 252,46,17472
 RT 254,46,17984
 MA 132,224,12
 CV 146,120,121
 CV 147,122,123
 MA 140,228,12
 RT 200,45,21824
 RT 202,45,22336
 MA 136,228,8
 buffer_store_dwordx4 v[144:147], v0, s[36:39], s5 offen sc1
 MA 128,232,16
 RT 204,46,21824
 RT 206,46,22336
 MA 132,232,20
 buffer_load_dwordx4 v6, s[32:35], s70 offen offset:3264 lds
 MA 140,236,20
 WL 4
 RT 208,45,26176
 RT 210,45,26688
 MA 136,236,16
 CV 148,116,117
 CV 149,118,119
 MA 128,240,24
 RT 212,46,26176
 RT 214,46,26688
 MA 132,240,28
 CV 150,124,125
 CV 151,126,127
 MA 140,244,28
 RT 216,45,30528
 RT 218,45,31040
 MA 136,244,24
 s_add_u32 m0, s89, s66
 s_add_u32 s70, s86, 0
 MA 128,248,32
 RT 220,46,30528
 RT 222,46,31040
 MA 132,248,36
 buffer_load_dwordx4 v3, s[32:35], s70 offen lds
 MA 140,252,36
 WL 4
 RT 224,45,34880
 RT 226,45,35392
 MA 136,252,32
 buffer_store_dwordx4 v[148:151], v0, s[36:39], s5 offen offset:1024 sc1
 MA 128,200,40
 RT 228,46,34880
 RT 230,46,35392
 MA 132,200,44
 v_add_u32 v45, s4, v44
 v_xor_b32 v46, 32, v45
 MA 140,204,44
 s_waitcnt vmcnt(16)
 s_barrier
 RT 232,45,0
 RT 234,45,512
 MA 136,204,40
 s_mov_b32 s89, s88
 s_mov_b32 s88, s87
 MA 128,208,48
 RT 236,46,0
 RT 238,46,512
 MA 132,208,52
 s_mov_b32 s87, s4
 MA 140,212,52
 WL 4
 RT 240,45,4352
 RT 242,45,4864
 MA 136,212,48
 s_add_u32 m0, s89, s65
 s_add_u32 s70, s83, 0
 MA 128,216,56
 RT 244,46,4352
 RT 246,46,4864
 MA 132,216,60
 buffer_load_dwordx4 v3, s[24:27], s70 offen lds
 MA 140,220,60
 RT 248,45,8704
 MA 136,220,56
 RT 250,45,9216
 MA 128,224,64
 RT 252,46,8704
 MA 132,224,68
 RT 254,46,9216
 MA 140,228,68
 WL 4
 RT 200,45,13056
 RT 202,45,13568
 MA 136,228,64
 buffer_load_dwordx4 v4, s[24:27], s70 offen offset:1088 lds
 v_mfma_f32_16x16x32_bf16 v[112:115], a[232:235], a[72:75], 0
 RT 204,46,13056
 RT 206,46,13568
 v_mfma_f32_16x16x32_bf16 v[116:119], a[232:235], a[76:79], 0
 CV 152,128,129
 CV 153,130,131
 v_mfma_f32_16x16x32_bf16 v[124:127], a[236:239], a[76:79], 0
 RT 208,45,17408
 RT 210,45,17920
 v_mfma_f32_16x16x32_bf16 v[120:123], a[236:239], a[72:75], 0
 CV 154,136,137
 CV 155,138,139
 MA 112,240,88
 RT 212,46,17408
 RT 214,46,17920
 MA 116,240,92
 buffer_load_dwordx4 v5, s[24:27], s70 offen offset:2176 lds
 MA 124,244,92
 WL 4
 RT 216,45,21760
 RT 218,45,22272
 MA 120,244,88
 buffer_store_dwordx4 v[152:155], v0, s[36:39], s5 offen offset:2048 sc1
 MA 112,248,104
 RT 220,46,21760
 RT 222,46,22272
 MA 116,248,108
 CV 156,132,133
 CV 157,134,135
 MA 124,252,108
 RT 224,45,26112
 RT 226,45,26624
 MA 120,252,104
 s_add_u32 s4, s87, 0x9900
 s_cmp_lt_u32 s4, 0x26400
 s_cselect_b32 s4, s4, 0
 MA 112,200,120
 RT 228,46,26112
 RT 230,46,26624
 MA 116,200,124
 buffer_load_dwordx4 v6, s[24:27], s70 offen offset:3264 lds
 MA 124,204,124
 WL 4
 RT 232,45,30464
 RT 234,45,30976
 MA 120,204,120
 CV 158,140,141
 CV 159,142,143
 MA 112,208,80
 RT 236,46,30464
 RT 238,46,30976
 MA 116,208,84
 buffer_store_dwordx4 v[156:159], v0, s[36:39], s5 offen offset:3072 sc1
 MA 124,212,84
 RT 240,45,64
 RT 242,45,576
 MA 120,212,80
 s_add_u32 m0, m0, 0x1100
 s_add_u32 s70, s83, 0x9000
 MA 112,216,96
 RT 244,46,64
 RT 246,46,576
 MA 116,216,100
 buffer_load_dwordx4 v3, s[24:27], s70 offen lds
 MA 124,220,100
 WL 4
 RT 248,45,4416
 RT 250,45,4928
 MA 120,220,96
 s_add_u32 s5, s5, 0x1000
 MA 112,224,112
 RT 252,46,4416
 MA 116,224,116
 RT 254,46,4928
 MA 124,228,116
 RT 200,45,8768
 RT 202,45,9280
 MA 120,228,112
 buffer_load_dwordx4 v4, s[24:27], s70 offen offset:1088 lds
 MA 112,232,128
 RT 204,46,8768
 MA 116,232,132
 RT 206,46,9280
 MA 124,236,132
 WL 4
 RT 208,45,13120
 MA 120,236,128
 RT 210,45,13632
 v_mfma_f32_16x16x32_bf16 v[128:131], a[240:243], a[72:75], 0
 RT 212,46,13120
 RT 214,46,13632
 v_mfma_f32_16x16x32_bf16 v[132:135], a[240:243], a[76:79], 0
 buffer_load_dwordx4 v5, s[24:27], s70 offen offset:2176 lds
 v_mfma_f32_16x16x32_bf16 v[140:143], a[244:247], a[76:79], 0
 RT 216,45,17472
 RT 218,45,17984
 v_mfma_f32_16x16x32_bf16 v[136:139], a[244:247], a[72:75], 0
 CV 144,112,113
 CV 145,114,115
 MA 128,248,88
 RT 220,46,17472
 RT 222,46,17984
 MA 132,248,92
 CV 146,120,121
 CV 147,122,123
 MA 140,252,92
 WL 4
 RT 224,45,21824
 RT 226,45,22336
 MA 136,252,88
 buffer_load_dwordx4 v6, s[24:27], s70 offen offset:3264 lds
 MA 128,200,104
 RT 228,46,21824
 RT 230,46,22336
 MA 132,200,108
 buffer_store_dwordx4 v[144:147], v0, s[36:39], s90 offen sc1
 MA 140,204,108
 RT 232,45,26176
 RT 234,45,26688
 MA 136,204,104
 CV 148,116,117
 CV 149,118,119
 MA 128,208,120
 RT 236,46,26176
 RT 238,46,26688
 MA 132,208,124
 CV 150,124,125
 CV 151,126,127
 MA 140,212,124
 WL 4
 RT 240,45,30528
 RT 242,45,31040
 MA 136,212,120
 buffer_store_dwordx4 v[148:151], v0, s[36:39], s90 offen offset:1024 sc1
 MA 128,216,80
 RT 244,46,30528
 RT 246,46,31040
 MA 132,216,84
 v_add_u32 v45, s4, v44
 v_xor_b32 v46, 32, v45
 MA 140,220,84
 s_sub_u32 s91, s91, 1
 s_cmp_lg_u32 s91, 0
 s_cbranch_scc1 L_M_loop1
 s_waitcnt vmcnt(13)
 s_barrier
 RT 200,45,0
 RT 202,45,512
 MA 136,220,80
 s_mov_b32 s89, s88
 s_mov_b32 s88, s87
 MA 128,224,96
 RT 204,46,0
 RT 206,46,512
 MA 132,224,100
 s_mov_b32 s87, s4
 MA 140,228,100
 WL 4
 RT 208,45,4352
 RT 210,45,4864
 MA 136,228,96
 v_add_u32 v36, 1, v36
 MA 128,232,112
 RT 212,46,4352
 RT 214,46,4864
 MA 132,232,116
 buffer_store_dword v36, v42, s[36:39], 0 offen sc1
 MA 140,236,116
 RT 216,45,8704
 RT 218,45,9216
 MA 136,236,112
 s_getpc_b64 s[94:95]
L_cp7:
 s_add_u32 s94, s94, L_M_red-L_cp7
 s_addc_u32 s95, s95, 0
 v_bfe_u32 v40, v38, 16, 5
 v_and_b32 v39, 63, v38
 v_min_u32 v39, 3, v39
 v_mad_u32_u24 v39, v40, 4, v39
 v_lshlrev_b32 v39, 7, v39
 v_min_u32 v39, L_roleM_end-L_M_red-4, v39
 MA 128,240,128
 RT 220,46,8704
 RT 222,46,9216
 MA 132,240,132
 global_load_dword v47, v39, s[94:95]
 MA 140,244,132
 WL 4
 RT 224,45,13056
 MA 136,244,128
 RT 226,45,13568
 v_mfma_f32_16x16x32_bf16 v[112:115], a[200:203], a[0:3], 0
 RT 228,46,13056
 RT 230,46,13568
 v_mfma_f32_16x16x32_bf16 v[116:119], a[200:203], a[4:7], 0
 CV 152,128,129
 CV 153,130,131
 v_mfma_f32_16x16x32_bf16 v[124:127], a[204:207], a[4:7], 0
 RT 232,45,17408
 RT 234,45,17920
 v_mfma_f32_16x16x32_bf16 v[120:123], a[204:207], a[0:3], 0
 s_add_u32 s4, s87, 0x9900
 s_cmp_lt_u32 s4, 0x26400
 s_cselect_b32 s4, s4, 0
 MA 112,208,8
 RT 236,46,17408
 RT 238,46,17920
 MA 116,208,12
 CV 154,136,137
 CV 155,138,139
 MA 124,212,12
 WL 4
 RT 240,45,21760
 RT 242,45,22272
 MA 120,212,8
 buffer_store_dwordx4 v[152:155], v0, s[36:39], s90 offen offset:2048 sc1
 MA 112,216,16
 RT 244,46,21760
 RT 246,46,22272
 MA 116,216,20
 CV 156,132,133
 CV 157,134,135
 MA 124,220,20
 RT 248,45,26112
 RT 250,45,26624
 MA 120,220,16
 CV 158,140,141
 CV 159,142,143
 MA 112,224,24
 RT 252,46,26112
 RT 254,46,26624
 MA 116,224,28
 buffer_store_dwordx4 v[156:159], v0, s[36:39], s90 offen offset:3072 sc1
 MA 124,228,28
 WL 4
 RT 200,45,30464
 RT 202,45,30976
 MA 120,228,24
 s_add_u32 s90, s90, 0x1000
 MA 112,232,32
 RT 204,46,30464
 MA 116,232,36
 RT 206,46,30976
 MA 124,236,36
 RT 208,45,34816
 MA 120,236,32
 RT 210,45,35328
 MA 112,240,40
 RT 212,46,34816
 MA 116,240,44
 RT 214,46,35328
 MA 124,244,44
 WL 4
 RT 216,45,64
 MA 120,244,40
 RT 218,45,576
 MA 112,248,48
 RT 220,46,64
 MA 116,248,52
 RT 222,46,576
 MA 124,252,52
 RT 224,45,4416
 MA 120,252,48
 RT 226,45,4928
 MA 112,200,56
 RT 228,46,4416
 MA 116,200,60
 RT 230,46,4928
 MA 124,204,60
 WL 4
 RT 232,45,8768
 MA 120,204,56
 RT 234,45,9280
 MA 112,208,64
 RT 236,46,8768
 MA 116,208,68
 RT 238,46,9280
 MA 124,212,68
 RT 240,45,13120
 MA 120,212,64
 RT 242,45,13632
 v_mfma_f32_16x16x32_bf16 v[128:131], a[216:219], a[0:3], 0
 RT 244,46,13120
 RT 246,46,13632
 v_mfma_f32_16x16x32_bf16 v[132:135], a[216:219], a[4:7], 0
 CV 144,112,113
 CV 145,114,115
 v_mfma_f32_16x16x32_bf16 v[140:143], a[220:223], a[4:7], 0
 WL 4
 RT 248,45,17472
 RT 250,45,17984
 v_mfma_f32_16x16x32_bf16 v[136:139], a[220:223], a[0:3], 0
 CV 146,120,121
 CV 147,122,123
 MA 128,224,8
 RT 252,46,17472
 RT 254,46,17984
 MA 132,224,12
 buffer_store_dwordx4 v[144:147], v0, s[36:39], s5 offen sc1
 MA 140,228,12
 RT 200,45,21824
 RT 202,45,22336
 MA 136,228,8
 CV 148,116,117
 CV 149,118,119
 MA 128,232,16
 RT 204,46,21824
 RT 206,46,22336
 MA 132,232,20
 CV 150,124,125
 CV 151,126,127
 MA 140,236,20
 WL 4
 RT 208,45,26176
 RT 210,45,26688
 MA 136,236,16
 buffer_store_dwordx4 v[148:151], v0, s[36:39], s5 offen offset:1024 sc1
 MA 128,240,24
 RT 212,46,26176
 MA 132,240,28
 RT 214,46,26688
 MA 140,244,28
 RT 216,45,30528
 MA 136,244,24
 RT 218,45,31040
 MA 128,248,32
 RT 220,46,30528
 MA 132,248,36
 RT 222,46,31040
 MA 140,252,36
 WL 4
 RT 224,45,34880
 MA 136,252,32
 RT 226,45,35392
 MA 128,200,40
 RT 228,46,34880
 RT 230,46,35392
 MA 132,200,44
 v_add_u32 v45, s4, v44
 v_xor_b32 v46, 32, v45
 MA 140,204,44
 s_waitcnt vmcnt(8)
 s_barrier
 RT 232,45,0
 RT 234,45,512
 MA 136,204,40
 s_mov_b32 s89, s88
 s_mov_b32 s88, s87
 MA 128,208,48
 RT 236,46,0
 RT 238,46,512
 MA 132,208,52
 s_mov_b32 s87, s4
 MA 140,212,52
 WL 4
 RT 240,45,4352
 RT 242,45,4864
 MA 136,212,48
 buffer_load_dword v16, v30, s[36:39], s76 offen sc1
 MA 128,216,56
 RT 244,46,4352
 MA 132,216,60
 RT 246,46,4864
 MA 140,220,60
 RT 248,45,8704
 MA 136,220,56
 RT 250,45,9216
 MA 128,224,64
 RT 252,46,8704
 MA 132,224,68
 RT 254,46,9216
 MA 140,228,68
 WL 4
 RT 200,45,13056
 MA 136,228,64
 RT 202,45,13568
 v_mfma_f32_16x16x32_bf16 v[112:115], a[232:235], a[72:75], 0
 RT 204,46,13056
 RT 206,46,13568
 v_mfma_f32_16x16x32_bf16 v[116:119], a[232:235], a[76:79], 0
 CV 152,128,129
 CV 153,130,131
 v_mfma_f32_16x16x32_bf16 v[124:127], a[236:239], a[76:79], 0
 RT 208,45,17408
 RT 210,45,17920
 v_mfma_f32_16x16x32_bf16 v[120:123], a[236:239], a[72:75], 0
 CV 154,136,137
 CV 155,138,139
 MA 112,240,88
 RT 212,46,17408
 RT 214,46,17920
 MA 116,240,92
 buffer_store_dwordx4 v[152:155], v0, s[36:39], s5 offen offset:2048 sc1
 MA 124,244,92
 WL 4
 RT 216,45,21760
 RT 218,45,22272
 MA 120,244,88
 CV 156,132,133
 CV 157,134,135
 MA 112,248,104
 RT 220,46,21760
 RT 222,46,22272
 MA 116,248,108
 CV 158,140,141
 CV 159,142,143
 MA 124,252,108
 RT 224,45,26112
 RT 226,45,26624
 MA 120,252,104
 buffer_store_dwordx4 v[156:159], v0, s[36:39], s5 offen offset:3072 sc1
 MA 112,200,120
 RT 228,46,26112
 RT 230,46,26624
 MA 116,200,124
 s_add_u32 s5, s5, 0x1000
 MA 124,204,124
 WL 4
 RT 232,45,30464
 MA 120,204,120
 RT 234,45,30976
 MA 112,208,80
 RT 236,46,30464
 MA 116,208,84
 RT 238,46,30976
 MA 124,212,84
 RT 240,45,64
 MA 120,212,80
 RT 242,45,576
 MA 112,216,96
 RT 244,46,64
 MA 116,216,100
 RT 246,46,576
 MA 124,220,100
 WL 4
 RT 248,45,4416
 MA 120,220,96
 RT 250,45,4928
 MA 112,224,112
 RT 252,46,4416
 MA 116,224,116
 RT 254,46,4928
 MA 124,228,116
 RT 200,45,8768
 MA 120,228,112
 RT 202,45,9280
 MA 112,232,128
 RT 204,46,8768
 MA 116,232,132
 RT 206,46,9280
 MA 124,236,132
 WL 4
 RT 208,45,13120
 MA 120,236,128
 RT 210,45,13632
 v_mfma_f32_16x16x32_bf16 v[128:131], a[240:243], a[72:75], 0
 RT 212,46,13120
 RT 214,46,13632
 v_mfma_f32_16x16x32_bf16 v[132:135], a[240:243], a[76:79], 0
 CV 144,112,113
 CV 145,114,115
 v_mfma_f32_16x16x32_bf16 v[140:143], a[244:247], a[76:79], 0
 RT 216,45,17472
 RT 218,45,17984
 v_mfma_f32_16x16x32_bf16 v[136:139], a[244:247], a[72:75], 0
 CV 146,120,121
 CV 147,122,123
 MA 128,248,88
 RT 220,46,17472
 RT 222,46,17984
 MA 132,248,92
 buffer_store_dwordx4 v[144:147], v0, s[36:39], s90 offen sc1
 MA 140,252,92
 WL 4
 RT 224,45,21824
 RT 226,45,22336
 MA 136,252,88
 CV 148,116,117
 CV 149,118,119
 MA 128,200,104
 RT 228,46,21824
 RT 230,46,22336
 MA 132,200,108
 CV 150,124,125
 CV 151,126,127
 MA 140,204,108
 RT 232,45,26176
 RT 234,45,26688
 MA 136,204,104
 buffer_store_dwordx4 v[148:151], v0, s[36:39], s90 offen offset:1024 sc1
 MA 128,208,120
 RT 236,46,26176
 MA 132,208,124
 RT 238,46,26688
 MA 140,212,124
 WL 4
 RT 240,45,30528
 MA 136,212,120
 RT 242,45,31040
 MA 128,216,80
 RT 244,46,30528
 MA 132,216,84
 RT 246,46,31040
 MA 140,220,84
 MA 136,220,80
 s_nop 0
 MA 128,224,96
 MA 132,224,100
 s_nop 0
 MA 140,228,100
 WL 0
 MA 136,228,96
 s_nop 0
 MA 128,232,112
 MA 132,232,116
 s_nop 0
 MA 140,236,116
 MA 136,236,112
 s_nop 0
 MA 128,240,128
 MA 132,240,132
 s_nop 0
 MA 140,244,132
 MA 136,244,128
 s_nop 0
 s_nop 2
 CV 152,128,129
 CV 153,130,131
 s_nop 1
 CV 154,136,137
 CV 155,138,139
 buffer_store_dwordx4 v[152:155], v0, s[36:39], s90 offen offset:2048 sc1
 CV 156,132,133
 CV 157,134,135
 CV 158,140,141
 CV 159,142,143
 buffer_store_dwordx4 v[156:159], v0, s[36:39], s90 offen offset:3072 sc1
 s_add_u32 s90, s90, 0x1000
 s_mov_b32 s78, 0
 s_mov_b32 s79, 0
 s_mov_b32 s40, 0
 s_mov_b32 s58, 0
 s_mov_b32 s41, 0x26404
 s_nop 1
 s_cmp_eq_u32 s62, 0
 s_cbranch_scc0 L_M_e2
 s_waitcnt vmcnt(6)
 v_readfirstlane_b32 s40, v17
 s_nop 1
 s_cmp_ge_u32 s40, 16
 s_cbranch_scc0 L_M_e1
 v_cmp_ne_u32 vcc, 0, v16
 s_nop 1
 s_lshr_b64 s[72:73], vcc, 18
 s_and_b32 s73, s73, 15
 s_mov_b32 s78, 0
 s_mov_b32 s79, 0
 v_cmp_ge_u32 vcc, 0, v16
 s_nop 1
 s_and_b32 s92, vcc_lo, 0x7ff
 s_cselect_b32 s78, s78, 4
 s_and_b32 s92, vcc_lo, 0x1f800
 s_cselect_b32 s79, s79, 4
 v_cmp_ge_u32 vcc, 1, v16
 s_nop 1
 s_and_b32 s92, vcc_lo, 0x7ff
 s_cselect_b32 s78, s78, 8
 s_and_b32 s92, vcc_lo, 0x1f800
 s_cselect_b32 s79, s79, 8
 v_cmp_ge_u32 vcc, 2, v16
 s_nop 1
 s_and_b32 s92, vcc_lo, 0x7ff
 s_cselect_b32 s78, s78, 12
 s_and_b32 s92, vcc_lo, 0x1f800
 s_cselect_b32 s79, s79, 12
 v_cmp_ge_u32 vcc, 3, v16
 s_nop 1
 s_and_b32 s92, vcc_lo, 0x7ff
 s_cselect_b32 s78, s78, 16
 s_and_b32 s92, vcc_lo, 0x1f800
 s_cselect_b32 s79, s79, 16
 v_cmp_ge_u32 vcc, 4, v16
 s_nop 1
 s_and_b32 s92, vcc_lo, 0x7ff
 s_cselect_b32 s78, s78, 20
 s_and_b32 s92, vcc_lo, 0x1f800
 s_cselect_b32 s79, s79, 20
 v_cmp_ge_u32 vcc, 5, v16
 s_nop 1
 s_and_b32 s92, vcc_lo, 0x7ff
 s_cselect_b32 s78, s78, 24
 s_and_b32 s92, vcc_lo, 0x1f800
 s_cselect_b32 s79, s79, 24
 v_cmp_ge_u32 vcc, 6, v16
 s_nop 1
 s_and_b32 s92, vcc_lo, 0x7ff
 s_cselect_b32 s78, s78, 28
 s_and_b32 s92, vcc_lo, 0x1f800
 s_cselect_b32 s79, s79, 28
 v_cmp_ge_u32 vcc, 7, v16
 s_nop 1
 s_and_b32 s92, vcc_lo, 0x7ff
 s_cselect_b32 s78, s78, 32
 s_and_b32 s92, vcc_lo, 0x1f800
 s_cselect_b32 s79, s79, 32
 v_cmp_ge_u32 vcc, 8, v16
 s_nop 1
 s_and_b32 s92, vcc_lo, 0x7ff
 s_cselect_b32 s78, s78, 36
 s_and_b32 s92, vcc_lo, 0x1f800
 s_cselect_b32 s79, s79, 36
L_M_e1:
 s_lshl_b32 s92, s79, 8
 s_or_b32 s92, s92, s78
 s_lshl_b32 s93, s58, 16
 s_or_b32 s92, s92, s93
 v_mov_b32 v24, s92
 v_mov_b32 v23, 0x26400
 ds_write_b32 v23, v24
 WL 0
L_M_e2:
 s_waitcnt vmcnt(0)
 s_barrier
 v_mov_b32 v36, 9
 buffer_store_dword v36, v42, s[36:39], 0 offen sc1
 s_call_b64 s[56:57], L_M_red
 s_endpgm
.p2align 2
L_M_slow0:
 s_nop 7
 s_nop 7
 v_lshrrev_b32 v202, 4, v0
 v_and_b32 v203, 15, v202
 v_lshrrev_b32 v202, 4, v202
 v_lshlrev_b32 v200, 8, v203
 v_lshl_add_u32 v200, v202, 4, v200
 v_lshlrev_b32 v201, 1, v203
 v_lshl_add_u32 v201, v202, 10, v201
 s_mov_b32 s98, s40
 v_mov_b32 v204, 0xff800000
 v_mov_b32 v205, 0xff800000
 s_mov_b32 s99, 0
L_M_slow0_a:
 s_add_u32 s97, s98, s99
 buffer_load_dwordx4 v[184:187], v200, s[12:15], s97 offen
 buffer_load_dwordx4 v[188:191], v200, s[12:15], s97 offen offset:64
 buffer_load_dwordx4 v[192:195], v200, s[12:15], s97 offen offset:128
 buffer_load_dwordx4 v[196:199], v200, s[12:15], s97 offen offset:192
 s_waitcnt vmcnt(0)
 v_mfma_f32_16x16x32_bf16 v[160:163], v[184:187], a[136:139], 0
 v_mfma_f32_16x16x32_bf16 v[164:167], v[184:187], a[140:143], 0
 v_mfma_f32_16x16x32_bf16 v[160:163], v[188:191], a[144:147], v[160:163]
 v_mfma_f32_16x16x32_bf16 v[164:167], v[188:191], a[148:151], v[164:167]
 v_mfma_f32_16x16x32_bf16 v[160:163], v[192:195], a[152:155], v[160:163]
 v_mfma_f32_16x16x32_bf16 v[164:167], v[192:195], a[156:159], v[164:167]
 v_mfma_f32_16x16x32_bf16 v[160:163], v[196:199], a[160:163], v[160:163]
 v_mfma_f32_16x16x32_bf16 v[164:167], v[196:199], a[164:167], v[164:167]
 s_nop 7
 s_nop 3
 s_add_u32 s97, s97, 0x1000
 buffer_load_dwordx4 v[184:187], v200, s[12:15], s97 offen
 buffer_load_dwordx4 v[188:191], v200, s[12:15], s97 offen offset:64
 buffer_load_dwordx4 v[192:195], v200, s[12:15], s97 offen offset:128
 buffer_load_dwordx4 v[196:199], v200, s[12:15], s97 offen offset:192
 s_waitcnt vmcnt(0)
 v_mfma_f32_16x16x32_bf16 v[168:171], v[184:187], a[136:139], 0
 v_mfma_f32_16x16x32_bf16 v[172:175], v[184:187], a[140:143], 0
 v_mfma_f32_16x16x32_bf16 v[168:171], v[188:191], a[144:147], v[168:171]
 v_mfma_f32_16x16x32_bf16 v[172:175], v[188:191], a[148:151], v[172:175]
 v_mfma_f32_16x16x32_bf16 v[168:171], v[192:195], a[152:155], v[168:171]
 v_mfma_f32_16x16x32_bf16 v[172:175], v[192:195], a[156:159], v[172:175]
 v_mfma_f32_16x16x32_bf16 v[168:171], v[196:199], a[160:163], v[168:171]
 v_mfma_f32_16x16x32_bf16 v[172:175], v[196:199], a[164:167], v[172:175]
 s_nop 7
 s_nop 3
 v_max3_f32 v204, v204, v160, v161
 v_max3_f32 v204, v204, v162, v163
 v_max3_f32 v205, v205, v164, v165
 v_max3_f32 v205, v205, v166, v167
 v_max3_f32 v204, v204, v168, v169
 v_max3_f32 v204, v204, v170, v171
 v_max3_f32 v205, v205, v172, v173
 v_max3_f32 v205, v205, v174, v175
 s_add_u32 s99, s99, 0x2000
 s_cmp_lt_u32 s99, 0x20000
 s_cbranch_scc1 L_M_slow0_a
 v_mov_b32 v202, v204
 s_nop 1
 v_permlane16_swap_b32 v204, v202
 v_max_f32 v204, v204, v202
 v_mov_b32 v202, v204
 s_nop 1
 v_permlane32_swap_b32 v204, v202
 v_max_f32 v204, v204, v202
 v_mov_b32 v202, v205
 s_nop 1
 v_permlane16_swap_b32 v205, v202
 v_max_f32 v205, v205, v202
 v_mov_b32 v202, v205
 s_nop 1
 v_permlane32_swap_b32 v205, v202
 v_max_f32 v205, v205, v202
 v_mov_b32 v48, 0
 v_mov_b32 v49, 0
 v_mov_b32 v50, 0
 v_mov_b32 v51, 0
 v_mov_b32 v52, 0
 v_mov_b32 v53, 0
 v_mov_b32 v54, 0
 v_mov_b32 v55, 0
 v_mov_b32 v56, 0
 v_mov_b32 v57, 0
 v_mov_b32 v58, 0
 v_mov_b32 v59, 0
 v_mov_b32 v60, 0
 v_mov_b32 v61, 0
 v_mov_b32 v62, 0
 v_mov_b32 v63, 0
 v_mov_b32 v64, 0
 v_mov_b32 v65, 0
 v_mov_b32 v66, 0
 v_mov_b32 v67, 0
 v_mov_b32 v68, 0
 v_mov_b32 v69, 0
 v_mov_b32 v70, 0
 v_mov_b32 v71, 0
 v_mov_b32 v72, 0
 v_mov_b32 v73, 0
 v_mov_b32 v74, 0
 v_mov_b32 v75, 0
 v_mov_b32 v76, 0
 v_mov_b32 v77, 0
 v_mov_b32 v78, 0
 v_mov_b32 v79, 0
 v_mov_b32 v80, 0
 v_mov_b32 v81, 0
 v_mov_b32 v82, 0
 v_mov_b32 v83, 0
 v_mov_b32 v84, 0
 v_mov_b32 v85, 0
 v_mov_b32 v86, 0
 v_mov_b32 v87, 0
 v_mov_b32 v88, 0
 v_mov_b32 v89, 0
 v_mov_b32 v90, 0
 v_mov_b32 v91, 0
 v_mov_b32 v92, 0
 v_mov_b32 v93, 0
 v_mov_b32 v94, 0
 v_mov_b32 v95, 0
 v_mov_b32 v96, 0
 v_mov_b32 v97, 0
 v_mov_b32 v98, 0
 v_mov_b32 v99, 0
 v_mov_b32 v100, 0
 v_mov_b32 v101, 0
 v_mov_b32 v102, 0
 v_mov_b32 v103, 0
 v_mov_b32 v104, 0
 v_mov_b32 v105, 0
 v_mov_b32 v106, 0
 v_mov_b32 v107, 0
 v_mov_b32 v108, 0
 v_mov_b32 v109, 0
 v_mov_b32 v110, 0
 v_mov_b32 v111, 0
 v_mov_b32 v206, 0
 v_mov_b32 v207, 0
 s_mov_b32 s99, 0
L_M_slow0_b:
 s_add_u32 s97, s98, s99
 buffer_load_dwordx4 v[184:187], v200, s[12:15], s97 offen
 buffer_load_dwordx4 v[188:191], v200, s[12:15], s97 offen offset:64
 buffer_load_dwordx4 v[192:195], v200, s[12:15], s97 offen offset:128
 buffer_load_dwordx4 v[196:199], v200, s[12:15], s97 offen offset:192
 s_waitcnt vmcnt(0)
 v_mfma_f32_16x16x32_bf16 v[160:163], v[184:187], a[136:139], 0
 v_mfma_f32_16x16x32_bf16 v[164:167], v[184:187], a[140:143], 0
 v_mfma_f32_16x16x32_bf16 v[160:163], v[188:191], a[144:147], v[160:163]
 v_mfma_f32_16x16x32_bf16 v[164:167], v[188:191], a[148:151], v[164:167]
 v_mfma_f32_16x16x32_bf16 v[160:163], v[192:195], a[152:155], v[160:163]
 v_mfma_f32_16x16x32_bf16 v[164:167], v[192:195], a[156:159], v[164:167]
 v_mfma_f32_16x16x32_bf16 v[160:163], v[196:199], a[160:163], v[160:163]
 v_mfma_f32_16x16x32_bf16 v[164:167], v[196:199], a[164:167], v[164:167]
 s_nop 7
 s_nop 3
 s_add_u32 s97, s97, 0x1000
 buffer_load_dwordx4 v[184:187], v200, s[12:15], s97 offen
 buffer_load_dwordx4 v[188:191], v200, s[12:15], s97 offen offset:64
 buffer_load_dwordx4 v[192:195], v200, s[12:15], s97 offen offset:128
 buffer_load_dwordx4 v[196:199], v200, s[12:15], s97 offen offset:192
 s_waitcnt vmcnt(0)
 v_mfma_f32_16x16x32_bf16 v[168:171], v[184:187], a[136:139], 0
 v_mfma_f32_16x16x32_bf16 v[172:175], v[184:187], a[140:143], 0
 v_mfma_f32_16x16x32_bf16 v[168:171], v[188:191], a[144:147], v[168:171]
 v_mfma_f32_16x16x32_bf16 v[172:175], v[188:191], a[148:151], v[172:175]
 v_mfma_f32_16x16x32_bf16 v[168:171], v[192:195], a[152:155], v[168:171]
 v_mfma_f32_16x16x32_bf16 v[172:175], v[192:195], a[156:159], v[172:175]
 v_mfma_f32_16x16x32_bf16 v[168:171], v[196:199], a[160:163], v[168:171]
 v_mfma_f32_16x16x32_bf16 v[172:175], v[196:199], a[164:167], v[172:175]
 s_nop 7
 s_nop 3
 v_sub_f32 v160, v160, v204
 v_sub_f32 v161, v161, v204
 v_sub_f32 v162, v162, v204
 v_sub_f32 v163, v163, v204
 v_sub_f32 v164, v164, v205
 v_sub_f32 v165, v165, v205
 v_sub_f32 v166, v166, v205
 v_sub_f32 v167, v167, v205
 v_sub_f32 v168, v168, v204
 v_sub_f32 v169, v169, v204
 v_sub_f32 v170, v170, v204
 v_sub_f32 v171, v171, v204
 v_sub_f32 v172, v172, v205
 v_sub_f32 v173, v173, v205
 v_sub_f32 v174, v174, v205
 v_sub_f32 v175, v175, v205
 EX 160,160
 EX 161,161
 EX 162,162
 EX 163,163
 EX 164,164
 EX 165,165
 EX 166,166
 EX 167,167
 EX 168,168
 EX 169,169
 EX 170,170
 EX 171,171
 EX 172,172
 EX 173,173
 EX 174,174
 EX 175,175
 AD 206,206,160
 AD 206,206,161
 AD 206,206,162
 AD 206,206,163
 AD 207,207,164
 AD 207,207,165
 AD 207,207,166
 AD 207,207,167
 AD 206,206,168
 AD 206,206,169
 AD 206,206,170
 AD 206,206,171
 AD 207,207,172
 AD 207,207,173
 AD 207,207,174
 AD 207,207,175
 CV 176,160,161
 CV 177,162,163
 CV 178,168,169
 CV 179,170,171
 CV 180,164,165
 CV 181,166,167
 CV 182,172,173
 CV 183,174,175
 s_add_u32 s97, s98, s99
 buffer_load_ushort v184, v201, s[16:19], s97 offen
 buffer_load_ushort v192, v201, s[16:19], s97 offen offset:256
 buffer_load_ushort v185, v201, s[16:19], s97 offen offset:512
 buffer_load_ushort v193, v201, s[16:19], s97 offen offset:768
 buffer_load_ushort v188, v201, s[16:19], s97 offen offset:32
 buffer_load_ushort v196, v201, s[16:19], s97 offen offset:288
 buffer_load_ushort v189, v201, s[16:19], s97 offen offset:544
 buffer_load_ushort v197, v201, s[16:19], s97 offen offset:800
 s_add_u32 s97, s97, 0x1000
 buffer_load_ushort v186, v201, s[16:19], s97 offen
 buffer_load_ushort v194, v201, s[16:19], s97 offen offset:256
 buffer_load_ushort v187, v201, s[16:19], s97 offen offset:512
 buffer_load_ushort v195, v201, s[16:19], s97 offen offset:768
 buffer_load_ushort v190, v201, s[16:19], s97 offen offset:32
 buffer_load_ushort v198, v201, s[16:19], s97 offen offset:288
 buffer_load_ushort v191, v201, s[16:19], s97 offen offset:544
 buffer_load_ushort v199, v201, s[16:19], s97 offen offset:800
 s_waitcnt vmcnt(0)
 v_lshl_or_b32 v184, v192, 16, v184
 v_lshl_or_b32 v185, v193, 16, v185
 v_lshl_or_b32 v186, v194, 16, v186
 v_lshl_or_b32 v187, v195, 16, v187
 v_lshl_or_b32 v188, v196, 16, v188
 v_lshl_or_b32 v189, v197, 16, v189
 v_lshl_or_b32 v190, v198, 16, v190
 v_lshl_or_b32 v191, v199, 16, v191
 v_mfma_f32_16x16x32_bf16 v[48:51], v[184:187], v[176:179], v[48:51]
 v_mfma_f32_16x16x32_bf16 v[52:55], v[184:187], v[180:183], v[52:55]
 v_mfma_f32_16x16x32_bf16 v[56:59], v[188:191], v[176:179], v[56:59]
 v_mfma_f32_16x16x32_bf16 v[60:63], v[188:191], v[180:183], v[60:63]
 s_nop 7
 s_add_u32 s97, s98, s99
 buffer_load_ushort v184, v201, s[16:19], s97 offen offset:64
 buffer_load_ushort v192, v201, s[16:19], s97 offen offset:320
 buffer_load_ushort v185, v201, s[16:19], s97 offen offset:576
 buffer_load_ushort v193, v201, s[16:19], s97 offen offset:832
 buffer_load_ushort v188, v201, s[16:19], s97 offen offset:96
 buffer_load_ushort v196, v201, s[16:19], s97 offen offset:352
 buffer_load_ushort v189, v201, s[16:19], s97 offen offset:608
 buffer_load_ushort v197, v201, s[16:19], s97 offen offset:864
 s_add_u32 s97, s97, 0x1000
 buffer_load_ushort v186, v201, s[16:19], s97 offen offset:64
 buffer_load_ushort v194, v201, s[16:19], s97 offen offset:320
 buffer_load_ushort v187, v201, s[16:19], s97 offen offset:576
 buffer_load_ushort v195, v201, s[16:19], s97 offen offset:832
 buffer_load_ushort v190, v201, s[16:19], s97 offen offset:96
 buffer_load_ushort v198, v201, s[16:19], s97 offen offset:352
 buffer_load_ushort v191, v201, s[16:19], s97 offen offset:608
 buffer_load_ushort v199, v201, s[16:19], s97 offen offset:864
 s_waitcnt vmcnt(0)
 v_lshl_or_b32 v184, v192, 16, v184
 v_lshl_or_b32 v185, v193, 16, v185
 v_lshl_or_b32 v186, v194, 16, v186
 v_lshl_or_b32 v187, v195, 16, v187
 v_lshl_or_b32 v188, v196, 16, v188
 v_lshl_or_b32 v189, v197, 16, v189
 v_lshl_or_b32 v190, v198, 16, v190
 v_lshl_or_b32 v191, v199, 16, v191
 v_mfma_f32_16x16x32_bf16 v[64:67], v[184:187], v[176:179], v[64:67]
 v_mfma_f32_16x16x32_bf16 v[68:71], v[184:187], v[180:183], v[68:71]
 v_mfma_f32_16x16x32_bf16 v[72:75], v[188:191], v[176:179], v[72:75]
 v_mfma_f32_16x16x32_bf16 v[76:79], v[188:191], v[180:183], v[76:79]
 s_nop 7
 s_add_u32 s97, s98, s99
 buffer_load_ushort v184, v201, s[16:19], s97 offen offset:128
 buffer_load_ushort v192, v201, s[16:19], s97 offen offset:384
 buffer_load_ushort v185, v201, s[16:19], s97 offen offset:640
 buffer_load_ushort v193, v201, s[16:19], s97 offen offset:896
 buffer_load_ushort v188, v201, s[16:19], s97 offen offset:160
 buffer_load_ushort v196, v201, s[16:19], s97 offen offset:416
 buffer_load_ushort v189, v201, s[16:19], s97 offen offset:672
 buffer_load_ushort v197, v201, s[16:19], s97 offen offset:928
 s_add_u32 s97, s97, 0x1000
 buffer_load_ushort v186, v201, s[16:19], s97 offen offset:128
 buffer_load_ushort v194, v201, s[16:19], s97 offen offset:384
 buffer_load_ushort v187, v201, s[16:19], s97 offen offset:640
 buffer_load_ushort v195, v201, s[16:19], s97 offen offset:896
 buffer_load_ushort v190, v201, s[16:19], s97 offen offset:160
 buffer_load_ushort v198, v201, s[16:19], s97 offen offset:416
 buffer_load_ushort v191, v201, s[16:19], s97 offen offset:672
 buffer_load_ushort v199, v201, s[16:19], s97 offen offset:928
 s_waitcnt vmcnt(0)
 v_lshl_or_b32 v184, v192, 16, v184
 v_lshl_or_b32 v185, v193, 16, v185
 v_lshl_or_b32 v186, v194, 16, v186
 v_lshl_or_b32 v187, v195, 16, v187
 v_lshl_or_b32 v188, v196, 16, v188
 v_lshl_or_b32 v189, v197, 16, v189
 v_lshl_or_b32 v190, v198, 16, v190
 v_lshl_or_b32 v191, v199, 16, v191
 v_mfma_f32_16x16x32_bf16 v[80:83], v[184:187], v[176:179], v[80:83]
 v_mfma_f32_16x16x32_bf16 v[84:87], v[184:187], v[180:183], v[84:87]
 v_mfma_f32_16x16x32_bf16 v[88:91], v[188:191], v[176:179], v[88:91]
 v_mfma_f32_16x16x32_bf16 v[92:95], v[188:191], v[180:183], v[92:95]
 s_nop 7
 s_add_u32 s97, s98, s99
 buffer_load_ushort v184, v201, s[16:19], s97 offen offset:192
 buffer_load_ushort v192, v201, s[16:19], s97 offen offset:448
 buffer_load_ushort v185, v201, s[16:19], s97 offen offset:704
 buffer_load_ushort v193, v201, s[16:19], s97 offen offset:960
 buffer_load_ushort v188, v201, s[16:19], s97 offen offset:224
 buffer_load_ushort v196, v201, s[16:19], s97 offen offset:480
 buffer_load_ushort v189, v201, s[16:19], s97 offen offset:736
 buffer_load_ushort v197, v201, s[16:19], s97 offen offset:992
 s_add_u32 s97, s97, 0x1000
 buffer_load_ushort v186, v201, s[16:19], s97 offen offset:192
 buffer_load_ushort v194, v201, s[16:19], s97 offen offset:448
 buffer_load_ushort v187, v201, s[16:19], s97 offen offset:704
 buffer_load_ushort v195, v201, s[16:19], s97 offen offset:960
 buffer_load_ushort v190, v201, s[16:19], s97 offen offset:224
 buffer_load_ushort v198, v201, s[16:19], s97 offen offset:480
 buffer_load_ushort v191, v201, s[16:19], s97 offen offset:736
 buffer_load_ushort v199, v201, s[16:19], s97 offen offset:992
 s_waitcnt vmcnt(0)
 v_lshl_or_b32 v184, v192, 16, v184
 v_lshl_or_b32 v185, v193, 16, v185
 v_lshl_or_b32 v186, v194, 16, v186
 v_lshl_or_b32 v187, v195, 16, v187
 v_lshl_or_b32 v188, v196, 16, v188
 v_lshl_or_b32 v189, v197, 16, v189
 v_lshl_or_b32 v190, v198, 16, v190
 v_lshl_or_b32 v191, v199, 16, v191
 v_mfma_f32_16x16x32_bf16 v[96:99], v[184:187], v[176:179], v[96:99]
 v_mfma_f32_16x16x32_bf16 v[100:103], v[184:187], v[180:183], v[100:103]
 v_mfma_f32_16x16x32_bf16 v[104:107], v[188:191], v[176:179], v[104:107]
 v_mfma_f32_16x16x32_bf16 v[108:111], v[188:191], v[180:183], v[108:111]
 s_nop 7
 s_add_u32 s99, s99, 0x2000
 s_cmp_lt_u32 s99, 0x20000
 s_cbranch_scc1 L_M_slow0_b
 s_nop 7
 s_nop 3
 v_mov_b32 v202, v206
 s_nop 1
 v_permlane16_swap_b32 v206, v202
 AD 206,206,202
 v_mov_b32 v202, v206
 s_nop 1
 v_permlane32_swap_b32 v206, v202
 AD 206,206,202
 v_mov_b32 v202, v207
 s_nop 1
 v_permlane16_swap_b32 v207, v202
 AD 207,207,202
 v_mov_b32 v202, v207
 s_nop 1
 v_permlane32_swap_b32 v207, v202
 AD 207,207,202
 v_rcp_f32 v206, v206
 v_rcp_f32 v207, v207
 ML 48,48,206
 ML 49,49,206
 ML 50,50,206
 ML 51,51,206
 ML 52,52,207
 ML 53,53,207
 ML 54,54,207
 ML 55,55,207
 ML 56,56,206
 ML 57,57,206
 ML 58,58,206
 ML 59,59,206
 ML 60,60,207
 ML 61,61,207
 ML 62,62,207
 ML 63,63,207
 ML 64,64,206
 ML 65,65,206
 ML 66,66,206
 ML 67,67,206
 ML 68,68,207
 ML 69,69,207
 ML 70,70,207
 ML 71,71,207
 ML 72,72,206
 ML 73,73,206
 ML 74,74,206
 ML 75,75,206
 ML 76,76,207
 ML 77,77,207
 ML 78,78,207
 ML 79,79,207
 ML 80,80,206
 ML 81,81,206
 ML 82,82,206
 ML 83,83,206
 ML 84,84,207
 ML 85,85,207
 ML 86,86,207
 ML 87,87,207
 ML 88,88,206
 ML 89,89,206
 ML 90,90,206
 ML 91,91,206
 ML 92,92,207
 ML 93,93,207
 ML 94,94,207
 ML 95,95,207
 ML 96,96,206
 ML 97,97,206
 ML 98,98,206
 ML 99,99,206
 ML 100,100,207
 ML 101,101,207
 ML 102,102,207
 ML 103,103,207
 ML 104,104,206
 ML 105,105,206
 ML 106,106,206
 ML 107,107,206
 ML 108,108,207
 ML 109,109,207
 ML 110,110,207
 ML 111,111,207
 CV 48,48,49
 AW 72,48
 CV 50,50,51
 AW 73,50
 CV 56,56,57
 AW 74,56
 CV 58,58,59
 AW 75,58
 CV 52,52,53
 AW 76,52
 CV 54,54,55
 AW 77,54
 CV 60,60,61
 AW 78,60
 CV 62,62,63
 AW 79,62
 CV 64,64,65
 AW 88,64
 CV 66,66,67
 AW 89,66
 CV 72,72,73
 AW 90,72
 CV 74,74,75
 AW 91,74
 CV 68,68,69
 AW 92,68
 CV 70,70,71
 AW 93,70
 CV 76,76,77
 AW 94,76
 CV 78,78,79
 AW 95,78
 CV 80,80,81
 AW 104,80
 CV 82,82,83
 AW 105,82
 CV 88,88,89
 AW 106,88
 CV 90,90,91
 AW 107,90
 CV 84,84,85
 AW 108,84
 CV 86,86,87
 AW 109,86
 CV 92,92,93
 AW 110,92
 CV 94,94,95
 AW 111,94
 CV 96,96,97
 AW 120,96
 CV 98,98,99
 AW 121,98
 CV 104,104,105
 AW 122,104
 CV 106,106,107
 AW 123,106
 CV 100,100,101
 AW 124,100
 CV 102,102,103
 AW 125,102
 CV 108,108,109
 AW 126,108
 CV 110,110,111
 AW 127,110
 s_nop 1
 s_setpc_b64 s[56:57]
.p2align 2
L_M_slow1:
 s_nop 7
 s_nop 7
 v_lshrrev_b32 v202, 4, v0
 v_and_b32 v203, 15, v202
 v_lshrrev_b32 v202, 4, v202
 v_lshlrev_b32 v200, 8, v203
 v_lshl_add_u32 v200, v202, 4, v200
 v_lshlrev_b32 v201, 1, v203
 v_lshl_add_u32 v201, v202, 10, v201
 s_mov_b32 s98, s40
 v_mov_b32 v204, 0xff800000
 v_mov_b32 v205, 0xff800000
 s_mov_b32 s99, 0
L_M_slow1_a:
 s_add_u32 s97, s98, s99
 buffer_load_dwordx4 v[184:187], v200, s[12:15], s97 offen
 buffer_load_dwordx4 v[188:191], v200, s[12:15], s97 offen offset:64
 buffer_load_dwordx4 v[192:195], v200, s[12:15], s97 offen offset:128
 buffer_load_dwordx4 v[196:199], v200, s[12:15], s97 offen offset:192
 s_waitcnt vmcnt(0)
 v_mfma_f32_16x16x32_bf16 v[160:163], v[184:187], a[168:171], 0
 v_mfma_f32_16x16x32_bf16 v[164:167], v[184:187], a[172:175], 0
 v_mfma_f32_16x16x32_bf16 v[160:163], v[188:191], a[176:179], v[160:163]
 v_mfma_f32_16x16x32_bf16 v[164:167], v[188:191], a[180:183], v[164:167]
 v_mfma_f32_16x16x32_bf16 v[160:163], v[192:195], a[184:187], v[160:163]
 v_mfma_f32_16x16x32_bf16 v[164:167], v[192:195], a[188:191], v[164:167]
 v_mfma_f32_16x16x32_bf16 v[160:163], v[196:199], a[192:195], v[160:163]
 v_mfma_f32_16x16x32_bf16 v[164:167], v[196:199], a[196:199], v[164:167]
 s_nop 7
 s_nop 3
 s_add_u32 s97, s97, 0x1000
 buffer_load_dwordx4 v[184:187], v200, s[12:15], s97 offen
 buffer_load_dwordx4 v[188:191], v200, s[12:15], s97 offen offset:64
 buffer_load_dwordx4 v[192:195], v200, s[12:15], s97 offen offset:128
 buffer_load_dwordx4 v[196:199], v200, s[12:15], s97 offen offset:192
 s_waitcnt vmcnt(0)
 v_mfma_f32_16x16x32_bf16 v[168:171], v[184:187], a[168:171], 0
 v_mfma_f32_16x16x32_bf16 v[172:175], v[184:187], a[172:175], 0
 v_mfma_f32_16x16x32_bf16 v[168:171], v[188:191], a[176:179], v[168:171]
 v_mfma_f32_16x16x32_bf16 v[172:175], v[188:191], a[180:183], v[172:175]
 v_mfma_f32_16x16x32_bf16 v[168:171], v[192:195], a[184:187], v[168:171]
 v_mfma_f32_16x16x32_bf16 v[172:175], v[192:195], a[188:191], v[172:175]
 v_mfma_f32_16x16x32_bf16 v[168:171], v[196:199], a[192:195], v[168:171]
 v_mfma_f32_16x16x32_bf16 v[172:175], v[196:199], a[196:199], v[172:175]
 s_nop 7
 s_nop 3
 v_max3_f32 v204, v204, v160, v161
 v_max3_f32 v204, v204, v162, v163
 v_max3_f32 v205, v205, v164, v165
 v_max3_f32 v205, v205, v166, v167
 v_max3_f32 v204, v204, v168, v169
 v_max3_f32 v204, v204, v170, v171
 v_max3_f32 v205, v205, v172, v173
 v_max3_f32 v205, v205, v174, v175
 s_add_u32 s99, s99, 0x2000
 s_cmp_lt_u32 s99, 0x20000
 s_cbranch_scc1 L_M_slow1_a
 v_mov_b32 v202, v204
 s_nop 1
 v_permlane16_swap_b32 v204, v202
 v_max_f32 v204, v204, v202
 v_mov_b32 v202, v204
 s_nop 1
 v_permlane32_swap_b32 v204, v202
 v_max_f32 v204, v204, v202
 v_mov_b32 v202, v205
 s_nop 1
 v_permlane16_swap_b32 v205, v202
 v_max_f32 v205, v205, v202
 v_mov_b32 v202, v205
 s_nop 1
 v_permlane32_swap_b32 v205, v202
 v_max_f32 v205, v205, v202
 v_mov_b32 v48, 0
 v_mov_b32 v49, 0
 v_mov_b32 v50, 0
 v_mov_b32 v51, 0
 v_mov_b32 v52, 0
 v_mov_b32 v53, 0
 v_mov_b32 v54, 0
 v_mov_b32 v55, 0
 v_mov_b32 v56, 0
 v_mov_b32 v57, 0
 v_mov_b32 v58, 0
 v_mov_b32 v59, 0
 v_mov_b32 v60, 0
 v_mov_b32 v61, 0
 v_mov_b32 v62, 0
 v_mov_b32 v63, 0
 v_mov_b32 v64, 0
 v_mov_b32 v65, 0
 v_mov_b32 v66, 0
 v_mov_b32 v67, 0
 v_mov_b32 v68, 0
 v_mov_b32 v69, 0
 v_mov_b32 v70, 0
 v_mov_b32 v71, 0
 v_mov_b32 v72, 0
 v_mov_b32 v73, 0
 v_mov_b32 v74, 0
 v_mov_b32 v75, 0
 v_mov_b32 v76, 0
 v_mov_b32 v77, 0
 v_mov_b32 v78, 0
 v_mov_b32 v79, 0
 v_mov_b32 v80, 0
 v_mov_b32 v81, 0
 v_mov_b32 v82, 0
 v_mov_b32 v83, 0
 v_mov_b32 v84, 0
 v_mov_b32 v85, 0
 v_mov_b32 v86, 0
 v_mov_b32 v87, 0
 v_mov_b32 v88, 0
 v_mov_b32 v89, 0
 v_mov_b32 v90, 0
 v_mov_b32 v91, 0
 v_mov_b32 v92, 0
 v_mov_b32 v93, 0
 v_mov_b32 v94, 0
 v_mov_b32 v95, 0
 v_mov_b32 v96, 0
 v_mov_b32 v97, 0
 v_mov_b32 v98, 0
 v_mov_b32 v99, 0
 v_mov_b32 v100, 0
 v_mov_b32 v101, 0
 v_mov_b32 v102, 0
 v_mov_b32 v103, 0
 v_mov_b32 v104, 0
 v_mov_b32 v105, 0
 v_mov_b32 v106, 0
 v_mov_b32 v107, 0
 v_mov_b32 v108, 0
 v_mov_b32 v109, 0
 v_mov_b32 v110, 0
 v_mov_b32 v111, 0
 v_mov_b32 v206, 0
 v_mov_b32 v207, 0
 s_mov_b32 s99, 0
L_M_slow1_b:
 s_add_u32 s97, s98, s99
 buffer_load_dwordx4 v[184:187], v200, s[12:15], s97 offen
 buffer_load_dwordx4 v[188:191], v200, s[12:15], s97 offen offset:64
 buffer_load_dwordx4 v[192:195], v200, s[12:15], s97 offen offset:128
 buffer_load_dwordx4 v[196:199], v200, s[12:15], s97 offen offset:192
 s_waitcnt vmcnt(0)
 v_mfma_f32_16x16x32_bf16 v[160:163], v[184:187], a[168:171], 0
 v_mfma_f32_16x16x32_bf16 v[164:167], v[184:187], a[172:175], 0
 v_mfma_f32_16x16x32_bf16 v[160:163], v[188:191], a[176:179], v[160:163]
 v_mfma_f32_16x16x32_bf16 v[164:167], v[188:191], a[180:183], v[164:167]
 v_mfma_f32_16x16x32_bf16 v[160:163], v[192:195], a[184:187], v[160:163]
 v_mfma_f32_16x16x32_bf16 v[164:167], v[192:195], a[188:191], v[164:167]
 v_mfma_f32_16x16x32_bf16 v[160:163], v[196:199], a[192:195], v[160:163]
 v_mfma_f32_16x16x32_bf16 v[164:167], v[196:199], a[196:199], v[164:167]
 s_nop 7
 s_nop 3
 s_add_u32 s97, s97, 0x1000
 buffer_load_dwordx4 v[184:187], v200, s[12:15], s97 offen
 buffer_load_dwordx4 v[188:191], v200, s[12:15], s97 offen offset:64
 buffer_load_dwordx4 v[192:195], v200, s[12:15], s97 offen offset:128
 buffer_load_dwordx4 v[196:199], v200, s[12:15], s97 offen offset:192
 s_waitcnt vmcnt(0)
 v_mfma_f32_16x16x32_bf16 v[168:171], v[184:187], a[168:171], 0
 v_mfma_f32_16x16x32_bf16 v[172:175], v[184:187], a[172:175], 0
 v_mfma_f32_16x16x32_bf16 v[168:171], v[188:191], a[176:179], v[168:171]
 v_mfma_f32_16x16x32_bf16 v[172:175], v[188:191], a[180:183], v[172:175]
 v_mfma_f32_16x16x32_bf16 v[168:171], v[192:195], a[184:187], v[168:171]
 v_mfma_f32_16x16x32_bf16 v[172:175], v[192:195], a[188:191], v[172:175]
 v_mfma_f32_16x16x32_bf16 v[168:171], v[196:199], a[192:195], v[168:171]
 v_mfma_f32_16x16x32_bf16 v[172:175], v[196:199], a[196:199], v[172:175]
 s_nop 7
 s_nop 3
 v_sub_f32 v160, v160, v204
 v_sub_f32 v161, v161, v204
 v_sub_f32 v162, v162, v204
 v_sub_f32 v163, v163, v204
 v_sub_f32 v164, v164, v205
 v_sub_f32 v165, v165, v205
 v_sub_f32 v166, v166, v205
 v_sub_f32 v167, v167, v205
 v_sub_f32 v168, v168, v204
 v_sub_f32 v169, v169, v204
 v_sub_f32 v170, v170, v204
 v_sub_f32 v171, v171, v204
 v_sub_f32 v172, v172, v205
 v_sub_f32 v173, v173, v205
 v_sub_f32 v174, v174, v205
 v_sub_f32 v175, v175, v205
 EX 160,160
 EX 161,161
 EX 162,162
 EX 163,163
 EX 164,164
 EX 165,165
 EX 166,166
 EX 167,167
 EX 168,168
 EX 169,169
 EX 170,170
 EX 171,171
 EX 172,172
 EX 173,173
 EX 174,174
 EX 175,175
 AD 206,206,160
 AD 206,206,161
 AD 206,206,162
 AD 206,206,163
 AD 207,207,164
 AD 207,207,165
 AD 207,207,166
 AD 207,207,167
 AD 206,206,168
 AD 206,206,169
 AD 206,206,170
 AD 206,206,171
 AD 207,207,172
 AD 207,207,173
 AD 207,207,174
 AD 207,207,175
 CV 176,160,161
 CV 177,162,163
 CV 178,168,169
 CV 179,170,171
 CV 180,164,165
 CV 181,166,167
 CV 182,172,173
 CV 183,174,175
 s_add_u32 s97, s98, s99
 buffer_load_ushort v184, v201, s[16:19], s97 offen
 buffer_load_ushort v192, v201, s[16:19], s97 offen offset:256
 buffer_load_ushort v185, v201, s[16:19], s97 offen offset:512
 buffer_load_ushort v193, v201, s[16:19], s97 offen offset:768
 buffer_load_ushort v188, v201, s[16:19], s97 offen offset:32
 buffer_load_ushort v196, v201, s[16:19], s97 offen offset:288
 buffer_load_ushort v189, v201, s[16:19], s97 offen offset:544
 buffer_load_ushort v197, v201, s[16:19], s97 offen offset:800
 s_add_u32 s97, s97, 0x1000
 buffer_load_ushort v186, v201, s[16:19], s97 offen
 buffer_load_ushort v194, v201, s[16:19], s97 offen offset:256
 buffer_load_ushort v187, v201, s[16:19], s97 offen offset:512
 buffer_load_ushort v195, v201, s[16:19], s97 offen offset:768
 buffer_load_ushort v190, v201, s[16:19], s97 offen offset:32
 buffer_load_ushort v198, v201, s[16:19], s97 offen offset:288
 buffer_load_ushort v191, v201, s[16:19], s97 offen offset:544
 buffer_load_ushort v199, v201, s[16:19], s97 offen offset:800
 s_waitcnt vmcnt(0)
 v_lshl_or_b32 v184, v192, 16, v184
 v_lshl_or_b32 v185, v193, 16, v185
 v_lshl_or_b32 v186, v194, 16, v186
 v_lshl_or_b32 v187, v195, 16, v187
 v_lshl_or_b32 v188, v196, 16, v188
 v_lshl_or_b32 v189, v197, 16, v189
 v_lshl_or_b32 v190, v198, 16, v190
 v_lshl_or_b32 v191, v199, 16, v191
 v_mfma_f32_16x16x32_bf16 v[48:51], v[184:187], v[176:179], v[48:51]
 v_mfma_f32_16x16x32_bf16 v[52:55], v[184:187], v[180:183], v[52:55]
 v_mfma_f32_16x16x32_bf16 v[56:59], v[188:191], v[176:179], v[56:59]
 v_mfma_f32_16x16x32_bf16 v[60:63], v[188:191], v[180:183], v[60:63]
 s_nop 7
 s_add_u32 s97, s98, s99
 buffer_load_ushort v184, v201, s[16:19], s97 offen offset:64
 buffer_load_ushort v192, v201, s[16:19], s97 offen offset:320
 buffer_load_ushort v185, v201, s[16:19], s97 offen offset:576
 buffer_load_ushort v193, v201, s[16:19], s97 offen offset:832
 buffer_load_ushort v188, v201, s[16:19], s97 offen offset:96
 buffer_load_ushort v196, v201, s[16:19], s97 offen offset:352
 buffer_load_ushort v189, v201, s[16:19], s97 offen offset:608
 buffer_load_ushort v197, v201, s[16:19], s97 offen offset:864
 s_add_u32 s97, s97, 0x1000
 buffer_load_ushort v186, v201, s[16:19], s97 offen offset:64
 buffer_load_ushort v194, v201, s[16:19], s97 offen offset:320
 buffer_load_ushort v187, v201, s[16:19], s97 offen offset:576
 buffer_load_ushort v195, v201, s[16:19], s97 offen offset:832
 buffer_load_ushort v190, v201, s[16:19], s97 offen offset:96
 buffer_load_ushort v198, v201, s[16:19], s97 offen offset:352
 buffer_load_ushort v191, v201, s[16:19], s97 offen offset:608
 buffer_load_ushort v199, v201, s[16:19], s97 offen offset:864
 s_waitcnt vmcnt(0)
 v_lshl_or_b32 v184, v192, 16, v184
 v_lshl_or_b32 v185, v193, 16, v185
 v_lshl_or_b32 v186, v194, 16, v186
 v_lshl_or_b32 v187, v195, 16, v187
 v_lshl_or_b32 v188, v196, 16, v188
 v_lshl_or_b32 v189, v197, 16, v189
 v_lshl_or_b32 v190, v198, 16, v190
 v_lshl_or_b32 v191, v199, 16, v191
 v_mfma_f32_16x16x32_bf16 v[64:67], v[184:187], v[176:179], v[64:67]
 v_mfma_f32_16x16x32_bf16 v[68:71], v[184:187], v[180:183], v[68:71]
 v_mfma_f32_16x16x32_bf16 v[72:75], v[188:191], v[176:179], v[72:75]
 v_mfma_f32_16x16x32_bf16 v[76:79], v[188:191], v[180:183], v[76:79]
 s_nop 7
 s_add_u32 s97, s98, s99
 buffer_load_ushort v184, v201, s[16:19], s97 offen offset:128
 buffer_load_ushort v192, v201, s[16:19], s97 offen offset:384
 buffer_load_ushort v185, v201, s[16:19], s97 offen offset:640
 buffer_load_ushort v193, v201, s[16:19], s97 offen offset:896
 buffer_load_ushort v188, v201, s[16:19], s97 offen offset:160
 buffer_load_ushort v196, v201, s[16:19], s97 offen offset:416
 buffer_load_ushort v189, v201, s[16:19], s97 offen offset:672
 buffer_load_ushort v197, v201, s[16:19], s97 offen offset:928
 s_add_u32 s97, s97, 0x1000
 buffer_load_ushort v186, v201, s[16:19], s97 offen offset:128
 buffer_load_ushort v194, v201, s[16:19], s97 offen offset:384
 buffer_load_ushort v187, v201, s[16:19], s97 offen offset:640
 buffer_load_ushort v195, v201, s[16:19], s97 offen offset:896
 buffer_load_ushort v190, v201, s[16:19], s97 offen offset:160
 buffer_load_ushort v198, v201, s[16:19], s97 offen offset:416
 buffer_load_ushort v191, v201, s[16:19], s97 offen offset:672
 buffer_load_ushort v199, v201, s[16:19], s97 offen offset:928
 s_waitcnt vmcnt(0)
 v_lshl_or_b32 v184, v192, 16, v184
 v_lshl_or_b32 v185, v193, 16, v185
 v_lshl_or_b32 v186, v194, 16, v186
 v_lshl_or_b32 v187, v195, 16, v187
 v_lshl_or_b32 v188, v196, 16, v188
 v_lshl_or_b32 v189, v197, 16, v189
 v_lshl_or_b32 v190, v198, 16, v190
 v_lshl_or_b32 v191, v199, 16, v191
 v_mfma_f32_16x16x32_bf16 v[80:83], v[184:187], v[176:179], v[80:83]
 v_mfma_f32_16x16x32_bf16 v[84:87], v[184:187], v[180:183], v[84:87]
 v_mfma_f32_16x16x32_bf16 v[88:91], v[188:191], v[176:179], v[88:91]
 v_mfma_f32_16x16x32_bf16 v[92:95], v[188:191], v[180:183], v[92:95]
 s_nop 7
 s_add_u32 s97, s98, s99
 buffer_load_ushort v184, v201, s[16:19], s97 offen offset:192
 buffer_load_ushort v192, v201, s[16:19], s97 offen offset:448
 buffer_load_ushort v185, v201, s[16:19], s97 offen offset:704
 buffer_load_ushort v193, v201, s[16:19], s97 offen offset:960
 buffer_load_ushort v188, v201, s[16:19], s97 offen offset:224
 buffer_load_ushort v196, v201, s[16:19], s97 offen offset:480
 buffer_load_ushort v189, v201, s[16:19], s97 offen offset:736
 buffer_load_ushort v197, v201, s[16:19], s97 offen offset:992
 s_add_u32 s97, s97, 0x1000
 buffer_load_ushort v186, v201, s[16:19], s97 offen offset:192
 buffer_load_ushort v194, v201, s[16:19], s97 offen offset:448
 buffer_load_ushort v187, v201, s[16:19], s97 offen offset:704
 buffer_load_ushort v195, v201, s[16:19], s97 offen offset:960
 buffer_load_ushort v190, v201, s[16:19], s97 offen offset:224
 buffer_load_ushort v198, v201, s[16:19], s97 offen offset:480
 buffer_load_ushort v191, v201, s[16:19], s97 offen offset:736
 buffer_load_ushort v199, v201, s[16:19], s97 offen offset:992
 s_waitcnt vmcnt(0)
 v_lshl_or_b32 v184, v192, 16, v184
 v_lshl_or_b32 v185, v193, 16, v185
 v_lshl_or_b32 v186, v194, 16, v186
 v_lshl_or_b32 v187, v195, 16, v187
 v_lshl_or_b32 v188, v196, 16, v188
 v_lshl_or_b32 v189, v197, 16, v189
 v_lshl_or_b32 v190, v198, 16, v190
 v_lshl_or_b32 v191, v199, 16, v191
 v_mfma_f32_16x16x32_bf16 v[96:99], v[184:187], v[176:179], v[96:99]
 v_mfma_f32_16x16x32_bf16 v[100:103], v[184:187], v[180:183], v[100:103]
 v_mfma_f32_16x16x32_bf16 v[104:107], v[188:191], v[176:179], v[104:107]
 v_mfma_f32_16x16x32_bf16 v[108:111], v[188:191], v[180:183], v[108:111]
 s_nop 7
 s_add_u32 s99, s99, 0x2000
 s_cmp_lt_u32 s99, 0x20000
 s_cbranch_scc1 L_M_slow1_b
 s_nop 7
 s_nop 3
 v_mov_b32 v202, v206
 s_nop 1
 v_permlane16_swap_b32 v206, v202
 AD 206,206,202
 v_mov_b32 v202, v206
 s_nop 1
 v_permlane32_swap_b32 v206, v202
 AD 206,206,202
 v_mov_b32 v202, v207
 s_nop 1
 v_permlane16_swap_b32 v207, v202
 AD 207,207,202
 v_mov_b32 v202, v207
 s_nop 1
 v_permlane32_swap_b32 v207, v202
 AD 207,207,202
 v_rcp_f32 v206, v206
 v_rcp_f32 v207, v207
 ML 48,48,206
 ML 49,49,206
 ML 50,50,206
 ML 51,51,206
 ML 52,52,207
 ML 53,53,207
 ML 54,54,207
 ML 55,55,207
 ML 56,56,206
 ML 57,57,206
 ML 58,58,206
 ML 59,59,206
 ML 60,60,207
 ML 61,61,207
 ML 62,62,207
 ML 63,63,207
 ML 64,64,206
 ML 65,65,206
 ML 66,66,206
 ML 67,67,206
 ML 68,68,207
 ML 69,69,207
 ML 70,70,207
 ML 71,71,207
 ML 72,72,206
 ML 73,73,206
 ML 74,74,206
 ML 75,75,206
 ML 76,76,207
 ML 77,77,207
 ML 78,78,207
 ML 79,79,207
 ML 80,80,206
 ML 81,81,206
 ML 82,82,206
 ML 83,83,206
 ML 84,84,207
 ML 85,85,207
 ML 86,86,207
 ML 87,87,207
 ML 88,88,206
 ML 89,89,206
 ML 90,90,206
 ML 91,91,206
 ML 92,92,207
 ML 93,93,207
 ML 94,94,207
 ML 95,95,207
 ML 96,96,206
 ML 97,97,206
 ML 98,98,206
 ML 99,99,206
 ML 100,100,207
 ML 101,101,207
 ML 102,102,207
 ML 103,103,207
 ML 104,104,206
 ML 105,105,206
 ML 106,106,206
 ML 107,107,206
 ML 108,108,207
 ML 109,109,207
 ML 110,110,207
 ML 111,111,207
 CV 48,48,49
 AW 80,48
 CV 50,50,51
 AW 81,50
 CV 56,56,57
 AW 82,56
 CV 58,58,59
 AW 83,58
 CV 52,52,53
 AW 84,52
 CV 54,54,55
 AW 85,54
 CV 60,60,61
 AW 86,60
 CV 62,62,63
 AW 87,62
 CV 64,64,65
 AW 96,64
 CV 66,66,67
 AW 97,66
 CV 72,72,73
 AW 98,72
 CV 74,74,75
 AW 99,74
 CV 68,68,69
 AW 100,68
 CV 70,70,71
 AW 101,70
 CV 76,76,77
 AW 102,76
 CV 78,78,79
 AW 103,78
 CV 80,80,81
 AW 112,80
 CV 82,82,83
 AW 113,82
 CV 88,88,89
 AW 114,88
 CV 90,90,91
 AW 115,90
 CV 84,84,85
 AW 116,84
 CV 86,86,87
 AW 117,86
 CV 92,92,93
 AW 118,92
 CV 94,94,95
 AW 119,94
 CV 96,96,97
 AW 128,96
 CV 98,98,99
 AW 129,98
 CV 104,104,105
 AW 130,104
 CV 106,106,107
 AW 131,106
 CV 100,100,101
 AW 132,100
 CV 102,102,103
 AW 133,102
 CV 108,108,109
 AW 134,108
 CV 110,110,111
 AW 135,110
 s_nop 1
 s_setpc_b64 s[56:57]
L_M_red:
 v_mov_b32 v23, 0x26400
 ds_read_b32 v24, v23
 WL 0
 v_readfirstlane_b32 s92, v24
 s_nop 1
 s_and_b32 s78, s92, 0xff
 s_bfe_u32 s79, s92, 0x80008
 s_lshr_b32 s58, s92, 16
 v_lshrrev_b32 v19, 4, v0
 v_and_b32 v20, 7, v19
 v_lshlrev_b32 v25, 4, v20
 s_mov_b32 s92, 0x480
 v_mul_u32_u24 v20, s92, v20
 v_lshrrev_b32 v18, 3, v19
 v_lshl_add_u32 v28, v18, 4, v20
 v_bfe_u32 v18, v19, 3, 2
 v_lshl_add_u32 v20, v18, 3, v20
 v_lshl_add_u32 v25, v18, 8, v25
 v_lshrrev_b32 v18, 5, v19
 v_lshl_add_u32 v20, v18, 6, v20
 v_lshl_add_u32 v25, v18, 11, v25
 s_mul_i32 s59, s62, 0x2400
 s_lshr_b32 s3, s62, 1
 s_lshl_b32 s3, s3, 10
 s_and_b32 s92, s62, 1
 s_lshl_b32 s92, s92, 7
 s_add_u32 s3, s3, s92
 s_mov_b32 s68, 0x3f80
 s_mov_b32 s69, 0x3f800000
 s_mov_b64 s[74:75], 0
 s_mov_b32 s42, 20
 s_mov_b32 s44, 25
 s_bitset1_b64 s[74:75], s42
 s_bitset1_b64 s[74:75], s44
 s_and_b32 s75, s75, 15
 s_and_b32 s92, s44, 3
 s_lshr_b32 s80, s44, 2
 s_lshl_b32 s93, s64, 2
 s_add_u32 s92, s92, s93
 s_mul_i32 s47, s92, 0x9000
 s_add_u32 s60, s47, s59
 s_lshl_b32 s93, s80, 12
 s_add_u32 s93, s93, s3
 s_add_u32 s47, s47, s93
 s_lshl_b32 s93, s80, 7
 s_add_u32 s60, s60, s93
 s_mov_b32 s65, s47
 s_and_b32 s92, s42, 3
 s_lshr_b32 s80, s42, 2
 s_lshl_b32 s93, s64, 2
 s_add_u32 s92, s92, s93
 s_mul_i32 s47, s92, 0x9000
 s_add_u32 s46, s47, s59
 s_lshl_b32 s93, s80, 12
 s_add_u32 s93, s93, s3
 s_add_u32 s47, s47, s93
 s_lshl_b32 s93, s80, 7
 s_add_u32 s46, s46, s93
 s_min_u32 s92, s78, s79
 s_cmp_lt_u32 s44, s92
 s_cbranch_scc0 L_M_sl
 s_mov_b32 s93, 0xffff0000
 buffer_load_dwordx2 v[140:141], v20, s[8:11], s46 offen
 buffer_load_dwordx2 v[142:143], v20, s[8:11], s46 offen offset:32
 s_add_u32 s92, s47, 0
 buffer_load_dwordx4 v[72:75], v25, s[36:39], s92 offen sc1
 s_add_u32 s92, s47, 0x240000
 buffer_load_dwordx4 v[76:79], v25, s[36:39], s92 offen sc1
 s_add_u32 s92, s47, 0x480000
 buffer_load_dwordx4 v[80:83], v25, s[36:39], s92 offen sc1
 s_add_u32 s92, s47, 0x6c0000
 buffer_load_dwordx4 v[84:87], v25, s[36:39], s92 offen sc1
 s_add_u32 s92, s47, 0x900000
 buffer_load_dwordx4 v[88:91], v25, s[36:39], s92 offen sc1
 s_add_u32 s92, s47, 0xb40000
 buffer_load_dwordx4 v[92:95], v25, s[36:39], s92 offen sc1
 s_add_u32 s92, s47, 0xd80000
 buffer_load_dwordx4 v[96:99], v25, s[36:39], s92 offen sc1
 s_add_u32 s92, s47, 0xfc0000
 buffer_load_dwordx4 v[100:103], v25, s[36:39], s92 offen sc1
 s_waitcnt vmcnt(7)
 v_lshlrev_b32 v48, 16, v72
 v_and_b32 v49, s93, v72
 v_lshlrev_b32 v50, 16, v73
 v_and_b32 v51, s93, v73
 v_lshlrev_b32 v52, 16, v74
 v_and_b32 v53, s93, v74
 v_lshlrev_b32 v54, 16, v75
 v_and_b32 v55, s93, v75
 s_add_u32 s92, s47, 0x1200000
 buffer_load_dwordx4 v[104:107], v25, s[36:39], s92 offen sc1
 s_waitcnt vmcnt(7)
 v_dot2c_f32_bf16 v48, s68, v76
 v_dot2c_f32_bf16 v49, s69, v76
 v_dot2c_f32_bf16 v50, s68, v77
 v_dot2c_f32_bf16 v51, s69, v77
 v_dot2c_f32_bf16 v52, s68, v78
 v_dot2c_f32_bf16 v53, s69, v78
 v_dot2c_f32_bf16 v54, s68, v79
 v_dot2c_f32_bf16 v55, s69, v79
 s_add_u32 s92, s47, 0x1440000
 buffer_load_dwordx4 v[108:111], v25, s[36:39], s92 offen sc1
 buffer_load_dword v31, v21, s[36:39], s77 offen sc1
 s_mov_b32 s93, 0xffff0000
 s_waitcnt vmcnt(8)
 v_dot2c_f32_bf16 v48, s68, v80
 v_dot2c_f32_bf16 v49, s69, v80
 v_dot2c_f32_bf16 v50, s68, v81
 v_dot2c_f32_bf16 v51, s69, v81
 v_dot2c_f32_bf16 v52, s68, v82
 v_dot2c_f32_bf16 v53, s69, v82
 v_dot2c_f32_bf16 v54, s68, v83
 v_dot2c_f32_bf16 v55, s69, v83
 s_add_u32 s92, s47, 0x1680000
 buffer_load_dwordx4 v[112:115], v25, s[36:39], s92 offen sc1
 s_waitcnt vmcnt(8)
 v_dot2c_f32_bf16 v48, s68, v84
 v_dot2c_f32_bf16 v49, s69, v84
 v_dot2c_f32_bf16 v50, s68, v85
 v_dot2c_f32_bf16 v51, s69, v85
 v_dot2c_f32_bf16 v52, s68, v86
 v_dot2c_f32_bf16 v53, s69, v86
 v_dot2c_f32_bf16 v54, s68, v87
 v_dot2c_f32_bf16 v55, s69, v87
 s_add_u32 s92, s47, 0x18c0000
 buffer_load_dwordx4 v[116:119], v25, s[36:39], s92 offen sc1
 s_waitcnt vmcnt(8)
 v_dot2c_f32_bf16 v48, s68, v88
 v_dot2c_f32_bf16 v49, s69, v88
 v_dot2c_f32_bf16 v50, s68, v89
 v_dot2c_f32_bf16 v51, s69, v89
 v_dot2c_f32_bf16 v52, s68, v90
 v_dot2c_f32_bf16 v53, s69, v90
 v_dot2c_f32_bf16 v54, s68, v91
 v_dot2c_f32_bf16 v55, s69, v91
 s_add_u32 s92, s47, 0x1b00000
 buffer_load_dwordx4 v[120:123], v25, s[36:39], s92 offen sc1
 s_waitcnt vmcnt(8)
 v_dot2c_f32_bf16 v48, s68, v92
 v_dot2c_f32_bf16 v49, s69, v92
 v_dot2c_f32_bf16 v50, s68, v93
 v_dot2c_f32_bf16 v51, s69, v93
 v_dot2c_f32_bf16 v52, s68, v94
 v_dot2c_f32_bf16 v53, s69, v94
 v_dot2c_f32_bf16 v54, s68, v95
 v_dot2c_f32_bf16 v55, s69, v95
 s_add_u32 s92, s47, 0x1d40000
 buffer_load_dwordx4 v[124:127], v25, s[36:39], s92 offen sc1
 s_waitcnt vmcnt(8)
 v_dot2c_f32_bf16 v48, s68, v96
 v_dot2c_f32_bf16 v49, s69, v96
 v_dot2c_f32_bf16 v50, s68, v97
 v_dot2c_f32_bf16 v51, s69, v97
 v_dot2c_f32_bf16 v52, s68, v98
 v_dot2c_f32_bf16 v53, s69, v98
 v_dot2c_f32_bf16 v54, s68, v99
 v_dot2c_f32_bf16 v55, s69, v99
 s_add_u32 s92, s47, 0x1f80000
 buffer_load_dwordx4 v[128:131], v25, s[36:39], s92 offen sc1
 s_waitcnt vmcnt(8)
 v_dot2c_f32_bf16 v48, s68, v100
 v_dot2c_f32_bf16 v49, s69, v100
 v_dot2c_f32_bf16 v50, s68, v101
 v_dot2c_f32_bf16 v51, s69, v101
 v_dot2c_f32_bf16 v52, s68, v102
 v_dot2c_f32_bf16 v53, s69, v102
 v_dot2c_f32_bf16 v54, s68, v103
 v_dot2c_f32_bf16 v55, s69, v103
 s_add_u32 s92, s47, 0x21c0000
 buffer_load_dwordx4 v[132:135], v25, s[36:39], s92 offen sc1
 s_waitcnt vmcnt(8)
 v_dot2c_f32_bf16 v48, s68, v104
 v_dot2c_f32_bf16 v49, s69, v104
 v_dot2c_f32_bf16 v50, s68, v105
 v_dot2c_f32_bf16 v51, s69, v105
 v_dot2c_f32_bf16 v52, s68, v106
 v_dot2c_f32_bf16 v53, s69, v106
 v_dot2c_f32_bf16 v54, s68, v107
 v_dot2c_f32_bf16 v55, s69, v107
 s_add_u32 s92, s47, 0x2400000
 buffer_load_dwordx4 v[136:139], v25, s[36:39], s92 offen sc1
 s_waitcnt vmcnt(8)
 v_dot2c_f32_bf16 v48, s68, v108
 v_dot2c_f32_bf16 v49, s69, v108
 v_dot2c_f32_bf16 v50, s68, v109
 v_dot2c_f32_bf16 v51, s69, v109
 v_dot2c_f32_bf16 v52, s68, v110
 v_dot2c_f32_bf16 v53, s69, v110
 v_dot2c_f32_bf16 v54, s68, v111
 v_dot2c_f32_bf16 v55, s69, v111
 buffer_load_dwordx2 v[212:213], v20, s[8:11], s60 offen
 s_waitcnt vmcnt(7)
 v_dot2c_f32_bf16 v48, s68, v112
 v_dot2c_f32_bf16 v49, s69, v112
 v_dot2c_f32_bf16 v50, s68, v113
 v_dot2c_f32_bf16 v51, s69, v113
 v_dot2c_f32_bf16 v52, s68, v114
 v_dot2c_f32_bf16 v53, s69, v114
 v_dot2c_f32_bf16 v54, s68, v115
 v_dot2c_f32_bf16 v55, s69, v115
 buffer_load_dwordx2 v[214:215], v20, s[8:11], s60 offen offset:32
 s_waitcnt vmcnt(7)
 v_lshlrev_b32 v56, 16, v116
 v_and_b32 v57, s93, v116
 v_lshlrev_b32 v58, 16, v117
 v_and_b32 v59, s93, v117
 v_lshlrev_b32 v60, 16, v118
 v_and_b32 v61, s93, v118
 v_lshlrev_b32 v62, 16, v119
 v_and_b32 v63, s93, v119
 s_add_u32 s92, s65, 0
 buffer_load_dwordx4 v[144:147], v25, s[36:39], s92 offen sc1
 s_waitcnt vmcnt(7)
 v_dot2c_f32_bf16 v56, s68, v120
 v_dot2c_f32_bf16 v57, s69, v120
 v_dot2c_f32_bf16 v58, s68, v121
 v_dot2c_f32_bf16 v59, s69, v121
 v_dot2c_f32_bf16 v60, s68, v122
 v_dot2c_f32_bf16 v61, s69, v122
 v_dot2c_f32_bf16 v62, s68, v123
 v_dot2c_f32_bf16 v63, s69, v123
 s_add_u32 s92, s65, 0x240000
 buffer_load_dwordx4 v[148:151], v25, s[36:39], s92 offen sc1
 s_waitcnt vmcnt(7)
 v_dot2c_f32_bf16 v56, s68, v124
 v_dot2c_f32_bf16 v57, s69, v124
 v_dot2c_f32_bf16 v58, s68, v125
 v_dot2c_f32_bf16 v59, s69, v125
 v_dot2c_f32_bf16 v60, s68, v126
 v_dot2c_f32_bf16 v61, s69, v126
 v_dot2c_f32_bf16 v62, s68, v127
 v_dot2c_f32_bf16 v63, s69, v127
 s_add_u32 s92, s65, 0x480000
 buffer_load_dwordx4 v[152:155], v25, s[36:39], s92 offen sc1
 s_waitcnt vmcnt(7)
 v_dot2c_f32_bf16 v56, s68, v128
 v_dot2c_f32_bf16 v57, s69, v128
 v_dot2c_f32_bf16 v58, s68, v129
 v_dot2c_f32_bf16 v59, s69, v129
 v_dot2c_f32_bf16 v60, s68, v130
 v_dot2c_f32_bf16 v61, s69, v130
 v_dot2c_f32_bf16 v62, s68, v131
 v_dot2c_f32_bf16 v63, s69, v131
 s_add_u32 s92, s65, 0x6c0000
 buffer_load_dwordx4 v[156:159], v25, s[36:39], s92 offen sc1
 s_waitcnt vmcnt(7)
 v_dot2c_f32_bf16 v56, s68, v132
 v_dot2c_f32_bf16 v57, s69, v132
 v_dot2c_f32_bf16 v58, s68, v133
 v_dot2c_f32_bf16 v59, s69, v133
 v_dot2c_f32_bf16 v60, s68, v134
 v_dot2c_f32_bf16 v61, s69, v134
 v_dot2c_f32_bf16 v62, s68, v135
 v_dot2c_f32_bf16 v63, s69, v135
 s_add_u32 s92, s65, 0x900000
 buffer_load_dwordx4 v[160:163], v25, s[36:39], s92 offen sc1
 s_waitcnt vmcnt(7)
 v_dot2c_f32_bf16 v56, s68, v136
 v_dot2c_f32_bf16 v57, s69, v136
 v_dot2c_f32_bf16 v58, s68, v137
 v_dot2c_f32_bf16 v59, s69, v137
 v_dot2c_f32_bf16 v60, s68, v138
 v_dot2c_f32_bf16 v61, s69, v138
 v_dot2c_f32_bf16 v62, s68, v139
 v_dot2c_f32_bf16 v63, s69, v139
 EX 64,56
 EX 65,57
 EX 66,58
 EX 67,59
 EX 68,60
 EX 69,61
 EX 70,62
 EX 71,63
 v_add_f32 v64, 1.0, v64
 v_add_f32 v65, 1.0, v65
 v_add_f32 v66, 1.0, v66
 v_add_f32 v67, 1.0, v67
 v_add_f32 v68, 1.0, v68
 v_add_f32 v69, 1.0, v69
 v_add_f32 v70, 1.0, v70
 v_add_f32 v71, 1.0, v71
 v_rcp_f32 v64, v64
 v_rcp_f32 v65, v65
 v_rcp_f32 v66, v66
 v_rcp_f32 v67, v67
 v_rcp_f32 v68, v68
 v_rcp_f32 v69, v69
 v_rcp_f32 v70, v70
 v_rcp_f32 v71, v71
 v_mul_f32 v56, 0xbf317218, v56
 v_mul_f32 v57, 0xbf317218, v57
 v_mul_f32 v58, 0xbf317218, v58
 v_mul_f32 v59, 0xbf317218, v59
 v_mul_f32 v60, 0xbf317218, v60
 v_mul_f32 v61, 0xbf317218, v61
 v_mul_f32 v62, 0xbf317218, v62
 v_mul_f32 v63, 0xbf317218, v63
 ML 56,56,64
 ML 57,57,65
 ML 58,58,66
 ML 59,59,67
 ML 60,60,68
 ML 61,61,69
 ML 62,62,70
 ML 63,63,71
 v_lshlrev_b32 v64, 16, v140
 v_and_b32 v65, s93, v140
 v_lshlrev_b32 v66, 16, v141
 v_and_b32 v67, s93, v141
 v_lshlrev_b32 v68, 16, v142
 v_and_b32 v69, s93, v142
 v_lshlrev_b32 v70, 16, v143
 v_and_b32 v71, s93, v143
 v_fma_f32 v64, v48, v56, v64
 v_fma_f32 v65, v49, v57, v65
 v_fma_f32 v66, v50, v58, v66
 v_fma_f32 v67, v51, v59, v67
 v_fma_f32 v68, v52, v60, v68
 v_fma_f32 v69, v53, v61, v69
 v_fma_f32 v70, v54, v62, v70
 v_fma_f32 v71, v55, v63, v71
 CV 140,64,65
 CV 141,66,67
 CV 142,68,69
 CV 143,70,71
 s_nop 0
 v_permlane16_swap_b32 v140, v142
 v_permlane16_swap_b32 v141, v143
 v_mov_b32 v64, v140
 v_mov_b32 v65, v141
 v_mov_b32_dpp v140, v142 row_ror:8 row_mask:0xf bank_mask:0xc
 v_mov_b32_dpp v141, v143 row_ror:8 row_mask:0xf bank_mask:0xc
 v_mov_b32_dpp v142, v64 row_ror:8 row_mask:0xf bank_mask:0x3
 v_mov_b32_dpp v143, v65 row_ror:8 row_mask:0xf bank_mask:0x3
 buffer_store_dwordx4 v[140:143], v28, s[48:51], s46 offen sc1
 v_mov_b32 v19, 0x10000000
 buffer_store_dword v19, v19, s[48:51], 0 offen
 s_add_u32 s92, s65, 0xb40000
 buffer_load_dwordx4 v[164:167], v25, s[36:39], s92 offen sc1
 s_add_u32 s92, s65, 0xd80000
 buffer_load_dwordx4 v[168:171], v25, s[36:39], s92 offen sc1
 s_add_u32 s92, s65, 0xfc0000
 buffer_load_dwordx4 v[172:175], v25, s[36:39], s92 offen sc1
 s_waitcnt vmcnt(9)
 v_lshlrev_b32 v48, 16, v144
 v_and_b32 v49, s93, v144
 v_lshlrev_b32 v50, 16, v145
 v_and_b32 v51, s93, v145
 v_lshlrev_b32 v52, 16, v146
 v_and_b32 v53, s93, v146
 v_lshlrev_b32 v54, 16, v147
 v_and_b32 v55, s93, v147
 s_add_u32 s92, s65, 0x1200000
 buffer_load_dwordx4 v[176:179], v25, s[36:39], s92 offen sc1
 s_waitcnt vmcnt(9)
 v_dot2c_f32_bf16 v48, s68, v148
 v_dot2c_f32_bf16 v49, s69, v148
 v_dot2c_f32_bf16 v50, s68, v149
 v_dot2c_f32_bf16 v51, s69, v149
 v_dot2c_f32_bf16 v52, s68, v150
 v_dot2c_f32_bf16 v53, s69, v150
 v_dot2c_f32_bf16 v54, s68, v151
 v_dot2c_f32_bf16 v55, s69, v151
 s_add_u32 s92, s65, 0x1440000
 buffer_load_dwordx4 v[180:183], v25, s[36:39], s92 offen sc1
 s_waitcnt vmcnt(9)
 v_dot2c_f32_bf16 v48, s68, v152
 v_dot2c_f32_bf16 v49, s69, v152
 v_dot2c_f32_bf16 v50, s68, v153
 v_dot2c_f32_bf16 v51, s69, v153
 v_dot2c_f32_bf16 v52, s68, v154
 v_dot2c_f32_bf16 v53, s69, v154
 v_dot2c_f32_bf16 v54, s68, v155
 v_dot2c_f32_bf16 v55, s69, v155
 s_add_u32 s92, s65, 0x1680000
 buffer_load_dwordx4 v[184:187], v25, s[36:39], s92 offen sc1
 s_waitcnt vmcnt(9)
 v_dot2c_f32_bf16 v48, s68, v156
 v_dot2c_f32_bf16 v49, s69, v156
 v_dot2c_f32_bf16 v50, s68, v157
 v_dot2c_f32_bf16 v51, s69, v157
 v_dot2c_f32_bf16 v52, s68, v158
 v_dot2c_f32_bf16 v53, s69, v158
 v_dot2c_f32_bf16 v54, s68, v159
 v_dot2c_f32_bf16 v55, s69, v159
 s_add_u32 s92, s65, 0x18c0000
 buffer_load_dwordx4 v[188:191], v25, s[36:39], s92 offen sc1
 s_waitcnt vmcnt(9)
 v_dot2c_f32_bf16 v48, s68, v160
 v_dot2c_f32_bf16 v49, s69, v160
 v_dot2c_f32_bf16 v50, s68, v161
 v_dot2c_f32_bf16 v51, s69, v161
 v_dot2c_f32_bf16 v52, s68, v162
 v_dot2c_f32_bf16 v53, s69, v162
 v_dot2c_f32_bf16 v54, s68, v163
 v_dot2c_f32_bf16 v55, s69, v163
 s_add_u32 s92, s65, 0x1b00000
 buffer_load_dwordx4 v[192:195], v25, s[36:39], s92 offen sc1
 s_waitcnt vmcnt(7)
 v_dot2c_f32_bf16 v48, s68, v164
 v_dot2c_f32_bf16 v49, s69, v164
 v_dot2c_f32_bf16 v50, s68, v165
 v_dot2c_f32_bf16 v51, s69, v165
 v_dot2c_f32_bf16 v52, s68, v166
 v_dot2c_f32_bf16 v53, s69, v166
 v_dot2c_f32_bf16 v54, s68, v167
 v_dot2c_f32_bf16 v55, s69, v167
 s_add_u32 s92, s65, 0x1d40000
 buffer_load_dwordx4 v[196:199], v25, s[36:39], s92 offen sc1
 s_waitcnt vmcnt(7)
 v_dot2c_f32_bf16 v48, s68, v168
 v_dot2c_f32_bf16 v49, s69, v168
 v_dot2c_f32_bf16 v50, s68, v169
 v_dot2c_f32_bf16 v51, s69, v169
 v_dot2c_f32_bf16 v52, s68, v170
 v_dot2c_f32_bf16 v53, s69, v170
 v_dot2c_f32_bf16 v54, s68, v171
 v_dot2c_f32_bf16 v55, s69, v171
 s_add_u32 s92, s65, 0x1f80000
 buffer_load_dwordx4 v[200:203], v25, s[36:39], s92 offen sc1
 s_waitcnt vmcnt(7)
 v_dot2c_f32_bf16 v48, s68, v172
 v_dot2c_f32_bf16 v49, s69, v172
 v_dot2c_f32_bf16 v50, s68, v173
 v_dot2c_f32_bf16 v51, s69, v173
 v_dot2c_f32_bf16 v52, s68, v174
 v_dot2c_f32_bf16 v53, s69, v174
 v_dot2c_f32_bf16 v54, s68, v175
 v_dot2c_f32_bf16 v55, s69, v175
 s_add_u32 s92, s65, 0x21c0000
 buffer_load_dwordx4 v[204:207], v25, s[36:39], s92 offen sc1
 s_waitcnt vmcnt(7)
 v_dot2c_f32_bf16 v48, s68, v176
 v_dot2c_f32_bf16 v49, s69, v176
 v_dot2c_f32_bf16 v50, s68, v177
 v_dot2c_f32_bf16 v51, s69, v177
 v_dot2c_f32_bf16 v52, s68, v178
 v_dot2c_f32_bf16 v53, s69, v178
 v_dot2c_f32_bf16 v54, s68, v179
 v_dot2c_f32_bf16 v55, s69, v179
 s_add_u32 s92, s65, 0x2400000
 buffer_load_dwordx4 v[208:211], v25, s[36:39], s92 offen sc1
 s_waitcnt vmcnt(7)
 v_dot2c_f32_bf16 v48, s68, v180
 v_dot2c_f32_bf16 v49, s69, v180
 v_dot2c_f32_bf16 v50, s68, v181
 v_dot2c_f32_bf16 v51, s69, v181
 v_dot2c_f32_bf16 v52, s68, v182
 v_dot2c_f32_bf16 v53, s69, v182
 v_dot2c_f32_bf16 v54, s68, v183
 v_dot2c_f32_bf16 v55, s69, v183
 s_waitcnt vmcnt(6)
 v_dot2c_f32_bf16 v48, s68, v184
 v_dot2c_f32_bf16 v49, s69, v184
 v_dot2c_f32_bf16 v50, s68, v185
 v_dot2c_f32_bf16 v51, s69, v185
 v_dot2c_f32_bf16 v52, s68, v186
 v_dot2c_f32_bf16 v53, s69, v186
 v_dot2c_f32_bf16 v54, s68, v187
 v_dot2c_f32_bf16 v55, s69, v187
 s_waitcnt vmcnt(5)
 v_lshlrev_b32 v56, 16, v188
 v_and_b32 v57, s93, v188
 v_lshlrev_b32 v58, 16, v189
 v_and_b32 v59, s93, v189
 v_lshlrev_b32 v60, 16, v190
 v_and_b32 v61, s93, v190
 v_lshlrev_b32 v62, 16, v191
 v_and_b32 v63, s93, v191
 s_waitcnt vmcnt(4)
 v_dot2c_f32_bf16 v56, s68, v192
 v_dot2c_f32_bf16 v57, s69, v192
 v_dot2c_f32_bf16 v58, s68, v193
 v_dot2c_f32_bf16 v59, s69, v193
 v_dot2c_f32_bf16 v60, s68, v194
 v_dot2c_f32_bf16 v61, s69, v194
 v_dot2c_f32_bf16 v62, s68, v195
 v_dot2c_f32_bf16 v63, s69, v195
 s_waitcnt vmcnt(3)
 v_dot2c_f32_bf16 v56, s68, v196
 v_dot2c_f32_bf16 v57, s69, v196
 v_dot2c_f32_bf16 v58, s68, v197
 v_dot2c_f32_bf16 v59, s69, v197
 v_dot2c_f32_bf16 v60, s68, v198
 v_dot2c_f32_bf16 v61, s69, v198
 v_dot2c_f32_bf16 v62, s68, v199
 v_dot2c_f32_bf16 v63, s69, v199
 s_waitcnt vmcnt(2)
 v_dot2c_f32_bf16 v56, s68, v200
 v_dot2c_f32_bf16 v57, s69, v200
 v_dot2c_f32_bf16 v58, s68, v201
 v_dot2c_f32_bf16 v59, s69, v201
 v_dot2c_f32_bf16 v60, s68, v202
 v_dot2c_f32_bf16 v61, s69, v202
 v_dot2c_f32_bf16 v62, s68, v203
 v_dot2c_f32_bf16 v63, s69, v203
 s_waitcnt vmcnt(1)
 v_dot2c_f32_bf16 v56, s68, v204
 v_dot2c_f32_bf16 v57, s69, v204
 v_dot2c_f32_bf16 v58, s68, v205
 v_dot2c_f32_bf16 v59, s69, v205
 v_dot2c_f32_bf16 v60, s68, v206
 v_dot2c_f32_bf16 v61, s69, v206
 v_dot2c_f32_bf16 v62, s68, v207
 v_dot2c_f32_bf16 v63, s69, v207
 s_waitcnt vmcnt(0)
 v_dot2c_f32_bf16 v56, s68, v208
 v_dot2c_f32_bf16 v57, s69, v208
 v_dot2c_f32_bf16 v58, s68, v209
 v_dot2c_f32_bf16 v59, s69, v209
 v_dot2c_f32_bf16 v60, s68, v210
 v_dot2c_f32_bf16 v61, s69, v210
 v_dot2c_f32_bf16 v62, s68, v211
 v_dot2c_f32_bf16 v63, s69, v211
 EX 64,56
 EX 65,57
 EX 66,58
 EX 67,59
 EX 68,60
 EX 69,61
 EX 70,62
 EX 71,63
 v_add_f32 v64, 1.0, v64
 v_add_f32 v65, 1.0, v65
 v_add_f32 v66, 1.0, v66
 v_add_f32 v67, 1.0, v67
 v_add_f32 v68, 1.0, v68
 v_add_f32 v69, 1.0, v69
 v_add_f32 v70, 1.0, v70
 v_add_f32 v71, 1.0, v71
 v_rcp_f32 v64, v64
 v_rcp_f32 v65, v65
 v_rcp_f32 v66, v66
 v_rcp_f32 v67, v67
 v_rcp_f32 v68, v68
 v_rcp_f32 v69, v69
 v_rcp_f32 v70, v70
 v_rcp_f32 v71, v71
 v_mul_f32 v56, 0xbf317218, v56
 v_mul_f32 v57, 0xbf317218, v57
 v_mul_f32 v58, 0xbf317218, v58
 v_mul_f32 v59, 0xbf317218, v59
 v_mul_f32 v60, 0xbf317218, v60
 v_mul_f32 v61, 0xbf317218, v61
 v_mul_f32 v62, 0xbf317218, v62
 v_mul_f32 v63, 0xbf317218, v63
 ML 56,56,64
 ML 57,57,65
 ML 58,58,66
 ML 59,59,67
 ML 60,60,68
 ML 61,61,69
 ML 62,62,70
 ML 63,63,71
 v_lshlrev_b32 v64, 16, v212
 v_and_b32 v65, s93, v212
 v_lshlrev_b32 v66, 16, v213
 v_and_b32 v67, s93, v213
 v_lshlrev_b32 v68, 16, v214
 v_and_b32 v69, s93, v214
 v_lshlrev_b32 v70, 16, v215
 v_and_b32 v71, s93, v215
 v_fma_f32 v64, v48, v56, v64
 v_fma_f32 v65, v49, v57, v65
 v_fma_f32 v66, v50, v58, v66
 v_fma_f32 v67, v51, v59, v67
 v_fma_f32 v68, v52, v60, v68
 v_fma_f32 v69, v53, v61, v69
 v_fma_f32 v70, v54, v62, v70
 v_fma_f32 v71, v55, v63, v71
 CV 212,64,65
 CV 213,66,67
 CV 214,68,69
 CV 215,70,71
 s_nop 0
 v_permlane16_swap_b32 v212, v214
 v_permlane16_swap_b32 v213, v215
 v_mov_b32 v64, v212
 v_mov_b32 v65, v213
 v_mov_b32_dpp v212, v214 row_ror:8 row_mask:0xf bank_mask:0xc
 v_mov_b32_dpp v213, v215 row_ror:8 row_mask:0xf bank_mask:0xc
 v_mov_b32_dpp v214, v64 row_ror:8 row_mask:0xf bank_mask:0x3
 v_mov_b32_dpp v215, v65 row_ror:8 row_mask:0xf bank_mask:0x3
 buffer_store_dwordx4 v[212:215], v28, s[48:51], s60 offen sc1
 v_mov_b32 v19, 0x10000000
 buffer_store_dword v19, v19, s[48:51], 0 offen
 s_branch L_M_j
L_M_sl:
 s_min_u32 s92, s78, s79
 s_cmp_lt_u32 s42, s92
 s_cbranch_scc1 L_M_en0
 s_mov_b32 s81, s42
 s_mov_b32 s80, 3
 s_call_b64 s[66:67], L_M_sync
 s_cmp_eq_u32 s58, 0
 s_cbranch_scc0 L_M_fb
L_M_en0:
 s_mov_b32 s93, 0xffff0000
 buffer_load_dwordx2 v[140:141], v20, s[8:11], s46 offen
 buffer_load_dwordx2 v[142:143], v20, s[8:11], s46 offen offset:32
 s_add_u32 s92, s47, 0
 buffer_load_dwordx4 v[72:75], v25, s[36:39], s92 offen sc1
 s_add_u32 s92, s47, 0x240000
 buffer_load_dwordx4 v[76:79], v25, s[36:39], s92 offen sc1
 s_add_u32 s92, s47, 0x480000
 buffer_load_dwordx4 v[80:83], v25, s[36:39], s92 offen sc1
 s_add_u32 s92, s47, 0x6c0000
 buffer_load_dwordx4 v[84:87], v25, s[36:39], s92 offen sc1
 s_add_u32 s92, s47, 0x900000
 buffer_load_dwordx4 v[88:91], v25, s[36:39], s92 offen sc1
 s_add_u32 s92, s47, 0xb40000
 buffer_load_dwordx4 v[92:95], v25, s[36:39], s92 offen sc1
 s_add_u32 s92, s47, 0xd80000
 buffer_load_dwordx4 v[96:99], v25, s[36:39], s92 offen sc1
 s_add_u32 s92, s47, 0xfc0000
 buffer_load_dwordx4 v[100:103], v25, s[36:39], s92 offen sc1
 s_waitcnt vmcnt(7)
 v_lshlrev_b32 v48, 16, v72
 v_and_b32 v49, s93, v72
 v_lshlrev_b32 v50, 16, v73
 v_and_b32 v51, s93, v73
 v_lshlrev_b32 v52, 16, v74
 v_and_b32 v53, s93, v74
 v_lshlrev_b32 v54, 16, v75
 v_and_b32 v55, s93, v75
 s_add_u32 s92, s47, 0x1200000
 buffer_load_dwordx4 v[104:107], v25, s[36:39], s92 offen sc1
 s_waitcnt vmcnt(7)
 v_dot2c_f32_bf16 v48, s68, v76
 v_dot2c_f32_bf16 v49, s69, v76
 v_dot2c_f32_bf16 v50, s68, v77
 v_dot2c_f32_bf16 v51, s69, v77
 v_dot2c_f32_bf16 v52, s68, v78
 v_dot2c_f32_bf16 v53, s69, v78
 v_dot2c_f32_bf16 v54, s68, v79
 v_dot2c_f32_bf16 v55, s69, v79
 s_add_u32 s92, s47, 0x1440000
 buffer_load_dwordx4 v[108:111], v25, s[36:39], s92 offen sc1
 s_waitcnt vmcnt(7)
 v_dot2c_f32_bf16 v48, s68, v80
 v_dot2c_f32_bf16 v49, s69, v80
 v_dot2c_f32_bf16 v50, s68, v81
 v_dot2c_f32_bf16 v51, s69, v81
 v_dot2c_f32_bf16 v52, s68, v82
 v_dot2c_f32_bf16 v53, s69, v82
 v_dot2c_f32_bf16 v54, s68, v83
 v_dot2c_f32_bf16 v55, s69, v83
 s_add_u32 s92, s47, 0x1680000
 buffer_load_dwordx4 v[112:115], v25, s[36:39], s92 offen sc1
 s_waitcnt vmcnt(7)
 v_dot2c_f32_bf16 v48, s68, v84
 v_dot2c_f32_bf16 v49, s69, v84
 v_dot2c_f32_bf16 v50, s68, v85
 v_dot2c_f32_bf16 v51, s69, v85
 v_dot2c_f32_bf16 v52, s68, v86
 v_dot2c_f32_bf16 v53, s69, v86
 v_dot2c_f32_bf16 v54, s68, v87
 v_dot2c_f32_bf16 v55, s69, v87
 s_add_u32 s92, s47, 0x18c0000
 buffer_load_dwordx4 v[116:119], v25, s[36:39], s92 offen sc1
 s_waitcnt vmcnt(7)
 v_dot2c_f32_bf16 v48, s68, v88
 v_dot2c_f32_bf16 v49, s69, v88
 v_dot2c_f32_bf16 v50, s68, v89
 v_dot2c_f32_bf16 v51, s69, v89
 v_dot2c_f32_bf16 v52, s68, v90
 v_dot2c_f32_bf16 v53, s69, v90
 v_dot2c_f32_bf16 v54, s68, v91
 v_dot2c_f32_bf16 v55, s69, v91
 s_add_u32 s92, s47, 0x1b00000
 buffer_load_dwordx4 v[120:123], v25, s[36:39], s92 offen sc1
 s_waitcnt vmcnt(7)
 v_dot2c_f32_bf16 v48, s68, v92
 v_dot2c_f32_bf16 v49, s69, v92
 v_dot2c_f32_bf16 v50, s68, v93
 v_dot2c_f32_bf16 v51, s69, v93
 v_dot2c_f32_bf16 v52, s68, v94
 v_dot2c_f32_bf16 v53, s69, v94
 v_dot2c_f32_bf16 v54, s68, v95
 v_dot2c_f32_bf16 v55, s69, v95
 s_add_u32 s92, s47, 0x1d40000
 buffer_load_dwordx4 v[124:127], v25, s[36:39], s92 offen sc1
 s_waitcnt vmcnt(7)
 v_dot2c_f32_bf16 v48, s68, v96
 v_dot2c_f32_bf16 v49, s69, v96
 v_dot2c_f32_bf16 v50, s68, v97
 v_dot2c_f32_bf16 v51, s69, v97
 v_dot2c_f32_bf16 v52, s68, v98
 v_dot2c_f32_bf16 v53, s69, v98
 v_dot2c_f32_bf16 v54, s68, v99
 v_dot2c_f32_bf16 v55, s69, v99
 s_add_u32 s92, s47, 0x1f80000
 buffer_load_dwordx4 v[128:131], v25, s[36:39], s92 offen sc1
 s_waitcnt vmcnt(7)
 v_dot2c_f32_bf16 v48, s68, v100
 v_dot2c_f32_bf16 v49, s69, v100
 v_dot2c_f32_bf16 v50, s68, v101
 v_dot2c_f32_bf16 v51, s69, v101
 v_dot2c_f32_bf16 v52, s68, v102
 v_dot2c_f32_bf16 v53, s69, v102
 v_dot2c_f32_bf16 v54, s68, v103
 v_dot2c_f32_bf16 v55, s69, v103
 s_add_u32 s92, s47, 0x21c0000
 buffer_load_dwordx4 v[132:135], v25, s[36:39], s92 offen sc1
 s_waitcnt vmcnt(7)
 v_dot2c_f32_bf16 v48, s68, v104
 v_dot2c_f32_bf16 v49, s69, v104
 v_dot2c_f32_bf16 v50, s68, v105
 v_dot2c_f32_bf16 v51, s69, v105
 v_dot2c_f32_bf16 v52, s68, v106
 v_dot2c_f32_bf16 v53, s69, v106
 v_dot2c_f32_bf16 v54, s68, v107
 v_dot2c_f32_bf16 v55, s69, v107
 s_add_u32 s92, s47, 0x2400000
 buffer_load_dwordx4 v[136:139], v25, s[36:39], s92 offen sc1
 s_waitcnt vmcnt(7)
 v_dot2c_f32_bf16 v48, s68, v108
 v_dot2c_f32_bf16 v49, s69, v108
 v_dot2c_f32_bf16 v50, s68, v109
 v_dot2c_f32_bf16 v51, s69, v109
 v_dot2c_f32_bf16 v52, s68, v110
 v_dot2c_f32_bf16 v53, s69, v110
 v_dot2c_f32_bf16 v54, s68, v111
 v_dot2c_f32_bf16 v55, s69, v111
 s_waitcnt vmcnt(6)
 v_dot2c_f32_bf16 v48, s68, v112
 v_dot2c_f32_bf16 v49, s69, v112
 v_dot2c_f32_bf16 v50, s68, v113
 v_dot2c_f32_bf16 v51, s69, v113
 v_dot2c_f32_bf16 v52, s68, v114
 v_dot2c_f32_bf16 v53, s69, v114
 v_dot2c_f32_bf16 v54, s68, v115
 v_dot2c_f32_bf16 v55, s69, v115
 s_waitcnt vmcnt(5)
 v_lshlrev_b32 v56, 16, v116
 v_and_b32 v57, s93, v116
 v_lshlrev_b32 v58, 16, v117
 v_and_b32 v59, s93, v117
 v_lshlrev_b32 v60, 16, v118
 v_and_b32 v61, s93, v118
 v_lshlrev_b32 v62, 16, v119
 v_and_b32 v63, s93, v119
 s_waitcnt vmcnt(4)
 v_dot2c_f32_bf16 v56, s68, v120
 v_dot2c_f32_bf16 v57, s69, v120
 v_dot2c_f32_bf16 v58, s68, v121
 v_dot2c_f32_bf16 v59, s69, v121
 v_dot2c_f32_bf16 v60, s68, v122
 v_dot2c_f32_bf16 v61, s69, v122
 v_dot2c_f32_bf16 v62, s68, v123
 v_dot2c_f32_bf16 v63, s69, v123
 s_waitcnt vmcnt(3)
 v_dot2c_f32_bf16 v56, s68, v124
 v_dot2c_f32_bf16 v57, s69, v124
 v_dot2c_f32_bf16 v58, s68, v125
 v_dot2c_f32_bf16 v59, s69, v125
 v_dot2c_f32_bf16 v60, s68, v126
 v_dot2c_f32_bf16 v61, s69, v126
 v_dot2c_f32_bf16 v62, s68, v127
 v_dot2c_f32_bf16 v63, s69, v127
 s_waitcnt vmcnt(2)
 v_dot2c_f32_bf16 v56, s68, v128
 v_dot2c_f32_bf16 v57, s69, v128
 v_dot2c_f32_bf16 v58, s68, v129
 v_dot2c_f32_bf16 v59, s69, v129
 v_dot2c_f32_bf16 v60, s68, v130
 v_dot2c_f32_bf16 v61, s69, v130
 v_dot2c_f32_bf16 v62, s68, v131
 v_dot2c_f32_bf16 v63, s69, v131
 s_waitcnt vmcnt(1)
 v_dot2c_f32_bf16 v56, s68, v132
 v_dot2c_f32_bf16 v57, s69, v132
 v_dot2c_f32_bf16 v58, s68, v133
 v_dot2c_f32_bf16 v59, s69, v133
 v_dot2c_f32_bf16 v60, s68, v134
 v_dot2c_f32_bf16 v61, s69, v134
 v_dot2c_f32_bf16 v62, s68, v135
 v_dot2c_f32_bf16 v63, s69, v135
 s_waitcnt vmcnt(0)
 v_dot2c_f32_bf16 v56, s68, v136
 v_dot2c_f32_bf16 v57, s69, v136
 v_dot2c_f32_bf16 v58, s68, v137
 v_dot2c_f32_bf16 v59, s69, v137
 v_dot2c_f32_bf16 v60, s68, v138
 v_dot2c_f32_bf16 v61, s69, v138
 v_dot2c_f32_bf16 v62, s68, v139
 v_dot2c_f32_bf16 v63, s69, v139
 EX 64,56
 EX 65,57
 EX 66,58
 EX 67,59
 EX 68,60
 EX 69,61
 EX 70,62
 EX 71,63
 v_add_f32 v64, 1.0, v64
 v_add_f32 v65, 1.0, v65
 v_add_f32 v66, 1.0, v66
 v_add_f32 v67, 1.0, v67
 v_add_f32 v68, 1.0, v68
 v_add_f32 v69, 1.0, v69
 v_add_f32 v70, 1.0, v70
 v_add_f32 v71, 1.0, v71
 v_rcp_f32 v64, v64
 v_rcp_f32 v65, v65
 v_rcp_f32 v66, v66
 v_rcp_f32 v67, v67
 v_rcp_f32 v68, v68
 v_rcp_f32 v69, v69
 v_rcp_f32 v70, v70
 v_rcp_f32 v71, v71
 v_mul_f32 v56, 0xbf317218, v56
 v_mul_f32 v57, 0xbf317218, v57
 v_mul_f32 v58, 0xbf317218, v58
 v_mul_f32 v59, 0xbf317218, v59
 v_mul_f32 v60, 0xbf317218, v60
 v_mul_f32 v61, 0xbf317218, v61
 v_mul_f32 v62, 0xbf317218, v62
 v_mul_f32 v63, 0xbf317218, v63
 ML 56,56,64
 ML 57,57,65
 ML 58,58,66
 ML 59,59,67
 ML 60,60,68
 ML 61,61,69
 ML 62,62,70
 ML 63,63,71
 v_lshlrev_b32 v64, 16, v140
 v_and_b32 v65, s93, v140
 v_lshlrev_b32 v66, 16, v141
 v_and_b32 v67, s93, v141
 v_lshlrev_b32 v68, 16, v142
 v_and_b32 v69, s93, v142
 v_lshlrev_b32 v70, 16, v143
 v_and_b32 v71, s93, v143
 v_fma_f32 v64, v48, v56, v64
 v_fma_f32 v65, v49, v57, v65
 v_fma_f32 v66, v50, v58, v66
 v_fma_f32 v67, v51, v59, v67
 v_fma_f32 v68, v52, v60, v68
 v_fma_f32 v69, v53, v61, v69
 v_fma_f32 v70, v54, v62, v70
 v_fma_f32 v71, v55, v63, v71
 CV 140,64,65
 CV 141,66,67
 CV 142,68,69
 CV 143,70,71
 s_nop 0
 v_permlane16_swap_b32 v140, v142
 v_permlane16_swap_b32 v141, v143
 v_mov_b32 v64, v140
 v_mov_b32 v65, v141
 v_mov_b32_dpp v140, v142 row_ror:8 row_mask:0xf bank_mask:0xc
 v_mov_b32_dpp v141, v143 row_ror:8 row_mask:0xf bank_mask:0xc
 v_mov_b32_dpp v142, v64 row_ror:8 row_mask:0xf bank_mask:0x3
 v_mov_b32_dpp v143, v65 row_ror:8 row_mask:0xf bank_mask:0x3
 buffer_store_dwordx4 v[140:143], v28, s[48:51], s46 offen sc1
 v_mov_b32 v19, 0x10000000
 buffer_store_dword v19, v19, s[48:51], 0 offen
 s_bitset0_b64 s[74:75], s42
 s_min_u32 s92, s78, s79
 s_cmp_lt_u32 s44, s92
 s_cbranch_scc1 L_M_en1
 s_mov_b32 s81, s44
 s_mov_b32 s80, 3
 s_call_b64 s[66:67], L_M_sync
 s_cmp_eq_u32 s58, 0
 s_cbranch_scc0 L_M_fb
L_M_en1:
 s_mov_b32 s93, 0xffff0000
 buffer_load_dwordx2 v[140:141], v20, s[8:11], s60 offen
 buffer_load_dwordx2 v[142:143], v20, s[8:11], s60 offen offset:32
 s_add_u32 s92, s65, 0
 buffer_load_dwordx4 v[72:75], v25, s[36:39], s92 offen sc1
 s_add_u32 s92, s65, 0x240000
 buffer_load_dwordx4 v[76:79], v25, s[36:39], s92 offen sc1
 s_add_u32 s92, s65, 0x480000
 buffer_load_dwordx4 v[80:83], v25, s[36:39], s92 offen sc1
 s_add_u32 s92, s65, 0x6c0000
 buffer_load_dwordx4 v[84:87], v25, s[36:39], s92 offen sc1
 s_add_u32 s92, s65, 0x900000
 buffer_load_dwordx4 v[88:91], v25, s[36:39], s92 offen sc1
 s_add_u32 s92, s65, 0xb40000
 buffer_load_dwordx4 v[92:95], v25, s[36:39], s92 offen sc1
 s_add_u32 s92, s65, 0xd80000
 buffer_load_dwordx4 v[96:99], v25, s[36:39], s92 offen sc1
 s_add_u32 s92, s65, 0xfc0000
 buffer_load_dwordx4 v[100:103], v25, s[36:39], s92 offen sc1
 s_waitcnt vmcnt(7)
 v_lshlrev_b32 v48, 16, v72
 v_and_b32 v49, s93, v72
 v_lshlrev_b32 v50, 16, v73
 v_and_b32 v51, s93, v73
 v_lshlrev_b32 v52, 16, v74
 v_and_b32 v53, s93, v74
 v_lshlrev_b32 v54, 16, v75
 v_and_b32 v55, s93, v75
 s_add_u32 s92, s65, 0x1200000
 buffer_load_dwordx4 v[104:107], v25, s[36:39], s92 offen sc1
 s_waitcnt vmcnt(7)
 v_dot2c_f32_bf16 v48, s68, v76
 v_dot2c_f32_bf16 v49, s69, v76
 v_dot2c_f32_bf16 v50, s68, v77
 v_dot2c_f32_bf16 v51, s69, v77
 v_dot2c_f32_bf16 v52, s68, v78
 v_dot2c_f32_bf16 v53, s69, v78
 v_dot2c_f32_bf16 v54, s68, v79
 v_dot2c_f32_bf16 v55, s69, v79
 s_add_u32 s92, s65, 0x1440000
 buffer_load_dwordx4 v[108:111], v25, s[36:39], s92 offen sc1
 buffer_load_dword v31, v21, s[36:39], s77 offen sc1
 s_mov_b32 s93, 0xffff0000
 s_waitcnt vmcnt(8)
 v_dot2c_f32_bf16 v48, s68, v80
 v_dot2c_f32_bf16 v49, s69, v80
 v_dot2c_f32_bf16 v50, s68, v81
 v_dot2c_f32_bf16 v51, s69, v81
 v_dot2c_f32_bf16 v52, s68, v82
 v_dot2c_f32_bf16 v53, s69, v82
 v_dot2c_f32_bf16 v54, s68, v83
 v_dot2c_f32_bf16 v55, s69, v83
 s_add_u32 s92, s65, 0x1680000
 buffer_load_dwordx4 v[112:115], v25, s[36:39], s92 offen sc1
 s_waitcnt vmcnt(8)
 v_dot2c_f32_bf16 v48, s68, v84
 v_dot2c_f32_bf16 v49, s69, v84
 v_dot2c_f32_bf16 v50, s68, v85
 v_dot2c_f32_bf16 v51, s69, v85
 v_dot2c_f32_bf16 v52, s68, v86
 v_dot2c_f32_bf16 v53, s69, v86
 v_dot2c_f32_bf16 v54, s68, v87
 v_dot2c_f32_bf16 v55, s69, v87
 s_add_u32 s92, s65, 0x18c0000
 buffer_load_dwordx4 v[116:119], v25, s[36:39], s92 offen sc1
 s_waitcnt vmcnt(8)
 v_dot2c_f32_bf16 v48, s68, v88
 v_dot2c_f32_bf16 v49, s69, v88
 v_dot2c_f32_bf16 v50, s68, v89
 v_dot2c_f32_bf16 v51, s69, v89
 v_dot2c_f32_bf16 v52, s68, v90
 v_dot2c_f32_bf16 v53, s69, v90
 v_dot2c_f32_bf16 v54, s68, v91
 v_dot2c_f32_bf16 v55, s69, v91
 s_add_u32 s92, s65, 0x1b00000
 buffer_load_dwordx4 v[120:123], v25, s[36:39], s92 offen sc1
 s_waitcnt vmcnt(8)
 v_dot2c_f32_bf16 v48, s68, v92
 v_dot2c_f32_bf16 v49, s69, v92
 v_dot2c_f32_bf16 v50, s68, v93
 v_dot2c_f32_bf16 v51, s69, v93
 v_dot2c_f32_bf16 v52, s68, v94
 v_dot2c_f32_bf16 v53, s69, v94
 v_dot2c_f32_bf16 v54, s68, v95
 v_dot2c_f32_bf16 v55, s69, v95
 s_add_u32 s92, s65, 0x1d40000
 buffer_load_dwordx4 v[124:127], v25, s[36:39], s92 offen sc1
 s_waitcnt vmcnt(8)
 v_dot2c_f32_bf16 v48, s68, v96
 v_dot2c_f32_bf16 v49, s69, v96
 v_dot2c_f32_bf16 v50, s68, v97
 v_dot2c_f32_bf16 v51, s69, v97
 v_dot2c_f32_bf16 v52, s68, v98
 v_dot2c_f32_bf16 v53, s69, v98
 v_dot2c_f32_bf16 v54, s68, v99
 v_dot2c_f32_bf16 v55, s69, v99
 s_add_u32 s92, s65, 0x1f80000
 buffer_load_dwordx4 v[128:131], v25, s[36:39], s92 offen sc1
 s_waitcnt vmcnt(8)
 v_dot2c_f32_bf16 v48, s68, v100
 v_dot2c_f32_bf16 v49, s69, v100
 v_dot2c_f32_bf16 v50, s68, v101
 v_dot2c_f32_bf16 v51, s69, v101
 v_dot2c_f32_bf16 v52, s68, v102
 v_dot2c_f32_bf16 v53, s69, v102
 v_dot2c_f32_bf16 v54, s68, v103
 v_dot2c_f32_bf16 v55, s69, v103
 s_add_u32 s92, s65, 0x21c0000
 buffer_load_dwordx4 v[132:135], v25, s[36:39], s92 offen sc1
 s_waitcnt vmcnt(8)
 v_dot2c_f32_bf16 v48, s68, v104
 v_dot2c_f32_bf16 v49, s69, v104
 v_dot2c_f32_bf16 v50, s68, v105
 v_dot2c_f32_bf16 v51, s69, v105
 v_dot2c_f32_bf16 v52, s68, v106
 v_dot2c_f32_bf16 v53, s69, v106
 v_dot2c_f32_bf16 v54, s68, v107
 v_dot2c_f32_bf16 v55, s69, v107
 s_add_u32 s92, s65, 0x2400000
 buffer_load_dwordx4 v[136:139], v25, s[36:39], s92 offen sc1
 s_waitcnt vmcnt(8)
 v_dot2c_f32_bf16 v48, s68, v108
 v_dot2c_f32_bf16 v49, s69, v108
 v_dot2c_f32_bf16 v50, s68, v109
 v_dot2c_f32_bf16 v51, s69, v109
 v_dot2c_f32_bf16 v52, s68, v110
 v_dot2c_f32_bf16 v53, s69, v110
 v_dot2c_f32_bf16 v54, s68, v111
 v_dot2c_f32_bf16 v55, s69, v111
 s_waitcnt vmcnt(6)
 v_dot2c_f32_bf16 v48, s68, v112
 v_dot2c_f32_bf16 v49, s69, v112
 v_dot2c_f32_bf16 v50, s68, v113
 v_dot2c_f32_bf16 v51, s69, v113
 v_dot2c_f32_bf16 v52, s68, v114
 v_dot2c_f32_bf16 v53, s69, v114
 v_dot2c_f32_bf16 v54, s68, v115
 v_dot2c_f32_bf16 v55, s69, v115
 s_waitcnt vmcnt(5)
 v_lshlrev_b32 v56, 16, v116
 v_and_b32 v57, s93, v116
 v_lshlrev_b32 v58, 16, v117
 v_and_b32 v59, s93, v117
 v_lshlrev_b32 v60, 16, v118
 v_and_b32 v61, s93, v118
 v_lshlrev_b32 v62, 16, v119
 v_and_b32 v63, s93, v119
 s_waitcnt vmcnt(4)
 v_dot2c_f32_bf16 v56, s68, v120
 v_dot2c_f32_bf16 v57, s69, v120
 v_dot2c_f32_bf16 v58, s68, v121
 v_dot2c_f32_bf16 v59, s69, v121
 v_dot2c_f32_bf16 v60, s68, v122
 v_dot2c_f32_bf16 v61, s69, v122
 v_dot2c_f32_bf16 v62, s68, v123
 v_dot2c_f32_bf16 v63, s69, v123
 s_waitcnt vmcnt(3)
 v_dot2c_f32_bf16 v56, s68, v124
 v_dot2c_f32_bf16 v57, s69, v124
 v_dot2c_f32_bf16 v58, s68, v125
 v_dot2c_f32_bf16 v59, s69, v125
 v_dot2c_f32_bf16 v60, s68, v126
 v_dot2c_f32_bf16 v61, s69, v126
 v_dot2c_f32_bf16 v62, s68, v127
 v_dot2c_f32_bf16 v63, s69, v127
 s_waitcnt vmcnt(2)
 v_dot2c_f32_bf16 v56, s68, v128
 v_dot2c_f32_bf16 v57, s69, v128
 v_dot2c_f32_bf16 v58, s68, v129
 v_dot2c_f32_bf16 v59, s69, v129
 v_dot2c_f32_bf16 v60, s68, v130
 v_dot2c_f32_bf16 v61, s69, v130
 v_dot2c_f32_bf16 v62, s68, v131
 v_dot2c_f32_bf16 v63, s69, v131
 s_waitcnt vmcnt(1)
 v_dot2c_f32_bf16 v56, s68, v132
 v_dot2c_f32_bf16 v57, s69, v132
 v_dot2c_f32_bf16 v58, s68, v133
 v_dot2c_f32_bf16 v59, s69, v133
 v_dot2c_f32_bf16 v60, s68, v134
 v_dot2c_f32_bf16 v61, s69, v134
 v_dot2c_f32_bf16 v62, s68, v135
 v_dot2c_f32_bf16 v63, s69, v135
 s_waitcnt vmcnt(0)
 v_dot2c_f32_bf16 v56, s68, v136
 v_dot2c_f32_bf16 v57, s69, v136
 v_dot2c_f32_bf16 v58, s68, v137
 v_dot2c_f32_bf16 v59, s69, v137
 v_dot2c_f32_bf16 v60, s68, v138
 v_dot2c_f32_bf16 v61, s69, v138
 v_dot2c_f32_bf16 v62, s68, v139
 v_dot2c_f32_bf16 v63, s69, v139
 EX 64,56
 EX 65,57
 EX 66,58
 EX 67,59
 EX 68,60
 EX 69,61
 EX 70,62
 EX 71,63
 v_add_f32 v64, 1.0, v64
 v_add_f32 v65, 1.0, v65
 v_add_f32 v66, 1.0, v66
 v_add_f32 v67, 1.0, v67
 v_add_f32 v68, 1.0, v68
 v_add_f32 v69, 1.0, v69
 v_add_f32 v70, 1.0, v70
 v_add_f32 v71, 1.0, v71
 v_rcp_f32 v64, v64
 v_rcp_f32 v65, v65
 v_rcp_f32 v66, v66
 v_rcp_f32 v67, v67
 v_rcp_f32 v68, v68
 v_rcp_f32 v69, v69
 v_rcp_f32 v70, v70
 v_rcp_f32 v71, v71
 v_mul_f32 v56, 0xbf317218, v56
 v_mul_f32 v57, 0xbf317218, v57
 v_mul_f32 v58, 0xbf317218, v58
 v_mul_f32 v59, 0xbf317218, v59
 v_mul_f32 v60, 0xbf317218, v60
 v_mul_f32 v61, 0xbf317218, v61
 v_mul_f32 v62, 0xbf317218, v62
 v_mul_f32 v63, 0xbf317218, v63
 ML 56,56,64
 ML 57,57,65
 ML 58,58,66
 ML 59,59,67
 ML 60,60,68
 ML 61,61,69
 ML 62,62,70
 ML 63,63,71
 v_lshlrev_b32 v64, 16, v140
 v_and_b32 v65, s93, v140
 v_lshlrev_b32 v66, 16, v141
 v_and_b32 v67, s93, v141
 v_lshlrev_b32 v68, 16, v142
 v_and_b32 v69, s93, v142
 v_lshlrev_b32 v70, 16, v143
 v_and_b32 v71, s93, v143
 v_fma_f32 v64, v48, v56, v64
 v_fma_f32 v65, v49, v57, v65
 v_fma_f32 v66, v50, v58, v66
 v_fma_f32 v67, v51, v59, v67
 v_fma_f32 v68, v52, v60, v68
 v_fma_f32 v69, v53, v61, v69
 v_fma_f32 v70, v54, v62, v70
 v_fma_f32 v71, v55, v63, v71
 CV 140,64,65
 CV 141,66,67
 CV 142,68,69
 CV 143,70,71
 s_nop 0
 v_permlane16_swap_b32 v140, v142
 v_permlane16_swap_b32 v141, v143
 v_mov_b32 v64, v140
 v_mov_b32 v65, v141
 v_mov_b32_dpp v140, v142 row_ror:8 row_mask:0xf bank_mask:0xc
 v_mov_b32_dpp v141, v143 row_ror:8 row_mask:0xf bank_mask:0xc
 v_mov_b32_dpp v142, v64 row_ror:8 row_mask:0xf bank_mask:0x3
 v_mov_b32_dpp v143, v65 row_ror:8 row_mask:0xf bank_mask:0x3
 buffer_store_dwordx4 v[140:143], v28, s[48:51], s60 offen sc1
 v_mov_b32 v19, 0x10000000
 buffer_store_dword v19, v19, s[48:51], 0 offen
 s_bitset0_b64 s[74:75], s44
L_M_j:
 s_bitset0_b64 s[74:75], s42
 s_bitset0_b64 s[74:75], s44
L_M_fin:
 s_cmp_eq_u32 s62, 0
 s_cbranch_scc0 L_M_b4
 v_cmp_ne_u32 vcc, 0, v31
 s_nop 1
 s_mov_b32 s72, vcc_lo
 s_and_b32 s73, vcc_hi, 15
 s_or_b32 s92, s72, s73
 s_cselect_b32 s58, 1, 0
 s_cmp_ge_u32 s40, 16
 s_cselect_b32 s58, s58, 1
 s_lshl_b32 s92, s79, 8
 s_or_b32 s92, s92, s78
 s_lshl_b32 s93, s58, 16
 s_or_b32 s92, s92, s93
 v_mov_b32 v24, s92
 v_mov_b32 v23, s41
 ds_write_b32 v23, v24
 WL 0
L_M_b4:
 s_barrier
 v_mov_b32 v23, s41
 ds_read_b32 v24, v23
 WL 0
 v_readfirstlane_b32 s92, v24
 s_nop 1
 s_and_b32 s78, s92, 0xff
 s_bfe_u32 s79, s92, 0x80008
 s_lshr_b32 s58, s92, 16
 s_xor_b32 s41, s41, 12
 s_cmp_eq_u32 s58, 0
 s_cbranch_scc1 L_M_exit
L_M_fb:
 s_waitcnt vmcnt(0)
 s_cmp_eq_u32 s62, 0
 s_cbranch_scc0 L_M_fb2
 s_mov_b64 s[98:99], s[74:75]
 v_mov_b32 v18, 1
 v_lshlrev_b32 v19, 4, v0
 v_mov_b32 v24, 0x10000000
 v_cmp_gt_u32 vcc, 0x100, v0
 s_nop 1
 v_cndmask_b32 v19, v24, v19, vcc
L_M_mk:
 s_cmp_eq_u64 s[98:99], 0
 s_cbranch_scc1 L_M_mk1
 s_ff1_i32_b64 s92, s[98:99]
 s_bitset0_b64 s[98:99], s92
 s_lshl2_add_u32 s92, s92, s82
 s_add_u32 s92, s92, 0x1000
 buffer_store_dword v18, v19, s[36:39], s92 offen sc1
 s_branch L_M_mk
L_M_mk1:
 s_waitcnt vmcnt(0)
 v_mov_b32 v17, 0
 buffer_atomic_add v17, v22, s[52:55], 0 offen sc0 sc1
 s_waitcnt vmcnt(0)
 v_mov_b32 v19, 0x10000000
 s_mov_b32 s92, 0x90
 v_writelane_b32 v19, s92, 1
 buffer_store_dword v18, v19, s[36:39], s77 offen sc1
 v_mov_b32 v24, 0
 v_mov_b32 v19, 0x10000000
 v_writelane_b32 v19, 0, 0
 buffer_atomic_add v24, v19, s[36:39], s77 offen sc1
 s_waitcnt vmcnt(0)
 buffer_load_dword v31, v21, s[36:39], s77 offen sc1
 buffer_store_dword v26, v26, s[36:39], s82 offen sc1
 buffer_load_dword v16, v21, s[36:39], s82 offen sc1
 s_waitcnt vmcnt(0)
 v_readfirstlane_b32 s40, v17
 v_cmp_ne_u32 vcc, 0, v16
 s_nop 1
 s_lshr_b64 s[72:73], vcc, 18
 s_and_b32 s73, s73, 15
 s_mov_b32 s78, 0
 s_mov_b32 s79, 0
 v_cmp_ge_u32 vcc, 0, v16
 s_nop 1
 s_and_b32 s92, vcc_lo, 0x7ff
 s_cselect_b32 s78, s78, 4
 s_and_b32 s92, vcc_lo, 0x1f800
 s_cselect_b32 s79, s79, 4
 v_cmp_ge_u32 vcc, 1, v16
 s_nop 1
 s_and_b32 s92, vcc_lo, 0x7ff
 s_cselect_b32 s78, s78, 8
 s_and_b32 s92, vcc_lo, 0x1f800
 s_cselect_b32 s79, s79, 8
 v_cmp_ge_u32 vcc, 2, v16
 s_nop 1
 s_and_b32 s92, vcc_lo, 0x7ff
 s_cselect_b32 s78, s78, 12
 s_and_b32 s92, vcc_lo, 0x1f800
 s_cselect_b32 s79, s79, 12
 v_cmp_ge_u32 vcc, 3, v16
 s_nop 1
 s_and_b32 s92, vcc_lo, 0x7ff
 s_cselect_b32 s78, s78, 16
 s_and_b32 s92, vcc_lo, 0x1f800
 s_cselect_b32 s79, s79, 16
 v_cmp_ge_u32 vcc, 4, v16
 s_nop 1
 s_and_b32 s92, vcc_lo, 0x7ff
 s_cselect_b32 s78, s78, 20
 s_and_b32 s92, vcc_lo, 0x1f800
 s_cselect_b32 s79, s79, 20
 v_cmp_ge_u32 vcc, 5, v16
 s_nop 1
 s_and_b32 s92, vcc_lo, 0x7ff
 s_cselect_b32 s78, s78, 24
 s_and_b32 s92, vcc_lo, 0x1f800
 s_cselect_b32 s79, s79, 24
 v_cmp_ge_u32 vcc, 6, v16
 s_nop 1
 s_and_b32 s92, vcc_lo, 0x7ff
 s_cselect_b32 s78, s78, 28
 s_and_b32 s92, vcc_lo, 0x1f800
 s_cselect_b32 s79, s79, 28
 v_cmp_ge_u32 vcc, 7, v16
 s_nop 1
 s_and_b32 s92, vcc_lo, 0x7ff
 s_cselect_b32 s78, s78, 32
 s_and_b32 s92, vcc_lo, 0x1f800
 s_cselect_b32 s79, s79, 32
 v_cmp_ge_u32 vcc, 8, v16
 s_nop 1
 s_and_b32 s92, vcc_lo, 0x7ff
 s_cselect_b32 s78, s78, 36
 s_and_b32 s92, vcc_lo, 0x1f800
 s_cselect_b32 s79, s79, 36
 v_cmp_ne_u32 vcc, 0, v31
 s_nop 1
 s_mov_b32 s72, vcc_lo
 s_and_b32 s73, vcc_hi, 15
 s_min_u32 s92, s78, s79
 s_cmp_ge_u32 s40, 16
 s_cselect_b32 s92, s92, 0
 s_bfm_b64 s[98:99], s92, 0
 s_or_b64 s[72:73], s[72:73], s[74:75]
 s_and_b64 s[72:73], s[72:73], s[98:99]
L_M_fb1:
 s_ff1_i32_b64 s78, s[72:73]
 s_and_b32 s78, s78, 0xff
 s_bitset0_b64 s[72:73], s78
 s_lshl_b32 s92, s79, 8
 s_or_b32 s92, s92, s78
 s_lshl_b32 s93, s58, 16
 s_or_b32 s92, s92, s93
 v_mov_b32 v24, s92
 v_mov_b32 v23, s41
 ds_write_b32 v23, v24
 WL 0
L_M_fb2:
 s_barrier
 v_mov_b32 v23, s41
 ds_read_b32 v24, v23
 WL 0
 v_readfirstlane_b32 s92, v24
 s_nop 1
 s_and_b32 s78, s92, 0xff
 s_bfe_u32 s79, s92, 0x80008
 s_lshr_b32 s58, s92, 16
 s_xor_b32 s41, s41, 12
 s_cmp_ge_u32 s78, 36
 s_cbranch_scc1 L_M_exit
 s_and_b32 s92, s78, 3
 s_lshr_b32 s80, s78, 2
 s_lshl_b32 s93, s64, 2
 s_add_u32 s92, s92, s93
 s_mul_i32 s47, s92, 0x9000
 s_add_u32 s46, s47, s59
 s_lshl_b32 s93, s80, 12
 s_add_u32 s93, s93, s3
 s_add_u32 s47, s47, s93
 s_lshl_b32 s93, s80, 7
 s_add_u32 s46, s46, s93
 s_add_u32 s92, s47, 0
 buffer_load_dwordx4 v[72:75], v25, s[36:39], s92 offen sc1
 s_add_u32 s92, s47, 0x240000
 buffer_load_dwordx4 v[76:79], v25, s[36:39], s92 offen sc1
 s_add_u32 s92, s47, 0x480000
 buffer_load_dwordx4 v[80:83], v25, s[36:39], s92 offen sc1
 s_add_u32 s92, s47, 0x6c0000
 buffer_load_dwordx4 v[84:87], v25, s[36:39], s92 offen sc1
 s_add_u32 s92, s47, 0x900000
 buffer_load_dwordx4 v[88:91], v25, s[36:39], s92 offen sc1
 s_add_u32 s92, s47, 0xb40000
 buffer_load_dwordx4 v[92:95], v25, s[36:39], s92 offen sc1
 s_add_u32 s92, s47, 0xd80000
 buffer_load_dwordx4 v[96:99], v25, s[36:39], s92 offen sc1
 s_add_u32 s92, s47, 0xfc0000
 buffer_load_dwordx4 v[100:103], v25, s[36:39], s92 offen sc1
 s_add_u32 s92, s47, 0x1200000
 buffer_load_dwordx4 v[104:107], v25, s[36:39], s92 offen sc1
 s_add_u32 s92, s47, 0x1440000
 buffer_load_dwordx4 v[108:111], v25, s[36:39], s92 offen sc1
 s_add_u32 s92, s47, 0x1680000
 buffer_load_dwordx4 v[112:115], v25, s[36:39], s92 offen sc1
 s_add_u32 s92, s47, 0x18c0000
 buffer_load_dwordx4 v[116:119], v25, s[36:39], s92 offen sc1
 s_add_u32 s92, s47, 0x1b00000
 buffer_load_dwordx4 v[120:123], v25, s[36:39], s92 offen sc1
 s_add_u32 s92, s47, 0x1d40000
 buffer_load_dwordx4 v[124:127], v25, s[36:39], s92 offen sc1
 s_add_u32 s92, s47, 0x1f80000
 buffer_load_dwordx4 v[128:131], v25, s[36:39], s92 offen sc1
 s_add_u32 s92, s47, 0x21c0000
 buffer_load_dwordx4 v[132:135], v25, s[36:39], s92 offen sc1
 s_add_u32 s92, s47, 0x2400000
 buffer_load_dwordx4 v[136:139], v25, s[36:39], s92 offen sc1
 buffer_load_dwordx2 v[140:141], v20, s[8:11], s46 offen
 buffer_load_dwordx2 v[142:143], v20, s[8:11], s46 offen offset:32
 s_waitcnt vmcnt(0)
 s_mov_b32 s93, 0xffff0000
 s_waitcnt vmcnt(18)
 v_lshlrev_b32 v48, 16, v72
 v_and_b32 v49, s93, v72
 v_lshlrev_b32 v50, 16, v73
 v_and_b32 v51, s93, v73
 v_lshlrev_b32 v52, 16, v74
 v_and_b32 v53, s93, v74
 v_lshlrev_b32 v54, 16, v75
 v_and_b32 v55, s93, v75
 s_waitcnt vmcnt(17)
 v_dot2c_f32_bf16 v48, s68, v76
 v_dot2c_f32_bf16 v49, s69, v76
 v_dot2c_f32_bf16 v50, s68, v77
 v_dot2c_f32_bf16 v51, s69, v77
 v_dot2c_f32_bf16 v52, s68, v78
 v_dot2c_f32_bf16 v53, s69, v78
 v_dot2c_f32_bf16 v54, s68, v79
 v_dot2c_f32_bf16 v55, s69, v79
 s_waitcnt vmcnt(16)
 v_dot2c_f32_bf16 v48, s68, v80
 v_dot2c_f32_bf16 v49, s69, v80
 v_dot2c_f32_bf16 v50, s68, v81
 v_dot2c_f32_bf16 v51, s69, v81
 v_dot2c_f32_bf16 v52, s68, v82
 v_dot2c_f32_bf16 v53, s69, v82
 v_dot2c_f32_bf16 v54, s68, v83
 v_dot2c_f32_bf16 v55, s69, v83
 s_waitcnt vmcnt(15)
 v_dot2c_f32_bf16 v48, s68, v84
 v_dot2c_f32_bf16 v49, s69, v84
 v_dot2c_f32_bf16 v50, s68, v85
 v_dot2c_f32_bf16 v51, s69, v85
 v_dot2c_f32_bf16 v52, s68, v86
 v_dot2c_f32_bf16 v53, s69, v86
 v_dot2c_f32_bf16 v54, s68, v87
 v_dot2c_f32_bf16 v55, s69, v87
 s_waitcnt vmcnt(14)
 v_dot2c_f32_bf16 v48, s68, v88
 v_dot2c_f32_bf16 v49, s69, v88
 v_dot2c_f32_bf16 v50, s68, v89
 v_dot2c_f32_bf16 v51, s69, v89
 v_dot2c_f32_bf16 v52, s68, v90
 v_dot2c_f32_bf16 v53, s69, v90
 v_dot2c_f32_bf16 v54, s68, v91
 v_dot2c_f32_bf16 v55, s69, v91
 s_waitcnt vmcnt(13)
 v_dot2c_f32_bf16 v48, s68, v92
 v_dot2c_f32_bf16 v49, s69, v92
 v_dot2c_f32_bf16 v50, s68, v93
 v_dot2c_f32_bf16 v51, s69, v93
 v_dot2c_f32_bf16 v52, s68, v94
 v_dot2c_f32_bf16 v53, s69, v94
 v_dot2c_f32_bf16 v54, s68, v95
 v_dot2c_f32_bf16 v55, s69, v95
 s_waitcnt vmcnt(12)
 v_dot2c_f32_bf16 v48, s68, v96
 v_dot2c_f32_bf16 v49, s69, v96
 v_dot2c_f32_bf16 v50, s68, v97
 v_dot2c_f32_bf16 v51, s69, v97
 v_dot2c_f32_bf16 v52, s68, v98
 v_dot2c_f32_bf16 v53, s69, v98
 v_dot2c_f32_bf16 v54, s68, v99
 v_dot2c_f32_bf16 v55, s69, v99
 s_waitcnt vmcnt(11)
 v_dot2c_f32_bf16 v48, s68, v100
 v_dot2c_f32_bf16 v49, s69, v100
 v_dot2c_f32_bf16 v50, s68, v101
 v_dot2c_f32_bf16 v51, s69, v101
 v_dot2c_f32_bf16 v52, s68, v102
 v_dot2c_f32_bf16 v53, s69, v102
 v_dot2c_f32_bf16 v54, s68, v103
 v_dot2c_f32_bf16 v55, s69, v103
 s_waitcnt vmcnt(10)
 v_dot2c_f32_bf16 v48, s68, v104
 v_dot2c_f32_bf16 v49, s69, v104
 v_dot2c_f32_bf16 v50, s68, v105
 v_dot2c_f32_bf16 v51, s69, v105
 v_dot2c_f32_bf16 v52, s68, v106
 v_dot2c_f32_bf16 v53, s69, v106
 v_dot2c_f32_bf16 v54, s68, v107
 v_dot2c_f32_bf16 v55, s69, v107
 s_waitcnt vmcnt(9)
 v_dot2c_f32_bf16 v48, s68, v108
 v_dot2c_f32_bf16 v49, s69, v108
 v_dot2c_f32_bf16 v50, s68, v109
 v_dot2c_f32_bf16 v51, s69, v109
 v_dot2c_f32_bf16 v52, s68, v110
 v_dot2c_f32_bf16 v53, s69, v110
 v_dot2c_f32_bf16 v54, s68, v111
 v_dot2c_f32_bf16 v55, s69, v111
 s_waitcnt vmcnt(8)
 v_dot2c_f32_bf16 v48, s68, v112
 v_dot2c_f32_bf16 v49, s69, v112
 v_dot2c_f32_bf16 v50, s68, v113
 v_dot2c_f32_bf16 v51, s69, v113
 v_dot2c_f32_bf16 v52, s68, v114
 v_dot2c_f32_bf16 v53, s69, v114
 v_dot2c_f32_bf16 v54, s68, v115
 v_dot2c_f32_bf16 v55, s69, v115
 s_waitcnt vmcnt(7)
 v_lshlrev_b32 v56, 16, v116
 v_and_b32 v57, s93, v116
 v_lshlrev_b32 v58, 16, v117
 v_and_b32 v59, s93, v117
 v_lshlrev_b32 v60, 16, v118
 v_and_b32 v61, s93, v118
 v_lshlrev_b32 v62, 16, v119
 v_and_b32 v63, s93, v119
 s_waitcnt vmcnt(6)
 v_dot2c_f32_bf16 v56, s68, v120
 v_dot2c_f32_bf16 v57, s69, v120
 v_dot2c_f32_bf16 v58, s68, v121
 v_dot2c_f32_bf16 v59, s69, v121
 v_dot2c_f32_bf16 v60, s68, v122
 v_dot2c_f32_bf16 v61, s69, v122
 v_dot2c_f32_bf16 v62, s68, v123
 v_dot2c_f32_bf16 v63, s69, v123
 s_waitcnt vmcnt(5)
 v_dot2c_f32_bf16 v56, s68, v124
 v_dot2c_f32_bf16 v57, s69, v124
 v_dot2c_f32_bf16 v58, s68, v125
 v_dot2c_f32_bf16 v59, s69, v125
 v_dot2c_f32_bf16 v60, s68, v126
 v_dot2c_f32_bf16 v61, s69, v126
 v_dot2c_f32_bf16 v62, s68, v127
 v_dot2c_f32_bf16 v63, s69, v127
 s_waitcnt vmcnt(4)
 v_dot2c_f32_bf16 v56, s68, v128
 v_dot2c_f32_bf16 v57, s69, v128
 v_dot2c_f32_bf16 v58, s68, v129
 v_dot2c_f32_bf16 v59, s69, v129
 v_dot2c_f32_bf16 v60, s68, v130
 v_dot2c_f32_bf16 v61, s69, v130
 v_dot2c_f32_bf16 v62, s68, v131
 v_dot2c_f32_bf16 v63, s69, v131
 s_waitcnt vmcnt(3)
 v_dot2c_f32_bf16 v56, s68, v132
 v_dot2c_f32_bf16 v57, s69, v132
 v_dot2c_f32_bf16 v58, s68, v133
 v_dot2c_f32_bf16 v59, s69, v133
 v_dot2c_f32_bf16 v60, s68, v134
 v_dot2c_f32_bf16 v61, s69, v134
 v_dot2c_f32_bf16 v62, s68, v135
 v_dot2c_f32_bf16 v63, s69, v135
 s_waitcnt vmcnt(2)
 v_dot2c_f32_bf16 v56, s68, v136
 v_dot2c_f32_bf16 v57, s69, v136
 v_dot2c_f32_bf16 v58, s68, v137
 v_dot2c_f32_bf16 v59, s69, v137
 v_dot2c_f32_bf16 v60, s68, v138
 v_dot2c_f32_bf16 v61, s69, v138
 v_dot2c_f32_bf16 v62, s68, v139
 v_dot2c_f32_bf16 v63, s69, v139
 EX 64,56
 EX 65,57
 EX 66,58
 EX 67,59
 EX 68,60
 EX 69,61
 EX 70,62
 EX 71,63
 v_add_f32 v64, 1.0, v64
 v_add_f32 v65, 1.0, v65
 v_add_f32 v66, 1.0, v66
 v_add_f32 v67, 1.0, v67
 v_add_f32 v68, 1.0, v68
 v_add_f32 v69, 1.0, v69
 v_add_f32 v70, 1.0, v70
 v_add_f32 v71, 1.0, v71
 v_rcp_f32 v64, v64
 v_rcp_f32 v65, v65
 v_rcp_f32 v66, v66
 v_rcp_f32 v67, v67
 v_rcp_f32 v68, v68
 v_rcp_f32 v69, v69
 v_rcp_f32 v70, v70
 v_rcp_f32 v71, v71
 v_mul_f32 v56, 0xbf317218, v56
 v_mul_f32 v57, 0xbf317218, v57
 v_mul_f32 v58, 0xbf317218, v58
 v_mul_f32 v59, 0xbf317218, v59
 v_mul_f32 v60, 0xbf317218, v60
 v_mul_f32 v61, 0xbf317218, v61
 v_mul_f32 v62, 0xbf317218, v62
 v_mul_f32 v63, 0xbf317218, v63
 ML 56,56,64
 ML 57,57,65
 ML 58,58,66
 ML 59,59,67
 ML 60,60,68
 ML 61,61,69
 ML 62,62,70
 ML 63,63,71
 s_waitcnt vmcnt(0)
 v_lshlrev_b32 v64, 16, v140
 v_and_b32 v65, s93, v140
 v_lshlrev_b32 v66, 16, v141
 v_and_b32 v67, s93, v141
 v_lshlrev_b32 v68, 16, v142
 v_and_b32 v69, s93, v142
 v_lshlrev_b32 v70, 16, v143
 v_and_b32 v71, s93, v143
 v_fma_f32 v64, v48, v56, v64
 v_fma_f32 v65, v49, v57, v65
 v_fma_f32 v66, v50, v58, v66
 v_fma_f32 v67, v51, v59, v67
 v_fma_f32 v68, v52, v60, v68
 v_fma_f32 v69, v53, v61, v69
 v_fma_f32 v70, v54, v62, v70
 v_fma_f32 v71, v55, v63, v71
 CV 140,64,65
 CV 141,66,67
 CV 142,68,69
 CV 143,70,71
 s_nop 0
 v_permlane16_swap_b32 v140, v142
 v_permlane16_swap_b32 v141, v143
 v_mov_b32 v64, v140
 v_mov_b32 v65, v141
 v_mov_b32_dpp v140, v142 row_ror:8 row_mask:0xf bank_mask:0xc
 v_mov_b32_dpp v141, v143 row_ror:8 row_mask:0xf bank_mask:0xc
 v_mov_b32_dpp v142, v64 row_ror:8 row_mask:0xf bank_mask:0x3
 v_mov_b32_dpp v143, v65 row_ror:8 row_mask:0xf bank_mask:0x3
 buffer_store_dwordx4 v[140:143], v28, s[48:51], s46 offen sc1
 v_mov_b32 v19, 0x10000000
 buffer_store_dword v19, v19, s[48:51], 0 offen
 s_cmp_eq_u32 s62, 0
 s_cbranch_scc1 L_M_fb1
 s_branch L_M_fb2
L_M_exit:
 s_endpgm
L_M_sync:
 s_cmp_eq_u32 s62, 0
 s_cbranch_scc0 L_M_sy2
 s_mov_b32 s71, 0
 buffer_store_dword v29, v29, s[36:39], s76 offen sc1
L_M_sy0:
 s_cmp_ge_u32 s40, 16
 s_cbranch_scc1 L_M_sy1
 v_mov_b32 v17, 0
 buffer_atomic_add v17, v22, s[52:55], 0 offen sc0 sc1
 s_waitcnt vmcnt(0)
 v_readfirstlane_b32 s40, v17
 s_nop 1
 s_cmp_ge_u32 s40, 16
 s_cbranch_scc0 L_M_syw
L_M_sy1:
 buffer_load_dword v16, v30, s[36:39], s76 offen sc1
 buffer_store_dword v29, v29, s[36:39], s76 offen sc1
 s_waitcnt vmcnt(1)
 v_cmp_ne_u32 vcc, 0, v16
 s_nop 1
 s_lshr_b64 s[72:73], vcc, 18
 s_and_b32 s73, s73, 15
 s_mov_b32 s78, 0
 s_mov_b32 s79, 0
 v_cmp_ge_u32 vcc, 0, v16
 s_nop 1
 s_and_b32 s92, vcc_lo, 0x7ff
 s_cselect_b32 s78, s78, 4
 s_and_b32 s92, vcc_lo, 0x1f800
 s_cselect_b32 s79, s79, 4
 v_cmp_ge_u32 vcc, 1, v16
 s_nop 1
 s_and_b32 s92, vcc_lo, 0x7ff
 s_cselect_b32 s78, s78, 8
 s_and_b32 s92, vcc_lo, 0x1f800
 s_cselect_b32 s79, s79, 8
 v_cmp_ge_u32 vcc, 2, v16
 s_nop 1
 s_and_b32 s92, vcc_lo, 0x7ff
 s_cselect_b32 s78, s78, 12
 s_and_b32 s92, vcc_lo, 0x1f800
 s_cselect_b32 s79, s79, 12
 v_cmp_ge_u32 vcc, 3, v16
 s_nop 1
 s_and_b32 s92, vcc_lo, 0x7ff
 s_cselect_b32 s78, s78, 16
 s_and_b32 s92, vcc_lo, 0x1f800
 s_cselect_b32 s79, s79, 16
 v_cmp_ge_u32 vcc, 4, v16
 s_nop 1
 s_and_b32 s92, vcc_lo, 0x7ff
 s_cselect_b32 s78, s78, 20
 s_and_b32 s92, vcc_lo, 0x1f800
 s_cselect_b32 s79, s79, 20
 v_cmp_ge_u32 vcc, 5, v16
 s_nop 1
 s_and_b32 s92, vcc_lo, 0x7ff
 s_cselect_b32 s78, s78, 24
 s_and_b32 s92, vcc_lo, 0x1f800
 s_cselect_b32 s79, s79, 24
 v_cmp_ge_u32 vcc, 6, v16
 s_nop 1
 s_and_b32 s92, vcc_lo, 0x7ff
 s_cselect_b32 s78, s78, 28
 s_and_b32 s92, vcc_lo, 0x1f800
 s_cselect_b32 s79, s79, 28
 v_cmp_ge_u32 vcc, 7, v16
 s_nop 1
 s_and_b32 s92, vcc_lo, 0x7ff
 s_cselect_b32 s78, s78, 32
 s_and_b32 s92, vcc_lo, 0x1f800
 s_cselect_b32 s79, s79, 32
 v_cmp_ge_u32 vcc, 8, v16
 s_nop 1
 s_and_b32 s92, vcc_lo, 0x7ff
 s_cselect_b32 s78, s78, 36
 s_and_b32 s92, vcc_lo, 0x1f800
 s_cselect_b32 s79, s79, 36
 s_bitcmp1_b32 s80, 0
 s_cselect_b32 s92, s78, 36
 s_bitcmp1_b32 s80, 1
 s_cselect_b32 s93, s79, 36
 s_min_u32 s92, s92, s93
 s_cmp_lt_u32 s81, s92
 s_cbranch_scc1 L_M_syp
L_M_syw:
 s_add_u32 s71, s71, 1
 s_cmp_gt_u32 s71, 0xfa0
 s_cselect_b32 s58, 1, 0
 s_cbranch_scc1 L_M_syp
 s_sleep 1
 s_branch L_M_sy0
L_M_syp:
 s_lshl_b32 s92, s79, 8
 s_or_b32 s92, s92, s78
 s_lshl_b32 s93, s58, 16
 s_or_b32 s92, s92, s93
 v_mov_b32 v24, s92
 v_mov_b32 v23, s41
 ds_write_b32 v23, v24
 WL 0
L_M_sy2:
 s_barrier
 v_mov_b32 v23, s41
 ds_read_b32 v24, v23
 WL 0
 v_readfirstlane_b32 s92, v24
 s_nop 1
 s_and_b32 s78, s92, 0xff
 s_bfe_u32 s79, s92, 0x80008
 s_lshr_b32 s58, s92, 16
 s_xor_b32 s41, s41, 12
 s_setpc_b64 s[66:67]
L_roleM_end:
.section .rodata,"a"
.p2align 6
.amdhsa_kernel recurrent_scan__sliding_block_cached__dense_activation_silu__prompt_kernel
  .amdhsa_next_free_vgpr 512
  .amdhsa_next_free_sgpr 102
  .amdhsa_accum_offset 256
  .amdhsa_group_segment_fixed_size 0
  .amdhsa_kernarg_size 88
  .amdhsa_user_sgpr_count 2
  .amdhsa_user_sgpr_kernarg_segment_ptr 1
  .amdhsa_system_sgpr_workgroup_id_x 1
.end_amdhsa_kernel
```
